```python
import torch

def _softmax(x, axis=-1):
    return torch.softmax(x, dim=axis)
def _gelu(x):
    return torch.nn.functional.gelu(x, approximate="tanh")
def _silu(x):
    return torch.nn.functional.silu(x)
def _sigmoid(x):
    return torch.sigmoid(x)
def _layernorm(x, axis=-1, eps=1e-5):
    m = x.mean(dim=axis, keepdim=True)
    v = x.var(dim=axis, keepdim=True, unbiased=False)
    return (x - m) / torch.sqrt(v + eps)
def _scatter_add(tgt, idx, src, axis=0):
    return tgt.clone().index_add_(axis, idx, src)
def _segment_sum(src, seg, n):
    out = torch.zeros((n,) + src.shape[1:], dtype=src.dtype)
    return out.index_add_(0, seg, src)
def _pad(x, pw):
    flat = tuple(v for pair in reversed(pw) for v in pair)
    return torch.nn.functional.pad(x, flat)

kernel_name = 'recurrent_scan__gqa_block_cached__glu_gated_reglu__prompt'

def setup_inputs():

    _w = (lambda a: (lambda t: t.to(torch.bfloat16) if t.is_floating_point() else t)(torch.as_tensor(a)))
    def _A_setup():
        B, Sq, D = 1, 2048, 576
        Hq, Hkv, Sk, Dh = 32, 16, 2048, 128
        assert Hq % Hkv == 0, (Hq, Hkv)
        return {
            "x": _w((lambda *s: torch.randn(*s, dtype=torch.bfloat16) * 0.05)(B, Sq, D)),
            "k_cache": _w((lambda *s: torch.randn(*s, dtype=torch.bfloat16) * 1.6)(B, Hkv, Sk, Dh)),
            "v_cache": _w((lambda *s: torch.randn(*s, dtype=torch.bfloat16) * 1.6)(B, Hkv, Sk, Dh)),
            "wq": _w((lambda *s: torch.randn(*s, dtype=torch.bfloat16) * 1.6)(D, Hq * Dh) * (D ** -0.5)),
            "wo": _w((lambda *s: torch.randn(*s, dtype=torch.bfloat16) * 1.6)(Hq * Dh, D) * ((Hq * Dh) ** -0.5)),
        }
    _A_in = _A_setup()

    def _B_setup():
        B, S, D, F = 1, 2048, 576, 4608
        return {
            "x": _w((lambda *s: torch.randn(*s, dtype=torch.bfloat16) * 0.05)(B, S, D)),
            "W_gate": _w((lambda *s: torch.randn(*s, dtype=torch.bfloat16) * 0.2)(D, F) * (2.0 / D) ** 0.5),
            "W_up": _w((lambda *s: torch.randn(*s, dtype=torch.bfloat16) * 0.2)(D, F) * (2.0 / D) ** 0.5),
            "W_down": _w((lambda *s: torch.randn(*s, dtype=torch.bfloat16) * 0.2)(F, D) * (1.0 / F) ** 0.5),
        }
    _B_in = _B_setup()

    return {
        "A_x": _A_in["x"],
        "A_k_cache": _A_in["k_cache"],
        "A_v_cache": _A_in["v_cache"],
        "A_wq": _A_in["wq"],
        "A_wo": _A_in["wo"],
        "B_x": _B_in["x"],
        "B_W_gate": _B_in["W_gate"],
        "B_W_up": _B_in["W_up"],
        "B_W_down": _B_in["W_down"],
    }

def reference(A_x, A_k_cache, A_v_cache, A_wq, A_wo, B_x, B_W_gate, B_W_up, B_W_down):
    def _A_ref(x, k_cache, v_cache, wq, wo):
        B, Sq, D = x.shape
        Hq, Dh = 32, 128
        Hkv = k_cache.shape[1]
        rep = Hq // Hkv
        q = (lambda x, *d: x.permute(*d))((x @ wq).reshape(B, Sq, Hq, Dh), 0, 2, 1, 3)
        k = (lambda x, n, axis: torch.repeat_interleave(x, n, dim=axis))(k_cache, rep, axis=1)
        v = (lambda x, n, axis: torch.repeat_interleave(x, n, dim=axis))(v_cache, rep, axis=1)
        scores = torch.einsum("bhqd,bhkd->bhqk", q, k) * (Dh ** -0.5)
        p = _softmax(scores, axis=-1)
        o = torch.einsum("bhqk,bhkd->bhqd", p, v)
        return (lambda x, *d: x.permute(*d))(o, 0, 2, 1, 3).reshape(B, Sq, Hq * Dh) @ wo

    def _B_ref(x, W_gate, W_up, W_down):
        gate = torch.einsum("bsd,df->bsf", x, W_gate)
        up = torch.einsum("bsd,df->bsf", x, W_up)
        gate = gate * (lambda x, dt: x.to(dt))(gate > 0, gate.dtype)
        h = gate * up
        return torch.einsum("bsf,fd->bsd", h, W_down)

    x = A_x
    xn = _layernorm(x, axis=-1)
    s = _A_ref(xn, A_k_cache, A_v_cache, A_wq, A_wo)
    g = _silu(_B_ref(xn, B_W_gate, B_W_up, B_W_down))
    return x + s * g
```

```asm
; @launch grid=(256,1,1) block=(256,1,1) lds=163840
.amdgcn_target "amdgcn-amd-amdhsa--gfx950"
.text
.globl recurrent_scan__gqa_block_cached__glu_gated_reglu__prompt_kernel
.p2align 8
.type recurrent_scan__gqa_block_cached__glu_gated_reglu__prompt_kernel,@function
recurrent_scan__gqa_block_cached__glu_gated_reglu__prompt_kernel:

    s_cmp_ge_u32 s2, 256
    s_cbranch_scc0 mk_go
    s_endpgm
mk_go:
    s_load_dwordx4 s[4:7], s[0:1], 8
    s_load_dwordx2 s[8:9], s[0:1], 24
    s_load_dwordx4 s[20:23], s[0:1], 48
    s_load_dwordx2 s[10:11], s[0:1], 88
    s_load_dwordx2 s[26:27], s[0:1], 0
    s_load_dwordx2 s[28:29], s[0:1], 72
    s_load_dwordx2 s[30:31], s[0:1], 32
    s_load_dwordx2 s[96:97], s[0:1], 64
    s_load_dwordx2 s[32:33], s[0:1], 80
    v_lshrrev_b32 v1, 6, v0
    v_and_b32 v2, 63, v0
    v_readfirstlane_b32 s12, v1
    s_and_b32 s53, s2, 7
    s_lshr_b32 s54, s2, 3
    s_and_b32 s55, s54, 3
    s_lshl_b32 s13, s53, 2
    s_add_u32 s13, s13, s55
    s_lshr_b32 s14, s54, 2
    s_lshr_b32 s15, s13, 1
    s_lshl_b32 s15, s15, 19
    v_lshlrev_b32 v3, 4, v2
    v_mov_b32 v254, 1
    v_mov_b32 v255, 0
    s_waitcnt lgkmcnt(0)
    s_lshl_b32 s98, s14, 5
    s_mov_b32 s84, s26
    s_mov_b32 s85, s27
    s_mov_b32 s86, 2359296
    s_mov_b32 s87, 0x20000
    v_and_b32 v22, 7, v2
    v_bfe_u32 v23, v2, 3, 2
    v_mul_u32_u24 v20, 1152, v22
    v_lshl_add_u32 v20, v23, 3, v20
    v_lshlrev_b32 v21, 4, v22
    v_lshl_add_u32 v21, v23, 8, v21
    v_lshrrev_b32 v23, 5, v2
    v_lshl_add_u32 v20, v23, 6, v20
    v_lshl_add_u32 v21, v23, 12, v21
    s_lshl_b32 s99, s14, 5
    s_add_u32 s99, s99, s13
    s_mul_i32 s99, s99, 9216
    s_lshl_b32 s100, s12, 7
    s_add_u32 s99, s99, s100
    s_cmp_eq_u32 s12, 0
    s_cselect_b32 s100, 0, 0x10000000
    s_add_u32 s101, s99, s100
    buffer_load_dwordx2 v[8:9], v20, s[84:87], s99 offen offset:0
    buffer_load_dwordx2 v[10:11], v20, s[84:87], s99 offen offset:32
    buffer_load_dwordx2 v[12:13], v20, s[84:87], s99 offen offset:512
    buffer_load_dwordx2 v[14:15], v20, s[84:87], s99 offen offset:544
    buffer_load_dwordx2 v[16:17], v20, s[84:87], s101 offen offset:1024
    buffer_load_dwordx2 v[18:19], v20, s[84:87], s101 offen offset:1056
    s_add_u32 s36, s4, s15
    s_addc_u32 s37, s5, 0
    s_mov_b32 s38, 524288
    s_mov_b32 s39, 0x20000
    s_add_u32 s40, s6, s15
    s_addc_u32 s41, s7, 0
    s_mov_b32 s42, 524288
    s_mov_b32 s43, 0x20000
    s_mov_b32 s16, s10
    s_mov_b32 s17, s11
    s_mov_b32 s18, 134217728
    s_mov_b32 s19, 0x20000
    s_mov_b32 s34, 256
    s_mov_b32 s35, 0x20000
    s_lshl_b32 s24, s14, 2
    s_lshr_b32 s25, s13, 3
    s_add_u32 s24, s24, s25
    s_lshl_b32 s24, s24, 2
    s_add_u32 s24, s24, s12
    s_lshl_b32 s24, s24, 7
    s_and_b32 s25, s13, 7
    s_lshl_b32 s25, s25, 2
    s_add_u32 s24, s24, s25
    s_add_u32 s56, s24, 100663296
    s_add_u32 s57, s56, 16384
    s_and_b32 s24, s53, 3
    s_lshl_b32 s25, s14, 2
    s_add_u32 s24, s24, s25
    s_lshl_b32 s24, s24, 2
    s_add_u32 s24, s24, s12
    s_lshl_b32 s24, s24, 7
    s_cmp_lt_u32 s53, 4
    s_cselect_b32 s25, 16384, 0
    s_add_u32 s24, s24, s25
    s_add_u32 s59, s24, 100663296
    s_lshl_b32 s24, s54, 2
    s_add_u32 s24, s24, s12
    s_lshl_b32 s24, s24, 7
    s_lshl_b32 s25, s53, 2
    s_add_u32 s24, s24, s25
    s_add_u32 s58, s24, 100696064
    s_getpc_b64 s[24:25]
mk_pc64:
    s_lshl_b32 s15, s54, 2
    s_add_u32 s15, s15, s12
    s_lshl_b32 s15, s15, 10
    v_add_u32 v4, s15, v3
    v_min_u32 v4, mk_end-mk_pc64-16, v4
    v_mov_b32 v5, s25
    v_add_co_u32 v4, vcc, s24, v4
    s_nop 1
    v_addc_co_u32 v5, vcc, 0, v5, vcc
    global_load_dwordx4 v[64:67], v[4:5], off
    buffer_store_dword v255, off, s[16:19], s56 sc1
    buffer_store_dword v255, off, s[16:19], s57 sc1
    buffer_store_dword v255, off, s[16:19], s58 sc1
    s_add_u32 s25, s57, 32768
    buffer_store_dword v255, off, s[16:19], s25 sc1
    s_mov_b32 s60, s20
    s_mov_b32 s61, s21
    s_mov_b32 s62, 5308416
    s_mov_b32 s63, 0x20000
    s_mov_b32 s64, s22
    s_mov_b32 s65, s23
    s_mov_b32 s66, 5308416
    s_mov_b32 s67, 0x20000
    s_mov_b32 s72, s8
    s_mov_b32 s73, s9
    s_mov_b32 s74, 4718592
    s_mov_b32 s75, 0x20000
    s_cmp_lt_u32 s12, 2
    s_cselect_b32 s68, s60, s64
    s_cselect_b32 s69, s61, s65
    s_mov_b32 s70, 5308416
    s_mov_b32 s71, 0x20000
    s_lshl_b32 s76, s12, 12
    s_and_b32 s80, s12, 1
    s_add_u32 s80, s80, 16
    s_lshl_b32 s77, s80, 10
    s_cmp_lt_u32 s12, 2
    s_cselect_b32 s81, 0, 18432
    s_add_u32 s77, s77, s81
    s_lshl_b32 s78, s12, 12
    s_add_u32 s78, s78, 36864
    s_mul_i32 s81, s13, 288
    s_and_b32 s87, s13, 1
    s_lshl_b32 s87, s87, 1
    s_lshl_b32 s85, s12, 2
    s_lshl_b32 s84, s85, 6
    v_add_u32 v168, s84, v2
    v_mul_u32_u24 v169, 3641, v168
    v_lshrrev_b32 v169, 16, v169
    v_mul_u32_u24 v170, 18, v169
    v_sub_u32 v170, v168, v170
    v_add_u32 v170, s87, v170
    v_subrev_u32 v173, 18, v170
    v_min_u32 v170, v170, v173
    v_mul_u32_u24 v169, 9216, v169
    v_lshl_add_u32 v169, v170, 4, v169
    v_add_u32 v232, s81, v169
    s_lshl_b32 s84, s85, 6
    v_add_u32 v168, s84, v2
    v_add_u32 v168, 64, v168
    v_mul_u32_u24 v169, 3641, v168
    v_lshrrev_b32 v169, 16, v169
    v_mul_u32_u24 v170, 18, v169
    v_sub_u32 v170, v168, v170
    v_add_u32 v170, s87, v170
    v_subrev_u32 v173, 18, v170
    v_min_u32 v170, v170, v173
    v_mul_u32_u24 v169, 9216, v169
    v_lshl_add_u32 v169, v170, 4, v169
    v_add_u32 v233, s81, v169
    v_subrev_u32 v233, 1024, v233
    s_lshl_b32 s84, s85, 6
    v_add_u32 v168, s84, v2
    v_add_u32 v168, 128, v168
    v_mul_u32_u24 v169, 3641, v168
    v_lshrrev_b32 v169, 16, v169
    v_mul_u32_u24 v170, 18, v169
    v_sub_u32 v170, v168, v170
    v_add_u32 v170, s87, v170
    v_subrev_u32 v173, 18, v170
    v_min_u32 v170, v170, v173
    v_mul_u32_u24 v169, 9216, v169
    v_lshl_add_u32 v169, v170, 4, v169
    v_add_u32 v234, s81, v169
    v_subrev_u32 v234, 2048, v234
    s_lshl_b32 s84, s85, 6
    v_add_u32 v168, s84, v2
    v_add_u32 v168, 192, v168
    v_mul_u32_u24 v169, 3641, v168
    v_lshrrev_b32 v169, 16, v169
    v_mul_u32_u24 v170, 18, v169
    v_sub_u32 v170, v168, v170
    v_add_u32 v170, s87, v170
    v_subrev_u32 v173, 18, v170
    v_min_u32 v170, v170, v173
    v_mul_u32_u24 v169, 9216, v169
    v_lshl_add_u32 v169, v170, 4, v169
    v_add_u32 v235, s81, v169
    v_subrev_u32 v235, 3072, v235
    s_lshl_b32 s84, s80, 6
    v_add_u32 v168, s84, v2
    v_mul_u32_u24 v169, 3641, v168
    v_lshrrev_b32 v169, 16, v169
    v_mul_u32_u24 v170, 18, v169
    v_sub_u32 v170, v168, v170
    v_add_u32 v170, s87, v170
    v_subrev_u32 v173, 18, v170
    v_min_u32 v170, v170, v173
    v_mul_u32_u24 v169, 9216, v169
    v_lshl_add_u32 v169, v170, 4, v169
    v_add_u32 v236, s81, v169
    v_and_b32 v171, 15, v2
    v_lshrrev_b32 v172, 4, v2
    s_lshl_b32 s84, s12, 4
    s_lshl_b32 s85, s13, 8
    v_add_u32 v168, 0, v172
    v_and_b32 v169, 7, v168
    v_lshlrev_b32 v169, 1, v169
    v_xor_b32 v169, v169, v171
    v_add_u32 v168, s84, v168
    v_lshlrev_b32 v168, 13, v168
    v_lshl_add_u32 v168, v169, 4, v168
    v_add_u32 v237, s85, v168
    v_add_u32 v168, 4, v172
    v_and_b32 v169, 7, v168
    v_lshlrev_b32 v169, 1, v169
    v_xor_b32 v169, v169, v171
    v_add_u32 v168, s84, v168
    v_lshlrev_b32 v168, 13, v168
    v_lshl_add_u32 v168, v169, 4, v168
    v_add_u32 v238, s85, v168
    v_subrev_u32 v238, 1024, v238
    v_add_u32 v168, 8, v172
    v_and_b32 v169, 7, v168
    v_lshlrev_b32 v169, 1, v169
    v_xor_b32 v169, v169, v171
    v_add_u32 v168, s84, v168
    v_lshlrev_b32 v168, 13, v168
    v_lshl_add_u32 v168, v169, 4, v168
    v_add_u32 v239, s85, v168
    v_subrev_u32 v239, 2048, v239
    v_add_u32 v168, 12, v172
    v_and_b32 v169, 7, v168
    v_lshlrev_b32 v169, 1, v169
    v_xor_b32 v169, v169, v171
    v_add_u32 v168, s84, v168
    v_lshlrev_b32 v168, 13, v168
    v_lshl_add_u32 v168, v169, 4, v168
    v_add_u32 v240, s85, v168
    v_subrev_u32 v240, 3072, v240
    v_lshrrev_b32 v168, 2, v171
    v_lshl_add_u32 v168, v172, 2, v168
    v_mul_u32_u24 v169, 288, v168
    v_and_b32 v170, 3, v171
    v_lshl_add_u32 v241, v170, 3, v169
    v_lshlrev_b32 v169, 8, v168
    v_and_b32 v170, 7, v168
    v_lshl_add_u32 v169, v170, 5, v169
    v_bfe_u32 v170, v171, 1, 1
    v_lshl_add_u32 v169, v170, 4, v169
    v_and_b32 v170, 1, v171
    v_lshl_add_u32 v169, v170, 3, v169
    v_add_u32 v243, 36864, v169
    s_lshl_b32 s79, s14, 2
    s_add_u32 s79, s79, s12
    s_mul_i32 s79, s79, 73728
    s_mul_i32 s84, s14, 144
    s_lshr_b32 s85, s13, 1
    s_mul_i32 s85, s85, 9
    s_add_u32 s84, s84, s85
    s_lshl_b32 s84, s84, 14
    s_lshl_b32 s85, s12, 12
    s_add_u32 s84, s84, s85
    s_add_u32 s84, s84, 4194304
    s_and_b32 s85, s13, 1
    s_mul_i32 s80, s85, 81920
    s_add_u32 s82, s84, s80
    s_lshl_b32 s80, s85, 9
    s_add_u32 s83, s84, s80
    s_add_u32 s83, s83, 65536
    v_and_b32 v4, 15, v2
    v_lshrrev_b32 v5, 4, v2
    s_lshl_b32 s52, s12, 12
    v_lshl_add_u32 v6, v5, 8, s52
    v_add_u32 v7, 0, v5
    v_xor_b32 v7, v7, v4
    v_lshl_add_u32 v247, v7, 4, v6
    v_add_u32 v7, 4, v5
    v_xor_b32 v7, v7, v4
    v_lshl_add_u32 v248, v7, 4, v6
    v_add_u32 v7, 8, v5
    v_xor_b32 v7, v7, v4
    v_lshl_add_u32 v249, v7, 4, v6
    v_add_u32 v7, 12, v5
    v_xor_b32 v7, v7, v4
    v_lshl_add_u32 v250, v7, 4, v6
    v_add_u32 v7, 0, v5
    v_lshlrev_b32 v7, 1, v7
    v_xor_b32 v7, v7, v4
    v_lshl_add_u32 v251, v7, 4, v6
    v_add_u32 v7, 4, v5
    v_lshlrev_b32 v7, 1, v7
    v_xor_b32 v7, v7, v4
    v_lshl_add_u32 v252, v7, 4, v6
    s_mov_b32 s46, s52
    s_add_u32 s47, s52, 0x10000
    s_mov_b32 s48, 1266679808
    s_lshl_b32 s24, s14, 7
    s_lshl_b32 s25, s13, 2
    s_add_u32 s24, s24, s25
    s_lshl_b32 s24, s24, 14
    s_lshl_b32 s25, s12, 12
    s_add_u32 s24, s24, s25
    s_add_u32 s24, s24, 33554432
    s_add_u32 m0, s76, 0
    s_mov_b32 s80, 0
    s_nop 0
    buffer_load_dwordx4 v232, s[60:63], s80 offen offset:0 nt lds
    buffer_load_dwordx4 v233, s[60:63], s80 offen offset:1024 nt lds
    buffer_load_dwordx4 v234, s[60:63], s80 offen offset:2048 nt lds
    buffer_load_dwordx4 v235, s[60:63], s80 offen offset:3072 nt lds
    s_add_u32 m0, s76, 18432
    s_nop 0
    buffer_load_dwordx4 v232, s[64:67], s80 offen offset:0 nt lds
    buffer_load_dwordx4 v233, s[64:67], s80 offen offset:1024 nt lds
    buffer_load_dwordx4 v234, s[64:67], s80 offen offset:2048 nt lds
    buffer_load_dwordx4 v235, s[64:67], s80 offen offset:3072 nt lds
    s_add_u32 m0, s77, 0
    s_nop 0
    buffer_load_dwordx4 v236, s[68:71], s80 offen nt lds
    s_add_u32 m0, s78, 0
    s_mov_b32 s81, 0
    s_nop 0
    buffer_load_dwordx4 v237, s[72:75], s81 offen offset:0 nt lds
    buffer_load_dwordx4 v238, s[72:75], s81 offen offset:1024 nt lds
    buffer_load_dwordx4 v239, s[72:75], s81 offen offset:2048 nt lds
    buffer_load_dwordx4 v240, s[72:75], s81 offen offset:3072 nt lds
    v_and_b32 v24, 7, v2
    v_lshlrev_b32 v24, 3, v24
    v_add_u32 v24, 159744, v24
    s_lshl_b32 s5, s12, 6
    v_add_u32 v25, s5, v24
    s_waitcnt vmcnt(18)
    v_mov_b32 v52, 0
    v_mov_b32 v53, 0
    v_lshlrev_b32 v28, 16, v8
    v_and_b32 v29, 0xffff0000, v8
    v_add_f32 v52, v52, v28
    v_fmac_f32 v53, v28, v28
    v_add_f32 v52, v52, v29
    v_fmac_f32 v53, v29, v29
    v_lshlrev_b32 v30, 16, v9
    v_and_b32 v31, 0xffff0000, v9
    v_add_f32 v52, v52, v30
    v_fmac_f32 v53, v30, v30
    v_add_f32 v52, v52, v31
    v_fmac_f32 v53, v31, v31
    v_lshlrev_b32 v32, 16, v10
    v_and_b32 v33, 0xffff0000, v10
    v_add_f32 v52, v52, v32
    v_fmac_f32 v53, v32, v32
    v_add_f32 v52, v52, v33
    v_fmac_f32 v53, v33, v33
    v_lshlrev_b32 v34, 16, v11
    v_and_b32 v35, 0xffff0000, v11
    v_add_f32 v52, v52, v34
    v_fmac_f32 v53, v34, v34
    v_add_f32 v52, v52, v35
    v_fmac_f32 v53, v35, v35
    v_lshlrev_b32 v36, 16, v12
    v_and_b32 v37, 0xffff0000, v12
    v_add_f32 v52, v52, v36
    v_fmac_f32 v53, v36, v36
    v_add_f32 v52, v52, v37
    v_fmac_f32 v53, v37, v37
    v_lshlrev_b32 v38, 16, v13
    v_and_b32 v39, 0xffff0000, v13
    v_add_f32 v52, v52, v38
    v_fmac_f32 v53, v38, v38
    v_add_f32 v52, v52, v39
    v_fmac_f32 v53, v39, v39
    v_lshlrev_b32 v40, 16, v14
    v_and_b32 v41, 0xffff0000, v14
    v_add_f32 v52, v52, v40
    v_fmac_f32 v53, v40, v40
    v_add_f32 v52, v52, v41
    v_fmac_f32 v53, v41, v41
    v_lshlrev_b32 v42, 16, v15
    v_and_b32 v43, 0xffff0000, v15
    v_add_f32 v52, v52, v42
    v_fmac_f32 v53, v42, v42
    v_add_f32 v52, v52, v43
    v_fmac_f32 v53, v43, v43
    v_lshlrev_b32 v44, 16, v16
    v_and_b32 v45, 0xffff0000, v16
    v_add_f32 v52, v52, v44
    v_fmac_f32 v53, v44, v44
    v_add_f32 v52, v52, v45
    v_fmac_f32 v53, v45, v45
    v_lshlrev_b32 v46, 16, v17
    v_and_b32 v47, 0xffff0000, v17
    v_add_f32 v52, v52, v46
    v_fmac_f32 v53, v46, v46
    v_add_f32 v52, v52, v47
    v_fmac_f32 v53, v47, v47
    v_lshlrev_b32 v48, 16, v18
    v_and_b32 v49, 0xffff0000, v18
    v_add_f32 v52, v52, v48
    v_fmac_f32 v53, v48, v48
    v_add_f32 v52, v52, v49
    v_fmac_f32 v53, v49, v49
    v_lshlrev_b32 v50, 16, v19
    v_and_b32 v51, 0xffff0000, v19
    v_add_f32 v52, v52, v50
    v_fmac_f32 v53, v50, v50
    v_add_f32 v52, v52, v51
    v_fmac_f32 v53, v51, v51
    v_mov_b32 v23, v52
    s_nop 1
    v_permlane32_swap_b32 v23, v52
    s_nop 1
    v_add_f32 v52, v23, v52
    v_mov_b32 v23, v52
    s_nop 1
    v_permlane16_swap_b32 v23, v52
    s_nop 1
    v_add_f32 v52, v23, v52
    s_nop 1
    v_add_f32_dpp v52, v52, v52 row_ror:8 row_mask:0xf bank_mask:0xf
    v_mov_b32 v23, v53
    s_nop 1
    v_permlane32_swap_b32 v23, v53
    s_nop 1
    v_add_f32 v53, v23, v53
    v_mov_b32 v23, v53
    s_nop 1
    v_permlane16_swap_b32 v23, v53
    s_nop 1
    v_add_f32 v53, v23, v53
    s_nop 1
    v_add_f32_dpp v53, v53, v53 row_ror:8 row_mask:0xf bank_mask:0xf
    ds_write_b64 v25, v[52:53]
    s_waitcnt lgkmcnt(0)
    s_barrier
    ds_read_b64 v[54:55], v24 offset:0
    ds_read_b64 v[56:57], v24 offset:64
    ds_read_b64 v[58:59], v24 offset:128
    ds_read_b64 v[60:61], v24 offset:192
    s_waitcnt lgkmcnt(0)
    v_add_f32 v54, v54, v56
    v_add_f32 v58, v58, v60
    v_add_f32 v54, v54, v58
    v_add_f32 v55, v55, v57
    v_add_f32 v59, v59, v61
    v_add_f32 v55, v55, v59
    v_mul_f32 v52, 0x3ae38e39, v54
    v_mul_f32 v22, 0x3ae38e39, v55
    v_fma_f32 v22, -v52, v52, v22
    v_max_f32 v22, 0, v22
    v_sub_f32 v28, v28, v52
    v_sub_f32 v29, v29, v52
    v_sub_f32 v30, v30, v52
    v_sub_f32 v31, v31, v52
    v_sub_f32 v32, v32, v52
    v_sub_f32 v33, v33, v52
    v_sub_f32 v34, v34, v52
    v_sub_f32 v35, v35, v52
    v_sub_f32 v36, v36, v52
    v_sub_f32 v37, v37, v52
    v_sub_f32 v38, v38, v52
    v_sub_f32 v39, v39, v52
    v_sub_f32 v40, v40, v52
    v_sub_f32 v41, v41, v52
    v_sub_f32 v42, v42, v52
    v_sub_f32 v43, v43, v52
    v_sub_f32 v44, v44, v52
    v_sub_f32 v45, v45, v52
    v_sub_f32 v46, v46, v52
    v_sub_f32 v47, v47, v52
    v_sub_f32 v48, v48, v52
    v_sub_f32 v49, v49, v52
    v_sub_f32 v50, v50, v52
    v_sub_f32 v51, v51, v52
    v_add_f32 v23, 0x3727c5ac, v22
    v_rsq_f32 v23, v23
    s_nop 0
    v_mul_f32 v28, v28, v23
    v_mul_f32 v29, v29, v23
    v_mul_f32 v30, v30, v23
    v_mul_f32 v31, v31, v23
    v_mul_f32 v32, v32, v23
    v_mul_f32 v33, v33, v23
    v_mul_f32 v34, v34, v23
    v_mul_f32 v35, v35, v23
    v_mul_f32 v36, v36, v23
    v_mul_f32 v37, v37, v23
    v_mul_f32 v38, v38, v23
    v_mul_f32 v39, v39, v23
    v_mul_f32 v40, v40, v23
    v_mul_f32 v41, v41, v23
    v_mul_f32 v42, v42, v23
    v_mul_f32 v43, v43, v23
    v_mul_f32 v44, v44, v23
    v_mul_f32 v45, v45, v23
    v_mul_f32 v46, v46, v23
    v_mul_f32 v47, v47, v23
    v_mul_f32 v48, v48, v23
    v_mul_f32 v49, v49, v23
    v_mul_f32 v50, v50, v23
    v_mul_f32 v51, v51, v23
    v_cvt_pk_bf16_f32 v8, v28, v29
    v_cvt_pk_bf16_f32 v9, v30, v31
    v_cvt_pk_bf16_f32 v10, v32, v33
    v_cvt_pk_bf16_f32 v11, v34, v35
    v_cvt_pk_bf16_f32 v12, v36, v37
    v_cvt_pk_bf16_f32 v13, v38, v39
    v_cvt_pk_bf16_f32 v14, v40, v41
    v_cvt_pk_bf16_f32 v15, v42, v43
    v_cvt_pk_bf16_f32 v16, v44, v45
    v_cvt_pk_bf16_f32 v17, v46, v47
    v_cvt_pk_bf16_f32 v18, v48, v49
    v_cvt_pk_bf16_f32 v19, v50, v51
    s_lshl_b32 s4, s14, 2
    s_lshr_b32 s5, s13, 3
    s_add_u32 s4, s4, s5
    s_mul_i32 s4, s4, 18
    s_lshl_b32 s5, s12, 1
    s_add_u32 s4, s4, s5
    s_lshl_b32 s4, s4, 2
    s_bfe_u32 s5, s13, 0x20001
    s_add_u32 s4, s4, s5
    s_lshl_b32 s4, s4, 10
    s_and_b32 s5, s13, 1
    s_lshl_b32 s5, s5, 7
    s_add_u32 s4, s4, s5
    s_cmp_eq_u32 s12, 0
    s_cselect_b32 s5, 0, 0x10000000
    s_add_u32 s6, s4, 0
    buffer_store_dwordx4 v[8:11], v21, s[16:19], s6 offen sc1
    s_add_u32 s6, s4, 32768
    buffer_store_dwordx4 v[12:15], v21, s[16:19], s6 offen sc1
    s_add_u32 s6, s4, 65536
    s_add_u32 s6, s6, s5
    buffer_store_dwordx4 v[16:19], v21, s[16:19], s6 offen sc1
    s_waitcnt vmcnt(0)
    s_barrier
    s_cmp_eq_u32 s12, 0
    s_cbranch_scc0 mk_noann
    s_mov_b64 exec, 1
    buffer_atomic_add v254, off, s[32:35], s98
    s_mov_b64 exec, -1
mk_noann:
    s_add_u32 m0, s76, 53248
    s_mov_b32 s80, 589824
    s_nop 0
    buffer_load_dwordx4 v232, s[60:63], s80 offen offset:0 nt lds
    buffer_load_dwordx4 v233, s[60:63], s80 offen offset:1024 nt lds
    buffer_load_dwordx4 v234, s[60:63], s80 offen offset:2048 nt lds
    buffer_load_dwordx4 v235, s[60:63], s80 offen offset:3072 nt lds
    s_add_u32 m0, s76, 71680
    s_nop 0
    buffer_load_dwordx4 v232, s[64:67], s80 offen offset:0 nt lds
    buffer_load_dwordx4 v233, s[64:67], s80 offen offset:1024 nt lds
    buffer_load_dwordx4 v234, s[64:67], s80 offen offset:2048 nt lds
    buffer_load_dwordx4 v235, s[64:67], s80 offen offset:3072 nt lds
    s_add_u32 m0, s77, 53248
    s_nop 0
    buffer_load_dwordx4 v236, s[68:71], s80 offen nt lds
    s_add_u32 m0, s78, 53248
    s_mov_b32 s81, 524288
    s_nop 0
    buffer_load_dwordx4 v237, s[72:75], s81 offen offset:0 nt lds
    buffer_load_dwordx4 v238, s[72:75], s81 offen offset:1024 nt lds
    buffer_load_dwordx4 v239, s[72:75], s81 offen offset:2048 nt lds
    buffer_load_dwordx4 v240, s[72:75], s81 offen offset:3072 nt lds
    s_mov_b32 s15, 0
mk_xn_spin:
    buffer_load_dword v246, off, s[32:35], s98 sc1
    s_waitcnt vmcnt(0)
    v_readfirstlane_b32 s25, v246
    s_add_u32 s15, s15, 1
    s_cmp_ge_u32 s15, 200000
    s_cbranch_scc1 mk_xn_ok
    s_cmp_ge_u32 s25, 32
    s_cbranch_scc0 mk_xn_spin
mk_xn_ok:
    s_add_u32 s86, s79, 0
    s_nop 0
    buffer_load_dwordx4 v[168:171], v3, s[16:19], s86 offen offset:0 sc1
    s_add_u32 s86, s79, 0
    s_nop 0
    buffer_load_dwordx4 v[172:175], v3, s[16:19], s86 offen offset:1024 sc1
    s_add_u32 s86, s79, 0
    s_nop 0
    buffer_load_dwordx4 v[176:179], v3, s[16:19], s86 offen offset:2048 sc1
    s_add_u32 s86, s79, 0
    s_nop 0
    buffer_load_dwordx4 v[180:183], v3, s[16:19], s86 offen offset:3072 sc1
    s_add_u32 s86, s79, 4096
    s_nop 0
    buffer_load_dwordx4 v[184:187], v3, s[16:19], s86 offen offset:0 sc1
    s_add_u32 s86, s79, 4096
    s_nop 0
    buffer_load_dwordx4 v[188:191], v3, s[16:19], s86 offen offset:1024 sc1
    s_add_u32 s86, s79, 4096
    s_nop 0
    buffer_load_dwordx4 v[192:195], v3, s[16:19], s86 offen offset:2048 sc1
    s_add_u32 s86, s79, 4096
    s_nop 0
    buffer_load_dwordx4 v[196:199], v3, s[16:19], s86 offen offset:3072 sc1
    s_waitcnt vmcnt(4)
    v_add_u32 v242, 0, v241
    v_add_u32 v244, 0, v243
    ds_read_b64_tr_b16 v[216:217], v242 offset:0
    ds_read_b64_tr_b16 v[218:219], v242 offset:4608
    ds_read_b64_tr_b16 v[220:221], v242 offset:18432
    ds_read_b64_tr_b16 v[222:223], v242 offset:23040
    ds_read_b64_tr_b16 v[224:225], v242 offset:32
    ds_read_b64_tr_b16 v[226:227], v242 offset:4640
    s_waitcnt lgkmcnt(4)
    v_mfma_f32_16x16x32_bf16 a[128:131], v[216:219], v[168:171], 0
    v_mfma_f32_16x16x32_bf16 a[132:135], v[216:219], v[172:175], 0
    ds_read_b64_tr_b16 v[228:229], v242 offset:18464
    v_mfma_f32_16x16x32_bf16 a[136:139], v[216:219], v[176:179], 0
    ds_read_b64_tr_b16 v[230:231], v242 offset:23072
    v_mfma_f32_16x16x32_bf16 a[140:143], v[216:219], v[180:183], 0
    s_waitcnt lgkmcnt(4)
    v_mfma_f32_16x16x32_bf16 v[8:11], v[220:223], v[168:171], 0
    v_mfma_f32_16x16x32_bf16 v[12:15], v[220:223], v[172:175], 0
    ds_read_b64_tr_b16 v[216:217], v242 offset:64
    v_mfma_f32_16x16x32_bf16 v[16:19], v[220:223], v[176:179], 0
    ds_read_b64_tr_b16 v[218:219], v242 offset:4672
    v_mfma_f32_16x16x32_bf16 v[20:23], v[220:223], v[180:183], 0
    s_add_u32 s86, s79, 8192
    s_waitcnt lgkmcnt(4)
    v_mfma_f32_16x16x32_bf16 a[144:147], v[224:227], v[168:171], 0
    buffer_load_dwordx4 v[200:203], v3, s[16:19], s86 offen offset:0 sc1
    v_mfma_f32_16x16x32_bf16 a[148:151], v[224:227], v[172:175], 0
    ds_read_b64_tr_b16 v[220:221], v242 offset:18496
    v_mfma_f32_16x16x32_bf16 a[152:155], v[224:227], v[176:179], 0
    ds_read_b64_tr_b16 v[222:223], v242 offset:23104
    v_mfma_f32_16x16x32_bf16 a[156:159], v[224:227], v[180:183], 0
    s_add_u32 s86, s79, 8192
    s_waitcnt lgkmcnt(4)
    v_mfma_f32_16x16x32_bf16 v[24:27], v[228:231], v[168:171], 0
    buffer_load_dwordx4 v[204:207], v3, s[16:19], s86 offen offset:1024 sc1
    v_mfma_f32_16x16x32_bf16 v[28:31], v[228:231], v[172:175], 0
    ds_read_b64_tr_b16 v[224:225], v242 offset:96
    v_mfma_f32_16x16x32_bf16 v[32:35], v[228:231], v[176:179], 0
    ds_read_b64_tr_b16 v[226:227], v242 offset:4704
    v_mfma_f32_16x16x32_bf16 v[36:39], v[228:231], v[180:183], 0
    s_add_u32 s86, s79, 8192
    s_waitcnt lgkmcnt(4)
    v_mfma_f32_16x16x32_bf16 a[160:163], v[216:219], v[168:171], 0
    buffer_load_dwordx4 v[208:211], v3, s[16:19], s86 offen offset:2048 sc1
    v_mfma_f32_16x16x32_bf16 a[164:167], v[216:219], v[172:175], 0
    ds_read_b64_tr_b16 v[228:229], v242 offset:18528
    v_mfma_f32_16x16x32_bf16 a[168:171], v[216:219], v[176:179], 0
    ds_read_b64_tr_b16 v[230:231], v242 offset:23136
    v_mfma_f32_16x16x32_bf16 a[172:175], v[216:219], v[180:183], 0
    s_add_u32 s86, s79, 8192
    s_waitcnt lgkmcnt(4)
    v_mfma_f32_16x16x32_bf16 v[40:43], v[220:223], v[168:171], 0
    buffer_load_dwordx4 v[212:215], v3, s[16:19], s86 offen offset:3072 sc1
    v_mfma_f32_16x16x32_bf16 v[44:47], v[220:223], v[172:175], 0
    ds_read_b64_tr_b16 v[216:217], v242 offset:128
    v_mfma_f32_16x16x32_bf16 v[48:51], v[220:223], v[176:179], 0
    ds_read_b64_tr_b16 v[218:219], v242 offset:4736
    v_mfma_f32_16x16x32_bf16 v[52:55], v[220:223], v[180:183], 0
    s_add_u32 m0, s76, 106496
    s_mov_b32 s80, 1179648
    s_waitcnt lgkmcnt(4)
    v_mfma_f32_16x16x32_bf16 a[176:179], v[224:227], v[168:171], 0
    buffer_load_dwordx4 v232, s[60:63], s80 offen offset:0 nt lds
    v_mfma_f32_16x16x32_bf16 a[180:183], v[224:227], v[172:175], 0
    ds_read_b64_tr_b16 v[220:221], v242 offset:18560
    v_mfma_f32_16x16x32_bf16 a[184:187], v[224:227], v[176:179], 0
    ds_read_b64_tr_b16 v[222:223], v242 offset:23168
    v_mfma_f32_16x16x32_bf16 a[188:191], v[224:227], v[180:183], 0
    s_waitcnt lgkmcnt(4)
    v_mfma_f32_16x16x32_bf16 v[56:59], v[228:231], v[168:171], 0
    buffer_load_dwordx4 v233, s[60:63], s80 offen offset:1024 nt lds
    v_mfma_f32_16x16x32_bf16 v[60:63], v[228:231], v[172:175], 0
    ds_read_b64_tr_b16 v[224:225], v242 offset:160
    v_mfma_f32_16x16x32_bf16 v[64:67], v[228:231], v[176:179], 0
    ds_read_b64_tr_b16 v[226:227], v242 offset:4768
    v_mfma_f32_16x16x32_bf16 v[68:71], v[228:231], v[180:183], 0
    s_waitcnt lgkmcnt(4)
    v_mfma_f32_16x16x32_bf16 a[192:195], v[216:219], v[168:171], 0
    buffer_load_dwordx4 v234, s[60:63], s80 offen offset:2048 nt lds
    v_mfma_f32_16x16x32_bf16 a[196:199], v[216:219], v[172:175], 0
    ds_read_b64_tr_b16 v[228:229], v242 offset:18592
    v_mfma_f32_16x16x32_bf16 a[200:203], v[216:219], v[176:179], 0
    ds_read_b64_tr_b16 v[230:231], v242 offset:23200
    v_mfma_f32_16x16x32_bf16 a[204:207], v[216:219], v[180:183], 0
    s_waitcnt lgkmcnt(4)
    v_mfma_f32_16x16x32_bf16 v[72:75], v[220:223], v[168:171], 0
    buffer_load_dwordx4 v235, s[60:63], s80 offen offset:3072 nt lds
    v_mfma_f32_16x16x32_bf16 v[76:79], v[220:223], v[172:175], 0
    ds_read_b64_tr_b16 v[216:217], v242 offset:192
    v_mfma_f32_16x16x32_bf16 v[80:83], v[220:223], v[176:179], 0
    ds_read_b64_tr_b16 v[218:219], v242 offset:4800
    v_mfma_f32_16x16x32_bf16 v[84:87], v[220:223], v[180:183], 0
    s_add_u32 m0, s76, 124928
    s_waitcnt lgkmcnt(4)
    v_mfma_f32_16x16x32_bf16 a[208:211], v[224:227], v[168:171], 0
    buffer_load_dwordx4 v232, s[64:67], s80 offen offset:0 nt lds
    v_mfma_f32_16x16x32_bf16 a[212:215], v[224:227], v[172:175], 0
    ds_read_b64_tr_b16 v[220:221], v242 offset:18624
    v_mfma_f32_16x16x32_bf16 a[216:219], v[224:227], v[176:179], 0
    ds_read_b64_tr_b16 v[222:223], v242 offset:23232
    v_mfma_f32_16x16x32_bf16 a[220:223], v[224:227], v[180:183], 0
    s_waitcnt lgkmcnt(4)
    v_mfma_f32_16x16x32_bf16 v[88:91], v[228:231], v[168:171], 0
    buffer_load_dwordx4 v233, s[64:67], s80 offen offset:1024 nt lds
    v_mfma_f32_16x16x32_bf16 v[92:95], v[228:231], v[172:175], 0
    ds_read_b64_tr_b16 v[224:225], v242 offset:224
    v_mfma_f32_16x16x32_bf16 v[96:99], v[228:231], v[176:179], 0
    ds_read_b64_tr_b16 v[226:227], v242 offset:4832
    v_mfma_f32_16x16x32_bf16 v[100:103], v[228:231], v[180:183], 0
    s_waitcnt lgkmcnt(4)
    v_mfma_f32_16x16x32_bf16 a[224:227], v[216:219], v[168:171], 0
    buffer_load_dwordx4 v234, s[64:67], s80 offen offset:2048 nt lds
    v_mfma_f32_16x16x32_bf16 a[228:231], v[216:219], v[172:175], 0
    ds_read_b64_tr_b16 v[228:229], v242 offset:18656
    v_mfma_f32_16x16x32_bf16 a[232:235], v[216:219], v[176:179], 0
    ds_read_b64_tr_b16 v[230:231], v242 offset:23264
    v_mfma_f32_16x16x32_bf16 a[236:239], v[216:219], v[180:183], 0
    s_waitcnt lgkmcnt(4)
    v_mfma_f32_16x16x32_bf16 v[104:107], v[220:223], v[168:171], 0
    buffer_load_dwordx4 v235, s[64:67], s80 offen offset:3072 nt lds
    v_mfma_f32_16x16x32_bf16 v[108:111], v[220:223], v[172:175], 0
    ds_read_b64_tr_b16 v[216:217], v242 offset:256
    v_mfma_f32_16x16x32_bf16 v[112:115], v[220:223], v[176:179], 0
    ds_read_b64_tr_b16 v[218:219], v242 offset:4864
    v_mfma_f32_16x16x32_bf16 v[116:119], v[220:223], v[180:183], 0
    s_add_u32 m0, s77, 106496
    s_waitcnt lgkmcnt(4)
    v_mfma_f32_16x16x32_bf16 a[240:243], v[224:227], v[168:171], 0
    buffer_load_dwordx4 v236, s[68:71], s80 offen nt lds
    v_mfma_f32_16x16x32_bf16 a[244:247], v[224:227], v[172:175], 0
    ds_read_b64_tr_b16 v[220:221], v242 offset:18688
    v_mfma_f32_16x16x32_bf16 a[248:251], v[224:227], v[176:179], 0
    ds_read_b64_tr_b16 v[222:223], v242 offset:23296
    v_mfma_f32_16x16x32_bf16 a[252:255], v[224:227], v[180:183], 0
    s_add_u32 m0, s78, 106496
    s_mov_b32 s81, 1048576
    s_waitcnt lgkmcnt(4)
    v_mfma_f32_16x16x32_bf16 v[120:123], v[228:231], v[168:171], 0
    v_xor_b32 v245, 0, v244
    buffer_load_dwordx4 v237, s[72:75], s81 offen offset:0 nt lds
    v_mfma_f32_16x16x32_bf16 v[124:127], v[228:231], v[172:175], 0
    ds_read_b64_tr_b16 v[224:225], v245 offset:0
    v_mfma_f32_16x16x32_bf16 v[128:131], v[228:231], v[176:179], 0
    ds_read_b64_tr_b16 v[226:227], v245 offset:4096
    v_mfma_f32_16x16x32_bf16 v[132:135], v[228:231], v[180:183], 0
    s_waitcnt lgkmcnt(4)
    v_mfma_f32_16x16x32_bf16 v[152:155], v[216:219], v[168:171], 0
    v_xor_b32 v246, 32, v244
    buffer_load_dwordx4 v238, s[72:75], s81 offen offset:1024 nt lds
    v_mfma_f32_16x16x32_bf16 v[156:159], v[216:219], v[172:175], 0
    ds_read_b64_tr_b16 v[228:229], v246 offset:0
    v_mfma_f32_16x16x32_bf16 v[160:163], v[216:219], v[176:179], 0
    ds_read_b64_tr_b16 v[230:231], v246 offset:4096
    v_mfma_f32_16x16x32_bf16 v[164:167], v[216:219], v[180:183], 0
    s_waitcnt lgkmcnt(4)
    v_mfma_f32_16x16x32_bf16 v[136:139], v[220:223], v[168:171], 0
    v_xor_b32 v245, 64, v244
    buffer_load_dwordx4 v239, s[72:75], s81 offen offset:2048 nt lds
    v_mfma_f32_16x16x32_bf16 v[140:143], v[220:223], v[172:175], 0
    ds_read_b64_tr_b16 v[216:217], v245 offset:0
    v_mfma_f32_16x16x32_bf16 v[144:147], v[220:223], v[176:179], 0
    ds_read_b64_tr_b16 v[218:219], v245 offset:4096
    v_mfma_f32_16x16x32_bf16 v[148:151], v[220:223], v[180:183], 0
    s_waitcnt lgkmcnt(4)
    v_mfma_f32_16x16x32_bf16 a[0:3], v[224:227], v[168:171], 0
    v_xor_b32 v246, 96, v244
    buffer_load_dwordx4 v240, s[72:75], s81 offen offset:3072 nt lds
    v_mfma_f32_16x16x32_bf16 a[4:7], v[224:227], v[172:175], 0
    ds_read_b64_tr_b16 v[220:221], v246 offset:0
    v_mfma_f32_16x16x32_bf16 a[8:11], v[224:227], v[176:179], 0
    ds_read_b64_tr_b16 v[222:223], v246 offset:4096
    v_mfma_f32_16x16x32_bf16 a[12:15], v[224:227], v[180:183], 0
    s_waitcnt lgkmcnt(4)
    v_mfma_f32_16x16x32_bf16 a[16:19], v[228:231], v[168:171], 0
    v_xor_b32 v245, 128, v244
    v_mfma_f32_16x16x32_bf16 a[20:23], v[228:231], v[172:175], 0
    ds_read_b64_tr_b16 v[224:225], v245 offset:0
    v_mfma_f32_16x16x32_bf16 a[24:27], v[228:231], v[176:179], 0
    ds_read_b64_tr_b16 v[226:227], v245 offset:4096
    v_mfma_f32_16x16x32_bf16 a[28:31], v[228:231], v[180:183], 0
    s_waitcnt lgkmcnt(4)
    v_mfma_f32_16x16x32_bf16 a[32:35], v[216:219], v[168:171], 0
    v_xor_b32 v246, 160, v244
    v_mfma_f32_16x16x32_bf16 a[36:39], v[216:219], v[172:175], 0
    ds_read_b64_tr_b16 v[228:229], v246 offset:0
    v_mfma_f32_16x16x32_bf16 a[40:43], v[216:219], v[176:179], 0
    ds_read_b64_tr_b16 v[230:231], v246 offset:4096
    v_mfma_f32_16x16x32_bf16 a[44:47], v[216:219], v[180:183], 0
    s_waitcnt lgkmcnt(4)
    v_mfma_f32_16x16x32_bf16 a[48:51], v[220:223], v[168:171], 0
    v_xor_b32 v245, 192, v244
    v_mfma_f32_16x16x32_bf16 a[52:55], v[220:223], v[172:175], 0
    ds_read_b64_tr_b16 v[216:217], v245 offset:0
    v_mfma_f32_16x16x32_bf16 a[56:59], v[220:223], v[176:179], 0
    ds_read_b64_tr_b16 v[218:219], v245 offset:4096
    v_mfma_f32_16x16x32_bf16 a[60:63], v[220:223], v[180:183], 0
    s_waitcnt lgkmcnt(4)
    v_mfma_f32_16x16x32_bf16 a[64:67], v[224:227], v[168:171], 0
    v_xor_b32 v246, 224, v244
    v_mfma_f32_16x16x32_bf16 a[68:71], v[224:227], v[172:175], 0
    ds_read_b64_tr_b16 v[220:221], v246 offset:0
    v_mfma_f32_16x16x32_bf16 a[72:75], v[224:227], v[176:179], 0
    ds_read_b64_tr_b16 v[222:223], v246 offset:4096
    v_mfma_f32_16x16x32_bf16 a[76:79], v[224:227], v[180:183], 0
    s_waitcnt lgkmcnt(4)
    v_mfma_f32_16x16x32_bf16 a[80:83], v[228:231], v[168:171], 0
    v_mfma_f32_16x16x32_bf16 a[84:87], v[228:231], v[172:175], 0
    ds_read_b64_tr_b16 v[224:225], v242 offset:9216
    v_mfma_f32_16x16x32_bf16 a[88:91], v[228:231], v[176:179], 0
    ds_read_b64_tr_b16 v[226:227], v242 offset:13824
    v_mfma_f32_16x16x32_bf16 a[92:95], v[228:231], v[180:183], 0
    s_waitcnt lgkmcnt(4)
    v_mfma_f32_16x16x32_bf16 a[96:99], v[216:219], v[168:171], 0
    v_mfma_f32_16x16x32_bf16 a[100:103], v[216:219], v[172:175], 0
    ds_read_b64_tr_b16 v[228:229], v242 offset:27648
    v_mfma_f32_16x16x32_bf16 a[104:107], v[216:219], v[176:179], 0
    ds_read_b64_tr_b16 v[230:231], v242 offset:32256
    v_mfma_f32_16x16x32_bf16 a[108:111], v[216:219], v[180:183], 0
    s_waitcnt lgkmcnt(4)
    v_mfma_f32_16x16x32_bf16 a[112:115], v[220:223], v[168:171], 0
    v_mfma_f32_16x16x32_bf16 a[116:119], v[220:223], v[172:175], 0
    ds_read_b64_tr_b16 v[216:217], v242 offset:9248
    v_mfma_f32_16x16x32_bf16 a[120:123], v[220:223], v[176:179], 0
    ds_read_b64_tr_b16 v[218:219], v242 offset:13856
    v_mfma_f32_16x16x32_bf16 a[124:127], v[220:223], v[180:183], 0
    s_waitcnt lgkmcnt(4)
    s_waitcnt vmcnt(17)
    v_mfma_f32_16x16x32_bf16 a[128:131], v[224:227], v[184:187], a[128:131]
    v_mfma_f32_16x16x32_bf16 a[132:135], v[224:227], v[188:191], a[132:135]
    ds_read_b64_tr_b16 v[220:221], v242 offset:27680
    v_mfma_f32_16x16x32_bf16 a[136:139], v[224:227], v[192:195], a[136:139]
    ds_read_b64_tr_b16 v[222:223], v242 offset:32288
    v_mfma_f32_16x16x32_bf16 a[140:143], v[224:227], v[196:199], a[140:143]
    s_waitcnt lgkmcnt(4)
    v_mfma_f32_16x16x32_bf16 v[8:11], v[228:231], v[184:187], v[8:11]
    v_mfma_f32_16x16x32_bf16 v[12:15], v[228:231], v[188:191], v[12:15]
    ds_read_b64_tr_b16 v[224:225], v242 offset:9280
    v_mfma_f32_16x16x32_bf16 v[16:19], v[228:231], v[192:195], v[16:19]
    ds_read_b64_tr_b16 v[226:227], v242 offset:13888
    v_mfma_f32_16x16x32_bf16 v[20:23], v[228:231], v[196:199], v[20:23]
    s_add_u32 s86, s79, 12288
    s_waitcnt lgkmcnt(4)
    v_mfma_f32_16x16x32_bf16 a[144:147], v[216:219], v[184:187], a[144:147]
    buffer_load_dwordx4 v[168:171], v3, s[16:19], s86 offen offset:0 sc1
    v_mfma_f32_16x16x32_bf16 a[148:151], v[216:219], v[188:191], a[148:151]
    ds_read_b64_tr_b16 v[228:229], v242 offset:27712
    v_mfma_f32_16x16x32_bf16 a[152:155], v[216:219], v[192:195], a[152:155]
    ds_read_b64_tr_b16 v[230:231], v242 offset:32320
    v_mfma_f32_16x16x32_bf16 a[156:159], v[216:219], v[196:199], a[156:159]
    s_add_u32 s86, s79, 12288
    s_waitcnt lgkmcnt(4)
    v_mfma_f32_16x16x32_bf16 v[24:27], v[220:223], v[184:187], v[24:27]
    buffer_load_dwordx4 v[172:175], v3, s[16:19], s86 offen offset:1024 sc1
    v_mfma_f32_16x16x32_bf16 v[28:31], v[220:223], v[188:191], v[28:31]
    ds_read_b64_tr_b16 v[216:217], v242 offset:9312
    v_mfma_f32_16x16x32_bf16 v[32:35], v[220:223], v[192:195], v[32:35]
    ds_read_b64_tr_b16 v[218:219], v242 offset:13920
    v_mfma_f32_16x16x32_bf16 v[36:39], v[220:223], v[196:199], v[36:39]
    s_add_u32 s86, s79, 12288
    s_waitcnt lgkmcnt(4)
    v_mfma_f32_16x16x32_bf16 a[160:163], v[224:227], v[184:187], a[160:163]
    buffer_load_dwordx4 v[176:179], v3, s[16:19], s86 offen offset:2048 sc1
    v_mfma_f32_16x16x32_bf16 a[164:167], v[224:227], v[188:191], a[164:167]
    ds_read_b64_tr_b16 v[220:221], v242 offset:27744
    v_mfma_f32_16x16x32_bf16 a[168:171], v[224:227], v[192:195], a[168:171]
    ds_read_b64_tr_b16 v[222:223], v242 offset:32352
    v_mfma_f32_16x16x32_bf16 a[172:175], v[224:227], v[196:199], a[172:175]
    s_add_u32 s86, s79, 12288
    s_waitcnt lgkmcnt(4)
    v_mfma_f32_16x16x32_bf16 v[40:43], v[228:231], v[184:187], v[40:43]
    buffer_load_dwordx4 v[180:183], v3, s[16:19], s86 offen offset:3072 sc1
    v_mfma_f32_16x16x32_bf16 v[44:47], v[228:231], v[188:191], v[44:47]
    ds_read_b64_tr_b16 v[224:225], v242 offset:9344
    v_mfma_f32_16x16x32_bf16 v[48:51], v[228:231], v[192:195], v[48:51]
    ds_read_b64_tr_b16 v[226:227], v242 offset:13952
    v_mfma_f32_16x16x32_bf16 v[52:55], v[228:231], v[196:199], v[52:55]
    s_waitcnt lgkmcnt(4)
    v_mfma_f32_16x16x32_bf16 a[176:179], v[216:219], v[184:187], a[176:179]
    v_mfma_f32_16x16x32_bf16 a[180:183], v[216:219], v[188:191], a[180:183]
    ds_read_b64_tr_b16 v[228:229], v242 offset:27776
    v_mfma_f32_16x16x32_bf16 a[184:187], v[216:219], v[192:195], a[184:187]
    ds_read_b64_tr_b16 v[230:231], v242 offset:32384
    v_mfma_f32_16x16x32_bf16 a[188:191], v[216:219], v[196:199], a[188:191]
    s_waitcnt lgkmcnt(4)
    v_mfma_f32_16x16x32_bf16 v[56:59], v[220:223], v[184:187], v[56:59]
    v_mfma_f32_16x16x32_bf16 v[60:63], v[220:223], v[188:191], v[60:63]
    ds_read_b64_tr_b16 v[216:217], v242 offset:9376
    v_mfma_f32_16x16x32_bf16 v[64:67], v[220:223], v[192:195], v[64:67]
    ds_read_b64_tr_b16 v[218:219], v242 offset:13984
    v_mfma_f32_16x16x32_bf16 v[68:71], v[220:223], v[196:199], v[68:71]
    s_waitcnt lgkmcnt(4)
    v_mfma_f32_16x16x32_bf16 a[192:195], v[224:227], v[184:187], a[192:195]
    v_mfma_f32_16x16x32_bf16 a[196:199], v[224:227], v[188:191], a[196:199]
    ds_read_b64_tr_b16 v[220:221], v242 offset:27808
    v_mfma_f32_16x16x32_bf16 a[200:203], v[224:227], v[192:195], a[200:203]
    ds_read_b64_tr_b16 v[222:223], v242 offset:32416
    v_mfma_f32_16x16x32_bf16 a[204:207], v[224:227], v[196:199], a[204:207]
    s_waitcnt lgkmcnt(4)
    v_mfma_f32_16x16x32_bf16 v[72:75], v[228:231], v[184:187], v[72:75]
    v_mfma_f32_16x16x32_bf16 v[76:79], v[228:231], v[188:191], v[76:79]
    ds_read_b64_tr_b16 v[224:225], v242 offset:9408
    v_mfma_f32_16x16x32_bf16 v[80:83], v[228:231], v[192:195], v[80:83]
    ds_read_b64_tr_b16 v[226:227], v242 offset:14016
    v_mfma_f32_16x16x32_bf16 v[84:87], v[228:231], v[196:199], v[84:87]
    s_waitcnt lgkmcnt(4)
    v_mfma_f32_16x16x32_bf16 a[208:211], v[216:219], v[184:187], a[208:211]
    v_mfma_f32_16x16x32_bf16 a[212:215], v[216:219], v[188:191], a[212:215]
    ds_read_b64_tr_b16 v[228:229], v242 offset:27840
    v_mfma_f32_16x16x32_bf16 a[216:219], v[216:219], v[192:195], a[216:219]
    ds_read_b64_tr_b16 v[230:231], v242 offset:32448
    v_mfma_f32_16x16x32_bf16 a[220:223], v[216:219], v[196:199], a[220:223]
    s_waitcnt lgkmcnt(4)
    v_mfma_f32_16x16x32_bf16 v[88:91], v[220:223], v[184:187], v[88:91]
    v_mfma_f32_16x16x32_bf16 v[92:95], v[220:223], v[188:191], v[92:95]
    ds_read_b64_tr_b16 v[216:217], v242 offset:9440
    v_mfma_f32_16x16x32_bf16 v[96:99], v[220:223], v[192:195], v[96:99]
    ds_read_b64_tr_b16 v[218:219], v242 offset:14048
    v_mfma_f32_16x16x32_bf16 v[100:103], v[220:223], v[196:199], v[100:103]
    s_waitcnt lgkmcnt(4)
    v_mfma_f32_16x16x32_bf16 a[224:227], v[224:227], v[184:187], a[224:227]
    v_mfma_f32_16x16x32_bf16 a[228:231], v[224:227], v[188:191], a[228:231]
    ds_read_b64_tr_b16 v[220:221], v242 offset:27872
    v_mfma_f32_16x16x32_bf16 a[232:235], v[224:227], v[192:195], a[232:235]
    ds_read_b64_tr_b16 v[222:223], v242 offset:32480
    v_mfma_f32_16x16x32_bf16 a[236:239], v[224:227], v[196:199], a[236:239]
    s_waitcnt lgkmcnt(4)
    v_mfma_f32_16x16x32_bf16 v[104:107], v[228:231], v[184:187], v[104:107]
    v_mfma_f32_16x16x32_bf16 v[108:111], v[228:231], v[188:191], v[108:111]
    ds_read_b64_tr_b16 v[224:225], v242 offset:9472
    v_mfma_f32_16x16x32_bf16 v[112:115], v[228:231], v[192:195], v[112:115]
    ds_read_b64_tr_b16 v[226:227], v242 offset:14080
    v_mfma_f32_16x16x32_bf16 v[116:119], v[228:231], v[196:199], v[116:119]
    s_waitcnt lgkmcnt(4)
    v_mfma_f32_16x16x32_bf16 a[240:243], v[216:219], v[184:187], a[240:243]
    v_mfma_f32_16x16x32_bf16 a[244:247], v[216:219], v[188:191], a[244:247]
    ds_read_b64_tr_b16 v[228:229], v242 offset:27904
    v_mfma_f32_16x16x32_bf16 a[248:251], v[216:219], v[192:195], a[248:251]
    ds_read_b64_tr_b16 v[230:231], v242 offset:32512
    v_mfma_f32_16x16x32_bf16 a[252:255], v[216:219], v[196:199], a[252:255]
    s_waitcnt lgkmcnt(4)
    v_mfma_f32_16x16x32_bf16 v[120:123], v[220:223], v[184:187], v[120:123]
    v_xor_b32 v245, 0, v244
    v_mfma_f32_16x16x32_bf16 v[124:127], v[220:223], v[188:191], v[124:127]
    ds_read_b64_tr_b16 v[216:217], v245 offset:8192
    v_mfma_f32_16x16x32_bf16 v[128:131], v[220:223], v[192:195], v[128:131]
    ds_read_b64_tr_b16 v[218:219], v245 offset:12288
    v_mfma_f32_16x16x32_bf16 v[132:135], v[220:223], v[196:199], v[132:135]
    s_waitcnt lgkmcnt(4)
    v_mfma_f32_16x16x32_bf16 v[152:155], v[224:227], v[184:187], v[152:155]
    v_xor_b32 v246, 32, v244
    v_mfma_f32_16x16x32_bf16 v[156:159], v[224:227], v[188:191], v[156:159]
    ds_read_b64_tr_b16 v[220:221], v246 offset:8192
    v_mfma_f32_16x16x32_bf16 v[160:163], v[224:227], v[192:195], v[160:163]
    ds_read_b64_tr_b16 v[222:223], v246 offset:12288
    v_mfma_f32_16x16x32_bf16 v[164:167], v[224:227], v[196:199], v[164:167]
    s_waitcnt lgkmcnt(4)
    v_mfma_f32_16x16x32_bf16 v[136:139], v[228:231], v[184:187], v[136:139]
    v_xor_b32 v245, 64, v244
    v_mfma_f32_16x16x32_bf16 v[140:143], v[228:231], v[188:191], v[140:143]
    ds_read_b64_tr_b16 v[224:225], v245 offset:8192
    v_mfma_f32_16x16x32_bf16 v[144:147], v[228:231], v[192:195], v[144:147]
    ds_read_b64_tr_b16 v[226:227], v245 offset:12288
    v_mfma_f32_16x16x32_bf16 v[148:151], v[228:231], v[196:199], v[148:151]
    s_waitcnt lgkmcnt(4)
    v_mfma_f32_16x16x32_bf16 a[0:3], v[216:219], v[184:187], a[0:3]
    v_xor_b32 v246, 96, v244
    v_mfma_f32_16x16x32_bf16 a[4:7], v[216:219], v[188:191], a[4:7]
    ds_read_b64_tr_b16 v[228:229], v246 offset:8192
    v_mfma_f32_16x16x32_bf16 a[8:11], v[216:219], v[192:195], a[8:11]
    ds_read_b64_tr_b16 v[230:231], v246 offset:12288
    v_mfma_f32_16x16x32_bf16 a[12:15], v[216:219], v[196:199], a[12:15]
    s_waitcnt lgkmcnt(4)
    v_mfma_f32_16x16x32_bf16 a[16:19], v[220:223], v[184:187], a[16:19]
    v_xor_b32 v245, 128, v244
    v_mfma_f32_16x16x32_bf16 a[20:23], v[220:223], v[188:191], a[20:23]
    ds_read_b64_tr_b16 v[216:217], v245 offset:8192
    v_mfma_f32_16x16x32_bf16 a[24:27], v[220:223], v[192:195], a[24:27]
    ds_read_b64_tr_b16 v[218:219], v245 offset:12288
    v_mfma_f32_16x16x32_bf16 a[28:31], v[220:223], v[196:199], a[28:31]
    s_waitcnt lgkmcnt(4)
    v_mfma_f32_16x16x32_bf16 a[32:35], v[224:227], v[184:187], a[32:35]
    v_xor_b32 v246, 160, v244
    v_mfma_f32_16x16x32_bf16 a[36:39], v[224:227], v[188:191], a[36:39]
    ds_read_b64_tr_b16 v[220:221], v246 offset:8192
    v_mfma_f32_16x16x32_bf16 a[40:43], v[224:227], v[192:195], a[40:43]
    ds_read_b64_tr_b16 v[222:223], v246 offset:12288
    v_mfma_f32_16x16x32_bf16 a[44:47], v[224:227], v[196:199], a[44:47]
    s_waitcnt lgkmcnt(4)
    v_mfma_f32_16x16x32_bf16 a[48:51], v[228:231], v[184:187], a[48:51]
    v_xor_b32 v245, 192, v244
    v_mfma_f32_16x16x32_bf16 a[52:55], v[228:231], v[188:191], a[52:55]
    ds_read_b64_tr_b16 v[224:225], v245 offset:8192
    v_mfma_f32_16x16x32_bf16 a[56:59], v[228:231], v[192:195], a[56:59]
    ds_read_b64_tr_b16 v[226:227], v245 offset:12288
    v_mfma_f32_16x16x32_bf16 a[60:63], v[228:231], v[196:199], a[60:63]
    s_waitcnt lgkmcnt(4)
    v_mfma_f32_16x16x32_bf16 a[64:67], v[216:219], v[184:187], a[64:67]
    v_xor_b32 v246, 224, v244
    v_mfma_f32_16x16x32_bf16 a[68:71], v[216:219], v[188:191], a[68:71]
    ds_read_b64_tr_b16 v[228:229], v246 offset:8192
    v_mfma_f32_16x16x32_bf16 a[72:75], v[216:219], v[192:195], a[72:75]
    ds_read_b64_tr_b16 v[230:231], v246 offset:12288
    v_mfma_f32_16x16x32_bf16 a[76:79], v[216:219], v[196:199], a[76:79]
    s_waitcnt lgkmcnt(4)
    v_mfma_f32_16x16x32_bf16 a[80:83], v[220:223], v[184:187], a[80:83]
    s_waitcnt lgkmcnt(0)
    s_barrier
    v_add_u32 v242, 53248, v241
    v_add_u32 v244, 53248, v243
    v_mfma_f32_16x16x32_bf16 a[84:87], v[220:223], v[188:191], a[84:87]
    ds_read_b64_tr_b16 v[216:217], v242 offset:0
    v_mfma_f32_16x16x32_bf16 a[88:91], v[220:223], v[192:195], a[88:91]
    ds_read_b64_tr_b16 v[218:219], v242 offset:4608
    v_mfma_f32_16x16x32_bf16 a[92:95], v[220:223], v[196:199], a[92:95]
    s_add_u32 m0, s76, 0
    s_mov_b32 s80, 1769472
    v_mfma_f32_16x16x32_bf16 a[96:99], v[224:227], v[184:187], a[96:99]
    buffer_load_dwordx4 v232, s[60:63], s80 offen offset:0 nt lds
    v_mfma_f32_16x16x32_bf16 a[100:103], v[224:227], v[188:191], a[100:103]
    ds_read_b64_tr_b16 v[220:221], v242 offset:18432
    v_mfma_f32_16x16x32_bf16 a[104:107], v[224:227], v[192:195], a[104:107]
    ds_read_b64_tr_b16 v[222:223], v242 offset:23040
    v_mfma_f32_16x16x32_bf16 a[108:111], v[224:227], v[196:199], a[108:111]
    v_mfma_f32_16x16x32_bf16 a[112:115], v[228:231], v[184:187], a[112:115]
    buffer_load_dwordx4 v233, s[60:63], s80 offen offset:1024 nt lds
    v_mfma_f32_16x16x32_bf16 a[116:119], v[228:231], v[188:191], a[116:119]
    ds_read_b64_tr_b16 v[224:225], v242 offset:32
    v_mfma_f32_16x16x32_bf16 a[120:123], v[228:231], v[192:195], a[120:123]
    ds_read_b64_tr_b16 v[226:227], v242 offset:4640
    v_mfma_f32_16x16x32_bf16 a[124:127], v[228:231], v[196:199], a[124:127]
    s_waitcnt lgkmcnt(4)
    s_waitcnt vmcnt(19)
    v_mfma_f32_16x16x32_bf16 a[128:131], v[216:219], v[200:203], a[128:131]
    buffer_load_dwordx4 v234, s[60:63], s80 offen offset:2048 nt lds
    v_mfma_f32_16x16x32_bf16 a[132:135], v[216:219], v[204:207], a[132:135]
    ds_read_b64_tr_b16 v[228:229], v242 offset:18464
    v_mfma_f32_16x16x32_bf16 a[136:139], v[216:219], v[208:211], a[136:139]
    ds_read_b64_tr_b16 v[230:231], v242 offset:23072
    v_mfma_f32_16x16x32_bf16 a[140:143], v[216:219], v[212:215], a[140:143]
    s_waitcnt lgkmcnt(4)
    v_mfma_f32_16x16x32_bf16 v[8:11], v[220:223], v[200:203], v[8:11]
    v_mfma_f32_16x16x32_bf16 v[12:15], v[220:223], v[204:207], v[12:15]
    ds_read_b64_tr_b16 v[216:217], v242 offset:64
    v_mfma_f32_16x16x32_bf16 v[16:19], v[220:223], v[208:211], v[16:19]
    ds_read_b64_tr_b16 v[218:219], v242 offset:4672
    v_mfma_f32_16x16x32_bf16 v[20:23], v[220:223], v[212:215], v[20:23]
    s_add_u32 s86, s79, 16384
    s_waitcnt lgkmcnt(4)
    v_mfma_f32_16x16x32_bf16 a[144:147], v[224:227], v[200:203], a[144:147]
    buffer_load_dwordx4 v[184:187], v3, s[16:19], s86 offen offset:0 sc1
    v_mfma_f32_16x16x32_bf16 a[148:151], v[224:227], v[204:207], a[148:151]
    ds_read_b64_tr_b16 v[220:221], v242 offset:18496
    v_mfma_f32_16x16x32_bf16 a[152:155], v[224:227], v[208:211], a[152:155]
    ds_read_b64_tr_b16 v[222:223], v242 offset:23104
    v_mfma_f32_16x16x32_bf16 a[156:159], v[224:227], v[212:215], a[156:159]
    s_waitcnt lgkmcnt(4)
    v_mfma_f32_16x16x32_bf16 v[24:27], v[228:231], v[200:203], v[24:27]
    v_mfma_f32_16x16x32_bf16 v[28:31], v[228:231], v[204:207], v[28:31]
    ds_read_b64_tr_b16 v[224:225], v242 offset:96
    v_mfma_f32_16x16x32_bf16 v[32:35], v[228:231], v[208:211], v[32:35]
    ds_read_b64_tr_b16 v[226:227], v242 offset:4704
    v_mfma_f32_16x16x32_bf16 v[36:39], v[228:231], v[212:215], v[36:39]
    s_add_u32 s86, s79, 16384
    s_waitcnt lgkmcnt(4)
    v_mfma_f32_16x16x32_bf16 a[160:163], v[216:219], v[200:203], a[160:163]
    buffer_load_dwordx4 v[188:191], v3, s[16:19], s86 offen offset:1024 sc1
    v_mfma_f32_16x16x32_bf16 a[164:167], v[216:219], v[204:207], a[164:167]
    ds_read_b64_tr_b16 v[228:229], v242 offset:18528
    v_mfma_f32_16x16x32_bf16 a[168:171], v[216:219], v[208:211], a[168:171]
    ds_read_b64_tr_b16 v[230:231], v242 offset:23136
    v_mfma_f32_16x16x32_bf16 a[172:175], v[216:219], v[212:215], a[172:175]
    s_waitcnt lgkmcnt(4)
    v_mfma_f32_16x16x32_bf16 v[40:43], v[220:223], v[200:203], v[40:43]
    v_mfma_f32_16x16x32_bf16 v[44:47], v[220:223], v[204:207], v[44:47]
    ds_read_b64_tr_b16 v[216:217], v242 offset:128
    v_mfma_f32_16x16x32_bf16 v[48:51], v[220:223], v[208:211], v[48:51]
    ds_read_b64_tr_b16 v[218:219], v242 offset:4736
    v_mfma_f32_16x16x32_bf16 v[52:55], v[220:223], v[212:215], v[52:55]
    s_add_u32 s86, s79, 16384
    s_waitcnt lgkmcnt(4)
    v_mfma_f32_16x16x32_bf16 a[176:179], v[224:227], v[200:203], a[176:179]
    buffer_load_dwordx4 v[192:195], v3, s[16:19], s86 offen offset:2048 sc1
    v_mfma_f32_16x16x32_bf16 a[180:183], v[224:227], v[204:207], a[180:183]
    ds_read_b64_tr_b16 v[220:221], v242 offset:18560
    v_mfma_f32_16x16x32_bf16 a[184:187], v[224:227], v[208:211], a[184:187]
    ds_read_b64_tr_b16 v[222:223], v242 offset:23168
    v_mfma_f32_16x16x32_bf16 a[188:191], v[224:227], v[212:215], a[188:191]
    s_waitcnt lgkmcnt(4)
    v_mfma_f32_16x16x32_bf16 v[56:59], v[228:231], v[200:203], v[56:59]
    v_mfma_f32_16x16x32_bf16 v[60:63], v[228:231], v[204:207], v[60:63]
    ds_read_b64_tr_b16 v[224:225], v242 offset:160
    v_mfma_f32_16x16x32_bf16 v[64:67], v[228:231], v[208:211], v[64:67]
    ds_read_b64_tr_b16 v[226:227], v242 offset:4768
    v_mfma_f32_16x16x32_bf16 v[68:71], v[228:231], v[212:215], v[68:71]
    s_add_u32 s86, s79, 16384
    s_waitcnt lgkmcnt(4)
    v_mfma_f32_16x16x32_bf16 a[192:195], v[216:219], v[200:203], a[192:195]
    buffer_load_dwordx4 v[196:199], v3, s[16:19], s86 offen offset:3072 sc1
    v_mfma_f32_16x16x32_bf16 a[196:199], v[216:219], v[204:207], a[196:199]
    ds_read_b64_tr_b16 v[228:229], v242 offset:18592
    v_mfma_f32_16x16x32_bf16 a[200:203], v[216:219], v[208:211], a[200:203]
    ds_read_b64_tr_b16 v[230:231], v242 offset:23200
    v_mfma_f32_16x16x32_bf16 a[204:207], v[216:219], v[212:215], a[204:207]
    s_waitcnt lgkmcnt(4)
    v_mfma_f32_16x16x32_bf16 v[72:75], v[220:223], v[200:203], v[72:75]
    v_mfma_f32_16x16x32_bf16 v[76:79], v[220:223], v[204:207], v[76:79]
    ds_read_b64_tr_b16 v[216:217], v242 offset:192
    v_mfma_f32_16x16x32_bf16 v[80:83], v[220:223], v[208:211], v[80:83]
    ds_read_b64_tr_b16 v[218:219], v242 offset:4800
    v_mfma_f32_16x16x32_bf16 v[84:87], v[220:223], v[212:215], v[84:87]
    s_waitcnt lgkmcnt(4)
    v_mfma_f32_16x16x32_bf16 a[208:211], v[224:227], v[200:203], a[208:211]
    buffer_load_dwordx4 v235, s[60:63], s80 offen offset:3072 nt lds
    v_mfma_f32_16x16x32_bf16 a[212:215], v[224:227], v[204:207], a[212:215]
    ds_read_b64_tr_b16 v[220:221], v242 offset:18624
    v_mfma_f32_16x16x32_bf16 a[216:219], v[224:227], v[208:211], a[216:219]
    ds_read_b64_tr_b16 v[222:223], v242 offset:23232
    v_mfma_f32_16x16x32_bf16 a[220:223], v[224:227], v[212:215], a[220:223]
    s_waitcnt lgkmcnt(4)
    v_mfma_f32_16x16x32_bf16 v[88:91], v[228:231], v[200:203], v[88:91]
    v_mfma_f32_16x16x32_bf16 v[92:95], v[228:231], v[204:207], v[92:95]
    ds_read_b64_tr_b16 v[224:225], v242 offset:224
    v_mfma_f32_16x16x32_bf16 v[96:99], v[228:231], v[208:211], v[96:99]
    ds_read_b64_tr_b16 v[226:227], v242 offset:4832
    v_mfma_f32_16x16x32_bf16 v[100:103], v[228:231], v[212:215], v[100:103]
    s_add_u32 m0, s76, 18432
    s_waitcnt lgkmcnt(4)
    v_mfma_f32_16x16x32_bf16 a[224:227], v[216:219], v[200:203], a[224:227]
    buffer_load_dwordx4 v232, s[64:67], s80 offen offset:0 nt lds
    v_mfma_f32_16x16x32_bf16 a[228:231], v[216:219], v[204:207], a[228:231]
    ds_read_b64_tr_b16 v[228:229], v242 offset:18656
    v_mfma_f32_16x16x32_bf16 a[232:235], v[216:219], v[208:211], a[232:235]
    ds_read_b64_tr_b16 v[230:231], v242 offset:23264
    v_mfma_f32_16x16x32_bf16 a[236:239], v[216:219], v[212:215], a[236:239]
    s_waitcnt lgkmcnt(4)
    v_mfma_f32_16x16x32_bf16 v[104:107], v[220:223], v[200:203], v[104:107]
    v_mfma_f32_16x16x32_bf16 v[108:111], v[220:223], v[204:207], v[108:111]
    ds_read_b64_tr_b16 v[216:217], v242 offset:256
    v_mfma_f32_16x16x32_bf16 v[112:115], v[220:223], v[208:211], v[112:115]
    ds_read_b64_tr_b16 v[218:219], v242 offset:4864
    v_mfma_f32_16x16x32_bf16 v[116:119], v[220:223], v[212:215], v[116:119]
    s_waitcnt lgkmcnt(4)
    v_mfma_f32_16x16x32_bf16 a[240:243], v[224:227], v[200:203], a[240:243]
    buffer_load_dwordx4 v233, s[64:67], s80 offen offset:1024 nt lds
    v_mfma_f32_16x16x32_bf16 a[244:247], v[224:227], v[204:207], a[244:247]
    ds_read_b64_tr_b16 v[220:221], v242 offset:18688
    v_mfma_f32_16x16x32_bf16 a[248:251], v[224:227], v[208:211], a[248:251]
    ds_read_b64_tr_b16 v[222:223], v242 offset:23296
    v_mfma_f32_16x16x32_bf16 a[252:255], v[224:227], v[212:215], a[252:255]
    s_waitcnt lgkmcnt(4)
    v_mfma_f32_16x16x32_bf16 v[120:123], v[228:231], v[200:203], v[120:123]
    v_xor_b32 v245, 0, v244
    v_mfma_f32_16x16x32_bf16 v[124:127], v[228:231], v[204:207], v[124:127]
    ds_read_b64_tr_b16 v[224:225], v245 offset:0
    v_mfma_f32_16x16x32_bf16 v[128:131], v[228:231], v[208:211], v[128:131]
    ds_read_b64_tr_b16 v[226:227], v245 offset:4096
    v_mfma_f32_16x16x32_bf16 v[132:135], v[228:231], v[212:215], v[132:135]
    s_waitcnt lgkmcnt(4)
    v_mfma_f32_16x16x32_bf16 v[152:155], v[216:219], v[200:203], v[152:155]
    v_xor_b32 v246, 32, v244
    buffer_load_dwordx4 v234, s[64:67], s80 offen offset:2048 nt lds
    v_mfma_f32_16x16x32_bf16 v[156:159], v[216:219], v[204:207], v[156:159]
    ds_read_b64_tr_b16 v[228:229], v246 offset:0
    v_mfma_f32_16x16x32_bf16 v[160:163], v[216:219], v[208:211], v[160:163]
    ds_read_b64_tr_b16 v[230:231], v246 offset:4096
    v_mfma_f32_16x16x32_bf16 v[164:167], v[216:219], v[212:215], v[164:167]
    s_waitcnt lgkmcnt(4)
    v_mfma_f32_16x16x32_bf16 v[136:139], v[220:223], v[200:203], v[136:139]
    v_xor_b32 v245, 64, v244
    v_mfma_f32_16x16x32_bf16 v[140:143], v[220:223], v[204:207], v[140:143]
    ds_read_b64_tr_b16 v[216:217], v245 offset:0
    v_mfma_f32_16x16x32_bf16 v[144:147], v[220:223], v[208:211], v[144:147]
    ds_read_b64_tr_b16 v[218:219], v245 offset:4096
    v_mfma_f32_16x16x32_bf16 v[148:151], v[220:223], v[212:215], v[148:151]
    s_waitcnt lgkmcnt(4)
    v_mfma_f32_16x16x32_bf16 a[0:3], v[224:227], v[200:203], a[0:3]
    v_xor_b32 v246, 96, v244
    buffer_load_dwordx4 v235, s[64:67], s80 offen offset:3072 nt lds
    v_mfma_f32_16x16x32_bf16 a[4:7], v[224:227], v[204:207], a[4:7]
    ds_read_b64_tr_b16 v[220:221], v246 offset:0
    v_mfma_f32_16x16x32_bf16 a[8:11], v[224:227], v[208:211], a[8:11]
    ds_read_b64_tr_b16 v[222:223], v246 offset:4096
    v_mfma_f32_16x16x32_bf16 a[12:15], v[224:227], v[212:215], a[12:15]
    s_waitcnt lgkmcnt(4)
    v_mfma_f32_16x16x32_bf16 a[16:19], v[228:231], v[200:203], a[16:19]
    v_xor_b32 v245, 128, v244
    v_mfma_f32_16x16x32_bf16 a[20:23], v[228:231], v[204:207], a[20:23]
    ds_read_b64_tr_b16 v[224:225], v245 offset:0
    v_mfma_f32_16x16x32_bf16 a[24:27], v[228:231], v[208:211], a[24:27]
    ds_read_b64_tr_b16 v[226:227], v245 offset:4096
    v_mfma_f32_16x16x32_bf16 a[28:31], v[228:231], v[212:215], a[28:31]
    s_add_u32 m0, s77, 0
    s_waitcnt lgkmcnt(4)
    v_mfma_f32_16x16x32_bf16 a[32:35], v[216:219], v[200:203], a[32:35]
    v_xor_b32 v246, 160, v244
    buffer_load_dwordx4 v236, s[68:71], s80 offen nt lds
    v_mfma_f32_16x16x32_bf16 a[36:39], v[216:219], v[204:207], a[36:39]
    ds_read_b64_tr_b16 v[228:229], v246 offset:0
    v_mfma_f32_16x16x32_bf16 a[40:43], v[216:219], v[208:211], a[40:43]
    ds_read_b64_tr_b16 v[230:231], v246 offset:4096
    v_mfma_f32_16x16x32_bf16 a[44:47], v[216:219], v[212:215], a[44:47]
    s_waitcnt lgkmcnt(4)
    v_mfma_f32_16x16x32_bf16 a[48:51], v[220:223], v[200:203], a[48:51]
    v_xor_b32 v245, 192, v244
    v_mfma_f32_16x16x32_bf16 a[52:55], v[220:223], v[204:207], a[52:55]
    ds_read_b64_tr_b16 v[216:217], v245 offset:0
    v_mfma_f32_16x16x32_bf16 a[56:59], v[220:223], v[208:211], a[56:59]
    ds_read_b64_tr_b16 v[218:219], v245 offset:4096
    v_mfma_f32_16x16x32_bf16 a[60:63], v[220:223], v[212:215], a[60:63]
    s_add_u32 m0, s78, 0
    s_mov_b32 s81, 1572864
    s_waitcnt lgkmcnt(4)
    v_mfma_f32_16x16x32_bf16 a[64:67], v[224:227], v[200:203], a[64:67]
    v_xor_b32 v246, 224, v244
    buffer_load_dwordx4 v237, s[72:75], s81 offen offset:0 nt lds
    v_mfma_f32_16x16x32_bf16 a[68:71], v[224:227], v[204:207], a[68:71]
    ds_read_b64_tr_b16 v[220:221], v246 offset:0
    v_mfma_f32_16x16x32_bf16 a[72:75], v[224:227], v[208:211], a[72:75]
    ds_read_b64_tr_b16 v[222:223], v246 offset:4096
    v_mfma_f32_16x16x32_bf16 a[76:79], v[224:227], v[212:215], a[76:79]
    s_waitcnt lgkmcnt(4)
    v_mfma_f32_16x16x32_bf16 a[80:83], v[228:231], v[200:203], a[80:83]
    v_mfma_f32_16x16x32_bf16 a[84:87], v[228:231], v[204:207], a[84:87]
    ds_read_b64_tr_b16 v[224:225], v242 offset:9216
    v_mfma_f32_16x16x32_bf16 a[88:91], v[228:231], v[208:211], a[88:91]
    ds_read_b64_tr_b16 v[226:227], v242 offset:13824
    v_mfma_f32_16x16x32_bf16 a[92:95], v[228:231], v[212:215], a[92:95]
    s_waitcnt lgkmcnt(4)
    v_mfma_f32_16x16x32_bf16 a[96:99], v[216:219], v[200:203], a[96:99]
    buffer_load_dwordx4 v238, s[72:75], s81 offen offset:1024 nt lds
    v_mfma_f32_16x16x32_bf16 a[100:103], v[216:219], v[204:207], a[100:103]
    ds_read_b64_tr_b16 v[228:229], v242 offset:27648
    v_mfma_f32_16x16x32_bf16 a[104:107], v[216:219], v[208:211], a[104:107]
    ds_read_b64_tr_b16 v[230:231], v242 offset:32256
    v_mfma_f32_16x16x32_bf16 a[108:111], v[216:219], v[212:215], a[108:111]
    s_waitcnt lgkmcnt(4)
    v_mfma_f32_16x16x32_bf16 a[112:115], v[220:223], v[200:203], a[112:115]
    v_mfma_f32_16x16x32_bf16 a[116:119], v[220:223], v[204:207], a[116:119]
    ds_read_b64_tr_b16 v[216:217], v242 offset:9248
    v_mfma_f32_16x16x32_bf16 a[120:123], v[220:223], v[208:211], a[120:123]
    ds_read_b64_tr_b16 v[218:219], v242 offset:13856
    v_mfma_f32_16x16x32_bf16 a[124:127], v[220:223], v[212:215], a[124:127]
    s_waitcnt lgkmcnt(4)
    s_waitcnt vmcnt(15)
    v_mfma_f32_16x16x32_bf16 a[128:131], v[224:227], v[168:171], a[128:131]
    buffer_load_dwordx4 v239, s[72:75], s81 offen offset:2048 nt lds
    v_mfma_f32_16x16x32_bf16 a[132:135], v[224:227], v[172:175], a[132:135]
    ds_read_b64_tr_b16 v[220:221], v242 offset:27680
    v_mfma_f32_16x16x32_bf16 a[136:139], v[224:227], v[176:179], a[136:139]
    ds_read_b64_tr_b16 v[222:223], v242 offset:32288
    v_mfma_f32_16x16x32_bf16 a[140:143], v[224:227], v[180:183], a[140:143]
    s_waitcnt lgkmcnt(4)
    v_mfma_f32_16x16x32_bf16 v[8:11], v[228:231], v[168:171], v[8:11]
    v_mfma_f32_16x16x32_bf16 v[12:15], v[228:231], v[172:175], v[12:15]
    ds_read_b64_tr_b16 v[224:225], v242 offset:9280
    v_mfma_f32_16x16x32_bf16 v[16:19], v[228:231], v[176:179], v[16:19]
    ds_read_b64_tr_b16 v[226:227], v242 offset:13888
    v_mfma_f32_16x16x32_bf16 v[20:23], v[228:231], v[180:183], v[20:23]
    s_add_u32 s86, s79, 20480
    s_waitcnt lgkmcnt(4)
    v_mfma_f32_16x16x32_bf16 a[144:147], v[216:219], v[168:171], a[144:147]
    buffer_load_dwordx4 v[200:203], v3, s[16:19], s86 offen offset:0 sc1
    v_mfma_f32_16x16x32_bf16 a[148:151], v[216:219], v[172:175], a[148:151]
    ds_read_b64_tr_b16 v[228:229], v242 offset:27712
    v_mfma_f32_16x16x32_bf16 a[152:155], v[216:219], v[176:179], a[152:155]
    ds_read_b64_tr_b16 v[230:231], v242 offset:32320
    v_mfma_f32_16x16x32_bf16 a[156:159], v[216:219], v[180:183], a[156:159]
    s_waitcnt lgkmcnt(4)
    v_mfma_f32_16x16x32_bf16 v[24:27], v[220:223], v[168:171], v[24:27]
    v_mfma_f32_16x16x32_bf16 v[28:31], v[220:223], v[172:175], v[28:31]
    ds_read_b64_tr_b16 v[216:217], v242 offset:9312
    v_mfma_f32_16x16x32_bf16 v[32:35], v[220:223], v[176:179], v[32:35]
    ds_read_b64_tr_b16 v[218:219], v242 offset:13920
    v_mfma_f32_16x16x32_bf16 v[36:39], v[220:223], v[180:183], v[36:39]
    s_add_u32 s86, s79, 20480
    s_waitcnt lgkmcnt(4)
    v_mfma_f32_16x16x32_bf16 a[160:163], v[224:227], v[168:171], a[160:163]
    buffer_load_dwordx4 v[204:207], v3, s[16:19], s86 offen offset:1024 sc1
    v_mfma_f32_16x16x32_bf16 a[164:167], v[224:227], v[172:175], a[164:167]
    ds_read_b64_tr_b16 v[220:221], v242 offset:27744
    v_mfma_f32_16x16x32_bf16 a[168:171], v[224:227], v[176:179], a[168:171]
    ds_read_b64_tr_b16 v[222:223], v242 offset:32352
    v_mfma_f32_16x16x32_bf16 a[172:175], v[224:227], v[180:183], a[172:175]
    s_waitcnt lgkmcnt(4)
    v_mfma_f32_16x16x32_bf16 v[40:43], v[228:231], v[168:171], v[40:43]
    v_mfma_f32_16x16x32_bf16 v[44:47], v[228:231], v[172:175], v[44:47]
    ds_read_b64_tr_b16 v[224:225], v242 offset:9344
    v_mfma_f32_16x16x32_bf16 v[48:51], v[228:231], v[176:179], v[48:51]
    ds_read_b64_tr_b16 v[226:227], v242 offset:13952
    v_mfma_f32_16x16x32_bf16 v[52:55], v[228:231], v[180:183], v[52:55]
    s_add_u32 s86, s79, 20480
    s_waitcnt lgkmcnt(4)
    v_mfma_f32_16x16x32_bf16 a[176:179], v[216:219], v[168:171], a[176:179]
    buffer_load_dwordx4 v[208:211], v3, s[16:19], s86 offen offset:2048 sc1
    v_mfma_f32_16x16x32_bf16 a[180:183], v[216:219], v[172:175], a[180:183]
    ds_read_b64_tr_b16 v[228:229], v242 offset:27776
    v_mfma_f32_16x16x32_bf16 a[184:187], v[216:219], v[176:179], a[184:187]
    ds_read_b64_tr_b16 v[230:231], v242 offset:32384
    v_mfma_f32_16x16x32_bf16 a[188:191], v[216:219], v[180:183], a[188:191]
    s_waitcnt lgkmcnt(4)
    v_mfma_f32_16x16x32_bf16 v[56:59], v[220:223], v[168:171], v[56:59]
    v_mfma_f32_16x16x32_bf16 v[60:63], v[220:223], v[172:175], v[60:63]
    ds_read_b64_tr_b16 v[216:217], v242 offset:9376
    v_mfma_f32_16x16x32_bf16 v[64:67], v[220:223], v[176:179], v[64:67]
    ds_read_b64_tr_b16 v[218:219], v242 offset:13984
    v_mfma_f32_16x16x32_bf16 v[68:71], v[220:223], v[180:183], v[68:71]
    s_add_u32 s86, s79, 20480
    s_waitcnt lgkmcnt(4)
    v_mfma_f32_16x16x32_bf16 a[192:195], v[224:227], v[168:171], a[192:195]
    buffer_load_dwordx4 v[212:215], v3, s[16:19], s86 offen offset:3072 sc1
    v_mfma_f32_16x16x32_bf16 a[196:199], v[224:227], v[172:175], a[196:199]
    ds_read_b64_tr_b16 v[220:221], v242 offset:27808
    v_mfma_f32_16x16x32_bf16 a[200:203], v[224:227], v[176:179], a[200:203]
    ds_read_b64_tr_b16 v[222:223], v242 offset:32416
    v_mfma_f32_16x16x32_bf16 a[204:207], v[224:227], v[180:183], a[204:207]
    s_waitcnt lgkmcnt(4)
    v_mfma_f32_16x16x32_bf16 v[72:75], v[228:231], v[168:171], v[72:75]
    v_mfma_f32_16x16x32_bf16 v[76:79], v[228:231], v[172:175], v[76:79]
    ds_read_b64_tr_b16 v[224:225], v242 offset:9408
    v_mfma_f32_16x16x32_bf16 v[80:83], v[228:231], v[176:179], v[80:83]
    ds_read_b64_tr_b16 v[226:227], v242 offset:14016
    v_mfma_f32_16x16x32_bf16 v[84:87], v[228:231], v[180:183], v[84:87]
    s_waitcnt lgkmcnt(4)
    v_mfma_f32_16x16x32_bf16 a[208:211], v[216:219], v[168:171], a[208:211]
    buffer_load_dwordx4 v240, s[72:75], s81 offen offset:3072 nt lds
    v_mfma_f32_16x16x32_bf16 a[212:215], v[216:219], v[172:175], a[212:215]
    ds_read_b64_tr_b16 v[228:229], v242 offset:27840
    v_mfma_f32_16x16x32_bf16 a[216:219], v[216:219], v[176:179], a[216:219]
    ds_read_b64_tr_b16 v[230:231], v242 offset:32448
    v_mfma_f32_16x16x32_bf16 a[220:223], v[216:219], v[180:183], a[220:223]
    s_waitcnt lgkmcnt(4)
    v_mfma_f32_16x16x32_bf16 v[88:91], v[220:223], v[168:171], v[88:91]
    v_mfma_f32_16x16x32_bf16 v[92:95], v[220:223], v[172:175], v[92:95]
    ds_read_b64_tr_b16 v[216:217], v242 offset:9440
    v_mfma_f32_16x16x32_bf16 v[96:99], v[220:223], v[176:179], v[96:99]
    ds_read_b64_tr_b16 v[218:219], v242 offset:14048
    v_mfma_f32_16x16x32_bf16 v[100:103], v[220:223], v[180:183], v[100:103]
    s_waitcnt lgkmcnt(4)
    v_mfma_f32_16x16x32_bf16 a[224:227], v[224:227], v[168:171], a[224:227]
    v_mfma_f32_16x16x32_bf16 a[228:231], v[224:227], v[172:175], a[228:231]
    ds_read_b64_tr_b16 v[220:221], v242 offset:27872
    v_mfma_f32_16x16x32_bf16 a[232:235], v[224:227], v[176:179], a[232:235]
    ds_read_b64_tr_b16 v[222:223], v242 offset:32480
    v_mfma_f32_16x16x32_bf16 a[236:239], v[224:227], v[180:183], a[236:239]
    s_waitcnt lgkmcnt(4)
    v_mfma_f32_16x16x32_bf16 v[104:107], v[228:231], v[168:171], v[104:107]
    v_mfma_f32_16x16x32_bf16 v[108:111], v[228:231], v[172:175], v[108:111]
    ds_read_b64_tr_b16 v[224:225], v242 offset:9472
    v_mfma_f32_16x16x32_bf16 v[112:115], v[228:231], v[176:179], v[112:115]
    ds_read_b64_tr_b16 v[226:227], v242 offset:14080
    v_mfma_f32_16x16x32_bf16 v[116:119], v[228:231], v[180:183], v[116:119]
    s_waitcnt lgkmcnt(4)
    v_mfma_f32_16x16x32_bf16 a[240:243], v[216:219], v[168:171], a[240:243]
    v_mfma_f32_16x16x32_bf16 a[244:247], v[216:219], v[172:175], a[244:247]
    ds_read_b64_tr_b16 v[228:229], v242 offset:27904
    v_mfma_f32_16x16x32_bf16 a[248:251], v[216:219], v[176:179], a[248:251]
    ds_read_b64_tr_b16 v[230:231], v242 offset:32512
    v_mfma_f32_16x16x32_bf16 a[252:255], v[216:219], v[180:183], a[252:255]
    s_waitcnt lgkmcnt(4)
    v_mfma_f32_16x16x32_bf16 v[120:123], v[220:223], v[168:171], v[120:123]
    v_xor_b32 v245, 0, v244
    v_mfma_f32_16x16x32_bf16 v[124:127], v[220:223], v[172:175], v[124:127]
    ds_read_b64_tr_b16 v[216:217], v245 offset:8192
    v_mfma_f32_16x16x32_bf16 v[128:131], v[220:223], v[176:179], v[128:131]
    ds_read_b64_tr_b16 v[218:219], v245 offset:12288
    v_mfma_f32_16x16x32_bf16 v[132:135], v[220:223], v[180:183], v[132:135]
    s_waitcnt lgkmcnt(4)
    v_mfma_f32_16x16x32_bf16 v[152:155], v[224:227], v[168:171], v[152:155]
    v_xor_b32 v246, 32, v244
    v_mfma_f32_16x16x32_bf16 v[156:159], v[224:227], v[172:175], v[156:159]
    ds_read_b64_tr_b16 v[220:221], v246 offset:8192
    v_mfma_f32_16x16x32_bf16 v[160:163], v[224:227], v[176:179], v[160:163]
    ds_read_b64_tr_b16 v[222:223], v246 offset:12288
    v_mfma_f32_16x16x32_bf16 v[164:167], v[224:227], v[180:183], v[164:167]
    s_waitcnt lgkmcnt(4)
    v_mfma_f32_16x16x32_bf16 v[136:139], v[228:231], v[168:171], v[136:139]
    v_xor_b32 v245, 64, v244
    v_mfma_f32_16x16x32_bf16 v[140:143], v[228:231], v[172:175], v[140:143]
    ds_read_b64_tr_b16 v[224:225], v245 offset:8192
    v_mfma_f32_16x16x32_bf16 v[144:147], v[228:231], v[176:179], v[144:147]
    ds_read_b64_tr_b16 v[226:227], v245 offset:12288
    v_mfma_f32_16x16x32_bf16 v[148:151], v[228:231], v[180:183], v[148:151]
    s_waitcnt lgkmcnt(4)
    v_mfma_f32_16x16x32_bf16 a[0:3], v[216:219], v[168:171], a[0:3]
    v_xor_b32 v246, 96, v244
    v_mfma_f32_16x16x32_bf16 a[4:7], v[216:219], v[172:175], a[4:7]
    ds_read_b64_tr_b16 v[228:229], v246 offset:8192
    v_mfma_f32_16x16x32_bf16 a[8:11], v[216:219], v[176:179], a[8:11]
    ds_read_b64_tr_b16 v[230:231], v246 offset:12288
    v_mfma_f32_16x16x32_bf16 a[12:15], v[216:219], v[180:183], a[12:15]
    s_waitcnt lgkmcnt(4)
    v_mfma_f32_16x16x32_bf16 a[16:19], v[220:223], v[168:171], a[16:19]
    v_xor_b32 v245, 128, v244
    v_mfma_f32_16x16x32_bf16 a[20:23], v[220:223], v[172:175], a[20:23]
    ds_read_b64_tr_b16 v[216:217], v245 offset:8192
    v_mfma_f32_16x16x32_bf16 a[24:27], v[220:223], v[176:179], a[24:27]
    ds_read_b64_tr_b16 v[218:219], v245 offset:12288
    v_mfma_f32_16x16x32_bf16 a[28:31], v[220:223], v[180:183], a[28:31]
    s_waitcnt lgkmcnt(4)
    v_mfma_f32_16x16x32_bf16 a[32:35], v[224:227], v[168:171], a[32:35]
    v_xor_b32 v246, 160, v244
    v_mfma_f32_16x16x32_bf16 a[36:39], v[224:227], v[172:175], a[36:39]
    ds_read_b64_tr_b16 v[220:221], v246 offset:8192
    v_mfma_f32_16x16x32_bf16 a[40:43], v[224:227], v[176:179], a[40:43]
    ds_read_b64_tr_b16 v[222:223], v246 offset:12288
    v_mfma_f32_16x16x32_bf16 a[44:47], v[224:227], v[180:183], a[44:47]
    s_waitcnt lgkmcnt(4)
    v_mfma_f32_16x16x32_bf16 a[48:51], v[228:231], v[168:171], a[48:51]
    v_xor_b32 v245, 192, v244
    v_mfma_f32_16x16x32_bf16 a[52:55], v[228:231], v[172:175], a[52:55]
    ds_read_b64_tr_b16 v[224:225], v245 offset:8192
    v_mfma_f32_16x16x32_bf16 a[56:59], v[228:231], v[176:179], a[56:59]
    ds_read_b64_tr_b16 v[226:227], v245 offset:12288
    v_mfma_f32_16x16x32_bf16 a[60:63], v[228:231], v[180:183], a[60:63]
    s_waitcnt lgkmcnt(4)
    v_mfma_f32_16x16x32_bf16 a[64:67], v[216:219], v[168:171], a[64:67]
    v_xor_b32 v246, 224, v244
    v_mfma_f32_16x16x32_bf16 a[68:71], v[216:219], v[172:175], a[68:71]
    ds_read_b64_tr_b16 v[228:229], v246 offset:8192
    v_mfma_f32_16x16x32_bf16 a[72:75], v[216:219], v[176:179], a[72:75]
    ds_read_b64_tr_b16 v[230:231], v246 offset:12288
    v_mfma_f32_16x16x32_bf16 a[76:79], v[216:219], v[180:183], a[76:79]
    s_waitcnt lgkmcnt(4)
    v_mfma_f32_16x16x32_bf16 a[80:83], v[220:223], v[168:171], a[80:83]
    s_waitcnt lgkmcnt(0)
    s_barrier
    v_add_u32 v242, 106496, v241
    v_add_u32 v244, 106496, v243
    v_mfma_f32_16x16x32_bf16 a[84:87], v[220:223], v[172:175], a[84:87]
    ds_read_b64_tr_b16 v[216:217], v242 offset:0
    v_mfma_f32_16x16x32_bf16 a[88:91], v[220:223], v[176:179], a[88:91]
    ds_read_b64_tr_b16 v[218:219], v242 offset:4608
    v_mfma_f32_16x16x32_bf16 a[92:95], v[220:223], v[180:183], a[92:95]
    s_add_u32 m0, s76, 53248
    s_mov_b32 s80, 2359296
    v_mfma_f32_16x16x32_bf16 a[96:99], v[224:227], v[168:171], a[96:99]
    buffer_load_dwordx4 v232, s[60:63], s80 offen offset:0 nt lds
    v_mfma_f32_16x16x32_bf16 a[100:103], v[224:227], v[172:175], a[100:103]
    ds_read_b64_tr_b16 v[220:221], v242 offset:18432
    v_mfma_f32_16x16x32_bf16 a[104:107], v[224:227], v[176:179], a[104:107]
    ds_read_b64_tr_b16 v[222:223], v242 offset:23040
    v_mfma_f32_16x16x32_bf16 a[108:111], v[224:227], v[180:183], a[108:111]
    v_mfma_f32_16x16x32_bf16 a[112:115], v[228:231], v[168:171], a[112:115]
    v_mfma_f32_16x16x32_bf16 a[116:119], v[228:231], v[172:175], a[116:119]
    ds_read_b64_tr_b16 v[224:225], v242 offset:32
    v_mfma_f32_16x16x32_bf16 a[120:123], v[228:231], v[176:179], a[120:123]
    ds_read_b64_tr_b16 v[226:227], v242 offset:4640
    v_mfma_f32_16x16x32_bf16 a[124:127], v[228:231], v[180:183], a[124:127]
    s_waitcnt lgkmcnt(4)
    s_waitcnt vmcnt(15)
    v_mfma_f32_16x16x32_bf16 a[128:131], v[216:219], v[184:187], a[128:131]
    buffer_load_dwordx4 v233, s[60:63], s80 offen offset:1024 nt lds
    v_mfma_f32_16x16x32_bf16 a[132:135], v[216:219], v[188:191], a[132:135]
    ds_read_b64_tr_b16 v[228:229], v242 offset:18464
    v_mfma_f32_16x16x32_bf16 a[136:139], v[216:219], v[192:195], a[136:139]
    ds_read_b64_tr_b16 v[230:231], v242 offset:23072
    v_mfma_f32_16x16x32_bf16 a[140:143], v[216:219], v[196:199], a[140:143]
    s_waitcnt lgkmcnt(4)
    v_mfma_f32_16x16x32_bf16 v[8:11], v[220:223], v[184:187], v[8:11]
    v_mfma_f32_16x16x32_bf16 v[12:15], v[220:223], v[188:191], v[12:15]
    ds_read_b64_tr_b16 v[216:217], v242 offset:64
    v_mfma_f32_16x16x32_bf16 v[16:19], v[220:223], v[192:195], v[16:19]
    ds_read_b64_tr_b16 v[218:219], v242 offset:4672
    v_mfma_f32_16x16x32_bf16 v[20:23], v[220:223], v[196:199], v[20:23]
    s_add_u32 s86, s79, 24576
    s_waitcnt lgkmcnt(4)
    v_mfma_f32_16x16x32_bf16 a[144:147], v[224:227], v[184:187], a[144:147]
    buffer_load_dwordx4 v[168:171], v3, s[16:19], s86 offen offset:0 sc1
    v_mfma_f32_16x16x32_bf16 a[148:151], v[224:227], v[188:191], a[148:151]
    ds_read_b64_tr_b16 v[220:221], v242 offset:18496
    v_mfma_f32_16x16x32_bf16 a[152:155], v[224:227], v[192:195], a[152:155]
    ds_read_b64_tr_b16 v[222:223], v242 offset:23104
    v_mfma_f32_16x16x32_bf16 a[156:159], v[224:227], v[196:199], a[156:159]
    s_waitcnt lgkmcnt(4)
    v_mfma_f32_16x16x32_bf16 v[24:27], v[228:231], v[184:187], v[24:27]
    v_mfma_f32_16x16x32_bf16 v[28:31], v[228:231], v[188:191], v[28:31]
    ds_read_b64_tr_b16 v[224:225], v242 offset:96
    v_mfma_f32_16x16x32_bf16 v[32:35], v[228:231], v[192:195], v[32:35]
    ds_read_b64_tr_b16 v[226:227], v242 offset:4704
    v_mfma_f32_16x16x32_bf16 v[36:39], v[228:231], v[196:199], v[36:39]
    s_add_u32 s86, s79, 24576
    s_waitcnt lgkmcnt(4)
    v_mfma_f32_16x16x32_bf16 a[160:163], v[216:219], v[184:187], a[160:163]
    buffer_load_dwordx4 v[172:175], v3, s[16:19], s86 offen offset:1024 sc1
    v_mfma_f32_16x16x32_bf16 a[164:167], v[216:219], v[188:191], a[164:167]
    ds_read_b64_tr_b16 v[228:229], v242 offset:18528
    v_mfma_f32_16x16x32_bf16 a[168:171], v[216:219], v[192:195], a[168:171]
    ds_read_b64_tr_b16 v[230:231], v242 offset:23136
    v_mfma_f32_16x16x32_bf16 a[172:175], v[216:219], v[196:199], a[172:175]
    s_waitcnt lgkmcnt(4)
    v_mfma_f32_16x16x32_bf16 v[40:43], v[220:223], v[184:187], v[40:43]
    v_mfma_f32_16x16x32_bf16 v[44:47], v[220:223], v[188:191], v[44:47]
    ds_read_b64_tr_b16 v[216:217], v242 offset:128
    v_mfma_f32_16x16x32_bf16 v[48:51], v[220:223], v[192:195], v[48:51]
    ds_read_b64_tr_b16 v[218:219], v242 offset:4736
    v_mfma_f32_16x16x32_bf16 v[52:55], v[220:223], v[196:199], v[52:55]
    s_add_u32 s86, s79, 24576
    s_waitcnt lgkmcnt(4)
    v_mfma_f32_16x16x32_bf16 a[176:179], v[224:227], v[184:187], a[176:179]
    buffer_load_dwordx4 v[176:179], v3, s[16:19], s86 offen offset:2048 sc1
    v_mfma_f32_16x16x32_bf16 a[180:183], v[224:227], v[188:191], a[180:183]
    ds_read_b64_tr_b16 v[220:221], v242 offset:18560
    v_mfma_f32_16x16x32_bf16 a[184:187], v[224:227], v[192:195], a[184:187]
    ds_read_b64_tr_b16 v[222:223], v242 offset:23168
    v_mfma_f32_16x16x32_bf16 a[188:191], v[224:227], v[196:199], a[188:191]
    s_waitcnt lgkmcnt(4)
    v_mfma_f32_16x16x32_bf16 v[56:59], v[228:231], v[184:187], v[56:59]
    v_mfma_f32_16x16x32_bf16 v[60:63], v[228:231], v[188:191], v[60:63]
    ds_read_b64_tr_b16 v[224:225], v242 offset:160
    v_mfma_f32_16x16x32_bf16 v[64:67], v[228:231], v[192:195], v[64:67]
    ds_read_b64_tr_b16 v[226:227], v242 offset:4768
    v_mfma_f32_16x16x32_bf16 v[68:71], v[228:231], v[196:199], v[68:71]
    s_add_u32 s86, s79, 24576
    s_waitcnt lgkmcnt(4)
    v_mfma_f32_16x16x32_bf16 a[192:195], v[216:219], v[184:187], a[192:195]
    buffer_load_dwordx4 v[180:183], v3, s[16:19], s86 offen offset:3072 sc1
    v_mfma_f32_16x16x32_bf16 a[196:199], v[216:219], v[188:191], a[196:199]
    ds_read_b64_tr_b16 v[228:229], v242 offset:18592
    v_mfma_f32_16x16x32_bf16 a[200:203], v[216:219], v[192:195], a[200:203]
    ds_read_b64_tr_b16 v[230:231], v242 offset:23200
    v_mfma_f32_16x16x32_bf16 a[204:207], v[216:219], v[196:199], a[204:207]
    s_waitcnt lgkmcnt(4)
    v_mfma_f32_16x16x32_bf16 v[72:75], v[220:223], v[184:187], v[72:75]
    v_mfma_f32_16x16x32_bf16 v[76:79], v[220:223], v[188:191], v[76:79]
    ds_read_b64_tr_b16 v[216:217], v242 offset:192
    v_mfma_f32_16x16x32_bf16 v[80:83], v[220:223], v[192:195], v[80:83]
    ds_read_b64_tr_b16 v[218:219], v242 offset:4800
    v_mfma_f32_16x16x32_bf16 v[84:87], v[220:223], v[196:199], v[84:87]
    s_waitcnt lgkmcnt(4)
    v_mfma_f32_16x16x32_bf16 a[208:211], v[224:227], v[184:187], a[208:211]
    buffer_load_dwordx4 v234, s[60:63], s80 offen offset:2048 nt lds
    v_mfma_f32_16x16x32_bf16 a[212:215], v[224:227], v[188:191], a[212:215]
    ds_read_b64_tr_b16 v[220:221], v242 offset:18624
    v_mfma_f32_16x16x32_bf16 a[216:219], v[224:227], v[192:195], a[216:219]
    ds_read_b64_tr_b16 v[222:223], v242 offset:23232
    v_mfma_f32_16x16x32_bf16 a[220:223], v[224:227], v[196:199], a[220:223]
    s_waitcnt lgkmcnt(4)
    v_mfma_f32_16x16x32_bf16 v[88:91], v[228:231], v[184:187], v[88:91]
    v_mfma_f32_16x16x32_bf16 v[92:95], v[228:231], v[188:191], v[92:95]
    ds_read_b64_tr_b16 v[224:225], v242 offset:224
    v_mfma_f32_16x16x32_bf16 v[96:99], v[228:231], v[192:195], v[96:99]
    ds_read_b64_tr_b16 v[226:227], v242 offset:4832
    v_mfma_f32_16x16x32_bf16 v[100:103], v[228:231], v[196:199], v[100:103]
    s_waitcnt lgkmcnt(4)
    v_mfma_f32_16x16x32_bf16 a[224:227], v[216:219], v[184:187], a[224:227]
    buffer_load_dwordx4 v235, s[60:63], s80 offen offset:3072 nt lds
    v_mfma_f32_16x16x32_bf16 a[228:231], v[216:219], v[188:191], a[228:231]
    ds_read_b64_tr_b16 v[228:229], v242 offset:18656
    v_mfma_f32_16x16x32_bf16 a[232:235], v[216:219], v[192:195], a[232:235]
    ds_read_b64_tr_b16 v[230:231], v242 offset:23264
    v_mfma_f32_16x16x32_bf16 a[236:239], v[216:219], v[196:199], a[236:239]
    s_waitcnt lgkmcnt(4)
    v_mfma_f32_16x16x32_bf16 v[104:107], v[220:223], v[184:187], v[104:107]
    v_mfma_f32_16x16x32_bf16 v[108:111], v[220:223], v[188:191], v[108:111]
    ds_read_b64_tr_b16 v[216:217], v242 offset:256
    v_mfma_f32_16x16x32_bf16 v[112:115], v[220:223], v[192:195], v[112:115]
    ds_read_b64_tr_b16 v[218:219], v242 offset:4864
    v_mfma_f32_16x16x32_bf16 v[116:119], v[220:223], v[196:199], v[116:119]
    s_add_u32 m0, s76, 71680
    s_waitcnt lgkmcnt(4)
    v_mfma_f32_16x16x32_bf16 a[240:243], v[224:227], v[184:187], a[240:243]
    buffer_load_dwordx4 v232, s[64:67], s80 offen offset:0 nt lds
    v_mfma_f32_16x16x32_bf16 a[244:247], v[224:227], v[188:191], a[244:247]
    ds_read_b64_tr_b16 v[220:221], v242 offset:18688
    v_mfma_f32_16x16x32_bf16 a[248:251], v[224:227], v[192:195], a[248:251]
    ds_read_b64_tr_b16 v[222:223], v242 offset:23296
    v_mfma_f32_16x16x32_bf16 a[252:255], v[224:227], v[196:199], a[252:255]
    s_waitcnt lgkmcnt(4)
    v_mfma_f32_16x16x32_bf16 v[120:123], v[228:231], v[184:187], v[120:123]
    v_xor_b32 v245, 0, v244
    v_mfma_f32_16x16x32_bf16 v[124:127], v[228:231], v[188:191], v[124:127]
    ds_read_b64_tr_b16 v[224:225], v245 offset:0
    v_mfma_f32_16x16x32_bf16 v[128:131], v[228:231], v[192:195], v[128:131]
    ds_read_b64_tr_b16 v[226:227], v245 offset:4096
    v_mfma_f32_16x16x32_bf16 v[132:135], v[228:231], v[196:199], v[132:135]
    s_waitcnt lgkmcnt(4)
    v_mfma_f32_16x16x32_bf16 v[152:155], v[216:219], v[184:187], v[152:155]
    v_xor_b32 v246, 32, v244
    buffer_load_dwordx4 v233, s[64:67], s80 offen offset:1024 nt lds
    v_mfma_f32_16x16x32_bf16 v[156:159], v[216:219], v[188:191], v[156:159]
    ds_read_b64_tr_b16 v[228:229], v246 offset:0
    v_mfma_f32_16x16x32_bf16 v[160:163], v[216:219], v[192:195], v[160:163]
    ds_read_b64_tr_b16 v[230:231], v246 offset:4096
    v_mfma_f32_16x16x32_bf16 v[164:167], v[216:219], v[196:199], v[164:167]
    s_waitcnt lgkmcnt(4)
    v_mfma_f32_16x16x32_bf16 v[136:139], v[220:223], v[184:187], v[136:139]
    v_xor_b32 v245, 64, v244
    v_mfma_f32_16x16x32_bf16 v[140:143], v[220:223], v[188:191], v[140:143]
    ds_read_b64_tr_b16 v[216:217], v245 offset:0
    v_mfma_f32_16x16x32_bf16 v[144:147], v[220:223], v[192:195], v[144:147]
    ds_read_b64_tr_b16 v[218:219], v245 offset:4096
    v_mfma_f32_16x16x32_bf16 v[148:151], v[220:223], v[196:199], v[148:151]
    s_waitcnt lgkmcnt(4)
    v_mfma_f32_16x16x32_bf16 a[0:3], v[224:227], v[184:187], a[0:3]
    v_xor_b32 v246, 96, v244
    buffer_load_dwordx4 v234, s[64:67], s80 offen offset:2048 nt lds
    v_mfma_f32_16x16x32_bf16 a[4:7], v[224:227], v[188:191], a[4:7]
    ds_read_b64_tr_b16 v[220:221], v246 offset:0
    v_mfma_f32_16x16x32_bf16 a[8:11], v[224:227], v[192:195], a[8:11]
    ds_read_b64_tr_b16 v[222:223], v246 offset:4096
    v_mfma_f32_16x16x32_bf16 a[12:15], v[224:227], v[196:199], a[12:15]
    s_waitcnt lgkmcnt(4)
    v_mfma_f32_16x16x32_bf16 a[16:19], v[228:231], v[184:187], a[16:19]
    v_xor_b32 v245, 128, v244
    v_mfma_f32_16x16x32_bf16 a[20:23], v[228:231], v[188:191], a[20:23]
    ds_read_b64_tr_b16 v[224:225], v245 offset:0
    v_mfma_f32_16x16x32_bf16 a[24:27], v[228:231], v[192:195], a[24:27]
    ds_read_b64_tr_b16 v[226:227], v245 offset:4096
    v_mfma_f32_16x16x32_bf16 a[28:31], v[228:231], v[196:199], a[28:31]
    s_waitcnt lgkmcnt(4)
    v_mfma_f32_16x16x32_bf16 a[32:35], v[216:219], v[184:187], a[32:35]
    v_xor_b32 v246, 160, v244
    buffer_load_dwordx4 v235, s[64:67], s80 offen offset:3072 nt lds
    v_mfma_f32_16x16x32_bf16 a[36:39], v[216:219], v[188:191], a[36:39]
    ds_read_b64_tr_b16 v[228:229], v246 offset:0
    v_mfma_f32_16x16x32_bf16 a[40:43], v[216:219], v[192:195], a[40:43]
    ds_read_b64_tr_b16 v[230:231], v246 offset:4096
    v_mfma_f32_16x16x32_bf16 a[44:47], v[216:219], v[196:199], a[44:47]
    s_waitcnt lgkmcnt(4)
    v_mfma_f32_16x16x32_bf16 a[48:51], v[220:223], v[184:187], a[48:51]
    v_xor_b32 v245, 192, v244
    v_mfma_f32_16x16x32_bf16 a[52:55], v[220:223], v[188:191], a[52:55]
    ds_read_b64_tr_b16 v[216:217], v245 offset:0
    v_mfma_f32_16x16x32_bf16 a[56:59], v[220:223], v[192:195], a[56:59]
    ds_read_b64_tr_b16 v[218:219], v245 offset:4096
    v_mfma_f32_16x16x32_bf16 a[60:63], v[220:223], v[196:199], a[60:63]
    s_add_u32 m0, s77, 53248
    s_waitcnt lgkmcnt(4)
    v_mfma_f32_16x16x32_bf16 a[64:67], v[224:227], v[184:187], a[64:67]
    v_xor_b32 v246, 224, v244
    buffer_load_dwordx4 v236, s[68:71], s80 offen nt lds
    v_mfma_f32_16x16x32_bf16 a[68:71], v[224:227], v[188:191], a[68:71]
    ds_read_b64_tr_b16 v[220:221], v246 offset:0
    v_mfma_f32_16x16x32_bf16 a[72:75], v[224:227], v[192:195], a[72:75]
    ds_read_b64_tr_b16 v[222:223], v246 offset:4096
    v_mfma_f32_16x16x32_bf16 a[76:79], v[224:227], v[196:199], a[76:79]
    s_waitcnt lgkmcnt(4)
    v_mfma_f32_16x16x32_bf16 a[80:83], v[228:231], v[184:187], a[80:83]
    v_mfma_f32_16x16x32_bf16 a[84:87], v[228:231], v[188:191], a[84:87]
    ds_read_b64_tr_b16 v[224:225], v242 offset:9216
    v_mfma_f32_16x16x32_bf16 a[88:91], v[228:231], v[192:195], a[88:91]
    ds_read_b64_tr_b16 v[226:227], v242 offset:13824
    v_mfma_f32_16x16x32_bf16 a[92:95], v[228:231], v[196:199], a[92:95]
    s_add_u32 m0, s78, 53248
    s_mov_b32 s81, 2097152
    s_waitcnt lgkmcnt(4)
    v_mfma_f32_16x16x32_bf16 a[96:99], v[216:219], v[184:187], a[96:99]
    buffer_load_dwordx4 v237, s[72:75], s81 offen offset:0 nt lds
    v_mfma_f32_16x16x32_bf16 a[100:103], v[216:219], v[188:191], a[100:103]
    ds_read_b64_tr_b16 v[228:229], v242 offset:27648
    v_mfma_f32_16x16x32_bf16 a[104:107], v[216:219], v[192:195], a[104:107]
    ds_read_b64_tr_b16 v[230:231], v242 offset:32256
    v_mfma_f32_16x16x32_bf16 a[108:111], v[216:219], v[196:199], a[108:111]
    s_waitcnt lgkmcnt(4)
    v_mfma_f32_16x16x32_bf16 a[112:115], v[220:223], v[184:187], a[112:115]
    v_mfma_f32_16x16x32_bf16 a[116:119], v[220:223], v[188:191], a[116:119]
    ds_read_b64_tr_b16 v[216:217], v242 offset:9248
    v_mfma_f32_16x16x32_bf16 a[120:123], v[220:223], v[192:195], a[120:123]
    ds_read_b64_tr_b16 v[218:219], v242 offset:13856
    v_mfma_f32_16x16x32_bf16 a[124:127], v[220:223], v[196:199], a[124:127]
    s_waitcnt lgkmcnt(4)
    s_waitcnt vmcnt(15)
    v_mfma_f32_16x16x32_bf16 a[128:131], v[224:227], v[200:203], a[128:131]
    buffer_load_dwordx4 v238, s[72:75], s81 offen offset:1024 nt lds
    v_mfma_f32_16x16x32_bf16 a[132:135], v[224:227], v[204:207], a[132:135]
    ds_read_b64_tr_b16 v[220:221], v242 offset:27680
    v_mfma_f32_16x16x32_bf16 a[136:139], v[224:227], v[208:211], a[136:139]
    ds_read_b64_tr_b16 v[222:223], v242 offset:32288
    v_mfma_f32_16x16x32_bf16 a[140:143], v[224:227], v[212:215], a[140:143]
    s_waitcnt lgkmcnt(4)
    v_mfma_f32_16x16x32_bf16 v[8:11], v[228:231], v[200:203], v[8:11]
    v_mfma_f32_16x16x32_bf16 v[12:15], v[228:231], v[204:207], v[12:15]
    ds_read_b64_tr_b16 v[224:225], v242 offset:9280
    v_mfma_f32_16x16x32_bf16 v[16:19], v[228:231], v[208:211], v[16:19]
    ds_read_b64_tr_b16 v[226:227], v242 offset:13888
    v_mfma_f32_16x16x32_bf16 v[20:23], v[228:231], v[212:215], v[20:23]
    s_add_u32 s86, s79, 28672
    s_waitcnt lgkmcnt(4)
    v_mfma_f32_16x16x32_bf16 a[144:147], v[216:219], v[200:203], a[144:147]
    buffer_load_dwordx4 v[184:187], v3, s[16:19], s86 offen offset:0 sc1
    v_mfma_f32_16x16x32_bf16 a[148:151], v[216:219], v[204:207], a[148:151]
    ds_read_b64_tr_b16 v[228:229], v242 offset:27712
    v_mfma_f32_16x16x32_bf16 a[152:155], v[216:219], v[208:211], a[152:155]
    ds_read_b64_tr_b16 v[230:231], v242 offset:32320
    v_mfma_f32_16x16x32_bf16 a[156:159], v[216:219], v[212:215], a[156:159]
    s_waitcnt lgkmcnt(4)
    v_mfma_f32_16x16x32_bf16 v[24:27], v[220:223], v[200:203], v[24:27]
    v_mfma_f32_16x16x32_bf16 v[28:31], v[220:223], v[204:207], v[28:31]
    ds_read_b64_tr_b16 v[216:217], v242 offset:9312
    v_mfma_f32_16x16x32_bf16 v[32:35], v[220:223], v[208:211], v[32:35]
    ds_read_b64_tr_b16 v[218:219], v242 offset:13920
    v_mfma_f32_16x16x32_bf16 v[36:39], v[220:223], v[212:215], v[36:39]
    s_add_u32 s86, s79, 28672
    s_waitcnt lgkmcnt(4)
    v_mfma_f32_16x16x32_bf16 a[160:163], v[224:227], v[200:203], a[160:163]
    buffer_load_dwordx4 v[188:191], v3, s[16:19], s86 offen offset:1024 sc1
    v_mfma_f32_16x16x32_bf16 a[164:167], v[224:227], v[204:207], a[164:167]
    ds_read_b64_tr_b16 v[220:221], v242 offset:27744
    v_mfma_f32_16x16x32_bf16 a[168:171], v[224:227], v[208:211], a[168:171]
    ds_read_b64_tr_b16 v[222:223], v242 offset:32352
    v_mfma_f32_16x16x32_bf16 a[172:175], v[224:227], v[212:215], a[172:175]
    s_waitcnt lgkmcnt(4)
    v_mfma_f32_16x16x32_bf16 v[40:43], v[228:231], v[200:203], v[40:43]
    v_mfma_f32_16x16x32_bf16 v[44:47], v[228:231], v[204:207], v[44:47]
    ds_read_b64_tr_b16 v[224:225], v242 offset:9344
    v_mfma_f32_16x16x32_bf16 v[48:51], v[228:231], v[208:211], v[48:51]
    ds_read_b64_tr_b16 v[226:227], v242 offset:13952
    v_mfma_f32_16x16x32_bf16 v[52:55], v[228:231], v[212:215], v[52:55]
    s_add_u32 s86, s79, 28672
    s_waitcnt lgkmcnt(4)
    v_mfma_f32_16x16x32_bf16 a[176:179], v[216:219], v[200:203], a[176:179]
    buffer_load_dwordx4 v[192:195], v3, s[16:19], s86 offen offset:2048 sc1
    v_mfma_f32_16x16x32_bf16 a[180:183], v[216:219], v[204:207], a[180:183]
    ds_read_b64_tr_b16 v[228:229], v242 offset:27776
    v_mfma_f32_16x16x32_bf16 a[184:187], v[216:219], v[208:211], a[184:187]
    ds_read_b64_tr_b16 v[230:231], v242 offset:32384
    v_mfma_f32_16x16x32_bf16 a[188:191], v[216:219], v[212:215], a[188:191]
    s_waitcnt lgkmcnt(4)
    v_mfma_f32_16x16x32_bf16 v[56:59], v[220:223], v[200:203], v[56:59]
    v_mfma_f32_16x16x32_bf16 v[60:63], v[220:223], v[204:207], v[60:63]
    ds_read_b64_tr_b16 v[216:217], v242 offset:9376
    v_mfma_f32_16x16x32_bf16 v[64:67], v[220:223], v[208:211], v[64:67]
    ds_read_b64_tr_b16 v[218:219], v242 offset:13984
    v_mfma_f32_16x16x32_bf16 v[68:71], v[220:223], v[212:215], v[68:71]
    s_add_u32 s86, s79, 28672
    s_waitcnt lgkmcnt(4)
    v_mfma_f32_16x16x32_bf16 a[192:195], v[224:227], v[200:203], a[192:195]
    buffer_load_dwordx4 v[196:199], v3, s[16:19], s86 offen offset:3072 sc1
    v_mfma_f32_16x16x32_bf16 a[196:199], v[224:227], v[204:207], a[196:199]
    ds_read_b64_tr_b16 v[220:221], v242 offset:27808
    v_mfma_f32_16x16x32_bf16 a[200:203], v[224:227], v[208:211], a[200:203]
    ds_read_b64_tr_b16 v[222:223], v242 offset:32416
    v_mfma_f32_16x16x32_bf16 a[204:207], v[224:227], v[212:215], a[204:207]
    s_waitcnt lgkmcnt(4)
    v_mfma_f32_16x16x32_bf16 v[72:75], v[228:231], v[200:203], v[72:75]
    v_mfma_f32_16x16x32_bf16 v[76:79], v[228:231], v[204:207], v[76:79]
    ds_read_b64_tr_b16 v[224:225], v242 offset:9408
    v_mfma_f32_16x16x32_bf16 v[80:83], v[228:231], v[208:211], v[80:83]
    ds_read_b64_tr_b16 v[226:227], v242 offset:14016
    v_mfma_f32_16x16x32_bf16 v[84:87], v[228:231], v[212:215], v[84:87]
    s_waitcnt lgkmcnt(4)
    v_mfma_f32_16x16x32_bf16 a[208:211], v[216:219], v[200:203], a[208:211]
    buffer_load_dwordx4 v239, s[72:75], s81 offen offset:2048 nt lds
    v_mfma_f32_16x16x32_bf16 a[212:215], v[216:219], v[204:207], a[212:215]
    ds_read_b64_tr_b16 v[228:229], v242 offset:27840
    v_mfma_f32_16x16x32_bf16 a[216:219], v[216:219], v[208:211], a[216:219]
    ds_read_b64_tr_b16 v[230:231], v242 offset:32448
    v_mfma_f32_16x16x32_bf16 a[220:223], v[216:219], v[212:215], a[220:223]
    s_waitcnt lgkmcnt(4)
    v_mfma_f32_16x16x32_bf16 v[88:91], v[220:223], v[200:203], v[88:91]
    v_mfma_f32_16x16x32_bf16 v[92:95], v[220:223], v[204:207], v[92:95]
    ds_read_b64_tr_b16 v[216:217], v242 offset:9440
    v_mfma_f32_16x16x32_bf16 v[96:99], v[220:223], v[208:211], v[96:99]
    ds_read_b64_tr_b16 v[218:219], v242 offset:14048
    v_mfma_f32_16x16x32_bf16 v[100:103], v[220:223], v[212:215], v[100:103]
    s_waitcnt lgkmcnt(4)
    v_mfma_f32_16x16x32_bf16 a[224:227], v[224:227], v[200:203], a[224:227]
    buffer_load_dwordx4 v240, s[72:75], s81 offen offset:3072 nt lds
    v_mfma_f32_16x16x32_bf16 a[228:231], v[224:227], v[204:207], a[228:231]
    ds_read_b64_tr_b16 v[220:221], v242 offset:27872
    v_mfma_f32_16x16x32_bf16 a[232:235], v[224:227], v[208:211], a[232:235]
    ds_read_b64_tr_b16 v[222:223], v242 offset:32480
    v_mfma_f32_16x16x32_bf16 a[236:239], v[224:227], v[212:215], a[236:239]
    s_waitcnt lgkmcnt(4)
    v_mfma_f32_16x16x32_bf16 v[104:107], v[228:231], v[200:203], v[104:107]
    v_mfma_f32_16x16x32_bf16 v[108:111], v[228:231], v[204:207], v[108:111]
    ds_read_b64_tr_b16 v[224:225], v242 offset:9472
    v_mfma_f32_16x16x32_bf16 v[112:115], v[228:231], v[208:211], v[112:115]
    ds_read_b64_tr_b16 v[226:227], v242 offset:14080
    v_mfma_f32_16x16x32_bf16 v[116:119], v[228:231], v[212:215], v[116:119]
    s_waitcnt lgkmcnt(4)
    v_mfma_f32_16x16x32_bf16 a[240:243], v[216:219], v[200:203], a[240:243]
    v_mfma_f32_16x16x32_bf16 a[244:247], v[216:219], v[204:207], a[244:247]
    ds_read_b64_tr_b16 v[228:229], v242 offset:27904
    v_mfma_f32_16x16x32_bf16 a[248:251], v[216:219], v[208:211], a[248:251]
    ds_read_b64_tr_b16 v[230:231], v242 offset:32512
    v_mfma_f32_16x16x32_bf16 a[252:255], v[216:219], v[212:215], a[252:255]
    s_waitcnt lgkmcnt(4)
    v_mfma_f32_16x16x32_bf16 v[120:123], v[220:223], v[200:203], v[120:123]
    v_xor_b32 v245, 0, v244
    v_mfma_f32_16x16x32_bf16 v[124:127], v[220:223], v[204:207], v[124:127]
    ds_read_b64_tr_b16 v[216:217], v245 offset:8192
    v_mfma_f32_16x16x32_bf16 v[128:131], v[220:223], v[208:211], v[128:131]
    ds_read_b64_tr_b16 v[218:219], v245 offset:12288
    v_mfma_f32_16x16x32_bf16 v[132:135], v[220:223], v[212:215], v[132:135]
    s_waitcnt lgkmcnt(4)
    v_mfma_f32_16x16x32_bf16 v[152:155], v[224:227], v[200:203], v[152:155]
    v_xor_b32 v246, 32, v244
    v_mfma_f32_16x16x32_bf16 v[156:159], v[224:227], v[204:207], v[156:159]
    ds_read_b64_tr_b16 v[220:221], v246 offset:8192
    v_mfma_f32_16x16x32_bf16 v[160:163], v[224:227], v[208:211], v[160:163]
    ds_read_b64_tr_b16 v[222:223], v246 offset:12288
    v_mfma_f32_16x16x32_bf16 v[164:167], v[224:227], v[212:215], v[164:167]
    s_waitcnt lgkmcnt(4)
    v_mfma_f32_16x16x32_bf16 v[136:139], v[228:231], v[200:203], v[136:139]
    v_xor_b32 v245, 64, v244
    v_mfma_f32_16x16x32_bf16 v[140:143], v[228:231], v[204:207], v[140:143]
    ds_read_b64_tr_b16 v[224:225], v245 offset:8192
    v_mfma_f32_16x16x32_bf16 v[144:147], v[228:231], v[208:211], v[144:147]
    ds_read_b64_tr_b16 v[226:227], v245 offset:12288
    v_mfma_f32_16x16x32_bf16 v[148:151], v[228:231], v[212:215], v[148:151]
    s_waitcnt lgkmcnt(4)
    v_mfma_f32_16x16x32_bf16 a[0:3], v[216:219], v[200:203], a[0:3]
    v_xor_b32 v246, 96, v244
    v_mfma_f32_16x16x32_bf16 a[4:7], v[216:219], v[204:207], a[4:7]
    ds_read_b64_tr_b16 v[228:229], v246 offset:8192
    v_mfma_f32_16x16x32_bf16 a[8:11], v[216:219], v[208:211], a[8:11]
    ds_read_b64_tr_b16 v[230:231], v246 offset:12288
    v_mfma_f32_16x16x32_bf16 a[12:15], v[216:219], v[212:215], a[12:15]
    s_waitcnt lgkmcnt(4)
    v_mfma_f32_16x16x32_bf16 a[16:19], v[220:223], v[200:203], a[16:19]
    v_xor_b32 v245, 128, v244
    v_mfma_f32_16x16x32_bf16 a[20:23], v[220:223], v[204:207], a[20:23]
    ds_read_b64_tr_b16 v[216:217], v245 offset:8192
    v_mfma_f32_16x16x32_bf16 a[24:27], v[220:223], v[208:211], a[24:27]
    ds_read_b64_tr_b16 v[218:219], v245 offset:12288
    v_mfma_f32_16x16x32_bf16 a[28:31], v[220:223], v[212:215], a[28:31]
    s_waitcnt lgkmcnt(4)
    v_mfma_f32_16x16x32_bf16 a[32:35], v[224:227], v[200:203], a[32:35]
    v_xor_b32 v246, 160, v244
    v_mfma_f32_16x16x32_bf16 a[36:39], v[224:227], v[204:207], a[36:39]
    ds_read_b64_tr_b16 v[220:221], v246 offset:8192
    v_mfma_f32_16x16x32_bf16 a[40:43], v[224:227], v[208:211], a[40:43]
    ds_read_b64_tr_b16 v[222:223], v246 offset:12288
    v_mfma_f32_16x16x32_bf16 a[44:47], v[224:227], v[212:215], a[44:47]
    s_waitcnt lgkmcnt(4)
    v_mfma_f32_16x16x32_bf16 a[48:51], v[228:231], v[200:203], a[48:51]
    v_xor_b32 v245, 192, v244
    v_mfma_f32_16x16x32_bf16 a[52:55], v[228:231], v[204:207], a[52:55]
    ds_read_b64_tr_b16 v[224:225], v245 offset:8192
    v_mfma_f32_16x16x32_bf16 a[56:59], v[228:231], v[208:211], a[56:59]
    ds_read_b64_tr_b16 v[226:227], v245 offset:12288
    v_mfma_f32_16x16x32_bf16 a[60:63], v[228:231], v[212:215], a[60:63]
    s_waitcnt lgkmcnt(4)
    v_mfma_f32_16x16x32_bf16 a[64:67], v[216:219], v[200:203], a[64:67]
    v_xor_b32 v246, 224, v244
    v_mfma_f32_16x16x32_bf16 a[68:71], v[216:219], v[204:207], a[68:71]
    ds_read_b64_tr_b16 v[228:229], v246 offset:8192
    v_mfma_f32_16x16x32_bf16 a[72:75], v[216:219], v[208:211], a[72:75]
    ds_read_b64_tr_b16 v[230:231], v246 offset:12288
    v_mfma_f32_16x16x32_bf16 a[76:79], v[216:219], v[212:215], a[76:79]
    s_waitcnt lgkmcnt(4)
    v_mfma_f32_16x16x32_bf16 a[80:83], v[220:223], v[200:203], a[80:83]
    s_waitcnt vmcnt(21)
    s_waitcnt lgkmcnt(0)
    s_barrier
    v_add_u32 v242, 0, v241
    v_add_u32 v244, 0, v243
    v_mfma_f32_16x16x32_bf16 a[84:87], v[220:223], v[204:207], a[84:87]
    ds_read_b64_tr_b16 v[216:217], v242 offset:0
    v_mfma_f32_16x16x32_bf16 a[88:91], v[220:223], v[208:211], a[88:91]
    ds_read_b64_tr_b16 v[218:219], v242 offset:4608
    v_mfma_f32_16x16x32_bf16 a[92:95], v[220:223], v[212:215], a[92:95]
    s_add_u32 m0, s76, 106496
    s_mov_b32 s80, 2949120
    v_mfma_f32_16x16x32_bf16 a[96:99], v[224:227], v[200:203], a[96:99]
    buffer_load_dwordx4 v232, s[60:63], s80 offen offset:0 nt lds
    v_mfma_f32_16x16x32_bf16 a[100:103], v[224:227], v[204:207], a[100:103]
    ds_read_b64_tr_b16 v[220:221], v242 offset:18432
    v_mfma_f32_16x16x32_bf16 a[104:107], v[224:227], v[208:211], a[104:107]
    ds_read_b64_tr_b16 v[222:223], v242 offset:23040
    v_mfma_f32_16x16x32_bf16 a[108:111], v[224:227], v[212:215], a[108:111]
    v_mfma_f32_16x16x32_bf16 a[112:115], v[228:231], v[200:203], a[112:115]
    v_mfma_f32_16x16x32_bf16 a[116:119], v[228:231], v[204:207], a[116:119]
    ds_read_b64_tr_b16 v[224:225], v242 offset:32
    v_mfma_f32_16x16x32_bf16 a[120:123], v[228:231], v[208:211], a[120:123]
    ds_read_b64_tr_b16 v[226:227], v242 offset:4640
    v_mfma_f32_16x16x32_bf16 a[124:127], v[228:231], v[212:215], a[124:127]
    s_waitcnt lgkmcnt(4)
    s_waitcnt vmcnt(16)
    v_mfma_f32_16x16x32_bf16 a[128:131], v[216:219], v[168:171], a[128:131]
    buffer_load_dwordx4 v233, s[60:63], s80 offen offset:1024 nt lds
    v_mfma_f32_16x16x32_bf16 a[132:135], v[216:219], v[172:175], a[132:135]
    ds_read_b64_tr_b16 v[228:229], v242 offset:18464
    v_mfma_f32_16x16x32_bf16 a[136:139], v[216:219], v[176:179], a[136:139]
    ds_read_b64_tr_b16 v[230:231], v242 offset:23072
    v_mfma_f32_16x16x32_bf16 a[140:143], v[216:219], v[180:183], a[140:143]
    s_waitcnt lgkmcnt(4)
    v_mfma_f32_16x16x32_bf16 v[8:11], v[220:223], v[168:171], v[8:11]
    v_mfma_f32_16x16x32_bf16 v[12:15], v[220:223], v[172:175], v[12:15]
    ds_read_b64_tr_b16 v[216:217], v242 offset:64
    v_mfma_f32_16x16x32_bf16 v[16:19], v[220:223], v[176:179], v[16:19]
    ds_read_b64_tr_b16 v[218:219], v242 offset:4672
    v_mfma_f32_16x16x32_bf16 v[20:23], v[220:223], v[180:183], v[20:23]
    s_add_u32 s86, s79, 32768
    s_waitcnt lgkmcnt(4)
    v_mfma_f32_16x16x32_bf16 a[144:147], v[224:227], v[168:171], a[144:147]
    buffer_load_dwordx4 v[200:203], v3, s[16:19], s86 offen offset:0 sc1
    v_mfma_f32_16x16x32_bf16 a[148:151], v[224:227], v[172:175], a[148:151]
    ds_read_b64_tr_b16 v[220:221], v242 offset:18496
    v_mfma_f32_16x16x32_bf16 a[152:155], v[224:227], v[176:179], a[152:155]
    ds_read_b64_tr_b16 v[222:223], v242 offset:23104
    v_mfma_f32_16x16x32_bf16 a[156:159], v[224:227], v[180:183], a[156:159]
    s_waitcnt lgkmcnt(4)
    v_mfma_f32_16x16x32_bf16 v[24:27], v[228:231], v[168:171], v[24:27]
    v_mfma_f32_16x16x32_bf16 v[28:31], v[228:231], v[172:175], v[28:31]
    ds_read_b64_tr_b16 v[224:225], v242 offset:96
    v_mfma_f32_16x16x32_bf16 v[32:35], v[228:231], v[176:179], v[32:35]
    ds_read_b64_tr_b16 v[226:227], v242 offset:4704
    v_mfma_f32_16x16x32_bf16 v[36:39], v[228:231], v[180:183], v[36:39]
    s_add_u32 s86, s79, 32768
    s_waitcnt lgkmcnt(4)
    v_mfma_f32_16x16x32_bf16 a[160:163], v[216:219], v[168:171], a[160:163]
    buffer_load_dwordx4 v[204:207], v3, s[16:19], s86 offen offset:1024 sc1
    v_mfma_f32_16x16x32_bf16 a[164:167], v[216:219], v[172:175], a[164:167]
    ds_read_b64_tr_b16 v[228:229], v242 offset:18528
    v_mfma_f32_16x16x32_bf16 a[168:171], v[216:219], v[176:179], a[168:171]
    ds_read_b64_tr_b16 v[230:231], v242 offset:23136
    v_mfma_f32_16x16x32_bf16 a[172:175], v[216:219], v[180:183], a[172:175]
    s_waitcnt lgkmcnt(4)
    v_mfma_f32_16x16x32_bf16 v[40:43], v[220:223], v[168:171], v[40:43]
    v_mfma_f32_16x16x32_bf16 v[44:47], v[220:223], v[172:175], v[44:47]
    ds_read_b64_tr_b16 v[216:217], v242 offset:128
    v_mfma_f32_16x16x32_bf16 v[48:51], v[220:223], v[176:179], v[48:51]
    ds_read_b64_tr_b16 v[218:219], v242 offset:4736
    v_mfma_f32_16x16x32_bf16 v[52:55], v[220:223], v[180:183], v[52:55]
    s_add_u32 s86, s79, 32768
    s_waitcnt lgkmcnt(4)
    v_mfma_f32_16x16x32_bf16 a[176:179], v[224:227], v[168:171], a[176:179]
    buffer_load_dwordx4 v[208:211], v3, s[16:19], s86 offen offset:2048 sc1
    v_mfma_f32_16x16x32_bf16 a[180:183], v[224:227], v[172:175], a[180:183]
    ds_read_b64_tr_b16 v[220:221], v242 offset:18560
    v_mfma_f32_16x16x32_bf16 a[184:187], v[224:227], v[176:179], a[184:187]
    ds_read_b64_tr_b16 v[222:223], v242 offset:23168
    v_mfma_f32_16x16x32_bf16 a[188:191], v[224:227], v[180:183], a[188:191]
    s_waitcnt lgkmcnt(4)
    v_mfma_f32_16x16x32_bf16 v[56:59], v[228:231], v[168:171], v[56:59]
    v_mfma_f32_16x16x32_bf16 v[60:63], v[228:231], v[172:175], v[60:63]
    ds_read_b64_tr_b16 v[224:225], v242 offset:160
    v_mfma_f32_16x16x32_bf16 v[64:67], v[228:231], v[176:179], v[64:67]
    ds_read_b64_tr_b16 v[226:227], v242 offset:4768
    v_mfma_f32_16x16x32_bf16 v[68:71], v[228:231], v[180:183], v[68:71]
    s_add_u32 s86, s79, 32768
    s_waitcnt lgkmcnt(4)
    v_mfma_f32_16x16x32_bf16 a[192:195], v[216:219], v[168:171], a[192:195]
    buffer_load_dwordx4 v[212:215], v3, s[16:19], s86 offen offset:3072 sc1
    v_mfma_f32_16x16x32_bf16 a[196:199], v[216:219], v[172:175], a[196:199]
    ds_read_b64_tr_b16 v[228:229], v242 offset:18592
    v_mfma_f32_16x16x32_bf16 a[200:203], v[216:219], v[176:179], a[200:203]
    ds_read_b64_tr_b16 v[230:231], v242 offset:23200
    v_mfma_f32_16x16x32_bf16 a[204:207], v[216:219], v[180:183], a[204:207]
    s_waitcnt lgkmcnt(4)
    v_mfma_f32_16x16x32_bf16 v[72:75], v[220:223], v[168:171], v[72:75]
    v_mfma_f32_16x16x32_bf16 v[76:79], v[220:223], v[172:175], v[76:79]
    ds_read_b64_tr_b16 v[216:217], v242 offset:192
    v_mfma_f32_16x16x32_bf16 v[80:83], v[220:223], v[176:179], v[80:83]
    ds_read_b64_tr_b16 v[218:219], v242 offset:4800
    v_mfma_f32_16x16x32_bf16 v[84:87], v[220:223], v[180:183], v[84:87]
    s_waitcnt lgkmcnt(4)
    v_mfma_f32_16x16x32_bf16 a[208:211], v[224:227], v[168:171], a[208:211]
    buffer_load_dwordx4 v234, s[60:63], s80 offen offset:2048 nt lds
    v_mfma_f32_16x16x32_bf16 a[212:215], v[224:227], v[172:175], a[212:215]
    ds_read_b64_tr_b16 v[220:221], v242 offset:18624
    v_mfma_f32_16x16x32_bf16 a[216:219], v[224:227], v[176:179], a[216:219]
    ds_read_b64_tr_b16 v[222:223], v242 offset:23232
    v_mfma_f32_16x16x32_bf16 a[220:223], v[224:227], v[180:183], a[220:223]
    s_waitcnt lgkmcnt(4)
    v_mfma_f32_16x16x32_bf16 v[88:91], v[228:231], v[168:171], v[88:91]
    v_mfma_f32_16x16x32_bf16 v[92:95], v[228:231], v[172:175], v[92:95]
    ds_read_b64_tr_b16 v[224:225], v242 offset:224
    v_mfma_f32_16x16x32_bf16 v[96:99], v[228:231], v[176:179], v[96:99]
    ds_read_b64_tr_b16 v[226:227], v242 offset:4832
    v_mfma_f32_16x16x32_bf16 v[100:103], v[228:231], v[180:183], v[100:103]
    s_waitcnt lgkmcnt(4)
    v_mfma_f32_16x16x32_bf16 a[224:227], v[216:219], v[168:171], a[224:227]
    buffer_load_dwordx4 v235, s[60:63], s80 offen offset:3072 nt lds
    v_mfma_f32_16x16x32_bf16 a[228:231], v[216:219], v[172:175], a[228:231]
    ds_read_b64_tr_b16 v[228:229], v242 offset:18656
    v_mfma_f32_16x16x32_bf16 a[232:235], v[216:219], v[176:179], a[232:235]
    ds_read_b64_tr_b16 v[230:231], v242 offset:23264
    v_mfma_f32_16x16x32_bf16 a[236:239], v[216:219], v[180:183], a[236:239]
    s_waitcnt lgkmcnt(4)
    v_mfma_f32_16x16x32_bf16 v[104:107], v[220:223], v[168:171], v[104:107]
    v_mfma_f32_16x16x32_bf16 v[108:111], v[220:223], v[172:175], v[108:111]
    ds_read_b64_tr_b16 v[216:217], v242 offset:256
    v_mfma_f32_16x16x32_bf16 v[112:115], v[220:223], v[176:179], v[112:115]
    ds_read_b64_tr_b16 v[218:219], v242 offset:4864
    v_mfma_f32_16x16x32_bf16 v[116:119], v[220:223], v[180:183], v[116:119]
    s_add_u32 m0, s76, 124928
    s_waitcnt lgkmcnt(4)
    v_mfma_f32_16x16x32_bf16 a[240:243], v[224:227], v[168:171], a[240:243]
    buffer_load_dwordx4 v232, s[64:67], s80 offen offset:0 nt lds
    v_mfma_f32_16x16x32_bf16 a[244:247], v[224:227], v[172:175], a[244:247]
    ds_read_b64_tr_b16 v[220:221], v242 offset:18688
    v_mfma_f32_16x16x32_bf16 a[248:251], v[224:227], v[176:179], a[248:251]
    ds_read_b64_tr_b16 v[222:223], v242 offset:23296
    v_mfma_f32_16x16x32_bf16 a[252:255], v[224:227], v[180:183], a[252:255]
    s_waitcnt lgkmcnt(4)
    v_mfma_f32_16x16x32_bf16 v[120:123], v[228:231], v[168:171], v[120:123]
    v_xor_b32 v245, 0, v244
    v_mfma_f32_16x16x32_bf16 v[124:127], v[228:231], v[172:175], v[124:127]
    ds_read_b64_tr_b16 v[224:225], v245 offset:0
    v_mfma_f32_16x16x32_bf16 v[128:131], v[228:231], v[176:179], v[128:131]
    ds_read_b64_tr_b16 v[226:227], v245 offset:4096
    v_mfma_f32_16x16x32_bf16 v[132:135], v[228:231], v[180:183], v[132:135]
    s_waitcnt lgkmcnt(4)
    v_mfma_f32_16x16x32_bf16 v[152:155], v[216:219], v[168:171], v[152:155]
    v_xor_b32 v246, 32, v244
    buffer_load_dwordx4 v233, s[64:67], s80 offen offset:1024 nt lds
    v_mfma_f32_16x16x32_bf16 v[156:159], v[216:219], v[172:175], v[156:159]
    ds_read_b64_tr_b16 v[228:229], v246 offset:0
    v_mfma_f32_16x16x32_bf16 v[160:163], v[216:219], v[176:179], v[160:163]
    ds_read_b64_tr_b16 v[230:231], v246 offset:4096
    v_mfma_f32_16x16x32_bf16 v[164:167], v[216:219], v[180:183], v[164:167]
    s_waitcnt lgkmcnt(4)
    v_mfma_f32_16x16x32_bf16 v[136:139], v[220:223], v[168:171], v[136:139]
    v_xor_b32 v245, 64, v244
    v_mfma_f32_16x16x32_bf16 v[140:143], v[220:223], v[172:175], v[140:143]
    ds_read_b64_tr_b16 v[216:217], v245 offset:0
    v_mfma_f32_16x16x32_bf16 v[144:147], v[220:223], v[176:179], v[144:147]
    ds_read_b64_tr_b16 v[218:219], v245 offset:4096
    v_mfma_f32_16x16x32_bf16 v[148:151], v[220:223], v[180:183], v[148:151]
    s_waitcnt lgkmcnt(4)
    v_mfma_f32_16x16x32_bf16 a[0:3], v[224:227], v[168:171], a[0:3]
    v_xor_b32 v246, 96, v244
    buffer_load_dwordx4 v234, s[64:67], s80 offen offset:2048 nt lds
    v_mfma_f32_16x16x32_bf16 a[4:7], v[224:227], v[172:175], a[4:7]
    ds_read_b64_tr_b16 v[220:221], v246 offset:0
    v_mfma_f32_16x16x32_bf16 a[8:11], v[224:227], v[176:179], a[8:11]
    ds_read_b64_tr_b16 v[222:223], v246 offset:4096
    v_mfma_f32_16x16x32_bf16 a[12:15], v[224:227], v[180:183], a[12:15]
    s_waitcnt lgkmcnt(4)
    v_mfma_f32_16x16x32_bf16 a[16:19], v[228:231], v[168:171], a[16:19]
    v_xor_b32 v245, 128, v244
    v_mfma_f32_16x16x32_bf16 a[20:23], v[228:231], v[172:175], a[20:23]
    ds_read_b64_tr_b16 v[224:225], v245 offset:0
    v_mfma_f32_16x16x32_bf16 a[24:27], v[228:231], v[176:179], a[24:27]
    ds_read_b64_tr_b16 v[226:227], v245 offset:4096
    v_mfma_f32_16x16x32_bf16 a[28:31], v[228:231], v[180:183], a[28:31]
    s_waitcnt lgkmcnt(4)
    v_mfma_f32_16x16x32_bf16 a[32:35], v[216:219], v[168:171], a[32:35]
    v_xor_b32 v246, 160, v244
    buffer_load_dwordx4 v235, s[64:67], s80 offen offset:3072 nt lds
    v_mfma_f32_16x16x32_bf16 a[36:39], v[216:219], v[172:175], a[36:39]
    ds_read_b64_tr_b16 v[228:229], v246 offset:0
    v_mfma_f32_16x16x32_bf16 a[40:43], v[216:219], v[176:179], a[40:43]
    ds_read_b64_tr_b16 v[230:231], v246 offset:4096
    v_mfma_f32_16x16x32_bf16 a[44:47], v[216:219], v[180:183], a[44:47]
    s_waitcnt lgkmcnt(4)
    v_mfma_f32_16x16x32_bf16 a[48:51], v[220:223], v[168:171], a[48:51]
    v_xor_b32 v245, 192, v244
    v_mfma_f32_16x16x32_bf16 a[52:55], v[220:223], v[172:175], a[52:55]
    ds_read_b64_tr_b16 v[216:217], v245 offset:0
    v_mfma_f32_16x16x32_bf16 a[56:59], v[220:223], v[176:179], a[56:59]
    ds_read_b64_tr_b16 v[218:219], v245 offset:4096
    v_mfma_f32_16x16x32_bf16 a[60:63], v[220:223], v[180:183], a[60:63]
    s_add_u32 m0, s77, 106496
    s_waitcnt lgkmcnt(4)
    v_mfma_f32_16x16x32_bf16 a[64:67], v[224:227], v[168:171], a[64:67]
    v_xor_b32 v246, 224, v244
    buffer_load_dwordx4 v236, s[68:71], s80 offen nt lds
    v_mfma_f32_16x16x32_bf16 a[68:71], v[224:227], v[172:175], a[68:71]
    ds_read_b64_tr_b16 v[220:221], v246 offset:0
    v_mfma_f32_16x16x32_bf16 a[72:75], v[224:227], v[176:179], a[72:75]
    ds_read_b64_tr_b16 v[222:223], v246 offset:4096
    v_mfma_f32_16x16x32_bf16 a[76:79], v[224:227], v[180:183], a[76:79]
    s_waitcnt lgkmcnt(4)
    v_mfma_f32_16x16x32_bf16 a[80:83], v[228:231], v[168:171], a[80:83]
    v_mfma_f32_16x16x32_bf16 a[84:87], v[228:231], v[172:175], a[84:87]
    ds_read_b64_tr_b16 v[224:225], v242 offset:9216
    v_mfma_f32_16x16x32_bf16 a[88:91], v[228:231], v[176:179], a[88:91]
    ds_read_b64_tr_b16 v[226:227], v242 offset:13824
    v_mfma_f32_16x16x32_bf16 a[92:95], v[228:231], v[180:183], a[92:95]
    s_add_u32 m0, s78, 106496
    s_mov_b32 s81, 2621440
    s_waitcnt lgkmcnt(4)
    v_mfma_f32_16x16x32_bf16 a[96:99], v[216:219], v[168:171], a[96:99]
    buffer_load_dwordx4 v237, s[72:75], s81 offen offset:0 nt lds
    v_mfma_f32_16x16x32_bf16 a[100:103], v[216:219], v[172:175], a[100:103]
    ds_read_b64_tr_b16 v[228:229], v242 offset:27648
    v_mfma_f32_16x16x32_bf16 a[104:107], v[216:219], v[176:179], a[104:107]
    ds_read_b64_tr_b16 v[230:231], v242 offset:32256
    v_mfma_f32_16x16x32_bf16 a[108:111], v[216:219], v[180:183], a[108:111]
    s_waitcnt lgkmcnt(4)
    v_mfma_f32_16x16x32_bf16 a[112:115], v[220:223], v[168:171], a[112:115]
    v_mfma_f32_16x16x32_bf16 a[116:119], v[220:223], v[172:175], a[116:119]
    ds_read_b64_tr_b16 v[216:217], v242 offset:9248
    v_mfma_f32_16x16x32_bf16 a[120:123], v[220:223], v[176:179], a[120:123]
    ds_read_b64_tr_b16 v[218:219], v242 offset:13856
    v_mfma_f32_16x16x32_bf16 a[124:127], v[220:223], v[180:183], a[124:127]
    s_waitcnt lgkmcnt(4)
    s_waitcnt vmcnt(16)
    v_mfma_f32_16x16x32_bf16 a[128:131], v[224:227], v[184:187], a[128:131]
    buffer_load_dwordx4 v238, s[72:75], s81 offen offset:1024 nt lds
    v_mfma_f32_16x16x32_bf16 a[132:135], v[224:227], v[188:191], a[132:135]
    ds_read_b64_tr_b16 v[220:221], v242 offset:27680
    v_mfma_f32_16x16x32_bf16 a[136:139], v[224:227], v[192:195], a[136:139]
    ds_read_b64_tr_b16 v[222:223], v242 offset:32288
    v_mfma_f32_16x16x32_bf16 a[140:143], v[224:227], v[196:199], a[140:143]
    s_waitcnt lgkmcnt(4)
    v_mfma_f32_16x16x32_bf16 v[8:11], v[228:231], v[184:187], v[8:11]
    v_mfma_f32_16x16x32_bf16 v[12:15], v[228:231], v[188:191], v[12:15]
    ds_read_b64_tr_b16 v[224:225], v242 offset:9280
    v_mfma_f32_16x16x32_bf16 v[16:19], v[228:231], v[192:195], v[16:19]
    ds_read_b64_tr_b16 v[226:227], v242 offset:13888
    v_mfma_f32_16x16x32_bf16 v[20:23], v[228:231], v[196:199], v[20:23]
    s_add_u32 s86, s79, 36864
    s_waitcnt lgkmcnt(4)
    v_mfma_f32_16x16x32_bf16 a[144:147], v[216:219], v[184:187], a[144:147]
    buffer_load_dwordx4 v[168:171], v3, s[16:19], s86 offen offset:0 sc1
    v_mfma_f32_16x16x32_bf16 a[148:151], v[216:219], v[188:191], a[148:151]
    ds_read_b64_tr_b16 v[228:229], v242 offset:27712
    v_mfma_f32_16x16x32_bf16 a[152:155], v[216:219], v[192:195], a[152:155]
    ds_read_b64_tr_b16 v[230:231], v242 offset:32320
    v_mfma_f32_16x16x32_bf16 a[156:159], v[216:219], v[196:199], a[156:159]
    s_waitcnt lgkmcnt(4)
    v_mfma_f32_16x16x32_bf16 v[24:27], v[220:223], v[184:187], v[24:27]
    v_mfma_f32_16x16x32_bf16 v[28:31], v[220:223], v[188:191], v[28:31]
    ds_read_b64_tr_b16 v[216:217], v242 offset:9312
    v_mfma_f32_16x16x32_bf16 v[32:35], v[220:223], v[192:195], v[32:35]
    ds_read_b64_tr_b16 v[218:219], v242 offset:13920
    v_mfma_f32_16x16x32_bf16 v[36:39], v[220:223], v[196:199], v[36:39]
    s_add_u32 s86, s79, 36864
    s_waitcnt lgkmcnt(4)
    v_mfma_f32_16x16x32_bf16 a[160:163], v[224:227], v[184:187], a[160:163]
    buffer_load_dwordx4 v[172:175], v3, s[16:19], s86 offen offset:1024 sc1
    v_mfma_f32_16x16x32_bf16 a[164:167], v[224:227], v[188:191], a[164:167]
    ds_read_b64_tr_b16 v[220:221], v242 offset:27744
    v_mfma_f32_16x16x32_bf16 a[168:171], v[224:227], v[192:195], a[168:171]
    ds_read_b64_tr_b16 v[222:223], v242 offset:32352
    v_mfma_f32_16x16x32_bf16 a[172:175], v[224:227], v[196:199], a[172:175]
    s_waitcnt lgkmcnt(4)
    v_mfma_f32_16x16x32_bf16 v[40:43], v[228:231], v[184:187], v[40:43]
    v_mfma_f32_16x16x32_bf16 v[44:47], v[228:231], v[188:191], v[44:47]
    ds_read_b64_tr_b16 v[224:225], v242 offset:9344
    v_mfma_f32_16x16x32_bf16 v[48:51], v[228:231], v[192:195], v[48:51]
    ds_read_b64_tr_b16 v[226:227], v242 offset:13952
    v_mfma_f32_16x16x32_bf16 v[52:55], v[228:231], v[196:199], v[52:55]
    s_add_u32 s86, s79, 36864
    s_waitcnt lgkmcnt(4)
    v_mfma_f32_16x16x32_bf16 a[176:179], v[216:219], v[184:187], a[176:179]
    buffer_load_dwordx4 v[176:179], v3, s[16:19], s86 offen offset:2048 sc1
    v_mfma_f32_16x16x32_bf16 a[180:183], v[216:219], v[188:191], a[180:183]
    ds_read_b64_tr_b16 v[228:229], v242 offset:27776
    v_mfma_f32_16x16x32_bf16 a[184:187], v[216:219], v[192:195], a[184:187]
    ds_read_b64_tr_b16 v[230:231], v242 offset:32384
    v_mfma_f32_16x16x32_bf16 a[188:191], v[216:219], v[196:199], a[188:191]
    s_waitcnt lgkmcnt(4)
    v_mfma_f32_16x16x32_bf16 v[56:59], v[220:223], v[184:187], v[56:59]
    v_mfma_f32_16x16x32_bf16 v[60:63], v[220:223], v[188:191], v[60:63]
    ds_read_b64_tr_b16 v[216:217], v242 offset:9376
    v_mfma_f32_16x16x32_bf16 v[64:67], v[220:223], v[192:195], v[64:67]
    ds_read_b64_tr_b16 v[218:219], v242 offset:13984
    v_mfma_f32_16x16x32_bf16 v[68:71], v[220:223], v[196:199], v[68:71]
    s_add_u32 s86, s79, 36864
    s_waitcnt lgkmcnt(4)
    v_mfma_f32_16x16x32_bf16 a[192:195], v[224:227], v[184:187], a[192:195]
    buffer_load_dwordx4 v[180:183], v3, s[16:19], s86 offen offset:3072 sc1
    v_mfma_f32_16x16x32_bf16 a[196:199], v[224:227], v[188:191], a[196:199]
    ds_read_b64_tr_b16 v[220:221], v242 offset:27808
    v_mfma_f32_16x16x32_bf16 a[200:203], v[224:227], v[192:195], a[200:203]
    ds_read_b64_tr_b16 v[222:223], v242 offset:32416
    v_mfma_f32_16x16x32_bf16 a[204:207], v[224:227], v[196:199], a[204:207]
    s_waitcnt lgkmcnt(4)
    v_mfma_f32_16x16x32_bf16 v[72:75], v[228:231], v[184:187], v[72:75]
    v_mfma_f32_16x16x32_bf16 v[76:79], v[228:231], v[188:191], v[76:79]
    ds_read_b64_tr_b16 v[224:225], v242 offset:9408
    v_mfma_f32_16x16x32_bf16 v[80:83], v[228:231], v[192:195], v[80:83]
    ds_read_b64_tr_b16 v[226:227], v242 offset:14016
    v_mfma_f32_16x16x32_bf16 v[84:87], v[228:231], v[196:199], v[84:87]
    s_waitcnt lgkmcnt(4)
    v_mfma_f32_16x16x32_bf16 a[208:211], v[216:219], v[184:187], a[208:211]
    buffer_load_dwordx4 v239, s[72:75], s81 offen offset:2048 nt lds
    v_mfma_f32_16x16x32_bf16 a[212:215], v[216:219], v[188:191], a[212:215]
    ds_read_b64_tr_b16 v[228:229], v242 offset:27840
    v_mfma_f32_16x16x32_bf16 a[216:219], v[216:219], v[192:195], a[216:219]
    ds_read_b64_tr_b16 v[230:231], v242 offset:32448
    v_mfma_f32_16x16x32_bf16 a[220:223], v[216:219], v[196:199], a[220:223]
    s_waitcnt lgkmcnt(4)
    v_mfma_f32_16x16x32_bf16 v[88:91], v[220:223], v[184:187], v[88:91]
    v_mfma_f32_16x16x32_bf16 v[92:95], v[220:223], v[188:191], v[92:95]
    ds_read_b64_tr_b16 v[216:217], v242 offset:9440
    v_mfma_f32_16x16x32_bf16 v[96:99], v[220:223], v[192:195], v[96:99]
    ds_read_b64_tr_b16 v[218:219], v242 offset:14048
    v_mfma_f32_16x16x32_bf16 v[100:103], v[220:223], v[196:199], v[100:103]
    s_waitcnt lgkmcnt(4)
    v_mfma_f32_16x16x32_bf16 a[224:227], v[224:227], v[184:187], a[224:227]
    buffer_load_dwordx4 v240, s[72:75], s81 offen offset:3072 nt lds
    v_mfma_f32_16x16x32_bf16 a[228:231], v[224:227], v[188:191], a[228:231]
    ds_read_b64_tr_b16 v[220:221], v242 offset:27872
    v_mfma_f32_16x16x32_bf16 a[232:235], v[224:227], v[192:195], a[232:235]
    ds_read_b64_tr_b16 v[222:223], v242 offset:32480
    v_mfma_f32_16x16x32_bf16 a[236:239], v[224:227], v[196:199], a[236:239]
    s_waitcnt lgkmcnt(4)
    v_mfma_f32_16x16x32_bf16 v[104:107], v[228:231], v[184:187], v[104:107]
    v_mfma_f32_16x16x32_bf16 v[108:111], v[228:231], v[188:191], v[108:111]
    ds_read_b64_tr_b16 v[224:225], v242 offset:9472
    v_mfma_f32_16x16x32_bf16 v[112:115], v[228:231], v[192:195], v[112:115]
    ds_read_b64_tr_b16 v[226:227], v242 offset:14080
    v_mfma_f32_16x16x32_bf16 v[116:119], v[228:231], v[196:199], v[116:119]
    s_waitcnt lgkmcnt(4)
    v_mfma_f32_16x16x32_bf16 a[240:243], v[216:219], v[184:187], a[240:243]
    v_mfma_f32_16x16x32_bf16 a[244:247], v[216:219], v[188:191], a[244:247]
    ds_read_b64_tr_b16 v[228:229], v242 offset:27904
    v_mfma_f32_16x16x32_bf16 a[248:251], v[216:219], v[192:195], a[248:251]
    ds_read_b64_tr_b16 v[230:231], v242 offset:32512
    v_mfma_f32_16x16x32_bf16 a[252:255], v[216:219], v[196:199], a[252:255]
    s_waitcnt lgkmcnt(4)
    v_mfma_f32_16x16x32_bf16 v[120:123], v[220:223], v[184:187], v[120:123]
    v_xor_b32 v245, 0, v244
    v_mfma_f32_16x16x32_bf16 v[124:127], v[220:223], v[188:191], v[124:127]
    ds_read_b64_tr_b16 v[216:217], v245 offset:8192
    v_mfma_f32_16x16x32_bf16 v[128:131], v[220:223], v[192:195], v[128:131]
    ds_read_b64_tr_b16 v[218:219], v245 offset:12288
    v_mfma_f32_16x16x32_bf16 v[132:135], v[220:223], v[196:199], v[132:135]
    s_waitcnt lgkmcnt(4)
    v_mfma_f32_16x16x32_bf16 v[152:155], v[224:227], v[184:187], v[152:155]
    v_xor_b32 v246, 32, v244
    v_mfma_f32_16x16x32_bf16 v[156:159], v[224:227], v[188:191], v[156:159]
    ds_read_b64_tr_b16 v[220:221], v246 offset:8192
    v_mfma_f32_16x16x32_bf16 v[160:163], v[224:227], v[192:195], v[160:163]
    ds_read_b64_tr_b16 v[222:223], v246 offset:12288
    v_mfma_f32_16x16x32_bf16 v[164:167], v[224:227], v[196:199], v[164:167]
    s_waitcnt lgkmcnt(4)
    v_mfma_f32_16x16x32_bf16 v[136:139], v[228:231], v[184:187], v[136:139]
    v_xor_b32 v245, 64, v244
    v_mfma_f32_16x16x32_bf16 v[140:143], v[228:231], v[188:191], v[140:143]
    ds_read_b64_tr_b16 v[224:225], v245 offset:8192
    v_mfma_f32_16x16x32_bf16 v[144:147], v[228:231], v[192:195], v[144:147]
    ds_read_b64_tr_b16 v[226:227], v245 offset:12288
    v_mfma_f32_16x16x32_bf16 v[148:151], v[228:231], v[196:199], v[148:151]
    s_waitcnt lgkmcnt(4)
    v_mfma_f32_16x16x32_bf16 a[0:3], v[216:219], v[184:187], a[0:3]
    v_xor_b32 v246, 96, v244
    v_mfma_f32_16x16x32_bf16 a[4:7], v[216:219], v[188:191], a[4:7]
    ds_read_b64_tr_b16 v[228:229], v246 offset:8192
    v_mfma_f32_16x16x32_bf16 a[8:11], v[216:219], v[192:195], a[8:11]
    ds_read_b64_tr_b16 v[230:231], v246 offset:12288
    v_mfma_f32_16x16x32_bf16 a[12:15], v[216:219], v[196:199], a[12:15]
    s_waitcnt lgkmcnt(4)
    v_mfma_f32_16x16x32_bf16 a[16:19], v[220:223], v[184:187], a[16:19]
    v_xor_b32 v245, 128, v244
    v_mfma_f32_16x16x32_bf16 a[20:23], v[220:223], v[188:191], a[20:23]
    ds_read_b64_tr_b16 v[216:217], v245 offset:8192
    v_mfma_f32_16x16x32_bf16 a[24:27], v[220:223], v[192:195], a[24:27]
    ds_read_b64_tr_b16 v[218:219], v245 offset:12288
    v_mfma_f32_16x16x32_bf16 a[28:31], v[220:223], v[196:199], a[28:31]
    s_waitcnt lgkmcnt(4)
    v_mfma_f32_16x16x32_bf16 a[32:35], v[224:227], v[184:187], a[32:35]
    v_xor_b32 v246, 160, v244
    v_mfma_f32_16x16x32_bf16 a[36:39], v[224:227], v[188:191], a[36:39]
    ds_read_b64_tr_b16 v[220:221], v246 offset:8192
    v_mfma_f32_16x16x32_bf16 a[40:43], v[224:227], v[192:195], a[40:43]
    ds_read_b64_tr_b16 v[222:223], v246 offset:12288
    v_mfma_f32_16x16x32_bf16 a[44:47], v[224:227], v[196:199], a[44:47]
    s_waitcnt lgkmcnt(4)
    v_mfma_f32_16x16x32_bf16 a[48:51], v[228:231], v[184:187], a[48:51]
    v_xor_b32 v245, 192, v244
    v_mfma_f32_16x16x32_bf16 a[52:55], v[228:231], v[188:191], a[52:55]
    ds_read_b64_tr_b16 v[224:225], v245 offset:8192
    v_mfma_f32_16x16x32_bf16 a[56:59], v[228:231], v[192:195], a[56:59]
    ds_read_b64_tr_b16 v[226:227], v245 offset:12288
    v_mfma_f32_16x16x32_bf16 a[60:63], v[228:231], v[196:199], a[60:63]
    s_waitcnt lgkmcnt(4)
    v_mfma_f32_16x16x32_bf16 a[64:67], v[216:219], v[184:187], a[64:67]
    v_xor_b32 v246, 224, v244
    v_mfma_f32_16x16x32_bf16 a[68:71], v[216:219], v[188:191], a[68:71]
    ds_read_b64_tr_b16 v[228:229], v246 offset:8192
    v_mfma_f32_16x16x32_bf16 a[72:75], v[216:219], v[192:195], a[72:75]
    ds_read_b64_tr_b16 v[230:231], v246 offset:12288
    v_mfma_f32_16x16x32_bf16 a[76:79], v[216:219], v[196:199], a[76:79]
    s_waitcnt lgkmcnt(4)
    v_mfma_f32_16x16x32_bf16 a[80:83], v[220:223], v[184:187], a[80:83]
    s_waitcnt vmcnt(21)
    s_waitcnt lgkmcnt(0)
    s_barrier
    v_add_u32 v242, 53248, v241
    v_add_u32 v244, 53248, v243
    v_mfma_f32_16x16x32_bf16 a[84:87], v[220:223], v[188:191], a[84:87]
    ds_read_b64_tr_b16 v[216:217], v242 offset:0
    v_mfma_f32_16x16x32_bf16 a[88:91], v[220:223], v[192:195], a[88:91]
    ds_read_b64_tr_b16 v[218:219], v242 offset:4608
    v_mfma_f32_16x16x32_bf16 a[92:95], v[220:223], v[196:199], a[92:95]
    s_add_u32 m0, s76, 0
    s_mov_b32 s80, 3538944
    v_mfma_f32_16x16x32_bf16 a[96:99], v[224:227], v[184:187], a[96:99]
    buffer_load_dwordx4 v232, s[60:63], s80 offen offset:0 nt lds
    v_mfma_f32_16x16x32_bf16 a[100:103], v[224:227], v[188:191], a[100:103]
    ds_read_b64_tr_b16 v[220:221], v242 offset:18432
    v_mfma_f32_16x16x32_bf16 a[104:107], v[224:227], v[192:195], a[104:107]
    ds_read_b64_tr_b16 v[222:223], v242 offset:23040
    v_mfma_f32_16x16x32_bf16 a[108:111], v[224:227], v[196:199], a[108:111]
    v_mfma_f32_16x16x32_bf16 a[112:115], v[228:231], v[184:187], a[112:115]
    v_mfma_f32_16x16x32_bf16 a[116:119], v[228:231], v[188:191], a[116:119]
    ds_read_b64_tr_b16 v[224:225], v242 offset:32
    v_mfma_f32_16x16x32_bf16 a[120:123], v[228:231], v[192:195], a[120:123]
    ds_read_b64_tr_b16 v[226:227], v242 offset:4640
    v_mfma_f32_16x16x32_bf16 a[124:127], v[228:231], v[196:199], a[124:127]
    s_waitcnt lgkmcnt(4)
    s_waitcnt vmcnt(16)
    v_mfma_f32_16x16x32_bf16 a[128:131], v[216:219], v[200:203], a[128:131]
    buffer_load_dwordx4 v233, s[60:63], s80 offen offset:1024 nt lds
    v_mfma_f32_16x16x32_bf16 a[132:135], v[216:219], v[204:207], a[132:135]
    ds_read_b64_tr_b16 v[228:229], v242 offset:18464
    v_mfma_f32_16x16x32_bf16 a[136:139], v[216:219], v[208:211], a[136:139]
    ds_read_b64_tr_b16 v[230:231], v242 offset:23072
    v_mfma_f32_16x16x32_bf16 a[140:143], v[216:219], v[212:215], a[140:143]
    s_waitcnt lgkmcnt(4)
    v_mfma_f32_16x16x32_bf16 v[8:11], v[220:223], v[200:203], v[8:11]
    v_mfma_f32_16x16x32_bf16 v[12:15], v[220:223], v[204:207], v[12:15]
    ds_read_b64_tr_b16 v[216:217], v242 offset:64
    v_mfma_f32_16x16x32_bf16 v[16:19], v[220:223], v[208:211], v[16:19]
    ds_read_b64_tr_b16 v[218:219], v242 offset:4672
    v_mfma_f32_16x16x32_bf16 v[20:23], v[220:223], v[212:215], v[20:23]
    s_add_u32 s86, s79, 40960
    s_waitcnt lgkmcnt(4)
    v_mfma_f32_16x16x32_bf16 a[144:147], v[224:227], v[200:203], a[144:147]
    buffer_load_dwordx4 v[184:187], v3, s[16:19], s86 offen offset:0 sc1
    v_mfma_f32_16x16x32_bf16 a[148:151], v[224:227], v[204:207], a[148:151]
    ds_read_b64_tr_b16 v[220:221], v242 offset:18496
    v_mfma_f32_16x16x32_bf16 a[152:155], v[224:227], v[208:211], a[152:155]
    ds_read_b64_tr_b16 v[222:223], v242 offset:23104
    v_mfma_f32_16x16x32_bf16 a[156:159], v[224:227], v[212:215], a[156:159]
    s_waitcnt lgkmcnt(4)
    v_mfma_f32_16x16x32_bf16 v[24:27], v[228:231], v[200:203], v[24:27]
    v_mfma_f32_16x16x32_bf16 v[28:31], v[228:231], v[204:207], v[28:31]
    ds_read_b64_tr_b16 v[224:225], v242 offset:96
    v_mfma_f32_16x16x32_bf16 v[32:35], v[228:231], v[208:211], v[32:35]
    ds_read_b64_tr_b16 v[226:227], v242 offset:4704
    v_mfma_f32_16x16x32_bf16 v[36:39], v[228:231], v[212:215], v[36:39]
    s_add_u32 s86, s79, 40960
    s_waitcnt lgkmcnt(4)
    v_mfma_f32_16x16x32_bf16 a[160:163], v[216:219], v[200:203], a[160:163]
    buffer_load_dwordx4 v[188:191], v3, s[16:19], s86 offen offset:1024 sc1
    v_mfma_f32_16x16x32_bf16 a[164:167], v[216:219], v[204:207], a[164:167]
    ds_read_b64_tr_b16 v[228:229], v242 offset:18528
    v_mfma_f32_16x16x32_bf16 a[168:171], v[216:219], v[208:211], a[168:171]
    ds_read_b64_tr_b16 v[230:231], v242 offset:23136
    v_mfma_f32_16x16x32_bf16 a[172:175], v[216:219], v[212:215], a[172:175]
    s_waitcnt lgkmcnt(4)
    v_mfma_f32_16x16x32_bf16 v[40:43], v[220:223], v[200:203], v[40:43]
    v_mfma_f32_16x16x32_bf16 v[44:47], v[220:223], v[204:207], v[44:47]
    ds_read_b64_tr_b16 v[216:217], v242 offset:128
    v_mfma_f32_16x16x32_bf16 v[48:51], v[220:223], v[208:211], v[48:51]
    ds_read_b64_tr_b16 v[218:219], v242 offset:4736
    v_mfma_f32_16x16x32_bf16 v[52:55], v[220:223], v[212:215], v[52:55]
    s_add_u32 s86, s79, 40960
    s_waitcnt lgkmcnt(4)
    v_mfma_f32_16x16x32_bf16 a[176:179], v[224:227], v[200:203], a[176:179]
    buffer_load_dwordx4 v[192:195], v3, s[16:19], s86 offen offset:2048 sc1
    v_mfma_f32_16x16x32_bf16 a[180:183], v[224:227], v[204:207], a[180:183]
    ds_read_b64_tr_b16 v[220:221], v242 offset:18560
    v_mfma_f32_16x16x32_bf16 a[184:187], v[224:227], v[208:211], a[184:187]
    ds_read_b64_tr_b16 v[222:223], v242 offset:23168
    v_mfma_f32_16x16x32_bf16 a[188:191], v[224:227], v[212:215], a[188:191]
    s_waitcnt lgkmcnt(4)
    v_mfma_f32_16x16x32_bf16 v[56:59], v[228:231], v[200:203], v[56:59]
    v_mfma_f32_16x16x32_bf16 v[60:63], v[228:231], v[204:207], v[60:63]
    ds_read_b64_tr_b16 v[224:225], v242 offset:160
    v_mfma_f32_16x16x32_bf16 v[64:67], v[228:231], v[208:211], v[64:67]
    ds_read_b64_tr_b16 v[226:227], v242 offset:4768
    v_mfma_f32_16x16x32_bf16 v[68:71], v[228:231], v[212:215], v[68:71]
    s_add_u32 s86, s79, 40960
    s_waitcnt lgkmcnt(4)
    v_mfma_f32_16x16x32_bf16 a[192:195], v[216:219], v[200:203], a[192:195]
    buffer_load_dwordx4 v[196:199], v3, s[16:19], s86 offen offset:3072 sc1
    v_mfma_f32_16x16x32_bf16 a[196:199], v[216:219], v[204:207], a[196:199]
    ds_read_b64_tr_b16 v[228:229], v242 offset:18592
    v_mfma_f32_16x16x32_bf16 a[200:203], v[216:219], v[208:211], a[200:203]
    ds_read_b64_tr_b16 v[230:231], v242 offset:23200
    v_mfma_f32_16x16x32_bf16 a[204:207], v[216:219], v[212:215], a[204:207]
    s_waitcnt lgkmcnt(4)
    v_mfma_f32_16x16x32_bf16 v[72:75], v[220:223], v[200:203], v[72:75]
    v_mfma_f32_16x16x32_bf16 v[76:79], v[220:223], v[204:207], v[76:79]
    ds_read_b64_tr_b16 v[216:217], v242 offset:192
    v_mfma_f32_16x16x32_bf16 v[80:83], v[220:223], v[208:211], v[80:83]
    ds_read_b64_tr_b16 v[218:219], v242 offset:4800
    v_mfma_f32_16x16x32_bf16 v[84:87], v[220:223], v[212:215], v[84:87]
    s_waitcnt lgkmcnt(4)
    v_mfma_f32_16x16x32_bf16 a[208:211], v[224:227], v[200:203], a[208:211]
    buffer_load_dwordx4 v234, s[60:63], s80 offen offset:2048 nt lds
    v_mfma_f32_16x16x32_bf16 a[212:215], v[224:227], v[204:207], a[212:215]
    ds_read_b64_tr_b16 v[220:221], v242 offset:18624
    v_mfma_f32_16x16x32_bf16 a[216:219], v[224:227], v[208:211], a[216:219]
    ds_read_b64_tr_b16 v[222:223], v242 offset:23232
    v_mfma_f32_16x16x32_bf16 a[220:223], v[224:227], v[212:215], a[220:223]
    s_waitcnt lgkmcnt(4)
    v_mfma_f32_16x16x32_bf16 v[88:91], v[228:231], v[200:203], v[88:91]
    v_mfma_f32_16x16x32_bf16 v[92:95], v[228:231], v[204:207], v[92:95]
    ds_read_b64_tr_b16 v[224:225], v242 offset:224
    v_mfma_f32_16x16x32_bf16 v[96:99], v[228:231], v[208:211], v[96:99]
    ds_read_b64_tr_b16 v[226:227], v242 offset:4832
    v_mfma_f32_16x16x32_bf16 v[100:103], v[228:231], v[212:215], v[100:103]
    s_waitcnt lgkmcnt(4)
    v_mfma_f32_16x16x32_bf16 a[224:227], v[216:219], v[200:203], a[224:227]
    buffer_load_dwordx4 v235, s[60:63], s80 offen offset:3072 nt lds
    v_mfma_f32_16x16x32_bf16 a[228:231], v[216:219], v[204:207], a[228:231]
    ds_read_b64_tr_b16 v[228:229], v242 offset:18656
    v_mfma_f32_16x16x32_bf16 a[232:235], v[216:219], v[208:211], a[232:235]
    ds_read_b64_tr_b16 v[230:231], v242 offset:23264
    v_mfma_f32_16x16x32_bf16 a[236:239], v[216:219], v[212:215], a[236:239]
    s_waitcnt lgkmcnt(4)
    v_mfma_f32_16x16x32_bf16 v[104:107], v[220:223], v[200:203], v[104:107]
    v_mfma_f32_16x16x32_bf16 v[108:111], v[220:223], v[204:207], v[108:111]
    ds_read_b64_tr_b16 v[216:217], v242 offset:256
    v_mfma_f32_16x16x32_bf16 v[112:115], v[220:223], v[208:211], v[112:115]
    ds_read_b64_tr_b16 v[218:219], v242 offset:4864
    v_mfma_f32_16x16x32_bf16 v[116:119], v[220:223], v[212:215], v[116:119]
    s_add_u32 m0, s76, 18432
    s_waitcnt lgkmcnt(4)
    v_mfma_f32_16x16x32_bf16 a[240:243], v[224:227], v[200:203], a[240:243]
    buffer_load_dwordx4 v232, s[64:67], s80 offen offset:0 nt lds
    v_mfma_f32_16x16x32_bf16 a[244:247], v[224:227], v[204:207], a[244:247]
    ds_read_b64_tr_b16 v[220:221], v242 offset:18688
    v_mfma_f32_16x16x32_bf16 a[248:251], v[224:227], v[208:211], a[248:251]
    ds_read_b64_tr_b16 v[222:223], v242 offset:23296
    v_mfma_f32_16x16x32_bf16 a[252:255], v[224:227], v[212:215], a[252:255]
    s_waitcnt lgkmcnt(4)
    v_mfma_f32_16x16x32_bf16 v[120:123], v[228:231], v[200:203], v[120:123]
    v_xor_b32 v245, 0, v244
    v_mfma_f32_16x16x32_bf16 v[124:127], v[228:231], v[204:207], v[124:127]
    ds_read_b64_tr_b16 v[224:225], v245 offset:0
    v_mfma_f32_16x16x32_bf16 v[128:131], v[228:231], v[208:211], v[128:131]
    ds_read_b64_tr_b16 v[226:227], v245 offset:4096
    v_mfma_f32_16x16x32_bf16 v[132:135], v[228:231], v[212:215], v[132:135]
    s_waitcnt lgkmcnt(4)
    v_mfma_f32_16x16x32_bf16 v[152:155], v[216:219], v[200:203], v[152:155]
    v_xor_b32 v246, 32, v244
    buffer_load_dwordx4 v233, s[64:67], s80 offen offset:1024 nt lds
    v_mfma_f32_16x16x32_bf16 v[156:159], v[216:219], v[204:207], v[156:159]
    ds_read_b64_tr_b16 v[228:229], v246 offset:0
    v_mfma_f32_16x16x32_bf16 v[160:163], v[216:219], v[208:211], v[160:163]
    ds_read_b64_tr_b16 v[230:231], v246 offset:4096
    v_mfma_f32_16x16x32_bf16 v[164:167], v[216:219], v[212:215], v[164:167]
    s_waitcnt lgkmcnt(4)
    v_mfma_f32_16x16x32_bf16 v[136:139], v[220:223], v[200:203], v[136:139]
    v_xor_b32 v245, 64, v244
    v_mfma_f32_16x16x32_bf16 v[140:143], v[220:223], v[204:207], v[140:143]
    ds_read_b64_tr_b16 v[216:217], v245 offset:0
    v_mfma_f32_16x16x32_bf16 v[144:147], v[220:223], v[208:211], v[144:147]
    ds_read_b64_tr_b16 v[218:219], v245 offset:4096
    v_mfma_f32_16x16x32_bf16 v[148:151], v[220:223], v[212:215], v[148:151]
    s_waitcnt lgkmcnt(4)
    v_mfma_f32_16x16x32_bf16 a[0:3], v[224:227], v[200:203], a[0:3]
    v_xor_b32 v246, 96, v244
    buffer_load_dwordx4 v234, s[64:67], s80 offen offset:2048 nt lds
    v_mfma_f32_16x16x32_bf16 a[4:7], v[224:227], v[204:207], a[4:7]
    ds_read_b64_tr_b16 v[220:221], v246 offset:0
    v_mfma_f32_16x16x32_bf16 a[8:11], v[224:227], v[208:211], a[8:11]
    ds_read_b64_tr_b16 v[222:223], v246 offset:4096
    v_mfma_f32_16x16x32_bf16 a[12:15], v[224:227], v[212:215], a[12:15]
    s_waitcnt lgkmcnt(4)
    v_mfma_f32_16x16x32_bf16 a[16:19], v[228:231], v[200:203], a[16:19]
    v_xor_b32 v245, 128, v244
    v_mfma_f32_16x16x32_bf16 a[20:23], v[228:231], v[204:207], a[20:23]
    ds_read_b64_tr_b16 v[224:225], v245 offset:0
    v_mfma_f32_16x16x32_bf16 a[24:27], v[228:231], v[208:211], a[24:27]
    ds_read_b64_tr_b16 v[226:227], v245 offset:4096
    v_mfma_f32_16x16x32_bf16 a[28:31], v[228:231], v[212:215], a[28:31]
    s_waitcnt lgkmcnt(4)
    v_mfma_f32_16x16x32_bf16 a[32:35], v[216:219], v[200:203], a[32:35]
    v_xor_b32 v246, 160, v244
    buffer_load_dwordx4 v235, s[64:67], s80 offen offset:3072 nt lds
    v_mfma_f32_16x16x32_bf16 a[36:39], v[216:219], v[204:207], a[36:39]
    ds_read_b64_tr_b16 v[228:229], v246 offset:0
    v_mfma_f32_16x16x32_bf16 a[40:43], v[216:219], v[208:211], a[40:43]
    ds_read_b64_tr_b16 v[230:231], v246 offset:4096
    v_mfma_f32_16x16x32_bf16 a[44:47], v[216:219], v[212:215], a[44:47]
    s_waitcnt lgkmcnt(4)
    v_mfma_f32_16x16x32_bf16 a[48:51], v[220:223], v[200:203], a[48:51]
    v_xor_b32 v245, 192, v244
    v_mfma_f32_16x16x32_bf16 a[52:55], v[220:223], v[204:207], a[52:55]
    ds_read_b64_tr_b16 v[216:217], v245 offset:0
    v_mfma_f32_16x16x32_bf16 a[56:59], v[220:223], v[208:211], a[56:59]
    ds_read_b64_tr_b16 v[218:219], v245 offset:4096
    v_mfma_f32_16x16x32_bf16 a[60:63], v[220:223], v[212:215], a[60:63]
    s_add_u32 m0, s77, 0
    s_waitcnt lgkmcnt(4)
    v_mfma_f32_16x16x32_bf16 a[64:67], v[224:227], v[200:203], a[64:67]
    v_xor_b32 v246, 224, v244
    buffer_load_dwordx4 v236, s[68:71], s80 offen nt lds
    v_mfma_f32_16x16x32_bf16 a[68:71], v[224:227], v[204:207], a[68:71]
    ds_read_b64_tr_b16 v[220:221], v246 offset:0
    v_mfma_f32_16x16x32_bf16 a[72:75], v[224:227], v[208:211], a[72:75]
    ds_read_b64_tr_b16 v[222:223], v246 offset:4096
    v_mfma_f32_16x16x32_bf16 a[76:79], v[224:227], v[212:215], a[76:79]
    s_waitcnt lgkmcnt(4)
    v_mfma_f32_16x16x32_bf16 a[80:83], v[228:231], v[200:203], a[80:83]
    v_mfma_f32_16x16x32_bf16 a[84:87], v[228:231], v[204:207], a[84:87]
    ds_read_b64_tr_b16 v[224:225], v242 offset:9216
    v_mfma_f32_16x16x32_bf16 a[88:91], v[228:231], v[208:211], a[88:91]
    ds_read_b64_tr_b16 v[226:227], v242 offset:13824
    v_mfma_f32_16x16x32_bf16 a[92:95], v[228:231], v[212:215], a[92:95]
    s_add_u32 m0, s78, 0
    s_mov_b32 s81, 3145728
    s_waitcnt lgkmcnt(4)
    v_mfma_f32_16x16x32_bf16 a[96:99], v[216:219], v[200:203], a[96:99]
    buffer_load_dwordx4 v237, s[72:75], s81 offen offset:0 nt lds
    v_mfma_f32_16x16x32_bf16 a[100:103], v[216:219], v[204:207], a[100:103]
    ds_read_b64_tr_b16 v[228:229], v242 offset:27648
    v_mfma_f32_16x16x32_bf16 a[104:107], v[216:219], v[208:211], a[104:107]
    ds_read_b64_tr_b16 v[230:231], v242 offset:32256
    v_mfma_f32_16x16x32_bf16 a[108:111], v[216:219], v[212:215], a[108:111]
    s_waitcnt lgkmcnt(4)
    v_mfma_f32_16x16x32_bf16 a[112:115], v[220:223], v[200:203], a[112:115]
    v_mfma_f32_16x16x32_bf16 a[116:119], v[220:223], v[204:207], a[116:119]
    ds_read_b64_tr_b16 v[216:217], v242 offset:9248
    v_mfma_f32_16x16x32_bf16 a[120:123], v[220:223], v[208:211], a[120:123]
    ds_read_b64_tr_b16 v[218:219], v242 offset:13856
    v_mfma_f32_16x16x32_bf16 a[124:127], v[220:223], v[212:215], a[124:127]
    s_waitcnt lgkmcnt(4)
    s_waitcnt vmcnt(16)
    v_mfma_f32_16x16x32_bf16 a[128:131], v[224:227], v[168:171], a[128:131]
    buffer_load_dwordx4 v238, s[72:75], s81 offen offset:1024 nt lds
    v_mfma_f32_16x16x32_bf16 a[132:135], v[224:227], v[172:175], a[132:135]
    ds_read_b64_tr_b16 v[220:221], v242 offset:27680
    v_mfma_f32_16x16x32_bf16 a[136:139], v[224:227], v[176:179], a[136:139]
    ds_read_b64_tr_b16 v[222:223], v242 offset:32288
    v_mfma_f32_16x16x32_bf16 a[140:143], v[224:227], v[180:183], a[140:143]
    s_waitcnt lgkmcnt(4)
    v_mfma_f32_16x16x32_bf16 v[8:11], v[228:231], v[168:171], v[8:11]
    v_mfma_f32_16x16x32_bf16 v[12:15], v[228:231], v[172:175], v[12:15]
    ds_read_b64_tr_b16 v[224:225], v242 offset:9280
    v_mfma_f32_16x16x32_bf16 v[16:19], v[228:231], v[176:179], v[16:19]
    ds_read_b64_tr_b16 v[226:227], v242 offset:13888
    v_mfma_f32_16x16x32_bf16 v[20:23], v[228:231], v[180:183], v[20:23]
    s_add_u32 s86, s79, 45056
    s_waitcnt lgkmcnt(4)
    v_mfma_f32_16x16x32_bf16 a[144:147], v[216:219], v[168:171], a[144:147]
    buffer_load_dwordx4 v[200:203], v3, s[16:19], s86 offen offset:0 sc1
    v_mfma_f32_16x16x32_bf16 a[148:151], v[216:219], v[172:175], a[148:151]
    ds_read_b64_tr_b16 v[228:229], v242 offset:27712
    v_mfma_f32_16x16x32_bf16 a[152:155], v[216:219], v[176:179], a[152:155]
    ds_read_b64_tr_b16 v[230:231], v242 offset:32320
    v_mfma_f32_16x16x32_bf16 a[156:159], v[216:219], v[180:183], a[156:159]
    s_waitcnt lgkmcnt(4)
    v_mfma_f32_16x16x32_bf16 v[24:27], v[220:223], v[168:171], v[24:27]
    v_mfma_f32_16x16x32_bf16 v[28:31], v[220:223], v[172:175], v[28:31]
    ds_read_b64_tr_b16 v[216:217], v242 offset:9312
    v_mfma_f32_16x16x32_bf16 v[32:35], v[220:223], v[176:179], v[32:35]
    ds_read_b64_tr_b16 v[218:219], v242 offset:13920
    v_mfma_f32_16x16x32_bf16 v[36:39], v[220:223], v[180:183], v[36:39]
    s_add_u32 s86, s79, 45056
    s_waitcnt lgkmcnt(4)
    v_mfma_f32_16x16x32_bf16 a[160:163], v[224:227], v[168:171], a[160:163]
    buffer_load_dwordx4 v[204:207], v3, s[16:19], s86 offen offset:1024 sc1
    v_mfma_f32_16x16x32_bf16 a[164:167], v[224:227], v[172:175], a[164:167]
    ds_read_b64_tr_b16 v[220:221], v242 offset:27744
    v_mfma_f32_16x16x32_bf16 a[168:171], v[224:227], v[176:179], a[168:171]
    ds_read_b64_tr_b16 v[222:223], v242 offset:32352
    v_mfma_f32_16x16x32_bf16 a[172:175], v[224:227], v[180:183], a[172:175]
    s_waitcnt lgkmcnt(4)
    v_mfma_f32_16x16x32_bf16 v[40:43], v[228:231], v[168:171], v[40:43]
    v_mfma_f32_16x16x32_bf16 v[44:47], v[228:231], v[172:175], v[44:47]
    ds_read_b64_tr_b16 v[224:225], v242 offset:9344
    v_mfma_f32_16x16x32_bf16 v[48:51], v[228:231], v[176:179], v[48:51]
    ds_read_b64_tr_b16 v[226:227], v242 offset:13952
    v_mfma_f32_16x16x32_bf16 v[52:55], v[228:231], v[180:183], v[52:55]
    s_add_u32 s86, s79, 45056
    s_waitcnt lgkmcnt(4)
    v_mfma_f32_16x16x32_bf16 a[176:179], v[216:219], v[168:171], a[176:179]
    buffer_load_dwordx4 v[208:211], v3, s[16:19], s86 offen offset:2048 sc1
    v_mfma_f32_16x16x32_bf16 a[180:183], v[216:219], v[172:175], a[180:183]
    ds_read_b64_tr_b16 v[228:229], v242 offset:27776
    v_mfma_f32_16x16x32_bf16 a[184:187], v[216:219], v[176:179], a[184:187]
    ds_read_b64_tr_b16 v[230:231], v242 offset:32384
    v_mfma_f32_16x16x32_bf16 a[188:191], v[216:219], v[180:183], a[188:191]
    s_waitcnt lgkmcnt(4)
    v_mfma_f32_16x16x32_bf16 v[56:59], v[220:223], v[168:171], v[56:59]
    v_mfma_f32_16x16x32_bf16 v[60:63], v[220:223], v[172:175], v[60:63]
    ds_read_b64_tr_b16 v[216:217], v242 offset:9376
    v_mfma_f32_16x16x32_bf16 v[64:67], v[220:223], v[176:179], v[64:67]
    ds_read_b64_tr_b16 v[218:219], v242 offset:13984
    v_mfma_f32_16x16x32_bf16 v[68:71], v[220:223], v[180:183], v[68:71]
    s_add_u32 s86, s79, 45056
    s_waitcnt lgkmcnt(4)
    v_mfma_f32_16x16x32_bf16 a[192:195], v[224:227], v[168:171], a[192:195]
    buffer_load_dwordx4 v[212:215], v3, s[16:19], s86 offen offset:3072 sc1
    v_mfma_f32_16x16x32_bf16 a[196:199], v[224:227], v[172:175], a[196:199]
    ds_read_b64_tr_b16 v[220:221], v242 offset:27808
    v_mfma_f32_16x16x32_bf16 a[200:203], v[224:227], v[176:179], a[200:203]
    ds_read_b64_tr_b16 v[222:223], v242 offset:32416
    v_mfma_f32_16x16x32_bf16 a[204:207], v[224:227], v[180:183], a[204:207]
    s_waitcnt lgkmcnt(4)
    v_mfma_f32_16x16x32_bf16 v[72:75], v[228:231], v[168:171], v[72:75]
    v_mfma_f32_16x16x32_bf16 v[76:79], v[228:231], v[172:175], v[76:79]
    ds_read_b64_tr_b16 v[224:225], v242 offset:9408
    v_mfma_f32_16x16x32_bf16 v[80:83], v[228:231], v[176:179], v[80:83]
    ds_read_b64_tr_b16 v[226:227], v242 offset:14016
    v_mfma_f32_16x16x32_bf16 v[84:87], v[228:231], v[180:183], v[84:87]
    s_waitcnt lgkmcnt(4)
    v_mfma_f32_16x16x32_bf16 a[208:211], v[216:219], v[168:171], a[208:211]
    buffer_load_dwordx4 v239, s[72:75], s81 offen offset:2048 nt lds
    v_mfma_f32_16x16x32_bf16 a[212:215], v[216:219], v[172:175], a[212:215]
    ds_read_b64_tr_b16 v[228:229], v242 offset:27840
    v_mfma_f32_16x16x32_bf16 a[216:219], v[216:219], v[176:179], a[216:219]
    ds_read_b64_tr_b16 v[230:231], v242 offset:32448
    v_mfma_f32_16x16x32_bf16 a[220:223], v[216:219], v[180:183], a[220:223]
    s_waitcnt lgkmcnt(4)
    v_mfma_f32_16x16x32_bf16 v[88:91], v[220:223], v[168:171], v[88:91]
    v_mfma_f32_16x16x32_bf16 v[92:95], v[220:223], v[172:175], v[92:95]
    ds_read_b64_tr_b16 v[216:217], v242 offset:9440
    v_mfma_f32_16x16x32_bf16 v[96:99], v[220:223], v[176:179], v[96:99]
    ds_read_b64_tr_b16 v[218:219], v242 offset:14048
    v_mfma_f32_16x16x32_bf16 v[100:103], v[220:223], v[180:183], v[100:103]
    s_waitcnt lgkmcnt(4)
    v_mfma_f32_16x16x32_bf16 a[224:227], v[224:227], v[168:171], a[224:227]
    buffer_load_dwordx4 v240, s[72:75], s81 offen offset:3072 nt lds
    v_mfma_f32_16x16x32_bf16 a[228:231], v[224:227], v[172:175], a[228:231]
    ds_read_b64_tr_b16 v[220:221], v242 offset:27872
    v_mfma_f32_16x16x32_bf16 a[232:235], v[224:227], v[176:179], a[232:235]
    ds_read_b64_tr_b16 v[222:223], v242 offset:32480
    v_mfma_f32_16x16x32_bf16 a[236:239], v[224:227], v[180:183], a[236:239]
    s_waitcnt lgkmcnt(4)
    v_mfma_f32_16x16x32_bf16 v[104:107], v[228:231], v[168:171], v[104:107]
    v_mfma_f32_16x16x32_bf16 v[108:111], v[228:231], v[172:175], v[108:111]
    ds_read_b64_tr_b16 v[224:225], v242 offset:9472
    v_mfma_f32_16x16x32_bf16 v[112:115], v[228:231], v[176:179], v[112:115]
    ds_read_b64_tr_b16 v[226:227], v242 offset:14080
    v_mfma_f32_16x16x32_bf16 v[116:119], v[228:231], v[180:183], v[116:119]
    s_lshl_b32 s25, s14, 1
    s_and_b32 s15, s13, 1
    s_add_u32 s25, s25, s15
    s_mul_i32 s15, s25, 3072
    s_lshl_b32 s3, s12, 10
    s_add_u32 s15, s15, s3
    s_waitcnt lgkmcnt(4)
    v_mfma_f32_16x16x32_bf16 a[240:243], v[216:219], v[168:171], a[240:243]
    buffer_load_dwordx4 v[4:7], v3, s[36:39], s15 offen
    v_mfma_f32_16x16x32_bf16 a[244:247], v[216:219], v[172:175], a[244:247]
    ds_read_b64_tr_b16 v[228:229], v242 offset:27904
    v_mfma_f32_16x16x32_bf16 a[248:251], v[216:219], v[176:179], a[248:251]
    ds_read_b64_tr_b16 v[230:231], v242 offset:32512
    v_mfma_f32_16x16x32_bf16 a[252:255], v[216:219], v[180:183], a[252:255]
    s_waitcnt lgkmcnt(4)
    v_mfma_f32_16x16x32_bf16 v[120:123], v[220:223], v[168:171], v[120:123]
    v_xor_b32 v245, 0, v244
    v_mfma_f32_16x16x32_bf16 v[124:127], v[220:223], v[172:175], v[124:127]
    ds_read_b64_tr_b16 v[216:217], v245 offset:8192
    v_mfma_f32_16x16x32_bf16 v[128:131], v[220:223], v[176:179], v[128:131]
    ds_read_b64_tr_b16 v[218:219], v245 offset:12288
    v_mfma_f32_16x16x32_bf16 v[132:135], v[220:223], v[180:183], v[132:135]
    s_lshl_b32 s25, s25, 11
    s_and_b32 s3, s12, 1
    s_lshl_b32 s3, s3, 10
    s_add_u32 s25, s25, s3
    s_waitcnt lgkmcnt(4)
    v_mfma_f32_16x16x32_bf16 v[152:155], v[224:227], v[168:171], v[152:155]
    v_xor_b32 v246, 32, v244
    buffer_load_dwordx4 v[4:7], v3, s[40:43], s25 offen
    v_mfma_f32_16x16x32_bf16 v[156:159], v[224:227], v[172:175], v[156:159]
    ds_read_b64_tr_b16 v[220:221], v246 offset:8192
    v_mfma_f32_16x16x32_bf16 v[160:163], v[224:227], v[176:179], v[160:163]
    ds_read_b64_tr_b16 v[222:223], v246 offset:12288
    v_mfma_f32_16x16x32_bf16 v[164:167], v[224:227], v[180:183], v[164:167]
    s_waitcnt lgkmcnt(4)
    v_mfma_f32_16x16x32_bf16 v[136:139], v[228:231], v[168:171], v[136:139]
    v_xor_b32 v245, 64, v244
    v_mfma_f32_16x16x32_bf16 v[140:143], v[228:231], v[172:175], v[140:143]
    ds_read_b64_tr_b16 v[224:225], v245 offset:8192
    v_mfma_f32_16x16x32_bf16 v[144:147], v[228:231], v[176:179], v[144:147]
    ds_read_b64_tr_b16 v[226:227], v245 offset:12288
    v_mfma_f32_16x16x32_bf16 v[148:151], v[228:231], v[180:183], v[148:151]
    s_waitcnt lgkmcnt(4)
    v_mfma_f32_16x16x32_bf16 a[0:3], v[216:219], v[168:171], a[0:3]
    v_xor_b32 v246, 96, v244
    v_mfma_f32_16x16x32_bf16 a[4:7], v[216:219], v[172:175], a[4:7]
    ds_read_b64_tr_b16 v[228:229], v246 offset:8192
    v_mfma_f32_16x16x32_bf16 a[8:11], v[216:219], v[176:179], a[8:11]
    ds_read_b64_tr_b16 v[230:231], v246 offset:12288
    v_mfma_f32_16x16x32_bf16 a[12:15], v[216:219], v[180:183], a[12:15]
    s_waitcnt lgkmcnt(4)
    v_mfma_f32_16x16x32_bf16 a[16:19], v[220:223], v[168:171], a[16:19]
    v_xor_b32 v245, 128, v244
    v_mfma_f32_16x16x32_bf16 a[20:23], v[220:223], v[172:175], a[20:23]
    ds_read_b64_tr_b16 v[216:217], v245 offset:8192
    v_mfma_f32_16x16x32_bf16 a[24:27], v[220:223], v[176:179], a[24:27]
    ds_read_b64_tr_b16 v[218:219], v245 offset:12288
    v_mfma_f32_16x16x32_bf16 a[28:31], v[220:223], v[180:183], a[28:31]
    s_waitcnt lgkmcnt(4)
    v_mfma_f32_16x16x32_bf16 a[32:35], v[224:227], v[168:171], a[32:35]
    v_xor_b32 v246, 160, v244
    v_mfma_f32_16x16x32_bf16 a[36:39], v[224:227], v[172:175], a[36:39]
    ds_read_b64_tr_b16 v[220:221], v246 offset:8192
    v_mfma_f32_16x16x32_bf16 a[40:43], v[224:227], v[176:179], a[40:43]
    ds_read_b64_tr_b16 v[222:223], v246 offset:12288
    v_mfma_f32_16x16x32_bf16 a[44:47], v[224:227], v[180:183], a[44:47]
    s_waitcnt lgkmcnt(4)
    v_mfma_f32_16x16x32_bf16 a[48:51], v[228:231], v[168:171], a[48:51]
    v_xor_b32 v245, 192, v244
    v_mfma_f32_16x16x32_bf16 a[52:55], v[228:231], v[172:175], a[52:55]
    ds_read_b64_tr_b16 v[224:225], v245 offset:8192
    v_mfma_f32_16x16x32_bf16 a[56:59], v[228:231], v[176:179], a[56:59]
    ds_read_b64_tr_b16 v[226:227], v245 offset:12288
    v_mfma_f32_16x16x32_bf16 a[60:63], v[228:231], v[180:183], a[60:63]
    s_waitcnt lgkmcnt(4)
    v_mfma_f32_16x16x32_bf16 a[64:67], v[216:219], v[168:171], a[64:67]
    v_xor_b32 v246, 224, v244
    v_mfma_f32_16x16x32_bf16 a[68:71], v[216:219], v[172:175], a[68:71]
    ds_read_b64_tr_b16 v[228:229], v246 offset:8192
    v_mfma_f32_16x16x32_bf16 a[72:75], v[216:219], v[176:179], a[72:75]
    ds_read_b64_tr_b16 v[230:231], v246 offset:12288
    v_mfma_f32_16x16x32_bf16 a[76:79], v[216:219], v[180:183], a[76:79]
    s_waitcnt lgkmcnt(4)
    v_mfma_f32_16x16x32_bf16 a[80:83], v[220:223], v[168:171], a[80:83]
    s_waitcnt vmcnt(23)
    s_waitcnt lgkmcnt(0)
    s_barrier
    v_add_u32 v242, 106496, v241
    v_add_u32 v244, 106496, v243
    v_mfma_f32_16x16x32_bf16 a[84:87], v[220:223], v[172:175], a[84:87]
    ds_read_b64_tr_b16 v[216:217], v242 offset:0
    v_mfma_f32_16x16x32_bf16 a[88:91], v[220:223], v[176:179], a[88:91]
    ds_read_b64_tr_b16 v[218:219], v242 offset:4608
    v_mfma_f32_16x16x32_bf16 a[92:95], v[220:223], v[180:183], a[92:95]
    s_add_u32 m0, s76, 53248
    s_mov_b32 s80, 4128768
    v_mfma_f32_16x16x32_bf16 a[96:99], v[224:227], v[168:171], a[96:99]
    buffer_load_dwordx4 v232, s[60:63], s80 offen offset:0 nt lds
    v_mfma_f32_16x16x32_bf16 a[100:103], v[224:227], v[172:175], a[100:103]
    ds_read_b64_tr_b16 v[220:221], v242 offset:18432
    v_mfma_f32_16x16x32_bf16 a[104:107], v[224:227], v[176:179], a[104:107]
    ds_read_b64_tr_b16 v[222:223], v242 offset:23040
    v_mfma_f32_16x16x32_bf16 a[108:111], v[224:227], v[180:183], a[108:111]
    v_mfma_f32_16x16x32_bf16 a[112:115], v[228:231], v[168:171], a[112:115]
    v_mfma_f32_16x16x32_bf16 a[116:119], v[228:231], v[172:175], a[116:119]
    ds_read_b64_tr_b16 v[224:225], v242 offset:32
    v_mfma_f32_16x16x32_bf16 a[120:123], v[228:231], v[176:179], a[120:123]
    ds_read_b64_tr_b16 v[226:227], v242 offset:4640
    v_mfma_f32_16x16x32_bf16 a[124:127], v[228:231], v[180:183], a[124:127]
    s_waitcnt lgkmcnt(4)
    s_waitcnt vmcnt(18)
    v_mfma_f32_16x16x32_bf16 a[128:131], v[216:219], v[184:187], a[128:131]
    buffer_load_dwordx4 v233, s[60:63], s80 offen offset:1024 nt lds
    v_mfma_f32_16x16x32_bf16 a[132:135], v[216:219], v[188:191], a[132:135]
    ds_read_b64_tr_b16 v[228:229], v242 offset:18464
    v_mfma_f32_16x16x32_bf16 a[136:139], v[216:219], v[192:195], a[136:139]
    ds_read_b64_tr_b16 v[230:231], v242 offset:23072
    v_mfma_f32_16x16x32_bf16 a[140:143], v[216:219], v[196:199], a[140:143]
    s_waitcnt lgkmcnt(4)
    v_mfma_f32_16x16x32_bf16 v[8:11], v[220:223], v[184:187], v[8:11]
    v_mfma_f32_16x16x32_bf16 v[12:15], v[220:223], v[188:191], v[12:15]
    ds_read_b64_tr_b16 v[216:217], v242 offset:64
    v_mfma_f32_16x16x32_bf16 v[16:19], v[220:223], v[192:195], v[16:19]
    ds_read_b64_tr_b16 v[218:219], v242 offset:4672
    v_mfma_f32_16x16x32_bf16 v[20:23], v[220:223], v[196:199], v[20:23]
    s_add_u32 s86, s79, 49152
    s_waitcnt lgkmcnt(4)
    v_mfma_f32_16x16x32_bf16 a[144:147], v[224:227], v[184:187], a[144:147]
    buffer_load_dwordx4 v[168:171], v3, s[16:19], s86 offen offset:0 sc1
    v_mfma_f32_16x16x32_bf16 a[148:151], v[224:227], v[188:191], a[148:151]
    ds_read_b64_tr_b16 v[220:221], v242 offset:18496
    v_mfma_f32_16x16x32_bf16 a[152:155], v[224:227], v[192:195], a[152:155]
    ds_read_b64_tr_b16 v[222:223], v242 offset:23104
    v_mfma_f32_16x16x32_bf16 a[156:159], v[224:227], v[196:199], a[156:159]
    s_waitcnt lgkmcnt(4)
    v_mfma_f32_16x16x32_bf16 v[24:27], v[228:231], v[184:187], v[24:27]
    v_mfma_f32_16x16x32_bf16 v[28:31], v[228:231], v[188:191], v[28:31]
    ds_read_b64_tr_b16 v[224:225], v242 offset:96
    v_mfma_f32_16x16x32_bf16 v[32:35], v[228:231], v[192:195], v[32:35]
    ds_read_b64_tr_b16 v[226:227], v242 offset:4704
    v_mfma_f32_16x16x32_bf16 v[36:39], v[228:231], v[196:199], v[36:39]
    s_add_u32 s86, s79, 49152
    s_waitcnt lgkmcnt(4)
    v_mfma_f32_16x16x32_bf16 a[160:163], v[216:219], v[184:187], a[160:163]
    buffer_load_dwordx4 v[172:175], v3, s[16:19], s86 offen offset:1024 sc1
    v_mfma_f32_16x16x32_bf16 a[164:167], v[216:219], v[188:191], a[164:167]
    ds_read_b64_tr_b16 v[228:229], v242 offset:18528
    v_mfma_f32_16x16x32_bf16 a[168:171], v[216:219], v[192:195], a[168:171]
    ds_read_b64_tr_b16 v[230:231], v242 offset:23136
    v_mfma_f32_16x16x32_bf16 a[172:175], v[216:219], v[196:199], a[172:175]
    s_waitcnt lgkmcnt(4)
    v_mfma_f32_16x16x32_bf16 v[40:43], v[220:223], v[184:187], v[40:43]
    v_mfma_f32_16x16x32_bf16 v[44:47], v[220:223], v[188:191], v[44:47]
    ds_read_b64_tr_b16 v[216:217], v242 offset:128
    v_mfma_f32_16x16x32_bf16 v[48:51], v[220:223], v[192:195], v[48:51]
    ds_read_b64_tr_b16 v[218:219], v242 offset:4736
    v_mfma_f32_16x16x32_bf16 v[52:55], v[220:223], v[196:199], v[52:55]
    s_add_u32 s86, s79, 49152
    s_waitcnt lgkmcnt(4)
    v_mfma_f32_16x16x32_bf16 a[176:179], v[224:227], v[184:187], a[176:179]
    buffer_load_dwordx4 v[176:179], v3, s[16:19], s86 offen offset:2048 sc1
    v_mfma_f32_16x16x32_bf16 a[180:183], v[224:227], v[188:191], a[180:183]
    ds_read_b64_tr_b16 v[220:221], v242 offset:18560
    v_mfma_f32_16x16x32_bf16 a[184:187], v[224:227], v[192:195], a[184:187]
    ds_read_b64_tr_b16 v[222:223], v242 offset:23168
    v_mfma_f32_16x16x32_bf16 a[188:191], v[224:227], v[196:199], a[188:191]
    s_waitcnt lgkmcnt(4)
    v_mfma_f32_16x16x32_bf16 v[56:59], v[228:231], v[184:187], v[56:59]
    v_mfma_f32_16x16x32_bf16 v[60:63], v[228:231], v[188:191], v[60:63]
    ds_read_b64_tr_b16 v[224:225], v242 offset:160
    v_mfma_f32_16x16x32_bf16 v[64:67], v[228:231], v[192:195], v[64:67]
    ds_read_b64_tr_b16 v[226:227], v242 offset:4768
    v_mfma_f32_16x16x32_bf16 v[68:71], v[228:231], v[196:199], v[68:71]
    s_add_u32 s86, s79, 49152
    s_waitcnt lgkmcnt(4)
    v_mfma_f32_16x16x32_bf16 a[192:195], v[216:219], v[184:187], a[192:195]
    buffer_load_dwordx4 v[180:183], v3, s[16:19], s86 offen offset:3072 sc1
    v_mfma_f32_16x16x32_bf16 a[196:199], v[216:219], v[188:191], a[196:199]
    ds_read_b64_tr_b16 v[228:229], v242 offset:18592
    v_mfma_f32_16x16x32_bf16 a[200:203], v[216:219], v[192:195], a[200:203]
    ds_read_b64_tr_b16 v[230:231], v242 offset:23200
    v_mfma_f32_16x16x32_bf16 a[204:207], v[216:219], v[196:199], a[204:207]
    s_waitcnt lgkmcnt(4)
    v_mfma_f32_16x16x32_bf16 v[72:75], v[220:223], v[184:187], v[72:75]
    v_mfma_f32_16x16x32_bf16 v[76:79], v[220:223], v[188:191], v[76:79]
    ds_read_b64_tr_b16 v[216:217], v242 offset:192
    v_mfma_f32_16x16x32_bf16 v[80:83], v[220:223], v[192:195], v[80:83]
    ds_read_b64_tr_b16 v[218:219], v242 offset:4800
    v_mfma_f32_16x16x32_bf16 v[84:87], v[220:223], v[196:199], v[84:87]
    s_waitcnt lgkmcnt(4)
    v_mfma_f32_16x16x32_bf16 a[208:211], v[224:227], v[184:187], a[208:211]
    buffer_load_dwordx4 v234, s[60:63], s80 offen offset:2048 nt lds
    v_mfma_f32_16x16x32_bf16 a[212:215], v[224:227], v[188:191], a[212:215]
    ds_read_b64_tr_b16 v[220:221], v242 offset:18624
    v_mfma_f32_16x16x32_bf16 a[216:219], v[224:227], v[192:195], a[216:219]
    ds_read_b64_tr_b16 v[222:223], v242 offset:23232
    v_mfma_f32_16x16x32_bf16 a[220:223], v[224:227], v[196:199], a[220:223]
    s_waitcnt lgkmcnt(4)
    v_mfma_f32_16x16x32_bf16 v[88:91], v[228:231], v[184:187], v[88:91]
    v_mfma_f32_16x16x32_bf16 v[92:95], v[228:231], v[188:191], v[92:95]
    ds_read_b64_tr_b16 v[224:225], v242 offset:224
    v_mfma_f32_16x16x32_bf16 v[96:99], v[228:231], v[192:195], v[96:99]
    ds_read_b64_tr_b16 v[226:227], v242 offset:4832
    v_mfma_f32_16x16x32_bf16 v[100:103], v[228:231], v[196:199], v[100:103]
    s_waitcnt lgkmcnt(4)
    v_mfma_f32_16x16x32_bf16 a[224:227], v[216:219], v[184:187], a[224:227]
    buffer_load_dwordx4 v235, s[60:63], s80 offen offset:3072 nt lds
    v_mfma_f32_16x16x32_bf16 a[228:231], v[216:219], v[188:191], a[228:231]
    ds_read_b64_tr_b16 v[228:229], v242 offset:18656
    v_mfma_f32_16x16x32_bf16 a[232:235], v[216:219], v[192:195], a[232:235]
    ds_read_b64_tr_b16 v[230:231], v242 offset:23264
    v_mfma_f32_16x16x32_bf16 a[236:239], v[216:219], v[196:199], a[236:239]
    s_waitcnt lgkmcnt(4)
    v_mfma_f32_16x16x32_bf16 v[104:107], v[220:223], v[184:187], v[104:107]
    v_mfma_f32_16x16x32_bf16 v[108:111], v[220:223], v[188:191], v[108:111]
    ds_read_b64_tr_b16 v[216:217], v242 offset:256
    v_mfma_f32_16x16x32_bf16 v[112:115], v[220:223], v[192:195], v[112:115]
    ds_read_b64_tr_b16 v[218:219], v242 offset:4864
    v_mfma_f32_16x16x32_bf16 v[116:119], v[220:223], v[196:199], v[116:119]
    s_add_u32 m0, s76, 71680
    s_waitcnt lgkmcnt(4)
    v_mfma_f32_16x16x32_bf16 a[240:243], v[224:227], v[184:187], a[240:243]
    buffer_load_dwordx4 v232, s[64:67], s80 offen offset:0 nt lds
    v_mfma_f32_16x16x32_bf16 a[244:247], v[224:227], v[188:191], a[244:247]
    ds_read_b64_tr_b16 v[220:221], v242 offset:18688
    v_mfma_f32_16x16x32_bf16 a[248:251], v[224:227], v[192:195], a[248:251]
    ds_read_b64_tr_b16 v[222:223], v242 offset:23296
    v_mfma_f32_16x16x32_bf16 a[252:255], v[224:227], v[196:199], a[252:255]
    s_waitcnt lgkmcnt(4)
    v_mfma_f32_16x16x32_bf16 v[120:123], v[228:231], v[184:187], v[120:123]
    v_xor_b32 v245, 0, v244
    v_mfma_f32_16x16x32_bf16 v[124:127], v[228:231], v[188:191], v[124:127]
    ds_read_b64_tr_b16 v[224:225], v245 offset:0
    v_mfma_f32_16x16x32_bf16 v[128:131], v[228:231], v[192:195], v[128:131]
    ds_read_b64_tr_b16 v[226:227], v245 offset:4096
    v_mfma_f32_16x16x32_bf16 v[132:135], v[228:231], v[196:199], v[132:135]
    s_waitcnt lgkmcnt(4)
    v_mfma_f32_16x16x32_bf16 v[152:155], v[216:219], v[184:187], v[152:155]
    v_xor_b32 v246, 32, v244
    buffer_load_dwordx4 v233, s[64:67], s80 offen offset:1024 nt lds
    v_mfma_f32_16x16x32_bf16 v[156:159], v[216:219], v[188:191], v[156:159]
    ds_read_b64_tr_b16 v[228:229], v246 offset:0
    v_mfma_f32_16x16x32_bf16 v[160:163], v[216:219], v[192:195], v[160:163]
    ds_read_b64_tr_b16 v[230:231], v246 offset:4096
    v_mfma_f32_16x16x32_bf16 v[164:167], v[216:219], v[196:199], v[164:167]
    s_waitcnt lgkmcnt(4)
    v_mfma_f32_16x16x32_bf16 v[136:139], v[220:223], v[184:187], v[136:139]
    v_xor_b32 v245, 64, v244
    v_mfma_f32_16x16x32_bf16 v[140:143], v[220:223], v[188:191], v[140:143]
    ds_read_b64_tr_b16 v[216:217], v245 offset:0
    v_mfma_f32_16x16x32_bf16 v[144:147], v[220:223], v[192:195], v[144:147]
    ds_read_b64_tr_b16 v[218:219], v245 offset:4096
    v_mfma_f32_16x16x32_bf16 v[148:151], v[220:223], v[196:199], v[148:151]
    s_waitcnt lgkmcnt(4)
    v_mfma_f32_16x16x32_bf16 a[0:3], v[224:227], v[184:187], a[0:3]
    v_xor_b32 v246, 96, v244
    buffer_load_dwordx4 v234, s[64:67], s80 offen offset:2048 nt lds
    v_mfma_f32_16x16x32_bf16 a[4:7], v[224:227], v[188:191], a[4:7]
    ds_read_b64_tr_b16 v[220:221], v246 offset:0
    v_mfma_f32_16x16x32_bf16 a[8:11], v[224:227], v[192:195], a[8:11]
    ds_read_b64_tr_b16 v[222:223], v246 offset:4096
    v_mfma_f32_16x16x32_bf16 a[12:15], v[224:227], v[196:199], a[12:15]
    s_waitcnt lgkmcnt(4)
    v_mfma_f32_16x16x32_bf16 a[16:19], v[228:231], v[184:187], a[16:19]
    v_xor_b32 v245, 128, v244
    v_mfma_f32_16x16x32_bf16 a[20:23], v[228:231], v[188:191], a[20:23]
    ds_read_b64_tr_b16 v[224:225], v245 offset:0
    v_mfma_f32_16x16x32_bf16 a[24:27], v[228:231], v[192:195], a[24:27]
    ds_read_b64_tr_b16 v[226:227], v245 offset:4096
    v_mfma_f32_16x16x32_bf16 a[28:31], v[228:231], v[196:199], a[28:31]
    s_waitcnt lgkmcnt(4)
    v_mfma_f32_16x16x32_bf16 a[32:35], v[216:219], v[184:187], a[32:35]
    v_xor_b32 v246, 160, v244
    buffer_load_dwordx4 v235, s[64:67], s80 offen offset:3072 nt lds
    v_mfma_f32_16x16x32_bf16 a[36:39], v[216:219], v[188:191], a[36:39]
    ds_read_b64_tr_b16 v[228:229], v246 offset:0
    v_mfma_f32_16x16x32_bf16 a[40:43], v[216:219], v[192:195], a[40:43]
    ds_read_b64_tr_b16 v[230:231], v246 offset:4096
    v_mfma_f32_16x16x32_bf16 a[44:47], v[216:219], v[196:199], a[44:47]
    s_waitcnt lgkmcnt(4)
    v_mfma_f32_16x16x32_bf16 a[48:51], v[220:223], v[184:187], a[48:51]
    v_xor_b32 v245, 192, v244
    v_mfma_f32_16x16x32_bf16 a[52:55], v[220:223], v[188:191], a[52:55]
    ds_read_b64_tr_b16 v[216:217], v245 offset:0
    v_mfma_f32_16x16x32_bf16 a[56:59], v[220:223], v[192:195], a[56:59]
    ds_read_b64_tr_b16 v[218:219], v245 offset:4096
    v_mfma_f32_16x16x32_bf16 a[60:63], v[220:223], v[196:199], a[60:63]
    s_add_u32 m0, s77, 53248
    s_waitcnt lgkmcnt(4)
    v_mfma_f32_16x16x32_bf16 a[64:67], v[224:227], v[184:187], a[64:67]
    v_xor_b32 v246, 224, v244
    buffer_load_dwordx4 v236, s[68:71], s80 offen nt lds
    v_mfma_f32_16x16x32_bf16 a[68:71], v[224:227], v[188:191], a[68:71]
    ds_read_b64_tr_b16 v[220:221], v246 offset:0
    v_mfma_f32_16x16x32_bf16 a[72:75], v[224:227], v[192:195], a[72:75]
    ds_read_b64_tr_b16 v[222:223], v246 offset:4096
    v_mfma_f32_16x16x32_bf16 a[76:79], v[224:227], v[196:199], a[76:79]
    s_waitcnt lgkmcnt(4)
    v_mfma_f32_16x16x32_bf16 a[80:83], v[228:231], v[184:187], a[80:83]
    v_mfma_f32_16x16x32_bf16 a[84:87], v[228:231], v[188:191], a[84:87]
    ds_read_b64_tr_b16 v[224:225], v242 offset:9216
    v_mfma_f32_16x16x32_bf16 a[88:91], v[228:231], v[192:195], a[88:91]
    ds_read_b64_tr_b16 v[226:227], v242 offset:13824
    v_mfma_f32_16x16x32_bf16 a[92:95], v[228:231], v[196:199], a[92:95]
    s_add_u32 m0, s78, 53248
    s_mov_b32 s81, 3670016
    s_waitcnt lgkmcnt(4)
    v_mfma_f32_16x16x32_bf16 a[96:99], v[216:219], v[184:187], a[96:99]
    buffer_load_dwordx4 v237, s[72:75], s81 offen offset:0 nt lds
    v_mfma_f32_16x16x32_bf16 a[100:103], v[216:219], v[188:191], a[100:103]
    ds_read_b64_tr_b16 v[228:229], v242 offset:27648
    v_mfma_f32_16x16x32_bf16 a[104:107], v[216:219], v[192:195], a[104:107]
    ds_read_b64_tr_b16 v[230:231], v242 offset:32256
    v_mfma_f32_16x16x32_bf16 a[108:111], v[216:219], v[196:199], a[108:111]
    s_waitcnt lgkmcnt(4)
    v_mfma_f32_16x16x32_bf16 a[112:115], v[220:223], v[184:187], a[112:115]
    v_mfma_f32_16x16x32_bf16 a[116:119], v[220:223], v[188:191], a[116:119]
    ds_read_b64_tr_b16 v[216:217], v242 offset:9248
    v_mfma_f32_16x16x32_bf16 a[120:123], v[220:223], v[192:195], a[120:123]
    ds_read_b64_tr_b16 v[218:219], v242 offset:13856
    v_mfma_f32_16x16x32_bf16 a[124:127], v[220:223], v[196:199], a[124:127]
    s_waitcnt lgkmcnt(4)
    s_waitcnt vmcnt(18)
    v_mfma_f32_16x16x32_bf16 a[128:131], v[224:227], v[200:203], a[128:131]
    buffer_load_dwordx4 v238, s[72:75], s81 offen offset:1024 nt lds
    v_mfma_f32_16x16x32_bf16 a[132:135], v[224:227], v[204:207], a[132:135]
    ds_read_b64_tr_b16 v[220:221], v242 offset:27680
    v_mfma_f32_16x16x32_bf16 a[136:139], v[224:227], v[208:211], a[136:139]
    ds_read_b64_tr_b16 v[222:223], v242 offset:32288
    v_mfma_f32_16x16x32_bf16 a[140:143], v[224:227], v[212:215], a[140:143]
    s_waitcnt lgkmcnt(4)
    v_mfma_f32_16x16x32_bf16 v[8:11], v[228:231], v[200:203], v[8:11]
    v_mfma_f32_16x16x32_bf16 v[12:15], v[228:231], v[204:207], v[12:15]
    ds_read_b64_tr_b16 v[224:225], v242 offset:9280
    v_mfma_f32_16x16x32_bf16 v[16:19], v[228:231], v[208:211], v[16:19]
    ds_read_b64_tr_b16 v[226:227], v242 offset:13888
    v_mfma_f32_16x16x32_bf16 v[20:23], v[228:231], v[212:215], v[20:23]
    s_add_u32 s86, s79, 53248
    s_waitcnt lgkmcnt(4)
    v_mfma_f32_16x16x32_bf16 a[144:147], v[216:219], v[200:203], a[144:147]
    buffer_load_dwordx4 v[184:187], v3, s[16:19], s86 offen offset:0 sc1
    v_mfma_f32_16x16x32_bf16 a[148:151], v[216:219], v[204:207], a[148:151]
    ds_read_b64_tr_b16 v[228:229], v242 offset:27712
    v_mfma_f32_16x16x32_bf16 a[152:155], v[216:219], v[208:211], a[152:155]
    ds_read_b64_tr_b16 v[230:231], v242 offset:32320
    v_mfma_f32_16x16x32_bf16 a[156:159], v[216:219], v[212:215], a[156:159]
    s_waitcnt lgkmcnt(4)
    v_mfma_f32_16x16x32_bf16 v[24:27], v[220:223], v[200:203], v[24:27]
    v_mfma_f32_16x16x32_bf16 v[28:31], v[220:223], v[204:207], v[28:31]
    ds_read_b64_tr_b16 v[216:217], v242 offset:9312
    v_mfma_f32_16x16x32_bf16 v[32:35], v[220:223], v[208:211], v[32:35]
    ds_read_b64_tr_b16 v[218:219], v242 offset:13920
    v_mfma_f32_16x16x32_bf16 v[36:39], v[220:223], v[212:215], v[36:39]
    s_add_u32 s86, s79, 53248
    s_waitcnt lgkmcnt(4)
    v_mfma_f32_16x16x32_bf16 a[160:163], v[224:227], v[200:203], a[160:163]
    buffer_load_dwordx4 v[188:191], v3, s[16:19], s86 offen offset:1024 sc1
    v_mfma_f32_16x16x32_bf16 a[164:167], v[224:227], v[204:207], a[164:167]
    ds_read_b64_tr_b16 v[220:221], v242 offset:27744
    v_mfma_f32_16x16x32_bf16 a[168:171], v[224:227], v[208:211], a[168:171]
    ds_read_b64_tr_b16 v[222:223], v242 offset:32352
    v_mfma_f32_16x16x32_bf16 a[172:175], v[224:227], v[212:215], a[172:175]
    s_waitcnt lgkmcnt(4)
    v_mfma_f32_16x16x32_bf16 v[40:43], v[228:231], v[200:203], v[40:43]
    v_mfma_f32_16x16x32_bf16 v[44:47], v[228:231], v[204:207], v[44:47]
    ds_read_b64_tr_b16 v[224:225], v242 offset:9344
    v_mfma_f32_16x16x32_bf16 v[48:51], v[228:231], v[208:211], v[48:51]
    ds_read_b64_tr_b16 v[226:227], v242 offset:13952
    v_mfma_f32_16x16x32_bf16 v[52:55], v[228:231], v[212:215], v[52:55]
    s_add_u32 s86, s79, 53248
    s_waitcnt lgkmcnt(4)
    v_mfma_f32_16x16x32_bf16 a[176:179], v[216:219], v[200:203], a[176:179]
    buffer_load_dwordx4 v[192:195], v3, s[16:19], s86 offen offset:2048 sc1
    v_mfma_f32_16x16x32_bf16 a[180:183], v[216:219], v[204:207], a[180:183]
    ds_read_b64_tr_b16 v[228:229], v242 offset:27776
    v_mfma_f32_16x16x32_bf16 a[184:187], v[216:219], v[208:211], a[184:187]
    ds_read_b64_tr_b16 v[230:231], v242 offset:32384
    v_mfma_f32_16x16x32_bf16 a[188:191], v[216:219], v[212:215], a[188:191]
    s_waitcnt lgkmcnt(4)
    v_mfma_f32_16x16x32_bf16 v[56:59], v[220:223], v[200:203], v[56:59]
    v_mfma_f32_16x16x32_bf16 v[60:63], v[220:223], v[204:207], v[60:63]
    ds_read_b64_tr_b16 v[216:217], v242 offset:9376
    v_mfma_f32_16x16x32_bf16 v[64:67], v[220:223], v[208:211], v[64:67]
    ds_read_b64_tr_b16 v[218:219], v242 offset:13984
    v_mfma_f32_16x16x32_bf16 v[68:71], v[220:223], v[212:215], v[68:71]
    s_add_u32 s86, s79, 53248
    s_waitcnt lgkmcnt(4)
    v_mfma_f32_16x16x32_bf16 a[192:195], v[224:227], v[200:203], a[192:195]
    buffer_load_dwordx4 v[196:199], v3, s[16:19], s86 offen offset:3072 sc1
    v_mfma_f32_16x16x32_bf16 a[196:199], v[224:227], v[204:207], a[196:199]
    ds_read_b64_tr_b16 v[220:221], v242 offset:27808
    v_mfma_f32_16x16x32_bf16 a[200:203], v[224:227], v[208:211], a[200:203]
    ds_read_b64_tr_b16 v[222:223], v242 offset:32416
    v_mfma_f32_16x16x32_bf16 a[204:207], v[224:227], v[212:215], a[204:207]
    s_waitcnt lgkmcnt(4)
    v_mfma_f32_16x16x32_bf16 v[72:75], v[228:231], v[200:203], v[72:75]
    v_mfma_f32_16x16x32_bf16 v[76:79], v[228:231], v[204:207], v[76:79]
    ds_read_b64_tr_b16 v[224:225], v242 offset:9408
    v_mfma_f32_16x16x32_bf16 v[80:83], v[228:231], v[208:211], v[80:83]
    ds_read_b64_tr_b16 v[226:227], v242 offset:14016
    v_mfma_f32_16x16x32_bf16 v[84:87], v[228:231], v[212:215], v[84:87]
    s_waitcnt lgkmcnt(4)
    v_mfma_f32_16x16x32_bf16 a[208:211], v[216:219], v[200:203], a[208:211]
    buffer_load_dwordx4 v239, s[72:75], s81 offen offset:2048 nt lds
    v_mfma_f32_16x16x32_bf16 a[212:215], v[216:219], v[204:207], a[212:215]
    ds_read_b64_tr_b16 v[228:229], v242 offset:27840
    v_mfma_f32_16x16x32_bf16 a[216:219], v[216:219], v[208:211], a[216:219]
    ds_read_b64_tr_b16 v[230:231], v242 offset:32448
    v_mfma_f32_16x16x32_bf16 a[220:223], v[216:219], v[212:215], a[220:223]
    s_waitcnt lgkmcnt(4)
    v_mfma_f32_16x16x32_bf16 v[88:91], v[220:223], v[200:203], v[88:91]
    v_mfma_f32_16x16x32_bf16 v[92:95], v[220:223], v[204:207], v[92:95]
    ds_read_b64_tr_b16 v[216:217], v242 offset:9440
    v_mfma_f32_16x16x32_bf16 v[96:99], v[220:223], v[208:211], v[96:99]
    ds_read_b64_tr_b16 v[218:219], v242 offset:14048
    v_mfma_f32_16x16x32_bf16 v[100:103], v[220:223], v[212:215], v[100:103]
    s_waitcnt lgkmcnt(4)
    v_mfma_f32_16x16x32_bf16 a[224:227], v[224:227], v[200:203], a[224:227]
    buffer_load_dwordx4 v240, s[72:75], s81 offen offset:3072 nt lds
    v_mfma_f32_16x16x32_bf16 a[228:231], v[224:227], v[204:207], a[228:231]
    ds_read_b64_tr_b16 v[220:221], v242 offset:27872
    v_mfma_f32_16x16x32_bf16 a[232:235], v[224:227], v[208:211], a[232:235]
    ds_read_b64_tr_b16 v[222:223], v242 offset:32480
    v_mfma_f32_16x16x32_bf16 a[236:239], v[224:227], v[212:215], a[236:239]
    s_waitcnt lgkmcnt(4)
    v_mfma_f32_16x16x32_bf16 v[104:107], v[228:231], v[200:203], v[104:107]
    v_mfma_f32_16x16x32_bf16 v[108:111], v[228:231], v[204:207], v[108:111]
    ds_read_b64_tr_b16 v[224:225], v242 offset:9472
    v_mfma_f32_16x16x32_bf16 v[112:115], v[228:231], v[208:211], v[112:115]
    ds_read_b64_tr_b16 v[226:227], v242 offset:14080
    v_mfma_f32_16x16x32_bf16 v[116:119], v[228:231], v[212:215], v[116:119]
    s_waitcnt lgkmcnt(4)
    v_mfma_f32_16x16x32_bf16 a[240:243], v[216:219], v[200:203], a[240:243]
    v_mfma_f32_16x16x32_bf16 a[244:247], v[216:219], v[204:207], a[244:247]
    ds_read_b64_tr_b16 v[228:229], v242 offset:27904
    v_mfma_f32_16x16x32_bf16 a[248:251], v[216:219], v[208:211], a[248:251]
    ds_read_b64_tr_b16 v[230:231], v242 offset:32512
    v_mfma_f32_16x16x32_bf16 a[252:255], v[216:219], v[212:215], a[252:255]
    s_waitcnt lgkmcnt(4)
    v_mfma_f32_16x16x32_bf16 v[120:123], v[220:223], v[200:203], v[120:123]
    v_xor_b32 v245, 0, v244
    v_mfma_f32_16x16x32_bf16 v[124:127], v[220:223], v[204:207], v[124:127]
    ds_read_b64_tr_b16 v[216:217], v245 offset:8192
    v_mfma_f32_16x16x32_bf16 v[128:131], v[220:223], v[208:211], v[128:131]
    ds_read_b64_tr_b16 v[218:219], v245 offset:12288
    v_mfma_f32_16x16x32_bf16 v[132:135], v[220:223], v[212:215], v[132:135]
    s_waitcnt lgkmcnt(4)
    v_mfma_f32_16x16x32_bf16 v[152:155], v[224:227], v[200:203], v[152:155]
    v_xor_b32 v246, 32, v244
    v_mfma_f32_16x16x32_bf16 v[156:159], v[224:227], v[204:207], v[156:159]
    ds_read_b64_tr_b16 v[220:221], v246 offset:8192
    v_mfma_f32_16x16x32_bf16 v[160:163], v[224:227], v[208:211], v[160:163]
    ds_read_b64_tr_b16 v[222:223], v246 offset:12288
    v_mfma_f32_16x16x32_bf16 v[164:167], v[224:227], v[212:215], v[164:167]
    s_waitcnt lgkmcnt(4)
    v_mfma_f32_16x16x32_bf16 v[136:139], v[228:231], v[200:203], v[136:139]
    v_xor_b32 v245, 64, v244
    v_mfma_f32_16x16x32_bf16 v[140:143], v[228:231], v[204:207], v[140:143]
    ds_read_b64_tr_b16 v[224:225], v245 offset:8192
    v_mfma_f32_16x16x32_bf16 v[144:147], v[228:231], v[208:211], v[144:147]
    ds_read_b64_tr_b16 v[226:227], v245 offset:12288
    v_mfma_f32_16x16x32_bf16 v[148:151], v[228:231], v[212:215], v[148:151]
    s_waitcnt lgkmcnt(4)
    v_mfma_f32_16x16x32_bf16 a[0:3], v[216:219], v[200:203], a[0:3]
    v_xor_b32 v246, 96, v244
    v_mfma_f32_16x16x32_bf16 a[4:7], v[216:219], v[204:207], a[4:7]
    ds_read_b64_tr_b16 v[228:229], v246 offset:8192
    v_mfma_f32_16x16x32_bf16 a[8:11], v[216:219], v[208:211], a[8:11]
    ds_read_b64_tr_b16 v[230:231], v246 offset:12288
    v_mfma_f32_16x16x32_bf16 a[12:15], v[216:219], v[212:215], a[12:15]
    s_waitcnt lgkmcnt(4)
    v_mfma_f32_16x16x32_bf16 a[16:19], v[220:223], v[200:203], a[16:19]
    v_xor_b32 v245, 128, v244
    v_mfma_f32_16x16x32_bf16 a[20:23], v[220:223], v[204:207], a[20:23]
    ds_read_b64_tr_b16 v[216:217], v245 offset:8192
    v_mfma_f32_16x16x32_bf16 a[24:27], v[220:223], v[208:211], a[24:27]
    ds_read_b64_tr_b16 v[218:219], v245 offset:12288
    v_mfma_f32_16x16x32_bf16 a[28:31], v[220:223], v[212:215], a[28:31]
    s_waitcnt lgkmcnt(4)
    v_mfma_f32_16x16x32_bf16 a[32:35], v[224:227], v[200:203], a[32:35]
    v_xor_b32 v246, 160, v244
    v_mfma_f32_16x16x32_bf16 a[36:39], v[224:227], v[204:207], a[36:39]
    ds_read_b64_tr_b16 v[220:221], v246 offset:8192
    v_mfma_f32_16x16x32_bf16 a[40:43], v[224:227], v[208:211], a[40:43]
    ds_read_b64_tr_b16 v[222:223], v246 offset:12288
    v_mfma_f32_16x16x32_bf16 a[44:47], v[224:227], v[212:215], a[44:47]
    s_waitcnt lgkmcnt(4)
    v_mfma_f32_16x16x32_bf16 a[48:51], v[228:231], v[200:203], a[48:51]
    v_xor_b32 v245, 192, v244
    v_mfma_f32_16x16x32_bf16 a[52:55], v[228:231], v[204:207], a[52:55]
    ds_read_b64_tr_b16 v[224:225], v245 offset:8192
    v_mfma_f32_16x16x32_bf16 a[56:59], v[228:231], v[208:211], a[56:59]
    ds_read_b64_tr_b16 v[226:227], v245 offset:12288
    v_mfma_f32_16x16x32_bf16 a[60:63], v[228:231], v[212:215], a[60:63]
    s_waitcnt lgkmcnt(4)
    v_mfma_f32_16x16x32_bf16 a[64:67], v[216:219], v[200:203], a[64:67]
    v_xor_b32 v246, 224, v244
    v_mfma_f32_16x16x32_bf16 a[68:71], v[216:219], v[204:207], a[68:71]
    ds_read_b64_tr_b16 v[228:229], v246 offset:8192
    v_mfma_f32_16x16x32_bf16 a[72:75], v[216:219], v[208:211], a[72:75]
    ds_read_b64_tr_b16 v[230:231], v246 offset:12288
    v_mfma_f32_16x16x32_bf16 a[76:79], v[216:219], v[212:215], a[76:79]
    s_waitcnt lgkmcnt(4)
    v_mfma_f32_16x16x32_bf16 a[80:83], v[220:223], v[200:203], a[80:83]
    s_waitcnt vmcnt(23)
    s_waitcnt lgkmcnt(0)
    s_barrier
    v_add_u32 v242, 0, v241
    v_add_u32 v244, 0, v243
    v_mfma_f32_16x16x32_bf16 a[84:87], v[220:223], v[204:207], a[84:87]
    ds_read_b64_tr_b16 v[216:217], v242 offset:0
    v_mfma_f32_16x16x32_bf16 a[88:91], v[220:223], v[208:211], a[88:91]
    ds_read_b64_tr_b16 v[218:219], v242 offset:4608
    v_mfma_f32_16x16x32_bf16 a[92:95], v[220:223], v[212:215], a[92:95]
    s_add_u32 m0, s76, 106496
    s_mov_b32 s80, 4718592
    v_mfma_f32_16x16x32_bf16 a[96:99], v[224:227], v[200:203], a[96:99]
    buffer_load_dwordx4 v232, s[60:63], s80 offen offset:0 nt lds
    v_mfma_f32_16x16x32_bf16 a[100:103], v[224:227], v[204:207], a[100:103]
    ds_read_b64_tr_b16 v[220:221], v242 offset:18432
    v_mfma_f32_16x16x32_bf16 a[104:107], v[224:227], v[208:211], a[104:107]
    ds_read_b64_tr_b16 v[222:223], v242 offset:23040
    v_mfma_f32_16x16x32_bf16 a[108:111], v[224:227], v[212:215], a[108:111]
    v_mfma_f32_16x16x32_bf16 a[112:115], v[228:231], v[200:203], a[112:115]
    v_mfma_f32_16x16x32_bf16 a[116:119], v[228:231], v[204:207], a[116:119]
    ds_read_b64_tr_b16 v[224:225], v242 offset:32
    v_mfma_f32_16x16x32_bf16 a[120:123], v[228:231], v[208:211], a[120:123]
    ds_read_b64_tr_b16 v[226:227], v242 offset:4640
    v_mfma_f32_16x16x32_bf16 a[124:127], v[228:231], v[212:215], a[124:127]
    s_waitcnt lgkmcnt(4)
    s_waitcnt vmcnt(16)
    v_mfma_f32_16x16x32_bf16 a[128:131], v[216:219], v[168:171], a[128:131]
    buffer_load_dwordx4 v233, s[60:63], s80 offen offset:1024 nt lds
    v_mfma_f32_16x16x32_bf16 a[132:135], v[216:219], v[172:175], a[132:135]
    ds_read_b64_tr_b16 v[228:229], v242 offset:18464
    v_mfma_f32_16x16x32_bf16 a[136:139], v[216:219], v[176:179], a[136:139]
    ds_read_b64_tr_b16 v[230:231], v242 offset:23072
    v_mfma_f32_16x16x32_bf16 a[140:143], v[216:219], v[180:183], a[140:143]
    s_waitcnt lgkmcnt(4)
    v_mfma_f32_16x16x32_bf16 v[8:11], v[220:223], v[168:171], v[8:11]
    v_mfma_f32_16x16x32_bf16 v[12:15], v[220:223], v[172:175], v[12:15]
    ds_read_b64_tr_b16 v[216:217], v242 offset:64
    v_mfma_f32_16x16x32_bf16 v[16:19], v[220:223], v[176:179], v[16:19]
    ds_read_b64_tr_b16 v[218:219], v242 offset:4672
    v_mfma_f32_16x16x32_bf16 v[20:23], v[220:223], v[180:183], v[20:23]
    s_add_u32 s86, s79, 57344
    s_waitcnt lgkmcnt(4)
    v_mfma_f32_16x16x32_bf16 a[144:147], v[224:227], v[168:171], a[144:147]
    buffer_load_dwordx4 v[200:203], v3, s[16:19], s86 offen offset:0 sc1
    v_mfma_f32_16x16x32_bf16 a[148:151], v[224:227], v[172:175], a[148:151]
    ds_read_b64_tr_b16 v[220:221], v242 offset:18496
    v_mfma_f32_16x16x32_bf16 a[152:155], v[224:227], v[176:179], a[152:155]
    ds_read_b64_tr_b16 v[222:223], v242 offset:23104
    v_mfma_f32_16x16x32_bf16 a[156:159], v[224:227], v[180:183], a[156:159]
    s_waitcnt lgkmcnt(4)
    v_mfma_f32_16x16x32_bf16 v[24:27], v[228:231], v[168:171], v[24:27]
    v_mfma_f32_16x16x32_bf16 v[28:31], v[228:231], v[172:175], v[28:31]
    ds_read_b64_tr_b16 v[224:225], v242 offset:96
    v_mfma_f32_16x16x32_bf16 v[32:35], v[228:231], v[176:179], v[32:35]
    ds_read_b64_tr_b16 v[226:227], v242 offset:4704
    v_mfma_f32_16x16x32_bf16 v[36:39], v[228:231], v[180:183], v[36:39]
    s_add_u32 s86, s79, 57344
    s_waitcnt lgkmcnt(4)
    v_mfma_f32_16x16x32_bf16 a[160:163], v[216:219], v[168:171], a[160:163]
    buffer_load_dwordx4 v[204:207], v3, s[16:19], s86 offen offset:1024 sc1
    v_mfma_f32_16x16x32_bf16 a[164:167], v[216:219], v[172:175], a[164:167]
    ds_read_b64_tr_b16 v[228:229], v242 offset:18528
    v_mfma_f32_16x16x32_bf16 a[168:171], v[216:219], v[176:179], a[168:171]
    ds_read_b64_tr_b16 v[230:231], v242 offset:23136
    v_mfma_f32_16x16x32_bf16 a[172:175], v[216:219], v[180:183], a[172:175]
    s_waitcnt lgkmcnt(4)
    v_mfma_f32_16x16x32_bf16 v[40:43], v[220:223], v[168:171], v[40:43]
    v_mfma_f32_16x16x32_bf16 v[44:47], v[220:223], v[172:175], v[44:47]
    ds_read_b64_tr_b16 v[216:217], v242 offset:128
    v_mfma_f32_16x16x32_bf16 v[48:51], v[220:223], v[176:179], v[48:51]
    ds_read_b64_tr_b16 v[218:219], v242 offset:4736
    v_mfma_f32_16x16x32_bf16 v[52:55], v[220:223], v[180:183], v[52:55]
    s_add_u32 s86, s79, 57344
    s_waitcnt lgkmcnt(4)
    v_mfma_f32_16x16x32_bf16 a[176:179], v[224:227], v[168:171], a[176:179]
    buffer_load_dwordx4 v[208:211], v3, s[16:19], s86 offen offset:2048 sc1
    v_mfma_f32_16x16x32_bf16 a[180:183], v[224:227], v[172:175], a[180:183]
    ds_read_b64_tr_b16 v[220:221], v242 offset:18560
    v_mfma_f32_16x16x32_bf16 a[184:187], v[224:227], v[176:179], a[184:187]
    ds_read_b64_tr_b16 v[222:223], v242 offset:23168
    v_mfma_f32_16x16x32_bf16 a[188:191], v[224:227], v[180:183], a[188:191]
    s_waitcnt lgkmcnt(4)
    v_mfma_f32_16x16x32_bf16 v[56:59], v[228:231], v[168:171], v[56:59]
    v_mfma_f32_16x16x32_bf16 v[60:63], v[228:231], v[172:175], v[60:63]
    ds_read_b64_tr_b16 v[224:225], v242 offset:160
    v_mfma_f32_16x16x32_bf16 v[64:67], v[228:231], v[176:179], v[64:67]
    ds_read_b64_tr_b16 v[226:227], v242 offset:4768
    v_mfma_f32_16x16x32_bf16 v[68:71], v[228:231], v[180:183], v[68:71]
    s_add_u32 s86, s79, 57344
    s_waitcnt lgkmcnt(4)
    v_mfma_f32_16x16x32_bf16 a[192:195], v[216:219], v[168:171], a[192:195]
    buffer_load_dwordx4 v[212:215], v3, s[16:19], s86 offen offset:3072 sc1
    v_mfma_f32_16x16x32_bf16 a[196:199], v[216:219], v[172:175], a[196:199]
    ds_read_b64_tr_b16 v[228:229], v242 offset:18592
    v_mfma_f32_16x16x32_bf16 a[200:203], v[216:219], v[176:179], a[200:203]
    ds_read_b64_tr_b16 v[230:231], v242 offset:23200
    v_mfma_f32_16x16x32_bf16 a[204:207], v[216:219], v[180:183], a[204:207]
    s_waitcnt lgkmcnt(4)
    v_mfma_f32_16x16x32_bf16 v[72:75], v[220:223], v[168:171], v[72:75]
    v_mfma_f32_16x16x32_bf16 v[76:79], v[220:223], v[172:175], v[76:79]
    ds_read_b64_tr_b16 v[216:217], v242 offset:192
    v_mfma_f32_16x16x32_bf16 v[80:83], v[220:223], v[176:179], v[80:83]
    ds_read_b64_tr_b16 v[218:219], v242 offset:4800
    v_mfma_f32_16x16x32_bf16 v[84:87], v[220:223], v[180:183], v[84:87]
    s_waitcnt lgkmcnt(4)
    v_mfma_f32_16x16x32_bf16 a[208:211], v[224:227], v[168:171], a[208:211]
    buffer_load_dwordx4 v234, s[60:63], s80 offen offset:2048 nt lds
    v_mfma_f32_16x16x32_bf16 a[212:215], v[224:227], v[172:175], a[212:215]
    ds_read_b64_tr_b16 v[220:221], v242 offset:18624
    v_mfma_f32_16x16x32_bf16 a[216:219], v[224:227], v[176:179], a[216:219]
    ds_read_b64_tr_b16 v[222:223], v242 offset:23232
    v_mfma_f32_16x16x32_bf16 a[220:223], v[224:227], v[180:183], a[220:223]
    s_waitcnt lgkmcnt(4)
    v_mfma_f32_16x16x32_bf16 v[88:91], v[228:231], v[168:171], v[88:91]
    v_mfma_f32_16x16x32_bf16 v[92:95], v[228:231], v[172:175], v[92:95]
    ds_read_b64_tr_b16 v[224:225], v242 offset:224
    v_mfma_f32_16x16x32_bf16 v[96:99], v[228:231], v[176:179], v[96:99]
    ds_read_b64_tr_b16 v[226:227], v242 offset:4832
    v_mfma_f32_16x16x32_bf16 v[100:103], v[228:231], v[180:183], v[100:103]
    s_waitcnt lgkmcnt(4)
    v_mfma_f32_16x16x32_bf16 a[224:227], v[216:219], v[168:171], a[224:227]
    buffer_load_dwordx4 v235, s[60:63], s80 offen offset:3072 nt lds
    v_mfma_f32_16x16x32_bf16 a[228:231], v[216:219], v[172:175], a[228:231]
    ds_read_b64_tr_b16 v[228:229], v242 offset:18656
    v_mfma_f32_16x16x32_bf16 a[232:235], v[216:219], v[176:179], a[232:235]
    ds_read_b64_tr_b16 v[230:231], v242 offset:23264
    v_mfma_f32_16x16x32_bf16 a[236:239], v[216:219], v[180:183], a[236:239]
    s_waitcnt lgkmcnt(4)
    v_mfma_f32_16x16x32_bf16 v[104:107], v[220:223], v[168:171], v[104:107]
    v_mfma_f32_16x16x32_bf16 v[108:111], v[220:223], v[172:175], v[108:111]
    ds_read_b64_tr_b16 v[216:217], v242 offset:256
    v_mfma_f32_16x16x32_bf16 v[112:115], v[220:223], v[176:179], v[112:115]
    ds_read_b64_tr_b16 v[218:219], v242 offset:4864
    v_mfma_f32_16x16x32_bf16 v[116:119], v[220:223], v[180:183], v[116:119]
    s_add_u32 m0, s76, 124928
    s_waitcnt lgkmcnt(4)
    v_mfma_f32_16x16x32_bf16 a[240:243], v[224:227], v[168:171], a[240:243]
    buffer_load_dwordx4 v232, s[64:67], s80 offen offset:0 nt lds
    v_mfma_f32_16x16x32_bf16 a[244:247], v[224:227], v[172:175], a[244:247]
    ds_read_b64_tr_b16 v[220:221], v242 offset:18688
    v_mfma_f32_16x16x32_bf16 a[248:251], v[224:227], v[176:179], a[248:251]
    ds_read_b64_tr_b16 v[222:223], v242 offset:23296
    v_mfma_f32_16x16x32_bf16 a[252:255], v[224:227], v[180:183], a[252:255]
    s_waitcnt lgkmcnt(4)
    v_mfma_f32_16x16x32_bf16 v[120:123], v[228:231], v[168:171], v[120:123]
    v_xor_b32 v245, 0, v244
    v_mfma_f32_16x16x32_bf16 v[124:127], v[228:231], v[172:175], v[124:127]
    ds_read_b64_tr_b16 v[224:225], v245 offset:0
    v_mfma_f32_16x16x32_bf16 v[128:131], v[228:231], v[176:179], v[128:131]
    ds_read_b64_tr_b16 v[226:227], v245 offset:4096
    v_mfma_f32_16x16x32_bf16 v[132:135], v[228:231], v[180:183], v[132:135]
    s_waitcnt lgkmcnt(4)
    v_mfma_f32_16x16x32_bf16 v[152:155], v[216:219], v[168:171], v[152:155]
    v_xor_b32 v246, 32, v244
    buffer_load_dwordx4 v233, s[64:67], s80 offen offset:1024 nt lds
    v_mfma_f32_16x16x32_bf16 v[156:159], v[216:219], v[172:175], v[156:159]
    ds_read_b64_tr_b16 v[228:229], v246 offset:0
    v_mfma_f32_16x16x32_bf16 v[160:163], v[216:219], v[176:179], v[160:163]
    ds_read_b64_tr_b16 v[230:231], v246 offset:4096
    v_mfma_f32_16x16x32_bf16 v[164:167], v[216:219], v[180:183], v[164:167]
    s_waitcnt lgkmcnt(4)
    v_mfma_f32_16x16x32_bf16 v[136:139], v[220:223], v[168:171], v[136:139]
    v_xor_b32 v245, 64, v244
    v_mfma_f32_16x16x32_bf16 v[140:143], v[220:223], v[172:175], v[140:143]
    ds_read_b64_tr_b16 v[216:217], v245 offset:0
    v_mfma_f32_16x16x32_bf16 v[144:147], v[220:223], v[176:179], v[144:147]
    ds_read_b64_tr_b16 v[218:219], v245 offset:4096
    v_mfma_f32_16x16x32_bf16 v[148:151], v[220:223], v[180:183], v[148:151]
    s_waitcnt lgkmcnt(4)
    v_mfma_f32_16x16x32_bf16 a[0:3], v[224:227], v[168:171], a[0:3]
    v_xor_b32 v246, 96, v244
    buffer_load_dwordx4 v234, s[64:67], s80 offen offset:2048 nt lds
    v_mfma_f32_16x16x32_bf16 a[4:7], v[224:227], v[172:175], a[4:7]
    ds_read_b64_tr_b16 v[220:221], v246 offset:0
    v_mfma_f32_16x16x32_bf16 a[8:11], v[224:227], v[176:179], a[8:11]
    ds_read_b64_tr_b16 v[222:223], v246 offset:4096
    v_mfma_f32_16x16x32_bf16 a[12:15], v[224:227], v[180:183], a[12:15]
    s_waitcnt lgkmcnt(4)
    v_mfma_f32_16x16x32_bf16 a[16:19], v[228:231], v[168:171], a[16:19]
    v_xor_b32 v245, 128, v244
    v_mfma_f32_16x16x32_bf16 a[20:23], v[228:231], v[172:175], a[20:23]
    ds_read_b64_tr_b16 v[224:225], v245 offset:0
    v_mfma_f32_16x16x32_bf16 a[24:27], v[228:231], v[176:179], a[24:27]
    ds_read_b64_tr_b16 v[226:227], v245 offset:4096
    v_mfma_f32_16x16x32_bf16 a[28:31], v[228:231], v[180:183], a[28:31]
    s_waitcnt lgkmcnt(4)
    v_mfma_f32_16x16x32_bf16 a[32:35], v[216:219], v[168:171], a[32:35]
    v_xor_b32 v246, 160, v244
    buffer_load_dwordx4 v235, s[64:67], s80 offen offset:3072 nt lds
    v_mfma_f32_16x16x32_bf16 a[36:39], v[216:219], v[172:175], a[36:39]
    ds_read_b64_tr_b16 v[228:229], v246 offset:0
    v_mfma_f32_16x16x32_bf16 a[40:43], v[216:219], v[176:179], a[40:43]
    ds_read_b64_tr_b16 v[230:231], v246 offset:4096
    v_mfma_f32_16x16x32_bf16 a[44:47], v[216:219], v[180:183], a[44:47]
    s_waitcnt lgkmcnt(4)
    v_mfma_f32_16x16x32_bf16 a[48:51], v[220:223], v[168:171], a[48:51]
    v_xor_b32 v245, 192, v244
    v_mfma_f32_16x16x32_bf16 a[52:55], v[220:223], v[172:175], a[52:55]
    ds_read_b64_tr_b16 v[216:217], v245 offset:0
    v_mfma_f32_16x16x32_bf16 a[56:59], v[220:223], v[176:179], a[56:59]
    ds_read_b64_tr_b16 v[218:219], v245 offset:4096
    v_mfma_f32_16x16x32_bf16 a[60:63], v[220:223], v[180:183], a[60:63]
    s_add_u32 m0, s77, 106496
    s_waitcnt lgkmcnt(4)
    v_mfma_f32_16x16x32_bf16 a[64:67], v[224:227], v[168:171], a[64:67]
    v_xor_b32 v246, 224, v244
    buffer_load_dwordx4 v236, s[68:71], s80 offen nt lds
    v_mfma_f32_16x16x32_bf16 a[68:71], v[224:227], v[172:175], a[68:71]
    ds_read_b64_tr_b16 v[220:221], v246 offset:0
    v_mfma_f32_16x16x32_bf16 a[72:75], v[224:227], v[176:179], a[72:75]
    ds_read_b64_tr_b16 v[222:223], v246 offset:4096
    v_mfma_f32_16x16x32_bf16 a[76:79], v[224:227], v[180:183], a[76:79]
    s_waitcnt lgkmcnt(4)
    v_mfma_f32_16x16x32_bf16 a[80:83], v[228:231], v[168:171], a[80:83]
    v_mfma_f32_16x16x32_bf16 a[84:87], v[228:231], v[172:175], a[84:87]
    ds_read_b64_tr_b16 v[224:225], v242 offset:9216
    v_mfma_f32_16x16x32_bf16 a[88:91], v[228:231], v[176:179], a[88:91]
    ds_read_b64_tr_b16 v[226:227], v242 offset:13824
    v_mfma_f32_16x16x32_bf16 a[92:95], v[228:231], v[180:183], a[92:95]
    s_add_u32 m0, s78, 106496
    s_mov_b32 s81, 4194304
    s_waitcnt lgkmcnt(4)
    v_mfma_f32_16x16x32_bf16 a[96:99], v[216:219], v[168:171], a[96:99]
    buffer_load_dwordx4 v237, s[72:75], s81 offen offset:0 nt lds
    v_mfma_f32_16x16x32_bf16 a[100:103], v[216:219], v[172:175], a[100:103]
    ds_read_b64_tr_b16 v[228:229], v242 offset:27648
    v_mfma_f32_16x16x32_bf16 a[104:107], v[216:219], v[176:179], a[104:107]
    ds_read_b64_tr_b16 v[230:231], v242 offset:32256
    v_mfma_f32_16x16x32_bf16 a[108:111], v[216:219], v[180:183], a[108:111]
    s_waitcnt lgkmcnt(4)
    v_mfma_f32_16x16x32_bf16 a[112:115], v[220:223], v[168:171], a[112:115]
    v_mfma_f32_16x16x32_bf16 a[116:119], v[220:223], v[172:175], a[116:119]
    ds_read_b64_tr_b16 v[216:217], v242 offset:9248
    v_mfma_f32_16x16x32_bf16 a[120:123], v[220:223], v[176:179], a[120:123]
    ds_read_b64_tr_b16 v[218:219], v242 offset:13856
    v_mfma_f32_16x16x32_bf16 a[124:127], v[220:223], v[180:183], a[124:127]
    s_waitcnt lgkmcnt(4)
    s_waitcnt vmcnt(16)
    v_mfma_f32_16x16x32_bf16 a[128:131], v[224:227], v[184:187], a[128:131]
    buffer_load_dwordx4 v238, s[72:75], s81 offen offset:1024 nt lds
    v_mfma_f32_16x16x32_bf16 a[132:135], v[224:227], v[188:191], a[132:135]
    ds_read_b64_tr_b16 v[220:221], v242 offset:27680
    v_mfma_f32_16x16x32_bf16 a[136:139], v[224:227], v[192:195], a[136:139]
    ds_read_b64_tr_b16 v[222:223], v242 offset:32288
    v_mfma_f32_16x16x32_bf16 a[140:143], v[224:227], v[196:199], a[140:143]
    s_waitcnt lgkmcnt(4)
    v_mfma_f32_16x16x32_bf16 v[8:11], v[228:231], v[184:187], v[8:11]
    v_mfma_f32_16x16x32_bf16 v[12:15], v[228:231], v[188:191], v[12:15]
    ds_read_b64_tr_b16 v[224:225], v242 offset:9280
    v_mfma_f32_16x16x32_bf16 v[16:19], v[228:231], v[192:195], v[16:19]
    ds_read_b64_tr_b16 v[226:227], v242 offset:13888
    v_mfma_f32_16x16x32_bf16 v[20:23], v[228:231], v[196:199], v[20:23]
    s_add_u32 s86, s79, 61440
    s_waitcnt lgkmcnt(4)
    v_mfma_f32_16x16x32_bf16 a[144:147], v[216:219], v[184:187], a[144:147]
    buffer_load_dwordx4 v[168:171], v3, s[16:19], s86 offen offset:0 sc1
    v_mfma_f32_16x16x32_bf16 a[148:151], v[216:219], v[188:191], a[148:151]
    ds_read_b64_tr_b16 v[228:229], v242 offset:27712
    v_mfma_f32_16x16x32_bf16 a[152:155], v[216:219], v[192:195], a[152:155]
    ds_read_b64_tr_b16 v[230:231], v242 offset:32320
    v_mfma_f32_16x16x32_bf16 a[156:159], v[216:219], v[196:199], a[156:159]
    s_waitcnt lgkmcnt(4)
    v_mfma_f32_16x16x32_bf16 v[24:27], v[220:223], v[184:187], v[24:27]
    v_mfma_f32_16x16x32_bf16 v[28:31], v[220:223], v[188:191], v[28:31]
    ds_read_b64_tr_b16 v[216:217], v242 offset:9312
    v_mfma_f32_16x16x32_bf16 v[32:35], v[220:223], v[192:195], v[32:35]
    ds_read_b64_tr_b16 v[218:219], v242 offset:13920
    v_mfma_f32_16x16x32_bf16 v[36:39], v[220:223], v[196:199], v[36:39]
    s_add_u32 s86, s79, 61440
    s_waitcnt lgkmcnt(4)
    v_mfma_f32_16x16x32_bf16 a[160:163], v[224:227], v[184:187], a[160:163]
    buffer_load_dwordx4 v[172:175], v3, s[16:19], s86 offen offset:1024 sc1
    v_mfma_f32_16x16x32_bf16 a[164:167], v[224:227], v[188:191], a[164:167]
    ds_read_b64_tr_b16 v[220:221], v242 offset:27744
    v_mfma_f32_16x16x32_bf16 a[168:171], v[224:227], v[192:195], a[168:171]
    ds_read_b64_tr_b16 v[222:223], v242 offset:32352
    v_mfma_f32_16x16x32_bf16 a[172:175], v[224:227], v[196:199], a[172:175]
    s_waitcnt lgkmcnt(4)
    v_mfma_f32_16x16x32_bf16 v[40:43], v[228:231], v[184:187], v[40:43]
    v_mfma_f32_16x16x32_bf16 v[44:47], v[228:231], v[188:191], v[44:47]
    ds_read_b64_tr_b16 v[224:225], v242 offset:9344
    v_mfma_f32_16x16x32_bf16 v[48:51], v[228:231], v[192:195], v[48:51]
    ds_read_b64_tr_b16 v[226:227], v242 offset:13952
    v_mfma_f32_16x16x32_bf16 v[52:55], v[228:231], v[196:199], v[52:55]
    s_add_u32 s86, s79, 61440
    s_waitcnt lgkmcnt(4)
    v_mfma_f32_16x16x32_bf16 a[176:179], v[216:219], v[184:187], a[176:179]
    buffer_load_dwordx4 v[176:179], v3, s[16:19], s86 offen offset:2048 sc1
    v_mfma_f32_16x16x32_bf16 a[180:183], v[216:219], v[188:191], a[180:183]
    ds_read_b64_tr_b16 v[228:229], v242 offset:27776
    v_mfma_f32_16x16x32_bf16 a[184:187], v[216:219], v[192:195], a[184:187]
    ds_read_b64_tr_b16 v[230:231], v242 offset:32384
    v_mfma_f32_16x16x32_bf16 a[188:191], v[216:219], v[196:199], a[188:191]
    s_waitcnt lgkmcnt(4)
    v_mfma_f32_16x16x32_bf16 v[56:59], v[220:223], v[184:187], v[56:59]
    v_mfma_f32_16x16x32_bf16 v[60:63], v[220:223], v[188:191], v[60:63]
    ds_read_b64_tr_b16 v[216:217], v242 offset:9376
    v_mfma_f32_16x16x32_bf16 v[64:67], v[220:223], v[192:195], v[64:67]
    ds_read_b64_tr_b16 v[218:219], v242 offset:13984
    v_mfma_f32_16x16x32_bf16 v[68:71], v[220:223], v[196:199], v[68:71]
    s_add_u32 s86, s79, 61440
    s_waitcnt lgkmcnt(4)
    v_mfma_f32_16x16x32_bf16 a[192:195], v[224:227], v[184:187], a[192:195]
    buffer_load_dwordx4 v[180:183], v3, s[16:19], s86 offen offset:3072 sc1
    v_mfma_f32_16x16x32_bf16 a[196:199], v[224:227], v[188:191], a[196:199]
    ds_read_b64_tr_b16 v[220:221], v242 offset:27808
    v_mfma_f32_16x16x32_bf16 a[200:203], v[224:227], v[192:195], a[200:203]
    ds_read_b64_tr_b16 v[222:223], v242 offset:32416
    v_mfma_f32_16x16x32_bf16 a[204:207], v[224:227], v[196:199], a[204:207]
    s_waitcnt lgkmcnt(4)
    v_mfma_f32_16x16x32_bf16 v[72:75], v[228:231], v[184:187], v[72:75]
    v_mfma_f32_16x16x32_bf16 v[76:79], v[228:231], v[188:191], v[76:79]
    ds_read_b64_tr_b16 v[224:225], v242 offset:9408
    v_mfma_f32_16x16x32_bf16 v[80:83], v[228:231], v[192:195], v[80:83]
    ds_read_b64_tr_b16 v[226:227], v242 offset:14016
    v_mfma_f32_16x16x32_bf16 v[84:87], v[228:231], v[196:199], v[84:87]
    s_waitcnt lgkmcnt(4)
    v_mfma_f32_16x16x32_bf16 a[208:211], v[216:219], v[184:187], a[208:211]
    buffer_load_dwordx4 v239, s[72:75], s81 offen offset:2048 nt lds
    v_mfma_f32_16x16x32_bf16 a[212:215], v[216:219], v[188:191], a[212:215]
    ds_read_b64_tr_b16 v[228:229], v242 offset:27840
    v_mfma_f32_16x16x32_bf16 a[216:219], v[216:219], v[192:195], a[216:219]
    ds_read_b64_tr_b16 v[230:231], v242 offset:32448
    v_mfma_f32_16x16x32_bf16 a[220:223], v[216:219], v[196:199], a[220:223]
    s_waitcnt lgkmcnt(4)
    v_mfma_f32_16x16x32_bf16 v[88:91], v[220:223], v[184:187], v[88:91]
    v_mfma_f32_16x16x32_bf16 v[92:95], v[220:223], v[188:191], v[92:95]
    ds_read_b64_tr_b16 v[216:217], v242 offset:9440
    v_mfma_f32_16x16x32_bf16 v[96:99], v[220:223], v[192:195], v[96:99]
    ds_read_b64_tr_b16 v[218:219], v242 offset:14048
    v_mfma_f32_16x16x32_bf16 v[100:103], v[220:223], v[196:199], v[100:103]
    s_waitcnt lgkmcnt(4)
    v_mfma_f32_16x16x32_bf16 a[224:227], v[224:227], v[184:187], a[224:227]
    buffer_load_dwordx4 v240, s[72:75], s81 offen offset:3072 nt lds
    v_mfma_f32_16x16x32_bf16 a[228:231], v[224:227], v[188:191], a[228:231]
    ds_read_b64_tr_b16 v[220:221], v242 offset:27872
    v_mfma_f32_16x16x32_bf16 a[232:235], v[224:227], v[192:195], a[232:235]
    ds_read_b64_tr_b16 v[222:223], v242 offset:32480
    v_mfma_f32_16x16x32_bf16 a[236:239], v[224:227], v[196:199], a[236:239]
    s_waitcnt lgkmcnt(4)
    v_mfma_f32_16x16x32_bf16 v[104:107], v[228:231], v[184:187], v[104:107]
    v_mfma_f32_16x16x32_bf16 v[108:111], v[228:231], v[188:191], v[108:111]
    ds_read_b64_tr_b16 v[224:225], v242 offset:9472
    v_mfma_f32_16x16x32_bf16 v[112:115], v[228:231], v[192:195], v[112:115]
    ds_read_b64_tr_b16 v[226:227], v242 offset:14080
    v_mfma_f32_16x16x32_bf16 v[116:119], v[228:231], v[196:199], v[116:119]
    s_waitcnt lgkmcnt(4)
    v_mfma_f32_16x16x32_bf16 a[240:243], v[216:219], v[184:187], a[240:243]
    v_mfma_f32_16x16x32_bf16 a[244:247], v[216:219], v[188:191], a[244:247]
    ds_read_b64_tr_b16 v[228:229], v242 offset:27904
    v_mfma_f32_16x16x32_bf16 a[248:251], v[216:219], v[192:195], a[248:251]
    ds_read_b64_tr_b16 v[230:231], v242 offset:32512
    v_mfma_f32_16x16x32_bf16 a[252:255], v[216:219], v[196:199], a[252:255]
    s_waitcnt lgkmcnt(4)
    v_mfma_f32_16x16x32_bf16 v[120:123], v[220:223], v[184:187], v[120:123]
    v_xor_b32 v245, 0, v244
    v_mfma_f32_16x16x32_bf16 v[124:127], v[220:223], v[188:191], v[124:127]
    ds_read_b64_tr_b16 v[216:217], v245 offset:8192
    v_mfma_f32_16x16x32_bf16 v[128:131], v[220:223], v[192:195], v[128:131]
    ds_read_b64_tr_b16 v[218:219], v245 offset:12288
    v_mfma_f32_16x16x32_bf16 v[132:135], v[220:223], v[196:199], v[132:135]
    s_waitcnt lgkmcnt(4)
    v_mfma_f32_16x16x32_bf16 v[152:155], v[224:227], v[184:187], v[152:155]
    v_xor_b32 v246, 32, v244
    v_mfma_f32_16x16x32_bf16 v[156:159], v[224:227], v[188:191], v[156:159]
    ds_read_b64_tr_b16 v[220:221], v246 offset:8192
    v_mfma_f32_16x16x32_bf16 v[160:163], v[224:227], v[192:195], v[160:163]
    ds_read_b64_tr_b16 v[222:223], v246 offset:12288
    v_mfma_f32_16x16x32_bf16 v[164:167], v[224:227], v[196:199], v[164:167]
    s_waitcnt lgkmcnt(4)
    v_mfma_f32_16x16x32_bf16 v[136:139], v[228:231], v[184:187], v[136:139]
    v_xor_b32 v245, 64, v244
    v_mfma_f32_16x16x32_bf16 v[140:143], v[228:231], v[188:191], v[140:143]
    ds_read_b64_tr_b16 v[224:225], v245 offset:8192
    v_mfma_f32_16x16x32_bf16 v[144:147], v[228:231], v[192:195], v[144:147]
    ds_read_b64_tr_b16 v[226:227], v245 offset:12288
    v_mfma_f32_16x16x32_bf16 v[148:151], v[228:231], v[196:199], v[148:151]
    s_waitcnt lgkmcnt(4)
    v_mfma_f32_16x16x32_bf16 a[0:3], v[216:219], v[184:187], a[0:3]
    v_xor_b32 v246, 96, v244
    v_mfma_f32_16x16x32_bf16 a[4:7], v[216:219], v[188:191], a[4:7]
    ds_read_b64_tr_b16 v[228:229], v246 offset:8192
    v_mfma_f32_16x16x32_bf16 a[8:11], v[216:219], v[192:195], a[8:11]
    ds_read_b64_tr_b16 v[230:231], v246 offset:12288
    v_mfma_f32_16x16x32_bf16 a[12:15], v[216:219], v[196:199], a[12:15]
    s_waitcnt lgkmcnt(4)
    v_mfma_f32_16x16x32_bf16 a[16:19], v[220:223], v[184:187], a[16:19]
    v_xor_b32 v245, 128, v244
    v_mfma_f32_16x16x32_bf16 a[20:23], v[220:223], v[188:191], a[20:23]
    ds_read_b64_tr_b16 v[216:217], v245 offset:8192
    v_mfma_f32_16x16x32_bf16 a[24:27], v[220:223], v[192:195], a[24:27]
    ds_read_b64_tr_b16 v[218:219], v245 offset:12288
    v_mfma_f32_16x16x32_bf16 a[28:31], v[220:223], v[196:199], a[28:31]
    s_waitcnt lgkmcnt(4)
    v_mfma_f32_16x16x32_bf16 a[32:35], v[224:227], v[184:187], a[32:35]
    v_xor_b32 v246, 160, v244
    v_mfma_f32_16x16x32_bf16 a[36:39], v[224:227], v[188:191], a[36:39]
    ds_read_b64_tr_b16 v[220:221], v246 offset:8192
    v_mfma_f32_16x16x32_bf16 a[40:43], v[224:227], v[192:195], a[40:43]
    ds_read_b64_tr_b16 v[222:223], v246 offset:12288
    v_mfma_f32_16x16x32_bf16 a[44:47], v[224:227], v[196:199], a[44:47]
    s_waitcnt lgkmcnt(4)
    v_mfma_f32_16x16x32_bf16 a[48:51], v[228:231], v[184:187], a[48:51]
    v_xor_b32 v245, 192, v244
    v_mfma_f32_16x16x32_bf16 a[52:55], v[228:231], v[188:191], a[52:55]
    ds_read_b64_tr_b16 v[224:225], v245 offset:8192
    v_mfma_f32_16x16x32_bf16 a[56:59], v[228:231], v[192:195], a[56:59]
    ds_read_b64_tr_b16 v[226:227], v245 offset:12288
    v_mfma_f32_16x16x32_bf16 a[60:63], v[228:231], v[196:199], a[60:63]
    s_waitcnt lgkmcnt(4)
    v_mfma_f32_16x16x32_bf16 a[64:67], v[216:219], v[184:187], a[64:67]
    v_xor_b32 v246, 224, v244
    v_mfma_f32_16x16x32_bf16 a[68:71], v[216:219], v[188:191], a[68:71]
    ds_read_b64_tr_b16 v[228:229], v246 offset:8192
    v_mfma_f32_16x16x32_bf16 a[72:75], v[216:219], v[192:195], a[72:75]
    ds_read_b64_tr_b16 v[230:231], v246 offset:12288
    v_mfma_f32_16x16x32_bf16 a[76:79], v[216:219], v[196:199], a[76:79]
    s_waitcnt lgkmcnt(4)
    v_mfma_f32_16x16x32_bf16 a[80:83], v[220:223], v[184:187], a[80:83]
    s_waitcnt vmcnt(21)
    s_waitcnt lgkmcnt(0)
    s_barrier
    v_add_u32 v242, 53248, v241
    v_add_u32 v244, 53248, v243
    v_mfma_f32_16x16x32_bf16 a[84:87], v[220:223], v[188:191], a[84:87]
    ds_read_b64_tr_b16 v[216:217], v242 offset:0
    v_mfma_f32_16x16x32_bf16 a[88:91], v[220:223], v[192:195], a[88:91]
    ds_read_b64_tr_b16 v[218:219], v242 offset:4608
    v_mfma_f32_16x16x32_bf16 a[92:95], v[220:223], v[196:199], a[92:95]
    v_mfma_f32_16x16x32_bf16 a[96:99], v[224:227], v[184:187], a[96:99]
    v_mfma_f32_16x16x32_bf16 a[100:103], v[224:227], v[188:191], a[100:103]
    ds_read_b64_tr_b16 v[220:221], v242 offset:18432
    v_mfma_f32_16x16x32_bf16 a[104:107], v[224:227], v[192:195], a[104:107]
    ds_read_b64_tr_b16 v[222:223], v242 offset:23040
    v_mfma_f32_16x16x32_bf16 a[108:111], v[224:227], v[196:199], a[108:111]
    v_mfma_f32_16x16x32_bf16 a[112:115], v[228:231], v[184:187], a[112:115]
    v_mfma_f32_16x16x32_bf16 a[116:119], v[228:231], v[188:191], a[116:119]
    ds_read_b64_tr_b16 v[224:225], v242 offset:32
    v_mfma_f32_16x16x32_bf16 a[120:123], v[228:231], v[192:195], a[120:123]
    ds_read_b64_tr_b16 v[226:227], v242 offset:4640
    v_mfma_f32_16x16x32_bf16 a[124:127], v[228:231], v[196:199], a[124:127]
    s_waitcnt lgkmcnt(4)
    s_waitcnt vmcnt(15)
    v_mfma_f32_16x16x32_bf16 a[128:131], v[216:219], v[200:203], a[128:131]
    v_mfma_f32_16x16x32_bf16 a[132:135], v[216:219], v[204:207], a[132:135]
    ds_read_b64_tr_b16 v[228:229], v242 offset:18464
    v_mfma_f32_16x16x32_bf16 a[136:139], v[216:219], v[208:211], a[136:139]
    ds_read_b64_tr_b16 v[230:231], v242 offset:23072
    v_mfma_f32_16x16x32_bf16 a[140:143], v[216:219], v[212:215], a[140:143]
    s_waitcnt lgkmcnt(4)
    v_mfma_f32_16x16x32_bf16 v[8:11], v[220:223], v[200:203], v[8:11]
    v_mfma_f32_16x16x32_bf16 v[12:15], v[220:223], v[204:207], v[12:15]
    ds_read_b64_tr_b16 v[216:217], v242 offset:64
    v_mfma_f32_16x16x32_bf16 v[16:19], v[220:223], v[208:211], v[16:19]
    ds_read_b64_tr_b16 v[218:219], v242 offset:4672
    v_mfma_f32_16x16x32_bf16 v[20:23], v[220:223], v[212:215], v[20:23]
    s_add_u32 s86, s79, 65536
    s_waitcnt lgkmcnt(4)
    v_mfma_f32_16x16x32_bf16 a[144:147], v[224:227], v[200:203], a[144:147]
    buffer_load_dwordx4 v[184:187], v3, s[16:19], s86 offen offset:0 sc1
    v_mfma_f32_16x16x32_bf16 a[148:151], v[224:227], v[204:207], a[148:151]
    ds_read_b64_tr_b16 v[220:221], v242 offset:18496
    v_mfma_f32_16x16x32_bf16 a[152:155], v[224:227], v[208:211], a[152:155]
    ds_read_b64_tr_b16 v[222:223], v242 offset:23104
    v_mfma_f32_16x16x32_bf16 a[156:159], v[224:227], v[212:215], a[156:159]
    s_waitcnt lgkmcnt(4)
    v_mfma_f32_16x16x32_bf16 v[24:27], v[228:231], v[200:203], v[24:27]
    v_mfma_f32_16x16x32_bf16 v[28:31], v[228:231], v[204:207], v[28:31]
    ds_read_b64_tr_b16 v[224:225], v242 offset:96
    v_mfma_f32_16x16x32_bf16 v[32:35], v[228:231], v[208:211], v[32:35]
    ds_read_b64_tr_b16 v[226:227], v242 offset:4704
    v_mfma_f32_16x16x32_bf16 v[36:39], v[228:231], v[212:215], v[36:39]
    s_add_u32 s86, s79, 65536
    s_waitcnt lgkmcnt(4)
    v_mfma_f32_16x16x32_bf16 a[160:163], v[216:219], v[200:203], a[160:163]
    buffer_load_dwordx4 v[188:191], v3, s[16:19], s86 offen offset:1024 sc1
    v_mfma_f32_16x16x32_bf16 a[164:167], v[216:219], v[204:207], a[164:167]
    ds_read_b64_tr_b16 v[228:229], v242 offset:18528
    v_mfma_f32_16x16x32_bf16 a[168:171], v[216:219], v[208:211], a[168:171]
    ds_read_b64_tr_b16 v[230:231], v242 offset:23136
    v_mfma_f32_16x16x32_bf16 a[172:175], v[216:219], v[212:215], a[172:175]
    s_waitcnt lgkmcnt(4)
    v_mfma_f32_16x16x32_bf16 v[40:43], v[220:223], v[200:203], v[40:43]
    v_mfma_f32_16x16x32_bf16 v[44:47], v[220:223], v[204:207], v[44:47]
    ds_read_b64_tr_b16 v[216:217], v242 offset:128
    v_mfma_f32_16x16x32_bf16 v[48:51], v[220:223], v[208:211], v[48:51]
    ds_read_b64_tr_b16 v[218:219], v242 offset:4736
    v_mfma_f32_16x16x32_bf16 v[52:55], v[220:223], v[212:215], v[52:55]
    s_add_u32 s86, s79, 65536
    s_waitcnt lgkmcnt(4)
    v_mfma_f32_16x16x32_bf16 a[176:179], v[224:227], v[200:203], a[176:179]
    buffer_load_dwordx4 v[192:195], v3, s[16:19], s86 offen offset:2048 sc1
    v_mfma_f32_16x16x32_bf16 a[180:183], v[224:227], v[204:207], a[180:183]
    ds_read_b64_tr_b16 v[220:221], v242 offset:18560
    v_mfma_f32_16x16x32_bf16 a[184:187], v[224:227], v[208:211], a[184:187]
    ds_read_b64_tr_b16 v[222:223], v242 offset:23168
    v_mfma_f32_16x16x32_bf16 a[188:191], v[224:227], v[212:215], a[188:191]
    s_waitcnt lgkmcnt(4)
    v_mfma_f32_16x16x32_bf16 v[56:59], v[228:231], v[200:203], v[56:59]
    v_mfma_f32_16x16x32_bf16 v[60:63], v[228:231], v[204:207], v[60:63]
    ds_read_b64_tr_b16 v[224:225], v242 offset:160
    v_mfma_f32_16x16x32_bf16 v[64:67], v[228:231], v[208:211], v[64:67]
    ds_read_b64_tr_b16 v[226:227], v242 offset:4768
    v_mfma_f32_16x16x32_bf16 v[68:71], v[228:231], v[212:215], v[68:71]
    s_add_u32 s86, s79, 65536
    s_waitcnt lgkmcnt(4)
    v_mfma_f32_16x16x32_bf16 a[192:195], v[216:219], v[200:203], a[192:195]
    buffer_load_dwordx4 v[196:199], v3, s[16:19], s86 offen offset:3072 sc1
    v_mfma_f32_16x16x32_bf16 a[196:199], v[216:219], v[204:207], a[196:199]
    ds_read_b64_tr_b16 v[228:229], v242 offset:18592
    v_mfma_f32_16x16x32_bf16 a[200:203], v[216:219], v[208:211], a[200:203]
    ds_read_b64_tr_b16 v[230:231], v242 offset:23200
    v_mfma_f32_16x16x32_bf16 a[204:207], v[216:219], v[212:215], a[204:207]
    s_waitcnt lgkmcnt(4)
    v_mfma_f32_16x16x32_bf16 v[72:75], v[220:223], v[200:203], v[72:75]
    v_mfma_f32_16x16x32_bf16 v[76:79], v[220:223], v[204:207], v[76:79]
    ds_read_b64_tr_b16 v[216:217], v242 offset:192
    v_mfma_f32_16x16x32_bf16 v[80:83], v[220:223], v[208:211], v[80:83]
    ds_read_b64_tr_b16 v[218:219], v242 offset:4800
    v_mfma_f32_16x16x32_bf16 v[84:87], v[220:223], v[212:215], v[84:87]
    s_waitcnt lgkmcnt(4)
    v_mfma_f32_16x16x32_bf16 a[208:211], v[224:227], v[200:203], a[208:211]
    v_mfma_f32_16x16x32_bf16 a[212:215], v[224:227], v[204:207], a[212:215]
    ds_read_b64_tr_b16 v[220:221], v242 offset:18624
    v_mfma_f32_16x16x32_bf16 a[216:219], v[224:227], v[208:211], a[216:219]
    ds_read_b64_tr_b16 v[222:223], v242 offset:23232
    v_mfma_f32_16x16x32_bf16 a[220:223], v[224:227], v[212:215], a[220:223]
    s_waitcnt lgkmcnt(4)
    v_mfma_f32_16x16x32_bf16 v[88:91], v[228:231], v[200:203], v[88:91]
    v_mfma_f32_16x16x32_bf16 v[92:95], v[228:231], v[204:207], v[92:95]
    ds_read_b64_tr_b16 v[224:225], v242 offset:224
    v_mfma_f32_16x16x32_bf16 v[96:99], v[228:231], v[208:211], v[96:99]
    ds_read_b64_tr_b16 v[226:227], v242 offset:4832
    v_mfma_f32_16x16x32_bf16 v[100:103], v[228:231], v[212:215], v[100:103]
    s_waitcnt lgkmcnt(4)
    v_mfma_f32_16x16x32_bf16 a[224:227], v[216:219], v[200:203], a[224:227]
    v_mfma_f32_16x16x32_bf16 a[228:231], v[216:219], v[204:207], a[228:231]
    ds_read_b64_tr_b16 v[228:229], v242 offset:18656
    v_mfma_f32_16x16x32_bf16 a[232:235], v[216:219], v[208:211], a[232:235]
    ds_read_b64_tr_b16 v[230:231], v242 offset:23264
    v_mfma_f32_16x16x32_bf16 a[236:239], v[216:219], v[212:215], a[236:239]
    s_waitcnt lgkmcnt(4)
    v_mfma_f32_16x16x32_bf16 v[104:107], v[220:223], v[200:203], v[104:107]
    v_mfma_f32_16x16x32_bf16 v[108:111], v[220:223], v[204:207], v[108:111]
    ds_read_b64_tr_b16 v[216:217], v242 offset:256
    v_mfma_f32_16x16x32_bf16 v[112:115], v[220:223], v[208:211], v[112:115]
    ds_read_b64_tr_b16 v[218:219], v242 offset:4864
    v_mfma_f32_16x16x32_bf16 v[116:119], v[220:223], v[212:215], v[116:119]
    s_waitcnt lgkmcnt(4)
    v_mfma_f32_16x16x32_bf16 a[240:243], v[224:227], v[200:203], a[240:243]
    v_mfma_f32_16x16x32_bf16 a[244:247], v[224:227], v[204:207], a[244:247]
    ds_read_b64_tr_b16 v[220:221], v242 offset:18688
    v_mfma_f32_16x16x32_bf16 a[248:251], v[224:227], v[208:211], a[248:251]
    ds_read_b64_tr_b16 v[222:223], v242 offset:23296
    v_mfma_f32_16x16x32_bf16 a[252:255], v[224:227], v[212:215], a[252:255]
    s_waitcnt lgkmcnt(4)
    v_mfma_f32_16x16x32_bf16 v[120:123], v[228:231], v[200:203], v[120:123]
    v_xor_b32 v245, 0, v244
    v_mfma_f32_16x16x32_bf16 v[124:127], v[228:231], v[204:207], v[124:127]
    ds_read_b64_tr_b16 v[224:225], v245 offset:0
    v_mfma_f32_16x16x32_bf16 v[128:131], v[228:231], v[208:211], v[128:131]
    ds_read_b64_tr_b16 v[226:227], v245 offset:4096
    v_mfma_f32_16x16x32_bf16 v[132:135], v[228:231], v[212:215], v[132:135]
    s_waitcnt lgkmcnt(4)
    v_mfma_f32_16x16x32_bf16 v[152:155], v[216:219], v[200:203], v[152:155]
    v_xor_b32 v246, 32, v244
    v_mfma_f32_16x16x32_bf16 v[156:159], v[216:219], v[204:207], v[156:159]
    ds_read_b64_tr_b16 v[228:229], v246 offset:0
    v_mfma_f32_16x16x32_bf16 v[160:163], v[216:219], v[208:211], v[160:163]
    ds_read_b64_tr_b16 v[230:231], v246 offset:4096
    v_mfma_f32_16x16x32_bf16 v[164:167], v[216:219], v[212:215], v[164:167]
    s_waitcnt lgkmcnt(4)
    v_mfma_f32_16x16x32_bf16 v[136:139], v[220:223], v[200:203], v[136:139]
    v_xor_b32 v245, 64, v244
    v_mfma_f32_16x16x32_bf16 v[140:143], v[220:223], v[204:207], v[140:143]
    ds_read_b64_tr_b16 v[216:217], v245 offset:0
    v_mfma_f32_16x16x32_bf16 v[144:147], v[220:223], v[208:211], v[144:147]
    ds_read_b64_tr_b16 v[218:219], v245 offset:4096
    v_mfma_f32_16x16x32_bf16 v[148:151], v[220:223], v[212:215], v[148:151]
    s_waitcnt lgkmcnt(4)
    v_mfma_f32_16x16x32_bf16 a[0:3], v[224:227], v[200:203], a[0:3]
    v_xor_b32 v246, 96, v244
    v_mfma_f32_16x16x32_bf16 a[4:7], v[224:227], v[204:207], a[4:7]
    ds_read_b64_tr_b16 v[220:221], v246 offset:0
    v_mfma_f32_16x16x32_bf16 a[8:11], v[224:227], v[208:211], a[8:11]
    ds_read_b64_tr_b16 v[222:223], v246 offset:4096
    v_mfma_f32_16x16x32_bf16 a[12:15], v[224:227], v[212:215], a[12:15]
    s_waitcnt lgkmcnt(4)
    v_mfma_f32_16x16x32_bf16 a[16:19], v[228:231], v[200:203], a[16:19]
    v_xor_b32 v245, 128, v244
    v_mfma_f32_16x16x32_bf16 a[20:23], v[228:231], v[204:207], a[20:23]
    ds_read_b64_tr_b16 v[224:225], v245 offset:0
    v_mfma_f32_16x16x32_bf16 a[24:27], v[228:231], v[208:211], a[24:27]
    ds_read_b64_tr_b16 v[226:227], v245 offset:4096
    v_mfma_f32_16x16x32_bf16 a[28:31], v[228:231], v[212:215], a[28:31]
    s_waitcnt lgkmcnt(4)
    v_mfma_f32_16x16x32_bf16 a[32:35], v[216:219], v[200:203], a[32:35]
    v_xor_b32 v246, 160, v244
    v_mfma_f32_16x16x32_bf16 a[36:39], v[216:219], v[204:207], a[36:39]
    ds_read_b64_tr_b16 v[228:229], v246 offset:0
    v_mfma_f32_16x16x32_bf16 a[40:43], v[216:219], v[208:211], a[40:43]
    ds_read_b64_tr_b16 v[230:231], v246 offset:4096
    v_mfma_f32_16x16x32_bf16 a[44:47], v[216:219], v[212:215], a[44:47]
    s_waitcnt lgkmcnt(4)
    v_mfma_f32_16x16x32_bf16 a[48:51], v[220:223], v[200:203], a[48:51]
    v_xor_b32 v245, 192, v244
    v_mfma_f32_16x16x32_bf16 a[52:55], v[220:223], v[204:207], a[52:55]
    ds_read_b64_tr_b16 v[216:217], v245 offset:0
    v_mfma_f32_16x16x32_bf16 a[56:59], v[220:223], v[208:211], a[56:59]
    ds_read_b64_tr_b16 v[218:219], v245 offset:4096
    v_mfma_f32_16x16x32_bf16 a[60:63], v[220:223], v[212:215], a[60:63]
    s_waitcnt lgkmcnt(4)
    v_mfma_f32_16x16x32_bf16 a[64:67], v[224:227], v[200:203], a[64:67]
    v_xor_b32 v246, 224, v244
    v_mfma_f32_16x16x32_bf16 a[68:71], v[224:227], v[204:207], a[68:71]
    ds_read_b64_tr_b16 v[220:221], v246 offset:0
    v_mfma_f32_16x16x32_bf16 a[72:75], v[224:227], v[208:211], a[72:75]
    ds_read_b64_tr_b16 v[222:223], v246 offset:4096
    v_mfma_f32_16x16x32_bf16 a[76:79], v[224:227], v[212:215], a[76:79]
    s_waitcnt lgkmcnt(4)
    v_mfma_f32_16x16x32_bf16 a[80:83], v[228:231], v[200:203], a[80:83]
    v_mfma_f32_16x16x32_bf16 a[84:87], v[228:231], v[204:207], a[84:87]
    ds_read_b64_tr_b16 v[224:225], v242 offset:9216
    v_mfma_f32_16x16x32_bf16 a[88:91], v[228:231], v[208:211], a[88:91]
    ds_read_b64_tr_b16 v[226:227], v242 offset:13824
    v_mfma_f32_16x16x32_bf16 a[92:95], v[228:231], v[212:215], a[92:95]
    s_waitcnt lgkmcnt(4)
    v_mfma_f32_16x16x32_bf16 a[96:99], v[216:219], v[200:203], a[96:99]
    v_mfma_f32_16x16x32_bf16 a[100:103], v[216:219], v[204:207], a[100:103]
    ds_read_b64_tr_b16 v[228:229], v242 offset:27648
    v_mfma_f32_16x16x32_bf16 a[104:107], v[216:219], v[208:211], a[104:107]
    ds_read_b64_tr_b16 v[230:231], v242 offset:32256
    v_mfma_f32_16x16x32_bf16 a[108:111], v[216:219], v[212:215], a[108:111]
    s_waitcnt lgkmcnt(4)
    v_mfma_f32_16x16x32_bf16 a[112:115], v[220:223], v[200:203], a[112:115]
    v_mfma_f32_16x16x32_bf16 a[116:119], v[220:223], v[204:207], a[116:119]
    ds_read_b64_tr_b16 v[216:217], v242 offset:9248
    v_mfma_f32_16x16x32_bf16 a[120:123], v[220:223], v[208:211], a[120:123]
    ds_read_b64_tr_b16 v[218:219], v242 offset:13856
    v_mfma_f32_16x16x32_bf16 a[124:127], v[220:223], v[212:215], a[124:127]
    s_waitcnt lgkmcnt(4)
    s_waitcnt vmcnt(6)
    v_mfma_f32_16x16x32_bf16 a[128:131], v[224:227], v[168:171], a[128:131]
    v_mfma_f32_16x16x32_bf16 a[132:135], v[224:227], v[172:175], a[132:135]
    ds_read_b64_tr_b16 v[220:221], v242 offset:27680
    v_mfma_f32_16x16x32_bf16 a[136:139], v[224:227], v[176:179], a[136:139]
    ds_read_b64_tr_b16 v[222:223], v242 offset:32288
    v_mfma_f32_16x16x32_bf16 a[140:143], v[224:227], v[180:183], a[140:143]
    s_waitcnt lgkmcnt(4)
    v_mfma_f32_16x16x32_bf16 v[8:11], v[228:231], v[168:171], v[8:11]
    v_mfma_f32_16x16x32_bf16 v[12:15], v[228:231], v[172:175], v[12:15]
    ds_read_b64_tr_b16 v[224:225], v242 offset:9280
    v_mfma_f32_16x16x32_bf16 v[16:19], v[228:231], v[176:179], v[16:19]
    ds_read_b64_tr_b16 v[226:227], v242 offset:13888
    v_mfma_f32_16x16x32_bf16 v[20:23], v[228:231], v[180:183], v[20:23]
    s_add_u32 s86, s79, 69632
    s_waitcnt lgkmcnt(4)
    v_mfma_f32_16x16x32_bf16 a[144:147], v[216:219], v[168:171], a[144:147]
    buffer_load_dwordx4 v[200:203], v3, s[16:19], s86 offen offset:0 sc1
    v_mfma_f32_16x16x32_bf16 a[148:151], v[216:219], v[172:175], a[148:151]
    ds_read_b64_tr_b16 v[228:229], v242 offset:27712
    v_mfma_f32_16x16x32_bf16 a[152:155], v[216:219], v[176:179], a[152:155]
    ds_read_b64_tr_b16 v[230:231], v242 offset:32320
    v_mfma_f32_16x16x32_bf16 a[156:159], v[216:219], v[180:183], a[156:159]
    s_waitcnt lgkmcnt(4)
    v_mfma_f32_16x16x32_bf16 v[24:27], v[220:223], v[168:171], v[24:27]
    v_mfma_f32_16x16x32_bf16 v[28:31], v[220:223], v[172:175], v[28:31]
    ds_read_b64_tr_b16 v[216:217], v242 offset:9312
    v_mfma_f32_16x16x32_bf16 v[32:35], v[220:223], v[176:179], v[32:35]
    ds_read_b64_tr_b16 v[218:219], v242 offset:13920
    v_mfma_f32_16x16x32_bf16 v[36:39], v[220:223], v[180:183], v[36:39]
    s_add_u32 s86, s79, 69632
    s_waitcnt lgkmcnt(4)
    v_mfma_f32_16x16x32_bf16 a[160:163], v[224:227], v[168:171], a[160:163]
    buffer_load_dwordx4 v[204:207], v3, s[16:19], s86 offen offset:1024 sc1
    v_mfma_f32_16x16x32_bf16 a[164:167], v[224:227], v[172:175], a[164:167]
    ds_read_b64_tr_b16 v[220:221], v242 offset:27744
    v_mfma_f32_16x16x32_bf16 a[168:171], v[224:227], v[176:179], a[168:171]
    ds_read_b64_tr_b16 v[222:223], v242 offset:32352
    v_mfma_f32_16x16x32_bf16 a[172:175], v[224:227], v[180:183], a[172:175]
    s_waitcnt lgkmcnt(4)
    v_mfma_f32_16x16x32_bf16 v[40:43], v[228:231], v[168:171], v[40:43]
    v_mfma_f32_16x16x32_bf16 v[44:47], v[228:231], v[172:175], v[44:47]
    ds_read_b64_tr_b16 v[224:225], v242 offset:9344
    v_mfma_f32_16x16x32_bf16 v[48:51], v[228:231], v[176:179], v[48:51]
    ds_read_b64_tr_b16 v[226:227], v242 offset:13952
    v_mfma_f32_16x16x32_bf16 v[52:55], v[228:231], v[180:183], v[52:55]
    s_add_u32 s86, s79, 69632
    s_waitcnt lgkmcnt(4)
    v_mfma_f32_16x16x32_bf16 a[176:179], v[216:219], v[168:171], a[176:179]
    buffer_load_dwordx4 v[208:211], v3, s[16:19], s86 offen offset:2048 sc1
    v_mfma_f32_16x16x32_bf16 a[180:183], v[216:219], v[172:175], a[180:183]
    ds_read_b64_tr_b16 v[228:229], v242 offset:27776
    v_mfma_f32_16x16x32_bf16 a[184:187], v[216:219], v[176:179], a[184:187]
    ds_read_b64_tr_b16 v[230:231], v242 offset:32384
    v_mfma_f32_16x16x32_bf16 a[188:191], v[216:219], v[180:183], a[188:191]
    s_waitcnt lgkmcnt(4)
    v_mfma_f32_16x16x32_bf16 v[56:59], v[220:223], v[168:171], v[56:59]
    v_mfma_f32_16x16x32_bf16 v[60:63], v[220:223], v[172:175], v[60:63]
    ds_read_b64_tr_b16 v[216:217], v242 offset:9376
    v_mfma_f32_16x16x32_bf16 v[64:67], v[220:223], v[176:179], v[64:67]
    ds_read_b64_tr_b16 v[218:219], v242 offset:13984
    v_mfma_f32_16x16x32_bf16 v[68:71], v[220:223], v[180:183], v[68:71]
    s_add_u32 s86, s79, 69632
    s_waitcnt lgkmcnt(4)
    v_mfma_f32_16x16x32_bf16 a[192:195], v[224:227], v[168:171], a[192:195]
    buffer_load_dwordx4 v[212:215], v3, s[16:19], s86 offen offset:3072 sc1
    v_mfma_f32_16x16x32_bf16 a[196:199], v[224:227], v[172:175], a[196:199]
    ds_read_b64_tr_b16 v[220:221], v242 offset:27808
    v_mfma_f32_16x16x32_bf16 a[200:203], v[224:227], v[176:179], a[200:203]
    ds_read_b64_tr_b16 v[222:223], v242 offset:32416
    v_mfma_f32_16x16x32_bf16 a[204:207], v[224:227], v[180:183], a[204:207]
    s_waitcnt lgkmcnt(4)
    v_mfma_f32_16x16x32_bf16 v[72:75], v[228:231], v[168:171], v[72:75]
    v_mfma_f32_16x16x32_bf16 v[76:79], v[228:231], v[172:175], v[76:79]
    ds_read_b64_tr_b16 v[224:225], v242 offset:9408
    v_mfma_f32_16x16x32_bf16 v[80:83], v[228:231], v[176:179], v[80:83]
    ds_read_b64_tr_b16 v[226:227], v242 offset:14016
    v_mfma_f32_16x16x32_bf16 v[84:87], v[228:231], v[180:183], v[84:87]
    s_waitcnt lgkmcnt(4)
    v_mfma_f32_16x16x32_bf16 a[208:211], v[216:219], v[168:171], a[208:211]
    v_mfma_f32_16x16x32_bf16 a[212:215], v[216:219], v[172:175], a[212:215]
    ds_read_b64_tr_b16 v[228:229], v242 offset:27840
    v_mfma_f32_16x16x32_bf16 a[216:219], v[216:219], v[176:179], a[216:219]
    ds_read_b64_tr_b16 v[230:231], v242 offset:32448
    v_mfma_f32_16x16x32_bf16 a[220:223], v[216:219], v[180:183], a[220:223]
    s_waitcnt lgkmcnt(4)
    v_mfma_f32_16x16x32_bf16 v[88:91], v[220:223], v[168:171], v[88:91]
    v_mfma_f32_16x16x32_bf16 v[92:95], v[220:223], v[172:175], v[92:95]
    ds_read_b64_tr_b16 v[216:217], v242 offset:9440
    v_mfma_f32_16x16x32_bf16 v[96:99], v[220:223], v[176:179], v[96:99]
    ds_read_b64_tr_b16 v[218:219], v242 offset:14048
    v_mfma_f32_16x16x32_bf16 v[100:103], v[220:223], v[180:183], v[100:103]
    s_waitcnt lgkmcnt(4)
    v_mfma_f32_16x16x32_bf16 a[224:227], v[224:227], v[168:171], a[224:227]
    v_mfma_f32_16x16x32_bf16 a[228:231], v[224:227], v[172:175], a[228:231]
    ds_read_b64_tr_b16 v[220:221], v242 offset:27872
    v_mfma_f32_16x16x32_bf16 a[232:235], v[224:227], v[176:179], a[232:235]
    ds_read_b64_tr_b16 v[222:223], v242 offset:32480
    v_mfma_f32_16x16x32_bf16 a[236:239], v[224:227], v[180:183], a[236:239]
    s_waitcnt lgkmcnt(4)
    v_mfma_f32_16x16x32_bf16 v[104:107], v[228:231], v[168:171], v[104:107]
    v_mfma_f32_16x16x32_bf16 v[108:111], v[228:231], v[172:175], v[108:111]
    ds_read_b64_tr_b16 v[224:225], v242 offset:9472
    v_mfma_f32_16x16x32_bf16 v[112:115], v[228:231], v[176:179], v[112:115]
    ds_read_b64_tr_b16 v[226:227], v242 offset:14080
    v_mfma_f32_16x16x32_bf16 v[116:119], v[228:231], v[180:183], v[116:119]
    s_waitcnt lgkmcnt(4)
    v_mfma_f32_16x16x32_bf16 a[240:243], v[216:219], v[168:171], a[240:243]
    v_mfma_f32_16x16x32_bf16 a[244:247], v[216:219], v[172:175], a[244:247]
    ds_read_b64_tr_b16 v[228:229], v242 offset:27904
    v_mfma_f32_16x16x32_bf16 a[248:251], v[216:219], v[176:179], a[248:251]
    ds_read_b64_tr_b16 v[230:231], v242 offset:32512
    v_mfma_f32_16x16x32_bf16 a[252:255], v[216:219], v[180:183], a[252:255]
    s_waitcnt lgkmcnt(4)
    v_mfma_f32_16x16x32_bf16 v[120:123], v[220:223], v[168:171], v[120:123]
    v_xor_b32 v245, 0, v244
    v_mfma_f32_16x16x32_bf16 v[124:127], v[220:223], v[172:175], v[124:127]
    ds_read_b64_tr_b16 v[216:217], v245 offset:8192
    v_mfma_f32_16x16x32_bf16 v[128:131], v[220:223], v[176:179], v[128:131]
    ds_read_b64_tr_b16 v[218:219], v245 offset:12288
    v_mfma_f32_16x16x32_bf16 v[132:135], v[220:223], v[180:183], v[132:135]
    s_waitcnt lgkmcnt(4)
    v_mfma_f32_16x16x32_bf16 v[152:155], v[224:227], v[168:171], v[152:155]
    v_xor_b32 v246, 32, v244
    v_mfma_f32_16x16x32_bf16 v[156:159], v[224:227], v[172:175], v[156:159]
    ds_read_b64_tr_b16 v[220:221], v246 offset:8192
    v_mfma_f32_16x16x32_bf16 v[160:163], v[224:227], v[176:179], v[160:163]
    ds_read_b64_tr_b16 v[222:223], v246 offset:12288
    v_mfma_f32_16x16x32_bf16 v[164:167], v[224:227], v[180:183], v[164:167]
    s_waitcnt lgkmcnt(4)
    v_mfma_f32_16x16x32_bf16 v[136:139], v[228:231], v[168:171], v[136:139]
    v_xor_b32 v245, 64, v244
    v_mfma_f32_16x16x32_bf16 v[140:143], v[228:231], v[172:175], v[140:143]
    ds_read_b64_tr_b16 v[224:225], v245 offset:8192
    v_mfma_f32_16x16x32_bf16 v[144:147], v[228:231], v[176:179], v[144:147]
    ds_read_b64_tr_b16 v[226:227], v245 offset:12288
    v_mfma_f32_16x16x32_bf16 v[148:151], v[228:231], v[180:183], v[148:151]
    s_waitcnt lgkmcnt(4)
    v_mfma_f32_16x16x32_bf16 a[0:3], v[216:219], v[168:171], a[0:3]
    v_xor_b32 v246, 96, v244
    v_mfma_f32_16x16x32_bf16 a[4:7], v[216:219], v[172:175], a[4:7]
    ds_read_b64_tr_b16 v[228:229], v246 offset:8192
    v_mfma_f32_16x16x32_bf16 a[8:11], v[216:219], v[176:179], a[8:11]
    ds_read_b64_tr_b16 v[230:231], v246 offset:12288
    v_mfma_f32_16x16x32_bf16 a[12:15], v[216:219], v[180:183], a[12:15]
    s_waitcnt lgkmcnt(4)
    v_mfma_f32_16x16x32_bf16 a[16:19], v[220:223], v[168:171], a[16:19]
    v_xor_b32 v245, 128, v244
    v_mfma_f32_16x16x32_bf16 a[20:23], v[220:223], v[172:175], a[20:23]
    ds_read_b64_tr_b16 v[216:217], v245 offset:8192
    v_mfma_f32_16x16x32_bf16 a[24:27], v[220:223], v[176:179], a[24:27]
    ds_read_b64_tr_b16 v[218:219], v245 offset:12288
    v_mfma_f32_16x16x32_bf16 a[28:31], v[220:223], v[180:183], a[28:31]
    s_waitcnt lgkmcnt(4)
    v_mfma_f32_16x16x32_bf16 a[32:35], v[224:227], v[168:171], a[32:35]
    v_xor_b32 v246, 160, v244
    v_mfma_f32_16x16x32_bf16 a[36:39], v[224:227], v[172:175], a[36:39]
    ds_read_b64_tr_b16 v[220:221], v246 offset:8192
    v_mfma_f32_16x16x32_bf16 a[40:43], v[224:227], v[176:179], a[40:43]
    ds_read_b64_tr_b16 v[222:223], v246 offset:12288
    v_mfma_f32_16x16x32_bf16 a[44:47], v[224:227], v[180:183], a[44:47]
    s_waitcnt lgkmcnt(4)
    v_mfma_f32_16x16x32_bf16 a[48:51], v[228:231], v[168:171], a[48:51]
    v_xor_b32 v245, 192, v244
    v_mfma_f32_16x16x32_bf16 a[52:55], v[228:231], v[172:175], a[52:55]
    ds_read_b64_tr_b16 v[224:225], v245 offset:8192
    v_mfma_f32_16x16x32_bf16 a[56:59], v[228:231], v[176:179], a[56:59]
    ds_read_b64_tr_b16 v[226:227], v245 offset:12288
    v_mfma_f32_16x16x32_bf16 a[60:63], v[228:231], v[180:183], a[60:63]
    s_waitcnt lgkmcnt(4)
    v_mfma_f32_16x16x32_bf16 a[64:67], v[216:219], v[168:171], a[64:67]
    v_xor_b32 v246, 224, v244
    v_mfma_f32_16x16x32_bf16 a[68:71], v[216:219], v[172:175], a[68:71]
    ds_read_b64_tr_b16 v[228:229], v246 offset:8192
    v_mfma_f32_16x16x32_bf16 a[72:75], v[216:219], v[176:179], a[72:75]
    ds_read_b64_tr_b16 v[230:231], v246 offset:12288
    v_mfma_f32_16x16x32_bf16 a[76:79], v[216:219], v[180:183], a[76:79]
    s_waitcnt lgkmcnt(4)
    v_mfma_f32_16x16x32_bf16 a[80:83], v[220:223], v[168:171], a[80:83]
    s_waitcnt vmcnt(8)
    s_waitcnt lgkmcnt(0)
    s_barrier
    v_add_u32 v242, 106496, v241
    v_add_u32 v244, 106496, v243
    v_mfma_f32_16x16x32_bf16 a[84:87], v[220:223], v[172:175], a[84:87]
    ds_read_b64_tr_b16 v[216:217], v242 offset:0
    v_mfma_f32_16x16x32_bf16 a[88:91], v[220:223], v[176:179], a[88:91]
    ds_read_b64_tr_b16 v[218:219], v242 offset:4608
    v_mfma_f32_16x16x32_bf16 a[92:95], v[220:223], v[180:183], a[92:95]
    s_add_u32 m0, s46, 24576
    s_and_b32 m0, m0, 0xffff
    s_mov_b32 s52, 0
    v_mfma_f32_16x16x32_bf16 a[96:99], v[224:227], v[168:171], a[96:99]
    buffer_load_dwordx4 v247, s[36:39], s52 offen offset:0 nt lds
    v_mfma_f32_16x16x32_bf16 a[100:103], v[224:227], v[172:175], a[100:103]
    ds_read_b64_tr_b16 v[220:221], v242 offset:18432
    v_mfma_f32_16x16x32_bf16 a[104:107], v[224:227], v[176:179], a[104:107]
    ds_read_b64_tr_b16 v[222:223], v242 offset:23040
    v_mfma_f32_16x16x32_bf16 a[108:111], v[224:227], v[180:183], a[108:111]
    v_mfma_f32_16x16x32_bf16 a[112:115], v[228:231], v[168:171], a[112:115]
    v_mfma_f32_16x16x32_bf16 a[116:119], v[228:231], v[172:175], a[116:119]
    ds_read_b64_tr_b16 v[224:225], v242 offset:32
    v_mfma_f32_16x16x32_bf16 a[120:123], v[228:231], v[176:179], a[120:123]
    ds_read_b64_tr_b16 v[226:227], v242 offset:4640
    v_mfma_f32_16x16x32_bf16 a[124:127], v[228:231], v[180:183], a[124:127]
    s_waitcnt lgkmcnt(4)
    s_waitcnt vmcnt(5)
    v_mfma_f32_16x16x32_bf16 a[128:131], v[216:219], v[184:187], a[128:131]
    buffer_load_dwordx4 v248, s[36:39], s52 offen offset:1024 nt lds
    v_mfma_f32_16x16x32_bf16 a[132:135], v[216:219], v[188:191], a[132:135]
    ds_read_b64_tr_b16 v[228:229], v242 offset:18464
    v_mfma_f32_16x16x32_bf16 a[136:139], v[216:219], v[192:195], a[136:139]
    ds_read_b64_tr_b16 v[230:231], v242 offset:23072
    v_mfma_f32_16x16x32_bf16 a[140:143], v[216:219], v[196:199], a[140:143]
    s_waitcnt lgkmcnt(4)
    v_mfma_f32_16x16x32_bf16 v[8:11], v[220:223], v[184:187], v[8:11]
    buffer_load_dwordx4 v249, s[36:39], s52 offen offset:2048 nt lds
    v_mfma_f32_16x16x32_bf16 v[12:15], v[220:223], v[188:191], v[12:15]
    ds_read_b64_tr_b16 v[216:217], v242 offset:64
    v_mfma_f32_16x16x32_bf16 v[16:19], v[220:223], v[192:195], v[16:19]
    ds_read_b64_tr_b16 v[218:219], v242 offset:4672
    v_mfma_f32_16x16x32_bf16 v[20:23], v[220:223], v[196:199], v[20:23]
    s_waitcnt lgkmcnt(4)
    v_mfma_f32_16x16x32_bf16 a[144:147], v[224:227], v[184:187], a[144:147]
    buffer_load_dwordx4 v250, s[36:39], s52 offen offset:3072 nt lds
    v_mfma_f32_16x16x32_bf16 a[148:151], v[224:227], v[188:191], a[148:151]
    ds_read_b64_tr_b16 v[220:221], v242 offset:18496
    v_mfma_f32_16x16x32_bf16 a[152:155], v[224:227], v[192:195], a[152:155]
    ds_read_b64_tr_b16 v[222:223], v242 offset:23104
    v_mfma_f32_16x16x32_bf16 a[156:159], v[224:227], v[196:199], a[156:159]
    s_add_u32 m0, s46, 40960
    s_and_b32 m0, m0, 0xffff
    s_mov_b32 s52, 16384
    s_waitcnt lgkmcnt(4)
    v_mfma_f32_16x16x32_bf16 v[24:27], v[228:231], v[184:187], v[24:27]
    buffer_load_dwordx4 v247, s[36:39], s52 offen offset:0 nt lds
    v_mfma_f32_16x16x32_bf16 v[28:31], v[228:231], v[188:191], v[28:31]
    ds_read_b64_tr_b16 v[224:225], v242 offset:96
    v_mfma_f32_16x16x32_bf16 v[32:35], v[228:231], v[192:195], v[32:35]
    ds_read_b64_tr_b16 v[226:227], v242 offset:4704
    v_mfma_f32_16x16x32_bf16 v[36:39], v[228:231], v[196:199], v[36:39]
    s_waitcnt lgkmcnt(4)
    v_mfma_f32_16x16x32_bf16 a[160:163], v[216:219], v[184:187], a[160:163]
    buffer_load_dwordx4 v248, s[36:39], s52 offen offset:1024 nt lds
    v_mfma_f32_16x16x32_bf16 a[164:167], v[216:219], v[188:191], a[164:167]
    ds_read_b64_tr_b16 v[228:229], v242 offset:18528
    v_mfma_f32_16x16x32_bf16 a[168:171], v[216:219], v[192:195], a[168:171]
    ds_read_b64_tr_b16 v[230:231], v242 offset:23136
    v_mfma_f32_16x16x32_bf16 a[172:175], v[216:219], v[196:199], a[172:175]
    s_waitcnt lgkmcnt(4)
    v_mfma_f32_16x16x32_bf16 v[40:43], v[220:223], v[184:187], v[40:43]
    buffer_load_dwordx4 v249, s[36:39], s52 offen offset:2048 nt lds
    v_mfma_f32_16x16x32_bf16 v[44:47], v[220:223], v[188:191], v[44:47]
    ds_read_b64_tr_b16 v[216:217], v242 offset:128
    v_mfma_f32_16x16x32_bf16 v[48:51], v[220:223], v[192:195], v[48:51]
    ds_read_b64_tr_b16 v[218:219], v242 offset:4736
    v_mfma_f32_16x16x32_bf16 v[52:55], v[220:223], v[196:199], v[52:55]
    s_waitcnt lgkmcnt(4)
    v_mfma_f32_16x16x32_bf16 a[176:179], v[224:227], v[184:187], a[176:179]
    buffer_load_dwordx4 v250, s[36:39], s52 offen offset:3072 nt lds
    v_mfma_f32_16x16x32_bf16 a[180:183], v[224:227], v[188:191], a[180:183]
    ds_read_b64_tr_b16 v[220:221], v242 offset:18560
    v_mfma_f32_16x16x32_bf16 a[184:187], v[224:227], v[192:195], a[184:187]
    ds_read_b64_tr_b16 v[222:223], v242 offset:23168
    v_mfma_f32_16x16x32_bf16 a[188:191], v[224:227], v[196:199], a[188:191]
    s_add_u32 m0, s46, 57344
    s_and_b32 m0, m0, 0xffff
    s_mov_b32 s52, 32768
    s_waitcnt lgkmcnt(4)
    v_mfma_f32_16x16x32_bf16 v[56:59], v[228:231], v[184:187], v[56:59]
    buffer_load_dwordx4 v247, s[36:39], s52 offen offset:0 nt lds
    v_mfma_f32_16x16x32_bf16 v[60:63], v[228:231], v[188:191], v[60:63]
    ds_read_b64_tr_b16 v[224:225], v242 offset:160
    v_mfma_f32_16x16x32_bf16 v[64:67], v[228:231], v[192:195], v[64:67]
    ds_read_b64_tr_b16 v[226:227], v242 offset:4768
    v_mfma_f32_16x16x32_bf16 v[68:71], v[228:231], v[196:199], v[68:71]
    s_waitcnt lgkmcnt(4)
    v_mfma_f32_16x16x32_bf16 a[192:195], v[216:219], v[184:187], a[192:195]
    buffer_load_dwordx4 v248, s[36:39], s52 offen offset:1024 nt lds
    v_mfma_f32_16x16x32_bf16 a[196:199], v[216:219], v[188:191], a[196:199]
    ds_read_b64_tr_b16 v[228:229], v242 offset:18592
    v_mfma_f32_16x16x32_bf16 a[200:203], v[216:219], v[192:195], a[200:203]
    ds_read_b64_tr_b16 v[230:231], v242 offset:23200
    v_mfma_f32_16x16x32_bf16 a[204:207], v[216:219], v[196:199], a[204:207]
    s_waitcnt lgkmcnt(4)
    v_mfma_f32_16x16x32_bf16 v[72:75], v[220:223], v[184:187], v[72:75]
    buffer_load_dwordx4 v249, s[36:39], s52 offen offset:2048 nt lds
    v_mfma_f32_16x16x32_bf16 v[76:79], v[220:223], v[188:191], v[76:79]
    ds_read_b64_tr_b16 v[216:217], v242 offset:192
    v_mfma_f32_16x16x32_bf16 v[80:83], v[220:223], v[192:195], v[80:83]
    ds_read_b64_tr_b16 v[218:219], v242 offset:4800
    v_mfma_f32_16x16x32_bf16 v[84:87], v[220:223], v[196:199], v[84:87]
    s_waitcnt lgkmcnt(4)
    v_mfma_f32_16x16x32_bf16 a[208:211], v[224:227], v[184:187], a[208:211]
    buffer_load_dwordx4 v250, s[36:39], s52 offen offset:3072 nt lds
    v_mfma_f32_16x16x32_bf16 a[212:215], v[224:227], v[188:191], a[212:215]
    ds_read_b64_tr_b16 v[220:221], v242 offset:18624
    v_mfma_f32_16x16x32_bf16 a[216:219], v[224:227], v[192:195], a[216:219]
    ds_read_b64_tr_b16 v[222:223], v242 offset:23232
    v_mfma_f32_16x16x32_bf16 a[220:223], v[224:227], v[196:199], a[220:223]
    s_add_u32 m0, s47, 0
    s_mov_b32 s52, 0
    s_waitcnt lgkmcnt(4)
    v_mfma_f32_16x16x32_bf16 v[88:91], v[228:231], v[184:187], v[88:91]
    buffer_load_dwordx4 v251, s[40:43], s52 offen offset:0 nt lds
    v_mfma_f32_16x16x32_bf16 v[92:95], v[228:231], v[188:191], v[92:95]
    ds_read_b64_tr_b16 v[224:225], v242 offset:224
    v_mfma_f32_16x16x32_bf16 v[96:99], v[228:231], v[192:195], v[96:99]
    ds_read_b64_tr_b16 v[226:227], v242 offset:4832
    v_mfma_f32_16x16x32_bf16 v[100:103], v[228:231], v[196:199], v[100:103]
    s_waitcnt lgkmcnt(4)
    v_mfma_f32_16x16x32_bf16 a[224:227], v[216:219], v[184:187], a[224:227]
    buffer_load_dwordx4 v252, s[40:43], s52 offen offset:1024 nt lds
    v_mfma_f32_16x16x32_bf16 a[228:231], v[216:219], v[188:191], a[228:231]
    ds_read_b64_tr_b16 v[228:229], v242 offset:18656
    v_mfma_f32_16x16x32_bf16 a[232:235], v[216:219], v[192:195], a[232:235]
    ds_read_b64_tr_b16 v[230:231], v242 offset:23264
    v_mfma_f32_16x16x32_bf16 a[236:239], v[216:219], v[196:199], a[236:239]
    s_waitcnt lgkmcnt(4)
    v_mfma_f32_16x16x32_bf16 v[104:107], v[220:223], v[184:187], v[104:107]
    buffer_load_dwordx4 v251, s[40:43], s52 offen offset:2048 nt lds
    v_mfma_f32_16x16x32_bf16 v[108:111], v[220:223], v[188:191], v[108:111]
    ds_read_b64_tr_b16 v[216:217], v242 offset:256
    v_mfma_f32_16x16x32_bf16 v[112:115], v[220:223], v[192:195], v[112:115]
    ds_read_b64_tr_b16 v[218:219], v242 offset:4864
    v_mfma_f32_16x16x32_bf16 v[116:119], v[220:223], v[196:199], v[116:119]
    s_waitcnt lgkmcnt(4)
    v_mfma_f32_16x16x32_bf16 a[240:243], v[224:227], v[184:187], a[240:243]
    buffer_load_dwordx4 v252, s[40:43], s52 offen offset:3072 nt lds
    v_mfma_f32_16x16x32_bf16 a[244:247], v[224:227], v[188:191], a[244:247]
    ds_read_b64_tr_b16 v[220:221], v242 offset:18688
    v_mfma_f32_16x16x32_bf16 a[248:251], v[224:227], v[192:195], a[248:251]
    ds_read_b64_tr_b16 v[222:223], v242 offset:23296
    v_mfma_f32_16x16x32_bf16 a[252:255], v[224:227], v[196:199], a[252:255]
    s_add_u32 m0, s47, 16384
    s_mov_b32 s52, 16384
    s_waitcnt lgkmcnt(4)
    v_mfma_f32_16x16x32_bf16 v[120:123], v[228:231], v[184:187], v[120:123]
    v_xor_b32 v245, 0, v244
    buffer_load_dwordx4 v251, s[40:43], s52 offen offset:0 nt lds
    v_mfma_f32_16x16x32_bf16 v[124:127], v[228:231], v[188:191], v[124:127]
    ds_read_b64_tr_b16 v[224:225], v245 offset:0
    v_mfma_f32_16x16x32_bf16 v[128:131], v[228:231], v[192:195], v[128:131]
    ds_read_b64_tr_b16 v[226:227], v245 offset:4096
    v_mfma_f32_16x16x32_bf16 v[132:135], v[228:231], v[196:199], v[132:135]
    s_waitcnt lgkmcnt(4)
    v_mfma_f32_16x16x32_bf16 v[152:155], v[216:219], v[184:187], v[152:155]
    v_xor_b32 v246, 32, v244
    buffer_load_dwordx4 v252, s[40:43], s52 offen offset:1024 nt lds
    v_mfma_f32_16x16x32_bf16 v[156:159], v[216:219], v[188:191], v[156:159]
    ds_read_b64_tr_b16 v[228:229], v246 offset:0
    v_mfma_f32_16x16x32_bf16 v[160:163], v[216:219], v[192:195], v[160:163]
    ds_read_b64_tr_b16 v[230:231], v246 offset:4096
    v_mfma_f32_16x16x32_bf16 v[164:167], v[216:219], v[196:199], v[164:167]
    s_waitcnt lgkmcnt(4)
    v_mfma_f32_16x16x32_bf16 v[136:139], v[220:223], v[184:187], v[136:139]
    v_xor_b32 v245, 64, v244
    buffer_load_dwordx4 v251, s[40:43], s52 offen offset:2048 nt lds
    v_mfma_f32_16x16x32_bf16 v[140:143], v[220:223], v[188:191], v[140:143]
    ds_read_b64_tr_b16 v[216:217], v245 offset:0
    v_mfma_f32_16x16x32_bf16 v[144:147], v[220:223], v[192:195], v[144:147]
    ds_read_b64_tr_b16 v[218:219], v245 offset:4096
    v_mfma_f32_16x16x32_bf16 v[148:151], v[220:223], v[196:199], v[148:151]
    s_waitcnt lgkmcnt(4)
    v_mfma_f32_16x16x32_bf16 a[0:3], v[224:227], v[184:187], a[0:3]
    v_xor_b32 v246, 96, v244
    buffer_load_dwordx4 v252, s[40:43], s52 offen offset:3072 nt lds
    v_mfma_f32_16x16x32_bf16 a[4:7], v[224:227], v[188:191], a[4:7]
    ds_read_b64_tr_b16 v[220:221], v246 offset:0
    v_mfma_f32_16x16x32_bf16 a[8:11], v[224:227], v[192:195], a[8:11]
    ds_read_b64_tr_b16 v[222:223], v246 offset:4096
    v_mfma_f32_16x16x32_bf16 a[12:15], v[224:227], v[196:199], a[12:15]
    s_waitcnt lgkmcnt(4)
    v_mfma_f32_16x16x32_bf16 a[16:19], v[228:231], v[184:187], a[16:19]
    v_xor_b32 v245, 128, v244
    v_mfma_f32_16x16x32_bf16 a[20:23], v[228:231], v[188:191], a[20:23]
    ds_read_b64_tr_b16 v[224:225], v245 offset:0
    v_mfma_f32_16x16x32_bf16 a[24:27], v[228:231], v[192:195], a[24:27]
    ds_read_b64_tr_b16 v[226:227], v245 offset:4096
    v_mfma_f32_16x16x32_bf16 a[28:31], v[228:231], v[196:199], a[28:31]
    s_waitcnt lgkmcnt(4)
    v_mfma_f32_16x16x32_bf16 a[32:35], v[216:219], v[184:187], a[32:35]
    v_xor_b32 v246, 160, v244
    v_mfma_f32_16x16x32_bf16 a[36:39], v[216:219], v[188:191], a[36:39]
    ds_read_b64_tr_b16 v[228:229], v246 offset:0
    v_mfma_f32_16x16x32_bf16 a[40:43], v[216:219], v[192:195], a[40:43]
    ds_read_b64_tr_b16 v[230:231], v246 offset:4096
    v_mfma_f32_16x16x32_bf16 a[44:47], v[216:219], v[196:199], a[44:47]
    s_waitcnt lgkmcnt(4)
    v_mfma_f32_16x16x32_bf16 a[48:51], v[220:223], v[184:187], a[48:51]
    v_xor_b32 v245, 192, v244
    v_mfma_f32_16x16x32_bf16 a[52:55], v[220:223], v[188:191], a[52:55]
    ds_read_b64_tr_b16 v[216:217], v245 offset:0
    v_mfma_f32_16x16x32_bf16 a[56:59], v[220:223], v[192:195], a[56:59]
    ds_read_b64_tr_b16 v[218:219], v245 offset:4096
    v_mfma_f32_16x16x32_bf16 a[60:63], v[220:223], v[196:199], a[60:63]
    s_waitcnt lgkmcnt(4)
    v_mfma_f32_16x16x32_bf16 a[64:67], v[224:227], v[184:187], a[64:67]
    v_xor_b32 v246, 224, v244
    v_mfma_f32_16x16x32_bf16 a[68:71], v[224:227], v[188:191], a[68:71]
    ds_read_b64_tr_b16 v[220:221], v246 offset:0
    v_mfma_f32_16x16x32_bf16 a[72:75], v[224:227], v[192:195], a[72:75]
    ds_read_b64_tr_b16 v[222:223], v246 offset:4096
    v_mfma_f32_16x16x32_bf16 a[76:79], v[224:227], v[196:199], a[76:79]
    s_waitcnt lgkmcnt(4)
    v_mfma_f32_16x16x32_bf16 a[80:83], v[228:231], v[184:187], a[80:83]
    v_mfma_f32_16x16x32_bf16 a[84:87], v[228:231], v[188:191], a[84:87]
    ds_read_b64_tr_b16 v[224:225], v242 offset:9216
    v_mfma_f32_16x16x32_bf16 a[88:91], v[228:231], v[192:195], a[88:91]
    ds_read_b64_tr_b16 v[226:227], v242 offset:13824
    v_mfma_f32_16x16x32_bf16 a[92:95], v[228:231], v[196:199], a[92:95]
    s_waitcnt lgkmcnt(4)
    v_mfma_f32_16x16x32_bf16 a[96:99], v[216:219], v[184:187], a[96:99]
    v_mfma_f32_16x16x32_bf16 a[100:103], v[216:219], v[188:191], a[100:103]
    ds_read_b64_tr_b16 v[228:229], v242 offset:27648
    v_mfma_f32_16x16x32_bf16 a[104:107], v[216:219], v[192:195], a[104:107]
    ds_read_b64_tr_b16 v[230:231], v242 offset:32256
    v_mfma_f32_16x16x32_bf16 a[108:111], v[216:219], v[196:199], a[108:111]
    s_waitcnt lgkmcnt(4)
    v_mfma_f32_16x16x32_bf16 a[112:115], v[220:223], v[184:187], a[112:115]
    v_mfma_f32_16x16x32_bf16 a[116:119], v[220:223], v[188:191], a[116:119]
    ds_read_b64_tr_b16 v[216:217], v242 offset:9248
    v_mfma_f32_16x16x32_bf16 a[120:123], v[220:223], v[192:195], a[120:123]
    ds_read_b64_tr_b16 v[218:219], v242 offset:13856
    v_mfma_f32_16x16x32_bf16 a[124:127], v[220:223], v[196:199], a[124:127]
    s_waitcnt lgkmcnt(4)
    s_waitcnt vmcnt(20)
    v_mfma_f32_16x16x32_bf16 a[128:131], v[224:227], v[200:203], a[128:131]
    v_mfma_f32_16x16x32_bf16 a[132:135], v[224:227], v[204:207], a[132:135]
    ds_read_b64_tr_b16 v[220:221], v242 offset:27680
    v_mfma_f32_16x16x32_bf16 a[136:139], v[224:227], v[208:211], a[136:139]
    ds_read_b64_tr_b16 v[222:223], v242 offset:32288
    v_mfma_f32_16x16x32_bf16 a[140:143], v[224:227], v[212:215], a[140:143]
    s_waitcnt lgkmcnt(4)
    v_mfma_f32_16x16x32_bf16 v[8:11], v[228:231], v[200:203], v[8:11]
    v_mfma_f32_16x16x32_bf16 v[12:15], v[228:231], v[204:207], v[12:15]
    ds_read_b64_tr_b16 v[224:225], v242 offset:9280
    v_mfma_f32_16x16x32_bf16 v[16:19], v[228:231], v[208:211], v[16:19]
    ds_read_b64_tr_b16 v[226:227], v242 offset:13888
    v_mfma_f32_16x16x32_bf16 v[20:23], v[228:231], v[212:215], v[20:23]
    s_waitcnt lgkmcnt(4)
    v_mfma_f32_16x16x32_bf16 a[144:147], v[216:219], v[200:203], a[144:147]
    v_mfma_f32_16x16x32_bf16 a[148:151], v[216:219], v[204:207], a[148:151]
    ds_read_b64_tr_b16 v[228:229], v242 offset:27712
    v_mfma_f32_16x16x32_bf16 a[152:155], v[216:219], v[208:211], a[152:155]
    ds_read_b64_tr_b16 v[230:231], v242 offset:32320
    v_mfma_f32_16x16x32_bf16 a[156:159], v[216:219], v[212:215], a[156:159]
    s_waitcnt lgkmcnt(4)
    v_mfma_f32_16x16x32_bf16 v[24:27], v[220:223], v[200:203], v[24:27]
    v_mfma_f32_16x16x32_bf16 v[28:31], v[220:223], v[204:207], v[28:31]
    ds_read_b64_tr_b16 v[216:217], v242 offset:9312
    v_mfma_f32_16x16x32_bf16 v[32:35], v[220:223], v[208:211], v[32:35]
    ds_read_b64_tr_b16 v[218:219], v242 offset:13920
    v_mfma_f32_16x16x32_bf16 v[36:39], v[220:223], v[212:215], v[36:39]
    s_waitcnt lgkmcnt(4)
    v_mfma_f32_16x16x32_bf16 a[160:163], v[224:227], v[200:203], a[160:163]
    v_mfma_f32_16x16x32_bf16 a[164:167], v[224:227], v[204:207], a[164:167]
    ds_read_b64_tr_b16 v[220:221], v242 offset:27744
    v_mfma_f32_16x16x32_bf16 a[168:171], v[224:227], v[208:211], a[168:171]
    ds_read_b64_tr_b16 v[222:223], v242 offset:32352
    v_mfma_f32_16x16x32_bf16 a[172:175], v[224:227], v[212:215], a[172:175]
    s_waitcnt lgkmcnt(4)
    v_mfma_f32_16x16x32_bf16 v[40:43], v[228:231], v[200:203], v[40:43]
    v_mfma_f32_16x16x32_bf16 v[44:47], v[228:231], v[204:207], v[44:47]
    ds_read_b64_tr_b16 v[224:225], v242 offset:9344
    v_mfma_f32_16x16x32_bf16 v[48:51], v[228:231], v[208:211], v[48:51]
    ds_read_b64_tr_b16 v[226:227], v242 offset:13952
    v_mfma_f32_16x16x32_bf16 v[52:55], v[228:231], v[212:215], v[52:55]
    s_waitcnt lgkmcnt(4)
    v_mfma_f32_16x16x32_bf16 a[176:179], v[216:219], v[200:203], a[176:179]
    v_mfma_f32_16x16x32_bf16 a[180:183], v[216:219], v[204:207], a[180:183]
    ds_read_b64_tr_b16 v[228:229], v242 offset:27776
    v_mfma_f32_16x16x32_bf16 a[184:187], v[216:219], v[208:211], a[184:187]
    ds_read_b64_tr_b16 v[230:231], v242 offset:32384
    v_mfma_f32_16x16x32_bf16 a[188:191], v[216:219], v[212:215], a[188:191]
    s_waitcnt lgkmcnt(4)
    v_mfma_f32_16x16x32_bf16 v[56:59], v[220:223], v[200:203], v[56:59]
    v_mfma_f32_16x16x32_bf16 v[60:63], v[220:223], v[204:207], v[60:63]
    ds_read_b64_tr_b16 v[216:217], v242 offset:9376
    v_mfma_f32_16x16x32_bf16 v[64:67], v[220:223], v[208:211], v[64:67]
    ds_read_b64_tr_b16 v[218:219], v242 offset:13984
    v_mfma_f32_16x16x32_bf16 v[68:71], v[220:223], v[212:215], v[68:71]
    s_waitcnt lgkmcnt(4)
    v_mfma_f32_16x16x32_bf16 a[192:195], v[224:227], v[200:203], a[192:195]
    v_mfma_f32_16x16x32_bf16 a[196:199], v[224:227], v[204:207], a[196:199]
    ds_read_b64_tr_b16 v[220:221], v242 offset:27808
    v_mfma_f32_16x16x32_bf16 a[200:203], v[224:227], v[208:211], a[200:203]
    ds_read_b64_tr_b16 v[222:223], v242 offset:32416
    v_mfma_f32_16x16x32_bf16 a[204:207], v[224:227], v[212:215], a[204:207]
    s_waitcnt lgkmcnt(4)
    v_mfma_f32_16x16x32_bf16 v[72:75], v[228:231], v[200:203], v[72:75]
    v_mfma_f32_16x16x32_bf16 v[76:79], v[228:231], v[204:207], v[76:79]
    ds_read_b64_tr_b16 v[224:225], v242 offset:9408
    v_mfma_f32_16x16x32_bf16 v[80:83], v[228:231], v[208:211], v[80:83]
    ds_read_b64_tr_b16 v[226:227], v242 offset:14016
    v_mfma_f32_16x16x32_bf16 v[84:87], v[228:231], v[212:215], v[84:87]
    s_waitcnt lgkmcnt(4)
    v_mfma_f32_16x16x32_bf16 a[208:211], v[216:219], v[200:203], a[208:211]
    v_mfma_f32_16x16x32_bf16 a[212:215], v[216:219], v[204:207], a[212:215]
    ds_read_b64_tr_b16 v[228:229], v242 offset:27840
    v_mfma_f32_16x16x32_bf16 a[216:219], v[216:219], v[208:211], a[216:219]
    ds_read_b64_tr_b16 v[230:231], v242 offset:32448
    v_mfma_f32_16x16x32_bf16 a[220:223], v[216:219], v[212:215], a[220:223]
    s_waitcnt lgkmcnt(4)
    v_mfma_f32_16x16x32_bf16 v[88:91], v[220:223], v[200:203], v[88:91]
    v_mfma_f32_16x16x32_bf16 v[92:95], v[220:223], v[204:207], v[92:95]
    ds_read_b64_tr_b16 v[216:217], v242 offset:9440
    v_mfma_f32_16x16x32_bf16 v[96:99], v[220:223], v[208:211], v[96:99]
    ds_read_b64_tr_b16 v[218:219], v242 offset:14048
    v_mfma_f32_16x16x32_bf16 v[100:103], v[220:223], v[212:215], v[100:103]
    s_waitcnt lgkmcnt(4)
    v_mfma_f32_16x16x32_bf16 a[224:227], v[224:227], v[200:203], a[224:227]
    v_mfma_f32_16x16x32_bf16 a[228:231], v[224:227], v[204:207], a[228:231]
    ds_read_b64_tr_b16 v[220:221], v242 offset:27872
    v_mfma_f32_16x16x32_bf16 a[232:235], v[224:227], v[208:211], a[232:235]
    ds_read_b64_tr_b16 v[222:223], v242 offset:32480
    v_mfma_f32_16x16x32_bf16 a[236:239], v[224:227], v[212:215], a[236:239]
    s_waitcnt lgkmcnt(4)
    v_mfma_f32_16x16x32_bf16 v[104:107], v[228:231], v[200:203], v[104:107]
    v_mfma_f32_16x16x32_bf16 v[108:111], v[228:231], v[204:207], v[108:111]
    ds_read_b64_tr_b16 v[224:225], v242 offset:9472
    v_mfma_f32_16x16x32_bf16 v[112:115], v[228:231], v[208:211], v[112:115]
    ds_read_b64_tr_b16 v[226:227], v242 offset:14080
    v_mfma_f32_16x16x32_bf16 v[116:119], v[228:231], v[212:215], v[116:119]
    s_waitcnt lgkmcnt(4)
    v_mfma_f32_16x16x32_bf16 a[240:243], v[216:219], v[200:203], a[240:243]
    v_mfma_f32_16x16x32_bf16 a[244:247], v[216:219], v[204:207], a[244:247]
    ds_read_b64_tr_b16 v[228:229], v242 offset:27904
    v_mfma_f32_16x16x32_bf16 a[248:251], v[216:219], v[208:211], a[248:251]
    ds_read_b64_tr_b16 v[230:231], v242 offset:32512
    v_mfma_f32_16x16x32_bf16 a[252:255], v[216:219], v[212:215], a[252:255]
    s_waitcnt lgkmcnt(4)
    v_mfma_f32_16x16x32_bf16 v[120:123], v[220:223], v[200:203], v[120:123]
    v_xor_b32 v245, 0, v244
    v_mfma_f32_16x16x32_bf16 v[124:127], v[220:223], v[204:207], v[124:127]
    ds_read_b64_tr_b16 v[216:217], v245 offset:8192
    v_mfma_f32_16x16x32_bf16 v[128:131], v[220:223], v[208:211], v[128:131]
    ds_read_b64_tr_b16 v[218:219], v245 offset:12288
    v_mfma_f32_16x16x32_bf16 v[132:135], v[220:223], v[212:215], v[132:135]
    s_waitcnt lgkmcnt(4)
    v_mfma_f32_16x16x32_bf16 v[152:155], v[224:227], v[200:203], v[152:155]
    v_xor_b32 v246, 32, v244
    v_mfma_f32_16x16x32_bf16 v[156:159], v[224:227], v[204:207], v[156:159]
    ds_read_b64_tr_b16 v[220:221], v246 offset:8192
    v_mfma_f32_16x16x32_bf16 v[160:163], v[224:227], v[208:211], v[160:163]
    ds_read_b64_tr_b16 v[222:223], v246 offset:12288
    v_mfma_f32_16x16x32_bf16 v[164:167], v[224:227], v[212:215], v[164:167]
    s_waitcnt lgkmcnt(4)
    v_mfma_f32_16x16x32_bf16 v[136:139], v[228:231], v[200:203], v[136:139]
    v_xor_b32 v245, 64, v244
    v_mfma_f32_16x16x32_bf16 v[140:143], v[228:231], v[204:207], v[140:143]
    ds_read_b64_tr_b16 v[224:225], v245 offset:8192
    v_mfma_f32_16x16x32_bf16 v[144:147], v[228:231], v[208:211], v[144:147]
    ds_read_b64_tr_b16 v[226:227], v245 offset:12288
    v_mfma_f32_16x16x32_bf16 v[148:151], v[228:231], v[212:215], v[148:151]
    s_waitcnt lgkmcnt(4)
    v_mfma_f32_16x16x32_bf16 a[0:3], v[216:219], v[200:203], a[0:3]
    v_xor_b32 v246, 96, v244
    v_mfma_f32_16x16x32_bf16 a[4:7], v[216:219], v[204:207], a[4:7]
    ds_read_b64_tr_b16 v[228:229], v246 offset:8192
    v_mfma_f32_16x16x32_bf16 a[8:11], v[216:219], v[208:211], a[8:11]
    ds_read_b64_tr_b16 v[230:231], v246 offset:12288
    v_mfma_f32_16x16x32_bf16 a[12:15], v[216:219], v[212:215], a[12:15]
    s_waitcnt lgkmcnt(4)
    v_mfma_f32_16x16x32_bf16 a[16:19], v[220:223], v[200:203], a[16:19]
    v_xor_b32 v245, 128, v244
    v_mfma_f32_16x16x32_bf16 a[20:23], v[220:223], v[204:207], a[20:23]
    ds_read_b64_tr_b16 v[216:217], v245 offset:8192
    v_mfma_f32_16x16x32_bf16 a[24:27], v[220:223], v[208:211], a[24:27]
    ds_read_b64_tr_b16 v[218:219], v245 offset:12288
    v_mfma_f32_16x16x32_bf16 a[28:31], v[220:223], v[212:215], a[28:31]
    s_waitcnt lgkmcnt(4)
    v_mfma_f32_16x16x32_bf16 a[32:35], v[224:227], v[200:203], a[32:35]
    v_xor_b32 v246, 160, v244
    v_mfma_f32_16x16x32_bf16 a[36:39], v[224:227], v[204:207], a[36:39]
    ds_read_b64_tr_b16 v[220:221], v246 offset:8192
    v_mfma_f32_16x16x32_bf16 a[40:43], v[224:227], v[208:211], a[40:43]
    ds_read_b64_tr_b16 v[222:223], v246 offset:12288
    v_mfma_f32_16x16x32_bf16 a[44:47], v[224:227], v[212:215], a[44:47]
    s_waitcnt lgkmcnt(4)
    v_mfma_f32_16x16x32_bf16 a[48:51], v[228:231], v[200:203], a[48:51]
    v_xor_b32 v245, 192, v244
    v_mfma_f32_16x16x32_bf16 a[52:55], v[228:231], v[204:207], a[52:55]
    ds_read_b64_tr_b16 v[224:225], v245 offset:8192
    v_mfma_f32_16x16x32_bf16 a[56:59], v[228:231], v[208:211], a[56:59]
    ds_read_b64_tr_b16 v[226:227], v245 offset:12288
    v_mfma_f32_16x16x32_bf16 a[60:63], v[228:231], v[212:215], a[60:63]
    s_waitcnt lgkmcnt(4)
    v_mfma_f32_16x16x32_bf16 a[64:67], v[216:219], v[200:203], a[64:67]
    v_xor_b32 v246, 224, v244
    v_mfma_f32_16x16x32_bf16 a[68:71], v[216:219], v[204:207], a[68:71]
    ds_read_b64_tr_b16 v[228:229], v246 offset:8192
    v_mfma_f32_16x16x32_bf16 a[72:75], v[216:219], v[208:211], a[72:75]
    ds_read_b64_tr_b16 v[230:231], v246 offset:12288
    v_mfma_f32_16x16x32_bf16 a[76:79], v[216:219], v[212:215], a[76:79]
    s_waitcnt lgkmcnt(4)
    v_mfma_f32_16x16x32_bf16 a[80:83], v[220:223], v[200:203], a[80:83]
    v_mfma_f32_16x16x32_bf16 a[84:87], v[220:223], v[204:207], a[84:87]
    v_mfma_f32_16x16x32_bf16 a[88:91], v[220:223], v[208:211], a[88:91]
    v_mfma_f32_16x16x32_bf16 a[92:95], v[220:223], v[212:215], a[92:95]
    s_waitcnt lgkmcnt(2)
    v_mfma_f32_16x16x32_bf16 a[96:99], v[224:227], v[200:203], a[96:99]
    v_mfma_f32_16x16x32_bf16 a[100:103], v[224:227], v[204:207], a[100:103]
    v_mfma_f32_16x16x32_bf16 a[104:107], v[224:227], v[208:211], a[104:107]
    v_mfma_f32_16x16x32_bf16 a[108:111], v[224:227], v[212:215], a[108:111]
    s_waitcnt lgkmcnt(0)
    v_mfma_f32_16x16x32_bf16 a[112:115], v[228:231], v[200:203], a[112:115]
    v_mfma_f32_16x16x32_bf16 a[116:119], v[228:231], v[204:207], a[116:119]
    v_mfma_f32_16x16x32_bf16 a[120:123], v[228:231], v[208:211], a[120:123]
    v_mfma_f32_16x16x32_bf16 a[124:127], v[228:231], v[212:215], a[124:127]
    v_lshlrev_b32 v1, 3, v2
    s_nop 7
    v_accvgpr_read_b32 v232, a128
    v_accvgpr_read_b32 v233, a129
    v_accvgpr_read_b32 v234, a130
    v_accvgpr_read_b32 v235, a131
    v_max_f32 v232, 0, v232
    v_max_f32 v233, 0, v233
    v_max_f32 v234, 0, v234
    v_max_f32 v235, 0, v235
    v_pk_mul_f32 v[8:9], v[232:233], v[8:9]
    v_pk_mul_f32 v[10:11], v[234:235], v[10:11]
    v_cvt_pk_bf16_f32 v8, v8, v9
    v_cvt_pk_bf16_f32 v9, v10, v11
    v_accvgpr_read_b32 v232, a144
    v_accvgpr_read_b32 v233, a145
    v_accvgpr_read_b32 v234, a146
    v_accvgpr_read_b32 v235, a147
    v_max_f32 v232, 0, v232
    v_max_f32 v233, 0, v233
    v_max_f32 v234, 0, v234
    v_max_f32 v235, 0, v235
    v_pk_mul_f32 v[24:25], v[232:233], v[24:25]
    v_pk_mul_f32 v[26:27], v[234:235], v[26:27]
    v_cvt_pk_bf16_f32 v10, v24, v25
    v_cvt_pk_bf16_f32 v11, v26, v27
    s_add_u32 s80, s82, 0
    buffer_store_dwordx4 v[8:11], v3, s[16:19], s80 offen offset:0 sc1
    v_accvgpr_read_b32 v232, a132
    v_accvgpr_read_b32 v233, a133
    v_accvgpr_read_b32 v234, a134
    v_accvgpr_read_b32 v235, a135
    v_max_f32 v232, 0, v232
    v_max_f32 v233, 0, v233
    v_max_f32 v234, 0, v234
    v_max_f32 v235, 0, v235
    v_pk_mul_f32 v[12:13], v[232:233], v[12:13]
    v_pk_mul_f32 v[14:15], v[234:235], v[14:15]
    v_cvt_pk_bf16_f32 v12, v12, v13
    v_cvt_pk_bf16_f32 v13, v14, v15
    v_accvgpr_read_b32 v232, a148
    v_accvgpr_read_b32 v233, a149
    v_accvgpr_read_b32 v234, a150
    v_accvgpr_read_b32 v235, a151
    v_max_f32 v232, 0, v232
    v_max_f32 v233, 0, v233
    v_max_f32 v234, 0, v234
    v_max_f32 v235, 0, v235
    v_pk_mul_f32 v[28:29], v[232:233], v[28:29]
    v_pk_mul_f32 v[30:31], v[234:235], v[30:31]
    v_cvt_pk_bf16_f32 v14, v28, v29
    v_cvt_pk_bf16_f32 v15, v30, v31
    s_add_u32 s80, s82, 0
    buffer_store_dwordx4 v[12:15], v3, s[16:19], s80 offen offset:1024 sc1
    v_accvgpr_read_b32 v232, a136
    v_accvgpr_read_b32 v233, a137
    v_accvgpr_read_b32 v234, a138
    v_accvgpr_read_b32 v235, a139
    v_max_f32 v232, 0, v232
    v_max_f32 v233, 0, v233
    v_max_f32 v234, 0, v234
    v_max_f32 v235, 0, v235
    v_pk_mul_f32 v[16:17], v[232:233], v[16:17]
    v_pk_mul_f32 v[18:19], v[234:235], v[18:19]
    v_cvt_pk_bf16_f32 v16, v16, v17
    v_cvt_pk_bf16_f32 v17, v18, v19
    v_accvgpr_read_b32 v232, a152
    v_accvgpr_read_b32 v233, a153
    v_accvgpr_read_b32 v234, a154
    v_accvgpr_read_b32 v235, a155
    v_max_f32 v232, 0, v232
    v_max_f32 v233, 0, v233
    v_max_f32 v234, 0, v234
    v_max_f32 v235, 0, v235
    v_pk_mul_f32 v[32:33], v[232:233], v[32:33]
    v_pk_mul_f32 v[34:35], v[234:235], v[34:35]
    v_cvt_pk_bf16_f32 v18, v32, v33
    v_cvt_pk_bf16_f32 v19, v34, v35
    s_add_u32 s80, s82, 0
    buffer_store_dwordx4 v[16:19], v3, s[16:19], s80 offen offset:2048 sc1
    v_accvgpr_read_b32 v232, a140
    v_accvgpr_read_b32 v233, a141
    v_accvgpr_read_b32 v234, a142
    v_accvgpr_read_b32 v235, a143
    v_max_f32 v232, 0, v232
    v_max_f32 v233, 0, v233
    v_max_f32 v234, 0, v234
    v_max_f32 v235, 0, v235
    v_pk_mul_f32 v[20:21], v[232:233], v[20:21]
    v_pk_mul_f32 v[22:23], v[234:235], v[22:23]
    v_cvt_pk_bf16_f32 v20, v20, v21
    v_cvt_pk_bf16_f32 v21, v22, v23
    v_accvgpr_read_b32 v232, a156
    v_accvgpr_read_b32 v233, a157
    v_accvgpr_read_b32 v234, a158
    v_accvgpr_read_b32 v235, a159
    v_max_f32 v232, 0, v232
    v_max_f32 v233, 0, v233
    v_max_f32 v234, 0, v234
    v_max_f32 v235, 0, v235
    v_pk_mul_f32 v[36:37], v[232:233], v[36:37]
    v_pk_mul_f32 v[38:39], v[234:235], v[38:39]
    v_cvt_pk_bf16_f32 v22, v36, v37
    v_cvt_pk_bf16_f32 v23, v38, v39
    s_add_u32 s80, s82, 0
    buffer_store_dwordx4 v[20:23], v3, s[16:19], s80 offen offset:3072 sc1
    v_accvgpr_read_b32 v232, a160
    v_accvgpr_read_b32 v233, a161
    v_accvgpr_read_b32 v234, a162
    v_accvgpr_read_b32 v235, a163
    v_max_f32 v232, 0, v232
    v_max_f32 v233, 0, v233
    v_max_f32 v234, 0, v234
    v_max_f32 v235, 0, v235
    v_pk_mul_f32 v[40:41], v[232:233], v[40:41]
    v_pk_mul_f32 v[42:43], v[234:235], v[42:43]
    v_cvt_pk_bf16_f32 v40, v40, v41
    v_cvt_pk_bf16_f32 v41, v42, v43
    v_accvgpr_read_b32 v232, a176
    v_accvgpr_read_b32 v233, a177
    v_accvgpr_read_b32 v234, a178
    v_accvgpr_read_b32 v235, a179
    v_max_f32 v232, 0, v232
    v_max_f32 v233, 0, v233
    v_max_f32 v234, 0, v234
    v_max_f32 v235, 0, v235
    v_pk_mul_f32 v[56:57], v[232:233], v[56:57]
    v_pk_mul_f32 v[58:59], v[234:235], v[58:59]
    v_cvt_pk_bf16_f32 v42, v56, v57
    v_cvt_pk_bf16_f32 v43, v58, v59
    s_add_u32 s80, s82, 16384
    buffer_store_dwordx4 v[40:43], v3, s[16:19], s80 offen offset:0 sc1
    v_accvgpr_read_b32 v232, a164
    v_accvgpr_read_b32 v233, a165
    v_accvgpr_read_b32 v234, a166
    v_accvgpr_read_b32 v235, a167
    v_max_f32 v232, 0, v232
    v_max_f32 v233, 0, v233
    v_max_f32 v234, 0, v234
    v_max_f32 v235, 0, v235
    v_pk_mul_f32 v[44:45], v[232:233], v[44:45]
    v_pk_mul_f32 v[46:47], v[234:235], v[46:47]
    v_cvt_pk_bf16_f32 v44, v44, v45
    v_cvt_pk_bf16_f32 v45, v46, v47
    v_accvgpr_read_b32 v232, a180
    v_accvgpr_read_b32 v233, a181
    v_accvgpr_read_b32 v234, a182
    v_accvgpr_read_b32 v235, a183
    v_max_f32 v232, 0, v232
    v_max_f32 v233, 0, v233
    v_max_f32 v234, 0, v234
    v_max_f32 v235, 0, v235
    v_pk_mul_f32 v[60:61], v[232:233], v[60:61]
    v_pk_mul_f32 v[62:63], v[234:235], v[62:63]
    v_cvt_pk_bf16_f32 v46, v60, v61
    v_cvt_pk_bf16_f32 v47, v62, v63
    s_add_u32 s80, s82, 16384
    buffer_store_dwordx4 v[44:47], v3, s[16:19], s80 offen offset:1024 sc1
    v_accvgpr_read_b32 v232, a168
    v_accvgpr_read_b32 v233, a169
    v_accvgpr_read_b32 v234, a170
    v_accvgpr_read_b32 v235, a171
    v_max_f32 v232, 0, v232
    v_max_f32 v233, 0, v233
    v_max_f32 v234, 0, v234
    v_max_f32 v235, 0, v235
    v_pk_mul_f32 v[48:49], v[232:233], v[48:49]
    v_pk_mul_f32 v[50:51], v[234:235], v[50:51]
    v_cvt_pk_bf16_f32 v48, v48, v49
    v_cvt_pk_bf16_f32 v49, v50, v51
    v_accvgpr_read_b32 v232, a184
    v_accvgpr_read_b32 v233, a185
    v_accvgpr_read_b32 v234, a186
    v_accvgpr_read_b32 v235, a187
    v_max_f32 v232, 0, v232
    v_max_f32 v233, 0, v233
    v_max_f32 v234, 0, v234
    v_max_f32 v235, 0, v235
    v_pk_mul_f32 v[64:65], v[232:233], v[64:65]
    v_pk_mul_f32 v[66:67], v[234:235], v[66:67]
    v_cvt_pk_bf16_f32 v50, v64, v65
    v_cvt_pk_bf16_f32 v51, v66, v67
    s_add_u32 s80, s82, 16384
    buffer_store_dwordx4 v[48:51], v3, s[16:19], s80 offen offset:2048 sc1
    v_accvgpr_read_b32 v232, a172
    v_accvgpr_read_b32 v233, a173
    v_accvgpr_read_b32 v234, a174
    v_accvgpr_read_b32 v235, a175
    v_max_f32 v232, 0, v232
    v_max_f32 v233, 0, v233
    v_max_f32 v234, 0, v234
    v_max_f32 v235, 0, v235
    v_pk_mul_f32 v[52:53], v[232:233], v[52:53]
    v_pk_mul_f32 v[54:55], v[234:235], v[54:55]
    v_cvt_pk_bf16_f32 v52, v52, v53
    v_cvt_pk_bf16_f32 v53, v54, v55
    v_accvgpr_read_b32 v232, a188
    v_accvgpr_read_b32 v233, a189
    v_accvgpr_read_b32 v234, a190
    v_accvgpr_read_b32 v235, a191
    v_max_f32 v232, 0, v232
    v_max_f32 v233, 0, v233
    v_max_f32 v234, 0, v234
    v_max_f32 v235, 0, v235
    v_pk_mul_f32 v[68:69], v[232:233], v[68:69]
    v_pk_mul_f32 v[70:71], v[234:235], v[70:71]
    v_cvt_pk_bf16_f32 v54, v68, v69
    v_cvt_pk_bf16_f32 v55, v70, v71
    s_add_u32 s80, s82, 16384
    buffer_store_dwordx4 v[52:55], v3, s[16:19], s80 offen offset:3072 sc1
    v_accvgpr_read_b32 v232, a192
    v_accvgpr_read_b32 v233, a193
    v_accvgpr_read_b32 v234, a194
    v_accvgpr_read_b32 v235, a195
    v_max_f32 v232, 0, v232
    v_max_f32 v233, 0, v233
    v_max_f32 v234, 0, v234
    v_max_f32 v235, 0, v235
    v_pk_mul_f32 v[72:73], v[232:233], v[72:73]
    v_pk_mul_f32 v[74:75], v[234:235], v[74:75]
    v_cvt_pk_bf16_f32 v72, v72, v73
    v_cvt_pk_bf16_f32 v73, v74, v75
    v_accvgpr_read_b32 v232, a208
    v_accvgpr_read_b32 v233, a209
    v_accvgpr_read_b32 v234, a210
    v_accvgpr_read_b32 v235, a211
    v_max_f32 v232, 0, v232
    v_max_f32 v233, 0, v233
    v_max_f32 v234, 0, v234
    v_max_f32 v235, 0, v235
    v_pk_mul_f32 v[88:89], v[232:233], v[88:89]
    v_pk_mul_f32 v[90:91], v[234:235], v[90:91]
    v_cvt_pk_bf16_f32 v74, v88, v89
    v_cvt_pk_bf16_f32 v75, v90, v91
    v_accvgpr_read_b32 v232, a196
    v_accvgpr_read_b32 v233, a197
    v_accvgpr_read_b32 v234, a198
    v_accvgpr_read_b32 v235, a199
    v_max_f32 v232, 0, v232
    v_max_f32 v233, 0, v233
    v_max_f32 v234, 0, v234
    v_max_f32 v235, 0, v235
    v_pk_mul_f32 v[76:77], v[232:233], v[76:77]
    v_pk_mul_f32 v[78:79], v[234:235], v[78:79]
    v_cvt_pk_bf16_f32 v76, v76, v77
    v_cvt_pk_bf16_f32 v77, v78, v79
    v_accvgpr_read_b32 v232, a212
    v_accvgpr_read_b32 v233, a213
    v_accvgpr_read_b32 v234, a214
    v_accvgpr_read_b32 v235, a215
    v_max_f32 v232, 0, v232
    v_max_f32 v233, 0, v233
    v_max_f32 v234, 0, v234
    v_max_f32 v235, 0, v235
    v_pk_mul_f32 v[92:93], v[232:233], v[92:93]
    v_pk_mul_f32 v[94:95], v[234:235], v[94:95]
    v_cvt_pk_bf16_f32 v78, v92, v93
    v_cvt_pk_bf16_f32 v79, v94, v95
    v_accvgpr_read_b32 v232, a200
    v_accvgpr_read_b32 v233, a201
    v_accvgpr_read_b32 v234, a202
    v_accvgpr_read_b32 v235, a203
    v_max_f32 v232, 0, v232
    v_max_f32 v233, 0, v233
    v_max_f32 v234, 0, v234
    v_max_f32 v235, 0, v235
    v_pk_mul_f32 v[80:81], v[232:233], v[80:81]
    v_pk_mul_f32 v[82:83], v[234:235], v[82:83]
    v_cvt_pk_bf16_f32 v80, v80, v81
    v_cvt_pk_bf16_f32 v81, v82, v83
    v_accvgpr_read_b32 v232, a216
    v_accvgpr_read_b32 v233, a217
    v_accvgpr_read_b32 v234, a218
    v_accvgpr_read_b32 v235, a219
    v_max_f32 v232, 0, v232
    v_max_f32 v233, 0, v233
    v_max_f32 v234, 0, v234
    v_max_f32 v235, 0, v235
    v_pk_mul_f32 v[96:97], v[232:233], v[96:97]
    v_pk_mul_f32 v[98:99], v[234:235], v[98:99]
    v_cvt_pk_bf16_f32 v82, v96, v97
    v_cvt_pk_bf16_f32 v83, v98, v99
    v_accvgpr_read_b32 v232, a204
    v_accvgpr_read_b32 v233, a205
    v_accvgpr_read_b32 v234, a206
    v_accvgpr_read_b32 v235, a207
    v_max_f32 v232, 0, v232
    v_max_f32 v233, 0, v233
    v_max_f32 v234, 0, v234
    v_max_f32 v235, 0, v235
    v_pk_mul_f32 v[84:85], v[232:233], v[84:85]
    v_pk_mul_f32 v[86:87], v[234:235], v[86:87]
    v_cvt_pk_bf16_f32 v84, v84, v85
    v_cvt_pk_bf16_f32 v85, v86, v87
    v_accvgpr_read_b32 v232, a220
    v_accvgpr_read_b32 v233, a221
    v_accvgpr_read_b32 v234, a222
    v_accvgpr_read_b32 v235, a223
    v_max_f32 v232, 0, v232
    v_max_f32 v233, 0, v233
    v_max_f32 v234, 0, v234
    v_max_f32 v235, 0, v235
    v_pk_mul_f32 v[100:101], v[232:233], v[100:101]
    v_pk_mul_f32 v[102:103], v[234:235], v[102:103]
    v_cvt_pk_bf16_f32 v86, v100, v101
    v_cvt_pk_bf16_f32 v87, v102, v103
    v_accvgpr_read_b32 v232, a224
    v_accvgpr_read_b32 v233, a225
    v_accvgpr_read_b32 v234, a226
    v_accvgpr_read_b32 v235, a227
    v_max_f32 v232, 0, v232
    v_max_f32 v233, 0, v233
    v_max_f32 v234, 0, v234
    v_max_f32 v235, 0, v235
    v_pk_mul_f32 v[104:105], v[232:233], v[104:105]
    v_pk_mul_f32 v[106:107], v[234:235], v[106:107]
    v_cvt_pk_bf16_f32 v104, v104, v105
    v_cvt_pk_bf16_f32 v105, v106, v107
    v_accvgpr_read_b32 v232, a240
    v_accvgpr_read_b32 v233, a241
    v_accvgpr_read_b32 v234, a242
    v_accvgpr_read_b32 v235, a243
    v_max_f32 v232, 0, v232
    v_max_f32 v233, 0, v233
    v_max_f32 v234, 0, v234
    v_max_f32 v235, 0, v235
    v_pk_mul_f32 v[120:121], v[232:233], v[120:121]
    v_pk_mul_f32 v[122:123], v[234:235], v[122:123]
    v_cvt_pk_bf16_f32 v106, v120, v121
    v_cvt_pk_bf16_f32 v107, v122, v123
    v_accvgpr_read_b32 v232, a228
    v_accvgpr_read_b32 v233, a229
    v_accvgpr_read_b32 v234, a230
    v_accvgpr_read_b32 v235, a231
    v_max_f32 v232, 0, v232
    v_max_f32 v233, 0, v233
    v_max_f32 v234, 0, v234
    v_max_f32 v235, 0, v235
    v_pk_mul_f32 v[108:109], v[232:233], v[108:109]
    v_pk_mul_f32 v[110:111], v[234:235], v[110:111]
    v_cvt_pk_bf16_f32 v108, v108, v109
    v_cvt_pk_bf16_f32 v109, v110, v111
    v_accvgpr_read_b32 v232, a244
    v_accvgpr_read_b32 v233, a245
    v_accvgpr_read_b32 v234, a246
    v_accvgpr_read_b32 v235, a247
    v_max_f32 v232, 0, v232
    v_max_f32 v233, 0, v233
    v_max_f32 v234, 0, v234
    v_max_f32 v235, 0, v235
    v_pk_mul_f32 v[124:125], v[232:233], v[124:125]
    v_pk_mul_f32 v[126:127], v[234:235], v[126:127]
    v_cvt_pk_bf16_f32 v110, v124, v125
    v_cvt_pk_bf16_f32 v111, v126, v127
    v_accvgpr_read_b32 v232, a232
    v_accvgpr_read_b32 v233, a233
    v_accvgpr_read_b32 v234, a234
    v_accvgpr_read_b32 v235, a235
    v_max_f32 v232, 0, v232
    v_max_f32 v233, 0, v233
    v_max_f32 v234, 0, v234
    v_max_f32 v235, 0, v235
    v_pk_mul_f32 v[112:113], v[232:233], v[112:113]
    v_pk_mul_f32 v[114:115], v[234:235], v[114:115]
    v_cvt_pk_bf16_f32 v112, v112, v113
    v_cvt_pk_bf16_f32 v113, v114, v115
    v_accvgpr_read_b32 v232, a248
    v_accvgpr_read_b32 v233, a249
    v_accvgpr_read_b32 v234, a250
    v_accvgpr_read_b32 v235, a251
    v_max_f32 v232, 0, v232
    v_max_f32 v233, 0, v233
    v_max_f32 v234, 0, v234
    v_max_f32 v235, 0, v235
    v_pk_mul_f32 v[128:129], v[232:233], v[128:129]
    v_pk_mul_f32 v[130:131], v[234:235], v[130:131]
    v_cvt_pk_bf16_f32 v114, v128, v129
    v_cvt_pk_bf16_f32 v115, v130, v131
    v_accvgpr_read_b32 v232, a236
    v_accvgpr_read_b32 v233, a237
    v_accvgpr_read_b32 v234, a238
    v_accvgpr_read_b32 v235, a239
    v_max_f32 v232, 0, v232
    v_max_f32 v233, 0, v233
    v_max_f32 v234, 0, v234
    v_max_f32 v235, 0, v235
    v_pk_mul_f32 v[116:117], v[232:233], v[116:117]
    v_pk_mul_f32 v[118:119], v[234:235], v[118:119]
    v_cvt_pk_bf16_f32 v116, v116, v117
    v_cvt_pk_bf16_f32 v117, v118, v119
    v_accvgpr_read_b32 v232, a252
    v_accvgpr_read_b32 v233, a253
    v_accvgpr_read_b32 v234, a254
    v_accvgpr_read_b32 v235, a255
    v_max_f32 v232, 0, v232
    v_max_f32 v233, 0, v233
    v_max_f32 v234, 0, v234
    v_max_f32 v235, 0, v235
    v_pk_mul_f32 v[132:133], v[232:233], v[132:133]
    v_pk_mul_f32 v[134:135], v[234:235], v[134:135]
    v_cvt_pk_bf16_f32 v118, v132, v133
    v_cvt_pk_bf16_f32 v119, v134, v135
    v_max_f32 v232, 0, v152
    v_max_f32 v233, 0, v153
    v_max_f32 v234, 0, v154
    v_max_f32 v235, 0, v155
    v_pk_mul_f32 v[136:137], v[232:233], v[136:137]
    v_pk_mul_f32 v[138:139], v[234:235], v[138:139]
    v_cvt_pk_bf16_f32 v208, v136, v137
    v_cvt_pk_bf16_f32 v209, v138, v139
    v_max_f32 v232, 0, v156
    v_max_f32 v233, 0, v157
    v_max_f32 v234, 0, v158
    v_max_f32 v235, 0, v159
    v_pk_mul_f32 v[140:141], v[232:233], v[140:141]
    v_pk_mul_f32 v[142:143], v[234:235], v[142:143]
    v_cvt_pk_bf16_f32 v210, v140, v141
    v_cvt_pk_bf16_f32 v211, v142, v143
    v_max_f32 v232, 0, v160
    v_max_f32 v233, 0, v161
    v_max_f32 v234, 0, v162
    v_max_f32 v235, 0, v163
    v_pk_mul_f32 v[144:145], v[232:233], v[144:145]
    v_pk_mul_f32 v[146:147], v[234:235], v[146:147]
    v_cvt_pk_bf16_f32 v212, v144, v145
    v_cvt_pk_bf16_f32 v213, v146, v147
    v_max_f32 v232, 0, v164
    v_max_f32 v233, 0, v165
    v_max_f32 v234, 0, v166
    v_max_f32 v235, 0, v167
    v_pk_mul_f32 v[148:149], v[232:233], v[148:149]
    v_pk_mul_f32 v[150:151], v[234:235], v[150:151]
    v_cvt_pk_bf16_f32 v214, v148, v149
    v_cvt_pk_bf16_f32 v215, v150, v151
    s_mov_b32 s86, 0x3e0293ee
    s_mov_b32 s87, 0x3e0293ee
    v_accvgpr_read_b32 v216, a0
    v_accvgpr_read_b32 v217, a1
    v_accvgpr_read_b32 v218, a2
    v_accvgpr_read_b32 v219, a3
    v_accvgpr_read_b32 v220, a16
    v_accvgpr_read_b32 v221, a17
    v_accvgpr_read_b32 v222, a18
    v_accvgpr_read_b32 v223, a19
    v_pk_mul_f32 v[216:217], v[216:217], s[86:87]
    v_pk_mul_f32 v[218:219], v[218:219], s[86:87]
    v_pk_mul_f32 v[220:221], v[220:221], s[86:87]
    v_pk_mul_f32 v[222:223], v[222:223], s[86:87]
    v_cvt_pk_bf16_f32 v224, v216, v217
    v_cvt_pk_bf16_f32 v225, v218, v219
    v_cvt_pk_bf16_f32 v226, v220, v221
    v_cvt_pk_bf16_f32 v227, v222, v223
    s_nop 0
    v_permlane32_swap_b32 v224, v226
    v_permlane32_swap_b32 v225, v227
    s_nop 0
    v_permlane16_swap_b32 v224, v226
    v_permlane16_swap_b32 v225, v227
    v_accvgpr_write_b32 a0, v224
    v_accvgpr_write_b32 a1, v225
    v_accvgpr_write_b32 a2, v226
    v_accvgpr_write_b32 a3, v227
    v_accvgpr_read_b32 v216, a4
    v_accvgpr_read_b32 v217, a5
    v_accvgpr_read_b32 v218, a6
    v_accvgpr_read_b32 v219, a7
    v_accvgpr_read_b32 v220, a20
    v_accvgpr_read_b32 v221, a21
    v_accvgpr_read_b32 v222, a22
    v_accvgpr_read_b32 v223, a23
    v_pk_mul_f32 v[216:217], v[216:217], s[86:87]
    v_pk_mul_f32 v[218:219], v[218:219], s[86:87]
    v_pk_mul_f32 v[220:221], v[220:221], s[86:87]
    v_pk_mul_f32 v[222:223], v[222:223], s[86:87]
    v_cvt_pk_bf16_f32 v224, v216, v217
    v_cvt_pk_bf16_f32 v225, v218, v219
    v_cvt_pk_bf16_f32 v226, v220, v221
    v_cvt_pk_bf16_f32 v227, v222, v223
    s_nop 0
    v_permlane32_swap_b32 v224, v226
    v_permlane32_swap_b32 v225, v227
    s_nop 0
    v_permlane16_swap_b32 v224, v226
    v_permlane16_swap_b32 v225, v227
    v_accvgpr_write_b32 a4, v224
    v_accvgpr_write_b32 a5, v225
    v_accvgpr_write_b32 a6, v226
    v_accvgpr_write_b32 a7, v227
    v_accvgpr_read_b32 v216, a8
    v_accvgpr_read_b32 v217, a9
    v_accvgpr_read_b32 v218, a10
    v_accvgpr_read_b32 v219, a11
    v_accvgpr_read_b32 v220, a24
    v_accvgpr_read_b32 v221, a25
    v_accvgpr_read_b32 v222, a26
    v_accvgpr_read_b32 v223, a27
    v_pk_mul_f32 v[216:217], v[216:217], s[86:87]
    v_pk_mul_f32 v[218:219], v[218:219], s[86:87]
    v_pk_mul_f32 v[220:221], v[220:221], s[86:87]
    v_pk_mul_f32 v[222:223], v[222:223], s[86:87]
    v_cvt_pk_bf16_f32 v224, v216, v217
    v_cvt_pk_bf16_f32 v225, v218, v219
    v_cvt_pk_bf16_f32 v226, v220, v221
    v_cvt_pk_bf16_f32 v227, v222, v223
    s_nop 0
    v_permlane32_swap_b32 v224, v226
    v_permlane32_swap_b32 v225, v227
    s_nop 0
    v_permlane16_swap_b32 v224, v226
    v_permlane16_swap_b32 v225, v227
    v_accvgpr_write_b32 a8, v224
    v_accvgpr_write_b32 a9, v225
    v_accvgpr_write_b32 a10, v226
    v_accvgpr_write_b32 a11, v227
    v_accvgpr_read_b32 v216, a12
    v_accvgpr_read_b32 v217, a13
    v_accvgpr_read_b32 v218, a14
    v_accvgpr_read_b32 v219, a15
    v_accvgpr_read_b32 v220, a28
    v_accvgpr_read_b32 v221, a29
    v_accvgpr_read_b32 v222, a30
    v_accvgpr_read_b32 v223, a31
    v_pk_mul_f32 v[216:217], v[216:217], s[86:87]
    v_pk_mul_f32 v[218:219], v[218:219], s[86:87]
    v_pk_mul_f32 v[220:221], v[220:221], s[86:87]
    v_pk_mul_f32 v[222:223], v[222:223], s[86:87]
    v_cvt_pk_bf16_f32 v224, v216, v217
    v_cvt_pk_bf16_f32 v225, v218, v219
    v_cvt_pk_bf16_f32 v226, v220, v221
    v_cvt_pk_bf16_f32 v227, v222, v223
    s_nop 0
    v_permlane32_swap_b32 v224, v226
    v_permlane32_swap_b32 v225, v227
    s_nop 0
    v_permlane16_swap_b32 v224, v226
    v_permlane16_swap_b32 v225, v227
    v_accvgpr_write_b32 a12, v224
    v_accvgpr_write_b32 a13, v225
    v_accvgpr_write_b32 a14, v226
    v_accvgpr_write_b32 a15, v227
    v_accvgpr_read_b32 v216, a32
    v_accvgpr_read_b32 v217, a33
    v_accvgpr_read_b32 v218, a34
    v_accvgpr_read_b32 v219, a35
    v_accvgpr_read_b32 v220, a48
    v_accvgpr_read_b32 v221, a49
    v_accvgpr_read_b32 v222, a50
    v_accvgpr_read_b32 v223, a51
    v_pk_mul_f32 v[216:217], v[216:217], s[86:87]
    v_pk_mul_f32 v[218:219], v[218:219], s[86:87]
    v_pk_mul_f32 v[220:221], v[220:221], s[86:87]
    v_pk_mul_f32 v[222:223], v[222:223], s[86:87]
    v_cvt_pk_bf16_f32 v224, v216, v217
    v_cvt_pk_bf16_f32 v225, v218, v219
    v_cvt_pk_bf16_f32 v226, v220, v221
    v_cvt_pk_bf16_f32 v227, v222, v223
    s_nop 0
    v_permlane32_swap_b32 v224, v226
    v_permlane32_swap_b32 v225, v227
    s_nop 0
    v_permlane16_swap_b32 v224, v226
    v_permlane16_swap_b32 v225, v227
    v_accvgpr_write_b32 a32, v224
    v_accvgpr_write_b32 a33, v225
    v_accvgpr_write_b32 a34, v226
    v_accvgpr_write_b32 a35, v227
    v_accvgpr_read_b32 v216, a36
    v_accvgpr_read_b32 v217, a37
    v_accvgpr_read_b32 v218, a38
    v_accvgpr_read_b32 v219, a39
    v_accvgpr_read_b32 v220, a52
    v_accvgpr_read_b32 v221, a53
    v_accvgpr_read_b32 v222, a54
    v_accvgpr_read_b32 v223, a55
    v_pk_mul_f32 v[216:217], v[216:217], s[86:87]
    v_pk_mul_f32 v[218:219], v[218:219], s[86:87]
    v_pk_mul_f32 v[220:221], v[220:221], s[86:87]
    v_pk_mul_f32 v[222:223], v[222:223], s[86:87]
    v_cvt_pk_bf16_f32 v224, v216, v217
    v_cvt_pk_bf16_f32 v225, v218, v219
    v_cvt_pk_bf16_f32 v226, v220, v221
    v_cvt_pk_bf16_f32 v227, v222, v223
    s_nop 0
    v_permlane32_swap_b32 v224, v226
    v_permlane32_swap_b32 v225, v227
    s_nop 0
    v_permlane16_swap_b32 v224, v226
    v_permlane16_swap_b32 v225, v227
    v_accvgpr_write_b32 a36, v224
    v_accvgpr_write_b32 a37, v225
    v_accvgpr_write_b32 a38, v226
    v_accvgpr_write_b32 a39, v227
    v_accvgpr_read_b32 v216, a40
    v_accvgpr_read_b32 v217, a41
    v_accvgpr_read_b32 v218, a42
    v_accvgpr_read_b32 v219, a43
    v_accvgpr_read_b32 v220, a56
    v_accvgpr_read_b32 v221, a57
    v_accvgpr_read_b32 v222, a58
    v_accvgpr_read_b32 v223, a59
    v_pk_mul_f32 v[216:217], v[216:217], s[86:87]
    v_pk_mul_f32 v[218:219], v[218:219], s[86:87]
    v_pk_mul_f32 v[220:221], v[220:221], s[86:87]
    v_pk_mul_f32 v[222:223], v[222:223], s[86:87]
    v_cvt_pk_bf16_f32 v224, v216, v217
    v_cvt_pk_bf16_f32 v225, v218, v219
    v_cvt_pk_bf16_f32 v226, v220, v221
    v_cvt_pk_bf16_f32 v227, v222, v223
    s_nop 0
    v_permlane32_swap_b32 v224, v226
    v_permlane32_swap_b32 v225, v227
    s_nop 0
    v_permlane16_swap_b32 v224, v226
    v_permlane16_swap_b32 v225, v227
    v_accvgpr_write_b32 a40, v224
    v_accvgpr_write_b32 a41, v225
    v_accvgpr_write_b32 a42, v226
    v_accvgpr_write_b32 a43, v227
    v_accvgpr_read_b32 v216, a44
    v_accvgpr_read_b32 v217, a45
    v_accvgpr_read_b32 v218, a46
    v_accvgpr_read_b32 v219, a47
    v_accvgpr_read_b32 v220, a60
    v_accvgpr_read_b32 v221, a61
    v_accvgpr_read_b32 v222, a62
    v_accvgpr_read_b32 v223, a63
    v_pk_mul_f32 v[216:217], v[216:217], s[86:87]
    v_pk_mul_f32 v[218:219], v[218:219], s[86:87]
    v_pk_mul_f32 v[220:221], v[220:221], s[86:87]
    v_pk_mul_f32 v[222:223], v[222:223], s[86:87]
    v_cvt_pk_bf16_f32 v224, v216, v217
    v_cvt_pk_bf16_f32 v225, v218, v219
    v_cvt_pk_bf16_f32 v226, v220, v221
    v_cvt_pk_bf16_f32 v227, v222, v223
    s_nop 0
    v_permlane32_swap_b32 v224, v226
    v_permlane32_swap_b32 v225, v227
    s_nop 0
    v_permlane16_swap_b32 v224, v226
    v_permlane16_swap_b32 v225, v227
    v_accvgpr_write_b32 a44, v224
    v_accvgpr_write_b32 a45, v225
    v_accvgpr_write_b32 a46, v226
    v_accvgpr_write_b32 a47, v227
    v_accvgpr_read_b32 v216, a64
    v_accvgpr_read_b32 v217, a65
    v_accvgpr_read_b32 v218, a66
    v_accvgpr_read_b32 v219, a67
    v_accvgpr_read_b32 v220, a80
    v_accvgpr_read_b32 v221, a81
    v_accvgpr_read_b32 v222, a82
    v_accvgpr_read_b32 v223, a83
    v_pk_mul_f32 v[216:217], v[216:217], s[86:87]
    v_pk_mul_f32 v[218:219], v[218:219], s[86:87]
    v_pk_mul_f32 v[220:221], v[220:221], s[86:87]
    v_pk_mul_f32 v[222:223], v[222:223], s[86:87]
    v_cvt_pk_bf16_f32 v224, v216, v217
    v_cvt_pk_bf16_f32 v225, v218, v219
    v_cvt_pk_bf16_f32 v226, v220, v221
    v_cvt_pk_bf16_f32 v227, v222, v223
    s_nop 0
    v_permlane32_swap_b32 v224, v226
    v_permlane32_swap_b32 v225, v227
    s_nop 0
    v_permlane16_swap_b32 v224, v226
    v_permlane16_swap_b32 v225, v227
    v_accvgpr_write_b32 a64, v224
    v_accvgpr_write_b32 a65, v225
    v_accvgpr_write_b32 a66, v226
    v_accvgpr_write_b32 a67, v227
    v_accvgpr_read_b32 v216, a68
    v_accvgpr_read_b32 v217, a69
    v_accvgpr_read_b32 v218, a70
    v_accvgpr_read_b32 v219, a71
    v_accvgpr_read_b32 v220, a84
    v_accvgpr_read_b32 v221, a85
    v_accvgpr_read_b32 v222, a86
    v_accvgpr_read_b32 v223, a87
    v_pk_mul_f32 v[216:217], v[216:217], s[86:87]
    v_pk_mul_f32 v[218:219], v[218:219], s[86:87]
    v_pk_mul_f32 v[220:221], v[220:221], s[86:87]
    v_pk_mul_f32 v[222:223], v[222:223], s[86:87]
    v_cvt_pk_bf16_f32 v224, v216, v217
    v_cvt_pk_bf16_f32 v225, v218, v219
    v_cvt_pk_bf16_f32 v226, v220, v221
    v_cvt_pk_bf16_f32 v227, v222, v223
    s_nop 0
    v_permlane32_swap_b32 v224, v226
    v_permlane32_swap_b32 v225, v227
    s_nop 0
    v_permlane16_swap_b32 v224, v226
    v_permlane16_swap_b32 v225, v227
    v_accvgpr_write_b32 a68, v224
    v_accvgpr_write_b32 a69, v225
    v_accvgpr_write_b32 a70, v226
    v_accvgpr_write_b32 a71, v227
    v_accvgpr_read_b32 v216, a72
    v_accvgpr_read_b32 v217, a73
    v_accvgpr_read_b32 v218, a74
    v_accvgpr_read_b32 v219, a75
    v_accvgpr_read_b32 v220, a88
    v_accvgpr_read_b32 v221, a89
    v_accvgpr_read_b32 v222, a90
    v_accvgpr_read_b32 v223, a91
    v_pk_mul_f32 v[216:217], v[216:217], s[86:87]
    v_pk_mul_f32 v[218:219], v[218:219], s[86:87]
    v_pk_mul_f32 v[220:221], v[220:221], s[86:87]
    v_pk_mul_f32 v[222:223], v[222:223], s[86:87]
    v_cvt_pk_bf16_f32 v224, v216, v217
    v_cvt_pk_bf16_f32 v225, v218, v219
    v_cvt_pk_bf16_f32 v226, v220, v221
    v_cvt_pk_bf16_f32 v227, v222, v223
    s_nop 0
    v_permlane32_swap_b32 v224, v226
    v_permlane32_swap_b32 v225, v227
    s_nop 0
    v_permlane16_swap_b32 v224, v226
    v_permlane16_swap_b32 v225, v227
    v_accvgpr_write_b32 a72, v224
    v_accvgpr_write_b32 a73, v225
    v_accvgpr_write_b32 a74, v226
    v_accvgpr_write_b32 a75, v227
    v_accvgpr_read_b32 v216, a76
    v_accvgpr_read_b32 v217, a77
    v_accvgpr_read_b32 v218, a78
    v_accvgpr_read_b32 v219, a79
    v_accvgpr_read_b32 v220, a92
    v_accvgpr_read_b32 v221, a93
    v_accvgpr_read_b32 v222, a94
    v_accvgpr_read_b32 v223, a95
    v_pk_mul_f32 v[216:217], v[216:217], s[86:87]
    v_pk_mul_f32 v[218:219], v[218:219], s[86:87]
    v_pk_mul_f32 v[220:221], v[220:221], s[86:87]
    v_pk_mul_f32 v[222:223], v[222:223], s[86:87]
    v_cvt_pk_bf16_f32 v224, v216, v217
    v_cvt_pk_bf16_f32 v225, v218, v219
    v_cvt_pk_bf16_f32 v226, v220, v221
    v_cvt_pk_bf16_f32 v227, v222, v223
    s_nop 0
    v_permlane32_swap_b32 v224, v226
    v_permlane32_swap_b32 v225, v227
    s_nop 0
    v_permlane16_swap_b32 v224, v226
    v_permlane16_swap_b32 v225, v227
    v_accvgpr_write_b32 a76, v224
    v_accvgpr_write_b32 a77, v225
    v_accvgpr_write_b32 a78, v226
    v_accvgpr_write_b32 a79, v227
    v_accvgpr_read_b32 v216, a96
    v_accvgpr_read_b32 v217, a97
    v_accvgpr_read_b32 v218, a98
    v_accvgpr_read_b32 v219, a99
    v_accvgpr_read_b32 v220, a112
    v_accvgpr_read_b32 v221, a113
    v_accvgpr_read_b32 v222, a114
    v_accvgpr_read_b32 v223, a115
    v_pk_mul_f32 v[216:217], v[216:217], s[86:87]
    v_pk_mul_f32 v[218:219], v[218:219], s[86:87]
    v_pk_mul_f32 v[220:221], v[220:221], s[86:87]
    v_pk_mul_f32 v[222:223], v[222:223], s[86:87]
    v_cvt_pk_bf16_f32 v224, v216, v217
    v_cvt_pk_bf16_f32 v225, v218, v219
    v_cvt_pk_bf16_f32 v226, v220, v221
    v_cvt_pk_bf16_f32 v227, v222, v223
    s_nop 0
    v_permlane32_swap_b32 v224, v226
    v_permlane32_swap_b32 v225, v227
    s_nop 0
    v_permlane16_swap_b32 v224, v226
    v_permlane16_swap_b32 v225, v227
    v_accvgpr_write_b32 a96, v224
    v_accvgpr_write_b32 a97, v225
    v_accvgpr_write_b32 a98, v226
    v_accvgpr_write_b32 a99, v227
    v_accvgpr_read_b32 v216, a100
    v_accvgpr_read_b32 v217, a101
    v_accvgpr_read_b32 v218, a102
    v_accvgpr_read_b32 v219, a103
    v_accvgpr_read_b32 v220, a116
    v_accvgpr_read_b32 v221, a117
    v_accvgpr_read_b32 v222, a118
    v_accvgpr_read_b32 v223, a119
    v_pk_mul_f32 v[216:217], v[216:217], s[86:87]
    v_pk_mul_f32 v[218:219], v[218:219], s[86:87]
    v_pk_mul_f32 v[220:221], v[220:221], s[86:87]
    v_pk_mul_f32 v[222:223], v[222:223], s[86:87]
    v_cvt_pk_bf16_f32 v224, v216, v217
    v_cvt_pk_bf16_f32 v225, v218, v219
    v_cvt_pk_bf16_f32 v226, v220, v221
    v_cvt_pk_bf16_f32 v227, v222, v223
    s_nop 0
    v_permlane32_swap_b32 v224, v226
    v_permlane32_swap_b32 v225, v227
    s_nop 0
    v_permlane16_swap_b32 v224, v226
    v_permlane16_swap_b32 v225, v227
    v_accvgpr_write_b32 a100, v224
    v_accvgpr_write_b32 a101, v225
    v_accvgpr_write_b32 a102, v226
    v_accvgpr_write_b32 a103, v227
    v_accvgpr_read_b32 v216, a104
    v_accvgpr_read_b32 v217, a105
    v_accvgpr_read_b32 v218, a106
    v_accvgpr_read_b32 v219, a107
    v_accvgpr_read_b32 v220, a120
    v_accvgpr_read_b32 v221, a121
    v_accvgpr_read_b32 v222, a122
    v_accvgpr_read_b32 v223, a123
    v_pk_mul_f32 v[216:217], v[216:217], s[86:87]
    v_pk_mul_f32 v[218:219], v[218:219], s[86:87]
    v_pk_mul_f32 v[220:221], v[220:221], s[86:87]
    v_pk_mul_f32 v[222:223], v[222:223], s[86:87]
    v_cvt_pk_bf16_f32 v224, v216, v217
    v_cvt_pk_bf16_f32 v225, v218, v219
    v_cvt_pk_bf16_f32 v226, v220, v221
    v_cvt_pk_bf16_f32 v227, v222, v223
    s_nop 0
    v_permlane32_swap_b32 v224, v226
    v_permlane32_swap_b32 v225, v227
    s_nop 0
    v_permlane16_swap_b32 v224, v226
    v_permlane16_swap_b32 v225, v227
    v_accvgpr_write_b32 a104, v224
    v_accvgpr_write_b32 a105, v225
    v_accvgpr_write_b32 a106, v226
    v_accvgpr_write_b32 a107, v227
    v_accvgpr_read_b32 v216, a108
    v_accvgpr_read_b32 v217, a109
    v_accvgpr_read_b32 v218, a110
    v_accvgpr_read_b32 v219, a111
    v_accvgpr_read_b32 v220, a124
    v_accvgpr_read_b32 v221, a125
    v_accvgpr_read_b32 v222, a126
    v_accvgpr_read_b32 v223, a127
    v_pk_mul_f32 v[216:217], v[216:217], s[86:87]
    v_pk_mul_f32 v[218:219], v[218:219], s[86:87]
    v_pk_mul_f32 v[220:221], v[220:221], s[86:87]
    v_pk_mul_f32 v[222:223], v[222:223], s[86:87]
    v_cvt_pk_bf16_f32 v224, v216, v217
    v_cvt_pk_bf16_f32 v225, v218, v219
    v_cvt_pk_bf16_f32 v226, v220, v221
    v_cvt_pk_bf16_f32 v227, v222, v223
    s_nop 0
    v_permlane32_swap_b32 v224, v226
    v_permlane32_swap_b32 v225, v227
    s_nop 0
    v_permlane16_swap_b32 v224, v226
    v_permlane16_swap_b32 v225, v227
    v_accvgpr_write_b32 a108, v224
    v_accvgpr_write_b32 a109, v225
    v_accvgpr_write_b32 a110, v226
    v_accvgpr_write_b32 a111, v227
    s_add_u32 s80, s82, 32768
    buffer_store_dwordx4 v[72:75], v3, s[16:19], s80 offen offset:0 sc1
    s_add_u32 s80, s82, 32768
    buffer_store_dwordx4 v[76:79], v3, s[16:19], s80 offen offset:1024 sc1
    s_add_u32 s80, s82, 32768
    buffer_store_dwordx4 v[80:83], v3, s[16:19], s80 offen offset:2048 sc1
    s_add_u32 s80, s82, 32768
    buffer_store_dwordx4 v[84:87], v3, s[16:19], s80 offen offset:3072 sc1
    s_add_u32 s80, s82, 49152
    buffer_store_dwordx4 v[104:107], v3, s[16:19], s80 offen offset:0 sc1
    s_add_u32 s80, s82, 49152
    buffer_store_dwordx4 v[108:111], v3, s[16:19], s80 offen offset:1024 sc1
    s_add_u32 s80, s82, 49152
    buffer_store_dwordx4 v[112:115], v3, s[16:19], s80 offen offset:2048 sc1
    s_add_u32 s80, s82, 49152
    buffer_store_dwordx4 v[116:119], v3, s[16:19], s80 offen offset:3072 sc1
    v_and_b32 v188, 15, v2
    v_lshrrev_b32 v189, 4, v2
    v_add_u32 v192, 0, v189
    v_xor_b32 v192, v192, v188
    v_lshlrev_b32 v192, 4, v192
    v_lshl_add_u32 v172, v188, 8, v192
    v_add_u32 v192, 4, v189
    v_xor_b32 v192, v192, v188
    v_lshlrev_b32 v192, 4, v192
    v_lshl_add_u32 v173, v188, 8, v192
    v_add_u32 v192, 8, v189
    v_xor_b32 v192, v192, v188
    v_lshlrev_b32 v192, 4, v192
    v_lshl_add_u32 v174, v188, 8, v192
    v_add_u32 v192, 12, v189
    v_xor_b32 v192, v192, v188
    v_lshlrev_b32 v192, 4, v192
    v_lshl_add_u32 v175, v188, 8, v192
    v_lshrrev_b32 v190, 2, v188
    v_lshl_add_u32 v192, v189, 2, v190
    v_and_b32 v193, 7, v192
    v_lshlrev_b32 v192, 8, v192
    v_add_u32 v192, 0x10000, v192
    v_bfe_u32 v194, v188, 1, 1
    v_lshl_add_u32 v192, v194, 4, v192
    v_and_b32 v194, 1, v188
    v_lshl_add_u32 v192, v194, 3, v192
    v_xor_b32 v194, 0, v193
    v_lshl_add_u32 v176, v194, 5, v192
    v_xor_b32 v194, 1, v193
    v_lshl_add_u32 v177, v194, 5, v192
    v_xor_b32 v194, 2, v193
    v_lshl_add_u32 v178, v194, 5, v192
    v_xor_b32 v194, 3, v193
    v_lshl_add_u32 v179, v194, 5, v192
    v_xor_b32 v194, 4, v193
    v_lshl_add_u32 v180, v194, 5, v192
    v_xor_b32 v194, 5, v193
    v_lshl_add_u32 v181, v194, 5, v192
    v_xor_b32 v194, 6, v193
    v_lshl_add_u32 v182, v194, 5, v192
    v_xor_b32 v194, 7, v193
    v_lshl_add_u32 v183, v194, 5, v192
    s_mov_b32 s44, 40960
    s_mov_b32 s45, 32768
    s_cmp_lt_u32 s53, 4
    s_cselect_b32 s60, s30, s96
    s_cselect_b32 s61, s31, s97
    s_cselect_b32 s73, 32, 36
    s_mov_b32 s75, 144
    s_cselect_b32 s75, 128, s75
    s_mov_b32 s76, 4194304
    s_cselect_b32 s76, 33554432, s76
    s_and_b32 s77, s53, 3
    s_mul_i32 s77, s77, s73
    s_mul_i32 s74, s77, 36864
    s_add_u32 s60, s60, s74
    s_addc_u32 s61, s61, 0
    s_mul_i32 s62, s73, 36864
    s_mov_b32 s63, 0x20000
    s_mul_i32 s74, s14, s75
    s_add_u32 s74, s74, s77
    s_lshl_b32 s74, s74, 14
    s_add_u32 s74, s74, s76
    s_add_u32 s64, s10, s74
    s_addc_u32 s65, s11, 0
    s_lshl_b32 s66, s73, 14
    s_mov_b32 s67, 0x20000
    s_lshl_b32 s69, s12, 12
    s_lshr_b32 s74, s12, 1
    s_lshl_b32 s74, s74, 1
    s_add_u32 s74, s74, s12
    s_cmp_lt_u32 s53, 4
    s_cselect_b32 s74, s74, s12
    s_mul_i32 s74, s74, 36864
    s_mul_i32 s68, s55, 288
    s_add_u32 s68, s68, s74
    v_add_u32 v4, 0, v2
    v_mul_u32_u24 v5, 3641, v4
    v_lshrrev_b32 v5, 16, v5
    v_mul_u32_u24 v6, 18, v5
    v_sub_u32 v6, v4, v6
    v_mul_u32_u24 v5, 1152, v5
    v_lshl_add_u32 v219, v6, 4, v5
    v_add_u32 v4, 64, v2
    v_mul_u32_u24 v5, 3641, v4
    v_lshrrev_b32 v5, 16, v5
    v_mul_u32_u24 v6, 18, v5
    v_sub_u32 v6, v4, v6
    v_mul_u32_u24 v5, 1152, v5
    v_lshl_add_u32 v220, v6, 4, v5
    v_subrev_u32 v220, 1024, v220
    v_add_u32 v4, 128, v2
    v_mul_u32_u24 v5, 3641, v4
    v_lshrrev_b32 v5, 16, v5
    v_mul_u32_u24 v6, 18, v5
    v_sub_u32 v6, v4, v6
    v_mul_u32_u24 v5, 1152, v5
    v_lshl_add_u32 v221, v6, 4, v5
    v_subrev_u32 v221, 2048, v221
    v_add_u32 v4, 192, v2
    v_mul_u32_u24 v5, 3641, v4
    v_lshrrev_b32 v5, 16, v5
    v_mul_u32_u24 v6, 18, v5
    v_sub_u32 v6, v4, v6
    v_mul_u32_u24 v5, 1152, v5
    v_lshl_add_u32 v222, v6, 4, v5
    v_subrev_u32 v222, 3072, v222
    v_add_u32 v4, 256, v2
    v_mul_u32_u24 v5, 3641, v4
    v_lshrrev_b32 v5, 16, v5
    v_mul_u32_u24 v6, 18, v5
    v_sub_u32 v6, v4, v6
    v_mul_u32_u24 v5, 1152, v5
    v_lshl_add_u32 v223, v6, 4, v5
    v_add_u32 v4, 320, v2
    v_mul_u32_u24 v5, 3641, v4
    v_lshrrev_b32 v5, 16, v5
    v_mul_u32_u24 v6, 18, v5
    v_sub_u32 v6, v4, v6
    v_mul_u32_u24 v5, 1152, v5
    v_lshl_add_u32 v224, v6, 4, v5
    v_subrev_u32 v224, 1024, v224
    v_add_u32 v4, 384, v2
    v_mul_u32_u24 v5, 3641, v4
    v_lshrrev_b32 v5, 16, v5
    v_mul_u32_u24 v6, 18, v5
    v_sub_u32 v6, v4, v6
    v_mul_u32_u24 v5, 1152, v5
    v_lshl_add_u32 v225, v6, 4, v5
    v_subrev_u32 v225, 2048, v225
    v_add_u32 v4, 448, v2
    v_mul_u32_u24 v5, 3641, v4
    v_lshrrev_b32 v5, 16, v5
    v_mul_u32_u24 v6, 18, v5
    v_sub_u32 v6, v4, v6
    v_mul_u32_u24 v5, 1152, v5
    v_lshl_add_u32 v226, v6, 4, v5
    v_subrev_u32 v226, 3072, v226
    v_add_u32 v4, 512, v2
    v_mul_u32_u24 v5, 3641, v4
    v_lshrrev_b32 v5, 16, v5
    v_mul_u32_u24 v6, 18, v5
    v_sub_u32 v6, v4, v6
    v_mul_u32_u24 v5, 1152, v5
    v_lshl_add_u32 v227, v6, 4, v5
    s_mul_i32 s70, s12, 9216
    v_lshlrev_b32 v232, 3, v2
    v_and_b32 v4, 15, v2
    v_lshrrev_b32 v5, 4, v2
    v_lshrrev_b32 v6, 2, v4
    v_lshl_add_u32 v6, v5, 2, v6
    v_mul_u32_u24 v6, 288, v6
    v_and_b32 v4, 3, v4
    v_lshl_add_u32 v228, v4, 3, v6
    s_lshl_b32 s74, s14, 4
    s_lshl_b32 s75, s12, 2
    s_add_u32 s74, s74, s75
    s_lshl_b32 s74, s74, 2
    s_add_u32 s74, s74, s55
    s_mul_i32 s74, s74, 36864
    s_add_u32 s74, s74, 50331648
    s_lshl_b32 s75, s53, 12
    s_add_u32 s71, s74, s75
    s_lshl_b32 s75, s53, 9
    s_add_u32 s72, s74, s75
    s_add_u32 s72, s72, 32768
    s_lshl_b32 s22, s54, 2
    s_add_u32 s22, s22, s12
    s_mul_i32 s20, s73, 288
    s_mul_i32 s20, s20, s22
    s_waitcnt vmcnt(16)
    s_barrier
    ds_read_b128 a[80:83], v172 offset:24576
    ds_read_b128 a[84:87], v173 offset:24576
    ds_read_b128 a[88:91], v174 offset:24576
    ds_read_b128 a[92:95], v175 offset:24576
    ds_read_b128 a[112:115], v172 offset:28672
    ds_read_b128 a[116:119], v173 offset:28672
    ds_read_b128 a[120:123], v174 offset:28672
    ds_read_b128 a[124:127], v175 offset:28672
    v_mov_b32 v128, 0x3f803f80
    v_mov_b32 v129, 0x3f803f80
    v_mov_b32 v130, 0x3f803f80
    v_mov_b32 v131, 0x3f803f80
    v_mov_b32 v168, 0
    v_mov_b32 v169, 0
    v_mov_b32 v170, 0
    v_mov_b32 v171, 0
    s_waitcnt lgkmcnt(0)
    v_mfma_f32_16x16x32_bf16 v[8:11], a[80:83], a[0:3], 0
    v_mfma_f32_16x16x32_bf16 v[16:19], a[80:83], a[4:7], 0
    v_mfma_f32_16x16x32_bf16 v[24:27], a[80:83], a[8:11], 0
    v_mfma_f32_16x16x32_bf16 v[32:35], a[80:83], a[12:15], 0
    v_mfma_f32_16x16x32_bf16 v[8:11], a[84:87], a[32:35], v[8:11]
    v_mfma_f32_16x16x32_bf16 v[16:19], a[84:87], a[36:39], v[16:19]
    v_mfma_f32_16x16x32_bf16 v[24:27], a[84:87], a[40:43], v[24:27]
    v_mfma_f32_16x16x32_bf16 v[32:35], a[84:87], a[44:47], v[32:35]
    v_mfma_f32_16x16x32_bf16 v[8:11], a[88:91], a[64:67], v[8:11]
    v_mfma_f32_16x16x32_bf16 v[16:19], a[88:91], a[68:71], v[16:19]
    v_mfma_f32_16x16x32_bf16 v[24:27], a[88:91], a[72:75], v[24:27]
    v_mfma_f32_16x16x32_bf16 v[32:35], a[88:91], a[76:79], v[32:35]
    v_mfma_f32_16x16x32_bf16 v[8:11], a[92:95], a[96:99], v[8:11]
    v_mfma_f32_16x16x32_bf16 v[16:19], a[92:95], a[100:103], v[16:19]
    v_mfma_f32_16x16x32_bf16 v[24:27], a[92:95], a[104:107], v[24:27]
    v_mfma_f32_16x16x32_bf16 v[32:35], a[92:95], a[108:111], v[32:35]
    v_mfma_f32_16x16x32_bf16 v[12:15], a[112:115], a[0:3], 0
    v_mfma_f32_16x16x32_bf16 v[20:23], a[112:115], a[4:7], 0
    v_mfma_f32_16x16x32_bf16 v[28:31], a[112:115], a[8:11], 0
    v_mfma_f32_16x16x32_bf16 v[36:39], a[112:115], a[12:15], 0
    v_mfma_f32_16x16x32_bf16 v[12:15], a[116:119], a[32:35], v[12:15]
    v_mfma_f32_16x16x32_bf16 v[20:23], a[116:119], a[36:39], v[20:23]
    v_mfma_f32_16x16x32_bf16 v[28:31], a[116:119], a[40:43], v[28:31]
    v_mfma_f32_16x16x32_bf16 v[36:39], a[116:119], a[44:47], v[36:39]
    v_mfma_f32_16x16x32_bf16 v[12:15], a[120:123], a[64:67], v[12:15]
    v_mfma_f32_16x16x32_bf16 v[20:23], a[120:123], a[68:71], v[20:23]
    v_mfma_f32_16x16x32_bf16 v[28:31], a[120:123], a[72:75], v[28:31]
    v_mfma_f32_16x16x32_bf16 v[36:39], a[120:123], a[76:79], v[36:39]
    v_mfma_f32_16x16x32_bf16 v[12:15], a[124:127], a[96:99], v[12:15]
    v_mfma_f32_16x16x32_bf16 v[20:23], a[124:127], a[100:103], v[20:23]
    v_mfma_f32_16x16x32_bf16 v[28:31], a[124:127], a[104:107], v[28:31]
    v_mfma_f32_16x16x32_bf16 v[36:39], a[124:127], a[108:111], v[36:39]
    s_nop 7
    v_max3_f32 v190, v8, v9, v10
    v_max3_f32 v190, v190, v11, v12
    v_max3_f32 v190, v190, v13, v14
    v_max_f32 v190, v190, v15
    v_mov_b32 v188, v190
    s_nop 1
    v_permlane32_swap_b32 v188, v190
    s_nop 1
    v_max_f32 v190, v188, v190
    v_mov_b32 v188, v190
    s_nop 1
    v_permlane16_swap_b32 v188, v190
    s_nop 1
    v_max_f32 v190, v188, v190
    v_sub_f32 v104, 0, v190
    v_sub_f32 v105, 0, v190
    v_sub_f32 v106, 0, v190
    v_sub_f32 v107, 0, v190
    v_sub_f32 v8, v8, v190
    v_sub_f32 v9, v9, v190
    v_sub_f32 v10, v10, v190
    v_sub_f32 v11, v11, v190
    v_sub_f32 v12, v12, v190
    v_sub_f32 v13, v13, v190
    v_sub_f32 v14, v14, v190
    v_sub_f32 v15, v15, v190
    v_max3_f32 v190, v16, v17, v18
    v_max3_f32 v190, v190, v19, v20
    v_max3_f32 v190, v190, v21, v22
    v_max_f32 v190, v190, v23
    v_mov_b32 v188, v190
    s_nop 1
    v_permlane32_swap_b32 v188, v190
    s_nop 1
    v_max_f32 v190, v188, v190
    v_mov_b32 v188, v190
    s_nop 1
    v_permlane16_swap_b32 v188, v190
    s_nop 1
    v_max_f32 v190, v188, v190
    v_sub_f32 v108, 0, v190
    v_sub_f32 v109, 0, v190
    v_sub_f32 v110, 0, v190
    v_sub_f32 v111, 0, v190
    v_sub_f32 v16, v16, v190
    v_sub_f32 v17, v17, v190
    v_sub_f32 v18, v18, v190
    v_sub_f32 v19, v19, v190
    v_sub_f32 v20, v20, v190
    v_sub_f32 v21, v21, v190
    v_sub_f32 v22, v22, v190
    v_sub_f32 v23, v23, v190
    v_max3_f32 v190, v24, v25, v26
    v_max3_f32 v190, v190, v27, v28
    v_max3_f32 v190, v190, v29, v30
    v_max_f32 v190, v190, v31
    v_mov_b32 v188, v190
    s_nop 1
    v_permlane32_swap_b32 v188, v190
    s_nop 1
    v_max_f32 v190, v188, v190
    v_mov_b32 v188, v190
    s_nop 1
    v_permlane16_swap_b32 v188, v190
    s_nop 1
    v_max_f32 v190, v188, v190
    v_sub_f32 v112, 0, v190
    v_sub_f32 v113, 0, v190
    v_sub_f32 v114, 0, v190
    v_sub_f32 v115, 0, v190
    v_sub_f32 v24, v24, v190
    v_sub_f32 v25, v25, v190
    v_sub_f32 v26, v26, v190
    v_sub_f32 v27, v27, v190
    v_sub_f32 v28, v28, v190
    v_sub_f32 v29, v29, v190
    v_sub_f32 v30, v30, v190
    v_sub_f32 v31, v31, v190
    v_max3_f32 v190, v32, v33, v34
    v_max3_f32 v190, v190, v35, v36
    v_max3_f32 v190, v190, v37, v38
    v_max_f32 v190, v190, v39
    v_mov_b32 v188, v190
    s_nop 1
    v_permlane32_swap_b32 v188, v190
    s_nop 1
    v_max_f32 v190, v188, v190
    v_mov_b32 v188, v190
    s_nop 1
    v_permlane16_swap_b32 v188, v190
    s_nop 1
    v_max_f32 v190, v188, v190
    v_sub_f32 v116, 0, v190
    v_sub_f32 v117, 0, v190
    v_sub_f32 v118, 0, v190
    v_sub_f32 v119, 0, v190
    v_sub_f32 v32, v32, v190
    v_sub_f32 v33, v33, v190
    v_sub_f32 v34, v34, v190
    v_sub_f32 v35, v35, v190
    v_sub_f32 v36, v36, v190
    v_sub_f32 v37, v37, v190
    v_sub_f32 v38, v38, v190
    v_sub_f32 v39, v39, v190
    v_exp_f32 v132, v8
    v_exp_f32 v133, v9
    v_exp_f32 v134, v10
    v_exp_f32 v135, v11
    s_nop 1
    buffer_store_dwordx2 v[208:209], v1, s[16:19], s83 offen offset:0 sc1
    buffer_store_dwordx2 v[210:211], v1, s[16:19], s83 offen offset:1024 sc1
    buffer_store_dwordx2 v[212:213], v1, s[16:19], s83 offen offset:2048 sc1
    buffer_store_dwordx2 v[214:215], v1, s[16:19], s83 offen offset:3072 sc1
    s_getpc_b64 s[84:85]
mk_pc2:
    s_lshl_b32 s15, s54, 2
    s_add_u32 s15, s15, s12
    s_lshl_b32 s15, s15, 10
    v_add_u32 v206, s15, v3
    v_min_u32 v206, mk_end-mk_pc2-16, v206
    v_mov_b32 v207, s85
    v_add_co_u32 v206, vcc, s84, v206
    s_nop 1
    v_addc_co_u32 v207, vcc, 0, v207, vcc
    s_nop 0
    v_exp_f32 v136, v12
    s_nop 0
    s_barrier
    ds_read_b128 a[80:83], v172 offset:32768
    v_cvt_pk_bf16_f32 v72, v132, v133
    s_nop 0
    v_exp_f32 v137, v13
    s_nop 0
    ds_read_b128 a[84:87], v173 offset:32768
    v_cvt_pk_bf16_f32 v73, v134, v135
    s_nop 0
    s_add_u32 m0, s46, 0
    v_exp_f32 v138, v14
    s_nop 0
    buffer_load_dwordx4 v247, s[36:39], s44 offen offset:0 nt lds
    v_cvt_pk_bf16_f32 v74, v136, v137
    s_nop 0
    v_exp_f32 v139, v15
    s_nop 0
    ds_read_b128 a[88:91], v174 offset:32768
    v_cvt_pk_bf16_f32 v75, v138, v139
    s_nop 0
    v_exp_f32 v140, v24
    s_nop 0
    ds_read_b128 a[92:95], v175 offset:32768
    v_mfma_f32_16x16x32_bf16 v[120:123], v[128:131], v[72:75], 0
    ds_read_b128 a[112:115], v172 offset:36864
    s_nop 0
    v_exp_f32 v141, v25
    s_nop 0
    buffer_load_dwordx4 v248, s[36:39], s44 offen offset:1024 nt lds
    v_add_f32 v166, v140, v141
    s_nop 0
    v_exp_f32 v142, v26
    s_nop 0
    ds_read_b128 a[116:119], v173 offset:36864
    v_add_f32 v166, v166, v142
    s_nop 0
    v_exp_f32 v143, v27
    s_nop 0
    s_nop 0
    v_add_f32 v166, v166, v143
    v_cvt_pk_bf16_f32 v80, v140, v141
    s_nop 0
    v_exp_f32 v144, v28
    s_nop 0
    ds_read_b128 a[120:123], v174 offset:36864
    v_add_f32 v166, v166, v144
    s_nop 0
    v_exp_f32 v145, v29
    s_nop 0
    s_nop 0
    v_add_f32 v166, v166, v145
    v_cvt_pk_bf16_f32 v81, v142, v143
    s_nop 0
    v_exp_f32 v146, v30
    s_nop 0
    ds_read_b128 a[124:127], v175 offset:36864
    v_add_f32 v166, v166, v146
    s_nop 0
    v_exp_f32 v147, v31
    s_nop 0
    s_nop 0
    v_add_f32 v166, v166, v147
    v_cvt_pk_bf16_f32 v82, v144, v145
    s_nop 0
    v_exp_f32 v148, v16
    s_nop 0
    ds_read_b64_tr_b16 a[16:17], v176 offset:0
    v_cvt_pk_bf16_f32 v83, v146, v147
    s_nop 0
    v_exp_f32 v149, v17
    s_nop 0
    buffer_load_dwordx4 v249, s[36:39], s44 offen offset:2048 nt lds
    v_cvt_pk_bf16_f32 v76, v148, v149
    s_nop 0
    v_exp_f32 v150, v18
    s_nop 0
    ds_read_b64_tr_b16 a[18:19], v176 offset:4096
    s_nop 0
    v_exp_f32 v151, v19
    s_nop 0
    s_waitcnt lgkmcnt(9)
    ds_read_b64_tr_b16 a[20:21], v177 offset:0
    v_cvt_pk_bf16_f32 v77, v150, v151
    v_mfma_f32_16x16x32_bf16 v[40:43], a[80:83], a[0:3], v[104:107]
    v_exp_f32 v152, v20
    v_mfma_f32_16x16x32_bf16 v[56:59], a[80:83], a[8:11], v[112:115]
    buffer_load_dwordx4 v250, s[36:39], s44 offen offset:3072 nt lds
    v_mfma_f32_16x16x32_bf16 v[48:51], a[80:83], a[4:7], v[108:111]
    s_add_u32 s44, s44, 16384
    v_exp_f32 v153, v21
    v_mfma_f32_16x16x32_bf16 v[64:67], a[80:83], a[12:15], v[116:119]
    s_waitcnt lgkmcnt(9)
    ds_read_b64_tr_b16 a[22:23], v177 offset:4096
    v_cvt_pk_bf16_f32 v78, v152, v153
    v_mfma_f32_16x16x32_bf16 v[40:43], a[84:87], a[32:35], v[40:43]
    v_exp_f32 v154, v22
    v_mfma_f32_16x16x32_bf16 v[56:59], a[84:87], a[40:43], v[56:59]
    ds_read_b64_tr_b16 a[24:25], v178 offset:0
    v_mfma_f32_16x16x32_bf16 v[48:51], a[84:87], a[36:39], v[48:51]
    v_exp_f32 v155, v23
    v_mfma_f32_16x16x32_bf16 v[64:67], a[84:87], a[44:47], v[64:67]
    s_waitcnt lgkmcnt(10)
    ds_read_b64_tr_b16 a[26:27], v178 offset:4096
    v_cvt_pk_bf16_f32 v79, v154, v155
    v_mfma_f32_16x16x32_bf16 v[40:43], a[88:91], a[64:67], v[40:43]
    v_exp_f32 v156, v32
    v_mfma_f32_16x16x32_bf16 v[56:59], a[88:91], a[72:75], v[56:59]
    ds_read_b64_tr_b16 a[28:29], v179 offset:0
    v_mfma_f32_16x16x32_bf16 v[124:127], v[128:131], v[76:79], 0
    ds_read_b64_tr_b16 a[30:31], v179 offset:4096
    v_mfma_f32_16x16x32_bf16 v[48:51], a[88:91], a[68:71], v[48:51]
    v_exp_f32 v157, v33
    v_mfma_f32_16x16x32_bf16 v[64:67], a[88:91], a[76:79], v[64:67]
    s_waitcnt lgkmcnt(12)
    ds_read_b64_tr_b16 a[48:49], v180 offset:0
    v_add_f32 v167, v156, v157
    v_mfma_f32_16x16x32_bf16 v[40:43], a[92:95], a[96:99], v[40:43]
    v_exp_f32 v158, v34
    v_mfma_f32_16x16x32_bf16 v[56:59], a[92:95], a[104:107], v[56:59]
    ds_read_b64_tr_b16 a[50:51], v180 offset:4096
    v_add_f32 v167, v167, v158
    v_mfma_f32_16x16x32_bf16 v[48:51], a[92:95], a[100:103], v[48:51]
    v_exp_f32 v159, v35
    v_mfma_f32_16x16x32_bf16 v[64:67], a[92:95], a[108:111], v[64:67]
    s_waitcnt lgkmcnt(13)
    ds_read_b64_tr_b16 a[52:53], v181 offset:0
    v_add_f32 v167, v167, v159
    v_mfma_f32_16x16x32_bf16 v[44:47], a[112:115], a[0:3], v[104:107]
    v_exp_f32 v160, v36
    v_mfma_f32_16x16x32_bf16 v[60:63], a[112:115], a[8:11], v[112:115]
    ds_read_b64_tr_b16 a[54:55], v181 offset:4096
    v_add_f32 v167, v167, v160
    v_mfma_f32_16x16x32_bf16 v[52:55], a[112:115], a[4:7], v[108:111]
    v_exp_f32 v161, v37
    v_mfma_f32_16x16x32_bf16 v[68:71], a[112:115], a[12:15], v[116:119]
    s_waitcnt lgkmcnt(14)
    ds_read_b64_tr_b16 a[56:57], v182 offset:0
    v_add_f32 v167, v167, v161
    v_mfma_f32_16x16x32_bf16 v[44:47], a[116:119], a[32:35], v[44:47]
    v_exp_f32 v162, v38
    v_mfma_f32_16x16x32_bf16 v[60:63], a[116:119], a[40:43], v[60:63]
    ds_read_b64_tr_b16 a[58:59], v182 offset:4096
    v_add_f32 v167, v167, v162
    v_mfma_f32_16x16x32_bf16 v[52:55], a[116:119], a[36:39], v[52:55]
    v_exp_f32 v163, v39
    v_mfma_f32_16x16x32_bf16 v[68:71], a[116:119], a[44:47], v[68:71]
    s_waitcnt lgkmcnt(15)
    ds_read_b64_tr_b16 a[60:61], v183 offset:0
    v_max3_f32 v184, v120, v124, v166
    v_mfma_f32_16x16x32_bf16 v[44:47], a[120:123], a[64:67], v[44:47]
    v_exp_f32 v132, v40
    v_mfma_f32_16x16x32_bf16 v[60:63], a[120:123], a[72:75], v[60:63]
    s_nop 0
    v_add_f32 v167, v167, v163
    v_max_f32 v184, v184, v167
    v_mfma_f32_16x16x32_bf16 v[52:55], a[120:123], a[68:71], v[52:55]
    v_exp_f32 v133, v41
    v_mfma_f32_16x16x32_bf16 v[68:71], a[120:123], a[76:79], v[68:71]
    s_waitcnt lgkmcnt(15)
    v_cmp_lt_f32 vcc, s48, v184
    v_cvt_pk_bf16_f32 v88, v132, v133
    v_mfma_f32_16x16x32_bf16 v[44:47], a[124:127], a[96:99], v[44:47]
    v_exp_f32 v134, v42
    v_mfma_f32_16x16x32_bf16 v[60:63], a[124:127], a[104:107], v[60:63]
    s_nop 0
    v_cvt_pk_bf16_f32 v84, v156, v157
    v_cvt_pk_bf16_f32 v85, v158, v159
    v_mfma_f32_16x16x32_bf16 v[52:55], a[124:127], a[100:103], v[52:55]
    s_cbranch_vccnz mk_stubp0
mk_okp0:
    v_exp_f32 v135, v43
    v_mfma_f32_16x16x32_bf16 v[68:71], a[124:127], a[108:111], v[68:71]
    s_waitcnt lgkmcnt(13)
    ds_read_b64_tr_b16 a[62:63], v183 offset:4096
    v_cvt_pk_bf16_f32 v89, v134, v135
    v_mfma_f32_16x16x32_bf16 a[128:131], a[16:19], v[72:75], 0
    s_waitcnt lgkmcnt(12)
    v_exp_f32 v136, v44
    v_mfma_f32_16x16x32_bf16 a[132:135], a[20:23], v[72:75], 0
    s_waitcnt lgkmcnt(10)
    ds_read_b128 a[80:83], v172 offset:40960
    v_add_f32 v168, v168, v120
    v_mfma_f32_16x16x32_bf16 a[136:139], a[24:27], v[72:75], 0
    s_waitcnt lgkmcnt(9)
    v_exp_f32 v137, v45
    v_mfma_f32_16x16x32_bf16 a[140:143], a[28:31], v[72:75], 0
    s_waitcnt lgkmcnt(7)
    ds_read_b128 a[84:87], v173 offset:40960
    v_cvt_pk_bf16_f32 v90, v136, v137
    v_mfma_f32_16x16x32_bf16 a[144:147], a[48:51], v[72:75], 0
    s_add_u32 m0, s47, 32768
    s_waitcnt lgkmcnt(6)
    v_exp_f32 v138, v46
    v_mfma_f32_16x16x32_bf16 a[148:151], a[52:55], v[72:75], 0
    s_waitcnt lgkmcnt(4)
    buffer_load_dwordx4 v251, s[40:43], s45 offen offset:0 nt lds
    v_add_f32 v170, v170, v166
    v_mfma_f32_16x16x32_bf16 a[152:155], a[56:59], v[72:75], 0
    s_waitcnt lgkmcnt(2)
    v_exp_f32 v139, v47
    v_mfma_f32_16x16x32_bf16 a[156:159], a[60:63], v[72:75], 0
    ds_read_b128 a[88:91], v174 offset:40960
    v_cvt_pk_bf16_f32 v91, v138, v139
    v_mfma_f32_16x16x32_bf16 a[192:195], a[16:19], v[80:83], 0
    v_exp_f32 v140, v56
    v_mfma_f32_16x16x32_bf16 a[196:199], a[20:23], v[80:83], 0
    ds_read_b128 a[92:95], v175 offset:40960
    v_cvt_pk_bf16_f32 v86, v160, v161
    v_mfma_f32_16x16x32_bf16 v[120:123], v[128:131], v[88:91], 0
    ds_read_b128 a[112:115], v172 offset:45056
    v_cvt_pk_bf16_f32 v87, v162, v163
    v_mfma_f32_16x16x32_bf16 a[200:203], a[24:27], v[80:83], 0
    v_exp_f32 v141, v57
    v_mfma_f32_16x16x32_bf16 a[204:207], a[28:31], v[80:83], 0
    buffer_load_dwordx4 v252, s[40:43], s45 offen offset:1024 nt lds
    v_add_f32 v166, v140, v141
    v_mfma_f32_16x16x32_bf16 a[208:211], a[48:51], v[80:83], 0
    v_exp_f32 v142, v58
    v_mfma_f32_16x16x32_bf16 a[212:215], a[52:55], v[80:83], 0
    ds_read_b128 a[116:119], v173 offset:45056
    v_add_f32 v166, v166, v142
    v_mfma_f32_16x16x32_bf16 a[216:219], a[56:59], v[80:83], 0
    v_exp_f32 v143, v59
    v_mfma_f32_16x16x32_bf16 a[220:223], a[60:63], v[80:83], 0
    s_nop 0
    v_add_f32 v166, v166, v143
    v_add_f32 v169, v169, v124
    v_mfma_f32_16x16x32_bf16 a[160:163], a[16:19], v[76:79], 0
    v_exp_f32 v144, v60
    v_mfma_f32_16x16x32_bf16 a[164:167], a[20:23], v[76:79], 0
    ds_read_b128 a[120:123], v174 offset:45056
    v_add_f32 v166, v166, v144
    v_mfma_f32_16x16x32_bf16 a[168:171], a[24:27], v[76:79], 0
    v_exp_f32 v145, v61
    v_mfma_f32_16x16x32_bf16 a[172:175], a[28:31], v[76:79], 0
    s_nop 0
    v_add_f32 v166, v166, v145
    v_add_f32 v171, v171, v167
    v_mfma_f32_16x16x32_bf16 a[176:179], a[48:51], v[76:79], 0
    v_exp_f32 v146, v62
    v_mfma_f32_16x16x32_bf16 a[180:183], a[52:55], v[76:79], 0
    ds_read_b128 a[124:127], v175 offset:45056
    v_add_f32 v166, v166, v146
    v_mfma_f32_16x16x32_bf16 a[184:187], a[56:59], v[76:79], 0
    v_exp_f32 v147, v63
    v_mfma_f32_16x16x32_bf16 a[188:191], a[60:63], v[76:79], 0
    s_nop 0
    v_add_f32 v166, v166, v147
    v_cvt_pk_bf16_f32 v96, v140, v141
    v_mfma_f32_16x16x32_bf16 a[224:227], a[16:19], v[84:87], 0
    v_exp_f32 v148, v48
    v_mfma_f32_16x16x32_bf16 a[228:231], a[20:23], v[84:87], 0
    ds_read_b64_tr_b16 a[16:17], v176 offset:8192
    v_cvt_pk_bf16_f32 v97, v142, v143
    v_mfma_f32_16x16x32_bf16 a[232:235], a[24:27], v[84:87], 0
    v_exp_f32 v149, v49
    v_mfma_f32_16x16x32_bf16 a[236:239], a[28:31], v[84:87], 0
    buffer_load_dwordx4 v251, s[40:43], s45 offen offset:2048 nt lds
    v_cvt_pk_bf16_f32 v92, v148, v149
    v_mfma_f32_16x16x32_bf16 a[240:243], a[48:51], v[84:87], 0
    v_exp_f32 v150, v50
    v_mfma_f32_16x16x32_bf16 a[244:247], a[52:55], v[84:87], 0
    ds_read_b64_tr_b16 a[18:19], v176 offset:12288
    v_cvt_pk_bf16_f32 v98, v144, v145
    v_mfma_f32_16x16x32_bf16 a[248:251], a[56:59], v[84:87], 0
    v_exp_f32 v151, v51
    v_mfma_f32_16x16x32_bf16 a[252:255], a[60:63], v[84:87], 0
    s_waitcnt lgkmcnt(9)
    ds_read_b64_tr_b16 a[20:21], v177 offset:8192
    v_cvt_pk_bf16_f32 v93, v150, v151
    v_mfma_f32_16x16x32_bf16 v[8:11], a[80:83], a[0:3], v[104:107]
    v_exp_f32 v152, v52
    v_mfma_f32_16x16x32_bf16 v[24:27], a[80:83], a[8:11], v[112:115]
    buffer_load_dwordx4 v252, s[40:43], s45 offen offset:3072 nt lds
    v_cvt_pk_bf16_f32 v99, v146, v147
    v_mfma_f32_16x16x32_bf16 v[16:19], a[80:83], a[4:7], v[108:111]
    s_add_u32 s45, s45, 16384
    v_exp_f32 v153, v53
    v_mfma_f32_16x16x32_bf16 v[32:35], a[80:83], a[12:15], v[116:119]
    s_waitcnt lgkmcnt(9)
    ds_read_b64_tr_b16 a[22:23], v177 offset:12288
    v_cvt_pk_bf16_f32 v94, v152, v153
    v_mfma_f32_16x16x32_bf16 v[8:11], a[84:87], a[32:35], v[8:11]
    v_exp_f32 v154, v54
    v_mfma_f32_16x16x32_bf16 v[24:27], a[84:87], a[40:43], v[24:27]
    ds_read_b64_tr_b16 a[24:25], v178 offset:8192
    v_mfma_f32_16x16x32_bf16 v[16:19], a[84:87], a[36:39], v[16:19]
    v_exp_f32 v155, v55
    v_mfma_f32_16x16x32_bf16 v[32:35], a[84:87], a[44:47], v[32:35]
    s_waitcnt lgkmcnt(10)
    ds_read_b64_tr_b16 a[26:27], v178 offset:12288
    v_cvt_pk_bf16_f32 v95, v154, v155
    v_mfma_f32_16x16x32_bf16 v[8:11], a[88:91], a[64:67], v[8:11]
    v_exp_f32 v156, v64
    v_mfma_f32_16x16x32_bf16 v[24:27], a[88:91], a[72:75], v[24:27]
    ds_read_b64_tr_b16 a[28:29], v179 offset:8192
    v_mfma_f32_16x16x32_bf16 v[124:127], v[128:131], v[92:95], 0
    ds_read_b64_tr_b16 a[30:31], v179 offset:12288
    v_mfma_f32_16x16x32_bf16 v[16:19], a[88:91], a[68:71], v[16:19]
    v_exp_f32 v157, v65
    v_mfma_f32_16x16x32_bf16 v[32:35], a[88:91], a[76:79], v[32:35]
    s_waitcnt lgkmcnt(12)
    ds_read_b64_tr_b16 a[48:49], v180 offset:8192
    v_add_f32 v167, v156, v157
    v_mfma_f32_16x16x32_bf16 v[8:11], a[92:95], a[96:99], v[8:11]
    v_exp_f32 v158, v66
    v_mfma_f32_16x16x32_bf16 v[24:27], a[92:95], a[104:107], v[24:27]
    ds_read_b64_tr_b16 a[50:51], v180 offset:12288
    v_add_f32 v167, v167, v158
    v_mfma_f32_16x16x32_bf16 v[16:19], a[92:95], a[100:103], v[16:19]
    v_exp_f32 v159, v67
    v_mfma_f32_16x16x32_bf16 v[32:35], a[92:95], a[108:111], v[32:35]
    s_waitcnt lgkmcnt(13)
    ds_read_b64_tr_b16 a[52:53], v181 offset:8192
    v_add_f32 v167, v167, v159
    v_mfma_f32_16x16x32_bf16 v[12:15], a[112:115], a[0:3], v[104:107]
    v_exp_f32 v160, v68
    v_mfma_f32_16x16x32_bf16 v[28:31], a[112:115], a[8:11], v[112:115]
    ds_read_b64_tr_b16 a[54:55], v181 offset:12288
    v_add_f32 v167, v167, v160
    v_mfma_f32_16x16x32_bf16 v[20:23], a[112:115], a[4:7], v[108:111]
    v_exp_f32 v161, v69
    v_mfma_f32_16x16x32_bf16 v[36:39], a[112:115], a[12:15], v[116:119]
    s_waitcnt lgkmcnt(14)
    ds_read_b64_tr_b16 a[56:57], v182 offset:8192
    v_add_f32 v167, v167, v161
    v_mfma_f32_16x16x32_bf16 v[12:15], a[116:119], a[32:35], v[12:15]
    v_exp_f32 v162, v70
    v_mfma_f32_16x16x32_bf16 v[28:31], a[116:119], a[40:43], v[28:31]
    ds_read_b64_tr_b16 a[58:59], v182 offset:12288
    v_add_f32 v167, v167, v162
    v_mfma_f32_16x16x32_bf16 v[20:23], a[116:119], a[36:39], v[20:23]
    v_exp_f32 v163, v71
    v_mfma_f32_16x16x32_bf16 v[36:39], a[116:119], a[44:47], v[36:39]
    s_waitcnt lgkmcnt(15)
    ds_read_b64_tr_b16 a[60:61], v183 offset:8192
    v_max3_f32 v184, v120, v124, v166
    v_mfma_f32_16x16x32_bf16 v[12:15], a[120:123], a[64:67], v[12:15]
    v_exp_f32 v132, v8
    v_mfma_f32_16x16x32_bf16 v[28:31], a[120:123], a[72:75], v[28:31]
    s_nop 0
    v_add_f32 v167, v167, v163
    v_max_f32 v184, v184, v167
    v_mfma_f32_16x16x32_bf16 v[20:23], a[120:123], a[68:71], v[20:23]
    v_exp_f32 v133, v9
    v_mfma_f32_16x16x32_bf16 v[36:39], a[120:123], a[76:79], v[36:39]
    s_waitcnt lgkmcnt(15)
    v_cmp_lt_f32 vcc, s48, v184
    v_cvt_pk_bf16_f32 v72, v132, v133
    v_mfma_f32_16x16x32_bf16 v[12:15], a[124:127], a[96:99], v[12:15]
    v_exp_f32 v134, v10
    v_mfma_f32_16x16x32_bf16 v[28:31], a[124:127], a[104:107], v[28:31]
    s_nop 0
    v_cvt_pk_bf16_f32 v100, v156, v157
    v_cvt_pk_bf16_f32 v101, v158, v159
    v_mfma_f32_16x16x32_bf16 v[20:23], a[124:127], a[100:103], v[20:23]
    s_cbranch_vccnz mk_stubp1
mk_okp1:
    v_exp_f32 v135, v11
    v_mfma_f32_16x16x32_bf16 v[36:39], a[124:127], a[108:111], v[36:39]
    s_waitcnt lgkmcnt(13)
    ds_read_b64_tr_b16 a[62:63], v183 offset:12288
    v_cvt_pk_bf16_f32 v73, v134, v135
    s_mov_b32 s49, 7
    .p2align 6
mk_loop:
    v_mfma_f32_16x16x32_bf16 a[128:131], a[16:19], v[88:91], a[128:131]
    s_waitcnt lgkmcnt(12)
    v_exp_f32 v136, v12
    v_mfma_f32_16x16x32_bf16 a[132:135], a[20:23], v[88:91], a[132:135]
    s_waitcnt vmcnt(9)
    s_barrier
    s_waitcnt lgkmcnt(10)
    ds_read_b128 a[80:83], v172 offset:49152
    v_add_f32 v168, v168, v120
    v_mfma_f32_16x16x32_bf16 a[136:139], a[24:27], v[88:91], a[136:139]
    s_waitcnt lgkmcnt(9)
    v_exp_f32 v137, v13
    v_mfma_f32_16x16x32_bf16 a[140:143], a[28:31], v[88:91], a[140:143]
    s_waitcnt lgkmcnt(7)
    ds_read_b128 a[84:87], v173 offset:49152
    v_cvt_pk_bf16_f32 v74, v136, v137
    v_mfma_f32_16x16x32_bf16 a[144:147], a[48:51], v[88:91], a[144:147]
    s_add_u32 m0, s46, 16384
    s_waitcnt lgkmcnt(6)
    v_exp_f32 v138, v14
    v_mfma_f32_16x16x32_bf16 a[148:151], a[52:55], v[88:91], a[148:151]
    s_waitcnt lgkmcnt(4)
    buffer_load_dwordx4 v247, s[36:39], s44 offen offset:0 nt lds
    v_add_f32 v170, v170, v166
    v_mfma_f32_16x16x32_bf16 a[152:155], a[56:59], v[88:91], a[152:155]
    s_waitcnt lgkmcnt(2)
    v_exp_f32 v139, v15
    v_mfma_f32_16x16x32_bf16 a[156:159], a[60:63], v[88:91], a[156:159]
    ds_read_b128 a[88:91], v174 offset:49152
    v_cvt_pk_bf16_f32 v75, v138, v139
    v_mfma_f32_16x16x32_bf16 a[192:195], a[16:19], v[96:99], a[192:195]
    v_exp_f32 v140, v24
    v_mfma_f32_16x16x32_bf16 a[196:199], a[20:23], v[96:99], a[196:199]
    ds_read_b128 a[92:95], v175 offset:49152
    v_cvt_pk_bf16_f32 v102, v160, v161
    v_mfma_f32_16x16x32_bf16 v[120:123], v[128:131], v[72:75], 0
    ds_read_b128 a[112:115], v172 offset:53248
    v_cvt_pk_bf16_f32 v103, v162, v163
    v_mfma_f32_16x16x32_bf16 a[200:203], a[24:27], v[96:99], a[200:203]
    v_exp_f32 v141, v25
    v_mfma_f32_16x16x32_bf16 a[204:207], a[28:31], v[96:99], a[204:207]
    buffer_load_dwordx4 v248, s[36:39], s44 offen offset:1024 nt lds
    v_add_f32 v166, v140, v141
    v_mfma_f32_16x16x32_bf16 a[208:211], a[48:51], v[96:99], a[208:211]
    v_exp_f32 v142, v26
    v_mfma_f32_16x16x32_bf16 a[212:215], a[52:55], v[96:99], a[212:215]
    ds_read_b128 a[116:119], v173 offset:53248
    v_add_f32 v166, v166, v142
    v_mfma_f32_16x16x32_bf16 a[216:219], a[56:59], v[96:99], a[216:219]
    v_exp_f32 v143, v27
    v_mfma_f32_16x16x32_bf16 a[220:223], a[60:63], v[96:99], a[220:223]
    s_nop 0
    v_add_f32 v166, v166, v143
    v_add_f32 v169, v169, v124
    v_mfma_f32_16x16x32_bf16 a[160:163], a[16:19], v[92:95], a[160:163]
    v_exp_f32 v144, v28
    v_mfma_f32_16x16x32_bf16 a[164:167], a[20:23], v[92:95], a[164:167]
    ds_read_b128 a[120:123], v174 offset:53248
    v_add_f32 v166, v166, v144
    v_mfma_f32_16x16x32_bf16 a[168:171], a[24:27], v[92:95], a[168:171]
    v_exp_f32 v145, v29
    v_mfma_f32_16x16x32_bf16 a[172:175], a[28:31], v[92:95], a[172:175]
    s_nop 0
    v_add_f32 v166, v166, v145
    v_add_f32 v171, v171, v167
    v_mfma_f32_16x16x32_bf16 a[176:179], a[48:51], v[92:95], a[176:179]
    v_exp_f32 v146, v30
    v_mfma_f32_16x16x32_bf16 a[180:183], a[52:55], v[92:95], a[180:183]
    ds_read_b128 a[124:127], v175 offset:53248
    v_add_f32 v166, v166, v146
    v_mfma_f32_16x16x32_bf16 a[184:187], a[56:59], v[92:95], a[184:187]
    v_exp_f32 v147, v31
    v_mfma_f32_16x16x32_bf16 a[188:191], a[60:63], v[92:95], a[188:191]
    s_nop 0
    v_add_f32 v166, v166, v147
    v_cvt_pk_bf16_f32 v80, v140, v141
    v_mfma_f32_16x16x32_bf16 a[224:227], a[16:19], v[100:103], a[224:227]
    v_exp_f32 v148, v16
    v_mfma_f32_16x16x32_bf16 a[228:231], a[20:23], v[100:103], a[228:231]
    ds_read_b64_tr_b16 a[16:17], v176 offset:16384
    v_cvt_pk_bf16_f32 v81, v142, v143
    v_mfma_f32_16x16x32_bf16 a[232:235], a[24:27], v[100:103], a[232:235]
    v_exp_f32 v149, v17
    v_mfma_f32_16x16x32_bf16 a[236:239], a[28:31], v[100:103], a[236:239]
    buffer_load_dwordx4 v249, s[36:39], s44 offen offset:2048 nt lds
    v_cvt_pk_bf16_f32 v76, v148, v149
    v_mfma_f32_16x16x32_bf16 a[240:243], a[48:51], v[100:103], a[240:243]
    v_exp_f32 v150, v18
    v_mfma_f32_16x16x32_bf16 a[244:247], a[52:55], v[100:103], a[244:247]
    ds_read_b64_tr_b16 a[18:19], v176 offset:20480
    v_cvt_pk_bf16_f32 v82, v144, v145
    v_mfma_f32_16x16x32_bf16 a[248:251], a[56:59], v[100:103], a[248:251]
    v_exp_f32 v151, v19
    v_mfma_f32_16x16x32_bf16 a[252:255], a[60:63], v[100:103], a[252:255]
    s_waitcnt lgkmcnt(9)
    ds_read_b64_tr_b16 a[20:21], v177 offset:16384
    v_cvt_pk_bf16_f32 v77, v150, v151
    v_mfma_f32_16x16x32_bf16 v[40:43], a[80:83], a[0:3], v[104:107]
    v_exp_f32 v152, v20
    v_mfma_f32_16x16x32_bf16 v[56:59], a[80:83], a[8:11], v[112:115]
    buffer_load_dwordx4 v250, s[36:39], s44 offen offset:3072 nt lds
    v_cvt_pk_bf16_f32 v83, v146, v147
    v_mfma_f32_16x16x32_bf16 v[48:51], a[80:83], a[4:7], v[108:111]
    s_add_u32 s44, s44, 16384
    v_exp_f32 v153, v21
    v_mfma_f32_16x16x32_bf16 v[64:67], a[80:83], a[12:15], v[116:119]
    s_waitcnt lgkmcnt(9)
    ds_read_b64_tr_b16 a[22:23], v177 offset:20480
    v_cvt_pk_bf16_f32 v78, v152, v153
    v_mfma_f32_16x16x32_bf16 v[40:43], a[84:87], a[32:35], v[40:43]
    v_exp_f32 v154, v22
    v_mfma_f32_16x16x32_bf16 v[56:59], a[84:87], a[40:43], v[56:59]
    ds_read_b64_tr_b16 a[24:25], v178 offset:16384
    v_mfma_f32_16x16x32_bf16 v[48:51], a[84:87], a[36:39], v[48:51]
    v_exp_f32 v155, v23
    v_mfma_f32_16x16x32_bf16 v[64:67], a[84:87], a[44:47], v[64:67]
    s_waitcnt lgkmcnt(10)
    ds_read_b64_tr_b16 a[26:27], v178 offset:20480
    v_cvt_pk_bf16_f32 v79, v154, v155
    v_mfma_f32_16x16x32_bf16 v[40:43], a[88:91], a[64:67], v[40:43]
    v_exp_f32 v156, v32
    v_mfma_f32_16x16x32_bf16 v[56:59], a[88:91], a[72:75], v[56:59]
    ds_read_b64_tr_b16 a[28:29], v179 offset:16384
    v_mfma_f32_16x16x32_bf16 v[124:127], v[128:131], v[76:79], 0
    ds_read_b64_tr_b16 a[30:31], v179 offset:20480
    v_mfma_f32_16x16x32_bf16 v[48:51], a[88:91], a[68:71], v[48:51]
    v_exp_f32 v157, v33
    v_mfma_f32_16x16x32_bf16 v[64:67], a[88:91], a[76:79], v[64:67]
    s_waitcnt lgkmcnt(12)
    ds_read_b64_tr_b16 a[48:49], v180 offset:16384
    v_add_f32 v167, v156, v157
    v_mfma_f32_16x16x32_bf16 v[40:43], a[92:95], a[96:99], v[40:43]
    v_exp_f32 v158, v34
    v_mfma_f32_16x16x32_bf16 v[56:59], a[92:95], a[104:107], v[56:59]
    ds_read_b64_tr_b16 a[50:51], v180 offset:20480
    v_add_f32 v167, v167, v158
    v_mfma_f32_16x16x32_bf16 v[48:51], a[92:95], a[100:103], v[48:51]
    v_exp_f32 v159, v35
    v_mfma_f32_16x16x32_bf16 v[64:67], a[92:95], a[108:111], v[64:67]
    s_waitcnt lgkmcnt(13)
    ds_read_b64_tr_b16 a[52:53], v181 offset:16384
    v_add_f32 v167, v167, v159
    v_mfma_f32_16x16x32_bf16 v[44:47], a[112:115], a[0:3], v[104:107]
    v_exp_f32 v160, v36
    v_mfma_f32_16x16x32_bf16 v[60:63], a[112:115], a[8:11], v[112:115]
    ds_read_b64_tr_b16 a[54:55], v181 offset:20480
    v_add_f32 v167, v167, v160
    v_mfma_f32_16x16x32_bf16 v[52:55], a[112:115], a[4:7], v[108:111]
    v_exp_f32 v161, v37
    v_mfma_f32_16x16x32_bf16 v[68:71], a[112:115], a[12:15], v[116:119]
    s_waitcnt lgkmcnt(14)
    ds_read_b64_tr_b16 a[56:57], v182 offset:16384
    v_add_f32 v167, v167, v161
    v_mfma_f32_16x16x32_bf16 v[44:47], a[116:119], a[32:35], v[44:47]
    v_exp_f32 v162, v38
    v_mfma_f32_16x16x32_bf16 v[60:63], a[116:119], a[40:43], v[60:63]
    ds_read_b64_tr_b16 a[58:59], v182 offset:20480
    v_add_f32 v167, v167, v162
    v_mfma_f32_16x16x32_bf16 v[52:55], a[116:119], a[36:39], v[52:55]
    v_exp_f32 v163, v39
    v_mfma_f32_16x16x32_bf16 v[68:71], a[116:119], a[44:47], v[68:71]
    s_waitcnt lgkmcnt(15)
    ds_read_b64_tr_b16 a[60:61], v183 offset:16384
    v_max3_f32 v184, v120, v124, v166
    v_mfma_f32_16x16x32_bf16 v[44:47], a[120:123], a[64:67], v[44:47]
    v_exp_f32 v132, v40
    v_mfma_f32_16x16x32_bf16 v[60:63], a[120:123], a[72:75], v[60:63]
    s_nop 0
    v_add_f32 v167, v167, v163
    v_max_f32 v184, v184, v167
    v_mfma_f32_16x16x32_bf16 v[52:55], a[120:123], a[68:71], v[52:55]
    v_exp_f32 v133, v41
    v_mfma_f32_16x16x32_bf16 v[68:71], a[120:123], a[76:79], v[68:71]
    s_waitcnt lgkmcnt(15)
    v_cmp_lt_f32 vcc, s48, v184
    v_cvt_pk_bf16_f32 v88, v132, v133
    v_mfma_f32_16x16x32_bf16 v[44:47], a[124:127], a[96:99], v[44:47]
    v_exp_f32 v134, v42
    v_mfma_f32_16x16x32_bf16 v[60:63], a[124:127], a[104:107], v[60:63]
    s_nop 0
    v_cvt_pk_bf16_f32 v84, v156, v157
    v_cvt_pk_bf16_f32 v85, v158, v159
    v_mfma_f32_16x16x32_bf16 v[52:55], a[124:127], a[100:103], v[52:55]
    s_cbranch_vccnz mk_stubl2
mk_okl2:
    v_exp_f32 v135, v43
    v_mfma_f32_16x16x32_bf16 v[68:71], a[124:127], a[108:111], v[68:71]
    s_waitcnt lgkmcnt(13)
    ds_read_b64_tr_b16 a[62:63], v183 offset:20480
    v_cvt_pk_bf16_f32 v89, v134, v135
    v_mfma_f32_16x16x32_bf16 a[128:131], a[16:19], v[72:75], a[128:131]
    s_waitcnt lgkmcnt(12)
    v_exp_f32 v136, v44
    v_mfma_f32_16x16x32_bf16 a[132:135], a[20:23], v[72:75], a[132:135]
    s_waitcnt lgkmcnt(10)
    ds_read_b128 a[80:83], v172 offset:57344
    v_add_f32 v168, v168, v120
    v_mfma_f32_16x16x32_bf16 a[136:139], a[24:27], v[72:75], a[136:139]
    s_waitcnt lgkmcnt(9)
    v_exp_f32 v137, v45
    v_mfma_f32_16x16x32_bf16 a[140:143], a[28:31], v[72:75], a[140:143]
    s_waitcnt lgkmcnt(7)
    ds_read_b128 a[84:87], v173 offset:57344
    v_cvt_pk_bf16_f32 v90, v136, v137
    v_mfma_f32_16x16x32_bf16 a[144:147], a[48:51], v[72:75], a[144:147]
    s_add_u32 m0, s47, 49152
    s_waitcnt lgkmcnt(6)
    v_exp_f32 v138, v46
    v_mfma_f32_16x16x32_bf16 a[148:151], a[52:55], v[72:75], a[148:151]
    s_waitcnt lgkmcnt(4)
    buffer_load_dwordx4 v251, s[40:43], s45 offen offset:0 nt lds
    v_add_f32 v170, v170, v166
    v_mfma_f32_16x16x32_bf16 a[152:155], a[56:59], v[72:75], a[152:155]
    s_waitcnt lgkmcnt(2)
    v_exp_f32 v139, v47
    v_mfma_f32_16x16x32_bf16 a[156:159], a[60:63], v[72:75], a[156:159]
    ds_read_b128 a[88:91], v174 offset:57344
    v_cvt_pk_bf16_f32 v91, v138, v139
    v_mfma_f32_16x16x32_bf16 a[192:195], a[16:19], v[80:83], a[192:195]
    v_exp_f32 v140, v56
    v_mfma_f32_16x16x32_bf16 a[196:199], a[20:23], v[80:83], a[196:199]
    ds_read_b128 a[92:95], v175 offset:57344
    v_cvt_pk_bf16_f32 v86, v160, v161
    v_mfma_f32_16x16x32_bf16 v[120:123], v[128:131], v[88:91], 0
    ds_read_b128 a[112:115], v172 offset:61440
    v_cvt_pk_bf16_f32 v87, v162, v163
    v_mfma_f32_16x16x32_bf16 a[200:203], a[24:27], v[80:83], a[200:203]
    v_exp_f32 v141, v57
    v_mfma_f32_16x16x32_bf16 a[204:207], a[28:31], v[80:83], a[204:207]
    buffer_load_dwordx4 v252, s[40:43], s45 offen offset:1024 nt lds
    v_add_f32 v166, v140, v141
    v_mfma_f32_16x16x32_bf16 a[208:211], a[48:51], v[80:83], a[208:211]
    v_exp_f32 v142, v58
    v_mfma_f32_16x16x32_bf16 a[212:215], a[52:55], v[80:83], a[212:215]
    ds_read_b128 a[116:119], v173 offset:61440
    v_add_f32 v166, v166, v142
    v_mfma_f32_16x16x32_bf16 a[216:219], a[56:59], v[80:83], a[216:219]
    v_exp_f32 v143, v59
    v_mfma_f32_16x16x32_bf16 a[220:223], a[60:63], v[80:83], a[220:223]
    s_nop 0
    v_add_f32 v166, v166, v143
    v_add_f32 v169, v169, v124
    v_mfma_f32_16x16x32_bf16 a[160:163], a[16:19], v[76:79], a[160:163]
    v_exp_f32 v144, v60
    v_mfma_f32_16x16x32_bf16 a[164:167], a[20:23], v[76:79], a[164:167]
    ds_read_b128 a[120:123], v174 offset:61440
    v_add_f32 v166, v166, v144
    v_mfma_f32_16x16x32_bf16 a[168:171], a[24:27], v[76:79], a[168:171]
    v_exp_f32 v145, v61
    v_mfma_f32_16x16x32_bf16 a[172:175], a[28:31], v[76:79], a[172:175]
    s_nop 0
    v_add_f32 v166, v166, v145
    v_add_f32 v171, v171, v167
    v_mfma_f32_16x16x32_bf16 a[176:179], a[48:51], v[76:79], a[176:179]
    v_exp_f32 v146, v62
    v_mfma_f32_16x16x32_bf16 a[180:183], a[52:55], v[76:79], a[180:183]
    ds_read_b128 a[124:127], v175 offset:61440
    v_add_f32 v166, v166, v146
    v_mfma_f32_16x16x32_bf16 a[184:187], a[56:59], v[76:79], a[184:187]
    v_exp_f32 v147, v63
    v_mfma_f32_16x16x32_bf16 a[188:191], a[60:63], v[76:79], a[188:191]
    buffer_load_dwordx4 v251, s[40:43], s45 offen offset:2048 nt lds
    v_add_f32 v166, v166, v147
    v_mfma_f32_16x16x32_bf16 a[224:227], a[16:19], v[84:87], a[224:227]
    v_exp_f32 v148, v48
    v_mfma_f32_16x16x32_bf16 a[228:231], a[20:23], v[84:87], a[228:231]
    ds_read_b64_tr_b16 a[16:17], v176 offset:24576
    v_cvt_pk_bf16_f32 v96, v140, v141
    v_mfma_f32_16x16x32_bf16 a[232:235], a[24:27], v[84:87], a[232:235]
    v_exp_f32 v149, v49
    v_mfma_f32_16x16x32_bf16 a[236:239], a[28:31], v[84:87], a[236:239]
    buffer_load_dwordx4 v252, s[40:43], s45 offen offset:3072 nt lds
    v_cvt_pk_bf16_f32 v92, v148, v149
    v_mfma_f32_16x16x32_bf16 a[240:243], a[48:51], v[84:87], a[240:243]
    s_add_u32 s45, s45, 16384
    v_exp_f32 v150, v50
    v_mfma_f32_16x16x32_bf16 a[244:247], a[52:55], v[84:87], a[244:247]
    ds_read_b64_tr_b16 a[18:19], v176 offset:28672
    v_cvt_pk_bf16_f32 v97, v142, v143
    v_mfma_f32_16x16x32_bf16 a[248:251], a[56:59], v[84:87], a[248:251]
    v_exp_f32 v151, v51
    v_mfma_f32_16x16x32_bf16 a[252:255], a[60:63], v[84:87], a[252:255]
    s_waitcnt lgkmcnt(9)
    ds_read_b64_tr_b16 a[20:21], v177 offset:24576
    v_cvt_pk_bf16_f32 v93, v150, v151
    v_mfma_f32_16x16x32_bf16 v[8:11], a[80:83], a[0:3], v[104:107]
    v_exp_f32 v152, v52
    v_mfma_f32_16x16x32_bf16 v[24:27], a[80:83], a[8:11], v[112:115]
    buffer_load_dwordx4 v[240:243], v3, s[60:63], s20 offen
    v_cvt_pk_bf16_f32 v98, v144, v145
    v_mfma_f32_16x16x32_bf16 v[16:19], a[80:83], a[4:7], v[108:111]
    s_add_u32 s20, s20, 1024
    v_exp_f32 v153, v53
    v_mfma_f32_16x16x32_bf16 v[32:35], a[80:83], a[12:15], v[116:119]
    s_waitcnt lgkmcnt(9)
    ds_read_b64_tr_b16 a[22:23], v177 offset:28672
    v_cvt_pk_bf16_f32 v94, v152, v153
    v_mfma_f32_16x16x32_bf16 v[8:11], a[84:87], a[32:35], v[8:11]
    v_exp_f32 v154, v54
    v_mfma_f32_16x16x32_bf16 v[24:27], a[84:87], a[40:43], v[24:27]
    ds_read_b64_tr_b16 a[24:25], v178 offset:24576
    v_cvt_pk_bf16_f32 v99, v146, v147
    v_mfma_f32_16x16x32_bf16 v[16:19], a[84:87], a[36:39], v[16:19]
    v_exp_f32 v155, v55
    v_mfma_f32_16x16x32_bf16 v[32:35], a[84:87], a[44:47], v[32:35]
    s_waitcnt lgkmcnt(10)
    ds_read_b64_tr_b16 a[26:27], v178 offset:28672
    v_cvt_pk_bf16_f32 v95, v154, v155
    v_mfma_f32_16x16x32_bf16 v[8:11], a[88:91], a[64:67], v[8:11]
    v_exp_f32 v156, v64
    v_mfma_f32_16x16x32_bf16 v[24:27], a[88:91], a[72:75], v[24:27]
    ds_read_b64_tr_b16 a[28:29], v179 offset:24576
    v_mfma_f32_16x16x32_bf16 v[124:127], v[128:131], v[92:95], 0
    ds_read_b64_tr_b16 a[30:31], v179 offset:28672
    v_mfma_f32_16x16x32_bf16 v[16:19], a[88:91], a[68:71], v[16:19]
    v_exp_f32 v157, v65
    v_mfma_f32_16x16x32_bf16 v[32:35], a[88:91], a[76:79], v[32:35]
    s_waitcnt lgkmcnt(12)
    ds_read_b64_tr_b16 a[48:49], v180 offset:24576
    v_add_f32 v167, v156, v157
    v_mfma_f32_16x16x32_bf16 v[8:11], a[92:95], a[96:99], v[8:11]
    v_exp_f32 v158, v66
    v_mfma_f32_16x16x32_bf16 v[24:27], a[92:95], a[104:107], v[24:27]
    ds_read_b64_tr_b16 a[50:51], v180 offset:28672
    v_add_f32 v167, v167, v158
    v_mfma_f32_16x16x32_bf16 v[16:19], a[92:95], a[100:103], v[16:19]
    v_exp_f32 v159, v67
    v_mfma_f32_16x16x32_bf16 v[32:35], a[92:95], a[108:111], v[32:35]
    s_waitcnt lgkmcnt(13)
    ds_read_b64_tr_b16 a[52:53], v181 offset:24576
    v_add_f32 v167, v167, v159
    v_mfma_f32_16x16x32_bf16 v[12:15], a[112:115], a[0:3], v[104:107]
    v_exp_f32 v160, v68
    v_mfma_f32_16x16x32_bf16 v[28:31], a[112:115], a[8:11], v[112:115]
    ds_read_b64_tr_b16 a[54:55], v181 offset:28672
    v_add_f32 v167, v167, v160
    v_mfma_f32_16x16x32_bf16 v[20:23], a[112:115], a[4:7], v[108:111]
    v_exp_f32 v161, v69
    v_mfma_f32_16x16x32_bf16 v[36:39], a[112:115], a[12:15], v[116:119]
    s_waitcnt lgkmcnt(14)
    ds_read_b64_tr_b16 a[56:57], v182 offset:24576
    v_add_f32 v167, v167, v161
    v_mfma_f32_16x16x32_bf16 v[12:15], a[116:119], a[32:35], v[12:15]
    v_exp_f32 v162, v70
    v_mfma_f32_16x16x32_bf16 v[28:31], a[116:119], a[40:43], v[28:31]
    ds_read_b64_tr_b16 a[58:59], v182 offset:28672
    v_add_f32 v167, v167, v162
    v_mfma_f32_16x16x32_bf16 v[20:23], a[116:119], a[36:39], v[20:23]
    v_exp_f32 v163, v71
    v_mfma_f32_16x16x32_bf16 v[36:39], a[116:119], a[44:47], v[36:39]
    s_waitcnt lgkmcnt(15)
    ds_read_b64_tr_b16 a[60:61], v183 offset:24576
    v_max3_f32 v184, v120, v124, v166
    v_mfma_f32_16x16x32_bf16 v[12:15], a[120:123], a[64:67], v[12:15]
    v_exp_f32 v132, v8
    v_mfma_f32_16x16x32_bf16 v[28:31], a[120:123], a[72:75], v[28:31]
    s_nop 0
    v_add_f32 v167, v167, v163
    v_max_f32 v184, v184, v167
    v_mfma_f32_16x16x32_bf16 v[20:23], a[120:123], a[68:71], v[20:23]
    v_exp_f32 v133, v9
    v_mfma_f32_16x16x32_bf16 v[36:39], a[120:123], a[76:79], v[36:39]
    s_waitcnt lgkmcnt(15)
    v_cmp_lt_f32 vcc, s48, v184
    v_cvt_pk_bf16_f32 v72, v132, v133
    v_mfma_f32_16x16x32_bf16 v[12:15], a[124:127], a[96:99], v[12:15]
    v_exp_f32 v134, v10
    v_mfma_f32_16x16x32_bf16 v[28:31], a[124:127], a[104:107], v[28:31]
    s_nop 0
    v_cvt_pk_bf16_f32 v100, v156, v157
    v_cvt_pk_bf16_f32 v101, v158, v159
    v_mfma_f32_16x16x32_bf16 v[20:23], a[124:127], a[100:103], v[20:23]
    s_cbranch_vccnz mk_stubl3
mk_okl3:
    v_exp_f32 v135, v11
    v_mfma_f32_16x16x32_bf16 v[36:39], a[124:127], a[108:111], v[36:39]
    s_waitcnt lgkmcnt(13)
    ds_read_b64_tr_b16 a[62:63], v183 offset:28672
    v_cvt_pk_bf16_f32 v73, v134, v135
    v_mfma_f32_16x16x32_bf16 a[128:131], a[16:19], v[88:91], a[128:131]
    s_waitcnt lgkmcnt(12)
    v_exp_f32 v136, v12
    v_mfma_f32_16x16x32_bf16 a[132:135], a[20:23], v[88:91], a[132:135]
    s_waitcnt vmcnt(9)
    s_barrier
    s_waitcnt lgkmcnt(10)
    ds_read_b128 a[80:83], v172 offset:0
    v_add_f32 v168, v168, v120
    v_mfma_f32_16x16x32_bf16 a[136:139], a[24:27], v[88:91], a[136:139]
    s_waitcnt lgkmcnt(9)
    v_exp_f32 v137, v13
    v_mfma_f32_16x16x32_bf16 a[140:143], a[28:31], v[88:91], a[140:143]
    s_waitcnt lgkmcnt(7)
    buffer_store_dword v254, off, s[16:19], s56 sc1
    ds_read_b128 a[84:87], v173 offset:0
    v_cvt_pk_bf16_f32 v74, v136, v137
    v_mfma_f32_16x16x32_bf16 a[144:147], a[48:51], v[88:91], a[144:147]
    s_add_u32 m0, s46, 32768
    s_waitcnt lgkmcnt(6)
    v_exp_f32 v138, v14
    v_mfma_f32_16x16x32_bf16 a[148:151], a[52:55], v[88:91], a[148:151]
    s_waitcnt lgkmcnt(4)
    buffer_load_dwordx4 v247, s[36:39], s44 offen offset:0 nt lds
    v_add_f32 v170, v170, v166
    v_mfma_f32_16x16x32_bf16 a[152:155], a[56:59], v[88:91], a[152:155]
    s_waitcnt lgkmcnt(2)
    v_exp_f32 v139, v15
    v_mfma_f32_16x16x32_bf16 a[156:159], a[60:63], v[88:91], a[156:159]
    ds_read_b128 a[88:91], v174 offset:0
    v_cvt_pk_bf16_f32 v75, v138, v139
    v_mfma_f32_16x16x32_bf16 a[192:195], a[16:19], v[96:99], a[192:195]
    v_exp_f32 v140, v24
    v_mfma_f32_16x16x32_bf16 a[196:199], a[20:23], v[96:99], a[196:199]
    ds_read_b128 a[92:95], v175 offset:0
    v_cvt_pk_bf16_f32 v102, v160, v161
    v_mfma_f32_16x16x32_bf16 v[120:123], v[128:131], v[72:75], 0
    ds_read_b128 a[112:115], v172 offset:4096
    v_cvt_pk_bf16_f32 v103, v162, v163
    v_mfma_f32_16x16x32_bf16 a[200:203], a[24:27], v[96:99], a[200:203]
    v_exp_f32 v141, v25
    v_mfma_f32_16x16x32_bf16 a[204:207], a[28:31], v[96:99], a[204:207]
    buffer_load_dwordx4 v248, s[36:39], s44 offen offset:1024 nt lds
    v_add_f32 v166, v140, v141
    v_mfma_f32_16x16x32_bf16 a[208:211], a[48:51], v[96:99], a[208:211]
    v_exp_f32 v142, v26
    v_mfma_f32_16x16x32_bf16 a[212:215], a[52:55], v[96:99], a[212:215]
    ds_read_b128 a[116:119], v173 offset:4096
    v_add_f32 v166, v166, v142
    v_mfma_f32_16x16x32_bf16 a[216:219], a[56:59], v[96:99], a[216:219]
    v_exp_f32 v143, v27
    v_mfma_f32_16x16x32_bf16 a[220:223], a[60:63], v[96:99], a[220:223]
    s_nop 0
    v_add_f32 v166, v166, v143
    v_add_f32 v169, v169, v124
    v_mfma_f32_16x16x32_bf16 a[160:163], a[16:19], v[92:95], a[160:163]
    v_exp_f32 v144, v28
    v_mfma_f32_16x16x32_bf16 a[164:167], a[20:23], v[92:95], a[164:167]
    ds_read_b128 a[120:123], v174 offset:4096
    v_add_f32 v166, v166, v144
    v_mfma_f32_16x16x32_bf16 a[168:171], a[24:27], v[92:95], a[168:171]
    v_exp_f32 v145, v29
    v_mfma_f32_16x16x32_bf16 a[172:175], a[28:31], v[92:95], a[172:175]
    s_nop 0
    v_add_f32 v166, v166, v145
    v_add_f32 v171, v171, v167
    v_mfma_f32_16x16x32_bf16 a[176:179], a[48:51], v[92:95], a[176:179]
    v_exp_f32 v146, v30
    v_mfma_f32_16x16x32_bf16 a[180:183], a[52:55], v[92:95], a[180:183]
    ds_read_b128 a[124:127], v175 offset:4096
    v_add_f32 v166, v166, v146
    v_mfma_f32_16x16x32_bf16 a[184:187], a[56:59], v[92:95], a[184:187]
    v_exp_f32 v147, v31
    v_mfma_f32_16x16x32_bf16 a[188:191], a[60:63], v[92:95], a[188:191]
    s_nop 0
    v_add_f32 v166, v166, v147
    v_cvt_pk_bf16_f32 v80, v140, v141
    v_mfma_f32_16x16x32_bf16 a[224:227], a[16:19], v[100:103], a[224:227]
    v_exp_f32 v148, v16
    v_mfma_f32_16x16x32_bf16 a[228:231], a[20:23], v[100:103], a[228:231]
    ds_read_b64_tr_b16 a[16:17], v176 offset:32768
    v_cvt_pk_bf16_f32 v81, v142, v143
    v_mfma_f32_16x16x32_bf16 a[232:235], a[24:27], v[100:103], a[232:235]
    v_exp_f32 v149, v17
    v_mfma_f32_16x16x32_bf16 a[236:239], a[28:31], v[100:103], a[236:239]
    buffer_load_dwordx4 v249, s[36:39], s44 offen offset:2048 nt lds
    v_cvt_pk_bf16_f32 v76, v148, v149
    v_mfma_f32_16x16x32_bf16 a[240:243], a[48:51], v[100:103], a[240:243]
    v_exp_f32 v150, v18
    v_mfma_f32_16x16x32_bf16 a[244:247], a[52:55], v[100:103], a[244:247]
    ds_read_b64_tr_b16 a[18:19], v176 offset:36864
    v_cvt_pk_bf16_f32 v82, v144, v145
    v_mfma_f32_16x16x32_bf16 a[248:251], a[56:59], v[100:103], a[248:251]
    v_exp_f32 v151, v19
    v_mfma_f32_16x16x32_bf16 a[252:255], a[60:63], v[100:103], a[252:255]
    s_waitcnt lgkmcnt(9)
    ds_read_b64_tr_b16 a[20:21], v177 offset:32768
    v_cvt_pk_bf16_f32 v77, v150, v151
    v_mfma_f32_16x16x32_bf16 v[40:43], a[80:83], a[0:3], v[104:107]
    v_exp_f32 v152, v20
    v_mfma_f32_16x16x32_bf16 v[56:59], a[80:83], a[8:11], v[112:115]
    buffer_load_dwordx4 v250, s[36:39], s44 offen offset:3072 nt lds
    v_cvt_pk_bf16_f32 v83, v146, v147
    v_mfma_f32_16x16x32_bf16 v[48:51], a[80:83], a[4:7], v[108:111]
    s_add_u32 s44, s44, 16384
    v_exp_f32 v153, v21
    v_mfma_f32_16x16x32_bf16 v[64:67], a[80:83], a[12:15], v[116:119]
    s_waitcnt lgkmcnt(9)
    ds_read_b64_tr_b16 a[22:23], v177 offset:36864
    v_cvt_pk_bf16_f32 v78, v152, v153
    v_mfma_f32_16x16x32_bf16 v[40:43], a[84:87], a[32:35], v[40:43]
    v_exp_f32 v154, v22
    v_mfma_f32_16x16x32_bf16 v[56:59], a[84:87], a[40:43], v[56:59]
    ds_read_b64_tr_b16 a[24:25], v178 offset:32768
    v_mfma_f32_16x16x32_bf16 v[48:51], a[84:87], a[36:39], v[48:51]
    v_exp_f32 v155, v23
    v_mfma_f32_16x16x32_bf16 v[64:67], a[84:87], a[44:47], v[64:67]
    s_waitcnt lgkmcnt(10)
    ds_read_b64_tr_b16 a[26:27], v178 offset:36864
    v_cvt_pk_bf16_f32 v79, v154, v155
    v_mfma_f32_16x16x32_bf16 v[40:43], a[88:91], a[64:67], v[40:43]
    v_exp_f32 v156, v32
    v_mfma_f32_16x16x32_bf16 v[56:59], a[88:91], a[72:75], v[56:59]
    ds_read_b64_tr_b16 a[28:29], v179 offset:32768
    v_mfma_f32_16x16x32_bf16 v[124:127], v[128:131], v[76:79], 0
    ds_read_b64_tr_b16 a[30:31], v179 offset:36864
    v_mfma_f32_16x16x32_bf16 v[48:51], a[88:91], a[68:71], v[48:51]
    v_exp_f32 v157, v33
    v_mfma_f32_16x16x32_bf16 v[64:67], a[88:91], a[76:79], v[64:67]
    s_waitcnt lgkmcnt(12)
    ds_read_b64_tr_b16 a[48:49], v180 offset:32768
    v_add_f32 v167, v156, v157
    v_mfma_f32_16x16x32_bf16 v[40:43], a[92:95], a[96:99], v[40:43]
    v_exp_f32 v158, v34
    v_mfma_f32_16x16x32_bf16 v[56:59], a[92:95], a[104:107], v[56:59]
    ds_read_b64_tr_b16 a[50:51], v180 offset:36864
    v_add_f32 v167, v167, v158
    v_mfma_f32_16x16x32_bf16 v[48:51], a[92:95], a[100:103], v[48:51]
    v_exp_f32 v159, v35
    v_mfma_f32_16x16x32_bf16 v[64:67], a[92:95], a[108:111], v[64:67]
    s_waitcnt lgkmcnt(13)
    ds_read_b64_tr_b16 a[52:53], v181 offset:32768
    v_add_f32 v167, v167, v159
    v_mfma_f32_16x16x32_bf16 v[44:47], a[112:115], a[0:3], v[104:107]
    v_exp_f32 v160, v36
    v_mfma_f32_16x16x32_bf16 v[60:63], a[112:115], a[8:11], v[112:115]
    ds_read_b64_tr_b16 a[54:55], v181 offset:36864
    v_add_f32 v167, v167, v160
    v_mfma_f32_16x16x32_bf16 v[52:55], a[112:115], a[4:7], v[108:111]
    v_exp_f32 v161, v37
    v_mfma_f32_16x16x32_bf16 v[68:71], a[112:115], a[12:15], v[116:119]
    s_waitcnt lgkmcnt(14)
    ds_read_b64_tr_b16 a[56:57], v182 offset:32768
    v_add_f32 v167, v167, v161
    v_mfma_f32_16x16x32_bf16 v[44:47], a[116:119], a[32:35], v[44:47]
    v_exp_f32 v162, v38
    v_mfma_f32_16x16x32_bf16 v[60:63], a[116:119], a[40:43], v[60:63]
    ds_read_b64_tr_b16 a[58:59], v182 offset:36864
    v_add_f32 v167, v167, v162
    v_mfma_f32_16x16x32_bf16 v[52:55], a[116:119], a[36:39], v[52:55]
    v_exp_f32 v163, v39
    v_mfma_f32_16x16x32_bf16 v[68:71], a[116:119], a[44:47], v[68:71]
    s_waitcnt lgkmcnt(15)
    ds_read_b64_tr_b16 a[60:61], v183 offset:32768
    v_max3_f32 v184, v120, v124, v166
    v_mfma_f32_16x16x32_bf16 v[44:47], a[120:123], a[64:67], v[44:47]
    v_exp_f32 v132, v40
    v_mfma_f32_16x16x32_bf16 v[60:63], a[120:123], a[72:75], v[60:63]
    s_nop 0
    v_add_f32 v167, v167, v163
    v_max_f32 v184, v184, v167
    v_mfma_f32_16x16x32_bf16 v[52:55], a[120:123], a[68:71], v[52:55]
    v_exp_f32 v133, v41
    v_mfma_f32_16x16x32_bf16 v[68:71], a[120:123], a[76:79], v[68:71]
    s_waitcnt lgkmcnt(15)
    v_cmp_lt_f32 vcc, s48, v184
    v_cvt_pk_bf16_f32 v88, v132, v133
    v_mfma_f32_16x16x32_bf16 v[44:47], a[124:127], a[96:99], v[44:47]
    v_exp_f32 v134, v42
    v_mfma_f32_16x16x32_bf16 v[60:63], a[124:127], a[104:107], v[60:63]
    s_nop 0
    v_cvt_pk_bf16_f32 v84, v156, v157
    v_cvt_pk_bf16_f32 v85, v158, v159
    v_mfma_f32_16x16x32_bf16 v[52:55], a[124:127], a[100:103], v[52:55]
    s_cbranch_vccnz mk_stubl4
mk_okl4:
    v_exp_f32 v135, v43
    v_mfma_f32_16x16x32_bf16 v[68:71], a[124:127], a[108:111], v[68:71]
    s_waitcnt lgkmcnt(13)
    ds_read_b64_tr_b16 a[62:63], v183 offset:36864
    v_cvt_pk_bf16_f32 v89, v134, v135
    v_mfma_f32_16x16x32_bf16 a[128:131], a[16:19], v[72:75], a[128:131]
    s_waitcnt lgkmcnt(12)
    v_exp_f32 v136, v44
    v_mfma_f32_16x16x32_bf16 a[132:135], a[20:23], v[72:75], a[132:135]
    s_waitcnt lgkmcnt(10)
    ds_read_b128 a[80:83], v172 offset:8192
    v_add_f32 v168, v168, v120
    v_mfma_f32_16x16x32_bf16 a[136:139], a[24:27], v[72:75], a[136:139]
    s_waitcnt lgkmcnt(9)
    v_exp_f32 v137, v45
    v_mfma_f32_16x16x32_bf16 a[140:143], a[28:31], v[72:75], a[140:143]
    s_waitcnt lgkmcnt(7)
    ds_read_b128 a[84:87], v173 offset:8192
    v_cvt_pk_bf16_f32 v90, v136, v137
    v_mfma_f32_16x16x32_bf16 a[144:147], a[48:51], v[72:75], a[144:147]
    s_add_u32 m0, s47, 0
    s_waitcnt lgkmcnt(6)
    v_exp_f32 v138, v46
    v_mfma_f32_16x16x32_bf16 a[148:151], a[52:55], v[72:75], a[148:151]
    s_waitcnt lgkmcnt(4)
    buffer_load_dwordx4 v251, s[40:43], s45 offen offset:0 nt lds
    v_add_f32 v170, v170, v166
    v_mfma_f32_16x16x32_bf16 a[152:155], a[56:59], v[72:75], a[152:155]
    s_waitcnt lgkmcnt(2)
    v_exp_f32 v139, v47
    v_mfma_f32_16x16x32_bf16 a[156:159], a[60:63], v[72:75], a[156:159]
    ds_read_b128 a[88:91], v174 offset:8192
    v_cvt_pk_bf16_f32 v91, v138, v139
    v_mfma_f32_16x16x32_bf16 a[192:195], a[16:19], v[80:83], a[192:195]
    v_exp_f32 v140, v56
    v_mfma_f32_16x16x32_bf16 a[196:199], a[20:23], v[80:83], a[196:199]
    ds_read_b128 a[92:95], v175 offset:8192
    v_cvt_pk_bf16_f32 v86, v160, v161
    v_mfma_f32_16x16x32_bf16 v[120:123], v[128:131], v[88:91], 0
    ds_read_b128 a[112:115], v172 offset:12288
    v_cvt_pk_bf16_f32 v87, v162, v163
    v_mfma_f32_16x16x32_bf16 a[200:203], a[24:27], v[80:83], a[200:203]
    v_exp_f32 v141, v57
    v_mfma_f32_16x16x32_bf16 a[204:207], a[28:31], v[80:83], a[204:207]
    buffer_load_dwordx4 v252, s[40:43], s45 offen offset:1024 nt lds
    v_add_f32 v166, v140, v141
    v_mfma_f32_16x16x32_bf16 a[208:211], a[48:51], v[80:83], a[208:211]
    v_exp_f32 v142, v58
    v_mfma_f32_16x16x32_bf16 a[212:215], a[52:55], v[80:83], a[212:215]
    ds_read_b128 a[116:119], v173 offset:12288
    v_add_f32 v166, v166, v142
    v_mfma_f32_16x16x32_bf16 a[216:219], a[56:59], v[80:83], a[216:219]
    v_exp_f32 v143, v59
    v_mfma_f32_16x16x32_bf16 a[220:223], a[60:63], v[80:83], a[220:223]
    s_nop 0
    v_add_f32 v166, v166, v143
    v_add_f32 v169, v169, v124
    v_mfma_f32_16x16x32_bf16 a[160:163], a[16:19], v[76:79], a[160:163]
    v_exp_f32 v144, v60
    v_mfma_f32_16x16x32_bf16 a[164:167], a[20:23], v[76:79], a[164:167]
    ds_read_b128 a[120:123], v174 offset:12288
    v_add_f32 v166, v166, v144
    v_mfma_f32_16x16x32_bf16 a[168:171], a[24:27], v[76:79], a[168:171]
    v_exp_f32 v145, v61
    v_mfma_f32_16x16x32_bf16 a[172:175], a[28:31], v[76:79], a[172:175]
    s_nop 0
    v_add_f32 v166, v166, v145
    v_add_f32 v171, v171, v167
    v_mfma_f32_16x16x32_bf16 a[176:179], a[48:51], v[76:79], a[176:179]
    v_exp_f32 v146, v62
    v_mfma_f32_16x16x32_bf16 a[180:183], a[52:55], v[76:79], a[180:183]
    ds_read_b128 a[124:127], v175 offset:12288
    v_add_f32 v166, v166, v146
    v_mfma_f32_16x16x32_bf16 a[184:187], a[56:59], v[76:79], a[184:187]
    v_exp_f32 v147, v63
    v_mfma_f32_16x16x32_bf16 a[188:191], a[60:63], v[76:79], a[188:191]
    s_nop 0
    v_add_f32 v166, v166, v147
    v_cvt_pk_bf16_f32 v96, v140, v141
    v_mfma_f32_16x16x32_bf16 a[224:227], a[16:19], v[84:87], a[224:227]
    v_exp_f32 v148, v48
    v_mfma_f32_16x16x32_bf16 a[228:231], a[20:23], v[84:87], a[228:231]
    ds_read_b64_tr_b16 a[16:17], v176 offset:40960
    v_cvt_pk_bf16_f32 v97, v142, v143
    v_mfma_f32_16x16x32_bf16 a[232:235], a[24:27], v[84:87], a[232:235]
    v_exp_f32 v149, v49
    v_mfma_f32_16x16x32_bf16 a[236:239], a[28:31], v[84:87], a[236:239]
    buffer_load_dwordx4 v251, s[40:43], s45 offen offset:2048 nt lds
    v_cvt_pk_bf16_f32 v92, v148, v149
    v_mfma_f32_16x16x32_bf16 a[240:243], a[48:51], v[84:87], a[240:243]
    v_exp_f32 v150, v50
    v_mfma_f32_16x16x32_bf16 a[244:247], a[52:55], v[84:87], a[244:247]
    ds_read_b64_tr_b16 a[18:19], v176 offset:45056
    v_cvt_pk_bf16_f32 v98, v144, v145
    v_mfma_f32_16x16x32_bf16 a[248:251], a[56:59], v[84:87], a[248:251]
    v_exp_f32 v151, v51
    v_mfma_f32_16x16x32_bf16 a[252:255], a[60:63], v[84:87], a[252:255]
    s_waitcnt lgkmcnt(9)
    ds_read_b64_tr_b16 a[20:21], v177 offset:40960
    v_cvt_pk_bf16_f32 v93, v150, v151
    v_mfma_f32_16x16x32_bf16 v[8:11], a[80:83], a[0:3], v[104:107]
    v_exp_f32 v152, v52
    v_mfma_f32_16x16x32_bf16 v[24:27], a[80:83], a[8:11], v[112:115]
    buffer_load_dwordx4 v252, s[40:43], s45 offen offset:3072 nt lds
    v_cvt_pk_bf16_f32 v99, v146, v147
    v_mfma_f32_16x16x32_bf16 v[16:19], a[80:83], a[4:7], v[108:111]
    s_add_u32 s45, s45, 16384
    v_exp_f32 v153, v53
    v_mfma_f32_16x16x32_bf16 v[32:35], a[80:83], a[12:15], v[116:119]
    s_waitcnt lgkmcnt(9)
    ds_read_b64_tr_b16 a[22:23], v177 offset:45056
    v_cvt_pk_bf16_f32 v94, v152, v153
    v_mfma_f32_16x16x32_bf16 v[8:11], a[84:87], a[32:35], v[8:11]
    v_exp_f32 v154, v54
    v_mfma_f32_16x16x32_bf16 v[24:27], a[84:87], a[40:43], v[24:27]
    ds_read_b64_tr_b16 a[24:25], v178 offset:40960
    v_mfma_f32_16x16x32_bf16 v[16:19], a[84:87], a[36:39], v[16:19]
    v_exp_f32 v155, v55
    v_mfma_f32_16x16x32_bf16 v[32:35], a[84:87], a[44:47], v[32:35]
    s_waitcnt lgkmcnt(10)
    ds_read_b64_tr_b16 a[26:27], v178 offset:45056
    v_cvt_pk_bf16_f32 v95, v154, v155
    v_mfma_f32_16x16x32_bf16 v[8:11], a[88:91], a[64:67], v[8:11]
    v_exp_f32 v156, v64
    v_mfma_f32_16x16x32_bf16 v[24:27], a[88:91], a[72:75], v[24:27]
    ds_read_b64_tr_b16 a[28:29], v179 offset:40960
    v_mfma_f32_16x16x32_bf16 v[124:127], v[128:131], v[92:95], 0
    ds_read_b64_tr_b16 a[30:31], v179 offset:45056
    v_mfma_f32_16x16x32_bf16 v[16:19], a[88:91], a[68:71], v[16:19]
    v_exp_f32 v157, v65
    v_mfma_f32_16x16x32_bf16 v[32:35], a[88:91], a[76:79], v[32:35]
    s_waitcnt lgkmcnt(12)
    ds_read_b64_tr_b16 a[48:49], v180 offset:40960
    v_add_f32 v167, v156, v157
    v_mfma_f32_16x16x32_bf16 v[8:11], a[92:95], a[96:99], v[8:11]
    v_exp_f32 v158, v66
    v_mfma_f32_16x16x32_bf16 v[24:27], a[92:95], a[104:107], v[24:27]
    ds_read_b64_tr_b16 a[50:51], v180 offset:45056
    v_add_f32 v167, v167, v158
    v_mfma_f32_16x16x32_bf16 v[16:19], a[92:95], a[100:103], v[16:19]
    v_exp_f32 v159, v67
    v_mfma_f32_16x16x32_bf16 v[32:35], a[92:95], a[108:111], v[32:35]
    s_waitcnt lgkmcnt(13)
    ds_read_b64_tr_b16 a[52:53], v181 offset:40960
    v_add_f32 v167, v167, v159
    v_mfma_f32_16x16x32_bf16 v[12:15], a[112:115], a[0:3], v[104:107]
    v_exp_f32 v160, v68
    v_mfma_f32_16x16x32_bf16 v[28:31], a[112:115], a[8:11], v[112:115]
    ds_read_b64_tr_b16 a[54:55], v181 offset:45056
    v_add_f32 v167, v167, v160
    v_mfma_f32_16x16x32_bf16 v[20:23], a[112:115], a[4:7], v[108:111]
    v_exp_f32 v161, v69
    v_mfma_f32_16x16x32_bf16 v[36:39], a[112:115], a[12:15], v[116:119]
    s_waitcnt lgkmcnt(14)
    ds_read_b64_tr_b16 a[56:57], v182 offset:40960
    v_add_f32 v167, v167, v161
    v_mfma_f32_16x16x32_bf16 v[12:15], a[116:119], a[32:35], v[12:15]
    v_exp_f32 v162, v70
    v_mfma_f32_16x16x32_bf16 v[28:31], a[116:119], a[40:43], v[28:31]
    ds_read_b64_tr_b16 a[58:59], v182 offset:45056
    v_add_f32 v167, v167, v162
    v_mfma_f32_16x16x32_bf16 v[20:23], a[116:119], a[36:39], v[20:23]
    v_exp_f32 v163, v71
    v_mfma_f32_16x16x32_bf16 v[36:39], a[116:119], a[44:47], v[36:39]
    s_waitcnt lgkmcnt(15)
    ds_read_b64_tr_b16 a[60:61], v183 offset:40960
    v_max3_f32 v184, v120, v124, v166
    v_mfma_f32_16x16x32_bf16 v[12:15], a[120:123], a[64:67], v[12:15]
    v_exp_f32 v132, v8
    v_mfma_f32_16x16x32_bf16 v[28:31], a[120:123], a[72:75], v[28:31]
    s_nop 0
    v_add_f32 v167, v167, v163
    v_max_f32 v184, v184, v167
    v_mfma_f32_16x16x32_bf16 v[20:23], a[120:123], a[68:71], v[20:23]
    v_exp_f32 v133, v9
    v_mfma_f32_16x16x32_bf16 v[36:39], a[120:123], a[76:79], v[36:39]
    s_waitcnt lgkmcnt(15)
    v_cmp_lt_f32 vcc, s48, v184
    v_cvt_pk_bf16_f32 v72, v132, v133
    v_mfma_f32_16x16x32_bf16 v[12:15], a[124:127], a[96:99], v[12:15]
    v_exp_f32 v134, v10
    v_mfma_f32_16x16x32_bf16 v[28:31], a[124:127], a[104:107], v[28:31]
    s_nop 0
    v_cvt_pk_bf16_f32 v100, v156, v157
    v_cvt_pk_bf16_f32 v101, v158, v159
    v_mfma_f32_16x16x32_bf16 v[20:23], a[124:127], a[100:103], v[20:23]
    s_cbranch_vccnz mk_stubl5
mk_okl5:
    v_exp_f32 v135, v11
    v_mfma_f32_16x16x32_bf16 v[36:39], a[124:127], a[108:111], v[36:39]
    s_waitcnt lgkmcnt(13)
    ds_read_b64_tr_b16 a[62:63], v183 offset:45056
    v_cvt_pk_bf16_f32 v73, v134, v135
    v_mfma_f32_16x16x32_bf16 a[128:131], a[16:19], v[88:91], a[128:131]
    s_waitcnt lgkmcnt(12)
    v_exp_f32 v136, v12
    v_mfma_f32_16x16x32_bf16 a[132:135], a[20:23], v[88:91], a[132:135]
    s_waitcnt vmcnt(10)
    s_barrier
    s_waitcnt lgkmcnt(10)
    ds_read_b128 a[80:83], v172 offset:16384
    v_add_f32 v168, v168, v120
    v_mfma_f32_16x16x32_bf16 a[136:139], a[24:27], v[88:91], a[136:139]
    s_waitcnt lgkmcnt(9)
    v_exp_f32 v137, v13
    v_mfma_f32_16x16x32_bf16 a[140:143], a[28:31], v[88:91], a[140:143]
    s_waitcnt lgkmcnt(7)
    ds_read_b128 a[84:87], v173 offset:16384
    v_cvt_pk_bf16_f32 v74, v136, v137
    v_mfma_f32_16x16x32_bf16 a[144:147], a[48:51], v[88:91], a[144:147]
    s_add_u32 m0, s46, 49152
    s_waitcnt lgkmcnt(6)
    v_exp_f32 v138, v14
    v_mfma_f32_16x16x32_bf16 a[148:151], a[52:55], v[88:91], a[148:151]
    s_waitcnt lgkmcnt(4)
    buffer_load_dwordx4 v247, s[36:39], s44 offen offset:0 nt lds
    v_add_f32 v170, v170, v166
    v_mfma_f32_16x16x32_bf16 a[152:155], a[56:59], v[88:91], a[152:155]
    s_waitcnt lgkmcnt(2)
    v_exp_f32 v139, v15
    v_mfma_f32_16x16x32_bf16 a[156:159], a[60:63], v[88:91], a[156:159]
    ds_read_b128 a[88:91], v174 offset:16384
    v_cvt_pk_bf16_f32 v75, v138, v139
    v_mfma_f32_16x16x32_bf16 a[192:195], a[16:19], v[96:99], a[192:195]
    v_exp_f32 v140, v24
    v_mfma_f32_16x16x32_bf16 a[196:199], a[20:23], v[96:99], a[196:199]
    ds_read_b128 a[92:95], v175 offset:16384
    v_cvt_pk_bf16_f32 v102, v160, v161
    v_mfma_f32_16x16x32_bf16 v[120:123], v[128:131], v[72:75], 0
    ds_read_b128 a[112:115], v172 offset:20480
    v_cvt_pk_bf16_f32 v103, v162, v163
    v_mfma_f32_16x16x32_bf16 a[200:203], a[24:27], v[96:99], a[200:203]
    v_exp_f32 v141, v25
    v_mfma_f32_16x16x32_bf16 a[204:207], a[28:31], v[96:99], a[204:207]
    buffer_load_dwordx4 v248, s[36:39], s44 offen offset:1024 nt lds
    v_add_f32 v166, v140, v141
    v_mfma_f32_16x16x32_bf16 a[208:211], a[48:51], v[96:99], a[208:211]
    v_exp_f32 v142, v26
    v_mfma_f32_16x16x32_bf16 a[212:215], a[52:55], v[96:99], a[212:215]
    ds_read_b128 a[116:119], v173 offset:20480
    v_add_f32 v166, v166, v142
    v_mfma_f32_16x16x32_bf16 a[216:219], a[56:59], v[96:99], a[216:219]
    v_exp_f32 v143, v27
    v_mfma_f32_16x16x32_bf16 a[220:223], a[60:63], v[96:99], a[220:223]
    s_nop 0
    v_add_f32 v166, v166, v143
    v_add_f32 v169, v169, v124
    v_mfma_f32_16x16x32_bf16 a[160:163], a[16:19], v[92:95], a[160:163]
    v_exp_f32 v144, v28
    v_mfma_f32_16x16x32_bf16 a[164:167], a[20:23], v[92:95], a[164:167]
    ds_read_b128 a[120:123], v174 offset:20480
    v_add_f32 v166, v166, v144
    v_mfma_f32_16x16x32_bf16 a[168:171], a[24:27], v[92:95], a[168:171]
    v_exp_f32 v145, v29
    v_mfma_f32_16x16x32_bf16 a[172:175], a[28:31], v[92:95], a[172:175]
    s_nop 0
    v_add_f32 v166, v166, v145
    v_add_f32 v171, v171, v167
    v_mfma_f32_16x16x32_bf16 a[176:179], a[48:51], v[92:95], a[176:179]
    v_exp_f32 v146, v30
    v_mfma_f32_16x16x32_bf16 a[180:183], a[52:55], v[92:95], a[180:183]
    ds_read_b128 a[124:127], v175 offset:20480
    v_add_f32 v166, v166, v146
    v_mfma_f32_16x16x32_bf16 a[184:187], a[56:59], v[92:95], a[184:187]
    v_exp_f32 v147, v31
    v_mfma_f32_16x16x32_bf16 a[188:191], a[60:63], v[92:95], a[188:191]
    s_nop 0
    v_add_f32 v166, v166, v147
    v_cvt_pk_bf16_f32 v80, v140, v141
    v_mfma_f32_16x16x32_bf16 a[224:227], a[16:19], v[100:103], a[224:227]
    v_exp_f32 v148, v16
    v_mfma_f32_16x16x32_bf16 a[228:231], a[20:23], v[100:103], a[228:231]
    ds_read_b64_tr_b16 a[16:17], v176 offset:49152
    v_cvt_pk_bf16_f32 v81, v142, v143
    v_mfma_f32_16x16x32_bf16 a[232:235], a[24:27], v[100:103], a[232:235]
    v_exp_f32 v149, v17
    v_mfma_f32_16x16x32_bf16 a[236:239], a[28:31], v[100:103], a[236:239]
    buffer_load_dwordx4 v249, s[36:39], s44 offen offset:2048 nt lds
    v_cvt_pk_bf16_f32 v76, v148, v149
    v_mfma_f32_16x16x32_bf16 a[240:243], a[48:51], v[100:103], a[240:243]
    v_exp_f32 v150, v18
    v_mfma_f32_16x16x32_bf16 a[244:247], a[52:55], v[100:103], a[244:247]
    ds_read_b64_tr_b16 a[18:19], v176 offset:53248
    v_cvt_pk_bf16_f32 v82, v144, v145
    v_mfma_f32_16x16x32_bf16 a[248:251], a[56:59], v[100:103], a[248:251]
    v_exp_f32 v151, v19
    v_mfma_f32_16x16x32_bf16 a[252:255], a[60:63], v[100:103], a[252:255]
    s_waitcnt lgkmcnt(9)
    ds_read_b64_tr_b16 a[20:21], v177 offset:49152
    v_cvt_pk_bf16_f32 v77, v150, v151
    v_mfma_f32_16x16x32_bf16 v[40:43], a[80:83], a[0:3], v[104:107]
    v_exp_f32 v152, v20
    v_mfma_f32_16x16x32_bf16 v[56:59], a[80:83], a[8:11], v[112:115]
    buffer_load_dwordx4 v250, s[36:39], s44 offen offset:3072 nt lds
    v_cvt_pk_bf16_f32 v83, v146, v147
    v_mfma_f32_16x16x32_bf16 v[48:51], a[80:83], a[4:7], v[108:111]
    s_add_u32 s44, s44, 16384
    v_exp_f32 v153, v21
    v_mfma_f32_16x16x32_bf16 v[64:67], a[80:83], a[12:15], v[116:119]
    s_waitcnt lgkmcnt(9)
    ds_read_b64_tr_b16 a[22:23], v177 offset:53248
    v_cvt_pk_bf16_f32 v78, v152, v153
    v_mfma_f32_16x16x32_bf16 v[40:43], a[84:87], a[32:35], v[40:43]
    v_exp_f32 v154, v22
    v_mfma_f32_16x16x32_bf16 v[56:59], a[84:87], a[40:43], v[56:59]
    ds_read_b64_tr_b16 a[24:25], v178 offset:49152
    v_mfma_f32_16x16x32_bf16 v[48:51], a[84:87], a[36:39], v[48:51]
    v_exp_f32 v155, v23
    v_mfma_f32_16x16x32_bf16 v[64:67], a[84:87], a[44:47], v[64:67]
    s_waitcnt lgkmcnt(10)
    ds_read_b64_tr_b16 a[26:27], v178 offset:53248
    v_cvt_pk_bf16_f32 v79, v154, v155
    v_mfma_f32_16x16x32_bf16 v[40:43], a[88:91], a[64:67], v[40:43]
    v_exp_f32 v156, v32
    v_mfma_f32_16x16x32_bf16 v[56:59], a[88:91], a[72:75], v[56:59]
    ds_read_b64_tr_b16 a[28:29], v179 offset:49152
    v_mfma_f32_16x16x32_bf16 v[124:127], v[128:131], v[76:79], 0
    ds_read_b64_tr_b16 a[30:31], v179 offset:53248
    v_mfma_f32_16x16x32_bf16 v[48:51], a[88:91], a[68:71], v[48:51]
    v_exp_f32 v157, v33
    v_mfma_f32_16x16x32_bf16 v[64:67], a[88:91], a[76:79], v[64:67]
    s_waitcnt lgkmcnt(12)
    ds_read_b64_tr_b16 a[48:49], v180 offset:49152
    v_add_f32 v167, v156, v157
    v_mfma_f32_16x16x32_bf16 v[40:43], a[92:95], a[96:99], v[40:43]
    v_exp_f32 v158, v34
    v_mfma_f32_16x16x32_bf16 v[56:59], a[92:95], a[104:107], v[56:59]
    ds_read_b64_tr_b16 a[50:51], v180 offset:53248
    v_add_f32 v167, v167, v158
    v_mfma_f32_16x16x32_bf16 v[48:51], a[92:95], a[100:103], v[48:51]
    v_exp_f32 v159, v35
    v_mfma_f32_16x16x32_bf16 v[64:67], a[92:95], a[108:111], v[64:67]
    s_waitcnt lgkmcnt(13)
    ds_read_b64_tr_b16 a[52:53], v181 offset:49152
    v_add_f32 v167, v167, v159
    v_mfma_f32_16x16x32_bf16 v[44:47], a[112:115], a[0:3], v[104:107]
    v_exp_f32 v160, v36
    v_mfma_f32_16x16x32_bf16 v[60:63], a[112:115], a[8:11], v[112:115]
    ds_read_b64_tr_b16 a[54:55], v181 offset:53248
    v_add_f32 v167, v167, v160
    v_mfma_f32_16x16x32_bf16 v[52:55], a[112:115], a[4:7], v[108:111]
    v_exp_f32 v161, v37
    v_mfma_f32_16x16x32_bf16 v[68:71], a[112:115], a[12:15], v[116:119]
    s_waitcnt lgkmcnt(14)
    ds_read_b64_tr_b16 a[56:57], v182 offset:49152
    v_add_f32 v167, v167, v161
    v_mfma_f32_16x16x32_bf16 v[44:47], a[116:119], a[32:35], v[44:47]
    v_exp_f32 v162, v38
    v_mfma_f32_16x16x32_bf16 v[60:63], a[116:119], a[40:43], v[60:63]
    ds_read_b64_tr_b16 a[58:59], v182 offset:53248
    v_add_f32 v167, v167, v162
    v_mfma_f32_16x16x32_bf16 v[52:55], a[116:119], a[36:39], v[52:55]
    v_exp_f32 v163, v39
    v_mfma_f32_16x16x32_bf16 v[68:71], a[116:119], a[44:47], v[68:71]
    s_waitcnt lgkmcnt(15)
    ds_read_b64_tr_b16 a[60:61], v183 offset:49152
    v_max3_f32 v184, v120, v124, v166
    v_mfma_f32_16x16x32_bf16 v[44:47], a[120:123], a[64:67], v[44:47]
    v_exp_f32 v132, v40
    v_mfma_f32_16x16x32_bf16 v[60:63], a[120:123], a[72:75], v[60:63]
    s_nop 0
    v_add_f32 v167, v167, v163
    v_max_f32 v184, v184, v167
    v_mfma_f32_16x16x32_bf16 v[52:55], a[120:123], a[68:71], v[52:55]
    v_exp_f32 v133, v41
    v_mfma_f32_16x16x32_bf16 v[68:71], a[120:123], a[76:79], v[68:71]
    s_waitcnt lgkmcnt(15)
    v_cmp_lt_f32 vcc, s48, v184
    v_cvt_pk_bf16_f32 v88, v132, v133
    v_mfma_f32_16x16x32_bf16 v[44:47], a[124:127], a[96:99], v[44:47]
    v_exp_f32 v134, v42
    v_mfma_f32_16x16x32_bf16 v[60:63], a[124:127], a[104:107], v[60:63]
    s_nop 0
    v_cvt_pk_bf16_f32 v84, v156, v157
    v_cvt_pk_bf16_f32 v85, v158, v159
    v_mfma_f32_16x16x32_bf16 v[52:55], a[124:127], a[100:103], v[52:55]
    s_cbranch_vccnz mk_stubl6
mk_okl6:
    v_exp_f32 v135, v43
    v_mfma_f32_16x16x32_bf16 v[68:71], a[124:127], a[108:111], v[68:71]
    s_waitcnt lgkmcnt(13)
    ds_read_b64_tr_b16 a[62:63], v183 offset:53248
    v_cvt_pk_bf16_f32 v89, v134, v135
    v_mfma_f32_16x16x32_bf16 a[128:131], a[16:19], v[72:75], a[128:131]
    s_waitcnt lgkmcnt(12)
    v_exp_f32 v136, v44
    v_mfma_f32_16x16x32_bf16 a[132:135], a[20:23], v[72:75], a[132:135]
    s_waitcnt lgkmcnt(10)
    ds_read_b128 a[80:83], v172 offset:24576
    v_add_f32 v168, v168, v120
    v_mfma_f32_16x16x32_bf16 a[136:139], a[24:27], v[72:75], a[136:139]
    s_waitcnt lgkmcnt(9)
    v_exp_f32 v137, v45
    v_mfma_f32_16x16x32_bf16 a[140:143], a[28:31], v[72:75], a[140:143]
    s_waitcnt lgkmcnt(7)
    ds_read_b128 a[84:87], v173 offset:24576
    v_cvt_pk_bf16_f32 v90, v136, v137
    v_mfma_f32_16x16x32_bf16 a[144:147], a[48:51], v[72:75], a[144:147]
    s_add_u32 m0, s47, 16384
    s_waitcnt lgkmcnt(6)
    v_exp_f32 v138, v46
    v_mfma_f32_16x16x32_bf16 a[148:151], a[52:55], v[72:75], a[148:151]
    s_waitcnt lgkmcnt(4)
    buffer_load_dwordx4 v251, s[40:43], s45 offen offset:0 nt lds
    v_add_f32 v170, v170, v166
    v_mfma_f32_16x16x32_bf16 a[152:155], a[56:59], v[72:75], a[152:155]
    s_waitcnt lgkmcnt(2)
    v_exp_f32 v139, v47
    v_mfma_f32_16x16x32_bf16 a[156:159], a[60:63], v[72:75], a[156:159]
    ds_read_b128 a[88:91], v174 offset:24576
    v_cvt_pk_bf16_f32 v91, v138, v139
    v_mfma_f32_16x16x32_bf16 a[192:195], a[16:19], v[80:83], a[192:195]
    v_exp_f32 v140, v56
    v_mfma_f32_16x16x32_bf16 a[196:199], a[20:23], v[80:83], a[196:199]
    ds_read_b128 a[92:95], v175 offset:24576
    v_cvt_pk_bf16_f32 v86, v160, v161
    v_mfma_f32_16x16x32_bf16 v[120:123], v[128:131], v[88:91], 0
    ds_read_b128 a[112:115], v172 offset:28672
    v_cvt_pk_bf16_f32 v87, v162, v163
    v_mfma_f32_16x16x32_bf16 a[200:203], a[24:27], v[80:83], a[200:203]
    v_exp_f32 v141, v57
    v_mfma_f32_16x16x32_bf16 a[204:207], a[28:31], v[80:83], a[204:207]
    buffer_load_dwordx4 v252, s[40:43], s45 offen offset:1024 nt lds
    v_add_f32 v166, v140, v141
    v_mfma_f32_16x16x32_bf16 a[208:211], a[48:51], v[80:83], a[208:211]
    v_exp_f32 v142, v58
    v_mfma_f32_16x16x32_bf16 a[212:215], a[52:55], v[80:83], a[212:215]
    ds_read_b128 a[116:119], v173 offset:28672
    v_add_f32 v166, v166, v142
    v_mfma_f32_16x16x32_bf16 a[216:219], a[56:59], v[80:83], a[216:219]
    v_exp_f32 v143, v59
    v_mfma_f32_16x16x32_bf16 a[220:223], a[60:63], v[80:83], a[220:223]
    s_nop 0
    v_add_f32 v166, v166, v143
    v_add_f32 v169, v169, v124
    v_mfma_f32_16x16x32_bf16 a[160:163], a[16:19], v[76:79], a[160:163]
    v_exp_f32 v144, v60
    v_mfma_f32_16x16x32_bf16 a[164:167], a[20:23], v[76:79], a[164:167]
    ds_read_b128 a[120:123], v174 offset:28672
    v_add_f32 v166, v166, v144
    v_mfma_f32_16x16x32_bf16 a[168:171], a[24:27], v[76:79], a[168:171]
    v_exp_f32 v145, v61
    v_mfma_f32_16x16x32_bf16 a[172:175], a[28:31], v[76:79], a[172:175]
    s_nop 0
    v_add_f32 v166, v166, v145
    v_add_f32 v171, v171, v167
    v_mfma_f32_16x16x32_bf16 a[176:179], a[48:51], v[76:79], a[176:179]
    v_exp_f32 v146, v62
    v_mfma_f32_16x16x32_bf16 a[180:183], a[52:55], v[76:79], a[180:183]
    ds_read_b128 a[124:127], v175 offset:28672
    v_add_f32 v166, v166, v146
    v_mfma_f32_16x16x32_bf16 a[184:187], a[56:59], v[76:79], a[184:187]
    v_exp_f32 v147, v63
    v_mfma_f32_16x16x32_bf16 a[188:191], a[60:63], v[76:79], a[188:191]
    buffer_load_dwordx4 v251, s[40:43], s45 offen offset:2048 nt lds
    v_add_f32 v166, v166, v147
    v_mfma_f32_16x16x32_bf16 a[224:227], a[16:19], v[84:87], a[224:227]
    v_exp_f32 v148, v48
    v_mfma_f32_16x16x32_bf16 a[228:231], a[20:23], v[84:87], a[228:231]
    ds_read_b64_tr_b16 a[16:17], v176 offset:57344
    v_cvt_pk_bf16_f32 v96, v140, v141
    v_mfma_f32_16x16x32_bf16 a[232:235], a[24:27], v[84:87], a[232:235]
    v_exp_f32 v149, v49
    v_mfma_f32_16x16x32_bf16 a[236:239], a[28:31], v[84:87], a[236:239]
    buffer_load_dwordx4 v252, s[40:43], s45 offen offset:3072 nt lds
    v_cvt_pk_bf16_f32 v92, v148, v149
    v_mfma_f32_16x16x32_bf16 a[240:243], a[48:51], v[84:87], a[240:243]
    s_add_u32 s45, s45, 16384
    v_exp_f32 v150, v50
    v_mfma_f32_16x16x32_bf16 a[244:247], a[52:55], v[84:87], a[244:247]
    ds_read_b64_tr_b16 a[18:19], v176 offset:61440
    v_cvt_pk_bf16_f32 v97, v142, v143
    v_mfma_f32_16x16x32_bf16 a[248:251], a[56:59], v[84:87], a[248:251]
    v_exp_f32 v151, v51
    v_mfma_f32_16x16x32_bf16 a[252:255], a[60:63], v[84:87], a[252:255]
    s_waitcnt lgkmcnt(9)
    ds_read_b64_tr_b16 a[20:21], v177 offset:57344
    v_cvt_pk_bf16_f32 v93, v150, v151
    v_mfma_f32_16x16x32_bf16 v[8:11], a[80:83], a[0:3], v[104:107]
    v_exp_f32 v152, v52
    v_mfma_f32_16x16x32_bf16 v[24:27], a[80:83], a[8:11], v[112:115]
    buffer_load_dwordx4 v[240:243], v3, s[60:63], s20 offen
    v_cvt_pk_bf16_f32 v98, v144, v145
    v_mfma_f32_16x16x32_bf16 v[16:19], a[80:83], a[4:7], v[108:111]
    s_add_u32 s20, s20, 1024
    v_exp_f32 v153, v53
    v_mfma_f32_16x16x32_bf16 v[32:35], a[80:83], a[12:15], v[116:119]
    s_waitcnt lgkmcnt(9)
    ds_read_b64_tr_b16 a[22:23], v177 offset:61440
    v_cvt_pk_bf16_f32 v94, v152, v153
    v_mfma_f32_16x16x32_bf16 v[8:11], a[84:87], a[32:35], v[8:11]
    v_exp_f32 v154, v54
    v_mfma_f32_16x16x32_bf16 v[24:27], a[84:87], a[40:43], v[24:27]
    ds_read_b64_tr_b16 a[24:25], v178 offset:57344
    v_cvt_pk_bf16_f32 v99, v146, v147
    v_mfma_f32_16x16x32_bf16 v[16:19], a[84:87], a[36:39], v[16:19]
    v_exp_f32 v155, v55
    v_mfma_f32_16x16x32_bf16 v[32:35], a[84:87], a[44:47], v[32:35]
    s_waitcnt lgkmcnt(10)
    ds_read_b64_tr_b16 a[26:27], v178 offset:61440
    v_cvt_pk_bf16_f32 v95, v154, v155
    v_mfma_f32_16x16x32_bf16 v[8:11], a[88:91], a[64:67], v[8:11]
    v_exp_f32 v156, v64
    v_mfma_f32_16x16x32_bf16 v[24:27], a[88:91], a[72:75], v[24:27]
    ds_read_b64_tr_b16 a[28:29], v179 offset:57344
    v_mfma_f32_16x16x32_bf16 v[124:127], v[128:131], v[92:95], 0
    ds_read_b64_tr_b16 a[30:31], v179 offset:61440
    v_mfma_f32_16x16x32_bf16 v[16:19], a[88:91], a[68:71], v[16:19]
    v_exp_f32 v157, v65
    v_mfma_f32_16x16x32_bf16 v[32:35], a[88:91], a[76:79], v[32:35]
    s_waitcnt lgkmcnt(12)
    ds_read_b64_tr_b16 a[48:49], v180 offset:57344
    v_add_f32 v167, v156, v157
    v_mfma_f32_16x16x32_bf16 v[8:11], a[92:95], a[96:99], v[8:11]
    v_exp_f32 v158, v66
    v_mfma_f32_16x16x32_bf16 v[24:27], a[92:95], a[104:107], v[24:27]
    ds_read_b64_tr_b16 a[50:51], v180 offset:61440
    v_add_f32 v167, v167, v158
    v_mfma_f32_16x16x32_bf16 v[16:19], a[92:95], a[100:103], v[16:19]
    v_exp_f32 v159, v67
    v_mfma_f32_16x16x32_bf16 v[32:35], a[92:95], a[108:111], v[32:35]
    s_waitcnt lgkmcnt(13)
    ds_read_b64_tr_b16 a[52:53], v181 offset:57344
    v_add_f32 v167, v167, v159
    v_mfma_f32_16x16x32_bf16 v[12:15], a[112:115], a[0:3], v[104:107]
    v_exp_f32 v160, v68
    v_mfma_f32_16x16x32_bf16 v[28:31], a[112:115], a[8:11], v[112:115]
    ds_read_b64_tr_b16 a[54:55], v181 offset:61440
    v_add_f32 v167, v167, v160
    v_mfma_f32_16x16x32_bf16 v[20:23], a[112:115], a[4:7], v[108:111]
    v_exp_f32 v161, v69
    v_mfma_f32_16x16x32_bf16 v[36:39], a[112:115], a[12:15], v[116:119]
    s_waitcnt lgkmcnt(14)
    ds_read_b64_tr_b16 a[56:57], v182 offset:57344
    v_add_f32 v167, v167, v161
    v_mfma_f32_16x16x32_bf16 v[12:15], a[116:119], a[32:35], v[12:15]
    v_exp_f32 v162, v70
    v_mfma_f32_16x16x32_bf16 v[28:31], a[116:119], a[40:43], v[28:31]
    ds_read_b64_tr_b16 a[58:59], v182 offset:61440
    v_add_f32 v167, v167, v162
    v_mfma_f32_16x16x32_bf16 v[20:23], a[116:119], a[36:39], v[20:23]
    v_exp_f32 v163, v71
    v_mfma_f32_16x16x32_bf16 v[36:39], a[116:119], a[44:47], v[36:39]
    s_waitcnt lgkmcnt(15)
    ds_read_b64_tr_b16 a[60:61], v183 offset:57344
    v_max3_f32 v184, v120, v124, v166
    v_mfma_f32_16x16x32_bf16 v[12:15], a[120:123], a[64:67], v[12:15]
    v_exp_f32 v132, v8
    v_mfma_f32_16x16x32_bf16 v[28:31], a[120:123], a[72:75], v[28:31]
    s_nop 0
    v_add_f32 v167, v167, v163
    v_max_f32 v184, v184, v167
    v_mfma_f32_16x16x32_bf16 v[20:23], a[120:123], a[68:71], v[20:23]
    v_exp_f32 v133, v9
    v_mfma_f32_16x16x32_bf16 v[36:39], a[120:123], a[76:79], v[36:39]
    s_waitcnt lgkmcnt(15)
    v_cmp_lt_f32 vcc, s48, v184
    v_cvt_pk_bf16_f32 v72, v132, v133
    v_mfma_f32_16x16x32_bf16 v[12:15], a[124:127], a[96:99], v[12:15]
    v_exp_f32 v134, v10
    v_mfma_f32_16x16x32_bf16 v[28:31], a[124:127], a[104:107], v[28:31]
    s_nop 0
    v_cvt_pk_bf16_f32 v100, v156, v157
    v_cvt_pk_bf16_f32 v101, v158, v159
    v_mfma_f32_16x16x32_bf16 v[20:23], a[124:127], a[100:103], v[20:23]
    s_cbranch_vccnz mk_stubl7
mk_okl7:
    v_exp_f32 v135, v11
    v_mfma_f32_16x16x32_bf16 v[36:39], a[124:127], a[108:111], v[36:39]
    s_waitcnt lgkmcnt(13)
    ds_read_b64_tr_b16 a[62:63], v183 offset:61440
    v_cvt_pk_bf16_f32 v73, v134, v135
    v_mfma_f32_16x16x32_bf16 a[128:131], a[16:19], v[88:91], a[128:131]
    s_waitcnt lgkmcnt(12)
    v_exp_f32 v136, v12
    v_mfma_f32_16x16x32_bf16 a[132:135], a[20:23], v[88:91], a[132:135]
    s_waitcnt vmcnt(9)
    s_barrier
    s_waitcnt lgkmcnt(10)
    ds_read_b128 a[80:83], v172 offset:32768
    v_add_f32 v168, v168, v120
    v_mfma_f32_16x16x32_bf16 a[136:139], a[24:27], v[88:91], a[136:139]
    s_waitcnt lgkmcnt(9)
    v_exp_f32 v137, v13
    v_mfma_f32_16x16x32_bf16 a[140:143], a[28:31], v[88:91], a[140:143]
    s_waitcnt lgkmcnt(7)
    ds_read_b128 a[84:87], v173 offset:32768
    v_cvt_pk_bf16_f32 v74, v136, v137
    v_mfma_f32_16x16x32_bf16 a[144:147], a[48:51], v[88:91], a[144:147]
    s_add_u32 m0, s46, 0
    s_waitcnt lgkmcnt(6)
    v_exp_f32 v138, v14
    v_mfma_f32_16x16x32_bf16 a[148:151], a[52:55], v[88:91], a[148:151]
    s_waitcnt lgkmcnt(4)
    buffer_load_dwordx4 v247, s[36:39], s44 offen offset:0 nt lds
    v_add_f32 v170, v170, v166
    v_mfma_f32_16x16x32_bf16 a[152:155], a[56:59], v[88:91], a[152:155]
    s_waitcnt lgkmcnt(2)
    v_exp_f32 v139, v15
    v_mfma_f32_16x16x32_bf16 a[156:159], a[60:63], v[88:91], a[156:159]
    ds_read_b128 a[88:91], v174 offset:32768
    v_cvt_pk_bf16_f32 v75, v138, v139
    v_mfma_f32_16x16x32_bf16 a[192:195], a[16:19], v[96:99], a[192:195]
    v_exp_f32 v140, v24
    v_mfma_f32_16x16x32_bf16 a[196:199], a[20:23], v[96:99], a[196:199]
    ds_read_b128 a[92:95], v175 offset:32768
    v_cvt_pk_bf16_f32 v102, v160, v161
    v_mfma_f32_16x16x32_bf16 v[120:123], v[128:131], v[72:75], 0
    ds_read_b128 a[112:115], v172 offset:36864
    v_cvt_pk_bf16_f32 v103, v162, v163
    v_mfma_f32_16x16x32_bf16 a[200:203], a[24:27], v[96:99], a[200:203]
    v_exp_f32 v141, v25
    v_mfma_f32_16x16x32_bf16 a[204:207], a[28:31], v[96:99], a[204:207]
    buffer_load_dwordx4 v248, s[36:39], s44 offen offset:1024 nt lds
    v_add_f32 v166, v140, v141
    v_mfma_f32_16x16x32_bf16 a[208:211], a[48:51], v[96:99], a[208:211]
    v_exp_f32 v142, v26
    v_mfma_f32_16x16x32_bf16 a[212:215], a[52:55], v[96:99], a[212:215]
    ds_read_b128 a[116:119], v173 offset:36864
    v_add_f32 v166, v166, v142
    v_mfma_f32_16x16x32_bf16 a[216:219], a[56:59], v[96:99], a[216:219]
    v_exp_f32 v143, v27
    v_mfma_f32_16x16x32_bf16 a[220:223], a[60:63], v[96:99], a[220:223]
    s_nop 0
    v_add_f32 v166, v166, v143
    v_add_f32 v169, v169, v124
    v_mfma_f32_16x16x32_bf16 a[160:163], a[16:19], v[92:95], a[160:163]
    v_exp_f32 v144, v28
    v_mfma_f32_16x16x32_bf16 a[164:167], a[20:23], v[92:95], a[164:167]
    ds_read_b128 a[120:123], v174 offset:36864
    v_add_f32 v166, v166, v144
    v_mfma_f32_16x16x32_bf16 a[168:171], a[24:27], v[92:95], a[168:171]
    v_exp_f32 v145, v29
    v_mfma_f32_16x16x32_bf16 a[172:175], a[28:31], v[92:95], a[172:175]
    s_nop 0
    v_add_f32 v166, v166, v145
    v_add_f32 v171, v171, v167
    v_mfma_f32_16x16x32_bf16 a[176:179], a[48:51], v[92:95], a[176:179]
    v_exp_f32 v146, v30
    v_mfma_f32_16x16x32_bf16 a[180:183], a[52:55], v[92:95], a[180:183]
    ds_read_b128 a[124:127], v175 offset:36864
    v_add_f32 v166, v166, v146
    v_mfma_f32_16x16x32_bf16 a[184:187], a[56:59], v[92:95], a[184:187]
    v_exp_f32 v147, v31
    v_mfma_f32_16x16x32_bf16 a[188:191], a[60:63], v[92:95], a[188:191]
    s_nop 0
    v_add_f32 v166, v166, v147
    v_cvt_pk_bf16_f32 v80, v140, v141
    v_mfma_f32_16x16x32_bf16 a[224:227], a[16:19], v[100:103], a[224:227]
    v_exp_f32 v148, v16
    v_mfma_f32_16x16x32_bf16 a[228:231], a[20:23], v[100:103], a[228:231]
    ds_read_b64_tr_b16 a[16:17], v176 offset:0
    v_cvt_pk_bf16_f32 v81, v142, v143
    v_mfma_f32_16x16x32_bf16 a[232:235], a[24:27], v[100:103], a[232:235]
    v_exp_f32 v149, v17
    v_mfma_f32_16x16x32_bf16 a[236:239], a[28:31], v[100:103], a[236:239]
    buffer_load_dwordx4 v249, s[36:39], s44 offen offset:2048 nt lds
    v_cvt_pk_bf16_f32 v76, v148, v149
    v_mfma_f32_16x16x32_bf16 a[240:243], a[48:51], v[100:103], a[240:243]
    v_exp_f32 v150, v18
    v_mfma_f32_16x16x32_bf16 a[244:247], a[52:55], v[100:103], a[244:247]
    ds_read_b64_tr_b16 a[18:19], v176 offset:4096
    v_cvt_pk_bf16_f32 v82, v144, v145
    v_mfma_f32_16x16x32_bf16 a[248:251], a[56:59], v[100:103], a[248:251]
    v_exp_f32 v151, v19
    v_mfma_f32_16x16x32_bf16 a[252:255], a[60:63], v[100:103], a[252:255]
    s_waitcnt lgkmcnt(9)
    ds_read_b64_tr_b16 a[20:21], v177 offset:0
    v_cvt_pk_bf16_f32 v77, v150, v151
    v_mfma_f32_16x16x32_bf16 v[40:43], a[80:83], a[0:3], v[104:107]
    v_exp_f32 v152, v20
    v_mfma_f32_16x16x32_bf16 v[56:59], a[80:83], a[8:11], v[112:115]
    buffer_load_dwordx4 v250, s[36:39], s44 offen offset:3072 nt lds
    v_cvt_pk_bf16_f32 v83, v146, v147
    v_mfma_f32_16x16x32_bf16 v[48:51], a[80:83], a[4:7], v[108:111]
    s_add_u32 s44, s44, 16384
    v_exp_f32 v153, v21
    v_mfma_f32_16x16x32_bf16 v[64:67], a[80:83], a[12:15], v[116:119]
    s_waitcnt lgkmcnt(9)
    ds_read_b64_tr_b16 a[22:23], v177 offset:4096
    v_cvt_pk_bf16_f32 v78, v152, v153
    v_mfma_f32_16x16x32_bf16 v[40:43], a[84:87], a[32:35], v[40:43]
    v_exp_f32 v154, v22
    v_mfma_f32_16x16x32_bf16 v[56:59], a[84:87], a[40:43], v[56:59]
    ds_read_b64_tr_b16 a[24:25], v178 offset:0
    v_mfma_f32_16x16x32_bf16 v[48:51], a[84:87], a[36:39], v[48:51]
    v_exp_f32 v155, v23
    v_mfma_f32_16x16x32_bf16 v[64:67], a[84:87], a[44:47], v[64:67]
    s_waitcnt lgkmcnt(10)
    ds_read_b64_tr_b16 a[26:27], v178 offset:4096
    v_cvt_pk_bf16_f32 v79, v154, v155
    v_mfma_f32_16x16x32_bf16 v[40:43], a[88:91], a[64:67], v[40:43]
    v_exp_f32 v156, v32
    v_mfma_f32_16x16x32_bf16 v[56:59], a[88:91], a[72:75], v[56:59]
    ds_read_b64_tr_b16 a[28:29], v179 offset:0
    v_mfma_f32_16x16x32_bf16 v[124:127], v[128:131], v[76:79], 0
    ds_read_b64_tr_b16 a[30:31], v179 offset:4096
    v_mfma_f32_16x16x32_bf16 v[48:51], a[88:91], a[68:71], v[48:51]
    v_exp_f32 v157, v33
    v_mfma_f32_16x16x32_bf16 v[64:67], a[88:91], a[76:79], v[64:67]
    s_waitcnt lgkmcnt(12)
    ds_read_b64_tr_b16 a[48:49], v180 offset:0
    v_add_f32 v167, v156, v157
    v_mfma_f32_16x16x32_bf16 v[40:43], a[92:95], a[96:99], v[40:43]
    v_exp_f32 v158, v34
    v_mfma_f32_16x16x32_bf16 v[56:59], a[92:95], a[104:107], v[56:59]
    ds_read_b64_tr_b16 a[50:51], v180 offset:4096
    v_add_f32 v167, v167, v158
    v_mfma_f32_16x16x32_bf16 v[48:51], a[92:95], a[100:103], v[48:51]
    v_exp_f32 v159, v35
    v_mfma_f32_16x16x32_bf16 v[64:67], a[92:95], a[108:111], v[64:67]
    s_waitcnt lgkmcnt(13)
    ds_read_b64_tr_b16 a[52:53], v181 offset:0
    v_add_f32 v167, v167, v159
    v_mfma_f32_16x16x32_bf16 v[44:47], a[112:115], a[0:3], v[104:107]
    v_exp_f32 v160, v36
    v_mfma_f32_16x16x32_bf16 v[60:63], a[112:115], a[8:11], v[112:115]
    ds_read_b64_tr_b16 a[54:55], v181 offset:4096
    v_add_f32 v167, v167, v160
    v_mfma_f32_16x16x32_bf16 v[52:55], a[112:115], a[4:7], v[108:111]
    v_exp_f32 v161, v37
    v_mfma_f32_16x16x32_bf16 v[68:71], a[112:115], a[12:15], v[116:119]
    s_waitcnt lgkmcnt(14)
    ds_read_b64_tr_b16 a[56:57], v182 offset:0
    v_add_f32 v167, v167, v161
    v_mfma_f32_16x16x32_bf16 v[44:47], a[116:119], a[32:35], v[44:47]
    v_exp_f32 v162, v38
    v_mfma_f32_16x16x32_bf16 v[60:63], a[116:119], a[40:43], v[60:63]
    ds_read_b64_tr_b16 a[58:59], v182 offset:4096
    v_add_f32 v167, v167, v162
    v_mfma_f32_16x16x32_bf16 v[52:55], a[116:119], a[36:39], v[52:55]
    v_exp_f32 v163, v39
    v_mfma_f32_16x16x32_bf16 v[68:71], a[116:119], a[44:47], v[68:71]
    s_waitcnt lgkmcnt(15)
    ds_read_b64_tr_b16 a[60:61], v183 offset:0
    v_max3_f32 v184, v120, v124, v166
    v_mfma_f32_16x16x32_bf16 v[44:47], a[120:123], a[64:67], v[44:47]
    v_exp_f32 v132, v40
    v_mfma_f32_16x16x32_bf16 v[60:63], a[120:123], a[72:75], v[60:63]
    s_nop 0
    v_add_f32 v167, v167, v163
    v_max_f32 v184, v184, v167
    v_mfma_f32_16x16x32_bf16 v[52:55], a[120:123], a[68:71], v[52:55]
    v_exp_f32 v133, v41
    v_mfma_f32_16x16x32_bf16 v[68:71], a[120:123], a[76:79], v[68:71]
    s_waitcnt lgkmcnt(15)
    v_cmp_lt_f32 vcc, s48, v184
    v_cvt_pk_bf16_f32 v88, v132, v133
    v_mfma_f32_16x16x32_bf16 v[44:47], a[124:127], a[96:99], v[44:47]
    v_exp_f32 v134, v42
    v_mfma_f32_16x16x32_bf16 v[60:63], a[124:127], a[104:107], v[60:63]
    s_nop 0
    v_cvt_pk_bf16_f32 v84, v156, v157
    v_cvt_pk_bf16_f32 v85, v158, v159
    v_mfma_f32_16x16x32_bf16 v[52:55], a[124:127], a[100:103], v[52:55]
    s_cbranch_vccnz mk_stubl8
mk_okl8:
    v_exp_f32 v135, v43
    v_mfma_f32_16x16x32_bf16 v[68:71], a[124:127], a[108:111], v[68:71]
    s_waitcnt lgkmcnt(13)
    ds_read_b64_tr_b16 a[62:63], v183 offset:4096
    v_cvt_pk_bf16_f32 v89, v134, v135
    v_mfma_f32_16x16x32_bf16 a[128:131], a[16:19], v[72:75], a[128:131]
    s_waitcnt lgkmcnt(12)
    v_exp_f32 v136, v44
    v_mfma_f32_16x16x32_bf16 a[132:135], a[20:23], v[72:75], a[132:135]
    s_waitcnt lgkmcnt(10)
    ds_read_b128 a[80:83], v172 offset:40960
    v_add_f32 v168, v168, v120
    v_mfma_f32_16x16x32_bf16 a[136:139], a[24:27], v[72:75], a[136:139]
    s_waitcnt lgkmcnt(9)
    v_exp_f32 v137, v45
    v_mfma_f32_16x16x32_bf16 a[140:143], a[28:31], v[72:75], a[140:143]
    s_waitcnt lgkmcnt(7)
    ds_read_b128 a[84:87], v173 offset:40960
    v_cvt_pk_bf16_f32 v90, v136, v137
    v_mfma_f32_16x16x32_bf16 a[144:147], a[48:51], v[72:75], a[144:147]
    s_add_u32 m0, s47, 32768
    s_waitcnt lgkmcnt(6)
    v_exp_f32 v138, v46
    v_mfma_f32_16x16x32_bf16 a[148:151], a[52:55], v[72:75], a[148:151]
    s_waitcnt lgkmcnt(4)
    buffer_load_dwordx4 v251, s[40:43], s45 offen offset:0 nt lds
    v_add_f32 v170, v170, v166
    v_mfma_f32_16x16x32_bf16 a[152:155], a[56:59], v[72:75], a[152:155]
    s_waitcnt lgkmcnt(2)
    v_exp_f32 v139, v47
    v_mfma_f32_16x16x32_bf16 a[156:159], a[60:63], v[72:75], a[156:159]
    ds_read_b128 a[88:91], v174 offset:40960
    v_cvt_pk_bf16_f32 v91, v138, v139
    v_mfma_f32_16x16x32_bf16 a[192:195], a[16:19], v[80:83], a[192:195]
    v_exp_f32 v140, v56
    v_mfma_f32_16x16x32_bf16 a[196:199], a[20:23], v[80:83], a[196:199]
    ds_read_b128 a[92:95], v175 offset:40960
    v_cvt_pk_bf16_f32 v86, v160, v161
    v_mfma_f32_16x16x32_bf16 v[120:123], v[128:131], v[88:91], 0
    ds_read_b128 a[112:115], v172 offset:45056
    v_cvt_pk_bf16_f32 v87, v162, v163
    v_mfma_f32_16x16x32_bf16 a[200:203], a[24:27], v[80:83], a[200:203]
    v_exp_f32 v141, v57
    v_mfma_f32_16x16x32_bf16 a[204:207], a[28:31], v[80:83], a[204:207]
    buffer_load_dwordx4 v252, s[40:43], s45 offen offset:1024 nt lds
    v_add_f32 v166, v140, v141
    v_mfma_f32_16x16x32_bf16 a[208:211], a[48:51], v[80:83], a[208:211]
    v_exp_f32 v142, v58
    v_mfma_f32_16x16x32_bf16 a[212:215], a[52:55], v[80:83], a[212:215]
    ds_read_b128 a[116:119], v173 offset:45056
    v_add_f32 v166, v166, v142
    v_mfma_f32_16x16x32_bf16 a[216:219], a[56:59], v[80:83], a[216:219]
    v_exp_f32 v143, v59
    v_mfma_f32_16x16x32_bf16 a[220:223], a[60:63], v[80:83], a[220:223]
    s_nop 0
    v_add_f32 v166, v166, v143
    v_add_f32 v169, v169, v124
    v_mfma_f32_16x16x32_bf16 a[160:163], a[16:19], v[76:79], a[160:163]
    v_exp_f32 v144, v60
    v_mfma_f32_16x16x32_bf16 a[164:167], a[20:23], v[76:79], a[164:167]
    ds_read_b128 a[120:123], v174 offset:45056
    v_add_f32 v166, v166, v144
    v_mfma_f32_16x16x32_bf16 a[168:171], a[24:27], v[76:79], a[168:171]
    v_exp_f32 v145, v61
    v_mfma_f32_16x16x32_bf16 a[172:175], a[28:31], v[76:79], a[172:175]
    s_nop 0
    v_add_f32 v166, v166, v145
    v_add_f32 v171, v171, v167
    v_mfma_f32_16x16x32_bf16 a[176:179], a[48:51], v[76:79], a[176:179]
    v_exp_f32 v146, v62
    v_mfma_f32_16x16x32_bf16 a[180:183], a[52:55], v[76:79], a[180:183]
    ds_read_b128 a[124:127], v175 offset:45056
    v_add_f32 v166, v166, v146
    v_mfma_f32_16x16x32_bf16 a[184:187], a[56:59], v[76:79], a[184:187]
    v_exp_f32 v147, v63
    v_mfma_f32_16x16x32_bf16 a[188:191], a[60:63], v[76:79], a[188:191]
    s_nop 0
    v_add_f32 v166, v166, v147
    v_cvt_pk_bf16_f32 v96, v140, v141
    v_mfma_f32_16x16x32_bf16 a[224:227], a[16:19], v[84:87], a[224:227]
    v_exp_f32 v148, v48
    v_mfma_f32_16x16x32_bf16 a[228:231], a[20:23], v[84:87], a[228:231]
    ds_read_b64_tr_b16 a[16:17], v176 offset:8192
    v_cvt_pk_bf16_f32 v97, v142, v143
    v_mfma_f32_16x16x32_bf16 a[232:235], a[24:27], v[84:87], a[232:235]
    v_exp_f32 v149, v49
    v_mfma_f32_16x16x32_bf16 a[236:239], a[28:31], v[84:87], a[236:239]
    buffer_load_dwordx4 v251, s[40:43], s45 offen offset:2048 nt lds
    v_cvt_pk_bf16_f32 v92, v148, v149
    v_mfma_f32_16x16x32_bf16 a[240:243], a[48:51], v[84:87], a[240:243]
    v_exp_f32 v150, v50
    v_mfma_f32_16x16x32_bf16 a[244:247], a[52:55], v[84:87], a[244:247]
    ds_read_b64_tr_b16 a[18:19], v176 offset:12288
    v_cvt_pk_bf16_f32 v98, v144, v145
    v_mfma_f32_16x16x32_bf16 a[248:251], a[56:59], v[84:87], a[248:251]
    v_exp_f32 v151, v51
    v_mfma_f32_16x16x32_bf16 a[252:255], a[60:63], v[84:87], a[252:255]
    s_waitcnt lgkmcnt(9)
    ds_read_b64_tr_b16 a[20:21], v177 offset:8192
    v_cvt_pk_bf16_f32 v93, v150, v151
    v_mfma_f32_16x16x32_bf16 v[8:11], a[80:83], a[0:3], v[104:107]
    v_exp_f32 v152, v52
    v_mfma_f32_16x16x32_bf16 v[24:27], a[80:83], a[8:11], v[112:115]
    buffer_load_dwordx4 v252, s[40:43], s45 offen offset:3072 nt lds
    v_cvt_pk_bf16_f32 v99, v146, v147
    v_mfma_f32_16x16x32_bf16 v[16:19], a[80:83], a[4:7], v[108:111]
    s_add_u32 s45, s45, 16384
    v_exp_f32 v153, v53
    v_mfma_f32_16x16x32_bf16 v[32:35], a[80:83], a[12:15], v[116:119]
    s_waitcnt lgkmcnt(9)
    ds_read_b64_tr_b16 a[22:23], v177 offset:12288
    v_cvt_pk_bf16_f32 v94, v152, v153
    v_mfma_f32_16x16x32_bf16 v[8:11], a[84:87], a[32:35], v[8:11]
    v_exp_f32 v154, v54
    v_mfma_f32_16x16x32_bf16 v[24:27], a[84:87], a[40:43], v[24:27]
    ds_read_b64_tr_b16 a[24:25], v178 offset:8192
    v_mfma_f32_16x16x32_bf16 v[16:19], a[84:87], a[36:39], v[16:19]
    v_exp_f32 v155, v55
    v_mfma_f32_16x16x32_bf16 v[32:35], a[84:87], a[44:47], v[32:35]
    s_waitcnt lgkmcnt(10)
    ds_read_b64_tr_b16 a[26:27], v178 offset:12288
    v_cvt_pk_bf16_f32 v95, v154, v155
    v_mfma_f32_16x16x32_bf16 v[8:11], a[88:91], a[64:67], v[8:11]
    v_exp_f32 v156, v64
    v_mfma_f32_16x16x32_bf16 v[24:27], a[88:91], a[72:75], v[24:27]
    ds_read_b64_tr_b16 a[28:29], v179 offset:8192
    v_mfma_f32_16x16x32_bf16 v[124:127], v[128:131], v[92:95], 0
    ds_read_b64_tr_b16 a[30:31], v179 offset:12288
    v_mfma_f32_16x16x32_bf16 v[16:19], a[88:91], a[68:71], v[16:19]
    v_exp_f32 v157, v65
    v_mfma_f32_16x16x32_bf16 v[32:35], a[88:91], a[76:79], v[32:35]
    s_waitcnt lgkmcnt(12)
    ds_read_b64_tr_b16 a[48:49], v180 offset:8192
    v_add_f32 v167, v156, v157
    v_mfma_f32_16x16x32_bf16 v[8:11], a[92:95], a[96:99], v[8:11]
    v_exp_f32 v158, v66
    v_mfma_f32_16x16x32_bf16 v[24:27], a[92:95], a[104:107], v[24:27]
    ds_read_b64_tr_b16 a[50:51], v180 offset:12288
    v_add_f32 v167, v167, v158
    v_mfma_f32_16x16x32_bf16 v[16:19], a[92:95], a[100:103], v[16:19]
    v_exp_f32 v159, v67
    v_mfma_f32_16x16x32_bf16 v[32:35], a[92:95], a[108:111], v[32:35]
    s_waitcnt lgkmcnt(13)
    ds_read_b64_tr_b16 a[52:53], v181 offset:8192
    v_add_f32 v167, v167, v159
    v_mfma_f32_16x16x32_bf16 v[12:15], a[112:115], a[0:3], v[104:107]
    v_exp_f32 v160, v68
    v_mfma_f32_16x16x32_bf16 v[28:31], a[112:115], a[8:11], v[112:115]
    ds_read_b64_tr_b16 a[54:55], v181 offset:12288
    v_add_f32 v167, v167, v160
    v_mfma_f32_16x16x32_bf16 v[20:23], a[112:115], a[4:7], v[108:111]
    v_exp_f32 v161, v69
    v_mfma_f32_16x16x32_bf16 v[36:39], a[112:115], a[12:15], v[116:119]
    s_waitcnt lgkmcnt(14)
    ds_read_b64_tr_b16 a[56:57], v182 offset:8192
    v_add_f32 v167, v167, v161
    v_mfma_f32_16x16x32_bf16 v[12:15], a[116:119], a[32:35], v[12:15]
    v_exp_f32 v162, v70
    v_mfma_f32_16x16x32_bf16 v[28:31], a[116:119], a[40:43], v[28:31]
    ds_read_b64_tr_b16 a[58:59], v182 offset:12288
    v_add_f32 v167, v167, v162
    v_mfma_f32_16x16x32_bf16 v[20:23], a[116:119], a[36:39], v[20:23]
    v_exp_f32 v163, v71
    v_mfma_f32_16x16x32_bf16 v[36:39], a[116:119], a[44:47], v[36:39]
    s_waitcnt lgkmcnt(15)
    ds_read_b64_tr_b16 a[60:61], v183 offset:8192
    v_max3_f32 v184, v120, v124, v166
    v_mfma_f32_16x16x32_bf16 v[12:15], a[120:123], a[64:67], v[12:15]
    v_exp_f32 v132, v8
    v_mfma_f32_16x16x32_bf16 v[28:31], a[120:123], a[72:75], v[28:31]
    s_nop 0
    v_add_f32 v167, v167, v163
    v_max_f32 v184, v184, v167
    v_mfma_f32_16x16x32_bf16 v[20:23], a[120:123], a[68:71], v[20:23]
    v_exp_f32 v133, v9
    v_mfma_f32_16x16x32_bf16 v[36:39], a[120:123], a[76:79], v[36:39]
    s_waitcnt lgkmcnt(15)
    v_cmp_lt_f32 vcc, s48, v184
    v_cvt_pk_bf16_f32 v72, v132, v133
    v_mfma_f32_16x16x32_bf16 v[12:15], a[124:127], a[96:99], v[12:15]
    v_exp_f32 v134, v10
    v_mfma_f32_16x16x32_bf16 v[28:31], a[124:127], a[104:107], v[28:31]
    s_nop 0
    v_cvt_pk_bf16_f32 v100, v156, v157
    v_cvt_pk_bf16_f32 v101, v158, v159
    v_mfma_f32_16x16x32_bf16 v[20:23], a[124:127], a[100:103], v[20:23]
    s_cbranch_vccnz mk_stubl9
mk_okl9:
    v_exp_f32 v135, v11
    v_mfma_f32_16x16x32_bf16 v[36:39], a[124:127], a[108:111], v[36:39]
    s_waitcnt lgkmcnt(13)
    ds_read_b64_tr_b16 a[62:63], v183 offset:12288
    v_cvt_pk_bf16_f32 v73, v134, v135
    s_sub_u32 s49, s49, 1
    s_cmp_lg_u32 s49, 0
    s_cbranch_scc1 mk_loop
    v_mfma_f32_16x16x32_bf16 a[128:131], a[16:19], v[88:91], a[128:131]
    s_waitcnt lgkmcnt(12)
    v_exp_f32 v136, v12
    v_mfma_f32_16x16x32_bf16 a[132:135], a[20:23], v[88:91], a[132:135]
    s_waitcnt vmcnt(9)
    s_barrier
    s_waitcnt lgkmcnt(10)
    ds_read_b128 a[80:83], v172 offset:49152
    v_add_f32 v168, v168, v120
    v_mfma_f32_16x16x32_bf16 a[136:139], a[24:27], v[88:91], a[136:139]
    s_waitcnt lgkmcnt(9)
    v_exp_f32 v137, v13
    v_mfma_f32_16x16x32_bf16 a[140:143], a[28:31], v[88:91], a[140:143]
    s_waitcnt lgkmcnt(7)
    ds_read_b128 a[84:87], v173 offset:49152
    v_cvt_pk_bf16_f32 v74, v136, v137
    v_mfma_f32_16x16x32_bf16 a[144:147], a[48:51], v[88:91], a[144:147]
    s_add_u32 m0, s46, 16384
    s_waitcnt lgkmcnt(6)
    v_exp_f32 v138, v14
    v_mfma_f32_16x16x32_bf16 a[148:151], a[52:55], v[88:91], a[148:151]
    s_waitcnt lgkmcnt(4)
    buffer_load_dwordx4 v247, s[36:39], s44 offen offset:0 nt lds
    v_add_f32 v170, v170, v166
    v_mfma_f32_16x16x32_bf16 a[152:155], a[56:59], v[88:91], a[152:155]
    s_waitcnt lgkmcnt(2)
    v_exp_f32 v139, v15
    v_mfma_f32_16x16x32_bf16 a[156:159], a[60:63], v[88:91], a[156:159]
    ds_read_b128 a[88:91], v174 offset:49152
    v_cvt_pk_bf16_f32 v75, v138, v139
    v_mfma_f32_16x16x32_bf16 a[192:195], a[16:19], v[96:99], a[192:195]
    v_exp_f32 v140, v24
    v_mfma_f32_16x16x32_bf16 a[196:199], a[20:23], v[96:99], a[196:199]
    ds_read_b128 a[92:95], v175 offset:49152
    v_cvt_pk_bf16_f32 v102, v160, v161
    v_mfma_f32_16x16x32_bf16 v[120:123], v[128:131], v[72:75], 0
    ds_read_b128 a[112:115], v172 offset:53248
    v_cvt_pk_bf16_f32 v103, v162, v163
    v_mfma_f32_16x16x32_bf16 a[200:203], a[24:27], v[96:99], a[200:203]
    v_exp_f32 v141, v25
    v_mfma_f32_16x16x32_bf16 a[204:207], a[28:31], v[96:99], a[204:207]
    buffer_load_dwordx4 v248, s[36:39], s44 offen offset:1024 nt lds
    v_add_f32 v166, v140, v141
    v_mfma_f32_16x16x32_bf16 a[208:211], a[48:51], v[96:99], a[208:211]
    v_exp_f32 v142, v26
    v_mfma_f32_16x16x32_bf16 a[212:215], a[52:55], v[96:99], a[212:215]
    ds_read_b128 a[116:119], v173 offset:53248
    v_add_f32 v166, v166, v142
    v_mfma_f32_16x16x32_bf16 a[216:219], a[56:59], v[96:99], a[216:219]
    v_exp_f32 v143, v27
    v_mfma_f32_16x16x32_bf16 a[220:223], a[60:63], v[96:99], a[220:223]
    s_nop 0
    v_add_f32 v166, v166, v143
    v_add_f32 v169, v169, v124
    v_mfma_f32_16x16x32_bf16 a[160:163], a[16:19], v[92:95], a[160:163]
    v_exp_f32 v144, v28
    v_mfma_f32_16x16x32_bf16 a[164:167], a[20:23], v[92:95], a[164:167]
    ds_read_b128 a[120:123], v174 offset:53248
    v_add_f32 v166, v166, v144
    v_mfma_f32_16x16x32_bf16 a[168:171], a[24:27], v[92:95], a[168:171]
    v_exp_f32 v145, v29
    v_mfma_f32_16x16x32_bf16 a[172:175], a[28:31], v[92:95], a[172:175]
    s_nop 0
    v_add_f32 v166, v166, v145
    v_add_f32 v171, v171, v167
    v_mfma_f32_16x16x32_bf16 a[176:179], a[48:51], v[92:95], a[176:179]
    v_exp_f32 v146, v30
    v_mfma_f32_16x16x32_bf16 a[180:183], a[52:55], v[92:95], a[180:183]
    ds_read_b128 a[124:127], v175 offset:53248
    v_add_f32 v166, v166, v146
    v_mfma_f32_16x16x32_bf16 a[184:187], a[56:59], v[92:95], a[184:187]
    v_exp_f32 v147, v31
    v_mfma_f32_16x16x32_bf16 a[188:191], a[60:63], v[92:95], a[188:191]
    s_nop 0
    v_add_f32 v166, v166, v147
    v_cvt_pk_bf16_f32 v80, v140, v141
    v_mfma_f32_16x16x32_bf16 a[224:227], a[16:19], v[100:103], a[224:227]
    v_exp_f32 v148, v16
    v_mfma_f32_16x16x32_bf16 a[228:231], a[20:23], v[100:103], a[228:231]
    ds_read_b64_tr_b16 a[16:17], v176 offset:16384
    v_cvt_pk_bf16_f32 v81, v142, v143
    v_mfma_f32_16x16x32_bf16 a[232:235], a[24:27], v[100:103], a[232:235]
    v_exp_f32 v149, v17
    v_mfma_f32_16x16x32_bf16 a[236:239], a[28:31], v[100:103], a[236:239]
    buffer_load_dwordx4 v249, s[36:39], s44 offen offset:2048 nt lds
    v_cvt_pk_bf16_f32 v76, v148, v149
    v_mfma_f32_16x16x32_bf16 a[240:243], a[48:51], v[100:103], a[240:243]
    v_exp_f32 v150, v18
    v_mfma_f32_16x16x32_bf16 a[244:247], a[52:55], v[100:103], a[244:247]
    ds_read_b64_tr_b16 a[18:19], v176 offset:20480
    v_cvt_pk_bf16_f32 v82, v144, v145
    v_mfma_f32_16x16x32_bf16 a[248:251], a[56:59], v[100:103], a[248:251]
    v_exp_f32 v151, v19
    v_mfma_f32_16x16x32_bf16 a[252:255], a[60:63], v[100:103], a[252:255]
    s_waitcnt lgkmcnt(9)
    ds_read_b64_tr_b16 a[20:21], v177 offset:16384
    v_cvt_pk_bf16_f32 v77, v150, v151
    v_mfma_f32_16x16x32_bf16 v[40:43], a[80:83], a[0:3], v[104:107]
    v_exp_f32 v152, v20
    v_mfma_f32_16x16x32_bf16 v[56:59], a[80:83], a[8:11], v[112:115]
    buffer_load_dwordx4 v250, s[36:39], s44 offen offset:3072 nt lds
    v_cvt_pk_bf16_f32 v83, v146, v147
    v_mfma_f32_16x16x32_bf16 v[48:51], a[80:83], a[4:7], v[108:111]
    s_add_u32 s44, s44, 16384
    v_exp_f32 v153, v21
    v_mfma_f32_16x16x32_bf16 v[64:67], a[80:83], a[12:15], v[116:119]
    s_waitcnt lgkmcnt(9)
    ds_read_b64_tr_b16 a[22:23], v177 offset:20480
    v_cvt_pk_bf16_f32 v78, v152, v153
    v_mfma_f32_16x16x32_bf16 v[40:43], a[84:87], a[32:35], v[40:43]
    v_exp_f32 v154, v22
    v_mfma_f32_16x16x32_bf16 v[56:59], a[84:87], a[40:43], v[56:59]
    ds_read_b64_tr_b16 a[24:25], v178 offset:16384
    v_mfma_f32_16x16x32_bf16 v[48:51], a[84:87], a[36:39], v[48:51]
    v_exp_f32 v155, v23
    v_mfma_f32_16x16x32_bf16 v[64:67], a[84:87], a[44:47], v[64:67]
    s_waitcnt lgkmcnt(10)
    ds_read_b64_tr_b16 a[26:27], v178 offset:20480
    v_cvt_pk_bf16_f32 v79, v154, v155
    v_mfma_f32_16x16x32_bf16 v[40:43], a[88:91], a[64:67], v[40:43]
    v_exp_f32 v156, v32
    v_mfma_f32_16x16x32_bf16 v[56:59], a[88:91], a[72:75], v[56:59]
    ds_read_b64_tr_b16 a[28:29], v179 offset:16384
    v_mfma_f32_16x16x32_bf16 v[124:127], v[128:131], v[76:79], 0
    ds_read_b64_tr_b16 a[30:31], v179 offset:20480
    v_mfma_f32_16x16x32_bf16 v[48:51], a[88:91], a[68:71], v[48:51]
    v_exp_f32 v157, v33
    v_mfma_f32_16x16x32_bf16 v[64:67], a[88:91], a[76:79], v[64:67]
    s_waitcnt lgkmcnt(12)
    ds_read_b64_tr_b16 a[48:49], v180 offset:16384
    v_add_f32 v167, v156, v157
    v_mfma_f32_16x16x32_bf16 v[40:43], a[92:95], a[96:99], v[40:43]
    v_exp_f32 v158, v34
    v_mfma_f32_16x16x32_bf16 v[56:59], a[92:95], a[104:107], v[56:59]
    ds_read_b64_tr_b16 a[50:51], v180 offset:20480
    v_add_f32 v167, v167, v158
    v_mfma_f32_16x16x32_bf16 v[48:51], a[92:95], a[100:103], v[48:51]
    v_exp_f32 v159, v35
    v_mfma_f32_16x16x32_bf16 v[64:67], a[92:95], a[108:111], v[64:67]
    s_waitcnt lgkmcnt(13)
    ds_read_b64_tr_b16 a[52:53], v181 offset:16384
    v_add_f32 v167, v167, v159
    v_mfma_f32_16x16x32_bf16 v[44:47], a[112:115], a[0:3], v[104:107]
    v_exp_f32 v160, v36
    v_mfma_f32_16x16x32_bf16 v[60:63], a[112:115], a[8:11], v[112:115]
    ds_read_b64_tr_b16 a[54:55], v181 offset:20480
    v_add_f32 v167, v167, v160
    v_mfma_f32_16x16x32_bf16 v[52:55], a[112:115], a[4:7], v[108:111]
    v_exp_f32 v161, v37
    v_mfma_f32_16x16x32_bf16 v[68:71], a[112:115], a[12:15], v[116:119]
    s_waitcnt lgkmcnt(14)
    ds_read_b64_tr_b16 a[56:57], v182 offset:16384
    v_add_f32 v167, v167, v161
    v_mfma_f32_16x16x32_bf16 v[44:47], a[116:119], a[32:35], v[44:47]
    v_exp_f32 v162, v38
    v_mfma_f32_16x16x32_bf16 v[60:63], a[116:119], a[40:43], v[60:63]
    ds_read_b64_tr_b16 a[58:59], v182 offset:20480
    v_add_f32 v167, v167, v162
    v_mfma_f32_16x16x32_bf16 v[52:55], a[116:119], a[36:39], v[52:55]
    v_exp_f32 v163, v39
    v_mfma_f32_16x16x32_bf16 v[68:71], a[116:119], a[44:47], v[68:71]
    s_waitcnt lgkmcnt(15)
    ds_read_b64_tr_b16 a[60:61], v183 offset:16384
    v_max3_f32 v184, v120, v124, v166
    v_mfma_f32_16x16x32_bf16 v[44:47], a[120:123], a[64:67], v[44:47]
    v_exp_f32 v132, v40
    v_mfma_f32_16x16x32_bf16 v[60:63], a[120:123], a[72:75], v[60:63]
    s_nop 0
    v_add_f32 v167, v167, v163
    v_max_f32 v184, v184, v167
    v_mfma_f32_16x16x32_bf16 v[52:55], a[120:123], a[68:71], v[52:55]
    v_exp_f32 v133, v41
    v_mfma_f32_16x16x32_bf16 v[68:71], a[120:123], a[76:79], v[68:71]
    s_waitcnt lgkmcnt(15)
    v_cmp_lt_f32 vcc, s48, v184
    v_cvt_pk_bf16_f32 v88, v132, v133
    v_mfma_f32_16x16x32_bf16 v[44:47], a[124:127], a[96:99], v[44:47]
    v_exp_f32 v134, v42
    v_mfma_f32_16x16x32_bf16 v[60:63], a[124:127], a[104:107], v[60:63]
    s_nop 0
    v_cvt_pk_bf16_f32 v84, v156, v157
    v_cvt_pk_bf16_f32 v85, v158, v159
    v_mfma_f32_16x16x32_bf16 v[52:55], a[124:127], a[100:103], v[52:55]
    s_cbranch_vccnz mk_stubt58
mk_okt58:
    v_exp_f32 v135, v43
    v_mfma_f32_16x16x32_bf16 v[68:71], a[124:127], a[108:111], v[68:71]
    s_waitcnt lgkmcnt(13)
    ds_read_b64_tr_b16 a[62:63], v183 offset:20480
    v_cvt_pk_bf16_f32 v89, v134, v135
    v_mfma_f32_16x16x32_bf16 a[128:131], a[16:19], v[72:75], a[128:131]
    s_waitcnt lgkmcnt(12)
    v_exp_f32 v136, v44
    v_mfma_f32_16x16x32_bf16 a[132:135], a[20:23], v[72:75], a[132:135]
    s_waitcnt lgkmcnt(10)
    ds_read_b128 a[80:83], v172 offset:57344
    v_add_f32 v168, v168, v120
    v_mfma_f32_16x16x32_bf16 a[136:139], a[24:27], v[72:75], a[136:139]
    s_waitcnt lgkmcnt(9)
    v_exp_f32 v137, v45
    v_mfma_f32_16x16x32_bf16 a[140:143], a[28:31], v[72:75], a[140:143]
    s_waitcnt lgkmcnt(7)
    ds_read_b128 a[84:87], v173 offset:57344
    v_cvt_pk_bf16_f32 v90, v136, v137
    v_mfma_f32_16x16x32_bf16 a[144:147], a[48:51], v[72:75], a[144:147]
    s_add_u32 m0, s47, 49152
    s_waitcnt lgkmcnt(6)
    v_exp_f32 v138, v46
    v_mfma_f32_16x16x32_bf16 a[148:151], a[52:55], v[72:75], a[148:151]
    s_waitcnt lgkmcnt(4)
    buffer_load_dwordx4 v251, s[40:43], s45 offen offset:0 nt lds
    v_add_f32 v170, v170, v166
    v_mfma_f32_16x16x32_bf16 a[152:155], a[56:59], v[72:75], a[152:155]
    s_waitcnt lgkmcnt(2)
    v_exp_f32 v139, v47
    v_mfma_f32_16x16x32_bf16 a[156:159], a[60:63], v[72:75], a[156:159]
    ds_read_b128 a[88:91], v174 offset:57344
    v_cvt_pk_bf16_f32 v91, v138, v139
    v_mfma_f32_16x16x32_bf16 a[192:195], a[16:19], v[80:83], a[192:195]
    v_exp_f32 v140, v56
    v_mfma_f32_16x16x32_bf16 a[196:199], a[20:23], v[80:83], a[196:199]
    ds_read_b128 a[92:95], v175 offset:57344
    v_cvt_pk_bf16_f32 v86, v160, v161
    v_mfma_f32_16x16x32_bf16 v[120:123], v[128:131], v[88:91], 0
    ds_read_b128 a[112:115], v172 offset:61440
    v_cvt_pk_bf16_f32 v87, v162, v163
    v_mfma_f32_16x16x32_bf16 a[200:203], a[24:27], v[80:83], a[200:203]
    v_exp_f32 v141, v57
    v_mfma_f32_16x16x32_bf16 a[204:207], a[28:31], v[80:83], a[204:207]
    buffer_load_dwordx4 v252, s[40:43], s45 offen offset:1024 nt lds
    v_add_f32 v166, v140, v141
    v_mfma_f32_16x16x32_bf16 a[208:211], a[48:51], v[80:83], a[208:211]
    v_exp_f32 v142, v58
    v_mfma_f32_16x16x32_bf16 a[212:215], a[52:55], v[80:83], a[212:215]
    ds_read_b128 a[116:119], v173 offset:61440
    v_add_f32 v166, v166, v142
    v_mfma_f32_16x16x32_bf16 a[216:219], a[56:59], v[80:83], a[216:219]
    v_exp_f32 v143, v59
    v_mfma_f32_16x16x32_bf16 a[220:223], a[60:63], v[80:83], a[220:223]
    s_nop 0
    v_add_f32 v166, v166, v143
    v_add_f32 v169, v169, v124
    v_mfma_f32_16x16x32_bf16 a[160:163], a[16:19], v[76:79], a[160:163]
    v_exp_f32 v144, v60
    v_mfma_f32_16x16x32_bf16 a[164:167], a[20:23], v[76:79], a[164:167]
    ds_read_b128 a[120:123], v174 offset:61440
    v_add_f32 v166, v166, v144
    v_mfma_f32_16x16x32_bf16 a[168:171], a[24:27], v[76:79], a[168:171]
    v_exp_f32 v145, v61
    v_mfma_f32_16x16x32_bf16 a[172:175], a[28:31], v[76:79], a[172:175]
    s_nop 0
    v_add_f32 v166, v166, v145
    v_add_f32 v171, v171, v167
    v_mfma_f32_16x16x32_bf16 a[176:179], a[48:51], v[76:79], a[176:179]
    v_exp_f32 v146, v62
    v_mfma_f32_16x16x32_bf16 a[180:183], a[52:55], v[76:79], a[180:183]
    ds_read_b128 a[124:127], v175 offset:61440
    v_add_f32 v166, v166, v146
    v_mfma_f32_16x16x32_bf16 a[184:187], a[56:59], v[76:79], a[184:187]
    v_exp_f32 v147, v63
    v_mfma_f32_16x16x32_bf16 a[188:191], a[60:63], v[76:79], a[188:191]
    buffer_load_dwordx4 v251, s[40:43], s45 offen offset:2048 nt lds
    v_add_f32 v166, v166, v147
    v_mfma_f32_16x16x32_bf16 a[224:227], a[16:19], v[84:87], a[224:227]
    v_exp_f32 v148, v48
    v_mfma_f32_16x16x32_bf16 a[228:231], a[20:23], v[84:87], a[228:231]
    ds_read_b64_tr_b16 a[16:17], v176 offset:24576
    v_cvt_pk_bf16_f32 v96, v140, v141
    v_mfma_f32_16x16x32_bf16 a[232:235], a[24:27], v[84:87], a[232:235]
    v_exp_f32 v149, v49
    v_mfma_f32_16x16x32_bf16 a[236:239], a[28:31], v[84:87], a[236:239]
    buffer_load_dwordx4 v252, s[40:43], s45 offen offset:3072 nt lds
    v_cvt_pk_bf16_f32 v92, v148, v149
    v_mfma_f32_16x16x32_bf16 a[240:243], a[48:51], v[84:87], a[240:243]
    s_add_u32 s45, s45, 16384
    v_exp_f32 v150, v50
    v_mfma_f32_16x16x32_bf16 a[244:247], a[52:55], v[84:87], a[244:247]
    ds_read_b64_tr_b16 a[18:19], v176 offset:28672
    v_cvt_pk_bf16_f32 v97, v142, v143
    v_mfma_f32_16x16x32_bf16 a[248:251], a[56:59], v[84:87], a[248:251]
    v_exp_f32 v151, v51
    v_mfma_f32_16x16x32_bf16 a[252:255], a[60:63], v[84:87], a[252:255]
    s_waitcnt lgkmcnt(9)
    ds_read_b64_tr_b16 a[20:21], v177 offset:24576
    v_cvt_pk_bf16_f32 v93, v150, v151
    v_mfma_f32_16x16x32_bf16 v[8:11], a[80:83], a[0:3], v[104:107]
    v_exp_f32 v152, v52
    v_mfma_f32_16x16x32_bf16 v[24:27], a[80:83], a[8:11], v[112:115]
    global_load_dwordx4 v[240:243], v[206:207], off
    v_cvt_pk_bf16_f32 v98, v144, v145
    v_mfma_f32_16x16x32_bf16 v[16:19], a[80:83], a[4:7], v[108:111]
    v_exp_f32 v153, v53
    v_mfma_f32_16x16x32_bf16 v[32:35], a[80:83], a[12:15], v[116:119]
    s_waitcnt lgkmcnt(9)
    ds_read_b64_tr_b16 a[22:23], v177 offset:28672
    v_cvt_pk_bf16_f32 v94, v152, v153
    v_mfma_f32_16x16x32_bf16 v[8:11], a[84:87], a[32:35], v[8:11]
    v_exp_f32 v154, v54
    v_mfma_f32_16x16x32_bf16 v[24:27], a[84:87], a[40:43], v[24:27]
    ds_read_b64_tr_b16 a[24:25], v178 offset:24576
    v_cvt_pk_bf16_f32 v99, v146, v147
    v_mfma_f32_16x16x32_bf16 v[16:19], a[84:87], a[36:39], v[16:19]
    v_exp_f32 v155, v55
    v_mfma_f32_16x16x32_bf16 v[32:35], a[84:87], a[44:47], v[32:35]
    s_waitcnt lgkmcnt(10)
    ds_read_b64_tr_b16 a[26:27], v178 offset:28672
    v_cvt_pk_bf16_f32 v95, v154, v155
    v_mfma_f32_16x16x32_bf16 v[8:11], a[88:91], a[64:67], v[8:11]
    v_exp_f32 v156, v64
    v_mfma_f32_16x16x32_bf16 v[24:27], a[88:91], a[72:75], v[24:27]
    ds_read_b64_tr_b16 a[28:29], v179 offset:24576
    v_mfma_f32_16x16x32_bf16 v[124:127], v[128:131], v[92:95], 0
    ds_read_b64_tr_b16 a[30:31], v179 offset:28672
    v_mfma_f32_16x16x32_bf16 v[16:19], a[88:91], a[68:71], v[16:19]
    v_exp_f32 v157, v65
    v_mfma_f32_16x16x32_bf16 v[32:35], a[88:91], a[76:79], v[32:35]
    s_waitcnt lgkmcnt(12)
    ds_read_b64_tr_b16 a[48:49], v180 offset:24576
    v_add_f32 v167, v156, v157
    v_mfma_f32_16x16x32_bf16 v[8:11], a[92:95], a[96:99], v[8:11]
    v_exp_f32 v158, v66
    v_mfma_f32_16x16x32_bf16 v[24:27], a[92:95], a[104:107], v[24:27]
    ds_read_b64_tr_b16 a[50:51], v180 offset:28672
    v_add_f32 v167, v167, v158
    v_mfma_f32_16x16x32_bf16 v[16:19], a[92:95], a[100:103], v[16:19]
    v_exp_f32 v159, v67
    v_mfma_f32_16x16x32_bf16 v[32:35], a[92:95], a[108:111], v[32:35]
    s_waitcnt lgkmcnt(13)
    ds_read_b64_tr_b16 a[52:53], v181 offset:24576
    v_add_f32 v167, v167, v159
    v_mfma_f32_16x16x32_bf16 v[12:15], a[112:115], a[0:3], v[104:107]
    v_exp_f32 v160, v68
    v_mfma_f32_16x16x32_bf16 v[28:31], a[112:115], a[8:11], v[112:115]
    ds_read_b64_tr_b16 a[54:55], v181 offset:28672
    v_add_f32 v167, v167, v160
    v_mfma_f32_16x16x32_bf16 v[20:23], a[112:115], a[4:7], v[108:111]
    v_exp_f32 v161, v69
    v_mfma_f32_16x16x32_bf16 v[36:39], a[112:115], a[12:15], v[116:119]
    s_waitcnt lgkmcnt(14)
    ds_read_b64_tr_b16 a[56:57], v182 offset:24576
    v_add_f32 v167, v167, v161
    v_mfma_f32_16x16x32_bf16 v[12:15], a[116:119], a[32:35], v[12:15]
    v_exp_f32 v162, v70
    v_mfma_f32_16x16x32_bf16 v[28:31], a[116:119], a[40:43], v[28:31]
    ds_read_b64_tr_b16 a[58:59], v182 offset:28672
    v_add_f32 v167, v167, v162
    v_mfma_f32_16x16x32_bf16 v[20:23], a[116:119], a[36:39], v[20:23]
    v_exp_f32 v163, v71
    v_mfma_f32_16x16x32_bf16 v[36:39], a[116:119], a[44:47], v[36:39]
    s_waitcnt lgkmcnt(15)
    ds_read_b64_tr_b16 a[60:61], v183 offset:24576
    v_max3_f32 v184, v120, v124, v166
    v_mfma_f32_16x16x32_bf16 v[12:15], a[120:123], a[64:67], v[12:15]
    v_exp_f32 v132, v8
    v_mfma_f32_16x16x32_bf16 v[28:31], a[120:123], a[72:75], v[28:31]
    s_nop 0
    v_add_f32 v167, v167, v163
    v_max_f32 v184, v184, v167
    v_mfma_f32_16x16x32_bf16 v[20:23], a[120:123], a[68:71], v[20:23]
    v_exp_f32 v133, v9
    v_mfma_f32_16x16x32_bf16 v[36:39], a[120:123], a[76:79], v[36:39]
    s_waitcnt lgkmcnt(15)
    v_cmp_lt_f32 vcc, s48, v184
    v_cvt_pk_bf16_f32 v72, v132, v133
    v_mfma_f32_16x16x32_bf16 v[12:15], a[124:127], a[96:99], v[12:15]
    v_exp_f32 v134, v10
    v_mfma_f32_16x16x32_bf16 v[28:31], a[124:127], a[104:107], v[28:31]
    s_nop 0
    v_cvt_pk_bf16_f32 v100, v156, v157
    v_cvt_pk_bf16_f32 v101, v158, v159
    v_mfma_f32_16x16x32_bf16 v[20:23], a[124:127], a[100:103], v[20:23]
    s_cbranch_vccnz mk_stubt59
mk_okt59:
    v_exp_f32 v135, v11
    v_mfma_f32_16x16x32_bf16 v[36:39], a[124:127], a[108:111], v[36:39]
    s_waitcnt lgkmcnt(13)
    ds_read_b64_tr_b16 a[62:63], v183 offset:28672
    v_cvt_pk_bf16_f32 v73, v134, v135
    v_mfma_f32_16x16x32_bf16 a[128:131], a[16:19], v[88:91], a[128:131]
    s_waitcnt lgkmcnt(12)
    v_exp_f32 v136, v12
    v_mfma_f32_16x16x32_bf16 a[132:135], a[20:23], v[88:91], a[132:135]
    s_waitcnt vmcnt(9)
    s_barrier
    s_waitcnt lgkmcnt(10)
    ds_read_b128 a[80:83], v172 offset:0
    v_add_f32 v168, v168, v120
    v_mfma_f32_16x16x32_bf16 a[136:139], a[24:27], v[88:91], a[136:139]
    s_waitcnt lgkmcnt(9)
    v_exp_f32 v137, v13
    v_mfma_f32_16x16x32_bf16 a[140:143], a[28:31], v[88:91], a[140:143]
    s_waitcnt lgkmcnt(7)
    ds_read_b128 a[84:87], v173 offset:0
    v_cvt_pk_bf16_f32 v74, v136, v137
    v_mfma_f32_16x16x32_bf16 a[144:147], a[48:51], v[88:91], a[144:147]
    s_waitcnt lgkmcnt(6)
    v_exp_f32 v138, v14
    v_mfma_f32_16x16x32_bf16 a[148:151], a[52:55], v[88:91], a[148:151]
    s_waitcnt lgkmcnt(4)
    v_add_f32 v170, v170, v166
    v_cvt_pk_bf16_f32 v102, v160, v161
    v_mfma_f32_16x16x32_bf16 a[152:155], a[56:59], v[88:91], a[152:155]
    s_waitcnt lgkmcnt(2)
    v_exp_f32 v139, v15
    v_mfma_f32_16x16x32_bf16 a[156:159], a[60:63], v[88:91], a[156:159]
    ds_read_b128 a[88:91], v174 offset:0
    v_cvt_pk_bf16_f32 v75, v138, v139
    v_mfma_f32_16x16x32_bf16 a[192:195], a[16:19], v[96:99], a[192:195]
    v_exp_f32 v140, v24
    v_mfma_f32_16x16x32_bf16 a[196:199], a[20:23], v[96:99], a[196:199]
    ds_read_b128 a[92:95], v175 offset:0
    v_cvt_pk_bf16_f32 v103, v162, v163
    v_mfma_f32_16x16x32_bf16 v[120:123], v[128:131], v[72:75], 0
    ds_read_b128 a[112:115], v172 offset:4096
    v_add_f32 v169, v169, v124
    v_mfma_f32_16x16x32_bf16 a[200:203], a[24:27], v[96:99], a[200:203]
    v_exp_f32 v141, v25
    v_mfma_f32_16x16x32_bf16 a[204:207], a[28:31], v[96:99], a[204:207]
    s_nop 0
    v_add_f32 v166, v140, v141
    v_add_f32 v171, v171, v167
    v_mfma_f32_16x16x32_bf16 a[208:211], a[48:51], v[96:99], a[208:211]
    v_exp_f32 v142, v26
    v_mfma_f32_16x16x32_bf16 a[212:215], a[52:55], v[96:99], a[212:215]
    ds_read_b128 a[116:119], v173 offset:4096
    v_add_f32 v166, v166, v142
    v_mfma_f32_16x16x32_bf16 a[216:219], a[56:59], v[96:99], a[216:219]
    v_exp_f32 v143, v27
    v_mfma_f32_16x16x32_bf16 a[220:223], a[60:63], v[96:99], a[220:223]
    s_nop 0
    v_add_f32 v166, v166, v143
    v_cvt_pk_bf16_f32 v80, v140, v141
    v_mfma_f32_16x16x32_bf16 a[160:163], a[16:19], v[92:95], a[160:163]
    v_exp_f32 v144, v28
    v_mfma_f32_16x16x32_bf16 a[164:167], a[20:23], v[92:95], a[164:167]
    ds_read_b128 a[120:123], v174 offset:4096
    v_add_f32 v166, v166, v144
    v_mfma_f32_16x16x32_bf16 a[168:171], a[24:27], v[92:95], a[168:171]
    v_exp_f32 v145, v29
    v_mfma_f32_16x16x32_bf16 a[172:175], a[28:31], v[92:95], a[172:175]
    s_nop 0
    v_add_f32 v166, v166, v145
    v_cvt_pk_bf16_f32 v81, v142, v143
    v_mfma_f32_16x16x32_bf16 a[176:179], a[48:51], v[92:95], a[176:179]
    v_exp_f32 v146, v30
    v_mfma_f32_16x16x32_bf16 a[180:183], a[52:55], v[92:95], a[180:183]
    ds_read_b128 a[124:127], v175 offset:4096
    v_add_f32 v166, v166, v146
    v_mfma_f32_16x16x32_bf16 a[184:187], a[56:59], v[92:95], a[184:187]
    v_exp_f32 v147, v31
    v_mfma_f32_16x16x32_bf16 a[188:191], a[60:63], v[92:95], a[188:191]
    s_nop 0
    v_add_f32 v166, v166, v147
    v_cvt_pk_bf16_f32 v82, v144, v145
    v_mfma_f32_16x16x32_bf16 a[224:227], a[16:19], v[100:103], a[224:227]
    v_exp_f32 v148, v16
    v_mfma_f32_16x16x32_bf16 a[228:231], a[20:23], v[100:103], a[228:231]
    ds_read_b64_tr_b16 a[16:17], v176 offset:32768
    v_cvt_pk_bf16_f32 v83, v146, v147
    v_mfma_f32_16x16x32_bf16 a[232:235], a[24:27], v[100:103], a[232:235]
    v_exp_f32 v149, v17
    v_mfma_f32_16x16x32_bf16 a[236:239], a[28:31], v[100:103], a[236:239]
    v_cvt_pk_bf16_f32 v76, v148, v149
    v_mfma_f32_16x16x32_bf16 a[240:243], a[48:51], v[100:103], a[240:243]
    v_exp_f32 v150, v18
    v_mfma_f32_16x16x32_bf16 a[244:247], a[52:55], v[100:103], a[244:247]
    ds_read_b64_tr_b16 a[18:19], v176 offset:36864
    v_mfma_f32_16x16x32_bf16 a[248:251], a[56:59], v[100:103], a[248:251]
    v_exp_f32 v151, v19
    v_mfma_f32_16x16x32_bf16 a[252:255], a[60:63], v[100:103], a[252:255]
    s_waitcnt lgkmcnt(9)
    ds_read_b64_tr_b16 a[20:21], v177 offset:32768
    v_cvt_pk_bf16_f32 v77, v150, v151
    v_mfma_f32_16x16x32_bf16 v[40:43], a[80:83], a[0:3], v[104:107]
    v_exp_f32 v152, v20
    v_mfma_f32_16x16x32_bf16 v[56:59], a[80:83], a[8:11], v[112:115]
    v_mfma_f32_16x16x32_bf16 v[48:51], a[80:83], a[4:7], v[108:111]
    v_exp_f32 v153, v21
    v_mfma_f32_16x16x32_bf16 v[64:67], a[80:83], a[12:15], v[116:119]
    s_waitcnt lgkmcnt(9)
    ds_read_b64_tr_b16 a[22:23], v177 offset:36864
    v_cvt_pk_bf16_f32 v78, v152, v153
    v_mfma_f32_16x16x32_bf16 v[40:43], a[84:87], a[32:35], v[40:43]
    v_exp_f32 v154, v22
    v_mfma_f32_16x16x32_bf16 v[56:59], a[84:87], a[40:43], v[56:59]
    ds_read_b64_tr_b16 a[24:25], v178 offset:32768
    v_mfma_f32_16x16x32_bf16 v[48:51], a[84:87], a[36:39], v[48:51]
    v_exp_f32 v155, v23
    v_mfma_f32_16x16x32_bf16 v[64:67], a[84:87], a[44:47], v[64:67]
    s_waitcnt lgkmcnt(10)
    ds_read_b64_tr_b16 a[26:27], v178 offset:36864
    v_cvt_pk_bf16_f32 v79, v154, v155
    v_mfma_f32_16x16x32_bf16 v[40:43], a[88:91], a[64:67], v[40:43]
    v_exp_f32 v156, v32
    v_mfma_f32_16x16x32_bf16 v[56:59], a[88:91], a[72:75], v[56:59]
    ds_read_b64_tr_b16 a[28:29], v179 offset:32768
    v_mfma_f32_16x16x32_bf16 v[124:127], v[128:131], v[76:79], 0
    ds_read_b64_tr_b16 a[30:31], v179 offset:36864
    v_mfma_f32_16x16x32_bf16 v[48:51], a[88:91], a[68:71], v[48:51]
    v_exp_f32 v157, v33
    v_mfma_f32_16x16x32_bf16 v[64:67], a[88:91], a[76:79], v[64:67]
    s_waitcnt lgkmcnt(12)
    ds_read_b64_tr_b16 a[48:49], v180 offset:32768
    v_add_f32 v167, v156, v157
    v_mfma_f32_16x16x32_bf16 v[40:43], a[92:95], a[96:99], v[40:43]
    v_exp_f32 v158, v34
    v_mfma_f32_16x16x32_bf16 v[56:59], a[92:95], a[104:107], v[56:59]
    ds_read_b64_tr_b16 a[50:51], v180 offset:36864
    v_add_f32 v167, v167, v158
    v_mfma_f32_16x16x32_bf16 v[48:51], a[92:95], a[100:103], v[48:51]
    v_exp_f32 v159, v35
    v_mfma_f32_16x16x32_bf16 v[64:67], a[92:95], a[108:111], v[64:67]
    s_waitcnt lgkmcnt(13)
    ds_read_b64_tr_b16 a[52:53], v181 offset:32768
    v_add_f32 v167, v167, v159
    v_mfma_f32_16x16x32_bf16 v[44:47], a[112:115], a[0:3], v[104:107]
    v_exp_f32 v160, v36
    v_mfma_f32_16x16x32_bf16 v[60:63], a[112:115], a[8:11], v[112:115]
    ds_read_b64_tr_b16 a[54:55], v181 offset:36864
    v_add_f32 v167, v167, v160
    v_mfma_f32_16x16x32_bf16 v[52:55], a[112:115], a[4:7], v[108:111]
    v_exp_f32 v161, v37
    v_mfma_f32_16x16x32_bf16 v[68:71], a[112:115], a[12:15], v[116:119]
    s_waitcnt lgkmcnt(14)
    ds_read_b64_tr_b16 a[56:57], v182 offset:32768
    v_add_f32 v167, v167, v161
    v_mfma_f32_16x16x32_bf16 v[44:47], a[116:119], a[32:35], v[44:47]
    v_exp_f32 v162, v38
    v_mfma_f32_16x16x32_bf16 v[60:63], a[116:119], a[40:43], v[60:63]
    ds_read_b64_tr_b16 a[58:59], v182 offset:36864
    v_add_f32 v167, v167, v162
    v_mfma_f32_16x16x32_bf16 v[52:55], a[116:119], a[36:39], v[52:55]
    v_exp_f32 v163, v39
    v_mfma_f32_16x16x32_bf16 v[68:71], a[116:119], a[44:47], v[68:71]
    s_waitcnt lgkmcnt(15)
    ds_read_b64_tr_b16 a[60:61], v183 offset:32768
    v_max3_f32 v184, v120, v124, v166
    v_mfma_f32_16x16x32_bf16 v[44:47], a[120:123], a[64:67], v[44:47]
    v_exp_f32 v132, v40
    v_mfma_f32_16x16x32_bf16 v[60:63], a[120:123], a[72:75], v[60:63]
    s_nop 0
    v_add_f32 v167, v167, v163
    v_max_f32 v184, v184, v167
    v_mfma_f32_16x16x32_bf16 v[52:55], a[120:123], a[68:71], v[52:55]
    v_exp_f32 v133, v41
    v_mfma_f32_16x16x32_bf16 v[68:71], a[120:123], a[76:79], v[68:71]
    s_waitcnt lgkmcnt(15)
    v_cmp_lt_f32 vcc, s48, v184
    v_cvt_pk_bf16_f32 v88, v132, v133
    v_mfma_f32_16x16x32_bf16 v[44:47], a[124:127], a[96:99], v[44:47]
    v_exp_f32 v134, v42
    v_mfma_f32_16x16x32_bf16 v[60:63], a[124:127], a[104:107], v[60:63]
    s_nop 0
    v_cvt_pk_bf16_f32 v84, v156, v157
    v_cvt_pk_bf16_f32 v85, v158, v159
    v_mfma_f32_16x16x32_bf16 v[52:55], a[124:127], a[100:103], v[52:55]
    s_cbranch_vccnz mk_stubt60
mk_okt60:
    v_exp_f32 v135, v43
    v_mfma_f32_16x16x32_bf16 v[68:71], a[124:127], a[108:111], v[68:71]
    s_waitcnt lgkmcnt(13)
    ds_read_b64_tr_b16 a[62:63], v183 offset:36864
    v_cvt_pk_bf16_f32 v89, v134, v135
    v_mfma_f32_16x16x32_bf16 a[128:131], a[16:19], v[72:75], a[128:131]
    s_waitcnt lgkmcnt(12)
    v_exp_f32 v136, v44
    v_mfma_f32_16x16x32_bf16 a[132:135], a[20:23], v[72:75], a[132:135]
    s_waitcnt lgkmcnt(10)
    ds_read_b128 a[80:83], v172 offset:8192
    v_add_f32 v168, v168, v120
    v_mfma_f32_16x16x32_bf16 a[136:139], a[24:27], v[72:75], a[136:139]
    s_waitcnt lgkmcnt(9)
    v_exp_f32 v137, v45
    v_mfma_f32_16x16x32_bf16 a[140:143], a[28:31], v[72:75], a[140:143]
    s_waitcnt lgkmcnt(7)
    ds_read_b128 a[84:87], v173 offset:8192
    v_cvt_pk_bf16_f32 v90, v136, v137
    v_mfma_f32_16x16x32_bf16 a[144:147], a[48:51], v[72:75], a[144:147]
    s_waitcnt lgkmcnt(6)
    v_exp_f32 v138, v46
    v_mfma_f32_16x16x32_bf16 a[148:151], a[52:55], v[72:75], a[148:151]
    v_min_u32 v231, 7, v2
    v_lshlrev_b32 v231, 2, v231
    s_nop 0
    s_waitcnt lgkmcnt(4)
    buffer_load_dword v230, v231, s[16:19], s59 offen sc1
    v_add_f32 v170, v170, v166
    v_mfma_f32_16x16x32_bf16 a[152:155], a[56:59], v[72:75], a[152:155]
    s_waitcnt lgkmcnt(2)
    v_exp_f32 v139, v47
    v_mfma_f32_16x16x32_bf16 a[156:159], a[60:63], v[72:75], a[156:159]
    ds_read_b128 a[88:91], v174 offset:8192
    v_cvt_pk_bf16_f32 v91, v138, v139
    v_mfma_f32_16x16x32_bf16 a[192:195], a[16:19], v[80:83], a[192:195]
    v_exp_f32 v140, v56
    v_mfma_f32_16x16x32_bf16 a[196:199], a[20:23], v[80:83], a[196:199]
    ds_read_b128 a[92:95], v175 offset:8192
    v_cvt_pk_bf16_f32 v86, v160, v161
    v_mfma_f32_16x16x32_bf16 v[120:123], v[128:131], v[88:91], 0
    ds_read_b128 a[112:115], v172 offset:12288
    v_cvt_pk_bf16_f32 v87, v162, v163
    v_mfma_f32_16x16x32_bf16 a[200:203], a[24:27], v[80:83], a[200:203]
    v_exp_f32 v141, v57
    v_mfma_f32_16x16x32_bf16 a[204:207], a[28:31], v[80:83], a[204:207]
    s_nop 0
    v_add_f32 v166, v140, v141
    v_add_f32 v169, v169, v124
    v_mfma_f32_16x16x32_bf16 a[208:211], a[48:51], v[80:83], a[208:211]
    v_exp_f32 v142, v58
    v_mfma_f32_16x16x32_bf16 a[212:215], a[52:55], v[80:83], a[212:215]
    ds_read_b128 a[116:119], v173 offset:12288
    v_add_f32 v166, v166, v142
    v_mfma_f32_16x16x32_bf16 a[216:219], a[56:59], v[80:83], a[216:219]
    v_exp_f32 v143, v59
    v_mfma_f32_16x16x32_bf16 a[220:223], a[60:63], v[80:83], a[220:223]
    s_nop 0
    v_add_f32 v166, v166, v143
    v_add_f32 v171, v171, v167
    v_mfma_f32_16x16x32_bf16 a[160:163], a[16:19], v[76:79], a[160:163]
    v_exp_f32 v144, v60
    v_mfma_f32_16x16x32_bf16 a[164:167], a[20:23], v[76:79], a[164:167]
    ds_read_b128 a[120:123], v174 offset:12288
    v_add_f32 v166, v166, v144
    v_mfma_f32_16x16x32_bf16 a[168:171], a[24:27], v[76:79], a[168:171]
    v_exp_f32 v145, v61
    v_mfma_f32_16x16x32_bf16 a[172:175], a[28:31], v[76:79], a[172:175]
    s_nop 0
    v_add_f32 v166, v166, v145
    v_cvt_pk_bf16_f32 v96, v140, v141
    v_mfma_f32_16x16x32_bf16 a[176:179], a[48:51], v[76:79], a[176:179]
    v_exp_f32 v146, v62
    v_mfma_f32_16x16x32_bf16 a[180:183], a[52:55], v[76:79], a[180:183]
    ds_read_b128 a[124:127], v175 offset:12288
    v_add_f32 v166, v166, v146
    v_mfma_f32_16x16x32_bf16 a[184:187], a[56:59], v[76:79], a[184:187]
    v_exp_f32 v147, v63
    v_mfma_f32_16x16x32_bf16 a[188:191], a[60:63], v[76:79], a[188:191]
    s_nop 0
    v_add_f32 v166, v166, v147
    v_cvt_pk_bf16_f32 v97, v142, v143
    v_mfma_f32_16x16x32_bf16 a[224:227], a[16:19], v[84:87], a[224:227]
    v_exp_f32 v148, v48
    v_mfma_f32_16x16x32_bf16 a[228:231], a[20:23], v[84:87], a[228:231]
    ds_read_b64_tr_b16 a[16:17], v176 offset:40960
    v_cvt_pk_bf16_f32 v98, v144, v145
    v_mfma_f32_16x16x32_bf16 a[232:235], a[24:27], v[84:87], a[232:235]
    v_exp_f32 v149, v49
    v_mfma_f32_16x16x32_bf16 a[236:239], a[28:31], v[84:87], a[236:239]
    s_nop 0
    v_cvt_pk_bf16_f32 v92, v148, v149
    v_cvt_pk_bf16_f32 v99, v146, v147
    v_mfma_f32_16x16x32_bf16 a[240:243], a[48:51], v[84:87], a[240:243]
    v_exp_f32 v150, v50
    v_mfma_f32_16x16x32_bf16 a[244:247], a[52:55], v[84:87], a[244:247]
    ds_read_b64_tr_b16 a[18:19], v176 offset:45056
    v_mfma_f32_16x16x32_bf16 a[248:251], a[56:59], v[84:87], a[248:251]
    v_exp_f32 v151, v51
    v_mfma_f32_16x16x32_bf16 a[252:255], a[60:63], v[84:87], a[252:255]
    s_waitcnt lgkmcnt(9)
    ds_read_b64_tr_b16 a[20:21], v177 offset:40960
    v_cvt_pk_bf16_f32 v93, v150, v151
    v_mfma_f32_16x16x32_bf16 v[8:11], a[80:83], a[0:3], v[104:107]
    v_exp_f32 v152, v52
    v_mfma_f32_16x16x32_bf16 v[24:27], a[80:83], a[8:11], v[112:115]
    v_mfma_f32_16x16x32_bf16 v[16:19], a[80:83], a[4:7], v[108:111]
    v_exp_f32 v153, v53
    v_mfma_f32_16x16x32_bf16 v[32:35], a[80:83], a[12:15], v[116:119]
    s_waitcnt lgkmcnt(9)
    ds_read_b64_tr_b16 a[22:23], v177 offset:45056
    v_cvt_pk_bf16_f32 v94, v152, v153
    v_mfma_f32_16x16x32_bf16 v[8:11], a[84:87], a[32:35], v[8:11]
    v_exp_f32 v154, v54
    v_mfma_f32_16x16x32_bf16 v[24:27], a[84:87], a[40:43], v[24:27]
    ds_read_b64_tr_b16 a[24:25], v178 offset:40960
    v_mfma_f32_16x16x32_bf16 v[16:19], a[84:87], a[36:39], v[16:19]
    v_exp_f32 v155, v55
    v_mfma_f32_16x16x32_bf16 v[32:35], a[84:87], a[44:47], v[32:35]
    s_waitcnt lgkmcnt(10)
    ds_read_b64_tr_b16 a[26:27], v178 offset:45056
    v_cvt_pk_bf16_f32 v95, v154, v155
    v_mfma_f32_16x16x32_bf16 v[8:11], a[88:91], a[64:67], v[8:11]
    v_exp_f32 v156, v64
    v_mfma_f32_16x16x32_bf16 v[24:27], a[88:91], a[72:75], v[24:27]
    ds_read_b64_tr_b16 a[28:29], v179 offset:40960
    v_mfma_f32_16x16x32_bf16 v[124:127], v[128:131], v[92:95], 0
    ds_read_b64_tr_b16 a[30:31], v179 offset:45056
    v_mfma_f32_16x16x32_bf16 v[16:19], a[88:91], a[68:71], v[16:19]
    v_exp_f32 v157, v65
    v_mfma_f32_16x16x32_bf16 v[32:35], a[88:91], a[76:79], v[32:35]
    s_waitcnt lgkmcnt(12)
    ds_read_b64_tr_b16 a[48:49], v180 offset:40960
    v_add_f32 v167, v156, v157
    v_mfma_f32_16x16x32_bf16 v[8:11], a[92:95], a[96:99], v[8:11]
    v_exp_f32 v158, v66
    v_mfma_f32_16x16x32_bf16 v[24:27], a[92:95], a[104:107], v[24:27]
    ds_read_b64_tr_b16 a[50:51], v180 offset:45056
    v_add_f32 v167, v167, v158
    v_mfma_f32_16x16x32_bf16 v[16:19], a[92:95], a[100:103], v[16:19]
    v_exp_f32 v159, v67
    v_mfma_f32_16x16x32_bf16 v[32:35], a[92:95], a[108:111], v[32:35]
    s_waitcnt lgkmcnt(13)
    ds_read_b64_tr_b16 a[52:53], v181 offset:40960
    v_add_f32 v167, v167, v159
    v_mfma_f32_16x16x32_bf16 v[12:15], a[112:115], a[0:3], v[104:107]
    v_exp_f32 v160, v68
    v_mfma_f32_16x16x32_bf16 v[28:31], a[112:115], a[8:11], v[112:115]
    ds_read_b64_tr_b16 a[54:55], v181 offset:45056
    v_add_f32 v167, v167, v160
    v_mfma_f32_16x16x32_bf16 v[20:23], a[112:115], a[4:7], v[108:111]
    v_exp_f32 v161, v69
    v_mfma_f32_16x16x32_bf16 v[36:39], a[112:115], a[12:15], v[116:119]
    s_waitcnt lgkmcnt(14)
    ds_read_b64_tr_b16 a[56:57], v182 offset:40960
    v_add_f32 v167, v167, v161
    v_mfma_f32_16x16x32_bf16 v[12:15], a[116:119], a[32:35], v[12:15]
    v_exp_f32 v162, v70
    v_mfma_f32_16x16x32_bf16 v[28:31], a[116:119], a[40:43], v[28:31]
    ds_read_b64_tr_b16 a[58:59], v182 offset:45056
    v_add_f32 v167, v167, v162
    v_mfma_f32_16x16x32_bf16 v[20:23], a[116:119], a[36:39], v[20:23]
    v_exp_f32 v163, v71
    v_mfma_f32_16x16x32_bf16 v[36:39], a[116:119], a[44:47], v[36:39]
    s_waitcnt lgkmcnt(15)
    ds_read_b64_tr_b16 a[60:61], v183 offset:40960
    v_max3_f32 v184, v120, v124, v166
    v_mfma_f32_16x16x32_bf16 v[12:15], a[120:123], a[64:67], v[12:15]
    v_exp_f32 v132, v8
    v_mfma_f32_16x16x32_bf16 v[28:31], a[120:123], a[72:75], v[28:31]
    s_nop 0
    v_add_f32 v167, v167, v163
    v_max_f32 v184, v184, v167
    v_mfma_f32_16x16x32_bf16 v[20:23], a[120:123], a[68:71], v[20:23]
    v_exp_f32 v133, v9
    v_mfma_f32_16x16x32_bf16 v[36:39], a[120:123], a[76:79], v[36:39]
    s_waitcnt lgkmcnt(15)
    v_cmp_lt_f32 vcc, s48, v184
    v_cvt_pk_bf16_f32 v72, v132, v133
    v_mfma_f32_16x16x32_bf16 v[12:15], a[124:127], a[96:99], v[12:15]
    v_exp_f32 v134, v10
    v_mfma_f32_16x16x32_bf16 v[28:31], a[124:127], a[104:107], v[28:31]
    s_nop 0
    v_cvt_pk_bf16_f32 v100, v156, v157
    v_cvt_pk_bf16_f32 v101, v158, v159
    v_mfma_f32_16x16x32_bf16 v[20:23], a[124:127], a[100:103], v[20:23]
    s_cbranch_vccnz mk_stubt61
mk_okt61:
    v_exp_f32 v135, v11
    v_mfma_f32_16x16x32_bf16 v[36:39], a[124:127], a[108:111], v[36:39]
    s_waitcnt lgkmcnt(13)
    ds_read_b64_tr_b16 a[62:63], v183 offset:45056
    v_cvt_pk_bf16_f32 v73, v134, v135
    v_mfma_f32_16x16x32_bf16 a[128:131], a[16:19], v[88:91], a[128:131]
    s_waitcnt lgkmcnt(12)
    v_exp_f32 v136, v12
    v_mfma_f32_16x16x32_bf16 a[132:135], a[20:23], v[88:91], a[132:135]
    s_waitcnt vmcnt(2)
    s_barrier
    s_waitcnt lgkmcnt(10)
    ds_read_b128 a[80:83], v172 offset:16384
    v_add_f32 v168, v168, v120
    v_mfma_f32_16x16x32_bf16 a[136:139], a[24:27], v[88:91], a[136:139]
    s_waitcnt lgkmcnt(9)
    v_exp_f32 v137, v13
    v_mfma_f32_16x16x32_bf16 a[140:143], a[28:31], v[88:91], a[140:143]
    s_waitcnt lgkmcnt(7)
    ds_read_b128 a[84:87], v173 offset:16384
    v_cvt_pk_bf16_f32 v74, v136, v137
    v_mfma_f32_16x16x32_bf16 a[144:147], a[48:51], v[88:91], a[144:147]
    s_waitcnt lgkmcnt(6)
    v_exp_f32 v138, v14
    v_mfma_f32_16x16x32_bf16 a[148:151], a[52:55], v[88:91], a[148:151]
    s_waitcnt lgkmcnt(4)
    v_add_f32 v170, v170, v166
    v_cvt_pk_bf16_f32 v102, v160, v161
    v_mfma_f32_16x16x32_bf16 a[152:155], a[56:59], v[88:91], a[152:155]
    s_waitcnt lgkmcnt(2)
    v_exp_f32 v139, v15
    v_mfma_f32_16x16x32_bf16 a[156:159], a[60:63], v[88:91], a[156:159]
    ds_read_b128 a[88:91], v174 offset:16384
    v_cvt_pk_bf16_f32 v75, v138, v139
    v_mfma_f32_16x16x32_bf16 a[192:195], a[16:19], v[96:99], a[192:195]
    v_exp_f32 v140, v24
    v_mfma_f32_16x16x32_bf16 a[196:199], a[20:23], v[96:99], a[196:199]
    ds_read_b128 a[92:95], v175 offset:16384
    v_cvt_pk_bf16_f32 v103, v162, v163
    v_mfma_f32_16x16x32_bf16 v[120:123], v[128:131], v[72:75], 0
    ds_read_b128 a[112:115], v172 offset:20480
    v_add_f32 v169, v169, v124
    v_mfma_f32_16x16x32_bf16 a[200:203], a[24:27], v[96:99], a[200:203]
    v_exp_f32 v141, v25
    v_mfma_f32_16x16x32_bf16 a[204:207], a[28:31], v[96:99], a[204:207]
    s_nop 0
    v_add_f32 v166, v140, v141
    v_add_f32 v171, v171, v167
    v_mfma_f32_16x16x32_bf16 a[208:211], a[48:51], v[96:99], a[208:211]
    v_exp_f32 v142, v26
    v_mfma_f32_16x16x32_bf16 a[212:215], a[52:55], v[96:99], a[212:215]
    ds_read_b128 a[116:119], v173 offset:20480
    v_add_f32 v166, v166, v142
    v_mfma_f32_16x16x32_bf16 a[216:219], a[56:59], v[96:99], a[216:219]
    v_exp_f32 v143, v27
    v_mfma_f32_16x16x32_bf16 a[220:223], a[60:63], v[96:99], a[220:223]
    s_nop 0
    v_add_f32 v166, v166, v143
    v_cvt_pk_bf16_f32 v80, v140, v141
    v_mfma_f32_16x16x32_bf16 a[160:163], a[16:19], v[92:95], a[160:163]
    v_exp_f32 v144, v28
    v_mfma_f32_16x16x32_bf16 a[164:167], a[20:23], v[92:95], a[164:167]
    ds_read_b128 a[120:123], v174 offset:20480
    v_add_f32 v166, v166, v144
    v_mfma_f32_16x16x32_bf16 a[168:171], a[24:27], v[92:95], a[168:171]
    v_exp_f32 v145, v29
    v_mfma_f32_16x16x32_bf16 a[172:175], a[28:31], v[92:95], a[172:175]
    s_nop 0
    v_add_f32 v166, v166, v145
    v_cvt_pk_bf16_f32 v81, v142, v143
    v_mfma_f32_16x16x32_bf16 a[176:179], a[48:51], v[92:95], a[176:179]
    v_exp_f32 v146, v30
    v_mfma_f32_16x16x32_bf16 a[180:183], a[52:55], v[92:95], a[180:183]
    ds_read_b128 a[124:127], v175 offset:20480
    v_add_f32 v166, v166, v146
    v_mfma_f32_16x16x32_bf16 a[184:187], a[56:59], v[92:95], a[184:187]
    v_exp_f32 v147, v31
    v_mfma_f32_16x16x32_bf16 a[188:191], a[60:63], v[92:95], a[188:191]
    s_nop 0
    v_add_f32 v166, v166, v147
    v_cvt_pk_bf16_f32 v82, v144, v145
    v_mfma_f32_16x16x32_bf16 a[224:227], a[16:19], v[100:103], a[224:227]
    v_exp_f32 v148, v16
    v_mfma_f32_16x16x32_bf16 a[228:231], a[20:23], v[100:103], a[228:231]
    ds_read_b64_tr_b16 a[16:17], v176 offset:49152
    v_cvt_pk_bf16_f32 v83, v146, v147
    v_mfma_f32_16x16x32_bf16 a[232:235], a[24:27], v[100:103], a[232:235]
    v_exp_f32 v149, v17
    v_mfma_f32_16x16x32_bf16 a[236:239], a[28:31], v[100:103], a[236:239]
    v_cvt_pk_bf16_f32 v76, v148, v149
    v_mfma_f32_16x16x32_bf16 a[240:243], a[48:51], v[100:103], a[240:243]
    v_exp_f32 v150, v18
    v_mfma_f32_16x16x32_bf16 a[244:247], a[52:55], v[100:103], a[244:247]
    ds_read_b64_tr_b16 a[18:19], v176 offset:53248
    v_mfma_f32_16x16x32_bf16 a[248:251], a[56:59], v[100:103], a[248:251]
    v_exp_f32 v151, v19
    v_mfma_f32_16x16x32_bf16 a[252:255], a[60:63], v[100:103], a[252:255]
    s_waitcnt lgkmcnt(9)
    ds_read_b64_tr_b16 a[20:21], v177 offset:49152
    v_cvt_pk_bf16_f32 v77, v150, v151
    v_mfma_f32_16x16x32_bf16 v[40:43], a[80:83], a[0:3], v[104:107]
    v_exp_f32 v152, v20
    v_mfma_f32_16x16x32_bf16 v[56:59], a[80:83], a[8:11], v[112:115]
    v_mfma_f32_16x16x32_bf16 v[48:51], a[80:83], a[4:7], v[108:111]
    v_exp_f32 v153, v21
    v_mfma_f32_16x16x32_bf16 v[64:67], a[80:83], a[12:15], v[116:119]
    s_waitcnt lgkmcnt(9)
    ds_read_b64_tr_b16 a[22:23], v177 offset:53248
    v_cvt_pk_bf16_f32 v78, v152, v153
    v_mfma_f32_16x16x32_bf16 v[40:43], a[84:87], a[32:35], v[40:43]
    v_exp_f32 v154, v22
    v_mfma_f32_16x16x32_bf16 v[56:59], a[84:87], a[40:43], v[56:59]
    ds_read_b64_tr_b16 a[24:25], v178 offset:49152
    v_mfma_f32_16x16x32_bf16 v[48:51], a[84:87], a[36:39], v[48:51]
    v_exp_f32 v155, v23
    v_mfma_f32_16x16x32_bf16 v[64:67], a[84:87], a[44:47], v[64:67]
    s_waitcnt lgkmcnt(10)
    ds_read_b64_tr_b16 a[26:27], v178 offset:53248
    v_cvt_pk_bf16_f32 v79, v154, v155
    v_mfma_f32_16x16x32_bf16 v[40:43], a[88:91], a[64:67], v[40:43]
    v_exp_f32 v156, v32
    v_mfma_f32_16x16x32_bf16 v[56:59], a[88:91], a[72:75], v[56:59]
    ds_read_b64_tr_b16 a[28:29], v179 offset:49152
    v_mfma_f32_16x16x32_bf16 v[124:127], v[128:131], v[76:79], 0
    ds_read_b64_tr_b16 a[30:31], v179 offset:53248
    v_mfma_f32_16x16x32_bf16 v[48:51], a[88:91], a[68:71], v[48:51]
    v_exp_f32 v157, v33
    v_mfma_f32_16x16x32_bf16 v[64:67], a[88:91], a[76:79], v[64:67]
    s_waitcnt lgkmcnt(12)
    ds_read_b64_tr_b16 a[48:49], v180 offset:49152
    v_add_f32 v167, v156, v157
    v_mfma_f32_16x16x32_bf16 v[40:43], a[92:95], a[96:99], v[40:43]
    v_exp_f32 v158, v34
    v_mfma_f32_16x16x32_bf16 v[56:59], a[92:95], a[104:107], v[56:59]
    ds_read_b64_tr_b16 a[50:51], v180 offset:53248
    v_add_f32 v167, v167, v158
    v_mfma_f32_16x16x32_bf16 v[48:51], a[92:95], a[100:103], v[48:51]
    v_exp_f32 v159, v35
    v_mfma_f32_16x16x32_bf16 v[64:67], a[92:95], a[108:111], v[64:67]
    s_waitcnt lgkmcnt(13)
    ds_read_b64_tr_b16 a[52:53], v181 offset:49152
    v_add_f32 v167, v167, v159
    v_mfma_f32_16x16x32_bf16 v[44:47], a[112:115], a[0:3], v[104:107]
    v_exp_f32 v160, v36
    v_mfma_f32_16x16x32_bf16 v[60:63], a[112:115], a[8:11], v[112:115]
    ds_read_b64_tr_b16 a[54:55], v181 offset:53248
    v_add_f32 v167, v167, v160
    v_mfma_f32_16x16x32_bf16 v[52:55], a[112:115], a[4:7], v[108:111]
    v_exp_f32 v161, v37
    v_mfma_f32_16x16x32_bf16 v[68:71], a[112:115], a[12:15], v[116:119]
    s_waitcnt lgkmcnt(14)
    ds_read_b64_tr_b16 a[56:57], v182 offset:49152
    v_add_f32 v167, v167, v161
    v_mfma_f32_16x16x32_bf16 v[44:47], a[116:119], a[32:35], v[44:47]
    v_exp_f32 v162, v38
    v_mfma_f32_16x16x32_bf16 v[60:63], a[116:119], a[40:43], v[60:63]
    ds_read_b64_tr_b16 a[58:59], v182 offset:53248
    v_add_f32 v167, v167, v162
    v_mfma_f32_16x16x32_bf16 v[52:55], a[116:119], a[36:39], v[52:55]
    v_exp_f32 v163, v39
    v_mfma_f32_16x16x32_bf16 v[68:71], a[116:119], a[44:47], v[68:71]
    s_waitcnt lgkmcnt(15)
    ds_read_b64_tr_b16 a[60:61], v183 offset:49152
    v_max3_f32 v184, v120, v124, v166
    v_mfma_f32_16x16x32_bf16 v[44:47], a[120:123], a[64:67], v[44:47]
    v_exp_f32 v132, v40
    v_mfma_f32_16x16x32_bf16 v[60:63], a[120:123], a[72:75], v[60:63]
    s_nop 0
    v_add_f32 v167, v167, v163
    v_max_f32 v184, v184, v167
    v_mfma_f32_16x16x32_bf16 v[52:55], a[120:123], a[68:71], v[52:55]
    v_exp_f32 v133, v41
    v_mfma_f32_16x16x32_bf16 v[68:71], a[120:123], a[76:79], v[68:71]
    s_waitcnt lgkmcnt(15)
    v_cmp_lt_f32 vcc, s48, v184
    v_cvt_pk_bf16_f32 v88, v132, v133
    v_mfma_f32_16x16x32_bf16 v[44:47], a[124:127], a[96:99], v[44:47]
    v_exp_f32 v134, v42
    v_mfma_f32_16x16x32_bf16 v[60:63], a[124:127], a[104:107], v[60:63]
    s_nop 0
    v_cvt_pk_bf16_f32 v84, v156, v157
    v_cvt_pk_bf16_f32 v85, v158, v159
    v_mfma_f32_16x16x32_bf16 v[52:55], a[124:127], a[100:103], v[52:55]
    s_cbranch_vccnz mk_stubt62
mk_okt62:
    v_exp_f32 v135, v43
    v_mfma_f32_16x16x32_bf16 v[68:71], a[124:127], a[108:111], v[68:71]
    s_waitcnt lgkmcnt(13)
    ds_read_b64_tr_b16 a[62:63], v183 offset:53248
    v_cvt_pk_bf16_f32 v89, v134, v135
    v_mfma_f32_16x16x32_bf16 a[128:131], a[16:19], v[72:75], a[128:131]
    s_waitcnt lgkmcnt(12)
    v_exp_f32 v136, v44
    v_mfma_f32_16x16x32_bf16 a[132:135], a[20:23], v[72:75], a[132:135]
    s_add_u32 s99, s68, 0
    s_add_u32 m0, s70, 0
    s_nop 0
    s_barrier
    s_waitcnt lgkmcnt(10)
    buffer_load_dwordx4 v219, s[60:63], s99 offen offset:0 lds
    v_add_f32 v168, v168, v120
    v_mfma_f32_16x16x32_bf16 a[136:139], a[24:27], v[72:75], a[136:139]
    s_waitcnt lgkmcnt(8)
    v_exp_f32 v137, v45
    v_mfma_f32_16x16x32_bf16 a[140:143], a[28:31], v[72:75], a[140:143]
    s_waitcnt lgkmcnt(6)
    buffer_load_dwordx4 v220, s[60:63], s99 offen offset:1024 lds
    v_cvt_pk_bf16_f32 v90, v136, v137
    v_mfma_f32_16x16x32_bf16 a[144:147], a[48:51], v[72:75], a[144:147]
    s_waitcnt lgkmcnt(4)
    v_exp_f32 v138, v46
    v_mfma_f32_16x16x32_bf16 a[148:151], a[52:55], v[72:75], a[148:151]
    s_waitcnt lgkmcnt(2)
    buffer_load_dwordx4 v221, s[60:63], s99 offen offset:2048 lds
    v_add_f32 v170, v170, v166
    v_mfma_f32_16x16x32_bf16 a[152:155], a[56:59], v[72:75], a[152:155]
    s_waitcnt lgkmcnt(0)
    v_exp_f32 v139, v47
    v_mfma_f32_16x16x32_bf16 a[156:159], a[60:63], v[72:75], a[156:159]
    buffer_load_dwordx4 v222, s[60:63], s99 offen offset:3072 lds
    v_cvt_pk_bf16_f32 v91, v138, v139
    v_mfma_f32_16x16x32_bf16 a[192:195], a[16:19], v[80:83], a[192:195]
    v_exp_f32 v140, v56
    v_mfma_f32_16x16x32_bf16 a[196:199], a[20:23], v[80:83], a[196:199]
    s_add_u32 m0, s70, 4096
    s_nop 0
    buffer_load_dwordx4 v223, s[60:63], s99 offen offset:0 lds
    v_cvt_pk_bf16_f32 v86, v160, v161
    v_mfma_f32_16x16x32_bf16 v[120:123], v[128:131], v[88:91], 0
    buffer_load_dwordx4 v224, s[60:63], s99 offen offset:1024 lds
    v_cvt_pk_bf16_f32 v87, v162, v163
    v_mfma_f32_16x16x32_bf16 a[200:203], a[24:27], v[80:83], a[200:203]
    v_exp_f32 v141, v57
    v_mfma_f32_16x16x32_bf16 a[204:207], a[28:31], v[80:83], a[204:207]
    buffer_load_dwordx4 v225, s[60:63], s99 offen offset:2048 lds
    v_add_f32 v166, v140, v141
    v_mfma_f32_16x16x32_bf16 a[208:211], a[48:51], v[80:83], a[208:211]
    v_exp_f32 v142, v58
    v_mfma_f32_16x16x32_bf16 a[212:215], a[52:55], v[80:83], a[212:215]
    buffer_load_dwordx4 v226, s[60:63], s99 offen offset:3072 lds
    v_add_f32 v166, v166, v142
    v_mfma_f32_16x16x32_bf16 a[216:219], a[56:59], v[80:83], a[216:219]
    v_exp_f32 v143, v59
    v_mfma_f32_16x16x32_bf16 a[220:223], a[60:63], v[80:83], a[220:223]
    s_nop 0
    v_add_f32 v166, v166, v143
    v_add_f32 v169, v169, v124
    v_mfma_f32_16x16x32_bf16 a[160:163], a[16:19], v[76:79], a[160:163]
    v_exp_f32 v144, v60
    v_mfma_f32_16x16x32_bf16 a[164:167], a[20:23], v[76:79], a[164:167]
    s_add_u32 m0, s70, 8192
    s_nop 0
    buffer_load_dwordx4 v227, s[60:63], s99 offen offset:0 lds
    v_add_f32 v166, v166, v144
    v_mfma_f32_16x16x32_bf16 a[168:171], a[24:27], v[76:79], a[168:171]
    v_exp_f32 v145, v61
    v_mfma_f32_16x16x32_bf16 a[172:175], a[28:31], v[76:79], a[172:175]
    s_nop 0
    v_add_f32 v166, v166, v145
    v_add_f32 v171, v171, v167
    v_mfma_f32_16x16x32_bf16 a[176:179], a[48:51], v[76:79], a[176:179]
    v_exp_f32 v146, v62
    v_mfma_f32_16x16x32_bf16 a[180:183], a[52:55], v[76:79], a[180:183]
    s_nop 0
    v_add_f32 v166, v166, v146
    v_cvt_pk_bf16_f32 v96, v140, v141
    v_mfma_f32_16x16x32_bf16 a[184:187], a[56:59], v[76:79], a[184:187]
    v_exp_f32 v147, v63
    v_mfma_f32_16x16x32_bf16 a[188:191], a[60:63], v[76:79], a[188:191]
    s_nop 0
    v_add_f32 v166, v166, v147
    v_cvt_pk_bf16_f32 v97, v142, v143
    v_mfma_f32_16x16x32_bf16 a[224:227], a[16:19], v[84:87], a[224:227]
    v_exp_f32 v148, v48
    v_mfma_f32_16x16x32_bf16 a[228:231], a[20:23], v[84:87], a[228:231]
    ds_read_b64_tr_b16 a[16:17], v176 offset:57344
    v_cvt_pk_bf16_f32 v98, v144, v145
    v_mfma_f32_16x16x32_bf16 a[232:235], a[24:27], v[84:87], a[232:235]
    v_exp_f32 v149, v49
    v_mfma_f32_16x16x32_bf16 a[236:239], a[28:31], v[84:87], a[236:239]
    s_nop 0
    v_cvt_pk_bf16_f32 v92, v148, v149
    v_cvt_pk_bf16_f32 v99, v146, v147
    v_mfma_f32_16x16x32_bf16 a[240:243], a[48:51], v[84:87], a[240:243]
    v_exp_f32 v150, v50
    v_mfma_f32_16x16x32_bf16 a[244:247], a[52:55], v[84:87], a[244:247]
    ds_read_b64_tr_b16 a[18:19], v176 offset:61440
    v_mfma_f32_16x16x32_bf16 a[248:251], a[56:59], v[84:87], a[248:251]
    v_exp_f32 v151, v51
    v_mfma_f32_16x16x32_bf16 a[252:255], a[60:63], v[84:87], a[252:255]
    ds_read_b64_tr_b16 a[20:21], v177 offset:57344
    v_cvt_pk_bf16_f32 v93, v150, v151
    s_nop 0
    v_exp_f32 v152, v52
    s_nop 0
    s_nop 0
    v_exp_f32 v153, v53
    s_nop 0
    ds_read_b64_tr_b16 a[22:23], v177 offset:61440
    v_cvt_pk_bf16_f32 v94, v152, v153
    s_nop 0
    v_exp_f32 v154, v54
    s_nop 0
    ds_read_b64_tr_b16 a[24:25], v178 offset:57344
    s_nop 0
    v_exp_f32 v155, v55
    s_nop 0
    ds_read_b64_tr_b16 a[26:27], v178 offset:61440
    v_cvt_pk_bf16_f32 v95, v154, v155
    s_nop 0
    v_exp_f32 v156, v64
    s_nop 0
    ds_read_b64_tr_b16 a[28:29], v179 offset:57344
    v_mfma_f32_16x16x32_bf16 v[124:127], v[128:131], v[92:95], 0
    ds_read_b64_tr_b16 a[30:31], v179 offset:61440
    s_nop 0
    v_exp_f32 v157, v65
    s_nop 0
    ds_read_b64_tr_b16 a[48:49], v180 offset:57344
    v_add_f32 v167, v156, v157
    s_nop 0
    v_exp_f32 v158, v66
    s_nop 0
    ds_read_b64_tr_b16 a[50:51], v180 offset:61440
    v_add_f32 v167, v167, v158
    s_nop 0
    v_exp_f32 v159, v67
    s_nop 0
    ds_read_b64_tr_b16 a[52:53], v181 offset:57344
    v_add_f32 v167, v167, v159
    s_nop 0
    v_exp_f32 v160, v68
    s_nop 0
    ds_read_b64_tr_b16 a[54:55], v181 offset:61440
    v_add_f32 v167, v167, v160
    s_nop 0
    v_exp_f32 v161, v69
    s_nop 0
    ds_read_b64_tr_b16 a[56:57], v182 offset:57344
    v_add_f32 v167, v167, v161
    s_nop 0
    v_exp_f32 v162, v70
    s_nop 0
    ds_read_b64_tr_b16 a[58:59], v182 offset:61440
    v_add_f32 v167, v167, v162
    s_nop 0
    v_exp_f32 v163, v71
    s_nop 0
    ds_read_b64_tr_b16 a[60:61], v183 offset:57344
    v_max3_f32 v184, v120, v124, v166
    s_nop 0
    s_nop 0
    s_nop 0
    v_add_f32 v167, v167, v163
    v_max_f32 v184, v184, v167
    s_nop 0
    s_nop 0
    s_nop 0
    v_cmp_lt_f32 vcc, s48, v184
    v_cvt_pk_bf16_f32 v100, v156, v157
    s_nop 0
    s_nop 0
    s_nop 0
    v_cvt_pk_bf16_f32 v101, v158, v159
    v_cvt_pk_bf16_f32 v102, v160, v161
    s_nop 0
    s_cbranch_vccnz mk_stubt63
mk_okt63:
    s_nop 0
    ds_read_b64_tr_b16 a[62:63], v183 offset:61440
    v_add_f32 v168, v168, v120
    v_cvt_pk_bf16_f32 v103, v162, v163
    v_add_f32 v169, v169, v124
    v_add_f32 v170, v170, v166
    v_add_f32 v171, v171, v167
    s_add_u32 s23, s57, 32768
    s_add_u32 s22, s59, 32768
    s_cmp_lt_u32 s53, 4
    s_cbranch_scc1 mk_role_s
    s_waitcnt lgkmcnt(0)
    s_nop 1
    s_waitcnt vmcnt(9)
    v_cmp_ne_u32 vcc, 1, v230
    s_nop 0
    s_cbranch_vccnz mk_slowh
mk_h_ok:
    v_mfma_f32_16x16x32_bf16 a[128:131], a[16:19], v[88:91], a[128:131]
    v_mfma_f32_16x16x32_bf16 a[132:135], a[20:23], v[88:91], a[132:135]
    s_add_u32 s100, s69, 0
    s_nop 0
    buffer_load_dwordx4 v[8:11], v3, s[64:67], s100 offen offset:0 sc1
    v_mfma_f32_16x16x32_bf16 a[136:139], a[24:27], v[88:91], a[136:139]
    v_mfma_f32_16x16x32_bf16 a[140:143], a[28:31], v[88:91], a[140:143]
    s_add_u32 s100, s69, 0
    s_nop 0
    buffer_load_dwordx4 v[12:15], v3, s[64:67], s100 offen offset:1024 sc1
    v_mfma_f32_16x16x32_bf16 a[144:147], a[48:51], v[88:91], a[144:147]
    v_mfma_f32_16x16x32_bf16 a[148:151], a[52:55], v[88:91], a[148:151]
    s_add_u32 s100, s69, 0
    s_nop 0
    buffer_load_dwordx4 v[16:19], v3, s[64:67], s100 offen offset:2048 sc1
    v_mfma_f32_16x16x32_bf16 a[152:155], a[56:59], v[88:91], a[152:155]
    v_mfma_f32_16x16x32_bf16 a[156:159], a[60:63], v[88:91], a[156:159]
    s_add_u32 s100, s69, 0
    s_nop 0
    buffer_load_dwordx4 v[20:23], v3, s[64:67], s100 offen offset:3072 sc1
    v_mfma_f32_16x16x32_bf16 a[192:195], a[16:19], v[96:99], a[192:195]
    v_mfma_f32_16x16x32_bf16 a[196:199], a[20:23], v[96:99], a[196:199]
    s_add_u32 s100, s69, 16384
    s_nop 0
    buffer_load_dwordx4 v[24:27], v3, s[64:67], s100 offen offset:0 sc1
    v_mfma_f32_16x16x32_bf16 a[200:203], a[24:27], v[96:99], a[200:203]
    v_mfma_f32_16x16x32_bf16 a[204:207], a[28:31], v[96:99], a[204:207]
    s_add_u32 s100, s69, 16384
    s_nop 0
    buffer_load_dwordx4 v[28:31], v3, s[64:67], s100 offen offset:1024 sc1
    v_mfma_f32_16x16x32_bf16 a[208:211], a[48:51], v[96:99], a[208:211]
    v_mfma_f32_16x16x32_bf16 a[212:215], a[52:55], v[96:99], a[212:215]
    s_add_u32 s100, s69, 16384
    s_nop 0
    buffer_load_dwordx4 v[32:35], v3, s[64:67], s100 offen offset:2048 sc1
    v_mfma_f32_16x16x32_bf16 a[216:219], a[56:59], v[96:99], a[216:219]
    v_mfma_f32_16x16x32_bf16 a[220:223], a[60:63], v[96:99], a[220:223]
    s_add_u32 s100, s69, 16384
    s_nop 0
    buffer_load_dwordx4 v[36:39], v3, s[64:67], s100 offen offset:3072 sc1
    v_mfma_f32_16x16x32_bf16 a[160:163], a[16:19], v[92:95], a[160:163]
    v_mfma_f32_16x16x32_bf16 a[164:167], a[20:23], v[92:95], a[164:167]
    s_add_u32 s100, s69, 32768
    s_nop 0
    buffer_load_dwordx4 v[40:43], v3, s[64:67], s100 offen offset:0 sc1
    v_mfma_f32_16x16x32_bf16 a[168:171], a[24:27], v[92:95], a[168:171]
    v_mfma_f32_16x16x32_bf16 a[172:175], a[28:31], v[92:95], a[172:175]
    s_add_u32 s100, s69, 32768
    s_nop 0
    buffer_load_dwordx4 v[44:47], v3, s[64:67], s100 offen offset:1024 sc1
    v_mfma_f32_16x16x32_bf16 a[176:179], a[48:51], v[92:95], a[176:179]
    v_mfma_f32_16x16x32_bf16 a[180:183], a[52:55], v[92:95], a[180:183]
    s_add_u32 s100, s69, 32768
    s_nop 0
    buffer_load_dwordx4 v[48:51], v3, s[64:67], s100 offen offset:2048 sc1
    v_mfma_f32_16x16x32_bf16 a[184:187], a[56:59], v[92:95], a[184:187]
    v_mfma_f32_16x16x32_bf16 a[188:191], a[60:63], v[92:95], a[188:191]
    s_add_u32 s100, s69, 32768
    s_nop 0
    buffer_load_dwordx4 v[52:55], v3, s[64:67], s100 offen offset:3072 sc1
    v_mfma_f32_16x16x32_bf16 a[224:227], a[16:19], v[100:103], a[224:227]
    v_mfma_f32_16x16x32_bf16 a[228:231], a[20:23], v[100:103], a[228:231]
    s_add_u32 s100, s69, 49152
    s_nop 0
    buffer_load_dwordx4 v[56:59], v3, s[64:67], s100 offen offset:0 sc1
    v_mfma_f32_16x16x32_bf16 a[232:235], a[24:27], v[100:103], a[232:235]
    v_mfma_f32_16x16x32_bf16 a[236:239], a[28:31], v[100:103], a[236:239]
    s_add_u32 s100, s69, 49152
    s_nop 0
    buffer_load_dwordx4 v[60:63], v3, s[64:67], s100 offen offset:1024 sc1
    v_mfma_f32_16x16x32_bf16 a[240:243], a[48:51], v[100:103], a[240:243]
    v_mfma_f32_16x16x32_bf16 a[244:247], a[52:55], v[100:103], a[244:247]
    s_add_u32 s100, s69, 49152
    s_nop 0
    buffer_load_dwordx4 v[64:67], v3, s[64:67], s100 offen offset:2048 sc1
    v_mfma_f32_16x16x32_bf16 a[248:251], a[56:59], v[100:103], a[248:251]
    v_mfma_f32_16x16x32_bf16 a[252:255], a[60:63], v[100:103], a[252:255]
    s_add_u32 s100, s69, 49152
    s_nop 0
    buffer_load_dwordx4 v[68:71], v3, s[64:67], s100 offen offset:3072 sc1
    s_barrier
    s_add_u32 s99, s68, 147456
    s_add_u32 m0, s70, 36864
    s_nop 0
    buffer_load_dwordx4 v219, s[60:63], s99 offen offset:0 lds
    buffer_load_dwordx4 v220, s[60:63], s99 offen offset:1024 lds
    buffer_load_dwordx4 v221, s[60:63], s99 offen offset:2048 lds
    buffer_load_dwordx4 v222, s[60:63], s99 offen offset:3072 lds
    s_add_u32 m0, s70, 40960
    s_nop 0
    buffer_load_dwordx4 v223, s[60:63], s99 offen offset:0 lds
    buffer_load_dwordx4 v224, s[60:63], s99 offen offset:1024 lds
    buffer_load_dwordx4 v225, s[60:63], s99 offen offset:2048 lds
    buffer_load_dwordx4 v226, s[60:63], s99 offen offset:3072 lds
    s_add_u32 m0, s70, 45056
    s_nop 0
    buffer_load_dwordx4 v227, s[60:63], s99 offen offset:0 lds
    v_mov_b32 v188, v170
    v_mov_b32 v189, v171
    s_nop 1
    v_permlane32_swap_b32 v188, v170
    v_permlane32_swap_b32 v189, v171
    s_nop 1
    v_add_f32 v170, v188, v170
    v_add_f32 v171, v189, v171
    v_mov_b32 v188, v170
    v_mov_b32 v189, v171
    s_nop 1
    v_permlane16_swap_b32 v188, v170
    v_permlane16_swap_b32 v189, v171
    s_nop 1
    v_add_f32 v170, v188, v170
    v_add_f32 v171, v189, v171
    v_rcp_f32 v4, v168
    v_rcp_f32 v5, v169
    v_rcp_f32 v6, v170
    v_rcp_f32 v7, v171
    s_nop 7
    v_accvgpr_read_b32 v136, a128
    v_accvgpr_read_b32 v137, a129
    v_accvgpr_read_b32 v138, a130
    v_accvgpr_read_b32 v139, a131
    v_accvgpr_read_b32 v140, a132
    v_accvgpr_read_b32 v141, a133
    v_accvgpr_read_b32 v142, a134
    v_accvgpr_read_b32 v143, a135
    v_pk_mul_f32 v[136:137], v[136:137], v[4:5] op_sel:[0,0] op_sel_hi:[1,0]
    v_pk_mul_f32 v[138:139], v[138:139], v[4:5] op_sel:[0,0] op_sel_hi:[1,0]
    v_pk_mul_f32 v[140:141], v[140:141], v[4:5] op_sel:[0,0] op_sel_hi:[1,0]
    v_pk_mul_f32 v[142:143], v[142:143], v[4:5] op_sel:[0,0] op_sel_hi:[1,0]
    v_cvt_pk_bf16_f32 v152, v136, v137
    v_cvt_pk_bf16_f32 v153, v138, v139
    v_cvt_pk_bf16_f32 v154, v140, v141
    v_cvt_pk_bf16_f32 v155, v142, v143
    s_add_u32 s25, s24, 0
    buffer_store_dwordx4 v[152:155], v3, s[16:19], s25 offen offset:0 sc1
    v_accvgpr_read_b32 v144, a192
    v_accvgpr_read_b32 v145, a193
    v_accvgpr_read_b32 v146, a194
    v_accvgpr_read_b32 v147, a195
    v_accvgpr_read_b32 v148, a196
    v_accvgpr_read_b32 v149, a197
    v_accvgpr_read_b32 v150, a198
    v_accvgpr_read_b32 v151, a199
    v_pk_mul_f32 v[144:145], v[144:145], v[6:7] op_sel:[0,0] op_sel_hi:[1,0]
    v_pk_mul_f32 v[146:147], v[146:147], v[6:7] op_sel:[0,0] op_sel_hi:[1,0]
    v_pk_mul_f32 v[148:149], v[148:149], v[6:7] op_sel:[0,0] op_sel_hi:[1,0]
    v_pk_mul_f32 v[150:151], v[150:151], v[6:7] op_sel:[0,0] op_sel_hi:[1,0]
    v_cvt_pk_bf16_f32 v160, v144, v145
    v_cvt_pk_bf16_f32 v161, v146, v147
    v_cvt_pk_bf16_f32 v162, v148, v149
    v_cvt_pk_bf16_f32 v163, v150, v151
    s_add_u32 s25, s24, 0
    buffer_store_dwordx4 v[160:163], v3, s[16:19], s25 offen offset:2048 sc1
    v_accvgpr_read_b32 v136, a160
    v_accvgpr_read_b32 v137, a161
    v_accvgpr_read_b32 v138, a162
    v_accvgpr_read_b32 v139, a163
    v_accvgpr_read_b32 v140, a164
    v_accvgpr_read_b32 v141, a165
    v_accvgpr_read_b32 v142, a166
    v_accvgpr_read_b32 v143, a167
    v_pk_mul_f32 v[136:137], v[136:137], v[4:5] op_sel:[0,1] op_sel_hi:[1,1]
    v_pk_mul_f32 v[138:139], v[138:139], v[4:5] op_sel:[0,1] op_sel_hi:[1,1]
    v_pk_mul_f32 v[140:141], v[140:141], v[4:5] op_sel:[0,1] op_sel_hi:[1,1]
    v_pk_mul_f32 v[142:143], v[142:143], v[4:5] op_sel:[0,1] op_sel_hi:[1,1]
    v_cvt_pk_bf16_f32 v156, v136, v137
    v_cvt_pk_bf16_f32 v157, v138, v139
    v_cvt_pk_bf16_f32 v158, v140, v141
    v_cvt_pk_bf16_f32 v159, v142, v143
    s_add_u32 s25, s24, 0
    buffer_store_dwordx4 v[156:159], v3, s[16:19], s25 offen offset:1024 sc1
    v_accvgpr_read_b32 v144, a224
    v_accvgpr_read_b32 v145, a225
    v_accvgpr_read_b32 v146, a226
    v_accvgpr_read_b32 v147, a227
    v_accvgpr_read_b32 v148, a228
    v_accvgpr_read_b32 v149, a229
    v_accvgpr_read_b32 v150, a230
    v_accvgpr_read_b32 v151, a231
    v_pk_mul_f32 v[144:145], v[144:145], v[6:7] op_sel:[0,1] op_sel_hi:[1,1]
    v_pk_mul_f32 v[146:147], v[146:147], v[6:7] op_sel:[0,1] op_sel_hi:[1,1]
    v_pk_mul_f32 v[148:149], v[148:149], v[6:7] op_sel:[0,1] op_sel_hi:[1,1]
    v_pk_mul_f32 v[150:151], v[150:151], v[6:7] op_sel:[0,1] op_sel_hi:[1,1]
    v_cvt_pk_bf16_f32 v164, v144, v145
    v_cvt_pk_bf16_f32 v165, v146, v147
    v_cvt_pk_bf16_f32 v166, v148, v149
    v_cvt_pk_bf16_f32 v167, v150, v151
    s_add_u32 s25, s24, 0
    buffer_store_dwordx4 v[164:167], v3, s[16:19], s25 offen offset:3072 sc1
    v_accvgpr_read_b32 v136, a136
    v_accvgpr_read_b32 v137, a137
    v_accvgpr_read_b32 v138, a138
    v_accvgpr_read_b32 v139, a139
    v_accvgpr_read_b32 v140, a140
    v_accvgpr_read_b32 v141, a141
    v_accvgpr_read_b32 v142, a142
    v_accvgpr_read_b32 v143, a143
    v_pk_mul_f32 v[136:137], v[136:137], v[4:5] op_sel:[0,0] op_sel_hi:[1,0]
    v_pk_mul_f32 v[138:139], v[138:139], v[4:5] op_sel:[0,0] op_sel_hi:[1,0]
    v_pk_mul_f32 v[140:141], v[140:141], v[4:5] op_sel:[0,0] op_sel_hi:[1,0]
    v_pk_mul_f32 v[142:143], v[142:143], v[4:5] op_sel:[0,0] op_sel_hi:[1,0]
    v_cvt_pk_bf16_f32 v168, v136, v137
    v_cvt_pk_bf16_f32 v169, v138, v139
    v_cvt_pk_bf16_f32 v170, v140, v141
    v_cvt_pk_bf16_f32 v171, v142, v143
    s_add_u32 s25, s24, 16384
    buffer_store_dwordx4 v[168:171], v3, s[16:19], s25 offen offset:0 sc1
    v_accvgpr_read_b32 v144, a200
    v_accvgpr_read_b32 v145, a201
    v_accvgpr_read_b32 v146, a202
    v_accvgpr_read_b32 v147, a203
    v_accvgpr_read_b32 v148, a204
    v_accvgpr_read_b32 v149, a205
    v_accvgpr_read_b32 v150, a206
    v_accvgpr_read_b32 v151, a207
    v_pk_mul_f32 v[144:145], v[144:145], v[6:7] op_sel:[0,0] op_sel_hi:[1,0]
    v_pk_mul_f32 v[146:147], v[146:147], v[6:7] op_sel:[0,0] op_sel_hi:[1,0]
    v_pk_mul_f32 v[148:149], v[148:149], v[6:7] op_sel:[0,0] op_sel_hi:[1,0]
    v_pk_mul_f32 v[150:151], v[150:151], v[6:7] op_sel:[0,0] op_sel_hi:[1,0]
    v_cvt_pk_bf16_f32 v176, v144, v145
    v_cvt_pk_bf16_f32 v177, v146, v147
    v_cvt_pk_bf16_f32 v178, v148, v149
    v_cvt_pk_bf16_f32 v179, v150, v151
    s_add_u32 s25, s24, 16384
    buffer_store_dwordx4 v[176:179], v3, s[16:19], s25 offen offset:2048 sc1
    v_accvgpr_read_b32 v136, a168
    v_accvgpr_read_b32 v137, a169
    v_accvgpr_read_b32 v138, a170
    v_accvgpr_read_b32 v139, a171
    v_accvgpr_read_b32 v140, a172
    v_accvgpr_read_b32 v141, a173
    v_accvgpr_read_b32 v142, a174
    v_accvgpr_read_b32 v143, a175
    v_pk_mul_f32 v[136:137], v[136:137], v[4:5] op_sel:[0,1] op_sel_hi:[1,1]
    v_pk_mul_f32 v[138:139], v[138:139], v[4:5] op_sel:[0,1] op_sel_hi:[1,1]
    v_pk_mul_f32 v[140:141], v[140:141], v[4:5] op_sel:[0,1] op_sel_hi:[1,1]
    v_pk_mul_f32 v[142:143], v[142:143], v[4:5] op_sel:[0,1] op_sel_hi:[1,1]
    v_cvt_pk_bf16_f32 v172, v136, v137
    v_cvt_pk_bf16_f32 v173, v138, v139
    v_cvt_pk_bf16_f32 v174, v140, v141
    v_cvt_pk_bf16_f32 v175, v142, v143
    s_add_u32 s25, s24, 16384
    buffer_store_dwordx4 v[172:175], v3, s[16:19], s25 offen offset:1024 sc1
    v_accvgpr_read_b32 v144, a232
    v_accvgpr_read_b32 v145, a233
    v_accvgpr_read_b32 v146, a234
    v_accvgpr_read_b32 v147, a235
    v_accvgpr_read_b32 v148, a236
    v_accvgpr_read_b32 v149, a237
    v_accvgpr_read_b32 v150, a238
    v_accvgpr_read_b32 v151, a239
    v_pk_mul_f32 v[144:145], v[144:145], v[6:7] op_sel:[0,1] op_sel_hi:[1,1]
    v_pk_mul_f32 v[146:147], v[146:147], v[6:7] op_sel:[0,1] op_sel_hi:[1,1]
    v_pk_mul_f32 v[148:149], v[148:149], v[6:7] op_sel:[0,1] op_sel_hi:[1,1]
    v_pk_mul_f32 v[150:151], v[150:151], v[6:7] op_sel:[0,1] op_sel_hi:[1,1]
    v_cvt_pk_bf16_f32 v180, v144, v145
    v_cvt_pk_bf16_f32 v181, v146, v147
    v_cvt_pk_bf16_f32 v182, v148, v149
    v_cvt_pk_bf16_f32 v183, v150, v151
    s_add_u32 s25, s24, 16384
    buffer_store_dwordx4 v[180:183], v3, s[16:19], s25 offen offset:3072 sc1
    v_accvgpr_read_b32 v136, a144
    v_accvgpr_read_b32 v137, a145
    v_accvgpr_read_b32 v138, a146
    v_accvgpr_read_b32 v139, a147
    v_accvgpr_read_b32 v140, a148
    v_accvgpr_read_b32 v141, a149
    v_accvgpr_read_b32 v142, a150
    v_accvgpr_read_b32 v143, a151
    v_pk_mul_f32 v[136:137], v[136:137], v[4:5] op_sel:[0,0] op_sel_hi:[1,0]
    v_pk_mul_f32 v[138:139], v[138:139], v[4:5] op_sel:[0,0] op_sel_hi:[1,0]
    v_pk_mul_f32 v[140:141], v[140:141], v[4:5] op_sel:[0,0] op_sel_hi:[1,0]
    v_pk_mul_f32 v[142:143], v[142:143], v[4:5] op_sel:[0,0] op_sel_hi:[1,0]
    v_cvt_pk_bf16_f32 v184, v136, v137
    v_cvt_pk_bf16_f32 v185, v138, v139
    v_cvt_pk_bf16_f32 v186, v140, v141
    v_cvt_pk_bf16_f32 v187, v142, v143
    v_accvgpr_read_b32 v144, a208
    v_accvgpr_read_b32 v145, a209
    v_accvgpr_read_b32 v146, a210
    v_accvgpr_read_b32 v147, a211
    v_accvgpr_read_b32 v148, a212
    v_accvgpr_read_b32 v149, a213
    v_accvgpr_read_b32 v150, a214
    v_accvgpr_read_b32 v151, a215
    v_pk_mul_f32 v[144:145], v[144:145], v[6:7] op_sel:[0,0] op_sel_hi:[1,0]
    v_pk_mul_f32 v[146:147], v[146:147], v[6:7] op_sel:[0,0] op_sel_hi:[1,0]
    v_pk_mul_f32 v[148:149], v[148:149], v[6:7] op_sel:[0,0] op_sel_hi:[1,0]
    v_pk_mul_f32 v[150:151], v[150:151], v[6:7] op_sel:[0,0] op_sel_hi:[1,0]
    v_cvt_pk_bf16_f32 v192, v144, v145
    v_cvt_pk_bf16_f32 v193, v146, v147
    v_cvt_pk_bf16_f32 v194, v148, v149
    v_cvt_pk_bf16_f32 v195, v150, v151
    v_accvgpr_read_b32 v136, a176
    v_accvgpr_read_b32 v137, a177
    v_accvgpr_read_b32 v138, a178
    v_accvgpr_read_b32 v139, a179
    v_accvgpr_read_b32 v140, a180
    v_accvgpr_read_b32 v141, a181
    v_accvgpr_read_b32 v142, a182
    v_accvgpr_read_b32 v143, a183
    v_pk_mul_f32 v[136:137], v[136:137], v[4:5] op_sel:[0,1] op_sel_hi:[1,1]
    v_pk_mul_f32 v[138:139], v[138:139], v[4:5] op_sel:[0,1] op_sel_hi:[1,1]
    v_pk_mul_f32 v[140:141], v[140:141], v[4:5] op_sel:[0,1] op_sel_hi:[1,1]
    v_pk_mul_f32 v[142:143], v[142:143], v[4:5] op_sel:[0,1] op_sel_hi:[1,1]
    v_cvt_pk_bf16_f32 v188, v136, v137
    v_cvt_pk_bf16_f32 v189, v138, v139
    v_cvt_pk_bf16_f32 v190, v140, v141
    v_cvt_pk_bf16_f32 v191, v142, v143
    v_accvgpr_read_b32 v144, a240
    v_accvgpr_read_b32 v145, a241
    v_accvgpr_read_b32 v146, a242
    v_accvgpr_read_b32 v147, a243
    v_accvgpr_read_b32 v148, a244
    v_accvgpr_read_b32 v149, a245
    v_accvgpr_read_b32 v150, a246
    v_accvgpr_read_b32 v151, a247
    v_pk_mul_f32 v[144:145], v[144:145], v[6:7] op_sel:[0,1] op_sel_hi:[1,1]
    v_pk_mul_f32 v[146:147], v[146:147], v[6:7] op_sel:[0,1] op_sel_hi:[1,1]
    v_pk_mul_f32 v[148:149], v[148:149], v[6:7] op_sel:[0,1] op_sel_hi:[1,1]
    v_pk_mul_f32 v[150:151], v[150:151], v[6:7] op_sel:[0,1] op_sel_hi:[1,1]
    v_cvt_pk_bf16_f32 v196, v144, v145
    v_cvt_pk_bf16_f32 v197, v146, v147
    v_cvt_pk_bf16_f32 v198, v148, v149
    v_cvt_pk_bf16_f32 v199, v150, v151
    v_accvgpr_read_b32 v136, a152
    v_accvgpr_read_b32 v137, a153
    v_accvgpr_read_b32 v138, a154
    v_accvgpr_read_b32 v139, a155
    v_accvgpr_read_b32 v140, a156
    v_accvgpr_read_b32 v141, a157
    v_accvgpr_read_b32 v142, a158
    v_accvgpr_read_b32 v143, a159
    v_pk_mul_f32 v[136:137], v[136:137], v[4:5] op_sel:[0,0] op_sel_hi:[1,0]
    v_pk_mul_f32 v[138:139], v[138:139], v[4:5] op_sel:[0,0] op_sel_hi:[1,0]
    v_pk_mul_f32 v[140:141], v[140:141], v[4:5] op_sel:[0,0] op_sel_hi:[1,0]
    v_pk_mul_f32 v[142:143], v[142:143], v[4:5] op_sel:[0,0] op_sel_hi:[1,0]
    v_cvt_pk_bf16_f32 v200, v136, v137
    v_cvt_pk_bf16_f32 v201, v138, v139
    v_cvt_pk_bf16_f32 v202, v140, v141
    v_cvt_pk_bf16_f32 v203, v142, v143
    v_accvgpr_read_b32 v144, a216
    v_accvgpr_read_b32 v145, a217
    v_accvgpr_read_b32 v146, a218
    v_accvgpr_read_b32 v147, a219
    v_accvgpr_read_b32 v148, a220
    v_accvgpr_read_b32 v149, a221
    v_accvgpr_read_b32 v150, a222
    v_accvgpr_read_b32 v151, a223
    v_pk_mul_f32 v[144:145], v[144:145], v[6:7] op_sel:[0,0] op_sel_hi:[1,0]
    v_pk_mul_f32 v[146:147], v[146:147], v[6:7] op_sel:[0,0] op_sel_hi:[1,0]
    v_pk_mul_f32 v[148:149], v[148:149], v[6:7] op_sel:[0,0] op_sel_hi:[1,0]
    v_pk_mul_f32 v[150:151], v[150:151], v[6:7] op_sel:[0,0] op_sel_hi:[1,0]
    v_cvt_pk_bf16_f32 v208, v144, v145
    v_cvt_pk_bf16_f32 v209, v146, v147
    v_cvt_pk_bf16_f32 v210, v148, v149
    v_cvt_pk_bf16_f32 v211, v150, v151
    v_accvgpr_read_b32 v136, a184
    v_accvgpr_read_b32 v137, a185
    v_accvgpr_read_b32 v138, a186
    v_accvgpr_read_b32 v139, a187
    v_accvgpr_read_b32 v140, a188
    v_accvgpr_read_b32 v141, a189
    v_accvgpr_read_b32 v142, a190
    v_accvgpr_read_b32 v143, a191
    v_pk_mul_f32 v[136:137], v[136:137], v[4:5] op_sel:[0,1] op_sel_hi:[1,1]
    v_pk_mul_f32 v[138:139], v[138:139], v[4:5] op_sel:[0,1] op_sel_hi:[1,1]
    v_pk_mul_f32 v[140:141], v[140:141], v[4:5] op_sel:[0,1] op_sel_hi:[1,1]
    v_pk_mul_f32 v[142:143], v[142:143], v[4:5] op_sel:[0,1] op_sel_hi:[1,1]
    v_cvt_pk_bf16_f32 v204, v136, v137
    v_cvt_pk_bf16_f32 v205, v138, v139
    v_cvt_pk_bf16_f32 v206, v140, v141
    v_cvt_pk_bf16_f32 v207, v142, v143
    v_accvgpr_read_b32 v144, a248
    v_accvgpr_read_b32 v145, a249
    v_accvgpr_read_b32 v146, a250
    v_accvgpr_read_b32 v147, a251
    v_accvgpr_read_b32 v148, a252
    v_accvgpr_read_b32 v149, a253
    v_accvgpr_read_b32 v150, a254
    v_accvgpr_read_b32 v151, a255
    v_pk_mul_f32 v[144:145], v[144:145], v[6:7] op_sel:[0,1] op_sel_hi:[1,1]
    v_pk_mul_f32 v[146:147], v[146:147], v[6:7] op_sel:[0,1] op_sel_hi:[1,1]
    v_pk_mul_f32 v[148:149], v[148:149], v[6:7] op_sel:[0,1] op_sel_hi:[1,1]
    v_pk_mul_f32 v[150:151], v[150:151], v[6:7] op_sel:[0,1] op_sel_hi:[1,1]
    v_cvt_pk_bf16_f32 v212, v144, v145
    v_cvt_pk_bf16_f32 v213, v146, v147
    v_cvt_pk_bf16_f32 v214, v148, v149
    v_cvt_pk_bf16_f32 v215, v150, v151
    s_waitcnt vmcnt(33)
    v_mov_b32 v229, v228
    v_lshlrev_b32 v4, 3, v2
    s_barrier
    ds_read_b64_tr_b16 v[136:137], v229 offset:0
    ds_read_b64_tr_b16 v[138:139], v229 offset:4608
    ds_read_b64_tr_b16 v[140:141], v229 offset:32
    ds_read_b64_tr_b16 v[142:143], v229 offset:4640
    ds_read_b64_tr_b16 v[144:145], v229 offset:64
    ds_read_b64_tr_b16 v[146:147], v229 offset:4672
    s_waitcnt lgkmcnt(4)
    s_waitcnt vmcnt(29)
    v_mfma_f32_16x16x32_bf16 a[0:3], v[136:139], v[8:11], 0
    v_mfma_f32_16x16x32_bf16 a[4:7], v[136:139], v[12:15], 0
    ds_read_b64_tr_b16 v[148:149], v229 offset:96
    v_mfma_f32_16x16x32_bf16 a[8:11], v[136:139], v[16:19], 0
    ds_read_b64_tr_b16 v[150:151], v229 offset:4704
    v_mfma_f32_16x16x32_bf16 a[12:15], v[136:139], v[20:23], 0
    s_add_u32 s100, s69, 65536
    s_waitcnt lgkmcnt(4)
    v_mfma_f32_16x16x32_bf16 a[16:19], v[140:143], v[8:11], 0
    buffer_load_dwordx2 v[72:73], v232, s[64:67], s100 offen offset:0 sc1
    v_mfma_f32_16x16x32_bf16 a[20:23], v[140:143], v[12:15], 0
    ds_read_b64_tr_b16 v[136:137], v229 offset:128
    v_mfma_f32_16x16x32_bf16 a[24:27], v[140:143], v[16:19], 0
    ds_read_b64_tr_b16 v[138:139], v229 offset:4736
    v_mfma_f32_16x16x32_bf16 a[28:31], v[140:143], v[20:23], 0
    s_add_u32 s100, s69, 65536
    s_waitcnt lgkmcnt(4)
    v_mfma_f32_16x16x32_bf16 a[32:35], v[144:147], v[8:11], 0
    buffer_load_dwordx2 v[74:75], v232, s[64:67], s100 offen offset:512 sc1
    v_mfma_f32_16x16x32_bf16 a[36:39], v[144:147], v[12:15], 0
    ds_read_b64_tr_b16 v[140:141], v229 offset:160
    v_mfma_f32_16x16x32_bf16 a[40:43], v[144:147], v[16:19], 0
    ds_read_b64_tr_b16 v[142:143], v229 offset:4768
    v_mfma_f32_16x16x32_bf16 a[44:47], v[144:147], v[20:23], 0
    s_add_u32 s100, s69, 65536
    s_waitcnt lgkmcnt(4)
    v_mfma_f32_16x16x32_bf16 a[48:51], v[148:151], v[8:11], 0
    buffer_load_dwordx2 v[76:77], v232, s[64:67], s100 offen offset:1024 sc1
    v_mfma_f32_16x16x32_bf16 a[52:55], v[148:151], v[12:15], 0
    ds_read_b64_tr_b16 v[144:145], v229 offset:192
    v_mfma_f32_16x16x32_bf16 a[56:59], v[148:151], v[16:19], 0
    ds_read_b64_tr_b16 v[146:147], v229 offset:4800
    v_mfma_f32_16x16x32_bf16 a[60:63], v[148:151], v[20:23], 0
    s_add_u32 s100, s69, 65536
    s_waitcnt lgkmcnt(4)
    v_mfma_f32_16x16x32_bf16 a[64:67], v[136:139], v[8:11], 0
    buffer_load_dwordx2 v[78:79], v232, s[64:67], s100 offen offset:1536 sc1
    v_mfma_f32_16x16x32_bf16 a[68:71], v[136:139], v[12:15], 0
    ds_read_b64_tr_b16 v[148:149], v229 offset:224
    v_mfma_f32_16x16x32_bf16 a[72:75], v[136:139], v[16:19], 0
    ds_read_b64_tr_b16 v[150:151], v229 offset:4832
    v_mfma_f32_16x16x32_bf16 a[76:79], v[136:139], v[20:23], 0
    s_add_u32 s100, s69, 65536
    s_waitcnt lgkmcnt(4)
    v_mfma_f32_16x16x32_bf16 a[80:83], v[140:143], v[8:11], 0
    buffer_load_dwordx2 v[80:81], v232, s[64:67], s100 offen offset:2048 sc1
    v_mfma_f32_16x16x32_bf16 a[84:87], v[140:143], v[12:15], 0
    ds_read_b64_tr_b16 v[136:137], v229 offset:256
    v_mfma_f32_16x16x32_bf16 a[88:91], v[140:143], v[16:19], 0
    ds_read_b64_tr_b16 v[138:139], v229 offset:4864
    v_mfma_f32_16x16x32_bf16 a[92:95], v[140:143], v[20:23], 0
    s_add_u32 s100, s69, 65536
    s_waitcnt lgkmcnt(4)
    v_mfma_f32_16x16x32_bf16 a[96:99], v[144:147], v[8:11], 0
    buffer_load_dwordx2 v[82:83], v232, s[64:67], s100 offen offset:2560 sc1
    v_mfma_f32_16x16x32_bf16 a[100:103], v[144:147], v[12:15], 0
    ds_read_b64_tr_b16 v[140:141], v229 offset:9216
    v_mfma_f32_16x16x32_bf16 a[104:107], v[144:147], v[16:19], 0
    ds_read_b64_tr_b16 v[142:143], v229 offset:13824
    v_mfma_f32_16x16x32_bf16 a[108:111], v[144:147], v[20:23], 0
    s_add_u32 s100, s69, 65536
    s_waitcnt lgkmcnt(4)
    v_mfma_f32_16x16x32_bf16 a[112:115], v[148:151], v[8:11], 0
    buffer_load_dwordx2 v[84:85], v232, s[64:67], s100 offen offset:3072 sc1
    v_mfma_f32_16x16x32_bf16 a[116:119], v[148:151], v[12:15], 0
    ds_read_b64_tr_b16 v[144:145], v229 offset:9248
    v_mfma_f32_16x16x32_bf16 a[120:123], v[148:151], v[16:19], 0
    ds_read_b64_tr_b16 v[146:147], v229 offset:13856
    v_mfma_f32_16x16x32_bf16 a[124:127], v[148:151], v[20:23], 0
    s_add_u32 s100, s69, 65536
    s_waitcnt lgkmcnt(4)
    v_mfma_f32_16x16x32_bf16 a[128:131], v[136:139], v[8:11], 0
    buffer_load_dwordx2 v[86:87], v232, s[64:67], s100 offen offset:3584 sc1
    v_mfma_f32_16x16x32_bf16 a[132:135], v[136:139], v[12:15], 0
    ds_read_b64_tr_b16 v[148:149], v229 offset:9280
    v_mfma_f32_16x16x32_bf16 a[136:139], v[136:139], v[16:19], 0
    ds_read_b64_tr_b16 v[150:151], v229 offset:13888
    v_mfma_f32_16x16x32_bf16 a[140:143], v[136:139], v[20:23], 0
    s_add_u32 s100, s69, 131072
    s_waitcnt lgkmcnt(4)
    s_waitcnt vmcnt(33)
    v_mfma_f32_16x16x32_bf16 a[0:3], v[140:143], v[24:27], a[0:3]
    buffer_load_dwordx4 v[8:11], v3, s[64:67], s100 offen offset:0 sc1
    v_mfma_f32_16x16x32_bf16 a[4:7], v[140:143], v[28:31], a[4:7]
    ds_read_b64_tr_b16 v[136:137], v229 offset:9312
    v_mfma_f32_16x16x32_bf16 a[8:11], v[140:143], v[32:35], a[8:11]
    ds_read_b64_tr_b16 v[138:139], v229 offset:13920
    v_mfma_f32_16x16x32_bf16 a[12:15], v[140:143], v[36:39], a[12:15]
    s_add_u32 s100, s69, 131072
    s_waitcnt lgkmcnt(4)
    v_mfma_f32_16x16x32_bf16 a[16:19], v[144:147], v[24:27], a[16:19]
    buffer_load_dwordx4 v[12:15], v3, s[64:67], s100 offen offset:1024 sc1
    v_mfma_f32_16x16x32_bf16 a[20:23], v[144:147], v[28:31], a[20:23]
    ds_read_b64_tr_b16 v[140:141], v229 offset:9344
    v_mfma_f32_16x16x32_bf16 a[24:27], v[144:147], v[32:35], a[24:27]
    ds_read_b64_tr_b16 v[142:143], v229 offset:13952
    v_mfma_f32_16x16x32_bf16 a[28:31], v[144:147], v[36:39], a[28:31]
    s_add_u32 s100, s69, 131072
    s_waitcnt lgkmcnt(4)
    v_mfma_f32_16x16x32_bf16 a[32:35], v[148:151], v[24:27], a[32:35]
    buffer_load_dwordx4 v[16:19], v3, s[64:67], s100 offen offset:2048 sc1
    v_mfma_f32_16x16x32_bf16 a[36:39], v[148:151], v[28:31], a[36:39]
    ds_read_b64_tr_b16 v[144:145], v229 offset:9376
    v_mfma_f32_16x16x32_bf16 a[40:43], v[148:151], v[32:35], a[40:43]
    ds_read_b64_tr_b16 v[146:147], v229 offset:13984
    v_mfma_f32_16x16x32_bf16 a[44:47], v[148:151], v[36:39], a[44:47]
    s_add_u32 s100, s69, 131072
    s_waitcnt lgkmcnt(4)
    v_mfma_f32_16x16x32_bf16 a[48:51], v[136:139], v[24:27], a[48:51]
    buffer_load_dwordx4 v[20:23], v3, s[64:67], s100 offen offset:3072 sc1
    v_mfma_f32_16x16x32_bf16 a[52:55], v[136:139], v[28:31], a[52:55]
    ds_read_b64_tr_b16 v[148:149], v229 offset:9408
    v_mfma_f32_16x16x32_bf16 a[56:59], v[136:139], v[32:35], a[56:59]
    ds_read_b64_tr_b16 v[150:151], v229 offset:14016
    v_mfma_f32_16x16x32_bf16 a[60:63], v[136:139], v[36:39], a[60:63]
    s_add_u32 s100, s69, 81920
    s_waitcnt lgkmcnt(4)
    v_mfma_f32_16x16x32_bf16 a[64:67], v[140:143], v[24:27], a[64:67]
    buffer_load_dwordx4 v[88:91], v3, s[64:67], s100 offen offset:0 sc1
    v_mfma_f32_16x16x32_bf16 a[68:71], v[140:143], v[28:31], a[68:71]
    ds_read_b64_tr_b16 v[136:137], v229 offset:9440
    v_mfma_f32_16x16x32_bf16 a[72:75], v[140:143], v[32:35], a[72:75]
    ds_read_b64_tr_b16 v[138:139], v229 offset:14048
    v_mfma_f32_16x16x32_bf16 a[76:79], v[140:143], v[36:39], a[76:79]
    s_add_u32 s100, s69, 81920
    s_waitcnt lgkmcnt(4)
    v_mfma_f32_16x16x32_bf16 a[80:83], v[144:147], v[24:27], a[80:83]
    buffer_load_dwordx4 v[92:95], v3, s[64:67], s100 offen offset:1024 sc1
    v_mfma_f32_16x16x32_bf16 a[84:87], v[144:147], v[28:31], a[84:87]
    ds_read_b64_tr_b16 v[140:141], v229 offset:9472
    v_mfma_f32_16x16x32_bf16 a[88:91], v[144:147], v[32:35], a[88:91]
    ds_read_b64_tr_b16 v[142:143], v229 offset:14080
    v_mfma_f32_16x16x32_bf16 a[92:95], v[144:147], v[36:39], a[92:95]
    s_add_u32 s100, s69, 81920
    s_waitcnt lgkmcnt(4)
    v_mfma_f32_16x16x32_bf16 a[96:99], v[148:151], v[24:27], a[96:99]
    buffer_load_dwordx4 v[96:99], v3, s[64:67], s100 offen offset:2048 sc1
    v_mfma_f32_16x16x32_bf16 a[100:103], v[148:151], v[28:31], a[100:103]
    ds_read_b64_tr_b16 v[144:145], v229 offset:18432
    v_mfma_f32_16x16x32_bf16 a[104:107], v[148:151], v[32:35], a[104:107]
    ds_read_b64_tr_b16 v[146:147], v229 offset:23040
    v_mfma_f32_16x16x32_bf16 a[108:111], v[148:151], v[36:39], a[108:111]
    s_add_u32 s100, s69, 81920
    s_waitcnt lgkmcnt(4)
    v_mfma_f32_16x16x32_bf16 a[112:115], v[136:139], v[24:27], a[112:115]
    buffer_load_dwordx4 v[100:103], v3, s[64:67], s100 offen offset:3072 sc1
    v_mfma_f32_16x16x32_bf16 a[116:119], v[136:139], v[28:31], a[116:119]
    ds_read_b64_tr_b16 v[148:149], v229 offset:18464
    v_mfma_f32_16x16x32_bf16 a[120:123], v[136:139], v[32:35], a[120:123]
    ds_read_b64_tr_b16 v[150:151], v229 offset:23072
    v_mfma_f32_16x16x32_bf16 a[124:127], v[136:139], v[36:39], a[124:127]
    s_add_u32 s99, s68, 294912
    s_add_u32 m0, s70, 73728
    s_waitcnt lgkmcnt(4)
    v_mfma_f32_16x16x32_bf16 a[128:131], v[140:143], v[24:27], a[128:131]
    buffer_load_dwordx4 v219, s[60:63], s99 offen offset:0 lds
    v_mfma_f32_16x16x32_bf16 a[132:135], v[140:143], v[28:31], a[132:135]
    ds_read_b64_tr_b16 v[136:137], v229 offset:18496
    v_mfma_f32_16x16x32_bf16 a[136:139], v[140:143], v[32:35], a[136:139]
    ds_read_b64_tr_b16 v[138:139], v229 offset:23104
    v_mfma_f32_16x16x32_bf16 a[140:143], v[140:143], v[36:39], a[140:143]
    s_add_u32 s100, s69, 147456
    s_waitcnt lgkmcnt(4)
    s_waitcnt vmcnt(38)
    s_waitcnt vmcnt(17)
    buffer_store_dword v254, off, s[16:19], s57 sc1
    v_mfma_f32_16x16x32_bf16 a[0:3], v[144:147], v[40:43], a[0:3]
    buffer_load_dwordx4 v[24:27], v3, s[64:67], s100 offen offset:0 sc1
    v_mfma_f32_16x16x32_bf16 a[4:7], v[144:147], v[44:47], a[4:7]
    ds_read_b64_tr_b16 v[140:141], v229 offset:18528
    v_mfma_f32_16x16x32_bf16 a[8:11], v[144:147], v[48:51], a[8:11]
    ds_read_b64_tr_b16 v[142:143], v229 offset:23136
    v_mfma_f32_16x16x32_bf16 a[12:15], v[144:147], v[52:55], a[12:15]
    s_add_u32 s100, s69, 147456
    s_waitcnt lgkmcnt(4)
    v_mfma_f32_16x16x32_bf16 a[16:19], v[148:151], v[40:43], a[16:19]
    buffer_load_dwordx4 v[28:31], v3, s[64:67], s100 offen offset:1024 sc1
    v_mfma_f32_16x16x32_bf16 a[20:23], v[148:151], v[44:47], a[20:23]
    ds_read_b64_tr_b16 v[144:145], v229 offset:18560
    v_mfma_f32_16x16x32_bf16 a[24:27], v[148:151], v[48:51], a[24:27]
    ds_read_b64_tr_b16 v[146:147], v229 offset:23168
    v_mfma_f32_16x16x32_bf16 a[28:31], v[148:151], v[52:55], a[28:31]
    s_add_u32 s100, s69, 147456
    s_waitcnt lgkmcnt(4)
    v_mfma_f32_16x16x32_bf16 a[32:35], v[136:139], v[40:43], a[32:35]
    buffer_load_dwordx4 v[32:35], v3, s[64:67], s100 offen offset:2048 sc1
    v_mfma_f32_16x16x32_bf16 a[36:39], v[136:139], v[44:47], a[36:39]
    ds_read_b64_tr_b16 v[148:149], v229 offset:18592
    v_mfma_f32_16x16x32_bf16 a[40:43], v[136:139], v[48:51], a[40:43]
    ds_read_b64_tr_b16 v[150:151], v229 offset:23200
    v_mfma_f32_16x16x32_bf16 a[44:47], v[136:139], v[52:55], a[44:47]
    s_add_u32 s100, s69, 147456
    s_waitcnt lgkmcnt(4)
    v_mfma_f32_16x16x32_bf16 a[48:51], v[140:143], v[40:43], a[48:51]
    buffer_load_dwordx4 v[36:39], v3, s[64:67], s100 offen offset:3072 sc1
    v_mfma_f32_16x16x32_bf16 a[52:55], v[140:143], v[44:47], a[52:55]
    ds_read_b64_tr_b16 v[136:137], v229 offset:18624
    v_mfma_f32_16x16x32_bf16 a[56:59], v[140:143], v[48:51], a[56:59]
    ds_read_b64_tr_b16 v[138:139], v229 offset:23232
    v_mfma_f32_16x16x32_bf16 a[60:63], v[140:143], v[52:55], a[60:63]
    s_waitcnt lgkmcnt(4)
    v_mfma_f32_16x16x32_bf16 a[64:67], v[144:147], v[40:43], a[64:67]
    buffer_load_dwordx4 v220, s[60:63], s99 offen offset:1024 lds
    v_mfma_f32_16x16x32_bf16 a[68:71], v[144:147], v[44:47], a[68:71]
    ds_read_b64_tr_b16 v[140:141], v229 offset:18656
    v_mfma_f32_16x16x32_bf16 a[72:75], v[144:147], v[48:51], a[72:75]
    ds_read_b64_tr_b16 v[142:143], v229 offset:23264
    v_mfma_f32_16x16x32_bf16 a[76:79], v[144:147], v[52:55], a[76:79]
    s_waitcnt lgkmcnt(4)
    v_mfma_f32_16x16x32_bf16 a[80:83], v[148:151], v[40:43], a[80:83]
    buffer_load_dwordx4 v221, s[60:63], s99 offen offset:2048 lds
    v_mfma_f32_16x16x32_bf16 a[84:87], v[148:151], v[44:47], a[84:87]
    ds_read_b64_tr_b16 v[144:145], v229 offset:18688
    v_mfma_f32_16x16x32_bf16 a[88:91], v[148:151], v[48:51], a[88:91]
    ds_read_b64_tr_b16 v[146:147], v229 offset:23296
    v_mfma_f32_16x16x32_bf16 a[92:95], v[148:151], v[52:55], a[92:95]
    s_waitcnt lgkmcnt(4)
    v_mfma_f32_16x16x32_bf16 a[96:99], v[136:139], v[40:43], a[96:99]
    buffer_load_dwordx4 v222, s[60:63], s99 offen offset:3072 lds
    v_mfma_f32_16x16x32_bf16 a[100:103], v[136:139], v[44:47], a[100:103]
    ds_read_b64_tr_b16 v[148:149], v229 offset:27648
    v_mfma_f32_16x16x32_bf16 a[104:107], v[136:139], v[48:51], a[104:107]
    ds_read_b64_tr_b16 v[150:151], v229 offset:32256
    v_mfma_f32_16x16x32_bf16 a[108:111], v[136:139], v[52:55], a[108:111]
    s_add_u32 m0, s70, 77824
    s_waitcnt lgkmcnt(4)
    v_mfma_f32_16x16x32_bf16 a[112:115], v[140:143], v[40:43], a[112:115]
    buffer_load_dwordx4 v223, s[60:63], s99 offen offset:0 lds
    v_mfma_f32_16x16x32_bf16 a[116:119], v[140:143], v[44:47], a[116:119]
    ds_read_b64_tr_b16 v[136:137], v229 offset:27680
    v_mfma_f32_16x16x32_bf16 a[120:123], v[140:143], v[48:51], a[120:123]
    ds_read_b64_tr_b16 v[138:139], v229 offset:32288
    v_mfma_f32_16x16x32_bf16 a[124:127], v[140:143], v[52:55], a[124:127]
    s_waitcnt lgkmcnt(4)
    v_mfma_f32_16x16x32_bf16 a[128:131], v[144:147], v[40:43], a[128:131]
    buffer_load_dwordx4 v224, s[60:63], s99 offen offset:1024 lds
    v_mfma_f32_16x16x32_bf16 a[132:135], v[144:147], v[44:47], a[132:135]
    ds_read_b64_tr_b16 v[140:141], v229 offset:27712
    v_mfma_f32_16x16x32_bf16 a[136:139], v[144:147], v[48:51], a[136:139]
    ds_read_b64_tr_b16 v[142:143], v229 offset:32320
    v_mfma_f32_16x16x32_bf16 a[140:143], v[144:147], v[52:55], a[140:143]
    s_add_u32 s100, s69, 163840
    s_waitcnt lgkmcnt(4)
    v_mfma_f32_16x16x32_bf16 a[0:3], v[148:151], v[56:59], a[0:3]
    buffer_load_dwordx4 v[40:43], v3, s[64:67], s100 offen offset:0 sc1
    v_mfma_f32_16x16x32_bf16 a[4:7], v[148:151], v[60:63], a[4:7]
    ds_read_b64_tr_b16 v[144:145], v229 offset:27744
    v_mfma_f32_16x16x32_bf16 a[8:11], v[148:151], v[64:67], a[8:11]
    ds_read_b64_tr_b16 v[146:147], v229 offset:32352
    v_mfma_f32_16x16x32_bf16 a[12:15], v[148:151], v[68:71], a[12:15]
    s_add_u32 s100, s69, 163840
    s_waitcnt lgkmcnt(4)
    v_mfma_f32_16x16x32_bf16 a[16:19], v[136:139], v[56:59], a[16:19]
    buffer_load_dwordx4 v[44:47], v3, s[64:67], s100 offen offset:1024 sc1
    v_mfma_f32_16x16x32_bf16 a[20:23], v[136:139], v[60:63], a[20:23]
    ds_read_b64_tr_b16 v[148:149], v229 offset:27776
    v_mfma_f32_16x16x32_bf16 a[24:27], v[136:139], v[64:67], a[24:27]
    ds_read_b64_tr_b16 v[150:151], v229 offset:32384
    v_mfma_f32_16x16x32_bf16 a[28:31], v[136:139], v[68:71], a[28:31]
    s_add_u32 s100, s69, 163840
    s_waitcnt lgkmcnt(4)
    v_mfma_f32_16x16x32_bf16 a[32:35], v[140:143], v[56:59], a[32:35]
    buffer_load_dwordx4 v[48:51], v3, s[64:67], s100 offen offset:2048 sc1
    v_mfma_f32_16x16x32_bf16 a[36:39], v[140:143], v[60:63], a[36:39]
    ds_read_b64_tr_b16 v[136:137], v229 offset:27808
    v_mfma_f32_16x16x32_bf16 a[40:43], v[140:143], v[64:67], a[40:43]
    ds_read_b64_tr_b16 v[138:139], v229 offset:32416
    v_mfma_f32_16x16x32_bf16 a[44:47], v[140:143], v[68:71], a[44:47]
    s_add_u32 s100, s69, 163840
    s_waitcnt lgkmcnt(4)
    v_mfma_f32_16x16x32_bf16 a[48:51], v[144:147], v[56:59], a[48:51]
    buffer_load_dwordx4 v[52:55], v3, s[64:67], s100 offen offset:3072 sc1
    v_mfma_f32_16x16x32_bf16 a[52:55], v[144:147], v[60:63], a[52:55]
    ds_read_b64_tr_b16 v[140:141], v229 offset:27840
    v_mfma_f32_16x16x32_bf16 a[56:59], v[144:147], v[64:67], a[56:59]
    ds_read_b64_tr_b16 v[142:143], v229 offset:32448
    v_mfma_f32_16x16x32_bf16 a[60:63], v[144:147], v[68:71], a[60:63]
    s_waitcnt lgkmcnt(4)
    v_mfma_f32_16x16x32_bf16 a[64:67], v[148:151], v[56:59], a[64:67]
    buffer_load_dwordx4 v225, s[60:63], s99 offen offset:2048 lds
    v_mfma_f32_16x16x32_bf16 a[68:71], v[148:151], v[60:63], a[68:71]
    ds_read_b64_tr_b16 v[144:145], v229 offset:27872
    v_mfma_f32_16x16x32_bf16 a[72:75], v[148:151], v[64:67], a[72:75]
    ds_read_b64_tr_b16 v[146:147], v229 offset:32480
    v_mfma_f32_16x16x32_bf16 a[76:79], v[148:151], v[68:71], a[76:79]
    s_waitcnt lgkmcnt(4)
    v_mfma_f32_16x16x32_bf16 a[80:83], v[136:139], v[56:59], a[80:83]
    buffer_load_dwordx4 v226, s[60:63], s99 offen offset:3072 lds
    v_mfma_f32_16x16x32_bf16 a[84:87], v[136:139], v[60:63], a[84:87]
    ds_read_b64_tr_b16 v[148:149], v229 offset:27904
    v_mfma_f32_16x16x32_bf16 a[88:91], v[136:139], v[64:67], a[88:91]
    ds_read_b64_tr_b16 v[150:151], v229 offset:32512
    v_mfma_f32_16x16x32_bf16 a[92:95], v[136:139], v[68:71], a[92:95]
    s_add_u32 m0, s70, 81920
    s_waitcnt lgkmcnt(4)
    v_mfma_f32_16x16x32_bf16 a[96:99], v[140:143], v[56:59], a[96:99]
    s_waitcnt lgkmcnt(0)
    s_barrier
    v_add_u32 v229, 36864, v228
    buffer_load_dwordx4 v227, s[60:63], s99 offen offset:0 lds
    v_mfma_f32_16x16x32_bf16 a[100:103], v[140:143], v[60:63], a[100:103]
    ds_read_b64_tr_b16 v[136:137], v229 offset:0
    v_mfma_f32_16x16x32_bf16 a[104:107], v[140:143], v[64:67], a[104:107]
    ds_read_b64_tr_b16 v[138:139], v229 offset:4608
    v_mfma_f32_16x16x32_bf16 a[108:111], v[140:143], v[68:71], a[108:111]
    s_add_u32 s100, s69, 98304
    v_mfma_f32_16x16x32_bf16 a[112:115], v[144:147], v[56:59], a[112:115]
    buffer_load_dwordx4 v[104:107], v3, s[64:67], s100 offen offset:0 sc1
    v_mfma_f32_16x16x32_bf16 a[116:119], v[144:147], v[60:63], a[116:119]
    ds_read_b64_tr_b16 v[140:141], v229 offset:32
    v_mfma_f32_16x16x32_bf16 a[120:123], v[144:147], v[64:67], a[120:123]
    ds_read_b64_tr_b16 v[142:143], v229 offset:4640
    v_mfma_f32_16x16x32_bf16 a[124:127], v[144:147], v[68:71], a[124:127]
    s_add_u32 s100, s69, 98304
    v_mfma_f32_16x16x32_bf16 a[128:131], v[148:151], v[56:59], a[128:131]
    buffer_load_dwordx4 v[108:111], v3, s[64:67], s100 offen offset:1024 sc1
    v_mfma_f32_16x16x32_bf16 a[132:135], v[148:151], v[60:63], a[132:135]
    ds_read_b64_tr_b16 v[144:145], v229 offset:64
    v_mfma_f32_16x16x32_bf16 a[136:139], v[148:151], v[64:67], a[136:139]
    ds_read_b64_tr_b16 v[146:147], v229 offset:4672
    v_mfma_f32_16x16x32_bf16 a[140:143], v[148:151], v[68:71], a[140:143]
    s_add_u32 s100, s69, 180224
    s_waitcnt lgkmcnt(4)
    s_waitcnt vmcnt(28)
    v_mfma_f32_16x16x32_bf16 a[0:3], v[136:139], v[72:75], a[0:3]
    buffer_load_dwordx4 v[56:59], v3, s[64:67], s100 offen offset:0 sc1
    v_mfma_f32_16x16x32_bf16 a[4:7], v[136:139], v[76:79], a[4:7]
    ds_read_b64_tr_b16 v[148:149], v229 offset:96
    v_mfma_f32_16x16x32_bf16 a[8:11], v[136:139], v[80:83], a[8:11]
    ds_read_b64_tr_b16 v[150:151], v229 offset:4704
    v_mfma_f32_16x16x32_bf16 a[12:15], v[136:139], v[84:87], a[12:15]
    s_add_u32 s100, s69, 180224
    s_waitcnt lgkmcnt(4)
    v_mfma_f32_16x16x32_bf16 a[16:19], v[140:143], v[72:75], a[16:19]
    buffer_load_dwordx4 v[60:63], v3, s[64:67], s100 offen offset:1024 sc1
    v_mfma_f32_16x16x32_bf16 a[20:23], v[140:143], v[76:79], a[20:23]
    ds_read_b64_tr_b16 v[136:137], v229 offset:128
    v_mfma_f32_16x16x32_bf16 a[24:27], v[140:143], v[80:83], a[24:27]
    ds_read_b64_tr_b16 v[138:139], v229 offset:4736
    v_mfma_f32_16x16x32_bf16 a[28:31], v[140:143], v[84:87], a[28:31]
    s_add_u32 s100, s69, 180224
    s_waitcnt lgkmcnt(4)
    v_mfma_f32_16x16x32_bf16 a[32:35], v[144:147], v[72:75], a[32:35]
    buffer_load_dwordx4 v[64:67], v3, s[64:67], s100 offen offset:2048 sc1
    v_mfma_f32_16x16x32_bf16 a[36:39], v[144:147], v[76:79], a[36:39]
    ds_read_b64_tr_b16 v[140:141], v229 offset:160
    v_mfma_f32_16x16x32_bf16 a[40:43], v[144:147], v[80:83], a[40:43]
    ds_read_b64_tr_b16 v[142:143], v229 offset:4768
    v_mfma_f32_16x16x32_bf16 a[44:47], v[144:147], v[84:87], a[44:47]
    s_add_u32 s100, s69, 180224
    s_waitcnt lgkmcnt(4)
    v_mfma_f32_16x16x32_bf16 a[48:51], v[148:151], v[72:75], a[48:51]
    buffer_load_dwordx4 v[68:71], v3, s[64:67], s100 offen offset:3072 sc1
    v_mfma_f32_16x16x32_bf16 a[52:55], v[148:151], v[76:79], a[52:55]
    ds_read_b64_tr_b16 v[144:145], v229 offset:192
    v_mfma_f32_16x16x32_bf16 a[56:59], v[148:151], v[80:83], a[56:59]
    ds_read_b64_tr_b16 v[146:147], v229 offset:4800
    v_mfma_f32_16x16x32_bf16 a[60:63], v[148:151], v[84:87], a[60:63]
    s_add_u32 s100, s69, 98304
    s_waitcnt lgkmcnt(4)
    v_mfma_f32_16x16x32_bf16 a[64:67], v[136:139], v[72:75], a[64:67]
    buffer_load_dwordx4 v[112:115], v3, s[64:67], s100 offen offset:2048 sc1
    v_mfma_f32_16x16x32_bf16 a[68:71], v[136:139], v[76:79], a[68:71]
    ds_read_b64_tr_b16 v[148:149], v229 offset:224
    v_mfma_f32_16x16x32_bf16 a[72:75], v[136:139], v[80:83], a[72:75]
    ds_read_b64_tr_b16 v[150:151], v229 offset:4832
    v_mfma_f32_16x16x32_bf16 a[76:79], v[136:139], v[84:87], a[76:79]
    s_add_u32 s100, s69, 98304
    s_waitcnt lgkmcnt(4)
    v_mfma_f32_16x16x32_bf16 a[80:83], v[140:143], v[72:75], a[80:83]
    buffer_load_dwordx4 v[116:119], v3, s[64:67], s100 offen offset:3072 sc1
    v_mfma_f32_16x16x32_bf16 a[84:87], v[140:143], v[76:79], a[84:87]
    ds_read_b64_tr_b16 v[136:137], v229 offset:256
    v_mfma_f32_16x16x32_bf16 a[88:91], v[140:143], v[80:83], a[88:91]
    ds_read_b64_tr_b16 v[138:139], v229 offset:4864
    v_mfma_f32_16x16x32_bf16 a[92:95], v[140:143], v[84:87], a[92:95]
    s_add_u32 s100, s69, 114688
    s_waitcnt lgkmcnt(4)
    v_mfma_f32_16x16x32_bf16 a[96:99], v[144:147], v[72:75], a[96:99]
    buffer_load_dwordx4 v[120:123], v3, s[64:67], s100 offen offset:0 sc1
    v_mfma_f32_16x16x32_bf16 a[100:103], v[144:147], v[76:79], a[100:103]
    ds_read_b64_tr_b16 v[140:141], v229 offset:9216
    v_mfma_f32_16x16x32_bf16 a[104:107], v[144:147], v[80:83], a[104:107]
    ds_read_b64_tr_b16 v[142:143], v229 offset:13824
    v_mfma_f32_16x16x32_bf16 a[108:111], v[144:147], v[84:87], a[108:111]
    s_add_u32 s100, s69, 114688
    s_waitcnt lgkmcnt(4)
    v_mfma_f32_16x16x32_bf16 a[112:115], v[148:151], v[72:75], a[112:115]
    buffer_load_dwordx4 v[124:127], v3, s[64:67], s100 offen offset:1024 sc1
    v_mfma_f32_16x16x32_bf16 a[116:119], v[148:151], v[76:79], a[116:119]
    ds_read_b64_tr_b16 v[144:145], v229 offset:9248
    v_mfma_f32_16x16x32_bf16 a[120:123], v[148:151], v[80:83], a[120:123]
    ds_read_b64_tr_b16 v[146:147], v229 offset:13856
    v_mfma_f32_16x16x32_bf16 a[124:127], v[148:151], v[84:87], a[124:127]
    s_add_u32 s100, s69, 114688
    s_waitcnt lgkmcnt(4)
    v_mfma_f32_16x16x32_bf16 a[128:131], v[136:139], v[72:75], a[128:131]
    buffer_load_dwordx4 v[128:131], v3, s[64:67], s100 offen offset:2048 sc1
    v_mfma_f32_16x16x32_bf16 a[132:135], v[136:139], v[76:79], a[132:135]
    ds_read_b64_tr_b16 v[148:149], v229 offset:9280
    v_mfma_f32_16x16x32_bf16 a[136:139], v[136:139], v[80:83], a[136:139]
    ds_read_b64_tr_b16 v[150:151], v229 offset:13888
    v_mfma_f32_16x16x32_bf16 a[140:143], v[136:139], v[84:87], a[140:143]
    s_add_u32 s100, s69, 196608
    s_waitcnt lgkmcnt(4)
    s_waitcnt vmcnt(29)
    v_mfma_f32_16x16x32_bf16 a[0:3], v[140:143], v[88:91], a[0:3]
    buffer_load_dwordx4 v[72:75], v3, s[64:67], s100 offen offset:0 sc1
    v_mfma_f32_16x16x32_bf16 a[4:7], v[140:143], v[92:95], a[4:7]
    ds_read_b64_tr_b16 v[136:137], v229 offset:9312
    v_mfma_f32_16x16x32_bf16 a[8:11], v[140:143], v[96:99], a[8:11]
    ds_read_b64_tr_b16 v[138:139], v229 offset:13920
    v_mfma_f32_16x16x32_bf16 a[12:15], v[140:143], v[100:103], a[12:15]
    s_add_u32 s100, s69, 196608
    s_waitcnt lgkmcnt(4)
    v_mfma_f32_16x16x32_bf16 a[16:19], v[144:147], v[88:91], a[16:19]
    buffer_load_dwordx4 v[76:79], v3, s[64:67], s100 offen offset:1024 sc1
    v_mfma_f32_16x16x32_bf16 a[20:23], v[144:147], v[92:95], a[20:23]
    ds_read_b64_tr_b16 v[140:141], v229 offset:9344
    v_mfma_f32_16x16x32_bf16 a[24:27], v[144:147], v[96:99], a[24:27]
    ds_read_b64_tr_b16 v[142:143], v229 offset:13952
    v_mfma_f32_16x16x32_bf16 a[28:31], v[144:147], v[100:103], a[28:31]
    s_add_u32 s100, s69, 196608
    s_waitcnt lgkmcnt(4)
    v_mfma_f32_16x16x32_bf16 a[32:35], v[148:151], v[88:91], a[32:35]
    buffer_load_dwordx4 v[80:83], v3, s[64:67], s100 offen offset:2048 sc1
    v_mfma_f32_16x16x32_bf16 a[36:39], v[148:151], v[92:95], a[36:39]
    ds_read_b64_tr_b16 v[144:145], v229 offset:9376
    v_mfma_f32_16x16x32_bf16 a[40:43], v[148:151], v[96:99], a[40:43]
    ds_read_b64_tr_b16 v[146:147], v229 offset:13984
    v_mfma_f32_16x16x32_bf16 a[44:47], v[148:151], v[100:103], a[44:47]
    s_add_u32 s100, s69, 196608
    s_waitcnt lgkmcnt(4)
    v_mfma_f32_16x16x32_bf16 a[48:51], v[136:139], v[88:91], a[48:51]
    buffer_load_dwordx4 v[84:87], v3, s[64:67], s100 offen offset:3072 sc1
    v_mfma_f32_16x16x32_bf16 a[52:55], v[136:139], v[92:95], a[52:55]
    ds_read_b64_tr_b16 v[148:149], v229 offset:9408
    v_mfma_f32_16x16x32_bf16 a[56:59], v[136:139], v[96:99], a[56:59]
    ds_read_b64_tr_b16 v[150:151], v229 offset:14016
    v_mfma_f32_16x16x32_bf16 a[60:63], v[136:139], v[100:103], a[60:63]
    s_add_u32 s100, s69, 114688
    s_waitcnt lgkmcnt(4)
    v_mfma_f32_16x16x32_bf16 a[64:67], v[140:143], v[88:91], a[64:67]
    buffer_load_dwordx4 v[132:135], v3, s[64:67], s100 offen offset:3072 sc1
    v_mfma_f32_16x16x32_bf16 a[68:71], v[140:143], v[92:95], a[68:71]
    ds_read_b64_tr_b16 v[136:137], v229 offset:9440
    v_mfma_f32_16x16x32_bf16 a[72:75], v[140:143], v[96:99], a[72:75]
    ds_read_b64_tr_b16 v[138:139], v229 offset:14048
    v_mfma_f32_16x16x32_bf16 a[76:79], v[140:143], v[100:103], a[76:79]
    s_add_u32 s25, s24, 32768
    s_waitcnt lgkmcnt(4)
    v_mfma_f32_16x16x32_bf16 a[80:83], v[144:147], v[88:91], a[80:83]
    buffer_store_dwordx4 v[184:187], v3, s[16:19], s25 offen offset:0 sc1
    v_mfma_f32_16x16x32_bf16 a[84:87], v[144:147], v[92:95], a[84:87]
    ds_read_b64_tr_b16 v[140:141], v229 offset:9472
    v_mfma_f32_16x16x32_bf16 a[88:91], v[144:147], v[96:99], a[88:91]
    ds_read_b64_tr_b16 v[142:143], v229 offset:14080
    v_mfma_f32_16x16x32_bf16 a[92:95], v[144:147], v[100:103], a[92:95]
    s_add_u32 s25, s24, 32768
    s_waitcnt lgkmcnt(4)
    v_mfma_f32_16x16x32_bf16 a[96:99], v[148:151], v[88:91], a[96:99]
    buffer_store_dwordx4 v[192:195], v3, s[16:19], s25 offen offset:2048 sc1
    v_mfma_f32_16x16x32_bf16 a[100:103], v[148:151], v[92:95], a[100:103]
    ds_read_b64_tr_b16 v[144:145], v229 offset:18432
    v_mfma_f32_16x16x32_bf16 a[104:107], v[148:151], v[96:99], a[104:107]
    ds_read_b64_tr_b16 v[146:147], v229 offset:23040
    v_mfma_f32_16x16x32_bf16 a[108:111], v[148:151], v[100:103], a[108:111]
    s_add_u32 s25, s24, 32768
    s_waitcnt lgkmcnt(4)
    v_mfma_f32_16x16x32_bf16 a[112:115], v[136:139], v[88:91], a[112:115]
    buffer_store_dwordx4 v[188:191], v3, s[16:19], s25 offen offset:1024 sc1
    v_mfma_f32_16x16x32_bf16 a[116:119], v[136:139], v[92:95], a[116:119]
    ds_read_b64_tr_b16 v[148:149], v229 offset:18464
    v_mfma_f32_16x16x32_bf16 a[120:123], v[136:139], v[96:99], a[120:123]
    ds_read_b64_tr_b16 v[150:151], v229 offset:23072
    v_mfma_f32_16x16x32_bf16 a[124:127], v[136:139], v[100:103], a[124:127]
    s_add_u32 s25, s24, 32768
    s_waitcnt lgkmcnt(4)
    v_mfma_f32_16x16x32_bf16 a[128:131], v[140:143], v[88:91], a[128:131]
    buffer_store_dwordx4 v[196:199], v3, s[16:19], s25 offen offset:3072 sc1
    v_mfma_f32_16x16x32_bf16 a[132:135], v[140:143], v[92:95], a[132:135]
    ds_read_b64_tr_b16 v[136:137], v229 offset:18496
    v_mfma_f32_16x16x32_bf16 a[136:139], v[140:143], v[96:99], a[136:139]
    ds_read_b64_tr_b16 v[138:139], v229 offset:23104
    v_mfma_f32_16x16x32_bf16 a[140:143], v[140:143], v[100:103], a[140:143]
    s_add_u32 s100, s69, 212992
    s_waitcnt lgkmcnt(4)
    s_waitcnt vmcnt(12)
    v_mfma_f32_16x16x32_bf16 a[0:3], v[144:147], v[104:107], a[0:3]
    buffer_load_dwordx2 v[88:89], v232, s[64:67], s100 offen offset:0 sc1
    v_mfma_f32_16x16x32_bf16 a[4:7], v[144:147], v[108:111], a[4:7]
    ds_read_b64_tr_b16 v[140:141], v229 offset:18528
    v_mfma_f32_16x16x32_bf16 a[8:11], v[144:147], v[112:115], a[8:11]
    ds_read_b64_tr_b16 v[142:143], v229 offset:23136
    v_mfma_f32_16x16x32_bf16 a[12:15], v[144:147], v[116:119], a[12:15]
    s_add_u32 s100, s69, 212992
    s_waitcnt lgkmcnt(4)
    v_mfma_f32_16x16x32_bf16 a[16:19], v[148:151], v[104:107], a[16:19]
    buffer_load_dwordx2 v[90:91], v232, s[64:67], s100 offen offset:512 sc1
    v_mfma_f32_16x16x32_bf16 a[20:23], v[148:151], v[108:111], a[20:23]
    ds_read_b64_tr_b16 v[144:145], v229 offset:18560
    v_mfma_f32_16x16x32_bf16 a[24:27], v[148:151], v[112:115], a[24:27]
    ds_read_b64_tr_b16 v[146:147], v229 offset:23168
    v_mfma_f32_16x16x32_bf16 a[28:31], v[148:151], v[116:119], a[28:31]
    s_add_u32 s100, s69, 212992
    s_waitcnt lgkmcnt(4)
    v_mfma_f32_16x16x32_bf16 a[32:35], v[136:139], v[104:107], a[32:35]
    buffer_load_dwordx2 v[92:93], v232, s[64:67], s100 offen offset:1024 sc1
    v_mfma_f32_16x16x32_bf16 a[36:39], v[136:139], v[108:111], a[36:39]
    ds_read_b64_tr_b16 v[148:149], v229 offset:18592
    v_mfma_f32_16x16x32_bf16 a[40:43], v[136:139], v[112:115], a[40:43]
    ds_read_b64_tr_b16 v[150:151], v229 offset:23200
    v_mfma_f32_16x16x32_bf16 a[44:47], v[136:139], v[116:119], a[44:47]
    s_add_u32 s100, s69, 212992
    s_waitcnt lgkmcnt(4)
    v_mfma_f32_16x16x32_bf16 a[48:51], v[140:143], v[104:107], a[48:51]
    buffer_load_dwordx2 v[94:95], v232, s[64:67], s100 offen offset:1536 sc1
    v_mfma_f32_16x16x32_bf16 a[52:55], v[140:143], v[108:111], a[52:55]
    ds_read_b64_tr_b16 v[136:137], v229 offset:18624
    v_mfma_f32_16x16x32_bf16 a[56:59], v[140:143], v[112:115], a[56:59]
    ds_read_b64_tr_b16 v[138:139], v229 offset:23232
    v_mfma_f32_16x16x32_bf16 a[60:63], v[140:143], v[116:119], a[60:63]
    s_add_u32 s100, s69, 212992
    s_waitcnt lgkmcnt(4)
    v_mfma_f32_16x16x32_bf16 a[64:67], v[144:147], v[104:107], a[64:67]
    buffer_load_dwordx2 v[96:97], v232, s[64:67], s100 offen offset:2048 sc1
    v_mfma_f32_16x16x32_bf16 a[68:71], v[144:147], v[108:111], a[68:71]
    ds_read_b64_tr_b16 v[140:141], v229 offset:18656
    v_mfma_f32_16x16x32_bf16 a[72:75], v[144:147], v[112:115], a[72:75]
    ds_read_b64_tr_b16 v[142:143], v229 offset:23264
    v_mfma_f32_16x16x32_bf16 a[76:79], v[144:147], v[116:119], a[76:79]
    s_add_u32 s100, s69, 212992
    s_waitcnt lgkmcnt(4)
    v_mfma_f32_16x16x32_bf16 a[80:83], v[148:151], v[104:107], a[80:83]
    buffer_load_dwordx2 v[98:99], v232, s[64:67], s100 offen offset:2560 sc1
    v_mfma_f32_16x16x32_bf16 a[84:87], v[148:151], v[108:111], a[84:87]
    ds_read_b64_tr_b16 v[144:145], v229 offset:18688
    v_mfma_f32_16x16x32_bf16 a[88:91], v[148:151], v[112:115], a[88:91]
    ds_read_b64_tr_b16 v[146:147], v229 offset:23296
    v_mfma_f32_16x16x32_bf16 a[92:95], v[148:151], v[116:119], a[92:95]
    s_add_u32 s100, s69, 212992
    s_waitcnt lgkmcnt(4)
    v_mfma_f32_16x16x32_bf16 a[96:99], v[136:139], v[104:107], a[96:99]
    buffer_load_dwordx2 v[100:101], v232, s[64:67], s100 offen offset:3072 sc1
    v_mfma_f32_16x16x32_bf16 a[100:103], v[136:139], v[108:111], a[100:103]
    ds_read_b64_tr_b16 v[148:149], v229 offset:27648
    v_mfma_f32_16x16x32_bf16 a[104:107], v[136:139], v[112:115], a[104:107]
    ds_read_b64_tr_b16 v[150:151], v229 offset:32256
    v_mfma_f32_16x16x32_bf16 a[108:111], v[136:139], v[116:119], a[108:111]
    s_add_u32 s100, s69, 212992
    s_waitcnt lgkmcnt(4)
    v_mfma_f32_16x16x32_bf16 a[112:115], v[140:143], v[104:107], a[112:115]
    buffer_load_dwordx2 v[102:103], v232, s[64:67], s100 offen offset:3584 sc1
    v_mfma_f32_16x16x32_bf16 a[116:119], v[140:143], v[108:111], a[116:119]
    ds_read_b64_tr_b16 v[136:137], v229 offset:27680
    v_mfma_f32_16x16x32_bf16 a[120:123], v[140:143], v[112:115], a[120:123]
    ds_read_b64_tr_b16 v[138:139], v229 offset:32288
    v_mfma_f32_16x16x32_bf16 a[124:127], v[140:143], v[116:119], a[124:127]
    s_add_u32 s25, s24, 49152
    s_waitcnt lgkmcnt(4)
    v_mfma_f32_16x16x32_bf16 a[128:131], v[144:147], v[104:107], a[128:131]
    buffer_store_dwordx4 v[200:203], v3, s[16:19], s25 offen offset:0 sc1
    v_mfma_f32_16x16x32_bf16 a[132:135], v[144:147], v[108:111], a[132:135]
    ds_read_b64_tr_b16 v[140:141], v229 offset:27712
    v_mfma_f32_16x16x32_bf16 a[136:139], v[144:147], v[112:115], a[136:139]
    ds_read_b64_tr_b16 v[142:143], v229 offset:32320
    v_mfma_f32_16x16x32_bf16 a[140:143], v[144:147], v[116:119], a[140:143]
    s_add_u32 s100, s69, 229376
    s_waitcnt lgkmcnt(4)
    s_waitcnt vmcnt(13)
    v_mfma_f32_16x16x32_bf16 a[0:3], v[148:151], v[120:123], a[0:3]
    buffer_load_dwordx4 v[104:107], v3, s[64:67], s100 offen offset:0 sc1
    v_mfma_f32_16x16x32_bf16 a[4:7], v[148:151], v[124:127], a[4:7]
    ds_read_b64_tr_b16 v[144:145], v229 offset:27744
    v_mfma_f32_16x16x32_bf16 a[8:11], v[148:151], v[128:131], a[8:11]
    ds_read_b64_tr_b16 v[146:147], v229 offset:32352
    v_mfma_f32_16x16x32_bf16 a[12:15], v[148:151], v[132:135], a[12:15]
    s_add_u32 s100, s69, 229376
    s_waitcnt lgkmcnt(4)
    v_mfma_f32_16x16x32_bf16 a[16:19], v[136:139], v[120:123], a[16:19]
    buffer_load_dwordx4 v[108:111], v3, s[64:67], s100 offen offset:1024 sc1
    v_mfma_f32_16x16x32_bf16 a[20:23], v[136:139], v[124:127], a[20:23]
    ds_read_b64_tr_b16 v[148:149], v229 offset:27776
    v_mfma_f32_16x16x32_bf16 a[24:27], v[136:139], v[128:131], a[24:27]
    ds_read_b64_tr_b16 v[150:151], v229 offset:32384
    v_mfma_f32_16x16x32_bf16 a[28:31], v[136:139], v[132:135], a[28:31]
    s_add_u32 s100, s69, 229376
    s_waitcnt lgkmcnt(4)
    v_mfma_f32_16x16x32_bf16 a[32:35], v[140:143], v[120:123], a[32:35]
    buffer_load_dwordx4 v[112:115], v3, s[64:67], s100 offen offset:2048 sc1
    v_mfma_f32_16x16x32_bf16 a[36:39], v[140:143], v[124:127], a[36:39]
    ds_read_b64_tr_b16 v[136:137], v229 offset:27808
    v_mfma_f32_16x16x32_bf16 a[40:43], v[140:143], v[128:131], a[40:43]
    ds_read_b64_tr_b16 v[138:139], v229 offset:32416
    v_mfma_f32_16x16x32_bf16 a[44:47], v[140:143], v[132:135], a[44:47]
    s_add_u32 s100, s69, 229376
    s_waitcnt lgkmcnt(4)
    v_mfma_f32_16x16x32_bf16 a[48:51], v[144:147], v[120:123], a[48:51]
    buffer_load_dwordx4 v[116:119], v3, s[64:67], s100 offen offset:3072 sc1
    v_mfma_f32_16x16x32_bf16 a[52:55], v[144:147], v[124:127], a[52:55]
    ds_read_b64_tr_b16 v[140:141], v229 offset:27840
    v_mfma_f32_16x16x32_bf16 a[56:59], v[144:147], v[128:131], a[56:59]
    ds_read_b64_tr_b16 v[142:143], v229 offset:32448
    v_mfma_f32_16x16x32_bf16 a[60:63], v[144:147], v[132:135], a[60:63]
    s_add_u32 s25, s24, 49152
    s_waitcnt lgkmcnt(4)
    v_mfma_f32_16x16x32_bf16 a[64:67], v[148:151], v[120:123], a[64:67]
    buffer_store_dwordx4 v[208:211], v3, s[16:19], s25 offen offset:2048 sc1
    v_mfma_f32_16x16x32_bf16 a[68:71], v[148:151], v[124:127], a[68:71]
    ds_read_b64_tr_b16 v[144:145], v229 offset:27872
    v_mfma_f32_16x16x32_bf16 a[72:75], v[148:151], v[128:131], a[72:75]
    ds_read_b64_tr_b16 v[146:147], v229 offset:32480
    v_mfma_f32_16x16x32_bf16 a[76:79], v[148:151], v[132:135], a[76:79]
    s_add_u32 s25, s24, 49152
    s_waitcnt lgkmcnt(4)
    v_mfma_f32_16x16x32_bf16 a[80:83], v[136:139], v[120:123], a[80:83]
    buffer_store_dwordx4 v[204:207], v3, s[16:19], s25 offen offset:1024 sc1
    v_mfma_f32_16x16x32_bf16 a[84:87], v[136:139], v[124:127], a[84:87]
    ds_read_b64_tr_b16 v[148:149], v229 offset:27904
    v_mfma_f32_16x16x32_bf16 a[88:91], v[136:139], v[128:131], a[88:91]
    ds_read_b64_tr_b16 v[150:151], v229 offset:32512
    v_mfma_f32_16x16x32_bf16 a[92:95], v[136:139], v[132:135], a[92:95]
    s_add_u32 s25, s24, 49152
    s_waitcnt lgkmcnt(4)
    v_mfma_f32_16x16x32_bf16 a[96:99], v[140:143], v[120:123], a[96:99]
    s_waitcnt lgkmcnt(0)
    s_barrier
    v_add_u32 v229, 73728, v228
    buffer_store_dwordx4 v[212:215], v3, s[16:19], s25 offen offset:3072 sc1
    v_mfma_f32_16x16x32_bf16 a[100:103], v[140:143], v[124:127], a[100:103]
    ds_read_b64_tr_b16 v[136:137], v229 offset:0
    v_mfma_f32_16x16x32_bf16 a[104:107], v[140:143], v[128:131], a[104:107]
    ds_read_b64_tr_b16 v[138:139], v229 offset:4608
    v_mfma_f32_16x16x32_bf16 a[108:111], v[140:143], v[132:135], a[108:111]
    s_add_u32 s99, s68, 442368
    s_add_u32 m0, s70, 110592
    v_mfma_f32_16x16x32_bf16 a[112:115], v[144:147], v[120:123], a[112:115]
    buffer_load_dwordx4 v219, s[60:63], s99 offen offset:0 lds
    v_mfma_f32_16x16x32_bf16 a[116:119], v[144:147], v[124:127], a[116:119]
    ds_read_b64_tr_b16 v[140:141], v229 offset:32
    v_mfma_f32_16x16x32_bf16 a[120:123], v[144:147], v[128:131], a[120:123]
    ds_read_b64_tr_b16 v[142:143], v229 offset:4640
    v_mfma_f32_16x16x32_bf16 a[124:127], v[144:147], v[132:135], a[124:127]
    v_mfma_f32_16x16x32_bf16 a[128:131], v[148:151], v[120:123], a[128:131]
    buffer_load_dwordx4 v220, s[60:63], s99 offen offset:1024 lds
    v_mfma_f32_16x16x32_bf16 a[132:135], v[148:151], v[124:127], a[132:135]
    ds_read_b64_tr_b16 v[144:145], v229 offset:64
    v_mfma_f32_16x16x32_bf16 a[136:139], v[148:151], v[128:131], a[136:139]
    ds_read_b64_tr_b16 v[146:147], v229 offset:4672
    v_mfma_f32_16x16x32_bf16 a[140:143], v[148:151], v[132:135], a[140:143]
    s_add_u32 s100, s69, 245760
    s_waitcnt lgkmcnt(4)
    s_waitcnt vmcnt(2)
    buffer_store_dword v254, off, s[16:19], s23 sc1
    v_mfma_f32_16x16x32_bf16 a[0:3], v[136:139], v[8:11], a[0:3]
    buffer_load_dwordx4 v[120:123], v3, s[64:67], s100 offen offset:0 sc1
    v_mfma_f32_16x16x32_bf16 a[4:7], v[136:139], v[12:15], a[4:7]
    ds_read_b64_tr_b16 v[148:149], v229 offset:96
    v_mfma_f32_16x16x32_bf16 a[8:11], v[136:139], v[16:19], a[8:11]
    ds_read_b64_tr_b16 v[150:151], v229 offset:4704
    v_mfma_f32_16x16x32_bf16 a[12:15], v[136:139], v[20:23], a[12:15]
    s_add_u32 s100, s69, 245760
    s_waitcnt lgkmcnt(4)
    v_mfma_f32_16x16x32_bf16 a[16:19], v[140:143], v[8:11], a[16:19]
    buffer_load_dwordx4 v[124:127], v3, s[64:67], s100 offen offset:1024 sc1
    v_mfma_f32_16x16x32_bf16 a[20:23], v[140:143], v[12:15], a[20:23]
    ds_read_b64_tr_b16 v[136:137], v229 offset:128
    v_mfma_f32_16x16x32_bf16 a[24:27], v[140:143], v[16:19], a[24:27]
    ds_read_b64_tr_b16 v[138:139], v229 offset:4736
    v_mfma_f32_16x16x32_bf16 a[28:31], v[140:143], v[20:23], a[28:31]
    s_add_u32 s100, s69, 245760
    s_waitcnt lgkmcnt(4)
    v_mfma_f32_16x16x32_bf16 a[32:35], v[144:147], v[8:11], a[32:35]
    buffer_load_dwordx4 v[128:131], v3, s[64:67], s100 offen offset:2048 sc1
    v_mfma_f32_16x16x32_bf16 a[36:39], v[144:147], v[12:15], a[36:39]
    ds_read_b64_tr_b16 v[140:141], v229 offset:160
    v_mfma_f32_16x16x32_bf16 a[40:43], v[144:147], v[16:19], a[40:43]
    ds_read_b64_tr_b16 v[142:143], v229 offset:4768
    v_mfma_f32_16x16x32_bf16 a[44:47], v[144:147], v[20:23], a[44:47]
    s_add_u32 s100, s69, 245760
    s_waitcnt lgkmcnt(4)
    v_mfma_f32_16x16x32_bf16 a[48:51], v[148:151], v[8:11], a[48:51]
    buffer_load_dwordx4 v[132:135], v3, s[64:67], s100 offen offset:3072 sc1
    v_mfma_f32_16x16x32_bf16 a[52:55], v[148:151], v[12:15], a[52:55]
    ds_read_b64_tr_b16 v[144:145], v229 offset:192
    v_mfma_f32_16x16x32_bf16 a[56:59], v[148:151], v[16:19], a[56:59]
    ds_read_b64_tr_b16 v[146:147], v229 offset:4800
    v_mfma_f32_16x16x32_bf16 a[60:63], v[148:151], v[20:23], a[60:63]
    s_waitcnt lgkmcnt(4)
    v_mfma_f32_16x16x32_bf16 a[64:67], v[136:139], v[8:11], a[64:67]
    buffer_load_dwordx4 v221, s[60:63], s99 offen offset:2048 lds
    v_mfma_f32_16x16x32_bf16 a[68:71], v[136:139], v[12:15], a[68:71]
    ds_read_b64_tr_b16 v[148:149], v229 offset:224
    v_mfma_f32_16x16x32_bf16 a[72:75], v[136:139], v[16:19], a[72:75]
    ds_read_b64_tr_b16 v[150:151], v229 offset:4832
    v_mfma_f32_16x16x32_bf16 a[76:79], v[136:139], v[20:23], a[76:79]
    s_waitcnt lgkmcnt(4)
    v_mfma_f32_16x16x32_bf16 a[80:83], v[140:143], v[8:11], a[80:83]
    buffer_load_dwordx4 v222, s[60:63], s99 offen offset:3072 lds
    v_mfma_f32_16x16x32_bf16 a[84:87], v[140:143], v[12:15], a[84:87]
    ds_read_b64_tr_b16 v[136:137], v229 offset:256
    v_mfma_f32_16x16x32_bf16 a[88:91], v[140:143], v[16:19], a[88:91]
    ds_read_b64_tr_b16 v[138:139], v229 offset:4864
    v_mfma_f32_16x16x32_bf16 a[92:95], v[140:143], v[20:23], a[92:95]
    s_add_u32 m0, s70, 114688
    s_waitcnt lgkmcnt(4)
    v_mfma_f32_16x16x32_bf16 a[96:99], v[144:147], v[8:11], a[96:99]
    buffer_load_dwordx4 v223, s[60:63], s99 offen offset:0 lds
    v_mfma_f32_16x16x32_bf16 a[100:103], v[144:147], v[12:15], a[100:103]
    ds_read_b64_tr_b16 v[140:141], v229 offset:9216
    v_mfma_f32_16x16x32_bf16 a[104:107], v[144:147], v[16:19], a[104:107]
    ds_read_b64_tr_b16 v[142:143], v229 offset:13824
    v_mfma_f32_16x16x32_bf16 a[108:111], v[144:147], v[20:23], a[108:111]
    s_waitcnt lgkmcnt(4)
    v_mfma_f32_16x16x32_bf16 a[112:115], v[148:151], v[8:11], a[112:115]
    buffer_load_dwordx4 v224, s[60:63], s99 offen offset:1024 lds
    v_mfma_f32_16x16x32_bf16 a[116:119], v[148:151], v[12:15], a[116:119]
    ds_read_b64_tr_b16 v[144:145], v229 offset:9248
    v_mfma_f32_16x16x32_bf16 a[120:123], v[148:151], v[16:19], a[120:123]
    ds_read_b64_tr_b16 v[146:147], v229 offset:13856
    v_mfma_f32_16x16x32_bf16 a[124:127], v[148:151], v[20:23], a[124:127]
    s_waitcnt lgkmcnt(4)
    v_mfma_f32_16x16x32_bf16 a[128:131], v[136:139], v[8:11], a[128:131]
    buffer_load_dwordx4 v225, s[60:63], s99 offen offset:2048 lds
    v_mfma_f32_16x16x32_bf16 a[132:135], v[136:139], v[12:15], a[132:135]
    ds_read_b64_tr_b16 v[148:149], v229 offset:9280
    v_mfma_f32_16x16x32_bf16 a[136:139], v[136:139], v[16:19], a[136:139]
    ds_read_b64_tr_b16 v[150:151], v229 offset:13888
    v_mfma_f32_16x16x32_bf16 a[140:143], v[136:139], v[20:23], a[140:143]
    s_add_u32 s100, s69, 262144
    s_waitcnt lgkmcnt(4)
    v_mfma_f32_16x16x32_bf16 a[0:3], v[140:143], v[24:27], a[0:3]
    buffer_load_dwordx4 v[8:11], v3, s[64:67], s100 offen offset:0 sc1
    v_mfma_f32_16x16x32_bf16 a[4:7], v[140:143], v[28:31], a[4:7]
    ds_read_b64_tr_b16 v[136:137], v229 offset:9312
    v_mfma_f32_16x16x32_bf16 a[8:11], v[140:143], v[32:35], a[8:11]
    ds_read_b64_tr_b16 v[138:139], v229 offset:13920
    v_mfma_f32_16x16x32_bf16 a[12:15], v[140:143], v[36:39], a[12:15]
    s_add_u32 s100, s69, 262144
    s_waitcnt lgkmcnt(4)
    v_mfma_f32_16x16x32_bf16 a[16:19], v[144:147], v[24:27], a[16:19]
    buffer_load_dwordx4 v[12:15], v3, s[64:67], s100 offen offset:1024 sc1
    v_mfma_f32_16x16x32_bf16 a[20:23], v[144:147], v[28:31], a[20:23]
    ds_read_b64_tr_b16 v[140:141], v229 offset:9344
    v_mfma_f32_16x16x32_bf16 a[24:27], v[144:147], v[32:35], a[24:27]
    ds_read_b64_tr_b16 v[142:143], v229 offset:13952
    v_mfma_f32_16x16x32_bf16 a[28:31], v[144:147], v[36:39], a[28:31]
    s_add_u32 s100, s69, 262144
    s_waitcnt lgkmcnt(4)
    v_mfma_f32_16x16x32_bf16 a[32:35], v[148:151], v[24:27], a[32:35]
    buffer_load_dwordx4 v[16:19], v3, s[64:67], s100 offen offset:2048 sc1
    v_mfma_f32_16x16x32_bf16 a[36:39], v[148:151], v[28:31], a[36:39]
    ds_read_b64_tr_b16 v[144:145], v229 offset:9376
    v_mfma_f32_16x16x32_bf16 a[40:43], v[148:151], v[32:35], a[40:43]
    ds_read_b64_tr_b16 v[146:147], v229 offset:13984
    v_mfma_f32_16x16x32_bf16 a[44:47], v[148:151], v[36:39], a[44:47]
    s_add_u32 s100, s69, 262144
    s_waitcnt lgkmcnt(4)
    v_mfma_f32_16x16x32_bf16 a[48:51], v[136:139], v[24:27], a[48:51]
    buffer_load_dwordx4 v[20:23], v3, s[64:67], s100 offen offset:3072 sc1
    v_mfma_f32_16x16x32_bf16 a[52:55], v[136:139], v[28:31], a[52:55]
    ds_read_b64_tr_b16 v[148:149], v229 offset:9408
    v_mfma_f32_16x16x32_bf16 a[56:59], v[136:139], v[32:35], a[56:59]
    ds_read_b64_tr_b16 v[150:151], v229 offset:14016
    v_mfma_f32_16x16x32_bf16 a[60:63], v[136:139], v[36:39], a[60:63]
    s_waitcnt lgkmcnt(4)
    v_mfma_f32_16x16x32_bf16 a[64:67], v[140:143], v[24:27], a[64:67]
    buffer_load_dwordx4 v226, s[60:63], s99 offen offset:3072 lds
    v_mfma_f32_16x16x32_bf16 a[68:71], v[140:143], v[28:31], a[68:71]
    ds_read_b64_tr_b16 v[136:137], v229 offset:9440
    v_mfma_f32_16x16x32_bf16 a[72:75], v[140:143], v[32:35], a[72:75]
    ds_read_b64_tr_b16 v[138:139], v229 offset:14048
    v_mfma_f32_16x16x32_bf16 a[76:79], v[140:143], v[36:39], a[76:79]
    s_add_u32 m0, s70, 118784
    s_waitcnt lgkmcnt(4)
    v_mfma_f32_16x16x32_bf16 a[80:83], v[144:147], v[24:27], a[80:83]
    buffer_load_dwordx4 v227, s[60:63], s99 offen offset:0 lds
    v_mfma_f32_16x16x32_bf16 a[84:87], v[144:147], v[28:31], a[84:87]
    ds_read_b64_tr_b16 v[140:141], v229 offset:9472
    v_mfma_f32_16x16x32_bf16 a[88:91], v[144:147], v[32:35], a[88:91]
    ds_read_b64_tr_b16 v[142:143], v229 offset:14080
    v_mfma_f32_16x16x32_bf16 a[92:95], v[144:147], v[36:39], a[92:95]
    s_add_u32 s99, s68, 589824
    s_add_u32 m0, s70, 0
    s_waitcnt lgkmcnt(4)
    v_mfma_f32_16x16x32_bf16 a[96:99], v[148:151], v[24:27], a[96:99]
    buffer_load_dwordx4 v219, s[60:63], s99 offen offset:0 lds
    v_mfma_f32_16x16x32_bf16 a[100:103], v[148:151], v[28:31], a[100:103]
    ds_read_b64_tr_b16 v[144:145], v229 offset:18432
    v_mfma_f32_16x16x32_bf16 a[104:107], v[148:151], v[32:35], a[104:107]
    ds_read_b64_tr_b16 v[146:147], v229 offset:23040
    v_mfma_f32_16x16x32_bf16 a[108:111], v[148:151], v[36:39], a[108:111]
    s_waitcnt lgkmcnt(4)
    v_mfma_f32_16x16x32_bf16 a[112:115], v[136:139], v[24:27], a[112:115]
    buffer_load_dwordx4 v220, s[60:63], s99 offen offset:1024 lds
    v_mfma_f32_16x16x32_bf16 a[116:119], v[136:139], v[28:31], a[116:119]
    ds_read_b64_tr_b16 v[148:149], v229 offset:18464
    v_mfma_f32_16x16x32_bf16 a[120:123], v[136:139], v[32:35], a[120:123]
    ds_read_b64_tr_b16 v[150:151], v229 offset:23072
    v_mfma_f32_16x16x32_bf16 a[124:127], v[136:139], v[36:39], a[124:127]
    s_waitcnt lgkmcnt(4)
    v_mfma_f32_16x16x32_bf16 a[128:131], v[140:143], v[24:27], a[128:131]
    buffer_load_dwordx4 v221, s[60:63], s99 offen offset:2048 lds
    v_mfma_f32_16x16x32_bf16 a[132:135], v[140:143], v[28:31], a[132:135]
    ds_read_b64_tr_b16 v[136:137], v229 offset:18496
    v_mfma_f32_16x16x32_bf16 a[136:139], v[140:143], v[32:35], a[136:139]
    ds_read_b64_tr_b16 v[138:139], v229 offset:23104
    v_mfma_f32_16x16x32_bf16 a[140:143], v[140:143], v[36:39], a[140:143]
    s_add_u32 s100, s69, 278528
    s_waitcnt lgkmcnt(4)
    v_mfma_f32_16x16x32_bf16 a[0:3], v[144:147], v[40:43], a[0:3]
    buffer_load_dwordx4 v[24:27], v3, s[64:67], s100 offen offset:0 sc1
    v_mfma_f32_16x16x32_bf16 a[4:7], v[144:147], v[44:47], a[4:7]
    ds_read_b64_tr_b16 v[140:141], v229 offset:18528
    v_mfma_f32_16x16x32_bf16 a[8:11], v[144:147], v[48:51], a[8:11]
    ds_read_b64_tr_b16 v[142:143], v229 offset:23136
    v_mfma_f32_16x16x32_bf16 a[12:15], v[144:147], v[52:55], a[12:15]
    s_add_u32 s100, s69, 278528
    s_waitcnt lgkmcnt(4)
    v_mfma_f32_16x16x32_bf16 a[16:19], v[148:151], v[40:43], a[16:19]
    buffer_load_dwordx4 v[28:31], v3, s[64:67], s100 offen offset:1024 sc1
    v_mfma_f32_16x16x32_bf16 a[20:23], v[148:151], v[44:47], a[20:23]
    ds_read_b64_tr_b16 v[144:145], v229 offset:18560
    v_mfma_f32_16x16x32_bf16 a[24:27], v[148:151], v[48:51], a[24:27]
    ds_read_b64_tr_b16 v[146:147], v229 offset:23168
    v_mfma_f32_16x16x32_bf16 a[28:31], v[148:151], v[52:55], a[28:31]
    s_add_u32 s100, s69, 278528
    s_waitcnt lgkmcnt(4)
    v_mfma_f32_16x16x32_bf16 a[32:35], v[136:139], v[40:43], a[32:35]
    buffer_load_dwordx4 v[32:35], v3, s[64:67], s100 offen offset:2048 sc1
    v_mfma_f32_16x16x32_bf16 a[36:39], v[136:139], v[44:47], a[36:39]
    ds_read_b64_tr_b16 v[148:149], v229 offset:18592
    v_mfma_f32_16x16x32_bf16 a[40:43], v[136:139], v[48:51], a[40:43]
    ds_read_b64_tr_b16 v[150:151], v229 offset:23200
    v_mfma_f32_16x16x32_bf16 a[44:47], v[136:139], v[52:55], a[44:47]
    s_add_u32 s100, s69, 278528
    s_waitcnt lgkmcnt(4)
    v_mfma_f32_16x16x32_bf16 a[48:51], v[140:143], v[40:43], a[48:51]
    buffer_load_dwordx4 v[36:39], v3, s[64:67], s100 offen offset:3072 sc1
    v_mfma_f32_16x16x32_bf16 a[52:55], v[140:143], v[44:47], a[52:55]
    ds_read_b64_tr_b16 v[136:137], v229 offset:18624
    v_mfma_f32_16x16x32_bf16 a[56:59], v[140:143], v[48:51], a[56:59]
    ds_read_b64_tr_b16 v[138:139], v229 offset:23232
    v_mfma_f32_16x16x32_bf16 a[60:63], v[140:143], v[52:55], a[60:63]
    s_waitcnt lgkmcnt(4)
    v_mfma_f32_16x16x32_bf16 a[64:67], v[144:147], v[40:43], a[64:67]
    buffer_load_dwordx4 v222, s[60:63], s99 offen offset:3072 lds
    v_mfma_f32_16x16x32_bf16 a[68:71], v[144:147], v[44:47], a[68:71]
    ds_read_b64_tr_b16 v[140:141], v229 offset:18656
    v_mfma_f32_16x16x32_bf16 a[72:75], v[144:147], v[48:51], a[72:75]
    ds_read_b64_tr_b16 v[142:143], v229 offset:23264
    v_mfma_f32_16x16x32_bf16 a[76:79], v[144:147], v[52:55], a[76:79]
    s_add_u32 m0, s70, 4096
    s_waitcnt lgkmcnt(4)
    v_mfma_f32_16x16x32_bf16 a[80:83], v[148:151], v[40:43], a[80:83]
    buffer_load_dwordx4 v223, s[60:63], s99 offen offset:0 lds
    v_mfma_f32_16x16x32_bf16 a[84:87], v[148:151], v[44:47], a[84:87]
    ds_read_b64_tr_b16 v[144:145], v229 offset:18688
    v_mfma_f32_16x16x32_bf16 a[88:91], v[148:151], v[48:51], a[88:91]
    ds_read_b64_tr_b16 v[146:147], v229 offset:23296
    v_mfma_f32_16x16x32_bf16 a[92:95], v[148:151], v[52:55], a[92:95]
    s_waitcnt lgkmcnt(4)
    v_mfma_f32_16x16x32_bf16 a[96:99], v[136:139], v[40:43], a[96:99]
    buffer_load_dwordx4 v224, s[60:63], s99 offen offset:1024 lds
    v_mfma_f32_16x16x32_bf16 a[100:103], v[136:139], v[44:47], a[100:103]
    ds_read_b64_tr_b16 v[148:149], v229 offset:27648
    v_mfma_f32_16x16x32_bf16 a[104:107], v[136:139], v[48:51], a[104:107]
    ds_read_b64_tr_b16 v[150:151], v229 offset:32256
    v_mfma_f32_16x16x32_bf16 a[108:111], v[136:139], v[52:55], a[108:111]
    s_waitcnt lgkmcnt(4)
    v_mfma_f32_16x16x32_bf16 a[112:115], v[140:143], v[40:43], a[112:115]
    buffer_load_dwordx4 v225, s[60:63], s99 offen offset:2048 lds
    v_mfma_f32_16x16x32_bf16 a[116:119], v[140:143], v[44:47], a[116:119]
    ds_read_b64_tr_b16 v[136:137], v229 offset:27680
    v_mfma_f32_16x16x32_bf16 a[120:123], v[140:143], v[48:51], a[120:123]
    ds_read_b64_tr_b16 v[138:139], v229 offset:32288
    v_mfma_f32_16x16x32_bf16 a[124:127], v[140:143], v[52:55], a[124:127]
    s_waitcnt lgkmcnt(4)
    v_mfma_f32_16x16x32_bf16 a[128:131], v[144:147], v[40:43], a[128:131]
    buffer_load_dwordx4 v226, s[60:63], s99 offen offset:3072 lds
    v_mfma_f32_16x16x32_bf16 a[132:135], v[144:147], v[44:47], a[132:135]
    ds_read_b64_tr_b16 v[140:141], v229 offset:27712
    v_mfma_f32_16x16x32_bf16 a[136:139], v[144:147], v[48:51], a[136:139]
    ds_read_b64_tr_b16 v[142:143], v229 offset:32320
    v_mfma_f32_16x16x32_bf16 a[140:143], v[144:147], v[52:55], a[140:143]
    s_add_u32 s100, s69, 294912
    s_waitcnt lgkmcnt(4)
    v_mfma_f32_16x16x32_bf16 a[0:3], v[148:151], v[56:59], a[0:3]
    buffer_load_dwordx4 v[40:43], v3, s[64:67], s100 offen offset:0 sc1
    v_mfma_f32_16x16x32_bf16 a[4:7], v[148:151], v[60:63], a[4:7]
    ds_read_b64_tr_b16 v[144:145], v229 offset:27744
    v_mfma_f32_16x16x32_bf16 a[8:11], v[148:151], v[64:67], a[8:11]
    ds_read_b64_tr_b16 v[146:147], v229 offset:32352
    v_mfma_f32_16x16x32_bf16 a[12:15], v[148:151], v[68:71], a[12:15]
    s_add_u32 s100, s69, 294912
    s_waitcnt lgkmcnt(4)
    v_mfma_f32_16x16x32_bf16 a[16:19], v[136:139], v[56:59], a[16:19]
    buffer_load_dwordx4 v[44:47], v3, s[64:67], s100 offen offset:1024 sc1
    v_mfma_f32_16x16x32_bf16 a[20:23], v[136:139], v[60:63], a[20:23]
    ds_read_b64_tr_b16 v[148:149], v229 offset:27776
    v_mfma_f32_16x16x32_bf16 a[24:27], v[136:139], v[64:67], a[24:27]
    ds_read_b64_tr_b16 v[150:151], v229 offset:32384
    v_mfma_f32_16x16x32_bf16 a[28:31], v[136:139], v[68:71], a[28:31]
    s_add_u32 s100, s69, 294912
    s_waitcnt lgkmcnt(4)
    v_mfma_f32_16x16x32_bf16 a[32:35], v[140:143], v[56:59], a[32:35]
    buffer_load_dwordx4 v[48:51], v3, s[64:67], s100 offen offset:2048 sc1
    v_mfma_f32_16x16x32_bf16 a[36:39], v[140:143], v[60:63], a[36:39]
    ds_read_b64_tr_b16 v[136:137], v229 offset:27808
    v_mfma_f32_16x16x32_bf16 a[40:43], v[140:143], v[64:67], a[40:43]
    ds_read_b64_tr_b16 v[138:139], v229 offset:32416
    v_mfma_f32_16x16x32_bf16 a[44:47], v[140:143], v[68:71], a[44:47]
    s_add_u32 s100, s69, 294912
    s_waitcnt lgkmcnt(4)
    v_mfma_f32_16x16x32_bf16 a[48:51], v[144:147], v[56:59], a[48:51]
    buffer_load_dwordx4 v[52:55], v3, s[64:67], s100 offen offset:3072 sc1
    v_mfma_f32_16x16x32_bf16 a[52:55], v[144:147], v[60:63], a[52:55]
    ds_read_b64_tr_b16 v[140:141], v229 offset:27840
    v_mfma_f32_16x16x32_bf16 a[56:59], v[144:147], v[64:67], a[56:59]
    ds_read_b64_tr_b16 v[142:143], v229 offset:32448
    v_mfma_f32_16x16x32_bf16 a[60:63], v[144:147], v[68:71], a[60:63]
    s_add_u32 m0, s70, 8192
    s_waitcnt lgkmcnt(4)
    v_mfma_f32_16x16x32_bf16 a[64:67], v[148:151], v[56:59], a[64:67]
    buffer_load_dwordx4 v227, s[60:63], s99 offen offset:0 lds
    v_mfma_f32_16x16x32_bf16 a[68:71], v[148:151], v[60:63], a[68:71]
    ds_read_b64_tr_b16 v[144:145], v229 offset:27872
    v_mfma_f32_16x16x32_bf16 a[72:75], v[148:151], v[64:67], a[72:75]
    ds_read_b64_tr_b16 v[146:147], v229 offset:32480
    v_mfma_f32_16x16x32_bf16 a[76:79], v[148:151], v[68:71], a[76:79]
    s_add_u32 s99, s68, 737280
    s_add_u32 m0, s70, 36864
    s_waitcnt lgkmcnt(4)
    v_mfma_f32_16x16x32_bf16 a[80:83], v[136:139], v[56:59], a[80:83]
    buffer_load_dwordx4 v219, s[60:63], s99 offen offset:0 lds
    v_mfma_f32_16x16x32_bf16 a[84:87], v[136:139], v[60:63], a[84:87]
    ds_read_b64_tr_b16 v[148:149], v229 offset:27904
    v_mfma_f32_16x16x32_bf16 a[88:91], v[136:139], v[64:67], a[88:91]
    ds_read_b64_tr_b16 v[150:151], v229 offset:32512
    v_mfma_f32_16x16x32_bf16 a[92:95], v[136:139], v[68:71], a[92:95]
    s_waitcnt lgkmcnt(4)
    v_mfma_f32_16x16x32_bf16 a[96:99], v[140:143], v[56:59], a[96:99]
    s_waitcnt vmcnt(18)
    s_waitcnt lgkmcnt(0)
    s_barrier
    v_add_u32 v229, 110592, v228
    buffer_load_dwordx4 v220, s[60:63], s99 offen offset:1024 lds
    v_mfma_f32_16x16x32_bf16 a[100:103], v[140:143], v[60:63], a[100:103]
    ds_read_b64_tr_b16 v[136:137], v229 offset:0
    v_mfma_f32_16x16x32_bf16 a[104:107], v[140:143], v[64:67], a[104:107]
    ds_read_b64_tr_b16 v[138:139], v229 offset:4608
    v_mfma_f32_16x16x32_bf16 a[108:111], v[140:143], v[68:71], a[108:111]
    v_mfma_f32_16x16x32_bf16 a[112:115], v[144:147], v[56:59], a[112:115]
    buffer_load_dwordx4 v221, s[60:63], s99 offen offset:2048 lds
    v_mfma_f32_16x16x32_bf16 a[116:119], v[144:147], v[60:63], a[116:119]
    ds_read_b64_tr_b16 v[140:141], v229 offset:32
    v_mfma_f32_16x16x32_bf16 a[120:123], v[144:147], v[64:67], a[120:123]
    ds_read_b64_tr_b16 v[142:143], v229 offset:4640
    v_mfma_f32_16x16x32_bf16 a[124:127], v[144:147], v[68:71], a[124:127]
    v_mfma_f32_16x16x32_bf16 a[128:131], v[148:151], v[56:59], a[128:131]
    buffer_load_dwordx4 v222, s[60:63], s99 offen offset:3072 lds
    v_mfma_f32_16x16x32_bf16 a[132:135], v[148:151], v[60:63], a[132:135]
    ds_read_b64_tr_b16 v[144:145], v229 offset:64
    v_mfma_f32_16x16x32_bf16 a[136:139], v[148:151], v[64:67], a[136:139]
    ds_read_b64_tr_b16 v[146:147], v229 offset:4672
    v_mfma_f32_16x16x32_bf16 a[140:143], v[148:151], v[68:71], a[140:143]
    s_add_u32 s100, s69, 311296
    s_waitcnt lgkmcnt(4)
    v_mfma_f32_16x16x32_bf16 a[0:3], v[136:139], v[72:75], a[0:3]
    buffer_load_dwordx4 v[56:59], v3, s[64:67], s100 offen offset:0 sc1
    v_mfma_f32_16x16x32_bf16 a[4:7], v[136:139], v[76:79], a[4:7]
    ds_read_b64_tr_b16 v[148:149], v229 offset:96
    v_mfma_f32_16x16x32_bf16 a[8:11], v[136:139], v[80:83], a[8:11]
    ds_read_b64_tr_b16 v[150:151], v229 offset:4704
    v_mfma_f32_16x16x32_bf16 a[12:15], v[136:139], v[84:87], a[12:15]
    s_add_u32 s100, s69, 311296
    s_waitcnt lgkmcnt(4)
    v_mfma_f32_16x16x32_bf16 a[16:19], v[140:143], v[72:75], a[16:19]
    buffer_load_dwordx4 v[60:63], v3, s[64:67], s100 offen offset:1024 sc1
    v_mfma_f32_16x16x32_bf16 a[20:23], v[140:143], v[76:79], a[20:23]
    ds_read_b64_tr_b16 v[136:137], v229 offset:128
    v_mfma_f32_16x16x32_bf16 a[24:27], v[140:143], v[80:83], a[24:27]
    ds_read_b64_tr_b16 v[138:139], v229 offset:4736
    v_mfma_f32_16x16x32_bf16 a[28:31], v[140:143], v[84:87], a[28:31]
    s_add_u32 s100, s69, 311296
    s_waitcnt lgkmcnt(4)
    v_mfma_f32_16x16x32_bf16 a[32:35], v[144:147], v[72:75], a[32:35]
    buffer_load_dwordx4 v[64:67], v3, s[64:67], s100 offen offset:2048 sc1
    v_mfma_f32_16x16x32_bf16 a[36:39], v[144:147], v[76:79], a[36:39]
    ds_read_b64_tr_b16 v[140:141], v229 offset:160
    v_mfma_f32_16x16x32_bf16 a[40:43], v[144:147], v[80:83], a[40:43]
    ds_read_b64_tr_b16 v[142:143], v229 offset:4768
    v_mfma_f32_16x16x32_bf16 a[44:47], v[144:147], v[84:87], a[44:47]
    s_add_u32 s100, s69, 311296
    s_waitcnt lgkmcnt(4)
    v_mfma_f32_16x16x32_bf16 a[48:51], v[148:151], v[72:75], a[48:51]
    buffer_load_dwordx4 v[68:71], v3, s[64:67], s100 offen offset:3072 sc1
    v_mfma_f32_16x16x32_bf16 a[52:55], v[148:151], v[76:79], a[52:55]
    ds_read_b64_tr_b16 v[144:145], v229 offset:192
    v_mfma_f32_16x16x32_bf16 a[56:59], v[148:151], v[80:83], a[56:59]
    ds_read_b64_tr_b16 v[146:147], v229 offset:4800
    v_mfma_f32_16x16x32_bf16 a[60:63], v[148:151], v[84:87], a[60:63]
    s_add_u32 m0, s70, 40960
    s_waitcnt lgkmcnt(4)
    v_mfma_f32_16x16x32_bf16 a[64:67], v[136:139], v[72:75], a[64:67]
    buffer_load_dwordx4 v223, s[60:63], s99 offen offset:0 lds
    v_mfma_f32_16x16x32_bf16 a[68:71], v[136:139], v[76:79], a[68:71]
    ds_read_b64_tr_b16 v[148:149], v229 offset:224
    v_mfma_f32_16x16x32_bf16 a[72:75], v[136:139], v[80:83], a[72:75]
    ds_read_b64_tr_b16 v[150:151], v229 offset:4832
    v_mfma_f32_16x16x32_bf16 a[76:79], v[136:139], v[84:87], a[76:79]
    s_waitcnt lgkmcnt(4)
    v_mfma_f32_16x16x32_bf16 a[80:83], v[140:143], v[72:75], a[80:83]
    buffer_load_dwordx4 v224, s[60:63], s99 offen offset:1024 lds
    v_mfma_f32_16x16x32_bf16 a[84:87], v[140:143], v[76:79], a[84:87]
    ds_read_b64_tr_b16 v[136:137], v229 offset:256
    v_mfma_f32_16x16x32_bf16 a[88:91], v[140:143], v[80:83], a[88:91]
    ds_read_b64_tr_b16 v[138:139], v229 offset:4864
    v_mfma_f32_16x16x32_bf16 a[92:95], v[140:143], v[84:87], a[92:95]
    s_waitcnt lgkmcnt(4)
    v_mfma_f32_16x16x32_bf16 a[96:99], v[144:147], v[72:75], a[96:99]
    buffer_load_dwordx4 v225, s[60:63], s99 offen offset:2048 lds
    v_mfma_f32_16x16x32_bf16 a[100:103], v[144:147], v[76:79], a[100:103]
    ds_read_b64_tr_b16 v[140:141], v229 offset:9216
    v_mfma_f32_16x16x32_bf16 a[104:107], v[144:147], v[80:83], a[104:107]
    ds_read_b64_tr_b16 v[142:143], v229 offset:13824
    v_mfma_f32_16x16x32_bf16 a[108:111], v[144:147], v[84:87], a[108:111]
    s_waitcnt lgkmcnt(4)
    v_mfma_f32_16x16x32_bf16 a[112:115], v[148:151], v[72:75], a[112:115]
    buffer_load_dwordx4 v226, s[60:63], s99 offen offset:3072 lds
    v_mfma_f32_16x16x32_bf16 a[116:119], v[148:151], v[76:79], a[116:119]
    ds_read_b64_tr_b16 v[144:145], v229 offset:9248
    v_mfma_f32_16x16x32_bf16 a[120:123], v[148:151], v[80:83], a[120:123]
    ds_read_b64_tr_b16 v[146:147], v229 offset:13856
    v_mfma_f32_16x16x32_bf16 a[124:127], v[148:151], v[84:87], a[124:127]
    s_add_u32 m0, s70, 45056
    s_waitcnt lgkmcnt(4)
    v_mfma_f32_16x16x32_bf16 a[128:131], v[136:139], v[72:75], a[128:131]
    buffer_load_dwordx4 v227, s[60:63], s99 offen offset:0 lds
    v_mfma_f32_16x16x32_bf16 a[132:135], v[136:139], v[76:79], a[132:135]
    ds_read_b64_tr_b16 v[148:149], v229 offset:9280
    v_mfma_f32_16x16x32_bf16 a[136:139], v[136:139], v[80:83], a[136:139]
    ds_read_b64_tr_b16 v[150:151], v229 offset:13888
    v_mfma_f32_16x16x32_bf16 a[140:143], v[136:139], v[84:87], a[140:143]
    s_add_u32 s100, s69, 327680
    s_waitcnt lgkmcnt(4)
    v_mfma_f32_16x16x32_bf16 a[0:3], v[140:143], v[88:91], a[0:3]
    buffer_load_dwordx4 v[72:75], v3, s[64:67], s100 offen offset:0 sc1
    v_mfma_f32_16x16x32_bf16 a[4:7], v[140:143], v[92:95], a[4:7]
    ds_read_b64_tr_b16 v[136:137], v229 offset:9312
    v_mfma_f32_16x16x32_bf16 a[8:11], v[140:143], v[96:99], a[8:11]
    ds_read_b64_tr_b16 v[138:139], v229 offset:13920
    v_mfma_f32_16x16x32_bf16 a[12:15], v[140:143], v[100:103], a[12:15]
    s_add_u32 s100, s69, 327680
    s_waitcnt lgkmcnt(4)
    v_mfma_f32_16x16x32_bf16 a[16:19], v[144:147], v[88:91], a[16:19]
    buffer_load_dwordx4 v[76:79], v3, s[64:67], s100 offen offset:1024 sc1
    v_mfma_f32_16x16x32_bf16 a[20:23], v[144:147], v[92:95], a[20:23]
    ds_read_b64_tr_b16 v[140:141], v229 offset:9344
    v_mfma_f32_16x16x32_bf16 a[24:27], v[144:147], v[96:99], a[24:27]
    ds_read_b64_tr_b16 v[142:143], v229 offset:13952
    v_mfma_f32_16x16x32_bf16 a[28:31], v[144:147], v[100:103], a[28:31]
    s_add_u32 s100, s69, 327680
    s_waitcnt lgkmcnt(4)
    v_mfma_f32_16x16x32_bf16 a[32:35], v[148:151], v[88:91], a[32:35]
    buffer_load_dwordx4 v[80:83], v3, s[64:67], s100 offen offset:2048 sc1
    v_mfma_f32_16x16x32_bf16 a[36:39], v[148:151], v[92:95], a[36:39]
    ds_read_b64_tr_b16 v[144:145], v229 offset:9376
    v_mfma_f32_16x16x32_bf16 a[40:43], v[148:151], v[96:99], a[40:43]
    ds_read_b64_tr_b16 v[146:147], v229 offset:13984
    v_mfma_f32_16x16x32_bf16 a[44:47], v[148:151], v[100:103], a[44:47]
    s_add_u32 s100, s69, 327680
    s_waitcnt lgkmcnt(4)
    v_mfma_f32_16x16x32_bf16 a[48:51], v[136:139], v[88:91], a[48:51]
    buffer_load_dwordx4 v[84:87], v3, s[64:67], s100 offen offset:3072 sc1
    v_mfma_f32_16x16x32_bf16 a[52:55], v[136:139], v[92:95], a[52:55]
    ds_read_b64_tr_b16 v[148:149], v229 offset:9408
    v_mfma_f32_16x16x32_bf16 a[56:59], v[136:139], v[96:99], a[56:59]
    ds_read_b64_tr_b16 v[150:151], v229 offset:14016
    v_mfma_f32_16x16x32_bf16 a[60:63], v[136:139], v[100:103], a[60:63]
    s_add_u32 s99, s68, 884736
    s_add_u32 m0, s70, 73728
    s_waitcnt lgkmcnt(4)
    v_mfma_f32_16x16x32_bf16 a[64:67], v[140:143], v[88:91], a[64:67]
    buffer_load_dwordx4 v219, s[60:63], s99 offen offset:0 lds
    v_mfma_f32_16x16x32_bf16 a[68:71], v[140:143], v[92:95], a[68:71]
    ds_read_b64_tr_b16 v[136:137], v229 offset:9440
    v_mfma_f32_16x16x32_bf16 a[72:75], v[140:143], v[96:99], a[72:75]
    ds_read_b64_tr_b16 v[138:139], v229 offset:14048
    v_mfma_f32_16x16x32_bf16 a[76:79], v[140:143], v[100:103], a[76:79]
    s_waitcnt lgkmcnt(4)
    v_mfma_f32_16x16x32_bf16 a[80:83], v[144:147], v[88:91], a[80:83]
    buffer_load_dwordx4 v220, s[60:63], s99 offen offset:1024 lds
    v_mfma_f32_16x16x32_bf16 a[84:87], v[144:147], v[92:95], a[84:87]
    ds_read_b64_tr_b16 v[140:141], v229 offset:9472
    v_mfma_f32_16x16x32_bf16 a[88:91], v[144:147], v[96:99], a[88:91]
    ds_read_b64_tr_b16 v[142:143], v229 offset:14080
    v_mfma_f32_16x16x32_bf16 a[92:95], v[144:147], v[100:103], a[92:95]
    s_waitcnt lgkmcnt(4)
    v_mfma_f32_16x16x32_bf16 a[96:99], v[148:151], v[88:91], a[96:99]
    buffer_load_dwordx4 v221, s[60:63], s99 offen offset:2048 lds
    v_mfma_f32_16x16x32_bf16 a[100:103], v[148:151], v[92:95], a[100:103]
    ds_read_b64_tr_b16 v[144:145], v229 offset:18432
    v_mfma_f32_16x16x32_bf16 a[104:107], v[148:151], v[96:99], a[104:107]
    ds_read_b64_tr_b16 v[146:147], v229 offset:23040
    v_mfma_f32_16x16x32_bf16 a[108:111], v[148:151], v[100:103], a[108:111]
    s_waitcnt lgkmcnt(4)
    v_mfma_f32_16x16x32_bf16 a[112:115], v[136:139], v[88:91], a[112:115]
    buffer_load_dwordx4 v222, s[60:63], s99 offen offset:3072 lds
    v_mfma_f32_16x16x32_bf16 a[116:119], v[136:139], v[92:95], a[116:119]
    ds_read_b64_tr_b16 v[148:149], v229 offset:18464
    v_mfma_f32_16x16x32_bf16 a[120:123], v[136:139], v[96:99], a[120:123]
    ds_read_b64_tr_b16 v[150:151], v229 offset:23072
    v_mfma_f32_16x16x32_bf16 a[124:127], v[136:139], v[100:103], a[124:127]
    s_add_u32 m0, s70, 77824
    s_waitcnt lgkmcnt(4)
    v_mfma_f32_16x16x32_bf16 a[128:131], v[140:143], v[88:91], a[128:131]
    buffer_load_dwordx4 v223, s[60:63], s99 offen offset:0 lds
    v_mfma_f32_16x16x32_bf16 a[132:135], v[140:143], v[92:95], a[132:135]
    ds_read_b64_tr_b16 v[136:137], v229 offset:18496
    v_mfma_f32_16x16x32_bf16 a[136:139], v[140:143], v[96:99], a[136:139]
    ds_read_b64_tr_b16 v[138:139], v229 offset:23104
    v_mfma_f32_16x16x32_bf16 a[140:143], v[140:143], v[100:103], a[140:143]
    s_add_u32 s100, s69, 344064
    s_waitcnt lgkmcnt(4)
    v_mfma_f32_16x16x32_bf16 a[0:3], v[144:147], v[104:107], a[0:3]
    buffer_load_dwordx4 v[88:91], v3, s[64:67], s100 offen offset:0 sc1
    v_mfma_f32_16x16x32_bf16 a[4:7], v[144:147], v[108:111], a[4:7]
    ds_read_b64_tr_b16 v[140:141], v229 offset:18528
    v_mfma_f32_16x16x32_bf16 a[8:11], v[144:147], v[112:115], a[8:11]
    ds_read_b64_tr_b16 v[142:143], v229 offset:23136
    v_mfma_f32_16x16x32_bf16 a[12:15], v[144:147], v[116:119], a[12:15]
    s_add_u32 s100, s69, 344064
    s_waitcnt lgkmcnt(4)
    v_mfma_f32_16x16x32_bf16 a[16:19], v[148:151], v[104:107], a[16:19]
    buffer_load_dwordx4 v[92:95], v3, s[64:67], s100 offen offset:1024 sc1
    v_mfma_f32_16x16x32_bf16 a[20:23], v[148:151], v[108:111], a[20:23]
    ds_read_b64_tr_b16 v[144:145], v229 offset:18560
    v_mfma_f32_16x16x32_bf16 a[24:27], v[148:151], v[112:115], a[24:27]
    ds_read_b64_tr_b16 v[146:147], v229 offset:23168
    v_mfma_f32_16x16x32_bf16 a[28:31], v[148:151], v[116:119], a[28:31]
    s_add_u32 s100, s69, 344064
    s_waitcnt lgkmcnt(4)
    v_mfma_f32_16x16x32_bf16 a[32:35], v[136:139], v[104:107], a[32:35]
    buffer_load_dwordx4 v[96:99], v3, s[64:67], s100 offen offset:2048 sc1
    v_mfma_f32_16x16x32_bf16 a[36:39], v[136:139], v[108:111], a[36:39]
    ds_read_b64_tr_b16 v[148:149], v229 offset:18592
    v_mfma_f32_16x16x32_bf16 a[40:43], v[136:139], v[112:115], a[40:43]
    ds_read_b64_tr_b16 v[150:151], v229 offset:23200
    v_mfma_f32_16x16x32_bf16 a[44:47], v[136:139], v[116:119], a[44:47]
    s_add_u32 s100, s69, 344064
    s_waitcnt lgkmcnt(4)
    v_mfma_f32_16x16x32_bf16 a[48:51], v[140:143], v[104:107], a[48:51]
    buffer_load_dwordx4 v[100:103], v3, s[64:67], s100 offen offset:3072 sc1
    v_mfma_f32_16x16x32_bf16 a[52:55], v[140:143], v[108:111], a[52:55]
    ds_read_b64_tr_b16 v[136:137], v229 offset:18624
    v_mfma_f32_16x16x32_bf16 a[56:59], v[140:143], v[112:115], a[56:59]
    ds_read_b64_tr_b16 v[138:139], v229 offset:23232
    v_mfma_f32_16x16x32_bf16 a[60:63], v[140:143], v[116:119], a[60:63]
    s_waitcnt lgkmcnt(4)
    v_mfma_f32_16x16x32_bf16 a[64:67], v[144:147], v[104:107], a[64:67]
    buffer_load_dwordx4 v224, s[60:63], s99 offen offset:1024 lds
    v_mfma_f32_16x16x32_bf16 a[68:71], v[144:147], v[108:111], a[68:71]
    ds_read_b64_tr_b16 v[140:141], v229 offset:18656
    v_mfma_f32_16x16x32_bf16 a[72:75], v[144:147], v[112:115], a[72:75]
    ds_read_b64_tr_b16 v[142:143], v229 offset:23264
    v_mfma_f32_16x16x32_bf16 a[76:79], v[144:147], v[116:119], a[76:79]
    s_waitcnt lgkmcnt(4)
    v_mfma_f32_16x16x32_bf16 a[80:83], v[148:151], v[104:107], a[80:83]
    buffer_load_dwordx4 v225, s[60:63], s99 offen offset:2048 lds
    v_mfma_f32_16x16x32_bf16 a[84:87], v[148:151], v[108:111], a[84:87]
    ds_read_b64_tr_b16 v[144:145], v229 offset:18688
    v_mfma_f32_16x16x32_bf16 a[88:91], v[148:151], v[112:115], a[88:91]
    ds_read_b64_tr_b16 v[146:147], v229 offset:23296
    v_mfma_f32_16x16x32_bf16 a[92:95], v[148:151], v[116:119], a[92:95]
    s_waitcnt lgkmcnt(4)
    v_mfma_f32_16x16x32_bf16 a[96:99], v[136:139], v[104:107], a[96:99]
    buffer_load_dwordx4 v226, s[60:63], s99 offen offset:3072 lds
    v_mfma_f32_16x16x32_bf16 a[100:103], v[136:139], v[108:111], a[100:103]
    ds_read_b64_tr_b16 v[148:149], v229 offset:27648
    v_mfma_f32_16x16x32_bf16 a[104:107], v[136:139], v[112:115], a[104:107]
    ds_read_b64_tr_b16 v[150:151], v229 offset:32256
    v_mfma_f32_16x16x32_bf16 a[108:111], v[136:139], v[116:119], a[108:111]
    s_add_u32 m0, s70, 81920
    s_waitcnt lgkmcnt(4)
    v_mfma_f32_16x16x32_bf16 a[112:115], v[140:143], v[104:107], a[112:115]
    buffer_load_dwordx4 v227, s[60:63], s99 offen offset:0 lds
    v_mfma_f32_16x16x32_bf16 a[116:119], v[140:143], v[108:111], a[116:119]
    ds_read_b64_tr_b16 v[136:137], v229 offset:27680
    v_mfma_f32_16x16x32_bf16 a[120:123], v[140:143], v[112:115], a[120:123]
    ds_read_b64_tr_b16 v[138:139], v229 offset:32288
    v_mfma_f32_16x16x32_bf16 a[124:127], v[140:143], v[116:119], a[124:127]
    s_waitcnt lgkmcnt(4)
    v_mfma_f32_16x16x32_bf16 a[128:131], v[144:147], v[104:107], a[128:131]
    v_mfma_f32_16x16x32_bf16 a[132:135], v[144:147], v[108:111], a[132:135]
    ds_read_b64_tr_b16 v[140:141], v229 offset:27712
    v_mfma_f32_16x16x32_bf16 a[136:139], v[144:147], v[112:115], a[136:139]
    ds_read_b64_tr_b16 v[142:143], v229 offset:32320
    v_mfma_f32_16x16x32_bf16 a[140:143], v[144:147], v[116:119], a[140:143]
    s_add_u32 s100, s69, 360448
    s_waitcnt lgkmcnt(4)
    v_mfma_f32_16x16x32_bf16 a[0:3], v[148:151], v[120:123], a[0:3]
    buffer_load_dwordx2 v[104:105], v232, s[64:67], s100 offen offset:0 sc1
    v_mfma_f32_16x16x32_bf16 a[4:7], v[148:151], v[124:127], a[4:7]
    ds_read_b64_tr_b16 v[144:145], v229 offset:27744
    v_mfma_f32_16x16x32_bf16 a[8:11], v[148:151], v[128:131], a[8:11]
    ds_read_b64_tr_b16 v[146:147], v229 offset:32352
    v_mfma_f32_16x16x32_bf16 a[12:15], v[148:151], v[132:135], a[12:15]
    s_add_u32 s100, s69, 360448
    s_waitcnt lgkmcnt(4)
    v_mfma_f32_16x16x32_bf16 a[16:19], v[136:139], v[120:123], a[16:19]
    buffer_load_dwordx2 v[106:107], v232, s[64:67], s100 offen offset:512 sc1
    v_mfma_f32_16x16x32_bf16 a[20:23], v[136:139], v[124:127], a[20:23]
    ds_read_b64_tr_b16 v[148:149], v229 offset:27776
    v_mfma_f32_16x16x32_bf16 a[24:27], v[136:139], v[128:131], a[24:27]
    ds_read_b64_tr_b16 v[150:151], v229 offset:32384
    v_mfma_f32_16x16x32_bf16 a[28:31], v[136:139], v[132:135], a[28:31]
    s_add_u32 s100, s69, 360448
    s_waitcnt lgkmcnt(4)
    v_mfma_f32_16x16x32_bf16 a[32:35], v[140:143], v[120:123], a[32:35]
    buffer_load_dwordx2 v[108:109], v232, s[64:67], s100 offen offset:1024 sc1
    v_mfma_f32_16x16x32_bf16 a[36:39], v[140:143], v[124:127], a[36:39]
    ds_read_b64_tr_b16 v[136:137], v229 offset:27808
    v_mfma_f32_16x16x32_bf16 a[40:43], v[140:143], v[128:131], a[40:43]
    ds_read_b64_tr_b16 v[138:139], v229 offset:32416
    v_mfma_f32_16x16x32_bf16 a[44:47], v[140:143], v[132:135], a[44:47]
    s_add_u32 s100, s69, 360448
    s_waitcnt lgkmcnt(4)
    v_mfma_f32_16x16x32_bf16 a[48:51], v[144:147], v[120:123], a[48:51]
    buffer_load_dwordx2 v[110:111], v232, s[64:67], s100 offen offset:1536 sc1
    v_mfma_f32_16x16x32_bf16 a[52:55], v[144:147], v[124:127], a[52:55]
    ds_read_b64_tr_b16 v[140:141], v229 offset:27840
    v_mfma_f32_16x16x32_bf16 a[56:59], v[144:147], v[128:131], a[56:59]
    ds_read_b64_tr_b16 v[142:143], v229 offset:32448
    v_mfma_f32_16x16x32_bf16 a[60:63], v[144:147], v[132:135], a[60:63]
    s_add_u32 s100, s69, 360448
    s_waitcnt lgkmcnt(4)
    v_mfma_f32_16x16x32_bf16 a[64:67], v[148:151], v[120:123], a[64:67]
    buffer_load_dwordx2 v[112:113], v232, s[64:67], s100 offen offset:2048 sc1
    v_mfma_f32_16x16x32_bf16 a[68:71], v[148:151], v[124:127], a[68:71]
    ds_read_b64_tr_b16 v[144:145], v229 offset:27872
    v_mfma_f32_16x16x32_bf16 a[72:75], v[148:151], v[128:131], a[72:75]
    ds_read_b64_tr_b16 v[146:147], v229 offset:32480
    v_mfma_f32_16x16x32_bf16 a[76:79], v[148:151], v[132:135], a[76:79]
    s_add_u32 s100, s69, 360448
    s_waitcnt lgkmcnt(4)
    v_mfma_f32_16x16x32_bf16 a[80:83], v[136:139], v[120:123], a[80:83]
    buffer_load_dwordx2 v[114:115], v232, s[64:67], s100 offen offset:2560 sc1
    v_mfma_f32_16x16x32_bf16 a[84:87], v[136:139], v[124:127], a[84:87]
    ds_read_b64_tr_b16 v[148:149], v229 offset:27904
    v_mfma_f32_16x16x32_bf16 a[88:91], v[136:139], v[128:131], a[88:91]
    ds_read_b64_tr_b16 v[150:151], v229 offset:32512
    v_mfma_f32_16x16x32_bf16 a[92:95], v[136:139], v[132:135], a[92:95]
    s_add_u32 s100, s69, 360448
    s_waitcnt lgkmcnt(4)
    v_mfma_f32_16x16x32_bf16 a[96:99], v[140:143], v[120:123], a[96:99]
    s_waitcnt vmcnt(36)
    s_waitcnt lgkmcnt(0)
    s_barrier
    v_add_u32 v229, 0, v228
    buffer_load_dwordx2 v[116:117], v232, s[64:67], s100 offen offset:3072 sc1
    v_mfma_f32_16x16x32_bf16 a[100:103], v[140:143], v[124:127], a[100:103]
    ds_read_b64_tr_b16 v[136:137], v229 offset:0
    v_mfma_f32_16x16x32_bf16 a[104:107], v[140:143], v[128:131], a[104:107]
    ds_read_b64_tr_b16 v[138:139], v229 offset:4608
    v_mfma_f32_16x16x32_bf16 a[108:111], v[140:143], v[132:135], a[108:111]
    s_add_u32 s100, s69, 360448
    v_mfma_f32_16x16x32_bf16 a[112:115], v[144:147], v[120:123], a[112:115]
    buffer_load_dwordx2 v[118:119], v232, s[64:67], s100 offen offset:3584 sc1
    v_mfma_f32_16x16x32_bf16 a[116:119], v[144:147], v[124:127], a[116:119]
    ds_read_b64_tr_b16 v[140:141], v229 offset:32
    v_mfma_f32_16x16x32_bf16 a[120:123], v[144:147], v[128:131], a[120:123]
    ds_read_b64_tr_b16 v[142:143], v229 offset:4640
    v_mfma_f32_16x16x32_bf16 a[124:127], v[144:147], v[132:135], a[124:127]
    s_add_u32 s99, s68, 1032192
    s_add_u32 m0, s70, 110592
    v_mfma_f32_16x16x32_bf16 a[128:131], v[148:151], v[120:123], a[128:131]
    buffer_load_dwordx4 v219, s[60:63], s99 offen offset:0 lds
    v_mfma_f32_16x16x32_bf16 a[132:135], v[148:151], v[124:127], a[132:135]
    ds_read_b64_tr_b16 v[144:145], v229 offset:64
    v_mfma_f32_16x16x32_bf16 a[136:139], v[148:151], v[128:131], a[136:139]
    ds_read_b64_tr_b16 v[146:147], v229 offset:4672
    v_mfma_f32_16x16x32_bf16 a[140:143], v[148:151], v[132:135], a[140:143]
    s_add_u32 s100, s69, 376832
    s_waitcnt lgkmcnt(4)
    v_mfma_f32_16x16x32_bf16 a[0:3], v[136:139], v[8:11], a[0:3]
    buffer_load_dwordx4 v[120:123], v3, s[64:67], s100 offen offset:0 sc1
    v_mfma_f32_16x16x32_bf16 a[4:7], v[136:139], v[12:15], a[4:7]
    ds_read_b64_tr_b16 v[148:149], v229 offset:96
    v_mfma_f32_16x16x32_bf16 a[8:11], v[136:139], v[16:19], a[8:11]
    ds_read_b64_tr_b16 v[150:151], v229 offset:4704
    v_mfma_f32_16x16x32_bf16 a[12:15], v[136:139], v[20:23], a[12:15]
    s_add_u32 s100, s69, 376832
    s_waitcnt lgkmcnt(4)
    v_mfma_f32_16x16x32_bf16 a[16:19], v[140:143], v[8:11], a[16:19]
    buffer_load_dwordx4 v[124:127], v3, s[64:67], s100 offen offset:1024 sc1
    v_mfma_f32_16x16x32_bf16 a[20:23], v[140:143], v[12:15], a[20:23]
    ds_read_b64_tr_b16 v[136:137], v229 offset:128
    v_mfma_f32_16x16x32_bf16 a[24:27], v[140:143], v[16:19], a[24:27]
    ds_read_b64_tr_b16 v[138:139], v229 offset:4736
    v_mfma_f32_16x16x32_bf16 a[28:31], v[140:143], v[20:23], a[28:31]
    s_add_u32 s100, s69, 376832
    s_waitcnt lgkmcnt(4)
    v_mfma_f32_16x16x32_bf16 a[32:35], v[144:147], v[8:11], a[32:35]
    buffer_load_dwordx4 v[128:131], v3, s[64:67], s100 offen offset:2048 sc1
    v_mfma_f32_16x16x32_bf16 a[36:39], v[144:147], v[12:15], a[36:39]
    ds_read_b64_tr_b16 v[140:141], v229 offset:160
    v_mfma_f32_16x16x32_bf16 a[40:43], v[144:147], v[16:19], a[40:43]
    ds_read_b64_tr_b16 v[142:143], v229 offset:4768
    v_mfma_f32_16x16x32_bf16 a[44:47], v[144:147], v[20:23], a[44:47]
    s_add_u32 s100, s69, 376832
    s_waitcnt lgkmcnt(4)
    v_mfma_f32_16x16x32_bf16 a[48:51], v[148:151], v[8:11], a[48:51]
    buffer_load_dwordx4 v[132:135], v3, s[64:67], s100 offen offset:3072 sc1
    v_mfma_f32_16x16x32_bf16 a[52:55], v[148:151], v[12:15], a[52:55]
    ds_read_b64_tr_b16 v[144:145], v229 offset:192
    v_mfma_f32_16x16x32_bf16 a[56:59], v[148:151], v[16:19], a[56:59]
    ds_read_b64_tr_b16 v[146:147], v229 offset:4800
    v_mfma_f32_16x16x32_bf16 a[60:63], v[148:151], v[20:23], a[60:63]
    s_waitcnt lgkmcnt(4)
    v_mfma_f32_16x16x32_bf16 a[64:67], v[136:139], v[8:11], a[64:67]
    buffer_load_dwordx4 v220, s[60:63], s99 offen offset:1024 lds
    v_mfma_f32_16x16x32_bf16 a[68:71], v[136:139], v[12:15], a[68:71]
    ds_read_b64_tr_b16 v[148:149], v229 offset:224
    v_mfma_f32_16x16x32_bf16 a[72:75], v[136:139], v[16:19], a[72:75]
    ds_read_b64_tr_b16 v[150:151], v229 offset:4832
    v_mfma_f32_16x16x32_bf16 a[76:79], v[136:139], v[20:23], a[76:79]
    s_waitcnt lgkmcnt(4)
    v_mfma_f32_16x16x32_bf16 a[80:83], v[140:143], v[8:11], a[80:83]
    buffer_load_dwordx4 v221, s[60:63], s99 offen offset:2048 lds
    v_mfma_f32_16x16x32_bf16 a[84:87], v[140:143], v[12:15], a[84:87]
    ds_read_b64_tr_b16 v[136:137], v229 offset:256
    v_mfma_f32_16x16x32_bf16 a[88:91], v[140:143], v[16:19], a[88:91]
    ds_read_b64_tr_b16 v[138:139], v229 offset:4864
    v_mfma_f32_16x16x32_bf16 a[92:95], v[140:143], v[20:23], a[92:95]
    s_waitcnt lgkmcnt(4)
    v_mfma_f32_16x16x32_bf16 a[96:99], v[144:147], v[8:11], a[96:99]
    buffer_load_dwordx4 v222, s[60:63], s99 offen offset:3072 lds
    v_mfma_f32_16x16x32_bf16 a[100:103], v[144:147], v[12:15], a[100:103]
    ds_read_b64_tr_b16 v[140:141], v229 offset:9216
    v_mfma_f32_16x16x32_bf16 a[104:107], v[144:147], v[16:19], a[104:107]
    ds_read_b64_tr_b16 v[142:143], v229 offset:13824
    v_mfma_f32_16x16x32_bf16 a[108:111], v[144:147], v[20:23], a[108:111]
    s_add_u32 m0, s70, 114688
    s_waitcnt lgkmcnt(4)
    v_mfma_f32_16x16x32_bf16 a[112:115], v[148:151], v[8:11], a[112:115]
    buffer_load_dwordx4 v223, s[60:63], s99 offen offset:0 lds
    v_mfma_f32_16x16x32_bf16 a[116:119], v[148:151], v[12:15], a[116:119]
    ds_read_b64_tr_b16 v[144:145], v229 offset:9248
    v_mfma_f32_16x16x32_bf16 a[120:123], v[148:151], v[16:19], a[120:123]
    ds_read_b64_tr_b16 v[146:147], v229 offset:13856
    v_mfma_f32_16x16x32_bf16 a[124:127], v[148:151], v[20:23], a[124:127]
    s_waitcnt lgkmcnt(4)
    v_mfma_f32_16x16x32_bf16 a[128:131], v[136:139], v[8:11], a[128:131]
    buffer_load_dwordx4 v224, s[60:63], s99 offen offset:1024 lds
    v_mfma_f32_16x16x32_bf16 a[132:135], v[136:139], v[12:15], a[132:135]
    ds_read_b64_tr_b16 v[148:149], v229 offset:9280
    v_mfma_f32_16x16x32_bf16 a[136:139], v[136:139], v[16:19], a[136:139]
    ds_read_b64_tr_b16 v[150:151], v229 offset:13888
    v_mfma_f32_16x16x32_bf16 a[140:143], v[136:139], v[20:23], a[140:143]
    s_add_u32 s100, s69, 393216
    s_waitcnt lgkmcnt(4)
    v_mfma_f32_16x16x32_bf16 a[0:3], v[140:143], v[24:27], a[0:3]
    buffer_load_dwordx4 v[8:11], v3, s[64:67], s100 offen offset:0 sc1
    v_mfma_f32_16x16x32_bf16 a[4:7], v[140:143], v[28:31], a[4:7]
    ds_read_b64_tr_b16 v[136:137], v229 offset:9312
    v_mfma_f32_16x16x32_bf16 a[8:11], v[140:143], v[32:35], a[8:11]
    ds_read_b64_tr_b16 v[138:139], v229 offset:13920
    v_mfma_f32_16x16x32_bf16 a[12:15], v[140:143], v[36:39], a[12:15]
    s_add_u32 s100, s69, 393216
    s_waitcnt lgkmcnt(4)
    v_mfma_f32_16x16x32_bf16 a[16:19], v[144:147], v[24:27], a[16:19]
    buffer_load_dwordx4 v[12:15], v3, s[64:67], s100 offen offset:1024 sc1
    v_mfma_f32_16x16x32_bf16 a[20:23], v[144:147], v[28:31], a[20:23]
    ds_read_b64_tr_b16 v[140:141], v229 offset:9344
    v_mfma_f32_16x16x32_bf16 a[24:27], v[144:147], v[32:35], a[24:27]
    ds_read_b64_tr_b16 v[142:143], v229 offset:13952
    v_mfma_f32_16x16x32_bf16 a[28:31], v[144:147], v[36:39], a[28:31]
    s_add_u32 s100, s69, 393216
    s_waitcnt lgkmcnt(4)
    v_mfma_f32_16x16x32_bf16 a[32:35], v[148:151], v[24:27], a[32:35]
    buffer_load_dwordx4 v[16:19], v3, s[64:67], s100 offen offset:2048 sc1
    v_mfma_f32_16x16x32_bf16 a[36:39], v[148:151], v[28:31], a[36:39]
    ds_read_b64_tr_b16 v[144:145], v229 offset:9376
    v_mfma_f32_16x16x32_bf16 a[40:43], v[148:151], v[32:35], a[40:43]
    ds_read_b64_tr_b16 v[146:147], v229 offset:13984
    v_mfma_f32_16x16x32_bf16 a[44:47], v[148:151], v[36:39], a[44:47]
    s_add_u32 s100, s69, 393216
    s_waitcnt lgkmcnt(4)
    v_mfma_f32_16x16x32_bf16 a[48:51], v[136:139], v[24:27], a[48:51]
    buffer_load_dwordx4 v[20:23], v3, s[64:67], s100 offen offset:3072 sc1
    v_mfma_f32_16x16x32_bf16 a[52:55], v[136:139], v[28:31], a[52:55]
    ds_read_b64_tr_b16 v[148:149], v229 offset:9408
    v_mfma_f32_16x16x32_bf16 a[56:59], v[136:139], v[32:35], a[56:59]
    ds_read_b64_tr_b16 v[150:151], v229 offset:14016
    v_mfma_f32_16x16x32_bf16 a[60:63], v[136:139], v[36:39], a[60:63]
    s_waitcnt lgkmcnt(4)
    v_mfma_f32_16x16x32_bf16 a[64:67], v[140:143], v[24:27], a[64:67]
    buffer_load_dwordx4 v225, s[60:63], s99 offen offset:2048 lds
    v_mfma_f32_16x16x32_bf16 a[68:71], v[140:143], v[28:31], a[68:71]
    ds_read_b64_tr_b16 v[136:137], v229 offset:9440
    v_mfma_f32_16x16x32_bf16 a[72:75], v[140:143], v[32:35], a[72:75]
    ds_read_b64_tr_b16 v[138:139], v229 offset:14048
    v_mfma_f32_16x16x32_bf16 a[76:79], v[140:143], v[36:39], a[76:79]
    s_waitcnt lgkmcnt(4)
    v_mfma_f32_16x16x32_bf16 a[80:83], v[144:147], v[24:27], a[80:83]
    buffer_load_dwordx4 v226, s[60:63], s99 offen offset:3072 lds
    v_mfma_f32_16x16x32_bf16 a[84:87], v[144:147], v[28:31], a[84:87]
    ds_read_b64_tr_b16 v[140:141], v229 offset:9472
    v_mfma_f32_16x16x32_bf16 a[88:91], v[144:147], v[32:35], a[88:91]
    ds_read_b64_tr_b16 v[142:143], v229 offset:14080
    v_mfma_f32_16x16x32_bf16 a[92:95], v[144:147], v[36:39], a[92:95]
    s_add_u32 m0, s70, 118784
    s_waitcnt lgkmcnt(4)
    v_mfma_f32_16x16x32_bf16 a[96:99], v[148:151], v[24:27], a[96:99]
    buffer_load_dwordx4 v227, s[60:63], s99 offen offset:0 lds
    v_mfma_f32_16x16x32_bf16 a[100:103], v[148:151], v[28:31], a[100:103]
    ds_read_b64_tr_b16 v[144:145], v229 offset:18432
    v_mfma_f32_16x16x32_bf16 a[104:107], v[148:151], v[32:35], a[104:107]
    ds_read_b64_tr_b16 v[146:147], v229 offset:23040
    v_mfma_f32_16x16x32_bf16 a[108:111], v[148:151], v[36:39], a[108:111]
    s_waitcnt lgkmcnt(4)
    v_mfma_f32_16x16x32_bf16 a[112:115], v[136:139], v[24:27], a[112:115]
    v_mfma_f32_16x16x32_bf16 a[116:119], v[136:139], v[28:31], a[116:119]
    ds_read_b64_tr_b16 v[148:149], v229 offset:18464
    v_mfma_f32_16x16x32_bf16 a[120:123], v[136:139], v[32:35], a[120:123]
    ds_read_b64_tr_b16 v[150:151], v229 offset:23072
    v_mfma_f32_16x16x32_bf16 a[124:127], v[136:139], v[36:39], a[124:127]
    s_waitcnt lgkmcnt(4)
    v_mfma_f32_16x16x32_bf16 a[128:131], v[140:143], v[24:27], a[128:131]
    v_mfma_f32_16x16x32_bf16 a[132:135], v[140:143], v[28:31], a[132:135]
    ds_read_b64_tr_b16 v[136:137], v229 offset:18496
    v_mfma_f32_16x16x32_bf16 a[136:139], v[140:143], v[32:35], a[136:139]
    ds_read_b64_tr_b16 v[138:139], v229 offset:23104
    v_mfma_f32_16x16x32_bf16 a[140:143], v[140:143], v[36:39], a[140:143]
    s_add_u32 s100, s69, 409600
    s_waitcnt lgkmcnt(4)
    v_mfma_f32_16x16x32_bf16 a[0:3], v[144:147], v[40:43], a[0:3]
    buffer_load_dwordx4 v[24:27], v3, s[64:67], s100 offen offset:0 sc1
    v_mfma_f32_16x16x32_bf16 a[4:7], v[144:147], v[44:47], a[4:7]
    ds_read_b64_tr_b16 v[140:141], v229 offset:18528
    v_mfma_f32_16x16x32_bf16 a[8:11], v[144:147], v[48:51], a[8:11]
    ds_read_b64_tr_b16 v[142:143], v229 offset:23136
    v_mfma_f32_16x16x32_bf16 a[12:15], v[144:147], v[52:55], a[12:15]
    s_add_u32 s100, s69, 409600
    s_waitcnt lgkmcnt(4)
    v_mfma_f32_16x16x32_bf16 a[16:19], v[148:151], v[40:43], a[16:19]
    buffer_load_dwordx4 v[28:31], v3, s[64:67], s100 offen offset:1024 sc1
    v_mfma_f32_16x16x32_bf16 a[20:23], v[148:151], v[44:47], a[20:23]
    ds_read_b64_tr_b16 v[144:145], v229 offset:18560
    v_mfma_f32_16x16x32_bf16 a[24:27], v[148:151], v[48:51], a[24:27]
    ds_read_b64_tr_b16 v[146:147], v229 offset:23168
    v_mfma_f32_16x16x32_bf16 a[28:31], v[148:151], v[52:55], a[28:31]
    s_add_u32 s100, s69, 409600
    s_waitcnt lgkmcnt(4)
    v_mfma_f32_16x16x32_bf16 a[32:35], v[136:139], v[40:43], a[32:35]
    buffer_load_dwordx4 v[32:35], v3, s[64:67], s100 offen offset:2048 sc1
    v_mfma_f32_16x16x32_bf16 a[36:39], v[136:139], v[44:47], a[36:39]
    ds_read_b64_tr_b16 v[148:149], v229 offset:18592
    v_mfma_f32_16x16x32_bf16 a[40:43], v[136:139], v[48:51], a[40:43]
    ds_read_b64_tr_b16 v[150:151], v229 offset:23200
    v_mfma_f32_16x16x32_bf16 a[44:47], v[136:139], v[52:55], a[44:47]
    s_add_u32 s100, s69, 409600
    s_waitcnt lgkmcnt(4)
    v_mfma_f32_16x16x32_bf16 a[48:51], v[140:143], v[40:43], a[48:51]
    buffer_load_dwordx4 v[36:39], v3, s[64:67], s100 offen offset:3072 sc1
    v_mfma_f32_16x16x32_bf16 a[52:55], v[140:143], v[44:47], a[52:55]
    ds_read_b64_tr_b16 v[136:137], v229 offset:18624
    v_mfma_f32_16x16x32_bf16 a[56:59], v[140:143], v[48:51], a[56:59]
    ds_read_b64_tr_b16 v[138:139], v229 offset:23232
    v_mfma_f32_16x16x32_bf16 a[60:63], v[140:143], v[52:55], a[60:63]
    s_waitcnt lgkmcnt(4)
    v_mfma_f32_16x16x32_bf16 a[64:67], v[144:147], v[40:43], a[64:67]
    v_mfma_f32_16x16x32_bf16 a[68:71], v[144:147], v[44:47], a[68:71]
    ds_read_b64_tr_b16 v[140:141], v229 offset:18656
    v_mfma_f32_16x16x32_bf16 a[72:75], v[144:147], v[48:51], a[72:75]
    ds_read_b64_tr_b16 v[142:143], v229 offset:23264
    v_mfma_f32_16x16x32_bf16 a[76:79], v[144:147], v[52:55], a[76:79]
    s_waitcnt lgkmcnt(4)
    v_mfma_f32_16x16x32_bf16 a[80:83], v[148:151], v[40:43], a[80:83]
    v_mfma_f32_16x16x32_bf16 a[84:87], v[148:151], v[44:47], a[84:87]
    ds_read_b64_tr_b16 v[144:145], v229 offset:18688
    v_mfma_f32_16x16x32_bf16 a[88:91], v[148:151], v[48:51], a[88:91]
    ds_read_b64_tr_b16 v[146:147], v229 offset:23296
    v_mfma_f32_16x16x32_bf16 a[92:95], v[148:151], v[52:55], a[92:95]
    s_waitcnt lgkmcnt(4)
    v_mfma_f32_16x16x32_bf16 a[96:99], v[136:139], v[40:43], a[96:99]
    v_mfma_f32_16x16x32_bf16 a[100:103], v[136:139], v[44:47], a[100:103]
    ds_read_b64_tr_b16 v[148:149], v229 offset:27648
    v_mfma_f32_16x16x32_bf16 a[104:107], v[136:139], v[48:51], a[104:107]
    ds_read_b64_tr_b16 v[150:151], v229 offset:32256
    v_mfma_f32_16x16x32_bf16 a[108:111], v[136:139], v[52:55], a[108:111]
    s_waitcnt lgkmcnt(4)
    v_mfma_f32_16x16x32_bf16 a[112:115], v[140:143], v[40:43], a[112:115]
    v_mfma_f32_16x16x32_bf16 a[116:119], v[140:143], v[44:47], a[116:119]
    ds_read_b64_tr_b16 v[136:137], v229 offset:27680
    v_mfma_f32_16x16x32_bf16 a[120:123], v[140:143], v[48:51], a[120:123]
    ds_read_b64_tr_b16 v[138:139], v229 offset:32288
    v_mfma_f32_16x16x32_bf16 a[124:127], v[140:143], v[52:55], a[124:127]
    s_waitcnt lgkmcnt(4)
    v_mfma_f32_16x16x32_bf16 a[128:131], v[144:147], v[40:43], a[128:131]
    v_mfma_f32_16x16x32_bf16 a[132:135], v[144:147], v[44:47], a[132:135]
    ds_read_b64_tr_b16 v[140:141], v229 offset:27712
    v_mfma_f32_16x16x32_bf16 a[136:139], v[144:147], v[48:51], a[136:139]
    ds_read_b64_tr_b16 v[142:143], v229 offset:32320
    v_mfma_f32_16x16x32_bf16 a[140:143], v[144:147], v[52:55], a[140:143]
    s_add_u32 s100, s69, 425984
    s_waitcnt lgkmcnt(4)
    s_waitcnt vmcnt(51)
    v_mfma_f32_16x16x32_bf16 a[0:3], v[148:151], v[56:59], a[0:3]
    buffer_load_dwordx4 v[40:43], v3, s[64:67], s100 offen offset:0 sc1
    v_mfma_f32_16x16x32_bf16 a[4:7], v[148:151], v[60:63], a[4:7]
    ds_read_b64_tr_b16 v[144:145], v229 offset:27744
    v_mfma_f32_16x16x32_bf16 a[8:11], v[148:151], v[64:67], a[8:11]
    ds_read_b64_tr_b16 v[146:147], v229 offset:32352
    v_mfma_f32_16x16x32_bf16 a[12:15], v[148:151], v[68:71], a[12:15]
    s_add_u32 s100, s69, 425984
    s_waitcnt lgkmcnt(4)
    v_mfma_f32_16x16x32_bf16 a[16:19], v[136:139], v[56:59], a[16:19]
    buffer_load_dwordx4 v[44:47], v3, s[64:67], s100 offen offset:1024 sc1
    v_mfma_f32_16x16x32_bf16 a[20:23], v[136:139], v[60:63], a[20:23]
    ds_read_b64_tr_b16 v[148:149], v229 offset:27776
    v_mfma_f32_16x16x32_bf16 a[24:27], v[136:139], v[64:67], a[24:27]
    ds_read_b64_tr_b16 v[150:151], v229 offset:32384
    v_mfma_f32_16x16x32_bf16 a[28:31], v[136:139], v[68:71], a[28:31]
    s_add_u32 s100, s69, 425984
    s_waitcnt lgkmcnt(4)
    v_mfma_f32_16x16x32_bf16 a[32:35], v[140:143], v[56:59], a[32:35]
    buffer_load_dwordx4 v[48:51], v3, s[64:67], s100 offen offset:2048 sc1
    v_mfma_f32_16x16x32_bf16 a[36:39], v[140:143], v[60:63], a[36:39]
    ds_read_b64_tr_b16 v[136:137], v229 offset:27808
    v_mfma_f32_16x16x32_bf16 a[40:43], v[140:143], v[64:67], a[40:43]
    ds_read_b64_tr_b16 v[138:139], v229 offset:32416
    v_mfma_f32_16x16x32_bf16 a[44:47], v[140:143], v[68:71], a[44:47]
    s_add_u32 s100, s69, 425984
    s_waitcnt lgkmcnt(4)
    v_mfma_f32_16x16x32_bf16 a[48:51], v[144:147], v[56:59], a[48:51]
    buffer_load_dwordx4 v[52:55], v3, s[64:67], s100 offen offset:3072 sc1
    v_mfma_f32_16x16x32_bf16 a[52:55], v[144:147], v[60:63], a[52:55]
    ds_read_b64_tr_b16 v[140:141], v229 offset:27840
    v_mfma_f32_16x16x32_bf16 a[56:59], v[144:147], v[64:67], a[56:59]
    ds_read_b64_tr_b16 v[142:143], v229 offset:32448
    v_mfma_f32_16x16x32_bf16 a[60:63], v[144:147], v[68:71], a[60:63]
    s_waitcnt lgkmcnt(4)
    v_mfma_f32_16x16x32_bf16 a[64:67], v[148:151], v[56:59], a[64:67]
    v_mfma_f32_16x16x32_bf16 a[68:71], v[148:151], v[60:63], a[68:71]
    ds_read_b64_tr_b16 v[144:145], v229 offset:27872
    v_mfma_f32_16x16x32_bf16 a[72:75], v[148:151], v[64:67], a[72:75]
    ds_read_b64_tr_b16 v[146:147], v229 offset:32480
    v_mfma_f32_16x16x32_bf16 a[76:79], v[148:151], v[68:71], a[76:79]
    s_waitcnt lgkmcnt(4)
    v_mfma_f32_16x16x32_bf16 a[80:83], v[136:139], v[56:59], a[80:83]
    v_mfma_f32_16x16x32_bf16 a[84:87], v[136:139], v[60:63], a[84:87]
    ds_read_b64_tr_b16 v[148:149], v229 offset:27904
    v_mfma_f32_16x16x32_bf16 a[88:91], v[136:139], v[64:67], a[88:91]
    ds_read_b64_tr_b16 v[150:151], v229 offset:32512
    v_mfma_f32_16x16x32_bf16 a[92:95], v[136:139], v[68:71], a[92:95]
    s_waitcnt lgkmcnt(4)
    v_mfma_f32_16x16x32_bf16 a[96:99], v[140:143], v[56:59], a[96:99]
    s_waitcnt vmcnt(50)
    s_waitcnt lgkmcnt(0)
    s_barrier
    v_add_u32 v229, 36864, v228
    v_mfma_f32_16x16x32_bf16 a[100:103], v[140:143], v[60:63], a[100:103]
    ds_read_b64_tr_b16 v[136:137], v229 offset:0
    v_mfma_f32_16x16x32_bf16 a[104:107], v[140:143], v[64:67], a[104:107]
    ds_read_b64_tr_b16 v[138:139], v229 offset:4608
    v_mfma_f32_16x16x32_bf16 a[108:111], v[140:143], v[68:71], a[108:111]
    s_add_u32 s99, s68, 1179648
    s_add_u32 m0, s70, 0
    v_mfma_f32_16x16x32_bf16 a[112:115], v[144:147], v[56:59], a[112:115]
    buffer_load_dwordx4 v219, s[60:63], s99 offen offset:0 lds
    v_mfma_f32_16x16x32_bf16 a[116:119], v[144:147], v[60:63], a[116:119]
    ds_read_b64_tr_b16 v[140:141], v229 offset:32
    v_mfma_f32_16x16x32_bf16 a[120:123], v[144:147], v[64:67], a[120:123]
    ds_read_b64_tr_b16 v[142:143], v229 offset:4640
    v_mfma_f32_16x16x32_bf16 a[124:127], v[144:147], v[68:71], a[124:127]
    v_mfma_f32_16x16x32_bf16 a[128:131], v[148:151], v[56:59], a[128:131]
    buffer_load_dwordx4 v220, s[60:63], s99 offen offset:1024 lds
    v_mfma_f32_16x16x32_bf16 a[132:135], v[148:151], v[60:63], a[132:135]
    ds_read_b64_tr_b16 v[144:145], v229 offset:64
    v_mfma_f32_16x16x32_bf16 a[136:139], v[148:151], v[64:67], a[136:139]
    ds_read_b64_tr_b16 v[146:147], v229 offset:4672
    v_mfma_f32_16x16x32_bf16 a[140:143], v[148:151], v[68:71], a[140:143]
    s_add_u32 s100, s69, 442368
    s_waitcnt lgkmcnt(4)
    s_waitcnt vmcnt(48)
    v_mfma_f32_16x16x32_bf16 a[0:3], v[136:139], v[72:75], a[0:3]
    buffer_load_dwordx4 v[56:59], v3, s[64:67], s100 offen offset:0 sc1
    v_mfma_f32_16x16x32_bf16 a[4:7], v[136:139], v[76:79], a[4:7]
    ds_read_b64_tr_b16 v[148:149], v229 offset:96
    v_mfma_f32_16x16x32_bf16 a[8:11], v[136:139], v[80:83], a[8:11]
    ds_read_b64_tr_b16 v[150:151], v229 offset:4704
    v_mfma_f32_16x16x32_bf16 a[12:15], v[136:139], v[84:87], a[12:15]
    s_add_u32 s100, s69, 442368
    s_waitcnt lgkmcnt(4)
    v_mfma_f32_16x16x32_bf16 a[16:19], v[140:143], v[72:75], a[16:19]
    buffer_load_dwordx4 v[60:63], v3, s[64:67], s100 offen offset:1024 sc1
    v_mfma_f32_16x16x32_bf16 a[20:23], v[140:143], v[76:79], a[20:23]
    ds_read_b64_tr_b16 v[136:137], v229 offset:128
    v_mfma_f32_16x16x32_bf16 a[24:27], v[140:143], v[80:83], a[24:27]
    ds_read_b64_tr_b16 v[138:139], v229 offset:4736
    v_mfma_f32_16x16x32_bf16 a[28:31], v[140:143], v[84:87], a[28:31]
    s_add_u32 s100, s69, 442368
    s_waitcnt lgkmcnt(4)
    v_mfma_f32_16x16x32_bf16 a[32:35], v[144:147], v[72:75], a[32:35]
    buffer_load_dwordx4 v[64:67], v3, s[64:67], s100 offen offset:2048 sc1
    v_mfma_f32_16x16x32_bf16 a[36:39], v[144:147], v[76:79], a[36:39]
    ds_read_b64_tr_b16 v[140:141], v229 offset:160
    v_mfma_f32_16x16x32_bf16 a[40:43], v[144:147], v[80:83], a[40:43]
    ds_read_b64_tr_b16 v[142:143], v229 offset:4768
    v_mfma_f32_16x16x32_bf16 a[44:47], v[144:147], v[84:87], a[44:47]
    s_add_u32 s100, s69, 442368
    s_waitcnt lgkmcnt(4)
    v_mfma_f32_16x16x32_bf16 a[48:51], v[148:151], v[72:75], a[48:51]
    buffer_load_dwordx4 v[68:71], v3, s[64:67], s100 offen offset:3072 sc1
    v_mfma_f32_16x16x32_bf16 a[52:55], v[148:151], v[76:79], a[52:55]
    ds_read_b64_tr_b16 v[144:145], v229 offset:192
    v_mfma_f32_16x16x32_bf16 a[56:59], v[148:151], v[80:83], a[56:59]
    ds_read_b64_tr_b16 v[146:147], v229 offset:4800
    v_mfma_f32_16x16x32_bf16 a[60:63], v[148:151], v[84:87], a[60:63]
    s_waitcnt lgkmcnt(4)
    v_mfma_f32_16x16x32_bf16 a[64:67], v[136:139], v[72:75], a[64:67]
    buffer_load_dwordx4 v221, s[60:63], s99 offen offset:2048 lds
    v_mfma_f32_16x16x32_bf16 a[68:71], v[136:139], v[76:79], a[68:71]
    ds_read_b64_tr_b16 v[148:149], v229 offset:224
    v_mfma_f32_16x16x32_bf16 a[72:75], v[136:139], v[80:83], a[72:75]
    ds_read_b64_tr_b16 v[150:151], v229 offset:4832
    v_mfma_f32_16x16x32_bf16 a[76:79], v[136:139], v[84:87], a[76:79]
    s_waitcnt lgkmcnt(4)
    v_mfma_f32_16x16x32_bf16 a[80:83], v[140:143], v[72:75], a[80:83]
    buffer_load_dwordx4 v222, s[60:63], s99 offen offset:3072 lds
    v_mfma_f32_16x16x32_bf16 a[84:87], v[140:143], v[76:79], a[84:87]
    ds_read_b64_tr_b16 v[136:137], v229 offset:256
    v_mfma_f32_16x16x32_bf16 a[88:91], v[140:143], v[80:83], a[88:91]
    ds_read_b64_tr_b16 v[138:139], v229 offset:4864
    v_mfma_f32_16x16x32_bf16 a[92:95], v[140:143], v[84:87], a[92:95]
    s_add_u32 m0, s70, 4096
    s_waitcnt lgkmcnt(4)
    v_mfma_f32_16x16x32_bf16 a[96:99], v[144:147], v[72:75], a[96:99]
    buffer_load_dwordx4 v223, s[60:63], s99 offen offset:0 lds
    v_mfma_f32_16x16x32_bf16 a[100:103], v[144:147], v[76:79], a[100:103]
    ds_read_b64_tr_b16 v[140:141], v229 offset:9216
    v_mfma_f32_16x16x32_bf16 a[104:107], v[144:147], v[80:83], a[104:107]
    ds_read_b64_tr_b16 v[142:143], v229 offset:13824
    v_mfma_f32_16x16x32_bf16 a[108:111], v[144:147], v[84:87], a[108:111]
    s_waitcnt lgkmcnt(4)
    v_mfma_f32_16x16x32_bf16 a[112:115], v[148:151], v[72:75], a[112:115]
    buffer_load_dwordx4 v224, s[60:63], s99 offen offset:1024 lds
    v_mfma_f32_16x16x32_bf16 a[116:119], v[148:151], v[76:79], a[116:119]
    ds_read_b64_tr_b16 v[144:145], v229 offset:9248
    v_mfma_f32_16x16x32_bf16 a[120:123], v[148:151], v[80:83], a[120:123]
    ds_read_b64_tr_b16 v[146:147], v229 offset:13856
    v_mfma_f32_16x16x32_bf16 a[124:127], v[148:151], v[84:87], a[124:127]
    s_waitcnt lgkmcnt(4)
    v_mfma_f32_16x16x32_bf16 a[128:131], v[136:139], v[72:75], a[128:131]
    buffer_load_dwordx4 v225, s[60:63], s99 offen offset:2048 lds
    v_mfma_f32_16x16x32_bf16 a[132:135], v[136:139], v[76:79], a[132:135]
    ds_read_b64_tr_b16 v[148:149], v229 offset:9280
    v_mfma_f32_16x16x32_bf16 a[136:139], v[136:139], v[80:83], a[136:139]
    ds_read_b64_tr_b16 v[150:151], v229 offset:13888
    v_mfma_f32_16x16x32_bf16 a[140:143], v[136:139], v[84:87], a[140:143]
    s_add_u32 s100, s69, 458752
    s_waitcnt lgkmcnt(4)
    s_waitcnt vmcnt(48)
    v_mfma_f32_16x16x32_bf16 a[0:3], v[140:143], v[88:91], a[0:3]
    buffer_load_dwordx4 v[72:75], v3, s[64:67], s100 offen offset:0 sc1
    v_mfma_f32_16x16x32_bf16 a[4:7], v[140:143], v[92:95], a[4:7]
    ds_read_b64_tr_b16 v[136:137], v229 offset:9312
    v_mfma_f32_16x16x32_bf16 a[8:11], v[140:143], v[96:99], a[8:11]
    ds_read_b64_tr_b16 v[138:139], v229 offset:13920
    v_mfma_f32_16x16x32_bf16 a[12:15], v[140:143], v[100:103], a[12:15]
    s_add_u32 s100, s69, 458752
    s_waitcnt lgkmcnt(4)
    v_mfma_f32_16x16x32_bf16 a[16:19], v[144:147], v[88:91], a[16:19]
    buffer_load_dwordx4 v[76:79], v3, s[64:67], s100 offen offset:1024 sc1
    v_mfma_f32_16x16x32_bf16 a[20:23], v[144:147], v[92:95], a[20:23]
    ds_read_b64_tr_b16 v[140:141], v229 offset:9344
    v_mfma_f32_16x16x32_bf16 a[24:27], v[144:147], v[96:99], a[24:27]
    ds_read_b64_tr_b16 v[142:143], v229 offset:13952
    v_mfma_f32_16x16x32_bf16 a[28:31], v[144:147], v[100:103], a[28:31]
    s_add_u32 s100, s69, 458752
    s_waitcnt lgkmcnt(4)
    v_mfma_f32_16x16x32_bf16 a[32:35], v[148:151], v[88:91], a[32:35]
    buffer_load_dwordx4 v[80:83], v3, s[64:67], s100 offen offset:2048 sc1
    v_mfma_f32_16x16x32_bf16 a[36:39], v[148:151], v[92:95], a[36:39]
    ds_read_b64_tr_b16 v[144:145], v229 offset:9376
    v_mfma_f32_16x16x32_bf16 a[40:43], v[148:151], v[96:99], a[40:43]
    ds_read_b64_tr_b16 v[146:147], v229 offset:13984
    v_mfma_f32_16x16x32_bf16 a[44:47], v[148:151], v[100:103], a[44:47]
    s_add_u32 s100, s69, 458752
    s_waitcnt lgkmcnt(4)
    v_mfma_f32_16x16x32_bf16 a[48:51], v[136:139], v[88:91], a[48:51]
    buffer_load_dwordx4 v[84:87], v3, s[64:67], s100 offen offset:3072 sc1
    v_mfma_f32_16x16x32_bf16 a[52:55], v[136:139], v[92:95], a[52:55]
    ds_read_b64_tr_b16 v[148:149], v229 offset:9408
    v_mfma_f32_16x16x32_bf16 a[56:59], v[136:139], v[96:99], a[56:59]
    ds_read_b64_tr_b16 v[150:151], v229 offset:14016
    v_mfma_f32_16x16x32_bf16 a[60:63], v[136:139], v[100:103], a[60:63]
    s_waitcnt lgkmcnt(4)
    v_mfma_f32_16x16x32_bf16 a[64:67], v[140:143], v[88:91], a[64:67]
    buffer_load_dwordx4 v226, s[60:63], s99 offen offset:3072 lds
    v_mfma_f32_16x16x32_bf16 a[68:71], v[140:143], v[92:95], a[68:71]
    ds_read_b64_tr_b16 v[136:137], v229 offset:9440
    v_mfma_f32_16x16x32_bf16 a[72:75], v[140:143], v[96:99], a[72:75]
    ds_read_b64_tr_b16 v[138:139], v229 offset:14048
    v_mfma_f32_16x16x32_bf16 a[76:79], v[140:143], v[100:103], a[76:79]
    s_add_u32 m0, s70, 8192
    s_waitcnt lgkmcnt(4)
    v_mfma_f32_16x16x32_bf16 a[80:83], v[144:147], v[88:91], a[80:83]
    buffer_load_dwordx4 v227, s[60:63], s99 offen offset:0 lds
    v_mfma_f32_16x16x32_bf16 a[84:87], v[144:147], v[92:95], a[84:87]
    ds_read_b64_tr_b16 v[140:141], v229 offset:9472
    v_mfma_f32_16x16x32_bf16 a[88:91], v[144:147], v[96:99], a[88:91]
    ds_read_b64_tr_b16 v[142:143], v229 offset:14080
    v_mfma_f32_16x16x32_bf16 a[92:95], v[144:147], v[100:103], a[92:95]
    s_waitcnt lgkmcnt(4)
    v_mfma_f32_16x16x32_bf16 a[96:99], v[148:151], v[88:91], a[96:99]
    v_mfma_f32_16x16x32_bf16 a[100:103], v[148:151], v[92:95], a[100:103]
    ds_read_b64_tr_b16 v[144:145], v229 offset:18432
    v_mfma_f32_16x16x32_bf16 a[104:107], v[148:151], v[96:99], a[104:107]
    ds_read_b64_tr_b16 v[146:147], v229 offset:23040
    v_mfma_f32_16x16x32_bf16 a[108:111], v[148:151], v[100:103], a[108:111]
    s_waitcnt lgkmcnt(4)
    v_mfma_f32_16x16x32_bf16 a[112:115], v[136:139], v[88:91], a[112:115]
    v_mfma_f32_16x16x32_bf16 a[116:119], v[136:139], v[92:95], a[116:119]
    ds_read_b64_tr_b16 v[148:149], v229 offset:18464
    v_mfma_f32_16x16x32_bf16 a[120:123], v[136:139], v[96:99], a[120:123]
    ds_read_b64_tr_b16 v[150:151], v229 offset:23072
    v_mfma_f32_16x16x32_bf16 a[124:127], v[136:139], v[100:103], a[124:127]
    s_waitcnt lgkmcnt(4)
    v_mfma_f32_16x16x32_bf16 a[128:131], v[140:143], v[88:91], a[128:131]
    v_mfma_f32_16x16x32_bf16 a[132:135], v[140:143], v[92:95], a[132:135]
    ds_read_b64_tr_b16 v[136:137], v229 offset:18496
    v_mfma_f32_16x16x32_bf16 a[136:139], v[140:143], v[96:99], a[136:139]
    ds_read_b64_tr_b16 v[138:139], v229 offset:23104
    v_mfma_f32_16x16x32_bf16 a[140:143], v[140:143], v[100:103], a[140:143]
    s_add_u32 s100, s69, 475136
    s_waitcnt lgkmcnt(4)
    s_waitcnt vmcnt(42)
    v_mfma_f32_16x16x32_bf16 a[0:3], v[144:147], v[104:107], a[0:3]
    buffer_load_dwordx4 v[88:91], v3, s[64:67], s100 offen offset:0 sc1
    v_mfma_f32_16x16x32_bf16 a[4:7], v[144:147], v[108:111], a[4:7]
    ds_read_b64_tr_b16 v[140:141], v229 offset:18528
    v_mfma_f32_16x16x32_bf16 a[8:11], v[144:147], v[112:115], a[8:11]
    ds_read_b64_tr_b16 v[142:143], v229 offset:23136
    v_mfma_f32_16x16x32_bf16 a[12:15], v[144:147], v[116:119], a[12:15]
    s_add_u32 s100, s69, 475136
    s_waitcnt lgkmcnt(4)
    v_mfma_f32_16x16x32_bf16 a[16:19], v[148:151], v[104:107], a[16:19]
    buffer_load_dwordx4 v[92:95], v3, s[64:67], s100 offen offset:1024 sc1
    v_mfma_f32_16x16x32_bf16 a[20:23], v[148:151], v[108:111], a[20:23]
    ds_read_b64_tr_b16 v[144:145], v229 offset:18560
    v_mfma_f32_16x16x32_bf16 a[24:27], v[148:151], v[112:115], a[24:27]
    ds_read_b64_tr_b16 v[146:147], v229 offset:23168
    v_mfma_f32_16x16x32_bf16 a[28:31], v[148:151], v[116:119], a[28:31]
    s_add_u32 s100, s69, 475136
    s_waitcnt lgkmcnt(4)
    v_mfma_f32_16x16x32_bf16 a[32:35], v[136:139], v[104:107], a[32:35]
    buffer_load_dwordx4 v[96:99], v3, s[64:67], s100 offen offset:2048 sc1
    v_mfma_f32_16x16x32_bf16 a[36:39], v[136:139], v[108:111], a[36:39]
    ds_read_b64_tr_b16 v[148:149], v229 offset:18592
    v_mfma_f32_16x16x32_bf16 a[40:43], v[136:139], v[112:115], a[40:43]
    ds_read_b64_tr_b16 v[150:151], v229 offset:23200
    v_mfma_f32_16x16x32_bf16 a[44:47], v[136:139], v[116:119], a[44:47]
    s_add_u32 s100, s69, 475136
    s_waitcnt lgkmcnt(4)
    v_mfma_f32_16x16x32_bf16 a[48:51], v[140:143], v[104:107], a[48:51]
    buffer_load_dwordx4 v[100:103], v3, s[64:67], s100 offen offset:3072 sc1
    v_mfma_f32_16x16x32_bf16 a[52:55], v[140:143], v[108:111], a[52:55]
    ds_read_b64_tr_b16 v[136:137], v229 offset:18624
    v_mfma_f32_16x16x32_bf16 a[56:59], v[140:143], v[112:115], a[56:59]
    ds_read_b64_tr_b16 v[138:139], v229 offset:23232
    v_mfma_f32_16x16x32_bf16 a[60:63], v[140:143], v[116:119], a[60:63]
    s_waitcnt lgkmcnt(4)
    v_mfma_f32_16x16x32_bf16 a[64:67], v[144:147], v[104:107], a[64:67]
    v_mfma_f32_16x16x32_bf16 a[68:71], v[144:147], v[108:111], a[68:71]
    ds_read_b64_tr_b16 v[140:141], v229 offset:18656
    v_mfma_f32_16x16x32_bf16 a[72:75], v[144:147], v[112:115], a[72:75]
    ds_read_b64_tr_b16 v[142:143], v229 offset:23264
    v_mfma_f32_16x16x32_bf16 a[76:79], v[144:147], v[116:119], a[76:79]
    s_waitcnt lgkmcnt(4)
    v_mfma_f32_16x16x32_bf16 a[80:83], v[148:151], v[104:107], a[80:83]
    v_mfma_f32_16x16x32_bf16 a[84:87], v[148:151], v[108:111], a[84:87]
    ds_read_b64_tr_b16 v[144:145], v229 offset:18688
    v_mfma_f32_16x16x32_bf16 a[88:91], v[148:151], v[112:115], a[88:91]
    ds_read_b64_tr_b16 v[146:147], v229 offset:23296
    v_mfma_f32_16x16x32_bf16 a[92:95], v[148:151], v[116:119], a[92:95]
    s_waitcnt lgkmcnt(4)
    v_mfma_f32_16x16x32_bf16 a[96:99], v[136:139], v[104:107], a[96:99]
    v_mfma_f32_16x16x32_bf16 a[100:103], v[136:139], v[108:111], a[100:103]
    ds_read_b64_tr_b16 v[148:149], v229 offset:27648
    v_mfma_f32_16x16x32_bf16 a[104:107], v[136:139], v[112:115], a[104:107]
    ds_read_b64_tr_b16 v[150:151], v229 offset:32256
    v_mfma_f32_16x16x32_bf16 a[108:111], v[136:139], v[116:119], a[108:111]
    s_waitcnt lgkmcnt(4)
    v_mfma_f32_16x16x32_bf16 a[112:115], v[140:143], v[104:107], a[112:115]
    v_mfma_f32_16x16x32_bf16 a[116:119], v[140:143], v[108:111], a[116:119]
    ds_read_b64_tr_b16 v[136:137], v229 offset:27680
    v_mfma_f32_16x16x32_bf16 a[120:123], v[140:143], v[112:115], a[120:123]
    ds_read_b64_tr_b16 v[138:139], v229 offset:32288
    v_mfma_f32_16x16x32_bf16 a[124:127], v[140:143], v[116:119], a[124:127]
    s_waitcnt lgkmcnt(4)
    v_mfma_f32_16x16x32_bf16 a[128:131], v[144:147], v[104:107], a[128:131]
    v_mfma_f32_16x16x32_bf16 a[132:135], v[144:147], v[108:111], a[132:135]
    ds_read_b64_tr_b16 v[140:141], v229 offset:27712
    v_mfma_f32_16x16x32_bf16 a[136:139], v[144:147], v[112:115], a[136:139]
    ds_read_b64_tr_b16 v[142:143], v229 offset:32320
    v_mfma_f32_16x16x32_bf16 a[140:143], v[144:147], v[116:119], a[140:143]
    s_add_u32 s100, s69, 491520
    s_waitcnt lgkmcnt(4)
    s_waitcnt vmcnt(41)
    v_mfma_f32_16x16x32_bf16 a[0:3], v[148:151], v[120:123], a[0:3]
    buffer_load_dwordx4 v[104:107], v3, s[64:67], s100 offen offset:0 sc1
    v_mfma_f32_16x16x32_bf16 a[4:7], v[148:151], v[124:127], a[4:7]
    ds_read_b64_tr_b16 v[144:145], v229 offset:27744
    v_mfma_f32_16x16x32_bf16 a[8:11], v[148:151], v[128:131], a[8:11]
    ds_read_b64_tr_b16 v[146:147], v229 offset:32352
    v_mfma_f32_16x16x32_bf16 a[12:15], v[148:151], v[132:135], a[12:15]
    s_add_u32 s100, s69, 491520
    s_waitcnt lgkmcnt(4)
    v_mfma_f32_16x16x32_bf16 a[16:19], v[136:139], v[120:123], a[16:19]
    buffer_load_dwordx4 v[108:111], v3, s[64:67], s100 offen offset:1024 sc1
    v_mfma_f32_16x16x32_bf16 a[20:23], v[136:139], v[124:127], a[20:23]
    ds_read_b64_tr_b16 v[148:149], v229 offset:27776
    v_mfma_f32_16x16x32_bf16 a[24:27], v[136:139], v[128:131], a[24:27]
    ds_read_b64_tr_b16 v[150:151], v229 offset:32384
    v_mfma_f32_16x16x32_bf16 a[28:31], v[136:139], v[132:135], a[28:31]
    s_add_u32 s100, s69, 491520
    s_waitcnt lgkmcnt(4)
    v_mfma_f32_16x16x32_bf16 a[32:35], v[140:143], v[120:123], a[32:35]
    buffer_load_dwordx4 v[112:115], v3, s[64:67], s100 offen offset:2048 sc1
    v_mfma_f32_16x16x32_bf16 a[36:39], v[140:143], v[124:127], a[36:39]
    ds_read_b64_tr_b16 v[136:137], v229 offset:27808
    v_mfma_f32_16x16x32_bf16 a[40:43], v[140:143], v[128:131], a[40:43]
    ds_read_b64_tr_b16 v[138:139], v229 offset:32416
    v_mfma_f32_16x16x32_bf16 a[44:47], v[140:143], v[132:135], a[44:47]
    s_add_u32 s100, s69, 491520
    s_waitcnt lgkmcnt(4)
    v_mfma_f32_16x16x32_bf16 a[48:51], v[144:147], v[120:123], a[48:51]
    buffer_load_dwordx4 v[116:119], v3, s[64:67], s100 offen offset:3072 sc1
    v_mfma_f32_16x16x32_bf16 a[52:55], v[144:147], v[124:127], a[52:55]
    ds_read_b64_tr_b16 v[140:141], v229 offset:27840
    v_mfma_f32_16x16x32_bf16 a[56:59], v[144:147], v[128:131], a[56:59]
    ds_read_b64_tr_b16 v[142:143], v229 offset:32448
    v_mfma_f32_16x16x32_bf16 a[60:63], v[144:147], v[132:135], a[60:63]
    s_waitcnt lgkmcnt(4)
    v_mfma_f32_16x16x32_bf16 a[64:67], v[148:151], v[120:123], a[64:67]
    v_mfma_f32_16x16x32_bf16 a[68:71], v[148:151], v[124:127], a[68:71]
    ds_read_b64_tr_b16 v[144:145], v229 offset:27872
    v_mfma_f32_16x16x32_bf16 a[72:75], v[148:151], v[128:131], a[72:75]
    ds_read_b64_tr_b16 v[146:147], v229 offset:32480
    v_mfma_f32_16x16x32_bf16 a[76:79], v[148:151], v[132:135], a[76:79]
    s_waitcnt lgkmcnt(4)
    v_mfma_f32_16x16x32_bf16 a[80:83], v[136:139], v[120:123], a[80:83]
    v_mfma_f32_16x16x32_bf16 a[84:87], v[136:139], v[124:127], a[84:87]
    ds_read_b64_tr_b16 v[148:149], v229 offset:27904
    v_mfma_f32_16x16x32_bf16 a[88:91], v[136:139], v[128:131], a[88:91]
    ds_read_b64_tr_b16 v[150:151], v229 offset:32512
    v_mfma_f32_16x16x32_bf16 a[92:95], v[136:139], v[132:135], a[92:95]
    s_waitcnt lgkmcnt(4)
    v_mfma_f32_16x16x32_bf16 a[96:99], v[140:143], v[120:123], a[96:99]
    s_waitcnt lgkmcnt(0)
    s_barrier
    v_add_u32 v229, 73728, v228
    v_mfma_f32_16x16x32_bf16 a[100:103], v[140:143], v[124:127], a[100:103]
    ds_read_b64_tr_b16 v[136:137], v229 offset:0
    v_mfma_f32_16x16x32_bf16 a[104:107], v[140:143], v[128:131], a[104:107]
    ds_read_b64_tr_b16 v[138:139], v229 offset:4608
    v_mfma_f32_16x16x32_bf16 a[108:111], v[140:143], v[132:135], a[108:111]
    v_mfma_f32_16x16x32_bf16 a[112:115], v[144:147], v[120:123], a[112:115]
    v_mfma_f32_16x16x32_bf16 a[116:119], v[144:147], v[124:127], a[116:119]
    ds_read_b64_tr_b16 v[140:141], v229 offset:32
    v_mfma_f32_16x16x32_bf16 a[120:123], v[144:147], v[128:131], a[120:123]
    ds_read_b64_tr_b16 v[142:143], v229 offset:4640
    v_mfma_f32_16x16x32_bf16 a[124:127], v[144:147], v[132:135], a[124:127]
    v_mfma_f32_16x16x32_bf16 a[128:131], v[148:151], v[120:123], a[128:131]
    v_mfma_f32_16x16x32_bf16 a[132:135], v[148:151], v[124:127], a[132:135]
    ds_read_b64_tr_b16 v[144:145], v229 offset:64
    v_mfma_f32_16x16x32_bf16 a[136:139], v[148:151], v[128:131], a[136:139]
    ds_read_b64_tr_b16 v[146:147], v229 offset:4672
    v_mfma_f32_16x16x32_bf16 a[140:143], v[148:151], v[132:135], a[140:143]
    s_add_u32 s100, s69, 507904
    s_waitcnt lgkmcnt(4)
    s_waitcnt vmcnt(36)
    v_mfma_f32_16x16x32_bf16 a[0:3], v[136:139], v[8:11], a[0:3]
    buffer_load_dwordx2 v[120:121], v232, s[64:67], s100 offen offset:0 sc1
    v_mfma_f32_16x16x32_bf16 a[4:7], v[136:139], v[12:15], a[4:7]
    ds_read_b64_tr_b16 v[148:149], v229 offset:96
    v_mfma_f32_16x16x32_bf16 a[8:11], v[136:139], v[16:19], a[8:11]
    ds_read_b64_tr_b16 v[150:151], v229 offset:4704
    v_mfma_f32_16x16x32_bf16 a[12:15], v[136:139], v[20:23], a[12:15]
    s_add_u32 s100, s69, 507904
    s_waitcnt lgkmcnt(4)
    v_mfma_f32_16x16x32_bf16 a[16:19], v[140:143], v[8:11], a[16:19]
    buffer_load_dwordx2 v[122:123], v232, s[64:67], s100 offen offset:512 sc1
    v_mfma_f32_16x16x32_bf16 a[20:23], v[140:143], v[12:15], a[20:23]
    ds_read_b64_tr_b16 v[136:137], v229 offset:128
    v_mfma_f32_16x16x32_bf16 a[24:27], v[140:143], v[16:19], a[24:27]
    ds_read_b64_tr_b16 v[138:139], v229 offset:4736
    v_mfma_f32_16x16x32_bf16 a[28:31], v[140:143], v[20:23], a[28:31]
    s_add_u32 s100, s69, 507904
    s_waitcnt lgkmcnt(4)
    v_mfma_f32_16x16x32_bf16 a[32:35], v[144:147], v[8:11], a[32:35]
    buffer_load_dwordx2 v[124:125], v232, s[64:67], s100 offen offset:1024 sc1
    v_mfma_f32_16x16x32_bf16 a[36:39], v[144:147], v[12:15], a[36:39]
    ds_read_b64_tr_b16 v[140:141], v229 offset:160
    v_mfma_f32_16x16x32_bf16 a[40:43], v[144:147], v[16:19], a[40:43]
    ds_read_b64_tr_b16 v[142:143], v229 offset:4768
    v_mfma_f32_16x16x32_bf16 a[44:47], v[144:147], v[20:23], a[44:47]
    s_add_u32 s100, s69, 507904
    s_waitcnt lgkmcnt(4)
    v_mfma_f32_16x16x32_bf16 a[48:51], v[148:151], v[8:11], a[48:51]
    buffer_load_dwordx2 v[126:127], v232, s[64:67], s100 offen offset:1536 sc1
    v_mfma_f32_16x16x32_bf16 a[52:55], v[148:151], v[12:15], a[52:55]
    ds_read_b64_tr_b16 v[144:145], v229 offset:192
    v_mfma_f32_16x16x32_bf16 a[56:59], v[148:151], v[16:19], a[56:59]
    ds_read_b64_tr_b16 v[146:147], v229 offset:4800
    v_mfma_f32_16x16x32_bf16 a[60:63], v[148:151], v[20:23], a[60:63]
    s_add_u32 s100, s69, 507904
    s_waitcnt lgkmcnt(4)
    v_mfma_f32_16x16x32_bf16 a[64:67], v[136:139], v[8:11], a[64:67]
    buffer_load_dwordx2 v[128:129], v232, s[64:67], s100 offen offset:2048 sc1
    v_mfma_f32_16x16x32_bf16 a[68:71], v[136:139], v[12:15], a[68:71]
    ds_read_b64_tr_b16 v[148:149], v229 offset:224
    v_mfma_f32_16x16x32_bf16 a[72:75], v[136:139], v[16:19], a[72:75]
    ds_read_b64_tr_b16 v[150:151], v229 offset:4832
    v_mfma_f32_16x16x32_bf16 a[76:79], v[136:139], v[20:23], a[76:79]
    s_add_u32 s100, s69, 507904
    s_waitcnt lgkmcnt(4)
    v_mfma_f32_16x16x32_bf16 a[80:83], v[140:143], v[8:11], a[80:83]
    buffer_load_dwordx2 v[130:131], v232, s[64:67], s100 offen offset:2560 sc1
    v_mfma_f32_16x16x32_bf16 a[84:87], v[140:143], v[12:15], a[84:87]
    ds_read_b64_tr_b16 v[136:137], v229 offset:256
    v_mfma_f32_16x16x32_bf16 a[88:91], v[140:143], v[16:19], a[88:91]
    ds_read_b64_tr_b16 v[138:139], v229 offset:4864
    v_mfma_f32_16x16x32_bf16 a[92:95], v[140:143], v[20:23], a[92:95]
    s_add_u32 s100, s69, 507904
    s_waitcnt lgkmcnt(4)
    v_mfma_f32_16x16x32_bf16 a[96:99], v[144:147], v[8:11], a[96:99]
    buffer_load_dwordx2 v[132:133], v232, s[64:67], s100 offen offset:3072 sc1
    v_mfma_f32_16x16x32_bf16 a[100:103], v[144:147], v[12:15], a[100:103]
    ds_read_b64_tr_b16 v[140:141], v229 offset:9216
    v_mfma_f32_16x16x32_bf16 a[104:107], v[144:147], v[16:19], a[104:107]
    ds_read_b64_tr_b16 v[142:143], v229 offset:13824
    v_mfma_f32_16x16x32_bf16 a[108:111], v[144:147], v[20:23], a[108:111]
    s_add_u32 s100, s69, 507904
    s_waitcnt lgkmcnt(4)
    v_mfma_f32_16x16x32_bf16 a[112:115], v[148:151], v[8:11], a[112:115]
    buffer_load_dwordx2 v[134:135], v232, s[64:67], s100 offen offset:3584 sc1
    v_mfma_f32_16x16x32_bf16 a[116:119], v[148:151], v[12:15], a[116:119]
    ds_read_b64_tr_b16 v[144:145], v229 offset:9248
    v_mfma_f32_16x16x32_bf16 a[120:123], v[148:151], v[16:19], a[120:123]
    ds_read_b64_tr_b16 v[146:147], v229 offset:13856
    v_mfma_f32_16x16x32_bf16 a[124:127], v[148:151], v[20:23], a[124:127]
    s_waitcnt lgkmcnt(4)
    v_mfma_f32_16x16x32_bf16 a[128:131], v[136:139], v[8:11], a[128:131]
    v_mfma_f32_16x16x32_bf16 a[132:135], v[136:139], v[12:15], a[132:135]
    ds_read_b64_tr_b16 v[148:149], v229 offset:9280
    v_mfma_f32_16x16x32_bf16 a[136:139], v[136:139], v[16:19], a[136:139]
    ds_read_b64_tr_b16 v[150:151], v229 offset:13888
    v_mfma_f32_16x16x32_bf16 a[140:143], v[136:139], v[20:23], a[140:143]
    s_add_u32 s100, s69, 524288
    s_waitcnt lgkmcnt(4)
    s_waitcnt vmcnt(37)
    v_mfma_f32_16x16x32_bf16 a[0:3], v[140:143], v[24:27], a[0:3]
    buffer_load_dwordx4 v[8:11], v3, s[64:67], s100 offen offset:0 sc1
    v_mfma_f32_16x16x32_bf16 a[4:7], v[140:143], v[28:31], a[4:7]
    ds_read_b64_tr_b16 v[136:137], v229 offset:9312
    v_mfma_f32_16x16x32_bf16 a[8:11], v[140:143], v[32:35], a[8:11]
    ds_read_b64_tr_b16 v[138:139], v229 offset:13920
    v_mfma_f32_16x16x32_bf16 a[12:15], v[140:143], v[36:39], a[12:15]
    s_add_u32 s100, s69, 524288
    s_waitcnt lgkmcnt(4)
    v_mfma_f32_16x16x32_bf16 a[16:19], v[144:147], v[24:27], a[16:19]
    buffer_load_dwordx4 v[12:15], v3, s[64:67], s100 offen offset:1024 sc1
    v_mfma_f32_16x16x32_bf16 a[20:23], v[144:147], v[28:31], a[20:23]
    ds_read_b64_tr_b16 v[140:141], v229 offset:9344
    v_mfma_f32_16x16x32_bf16 a[24:27], v[144:147], v[32:35], a[24:27]
    ds_read_b64_tr_b16 v[142:143], v229 offset:13952
    v_mfma_f32_16x16x32_bf16 a[28:31], v[144:147], v[36:39], a[28:31]
    s_add_u32 s100, s69, 524288
    s_waitcnt lgkmcnt(4)
    v_mfma_f32_16x16x32_bf16 a[32:35], v[148:151], v[24:27], a[32:35]
    buffer_load_dwordx4 v[16:19], v3, s[64:67], s100 offen offset:2048 sc1
    v_mfma_f32_16x16x32_bf16 a[36:39], v[148:151], v[28:31], a[36:39]
    ds_read_b64_tr_b16 v[144:145], v229 offset:9376
    v_mfma_f32_16x16x32_bf16 a[40:43], v[148:151], v[32:35], a[40:43]
    ds_read_b64_tr_b16 v[146:147], v229 offset:13984
    v_mfma_f32_16x16x32_bf16 a[44:47], v[148:151], v[36:39], a[44:47]
    s_add_u32 s100, s69, 524288
    s_waitcnt lgkmcnt(4)
    v_mfma_f32_16x16x32_bf16 a[48:51], v[136:139], v[24:27], a[48:51]
    buffer_load_dwordx4 v[20:23], v3, s[64:67], s100 offen offset:3072 sc1
    v_mfma_f32_16x16x32_bf16 a[52:55], v[136:139], v[28:31], a[52:55]
    ds_read_b64_tr_b16 v[148:149], v229 offset:9408
    v_mfma_f32_16x16x32_bf16 a[56:59], v[136:139], v[32:35], a[56:59]
    ds_read_b64_tr_b16 v[150:151], v229 offset:14016
    v_mfma_f32_16x16x32_bf16 a[60:63], v[136:139], v[36:39], a[60:63]
    s_waitcnt lgkmcnt(4)
    v_mfma_f32_16x16x32_bf16 a[64:67], v[140:143], v[24:27], a[64:67]
    v_mfma_f32_16x16x32_bf16 a[68:71], v[140:143], v[28:31], a[68:71]
    ds_read_b64_tr_b16 v[136:137], v229 offset:9440
    v_mfma_f32_16x16x32_bf16 a[72:75], v[140:143], v[32:35], a[72:75]
    ds_read_b64_tr_b16 v[138:139], v229 offset:14048
    v_mfma_f32_16x16x32_bf16 a[76:79], v[140:143], v[36:39], a[76:79]
    s_waitcnt lgkmcnt(4)
    v_mfma_f32_16x16x32_bf16 a[80:83], v[144:147], v[24:27], a[80:83]
    v_mfma_f32_16x16x32_bf16 a[84:87], v[144:147], v[28:31], a[84:87]
    ds_read_b64_tr_b16 v[140:141], v229 offset:9472
    v_mfma_f32_16x16x32_bf16 a[88:91], v[144:147], v[32:35], a[88:91]
    ds_read_b64_tr_b16 v[142:143], v229 offset:14080
    v_mfma_f32_16x16x32_bf16 a[92:95], v[144:147], v[36:39], a[92:95]
    s_waitcnt lgkmcnt(4)
    v_mfma_f32_16x16x32_bf16 a[96:99], v[148:151], v[24:27], a[96:99]
    v_mfma_f32_16x16x32_bf16 a[100:103], v[148:151], v[28:31], a[100:103]
    ds_read_b64_tr_b16 v[144:145], v229 offset:18432
    v_mfma_f32_16x16x32_bf16 a[104:107], v[148:151], v[32:35], a[104:107]
    ds_read_b64_tr_b16 v[146:147], v229 offset:23040
    v_mfma_f32_16x16x32_bf16 a[108:111], v[148:151], v[36:39], a[108:111]
    s_waitcnt lgkmcnt(4)
    v_mfma_f32_16x16x32_bf16 a[112:115], v[136:139], v[24:27], a[112:115]
    v_mfma_f32_16x16x32_bf16 a[116:119], v[136:139], v[28:31], a[116:119]
    ds_read_b64_tr_b16 v[148:149], v229 offset:18464
    v_mfma_f32_16x16x32_bf16 a[120:123], v[136:139], v[32:35], a[120:123]
    ds_read_b64_tr_b16 v[150:151], v229 offset:23072
    v_mfma_f32_16x16x32_bf16 a[124:127], v[136:139], v[36:39], a[124:127]
    s_waitcnt lgkmcnt(4)
    v_mfma_f32_16x16x32_bf16 a[128:131], v[140:143], v[24:27], a[128:131]
    v_mfma_f32_16x16x32_bf16 a[132:135], v[140:143], v[28:31], a[132:135]
    ds_read_b64_tr_b16 v[136:137], v229 offset:18496
    v_mfma_f32_16x16x32_bf16 a[136:139], v[140:143], v[32:35], a[136:139]
    ds_read_b64_tr_b16 v[138:139], v229 offset:23104
    v_mfma_f32_16x16x32_bf16 a[140:143], v[140:143], v[36:39], a[140:143]
    s_add_u32 s100, s69, 540672
    s_waitcnt lgkmcnt(4)
    s_waitcnt vmcnt(37)
    v_mfma_f32_16x16x32_bf16 a[0:3], v[144:147], v[40:43], a[0:3]
    buffer_load_dwordx4 v[24:27], v3, s[64:67], s100 offen offset:0 sc1
    v_mfma_f32_16x16x32_bf16 a[4:7], v[144:147], v[44:47], a[4:7]
    ds_read_b64_tr_b16 v[140:141], v229 offset:18528
    v_mfma_f32_16x16x32_bf16 a[8:11], v[144:147], v[48:51], a[8:11]
    ds_read_b64_tr_b16 v[142:143], v229 offset:23136
    v_mfma_f32_16x16x32_bf16 a[12:15], v[144:147], v[52:55], a[12:15]
    s_add_u32 s100, s69, 540672
    s_waitcnt lgkmcnt(4)
    v_mfma_f32_16x16x32_bf16 a[16:19], v[148:151], v[40:43], a[16:19]
    buffer_load_dwordx4 v[28:31], v3, s[64:67], s100 offen offset:1024 sc1
    v_mfma_f32_16x16x32_bf16 a[20:23], v[148:151], v[44:47], a[20:23]
    ds_read_b64_tr_b16 v[144:145], v229 offset:18560
    v_mfma_f32_16x16x32_bf16 a[24:27], v[148:151], v[48:51], a[24:27]
    ds_read_b64_tr_b16 v[146:147], v229 offset:23168
    v_mfma_f32_16x16x32_bf16 a[28:31], v[148:151], v[52:55], a[28:31]
    s_add_u32 s100, s69, 540672
    s_waitcnt lgkmcnt(4)
    v_mfma_f32_16x16x32_bf16 a[32:35], v[136:139], v[40:43], a[32:35]
    buffer_load_dwordx4 v[32:35], v3, s[64:67], s100 offen offset:2048 sc1
    v_mfma_f32_16x16x32_bf16 a[36:39], v[136:139], v[44:47], a[36:39]
    ds_read_b64_tr_b16 v[148:149], v229 offset:18592
    v_mfma_f32_16x16x32_bf16 a[40:43], v[136:139], v[48:51], a[40:43]
    ds_read_b64_tr_b16 v[150:151], v229 offset:23200
    v_mfma_f32_16x16x32_bf16 a[44:47], v[136:139], v[52:55], a[44:47]
    s_add_u32 s100, s69, 540672
    s_waitcnt lgkmcnt(4)
    v_mfma_f32_16x16x32_bf16 a[48:51], v[140:143], v[40:43], a[48:51]
    buffer_load_dwordx4 v[36:39], v3, s[64:67], s100 offen offset:3072 sc1
    v_mfma_f32_16x16x32_bf16 a[52:55], v[140:143], v[44:47], a[52:55]
    ds_read_b64_tr_b16 v[136:137], v229 offset:18624
    v_mfma_f32_16x16x32_bf16 a[56:59], v[140:143], v[48:51], a[56:59]
    ds_read_b64_tr_b16 v[138:139], v229 offset:23232
    v_mfma_f32_16x16x32_bf16 a[60:63], v[140:143], v[52:55], a[60:63]
    s_waitcnt lgkmcnt(4)
    v_mfma_f32_16x16x32_bf16 a[64:67], v[144:147], v[40:43], a[64:67]
    v_mfma_f32_16x16x32_bf16 a[68:71], v[144:147], v[44:47], a[68:71]
    ds_read_b64_tr_b16 v[140:141], v229 offset:18656
    v_mfma_f32_16x16x32_bf16 a[72:75], v[144:147], v[48:51], a[72:75]
    ds_read_b64_tr_b16 v[142:143], v229 offset:23264
    v_mfma_f32_16x16x32_bf16 a[76:79], v[144:147], v[52:55], a[76:79]
    s_waitcnt lgkmcnt(4)
    v_mfma_f32_16x16x32_bf16 a[80:83], v[148:151], v[40:43], a[80:83]
    v_mfma_f32_16x16x32_bf16 a[84:87], v[148:151], v[44:47], a[84:87]
    ds_read_b64_tr_b16 v[144:145], v229 offset:18688
    v_mfma_f32_16x16x32_bf16 a[88:91], v[148:151], v[48:51], a[88:91]
    ds_read_b64_tr_b16 v[146:147], v229 offset:23296
    v_mfma_f32_16x16x32_bf16 a[92:95], v[148:151], v[52:55], a[92:95]
    s_waitcnt lgkmcnt(4)
    v_mfma_f32_16x16x32_bf16 a[96:99], v[136:139], v[40:43], a[96:99]
    v_mfma_f32_16x16x32_bf16 a[100:103], v[136:139], v[44:47], a[100:103]
    ds_read_b64_tr_b16 v[148:149], v229 offset:27648
    v_mfma_f32_16x16x32_bf16 a[104:107], v[136:139], v[48:51], a[104:107]
    ds_read_b64_tr_b16 v[150:151], v229 offset:32256
    v_mfma_f32_16x16x32_bf16 a[108:111], v[136:139], v[52:55], a[108:111]
    s_waitcnt lgkmcnt(4)
    v_mfma_f32_16x16x32_bf16 a[112:115], v[140:143], v[40:43], a[112:115]
    v_mfma_f32_16x16x32_bf16 a[116:119], v[140:143], v[44:47], a[116:119]
    ds_read_b64_tr_b16 v[136:137], v229 offset:27680
    v_mfma_f32_16x16x32_bf16 a[120:123], v[140:143], v[48:51], a[120:123]
    ds_read_b64_tr_b16 v[138:139], v229 offset:32288
    v_mfma_f32_16x16x32_bf16 a[124:127], v[140:143], v[52:55], a[124:127]
    s_waitcnt lgkmcnt(4)
    v_mfma_f32_16x16x32_bf16 a[128:131], v[144:147], v[40:43], a[128:131]
    v_mfma_f32_16x16x32_bf16 a[132:135], v[144:147], v[44:47], a[132:135]
    ds_read_b64_tr_b16 v[140:141], v229 offset:27712
    v_mfma_f32_16x16x32_bf16 a[136:139], v[144:147], v[48:51], a[136:139]
    ds_read_b64_tr_b16 v[142:143], v229 offset:32320
    v_mfma_f32_16x16x32_bf16 a[140:143], v[144:147], v[52:55], a[140:143]
    s_add_u32 s100, s69, 557056
    s_waitcnt lgkmcnt(4)
    s_waitcnt vmcnt(35)
    v_mfma_f32_16x16x32_bf16 a[0:3], v[148:151], v[56:59], a[0:3]
    buffer_load_dwordx4 v[40:43], v3, s[64:67], s100 offen offset:0 sc1
    v_mfma_f32_16x16x32_bf16 a[4:7], v[148:151], v[60:63], a[4:7]
    ds_read_b64_tr_b16 v[144:145], v229 offset:27744
    v_mfma_f32_16x16x32_bf16 a[8:11], v[148:151], v[64:67], a[8:11]
    ds_read_b64_tr_b16 v[146:147], v229 offset:32352
    v_mfma_f32_16x16x32_bf16 a[12:15], v[148:151], v[68:71], a[12:15]
    s_add_u32 s100, s69, 557056
    s_waitcnt lgkmcnt(4)
    v_mfma_f32_16x16x32_bf16 a[16:19], v[136:139], v[56:59], a[16:19]
    buffer_load_dwordx4 v[44:47], v3, s[64:67], s100 offen offset:1024 sc1
    v_mfma_f32_16x16x32_bf16 a[20:23], v[136:139], v[60:63], a[20:23]
    ds_read_b64_tr_b16 v[148:149], v229 offset:27776
    v_mfma_f32_16x16x32_bf16 a[24:27], v[136:139], v[64:67], a[24:27]
    ds_read_b64_tr_b16 v[150:151], v229 offset:32384
    v_mfma_f32_16x16x32_bf16 a[28:31], v[136:139], v[68:71], a[28:31]
    s_add_u32 s100, s69, 557056
    s_waitcnt lgkmcnt(4)
    v_mfma_f32_16x16x32_bf16 a[32:35], v[140:143], v[56:59], a[32:35]
    buffer_load_dwordx4 v[48:51], v3, s[64:67], s100 offen offset:2048 sc1
    v_mfma_f32_16x16x32_bf16 a[36:39], v[140:143], v[60:63], a[36:39]
    ds_read_b64_tr_b16 v[136:137], v229 offset:27808
    v_mfma_f32_16x16x32_bf16 a[40:43], v[140:143], v[64:67], a[40:43]
    ds_read_b64_tr_b16 v[138:139], v229 offset:32416
    v_mfma_f32_16x16x32_bf16 a[44:47], v[140:143], v[68:71], a[44:47]
    s_add_u32 s100, s69, 557056
    s_waitcnt lgkmcnt(4)
    v_mfma_f32_16x16x32_bf16 a[48:51], v[144:147], v[56:59], a[48:51]
    buffer_load_dwordx4 v[52:55], v3, s[64:67], s100 offen offset:3072 sc1
    v_mfma_f32_16x16x32_bf16 a[52:55], v[144:147], v[60:63], a[52:55]
    ds_read_b64_tr_b16 v[140:141], v229 offset:27840
    v_mfma_f32_16x16x32_bf16 a[56:59], v[144:147], v[64:67], a[56:59]
    ds_read_b64_tr_b16 v[142:143], v229 offset:32448
    v_mfma_f32_16x16x32_bf16 a[60:63], v[144:147], v[68:71], a[60:63]
    s_waitcnt lgkmcnt(4)
    v_mfma_f32_16x16x32_bf16 a[64:67], v[148:151], v[56:59], a[64:67]
    v_mfma_f32_16x16x32_bf16 a[68:71], v[148:151], v[60:63], a[68:71]
    ds_read_b64_tr_b16 v[144:145], v229 offset:27872
    v_mfma_f32_16x16x32_bf16 a[72:75], v[148:151], v[64:67], a[72:75]
    ds_read_b64_tr_b16 v[146:147], v229 offset:32480
    v_mfma_f32_16x16x32_bf16 a[76:79], v[148:151], v[68:71], a[76:79]
    s_waitcnt lgkmcnt(4)
    v_mfma_f32_16x16x32_bf16 a[80:83], v[136:139], v[56:59], a[80:83]
    v_mfma_f32_16x16x32_bf16 a[84:87], v[136:139], v[60:63], a[84:87]
    ds_read_b64_tr_b16 v[148:149], v229 offset:27904
    v_mfma_f32_16x16x32_bf16 a[88:91], v[136:139], v[64:67], a[88:91]
    ds_read_b64_tr_b16 v[150:151], v229 offset:32512
    v_mfma_f32_16x16x32_bf16 a[92:95], v[136:139], v[68:71], a[92:95]
    s_waitcnt lgkmcnt(4)
    v_mfma_f32_16x16x32_bf16 a[96:99], v[140:143], v[56:59], a[96:99]
    s_waitcnt lgkmcnt(0)
    s_barrier
    v_add_u32 v229, 110592, v228
    v_mfma_f32_16x16x32_bf16 a[100:103], v[140:143], v[60:63], a[100:103]
    ds_read_b64_tr_b16 v[136:137], v229 offset:0
    v_mfma_f32_16x16x32_bf16 a[104:107], v[140:143], v[64:67], a[104:107]
    ds_read_b64_tr_b16 v[138:139], v229 offset:4608
    v_mfma_f32_16x16x32_bf16 a[108:111], v[140:143], v[68:71], a[108:111]
    v_mfma_f32_16x16x32_bf16 a[112:115], v[144:147], v[56:59], a[112:115]
    v_mfma_f32_16x16x32_bf16 a[116:119], v[144:147], v[60:63], a[116:119]
    ds_read_b64_tr_b16 v[140:141], v229 offset:32
    v_mfma_f32_16x16x32_bf16 a[120:123], v[144:147], v[64:67], a[120:123]
    ds_read_b64_tr_b16 v[142:143], v229 offset:4640
    v_mfma_f32_16x16x32_bf16 a[124:127], v[144:147], v[68:71], a[124:127]
    v_mfma_f32_16x16x32_bf16 a[128:131], v[148:151], v[56:59], a[128:131]
    v_mfma_f32_16x16x32_bf16 a[132:135], v[148:151], v[60:63], a[132:135]
    ds_read_b64_tr_b16 v[144:145], v229 offset:64
    v_mfma_f32_16x16x32_bf16 a[136:139], v[148:151], v[64:67], a[136:139]
    ds_read_b64_tr_b16 v[146:147], v229 offset:4672
    v_mfma_f32_16x16x32_bf16 a[140:143], v[148:151], v[68:71], a[140:143]
    s_add_u32 s100, s69, 573440
    s_waitcnt lgkmcnt(4)
    s_waitcnt vmcnt(30)
    v_mfma_f32_16x16x32_bf16 a[0:3], v[136:139], v[72:75], a[0:3]
    buffer_load_dwordx4 v[56:59], v3, s[64:67], s100 offen offset:0 sc1
    v_mfma_f32_16x16x32_bf16 a[4:7], v[136:139], v[76:79], a[4:7]
    ds_read_b64_tr_b16 v[148:149], v229 offset:96
    v_mfma_f32_16x16x32_bf16 a[8:11], v[136:139], v[80:83], a[8:11]
    ds_read_b64_tr_b16 v[150:151], v229 offset:4704
    v_mfma_f32_16x16x32_bf16 a[12:15], v[136:139], v[84:87], a[12:15]
    s_add_u32 s100, s69, 573440
    s_waitcnt lgkmcnt(4)
    v_mfma_f32_16x16x32_bf16 a[16:19], v[140:143], v[72:75], a[16:19]
    buffer_load_dwordx4 v[60:63], v3, s[64:67], s100 offen offset:1024 sc1
    v_mfma_f32_16x16x32_bf16 a[20:23], v[140:143], v[76:79], a[20:23]
    ds_read_b64_tr_b16 v[136:137], v229 offset:128
    v_mfma_f32_16x16x32_bf16 a[24:27], v[140:143], v[80:83], a[24:27]
    ds_read_b64_tr_b16 v[138:139], v229 offset:4736
    v_mfma_f32_16x16x32_bf16 a[28:31], v[140:143], v[84:87], a[28:31]
    s_add_u32 s100, s69, 573440
    s_waitcnt lgkmcnt(4)
    v_mfma_f32_16x16x32_bf16 a[32:35], v[144:147], v[72:75], a[32:35]
    buffer_load_dwordx4 v[64:67], v3, s[64:67], s100 offen offset:2048 sc1
    v_mfma_f32_16x16x32_bf16 a[36:39], v[144:147], v[76:79], a[36:39]
    ds_read_b64_tr_b16 v[140:141], v229 offset:160
    v_mfma_f32_16x16x32_bf16 a[40:43], v[144:147], v[80:83], a[40:43]
    ds_read_b64_tr_b16 v[142:143], v229 offset:4768
    v_mfma_f32_16x16x32_bf16 a[44:47], v[144:147], v[84:87], a[44:47]
    s_add_u32 s100, s69, 573440
    s_waitcnt lgkmcnt(4)
    v_mfma_f32_16x16x32_bf16 a[48:51], v[148:151], v[72:75], a[48:51]
    buffer_load_dwordx4 v[68:71], v3, s[64:67], s100 offen offset:3072 sc1
    v_mfma_f32_16x16x32_bf16 a[52:55], v[148:151], v[76:79], a[52:55]
    ds_read_b64_tr_b16 v[144:145], v229 offset:192
    v_mfma_f32_16x16x32_bf16 a[56:59], v[148:151], v[80:83], a[56:59]
    ds_read_b64_tr_b16 v[146:147], v229 offset:4800
    v_mfma_f32_16x16x32_bf16 a[60:63], v[148:151], v[84:87], a[60:63]
    s_waitcnt lgkmcnt(4)
    v_mfma_f32_16x16x32_bf16 a[64:67], v[136:139], v[72:75], a[64:67]
    v_mfma_f32_16x16x32_bf16 a[68:71], v[136:139], v[76:79], a[68:71]
    ds_read_b64_tr_b16 v[148:149], v229 offset:224
    v_mfma_f32_16x16x32_bf16 a[72:75], v[136:139], v[80:83], a[72:75]
    ds_read_b64_tr_b16 v[150:151], v229 offset:4832
    v_mfma_f32_16x16x32_bf16 a[76:79], v[136:139], v[84:87], a[76:79]
    s_waitcnt lgkmcnt(4)
    v_mfma_f32_16x16x32_bf16 a[80:83], v[140:143], v[72:75], a[80:83]
    v_mfma_f32_16x16x32_bf16 a[84:87], v[140:143], v[76:79], a[84:87]
    ds_read_b64_tr_b16 v[136:137], v229 offset:256
    v_mfma_f32_16x16x32_bf16 a[88:91], v[140:143], v[80:83], a[88:91]
    ds_read_b64_tr_b16 v[138:139], v229 offset:4864
    v_mfma_f32_16x16x32_bf16 a[92:95], v[140:143], v[84:87], a[92:95]
    s_waitcnt lgkmcnt(4)
    v_mfma_f32_16x16x32_bf16 a[96:99], v[144:147], v[72:75], a[96:99]
    v_mfma_f32_16x16x32_bf16 a[100:103], v[144:147], v[76:79], a[100:103]
    ds_read_b64_tr_b16 v[140:141], v229 offset:9216
    v_mfma_f32_16x16x32_bf16 a[104:107], v[144:147], v[80:83], a[104:107]
    ds_read_b64_tr_b16 v[142:143], v229 offset:13824
    v_mfma_f32_16x16x32_bf16 a[108:111], v[144:147], v[84:87], a[108:111]
    s_waitcnt lgkmcnt(4)
    v_mfma_f32_16x16x32_bf16 a[112:115], v[148:151], v[72:75], a[112:115]
    v_mfma_f32_16x16x32_bf16 a[116:119], v[148:151], v[76:79], a[116:119]
    ds_read_b64_tr_b16 v[144:145], v229 offset:9248
    v_mfma_f32_16x16x32_bf16 a[120:123], v[148:151], v[80:83], a[120:123]
    ds_read_b64_tr_b16 v[146:147], v229 offset:13856
    v_mfma_f32_16x16x32_bf16 a[124:127], v[148:151], v[84:87], a[124:127]
    s_waitcnt lgkmcnt(4)
    v_mfma_f32_16x16x32_bf16 a[128:131], v[136:139], v[72:75], a[128:131]
    v_mfma_f32_16x16x32_bf16 a[132:135], v[136:139], v[76:79], a[132:135]
    ds_read_b64_tr_b16 v[148:149], v229 offset:9280
    v_mfma_f32_16x16x32_bf16 a[136:139], v[136:139], v[80:83], a[136:139]
    ds_read_b64_tr_b16 v[150:151], v229 offset:13888
    v_mfma_f32_16x16x32_bf16 a[140:143], v[136:139], v[84:87], a[140:143]
    s_waitcnt lgkmcnt(4)
    s_waitcnt vmcnt(28)
    v_mfma_f32_16x16x32_bf16 a[0:3], v[140:143], v[88:91], a[0:3]
    v_mfma_f32_16x16x32_bf16 a[4:7], v[140:143], v[92:95], a[4:7]
    ds_read_b64_tr_b16 v[136:137], v229 offset:9312
    v_mfma_f32_16x16x32_bf16 a[8:11], v[140:143], v[96:99], a[8:11]
    ds_read_b64_tr_b16 v[138:139], v229 offset:13920
    v_mfma_f32_16x16x32_bf16 a[12:15], v[140:143], v[100:103], a[12:15]
    s_waitcnt lgkmcnt(4)
    v_mfma_f32_16x16x32_bf16 a[16:19], v[144:147], v[88:91], a[16:19]
    v_mfma_f32_16x16x32_bf16 a[20:23], v[144:147], v[92:95], a[20:23]
    ds_read_b64_tr_b16 v[140:141], v229 offset:9344
    v_mfma_f32_16x16x32_bf16 a[24:27], v[144:147], v[96:99], a[24:27]
    ds_read_b64_tr_b16 v[142:143], v229 offset:13952
    v_mfma_f32_16x16x32_bf16 a[28:31], v[144:147], v[100:103], a[28:31]
    s_waitcnt lgkmcnt(4)
    v_mfma_f32_16x16x32_bf16 a[32:35], v[148:151], v[88:91], a[32:35]
    v_mfma_f32_16x16x32_bf16 a[36:39], v[148:151], v[92:95], a[36:39]
    ds_read_b64_tr_b16 v[144:145], v229 offset:9376
    v_mfma_f32_16x16x32_bf16 a[40:43], v[148:151], v[96:99], a[40:43]
    ds_read_b64_tr_b16 v[146:147], v229 offset:13984
    v_mfma_f32_16x16x32_bf16 a[44:47], v[148:151], v[100:103], a[44:47]
    s_waitcnt lgkmcnt(4)
    v_mfma_f32_16x16x32_bf16 a[48:51], v[136:139], v[88:91], a[48:51]
    v_mfma_f32_16x16x32_bf16 a[52:55], v[136:139], v[92:95], a[52:55]
    ds_read_b64_tr_b16 v[148:149], v229 offset:9408
    v_mfma_f32_16x16x32_bf16 a[56:59], v[136:139], v[96:99], a[56:59]
    ds_read_b64_tr_b16 v[150:151], v229 offset:14016
    v_mfma_f32_16x16x32_bf16 a[60:63], v[136:139], v[100:103], a[60:63]
    s_waitcnt lgkmcnt(4)
    v_mfma_f32_16x16x32_bf16 a[64:67], v[140:143], v[88:91], a[64:67]
    v_mfma_f32_16x16x32_bf16 a[68:71], v[140:143], v[92:95], a[68:71]
    ds_read_b64_tr_b16 v[136:137], v229 offset:9440
    v_mfma_f32_16x16x32_bf16 a[72:75], v[140:143], v[96:99], a[72:75]
    ds_read_b64_tr_b16 v[138:139], v229 offset:14048
    v_mfma_f32_16x16x32_bf16 a[76:79], v[140:143], v[100:103], a[76:79]
    s_waitcnt lgkmcnt(4)
    v_mfma_f32_16x16x32_bf16 a[80:83], v[144:147], v[88:91], a[80:83]
    v_mfma_f32_16x16x32_bf16 a[84:87], v[144:147], v[92:95], a[84:87]
    ds_read_b64_tr_b16 v[140:141], v229 offset:9472
    v_mfma_f32_16x16x32_bf16 a[88:91], v[144:147], v[96:99], a[88:91]
    ds_read_b64_tr_b16 v[142:143], v229 offset:14080
    v_mfma_f32_16x16x32_bf16 a[92:95], v[144:147], v[100:103], a[92:95]
    s_waitcnt lgkmcnt(4)
    v_mfma_f32_16x16x32_bf16 a[96:99], v[148:151], v[88:91], a[96:99]
    v_mfma_f32_16x16x32_bf16 a[100:103], v[148:151], v[92:95], a[100:103]
    ds_read_b64_tr_b16 v[144:145], v229 offset:18432
    v_mfma_f32_16x16x32_bf16 a[104:107], v[148:151], v[96:99], a[104:107]
    ds_read_b64_tr_b16 v[146:147], v229 offset:23040
    v_mfma_f32_16x16x32_bf16 a[108:111], v[148:151], v[100:103], a[108:111]
    s_waitcnt lgkmcnt(4)
    v_mfma_f32_16x16x32_bf16 a[112:115], v[136:139], v[88:91], a[112:115]
    v_mfma_f32_16x16x32_bf16 a[116:119], v[136:139], v[92:95], a[116:119]
    ds_read_b64_tr_b16 v[148:149], v229 offset:18464
    v_mfma_f32_16x16x32_bf16 a[120:123], v[136:139], v[96:99], a[120:123]
    ds_read_b64_tr_b16 v[150:151], v229 offset:23072
    v_mfma_f32_16x16x32_bf16 a[124:127], v[136:139], v[100:103], a[124:127]
    s_waitcnt lgkmcnt(4)
    v_mfma_f32_16x16x32_bf16 a[128:131], v[140:143], v[88:91], a[128:131]
    v_mfma_f32_16x16x32_bf16 a[132:135], v[140:143], v[92:95], a[132:135]
    ds_read_b64_tr_b16 v[136:137], v229 offset:18496
    v_mfma_f32_16x16x32_bf16 a[136:139], v[140:143], v[96:99], a[136:139]
    ds_read_b64_tr_b16 v[138:139], v229 offset:23104
    v_mfma_f32_16x16x32_bf16 a[140:143], v[140:143], v[100:103], a[140:143]
    s_waitcnt lgkmcnt(4)
    s_waitcnt vmcnt(24)
    v_mfma_f32_16x16x32_bf16 a[0:3], v[144:147], v[104:107], a[0:3]
    v_mfma_f32_16x16x32_bf16 a[4:7], v[144:147], v[108:111], a[4:7]
    ds_read_b64_tr_b16 v[140:141], v229 offset:18528
    v_mfma_f32_16x16x32_bf16 a[8:11], v[144:147], v[112:115], a[8:11]
    ds_read_b64_tr_b16 v[142:143], v229 offset:23136
    v_mfma_f32_16x16x32_bf16 a[12:15], v[144:147], v[116:119], a[12:15]
    s_waitcnt lgkmcnt(4)
    v_mfma_f32_16x16x32_bf16 a[16:19], v[148:151], v[104:107], a[16:19]
    v_mfma_f32_16x16x32_bf16 a[20:23], v[148:151], v[108:111], a[20:23]
    ds_read_b64_tr_b16 v[144:145], v229 offset:18560
    v_mfma_f32_16x16x32_bf16 a[24:27], v[148:151], v[112:115], a[24:27]
    ds_read_b64_tr_b16 v[146:147], v229 offset:23168
    v_mfma_f32_16x16x32_bf16 a[28:31], v[148:151], v[116:119], a[28:31]
    s_waitcnt lgkmcnt(4)
    v_mfma_f32_16x16x32_bf16 a[32:35], v[136:139], v[104:107], a[32:35]
    v_mfma_f32_16x16x32_bf16 a[36:39], v[136:139], v[108:111], a[36:39]
    ds_read_b64_tr_b16 v[148:149], v229 offset:18592
    v_mfma_f32_16x16x32_bf16 a[40:43], v[136:139], v[112:115], a[40:43]
    ds_read_b64_tr_b16 v[150:151], v229 offset:23200
    v_mfma_f32_16x16x32_bf16 a[44:47], v[136:139], v[116:119], a[44:47]
    s_waitcnt lgkmcnt(4)
    v_mfma_f32_16x16x32_bf16 a[48:51], v[140:143], v[104:107], a[48:51]
    v_mfma_f32_16x16x32_bf16 a[52:55], v[140:143], v[108:111], a[52:55]
    ds_read_b64_tr_b16 v[136:137], v229 offset:18624
    v_mfma_f32_16x16x32_bf16 a[56:59], v[140:143], v[112:115], a[56:59]
    ds_read_b64_tr_b16 v[138:139], v229 offset:23232
    v_mfma_f32_16x16x32_bf16 a[60:63], v[140:143], v[116:119], a[60:63]
    s_waitcnt lgkmcnt(4)
    v_mfma_f32_16x16x32_bf16 a[64:67], v[144:147], v[104:107], a[64:67]
    v_mfma_f32_16x16x32_bf16 a[68:71], v[144:147], v[108:111], a[68:71]
    ds_read_b64_tr_b16 v[140:141], v229 offset:18656
    v_mfma_f32_16x16x32_bf16 a[72:75], v[144:147], v[112:115], a[72:75]
    ds_read_b64_tr_b16 v[142:143], v229 offset:23264
    v_mfma_f32_16x16x32_bf16 a[76:79], v[144:147], v[116:119], a[76:79]
    s_waitcnt lgkmcnt(4)
    v_mfma_f32_16x16x32_bf16 a[80:83], v[148:151], v[104:107], a[80:83]
    v_mfma_f32_16x16x32_bf16 a[84:87], v[148:151], v[108:111], a[84:87]
    ds_read_b64_tr_b16 v[144:145], v229 offset:18688
    v_mfma_f32_16x16x32_bf16 a[88:91], v[148:151], v[112:115], a[88:91]
    ds_read_b64_tr_b16 v[146:147], v229 offset:23296
    v_mfma_f32_16x16x32_bf16 a[92:95], v[148:151], v[116:119], a[92:95]
    s_waitcnt lgkmcnt(4)
    v_mfma_f32_16x16x32_bf16 a[96:99], v[136:139], v[104:107], a[96:99]
    v_mfma_f32_16x16x32_bf16 a[100:103], v[136:139], v[108:111], a[100:103]
    ds_read_b64_tr_b16 v[148:149], v229 offset:27648
    v_mfma_f32_16x16x32_bf16 a[104:107], v[136:139], v[112:115], a[104:107]
    ds_read_b64_tr_b16 v[150:151], v229 offset:32256
    v_mfma_f32_16x16x32_bf16 a[108:111], v[136:139], v[116:119], a[108:111]
    s_waitcnt lgkmcnt(4)
    v_mfma_f32_16x16x32_bf16 a[112:115], v[140:143], v[104:107], a[112:115]
    v_mfma_f32_16x16x32_bf16 a[116:119], v[140:143], v[108:111], a[116:119]
    ds_read_b64_tr_b16 v[136:137], v229 offset:27680
    v_mfma_f32_16x16x32_bf16 a[120:123], v[140:143], v[112:115], a[120:123]
    ds_read_b64_tr_b16 v[138:139], v229 offset:32288
    v_mfma_f32_16x16x32_bf16 a[124:127], v[140:143], v[116:119], a[124:127]
    s_waitcnt lgkmcnt(4)
    v_mfma_f32_16x16x32_bf16 a[128:131], v[144:147], v[104:107], a[128:131]
    v_mfma_f32_16x16x32_bf16 a[132:135], v[144:147], v[108:111], a[132:135]
    ds_read_b64_tr_b16 v[140:141], v229 offset:27712
    v_mfma_f32_16x16x32_bf16 a[136:139], v[144:147], v[112:115], a[136:139]
    ds_read_b64_tr_b16 v[142:143], v229 offset:32320
    v_mfma_f32_16x16x32_bf16 a[140:143], v[144:147], v[116:119], a[140:143]
    s_waitcnt lgkmcnt(4)
    s_waitcnt vmcnt(16)
    v_mfma_f32_16x16x32_bf16 a[0:3], v[148:151], v[120:123], a[0:3]
    v_mfma_f32_16x16x32_bf16 a[4:7], v[148:151], v[124:127], a[4:7]
    ds_read_b64_tr_b16 v[144:145], v229 offset:27744
    v_mfma_f32_16x16x32_bf16 a[8:11], v[148:151], v[128:131], a[8:11]
    ds_read_b64_tr_b16 v[146:147], v229 offset:32352
    v_mfma_f32_16x16x32_bf16 a[12:15], v[148:151], v[132:135], a[12:15]
    s_waitcnt lgkmcnt(4)
    v_mfma_f32_16x16x32_bf16 a[16:19], v[136:139], v[120:123], a[16:19]
    v_mfma_f32_16x16x32_bf16 a[20:23], v[136:139], v[124:127], a[20:23]
    ds_read_b64_tr_b16 v[148:149], v229 offset:27776
    v_mfma_f32_16x16x32_bf16 a[24:27], v[136:139], v[128:131], a[24:27]
    ds_read_b64_tr_b16 v[150:151], v229 offset:32384
    v_mfma_f32_16x16x32_bf16 a[28:31], v[136:139], v[132:135], a[28:31]
    s_waitcnt lgkmcnt(4)
    v_mfma_f32_16x16x32_bf16 a[32:35], v[140:143], v[120:123], a[32:35]
    v_mfma_f32_16x16x32_bf16 a[36:39], v[140:143], v[124:127], a[36:39]
    ds_read_b64_tr_b16 v[136:137], v229 offset:27808
    v_mfma_f32_16x16x32_bf16 a[40:43], v[140:143], v[128:131], a[40:43]
    ds_read_b64_tr_b16 v[138:139], v229 offset:32416
    v_mfma_f32_16x16x32_bf16 a[44:47], v[140:143], v[132:135], a[44:47]
    s_waitcnt lgkmcnt(4)
    v_mfma_f32_16x16x32_bf16 a[48:51], v[144:147], v[120:123], a[48:51]
    v_mfma_f32_16x16x32_bf16 a[52:55], v[144:147], v[124:127], a[52:55]
    ds_read_b64_tr_b16 v[140:141], v229 offset:27840
    v_mfma_f32_16x16x32_bf16 a[56:59], v[144:147], v[128:131], a[56:59]
    ds_read_b64_tr_b16 v[142:143], v229 offset:32448
    v_mfma_f32_16x16x32_bf16 a[60:63], v[144:147], v[132:135], a[60:63]
    s_waitcnt lgkmcnt(4)
    v_mfma_f32_16x16x32_bf16 a[64:67], v[148:151], v[120:123], a[64:67]
    v_mfma_f32_16x16x32_bf16 a[68:71], v[148:151], v[124:127], a[68:71]
    ds_read_b64_tr_b16 v[144:145], v229 offset:27872
    v_mfma_f32_16x16x32_bf16 a[72:75], v[148:151], v[128:131], a[72:75]
    ds_read_b64_tr_b16 v[146:147], v229 offset:32480
    v_mfma_f32_16x16x32_bf16 a[76:79], v[148:151], v[132:135], a[76:79]
    s_waitcnt lgkmcnt(4)
    v_mfma_f32_16x16x32_bf16 a[80:83], v[136:139], v[120:123], a[80:83]
    v_mfma_f32_16x16x32_bf16 a[84:87], v[136:139], v[124:127], a[84:87]
    ds_read_b64_tr_b16 v[148:149], v229 offset:27904
    v_mfma_f32_16x16x32_bf16 a[88:91], v[136:139], v[128:131], a[88:91]
    ds_read_b64_tr_b16 v[150:151], v229 offset:32512
    v_mfma_f32_16x16x32_bf16 a[92:95], v[136:139], v[132:135], a[92:95]
    s_waitcnt lgkmcnt(4)
    v_mfma_f32_16x16x32_bf16 a[96:99], v[140:143], v[120:123], a[96:99]
    s_waitcnt lgkmcnt(0)
    s_barrier
    v_add_u32 v229, 0, v228
    v_mfma_f32_16x16x32_bf16 a[100:103], v[140:143], v[124:127], a[100:103]
    ds_read_b64_tr_b16 v[136:137], v229 offset:0
    v_mfma_f32_16x16x32_bf16 a[104:107], v[140:143], v[128:131], a[104:107]
    ds_read_b64_tr_b16 v[138:139], v229 offset:4608
    v_mfma_f32_16x16x32_bf16 a[108:111], v[140:143], v[132:135], a[108:111]
    v_mfma_f32_16x16x32_bf16 a[112:115], v[144:147], v[120:123], a[112:115]
    v_mfma_f32_16x16x32_bf16 a[116:119], v[144:147], v[124:127], a[116:119]
    ds_read_b64_tr_b16 v[140:141], v229 offset:32
    v_mfma_f32_16x16x32_bf16 a[120:123], v[144:147], v[128:131], a[120:123]
    ds_read_b64_tr_b16 v[142:143], v229 offset:4640
    v_mfma_f32_16x16x32_bf16 a[124:127], v[144:147], v[132:135], a[124:127]
    v_mfma_f32_16x16x32_bf16 a[128:131], v[148:151], v[120:123], a[128:131]
    v_mfma_f32_16x16x32_bf16 a[132:135], v[148:151], v[124:127], a[132:135]
    ds_read_b64_tr_b16 v[144:145], v229 offset:64
    v_mfma_f32_16x16x32_bf16 a[136:139], v[148:151], v[128:131], a[136:139]
    ds_read_b64_tr_b16 v[146:147], v229 offset:4672
    v_mfma_f32_16x16x32_bf16 a[140:143], v[148:151], v[132:135], a[140:143]
    s_waitcnt lgkmcnt(4)
    s_waitcnt vmcnt(12)
    v_mfma_f32_16x16x32_bf16 a[0:3], v[136:139], v[8:11], a[0:3]
    v_mfma_f32_16x16x32_bf16 a[4:7], v[136:139], v[12:15], a[4:7]
    ds_read_b64_tr_b16 v[148:149], v229 offset:96
    v_mfma_f32_16x16x32_bf16 a[8:11], v[136:139], v[16:19], a[8:11]
    ds_read_b64_tr_b16 v[150:151], v229 offset:4704
    v_mfma_f32_16x16x32_bf16 a[12:15], v[136:139], v[20:23], a[12:15]
    s_waitcnt lgkmcnt(4)
    v_mfma_f32_16x16x32_bf16 a[16:19], v[140:143], v[8:11], a[16:19]
    v_mfma_f32_16x16x32_bf16 a[20:23], v[140:143], v[12:15], a[20:23]
    ds_read_b64_tr_b16 v[136:137], v229 offset:128
    v_mfma_f32_16x16x32_bf16 a[24:27], v[140:143], v[16:19], a[24:27]
    ds_read_b64_tr_b16 v[138:139], v229 offset:4736
    v_mfma_f32_16x16x32_bf16 a[28:31], v[140:143], v[20:23], a[28:31]
    s_waitcnt lgkmcnt(4)
    v_mfma_f32_16x16x32_bf16 a[32:35], v[144:147], v[8:11], a[32:35]
    v_mfma_f32_16x16x32_bf16 a[36:39], v[144:147], v[12:15], a[36:39]
    ds_read_b64_tr_b16 v[140:141], v229 offset:160
    v_mfma_f32_16x16x32_bf16 a[40:43], v[144:147], v[16:19], a[40:43]
    ds_read_b64_tr_b16 v[142:143], v229 offset:4768
    v_mfma_f32_16x16x32_bf16 a[44:47], v[144:147], v[20:23], a[44:47]
    s_waitcnt lgkmcnt(4)
    v_mfma_f32_16x16x32_bf16 a[48:51], v[148:151], v[8:11], a[48:51]
    v_mfma_f32_16x16x32_bf16 a[52:55], v[148:151], v[12:15], a[52:55]
    ds_read_b64_tr_b16 v[144:145], v229 offset:192
    v_mfma_f32_16x16x32_bf16 a[56:59], v[148:151], v[16:19], a[56:59]
    ds_read_b64_tr_b16 v[146:147], v229 offset:4800
    v_mfma_f32_16x16x32_bf16 a[60:63], v[148:151], v[20:23], a[60:63]
    s_waitcnt lgkmcnt(4)
    v_mfma_f32_16x16x32_bf16 a[64:67], v[136:139], v[8:11], a[64:67]
    v_mfma_f32_16x16x32_bf16 a[68:71], v[136:139], v[12:15], a[68:71]
    ds_read_b64_tr_b16 v[148:149], v229 offset:224
    v_mfma_f32_16x16x32_bf16 a[72:75], v[136:139], v[16:19], a[72:75]
    ds_read_b64_tr_b16 v[150:151], v229 offset:4832
    v_mfma_f32_16x16x32_bf16 a[76:79], v[136:139], v[20:23], a[76:79]
    s_waitcnt lgkmcnt(4)
    v_mfma_f32_16x16x32_bf16 a[80:83], v[140:143], v[8:11], a[80:83]
    v_mfma_f32_16x16x32_bf16 a[84:87], v[140:143], v[12:15], a[84:87]
    ds_read_b64_tr_b16 v[136:137], v229 offset:256
    v_mfma_f32_16x16x32_bf16 a[88:91], v[140:143], v[16:19], a[88:91]
    ds_read_b64_tr_b16 v[138:139], v229 offset:4864
    v_mfma_f32_16x16x32_bf16 a[92:95], v[140:143], v[20:23], a[92:95]
    s_waitcnt lgkmcnt(4)
    v_mfma_f32_16x16x32_bf16 a[96:99], v[144:147], v[8:11], a[96:99]
    v_mfma_f32_16x16x32_bf16 a[100:103], v[144:147], v[12:15], a[100:103]
    ds_read_b64_tr_b16 v[140:141], v229 offset:9216
    v_mfma_f32_16x16x32_bf16 a[104:107], v[144:147], v[16:19], a[104:107]
    ds_read_b64_tr_b16 v[142:143], v229 offset:13824
    v_mfma_f32_16x16x32_bf16 a[108:111], v[144:147], v[20:23], a[108:111]
    s_waitcnt lgkmcnt(4)
    v_mfma_f32_16x16x32_bf16 a[112:115], v[148:151], v[8:11], a[112:115]
    v_mfma_f32_16x16x32_bf16 a[116:119], v[148:151], v[12:15], a[116:119]
    ds_read_b64_tr_b16 v[144:145], v229 offset:9248
    v_mfma_f32_16x16x32_bf16 a[120:123], v[148:151], v[16:19], a[120:123]
    ds_read_b64_tr_b16 v[146:147], v229 offset:13856
    v_mfma_f32_16x16x32_bf16 a[124:127], v[148:151], v[20:23], a[124:127]
    s_waitcnt lgkmcnt(4)
    v_mfma_f32_16x16x32_bf16 a[128:131], v[136:139], v[8:11], a[128:131]
    v_mfma_f32_16x16x32_bf16 a[132:135], v[136:139], v[12:15], a[132:135]
    ds_read_b64_tr_b16 v[148:149], v229 offset:9280
    v_mfma_f32_16x16x32_bf16 a[136:139], v[136:139], v[16:19], a[136:139]
    ds_read_b64_tr_b16 v[150:151], v229 offset:13888
    v_mfma_f32_16x16x32_bf16 a[140:143], v[136:139], v[20:23], a[140:143]
    s_waitcnt lgkmcnt(4)
    s_waitcnt vmcnt(8)
    v_mfma_f32_16x16x32_bf16 a[0:3], v[140:143], v[24:27], a[0:3]
    v_mfma_f32_16x16x32_bf16 a[4:7], v[140:143], v[28:31], a[4:7]
    ds_read_b64_tr_b16 v[136:137], v229 offset:9312
    v_mfma_f32_16x16x32_bf16 a[8:11], v[140:143], v[32:35], a[8:11]
    ds_read_b64_tr_b16 v[138:139], v229 offset:13920
    v_mfma_f32_16x16x32_bf16 a[12:15], v[140:143], v[36:39], a[12:15]
    s_waitcnt lgkmcnt(4)
    v_mfma_f32_16x16x32_bf16 a[16:19], v[144:147], v[24:27], a[16:19]
    v_mfma_f32_16x16x32_bf16 a[20:23], v[144:147], v[28:31], a[20:23]
    ds_read_b64_tr_b16 v[140:141], v229 offset:9344
    v_mfma_f32_16x16x32_bf16 a[24:27], v[144:147], v[32:35], a[24:27]
    ds_read_b64_tr_b16 v[142:143], v229 offset:13952
    v_mfma_f32_16x16x32_bf16 a[28:31], v[144:147], v[36:39], a[28:31]
    s_waitcnt lgkmcnt(4)
    v_mfma_f32_16x16x32_bf16 a[32:35], v[148:151], v[24:27], a[32:35]
    v_mfma_f32_16x16x32_bf16 a[36:39], v[148:151], v[28:31], a[36:39]
    ds_read_b64_tr_b16 v[144:145], v229 offset:9376
    v_mfma_f32_16x16x32_bf16 a[40:43], v[148:151], v[32:35], a[40:43]
    ds_read_b64_tr_b16 v[146:147], v229 offset:13984
    v_mfma_f32_16x16x32_bf16 a[44:47], v[148:151], v[36:39], a[44:47]
    s_waitcnt lgkmcnt(4)
    v_mfma_f32_16x16x32_bf16 a[48:51], v[136:139], v[24:27], a[48:51]
    v_mfma_f32_16x16x32_bf16 a[52:55], v[136:139], v[28:31], a[52:55]
    ds_read_b64_tr_b16 v[148:149], v229 offset:9408
    v_mfma_f32_16x16x32_bf16 a[56:59], v[136:139], v[32:35], a[56:59]
    ds_read_b64_tr_b16 v[150:151], v229 offset:14016
    v_mfma_f32_16x16x32_bf16 a[60:63], v[136:139], v[36:39], a[60:63]
    s_waitcnt lgkmcnt(4)
    v_mfma_f32_16x16x32_bf16 a[64:67], v[140:143], v[24:27], a[64:67]
    v_mfma_f32_16x16x32_bf16 a[68:71], v[140:143], v[28:31], a[68:71]
    ds_read_b64_tr_b16 v[136:137], v229 offset:9440
    v_mfma_f32_16x16x32_bf16 a[72:75], v[140:143], v[32:35], a[72:75]
    ds_read_b64_tr_b16 v[138:139], v229 offset:14048
    v_mfma_f32_16x16x32_bf16 a[76:79], v[140:143], v[36:39], a[76:79]
    s_waitcnt lgkmcnt(4)
    v_mfma_f32_16x16x32_bf16 a[80:83], v[144:147], v[24:27], a[80:83]
    v_mfma_f32_16x16x32_bf16 a[84:87], v[144:147], v[28:31], a[84:87]
    ds_read_b64_tr_b16 v[140:141], v229 offset:9472
    v_mfma_f32_16x16x32_bf16 a[88:91], v[144:147], v[32:35], a[88:91]
    ds_read_b64_tr_b16 v[142:143], v229 offset:14080
    v_mfma_f32_16x16x32_bf16 a[92:95], v[144:147], v[36:39], a[92:95]
    s_waitcnt lgkmcnt(4)
    v_mfma_f32_16x16x32_bf16 a[96:99], v[148:151], v[24:27], a[96:99]
    v_mfma_f32_16x16x32_bf16 a[100:103], v[148:151], v[28:31], a[100:103]
    ds_read_b64_tr_b16 v[144:145], v229 offset:18432
    v_mfma_f32_16x16x32_bf16 a[104:107], v[148:151], v[32:35], a[104:107]
    ds_read_b64_tr_b16 v[146:147], v229 offset:23040
    v_mfma_f32_16x16x32_bf16 a[108:111], v[148:151], v[36:39], a[108:111]
    s_waitcnt lgkmcnt(4)
    v_mfma_f32_16x16x32_bf16 a[112:115], v[136:139], v[24:27], a[112:115]
    v_mfma_f32_16x16x32_bf16 a[116:119], v[136:139], v[28:31], a[116:119]
    ds_read_b64_tr_b16 v[148:149], v229 offset:18464
    v_mfma_f32_16x16x32_bf16 a[120:123], v[136:139], v[32:35], a[120:123]
    ds_read_b64_tr_b16 v[150:151], v229 offset:23072
    v_mfma_f32_16x16x32_bf16 a[124:127], v[136:139], v[36:39], a[124:127]
    s_waitcnt lgkmcnt(4)
    v_mfma_f32_16x16x32_bf16 a[128:131], v[140:143], v[24:27], a[128:131]
    v_mfma_f32_16x16x32_bf16 a[132:135], v[140:143], v[28:31], a[132:135]
    ds_read_b64_tr_b16 v[136:137], v229 offset:18496
    v_mfma_f32_16x16x32_bf16 a[136:139], v[140:143], v[32:35], a[136:139]
    ds_read_b64_tr_b16 v[138:139], v229 offset:23104
    v_mfma_f32_16x16x32_bf16 a[140:143], v[140:143], v[36:39], a[140:143]
    s_waitcnt lgkmcnt(4)
    s_waitcnt vmcnt(4)
    v_mfma_f32_16x16x32_bf16 a[0:3], v[144:147], v[40:43], a[0:3]
    v_mfma_f32_16x16x32_bf16 a[4:7], v[144:147], v[44:47], a[4:7]
    ds_read_b64_tr_b16 v[140:141], v229 offset:18528
    v_mfma_f32_16x16x32_bf16 a[8:11], v[144:147], v[48:51], a[8:11]
    ds_read_b64_tr_b16 v[142:143], v229 offset:23136
    v_mfma_f32_16x16x32_bf16 a[12:15], v[144:147], v[52:55], a[12:15]
    s_waitcnt lgkmcnt(4)
    v_mfma_f32_16x16x32_bf16 a[16:19], v[148:151], v[40:43], a[16:19]
    v_mfma_f32_16x16x32_bf16 a[20:23], v[148:151], v[44:47], a[20:23]
    ds_read_b64_tr_b16 v[144:145], v229 offset:18560
    v_mfma_f32_16x16x32_bf16 a[24:27], v[148:151], v[48:51], a[24:27]
    ds_read_b64_tr_b16 v[146:147], v229 offset:23168
    v_mfma_f32_16x16x32_bf16 a[28:31], v[148:151], v[52:55], a[28:31]
    s_waitcnt lgkmcnt(4)
    v_mfma_f32_16x16x32_bf16 a[32:35], v[136:139], v[40:43], a[32:35]
    v_mfma_f32_16x16x32_bf16 a[36:39], v[136:139], v[44:47], a[36:39]
    ds_read_b64_tr_b16 v[148:149], v229 offset:18592
    v_mfma_f32_16x16x32_bf16 a[40:43], v[136:139], v[48:51], a[40:43]
    ds_read_b64_tr_b16 v[150:151], v229 offset:23200
    v_mfma_f32_16x16x32_bf16 a[44:47], v[136:139], v[52:55], a[44:47]
    s_waitcnt lgkmcnt(4)
    v_mfma_f32_16x16x32_bf16 a[48:51], v[140:143], v[40:43], a[48:51]
    v_mfma_f32_16x16x32_bf16 a[52:55], v[140:143], v[44:47], a[52:55]
    ds_read_b64_tr_b16 v[136:137], v229 offset:18624
    v_mfma_f32_16x16x32_bf16 a[56:59], v[140:143], v[48:51], a[56:59]
    ds_read_b64_tr_b16 v[138:139], v229 offset:23232
    v_mfma_f32_16x16x32_bf16 a[60:63], v[140:143], v[52:55], a[60:63]
    s_waitcnt lgkmcnt(4)
    v_mfma_f32_16x16x32_bf16 a[64:67], v[144:147], v[40:43], a[64:67]
    v_mfma_f32_16x16x32_bf16 a[68:71], v[144:147], v[44:47], a[68:71]
    ds_read_b64_tr_b16 v[140:141], v229 offset:18656
    v_mfma_f32_16x16x32_bf16 a[72:75], v[144:147], v[48:51], a[72:75]
    ds_read_b64_tr_b16 v[142:143], v229 offset:23264
    v_mfma_f32_16x16x32_bf16 a[76:79], v[144:147], v[52:55], a[76:79]
    s_waitcnt lgkmcnt(4)
    v_mfma_f32_16x16x32_bf16 a[80:83], v[148:151], v[40:43], a[80:83]
    v_mfma_f32_16x16x32_bf16 a[84:87], v[148:151], v[44:47], a[84:87]
    ds_read_b64_tr_b16 v[144:145], v229 offset:18688
    v_mfma_f32_16x16x32_bf16 a[88:91], v[148:151], v[48:51], a[88:91]
    ds_read_b64_tr_b16 v[146:147], v229 offset:23296
    v_mfma_f32_16x16x32_bf16 a[92:95], v[148:151], v[52:55], a[92:95]
    s_waitcnt lgkmcnt(4)
    v_mfma_f32_16x16x32_bf16 a[96:99], v[136:139], v[40:43], a[96:99]
    v_mfma_f32_16x16x32_bf16 a[100:103], v[136:139], v[44:47], a[100:103]
    ds_read_b64_tr_b16 v[148:149], v229 offset:27648
    v_mfma_f32_16x16x32_bf16 a[104:107], v[136:139], v[48:51], a[104:107]
    ds_read_b64_tr_b16 v[150:151], v229 offset:32256
    v_mfma_f32_16x16x32_bf16 a[108:111], v[136:139], v[52:55], a[108:111]
    s_waitcnt lgkmcnt(4)
    v_mfma_f32_16x16x32_bf16 a[112:115], v[140:143], v[40:43], a[112:115]
    v_mfma_f32_16x16x32_bf16 a[116:119], v[140:143], v[44:47], a[116:119]
    ds_read_b64_tr_b16 v[136:137], v229 offset:27680
    v_mfma_f32_16x16x32_bf16 a[120:123], v[140:143], v[48:51], a[120:123]
    ds_read_b64_tr_b16 v[138:139], v229 offset:32288
    v_mfma_f32_16x16x32_bf16 a[124:127], v[140:143], v[52:55], a[124:127]
    s_waitcnt lgkmcnt(4)
    v_mfma_f32_16x16x32_bf16 a[128:131], v[144:147], v[40:43], a[128:131]
    v_mfma_f32_16x16x32_bf16 a[132:135], v[144:147], v[44:47], a[132:135]
    ds_read_b64_tr_b16 v[140:141], v229 offset:27712
    v_mfma_f32_16x16x32_bf16 a[136:139], v[144:147], v[48:51], a[136:139]
    ds_read_b64_tr_b16 v[142:143], v229 offset:32320
    v_mfma_f32_16x16x32_bf16 a[140:143], v[144:147], v[52:55], a[140:143]
    s_waitcnt lgkmcnt(4)
    s_waitcnt vmcnt(0)
    v_mfma_f32_16x16x32_bf16 a[0:3], v[148:151], v[56:59], a[0:3]
    v_mfma_f32_16x16x32_bf16 a[4:7], v[148:151], v[60:63], a[4:7]
    ds_read_b64_tr_b16 v[144:145], v229 offset:27744
    v_mfma_f32_16x16x32_bf16 a[8:11], v[148:151], v[64:67], a[8:11]
    ds_read_b64_tr_b16 v[146:147], v229 offset:32352
    v_mfma_f32_16x16x32_bf16 a[12:15], v[148:151], v[68:71], a[12:15]
    s_waitcnt lgkmcnt(4)
    v_mfma_f32_16x16x32_bf16 a[16:19], v[136:139], v[56:59], a[16:19]
    v_mfma_f32_16x16x32_bf16 a[20:23], v[136:139], v[60:63], a[20:23]
    ds_read_b64_tr_b16 v[148:149], v229 offset:27776
    v_mfma_f32_16x16x32_bf16 a[24:27], v[136:139], v[64:67], a[24:27]
    ds_read_b64_tr_b16 v[150:151], v229 offset:32384
    v_mfma_f32_16x16x32_bf16 a[28:31], v[136:139], v[68:71], a[28:31]
    s_waitcnt lgkmcnt(4)
    v_mfma_f32_16x16x32_bf16 a[32:35], v[140:143], v[56:59], a[32:35]
    v_mfma_f32_16x16x32_bf16 a[36:39], v[140:143], v[60:63], a[36:39]
    ds_read_b64_tr_b16 v[136:137], v229 offset:27808
    v_mfma_f32_16x16x32_bf16 a[40:43], v[140:143], v[64:67], a[40:43]
    ds_read_b64_tr_b16 v[138:139], v229 offset:32416
    v_mfma_f32_16x16x32_bf16 a[44:47], v[140:143], v[68:71], a[44:47]
    s_waitcnt lgkmcnt(4)
    v_mfma_f32_16x16x32_bf16 a[48:51], v[144:147], v[56:59], a[48:51]
    v_mfma_f32_16x16x32_bf16 a[52:55], v[144:147], v[60:63], a[52:55]
    ds_read_b64_tr_b16 v[140:141], v229 offset:27840
    v_mfma_f32_16x16x32_bf16 a[56:59], v[144:147], v[64:67], a[56:59]
    ds_read_b64_tr_b16 v[142:143], v229 offset:32448
    v_mfma_f32_16x16x32_bf16 a[60:63], v[144:147], v[68:71], a[60:63]
    s_waitcnt lgkmcnt(4)
    v_mfma_f32_16x16x32_bf16 a[64:67], v[148:151], v[56:59], a[64:67]
    v_mfma_f32_16x16x32_bf16 a[68:71], v[148:151], v[60:63], a[68:71]
    ds_read_b64_tr_b16 v[144:145], v229 offset:27872
    v_mfma_f32_16x16x32_bf16 a[72:75], v[148:151], v[64:67], a[72:75]
    ds_read_b64_tr_b16 v[146:147], v229 offset:32480
    v_mfma_f32_16x16x32_bf16 a[76:79], v[148:151], v[68:71], a[76:79]
    s_waitcnt lgkmcnt(4)
    v_mfma_f32_16x16x32_bf16 a[80:83], v[136:139], v[56:59], a[80:83]
    v_mfma_f32_16x16x32_bf16 a[84:87], v[136:139], v[60:63], a[84:87]
    ds_read_b64_tr_b16 v[148:149], v229 offset:27904
    v_mfma_f32_16x16x32_bf16 a[88:91], v[136:139], v[64:67], a[88:91]
    ds_read_b64_tr_b16 v[150:151], v229 offset:32512
    v_mfma_f32_16x16x32_bf16 a[92:95], v[136:139], v[68:71], a[92:95]
    s_waitcnt lgkmcnt(4)
    v_mfma_f32_16x16x32_bf16 a[96:99], v[140:143], v[56:59], a[96:99]
    v_mfma_f32_16x16x32_bf16 a[100:103], v[140:143], v[60:63], a[100:103]
    v_mfma_f32_16x16x32_bf16 a[104:107], v[140:143], v[64:67], a[104:107]
    v_mfma_f32_16x16x32_bf16 a[108:111], v[140:143], v[68:71], a[108:111]
    s_waitcnt lgkmcnt(2)
    v_mfma_f32_16x16x32_bf16 a[112:115], v[144:147], v[56:59], a[112:115]
    v_mfma_f32_16x16x32_bf16 a[116:119], v[144:147], v[60:63], a[116:119]
    v_mfma_f32_16x16x32_bf16 a[120:123], v[144:147], v[64:67], a[120:123]
    v_mfma_f32_16x16x32_bf16 a[124:127], v[144:147], v[68:71], a[124:127]
    s_waitcnt lgkmcnt(0)
    v_mfma_f32_16x16x32_bf16 a[128:131], v[148:151], v[56:59], a[128:131]
    v_mfma_f32_16x16x32_bf16 a[132:135], v[148:151], v[60:63], a[132:135]
    v_mfma_f32_16x16x32_bf16 a[136:139], v[148:151], v[64:67], a[136:139]
    v_mfma_f32_16x16x32_bf16 a[140:143], v[148:151], v[68:71], a[140:143]
    s_nop 7
    s_branch mk_join
mk_role_s:
    s_waitcnt lgkmcnt(0)
    s_nop 1
    v_mfma_f32_16x16x32_bf16 a[128:131], a[16:19], v[88:91], a[128:131]
    v_mfma_f32_16x16x32_bf16 a[132:135], a[20:23], v[88:91], a[132:135]
    v_mfma_f32_16x16x32_bf16 a[136:139], a[24:27], v[88:91], a[136:139]
    v_mfma_f32_16x16x32_bf16 a[140:143], a[28:31], v[88:91], a[140:143]
    v_mfma_f32_16x16x32_bf16 a[144:147], a[48:51], v[88:91], a[144:147]
    v_mfma_f32_16x16x32_bf16 a[148:151], a[52:55], v[88:91], a[148:151]
    v_mfma_f32_16x16x32_bf16 a[152:155], a[56:59], v[88:91], a[152:155]
    v_mfma_f32_16x16x32_bf16 a[156:159], a[60:63], v[88:91], a[156:159]
    v_mfma_f32_16x16x32_bf16 a[192:195], a[16:19], v[96:99], a[192:195]
    v_mfma_f32_16x16x32_bf16 a[196:199], a[20:23], v[96:99], a[196:199]
    v_mfma_f32_16x16x32_bf16 a[200:203], a[24:27], v[96:99], a[200:203]
    v_mfma_f32_16x16x32_bf16 a[204:207], a[28:31], v[96:99], a[204:207]
    v_mfma_f32_16x16x32_bf16 a[208:211], a[48:51], v[96:99], a[208:211]
    v_mfma_f32_16x16x32_bf16 a[212:215], a[52:55], v[96:99], a[212:215]
    v_mfma_f32_16x16x32_bf16 a[216:219], a[56:59], v[96:99], a[216:219]
    v_mfma_f32_16x16x32_bf16 a[220:223], a[60:63], v[96:99], a[220:223]
    v_mfma_f32_16x16x32_bf16 a[160:163], a[16:19], v[92:95], a[160:163]
    v_mfma_f32_16x16x32_bf16 a[164:167], a[20:23], v[92:95], a[164:167]
    v_mfma_f32_16x16x32_bf16 a[168:171], a[24:27], v[92:95], a[168:171]
    v_mfma_f32_16x16x32_bf16 a[172:175], a[28:31], v[92:95], a[172:175]
    v_mfma_f32_16x16x32_bf16 a[176:179], a[48:51], v[92:95], a[176:179]
    v_mfma_f32_16x16x32_bf16 a[180:183], a[52:55], v[92:95], a[180:183]
    v_mfma_f32_16x16x32_bf16 a[184:187], a[56:59], v[92:95], a[184:187]
    v_mfma_f32_16x16x32_bf16 a[188:191], a[60:63], v[92:95], a[188:191]
    v_mfma_f32_16x16x32_bf16 a[224:227], a[16:19], v[100:103], a[224:227]
    v_mfma_f32_16x16x32_bf16 a[228:231], a[20:23], v[100:103], a[228:231]
    v_mfma_f32_16x16x32_bf16 a[232:235], a[24:27], v[100:103], a[232:235]
    v_mfma_f32_16x16x32_bf16 a[236:239], a[28:31], v[100:103], a[236:239]
    v_mfma_f32_16x16x32_bf16 a[240:243], a[48:51], v[100:103], a[240:243]
    v_mfma_f32_16x16x32_bf16 a[244:247], a[52:55], v[100:103], a[244:247]
    v_mfma_f32_16x16x32_bf16 a[248:251], a[56:59], v[100:103], a[248:251]
    v_mfma_f32_16x16x32_bf16 a[252:255], a[60:63], v[100:103], a[252:255]
    s_barrier
    s_add_u32 s99, s68, 294912
    s_add_u32 m0, s70, 36864
    s_nop 0
    buffer_load_dwordx4 v219, s[60:63], s99 offen offset:0 lds
    buffer_load_dwordx4 v220, s[60:63], s99 offen offset:1024 lds
    buffer_load_dwordx4 v221, s[60:63], s99 offen offset:2048 lds
    buffer_load_dwordx4 v222, s[60:63], s99 offen offset:3072 lds
    s_add_u32 m0, s70, 40960
    s_nop 0
    buffer_load_dwordx4 v223, s[60:63], s99 offen offset:0 lds
    buffer_load_dwordx4 v224, s[60:63], s99 offen offset:1024 lds
    buffer_load_dwordx4 v225, s[60:63], s99 offen offset:2048 lds
    buffer_load_dwordx4 v226, s[60:63], s99 offen offset:3072 lds
    s_add_u32 m0, s70, 45056
    s_nop 0
    buffer_load_dwordx4 v227, s[60:63], s99 offen offset:0 lds
    s_add_u32 s99, s68, 589824
    s_add_u32 m0, s70, 73728
    s_nop 0
    buffer_load_dwordx4 v219, s[60:63], s99 offen offset:0 lds
    buffer_load_dwordx4 v220, s[60:63], s99 offen offset:1024 lds
    buffer_load_dwordx4 v221, s[60:63], s99 offen offset:2048 lds
    buffer_load_dwordx4 v222, s[60:63], s99 offen offset:3072 lds
    s_add_u32 m0, s70, 77824
    s_nop 0
    buffer_load_dwordx4 v223, s[60:63], s99 offen offset:0 lds
    buffer_load_dwordx4 v224, s[60:63], s99 offen offset:1024 lds
    buffer_load_dwordx4 v225, s[60:63], s99 offen offset:2048 lds
    buffer_load_dwordx4 v226, s[60:63], s99 offen offset:3072 lds
    s_add_u32 m0, s70, 81920
    s_nop 0
    buffer_load_dwordx4 v227, s[60:63], s99 offen offset:0 lds
    v_mov_b32 v188, v170
    v_mov_b32 v189, v171
    s_nop 1
    v_permlane32_swap_b32 v188, v170
    v_permlane32_swap_b32 v189, v171
    s_nop 1
    v_add_f32 v170, v188, v170
    v_add_f32 v171, v189, v171
    v_mov_b32 v188, v170
    v_mov_b32 v189, v171
    s_nop 1
    v_permlane16_swap_b32 v188, v170
    v_permlane16_swap_b32 v189, v171
    s_nop 1
    v_add_f32 v170, v188, v170
    v_add_f32 v171, v189, v171
    v_rcp_f32 v4, v168
    v_rcp_f32 v5, v169
    v_rcp_f32 v6, v170
    v_rcp_f32 v7, v171
    s_nop 7
    v_accvgpr_read_b32 v136, a128
    v_accvgpr_read_b32 v137, a129
    v_accvgpr_read_b32 v138, a130
    v_accvgpr_read_b32 v139, a131
    v_accvgpr_read_b32 v140, a132
    v_accvgpr_read_b32 v141, a133
    v_accvgpr_read_b32 v142, a134
    v_accvgpr_read_b32 v143, a135
    v_pk_mul_f32 v[136:137], v[136:137], v[4:5] op_sel:[0,0] op_sel_hi:[1,0]
    v_pk_mul_f32 v[138:139], v[138:139], v[4:5] op_sel:[0,0] op_sel_hi:[1,0]
    v_pk_mul_f32 v[140:141], v[140:141], v[4:5] op_sel:[0,0] op_sel_hi:[1,0]
    v_pk_mul_f32 v[142:143], v[142:143], v[4:5] op_sel:[0,0] op_sel_hi:[1,0]
    v_cvt_pk_bf16_f32 v152, v136, v137
    v_cvt_pk_bf16_f32 v153, v138, v139
    v_cvt_pk_bf16_f32 v154, v140, v141
    v_cvt_pk_bf16_f32 v155, v142, v143
    s_add_u32 s25, s24, 0
    buffer_store_dwordx4 v[152:155], v3, s[16:19], s25 offen offset:0 sc1
    v_accvgpr_read_b32 v144, a192
    v_accvgpr_read_b32 v145, a193
    v_accvgpr_read_b32 v146, a194
    v_accvgpr_read_b32 v147, a195
    v_accvgpr_read_b32 v148, a196
    v_accvgpr_read_b32 v149, a197
    v_accvgpr_read_b32 v150, a198
    v_accvgpr_read_b32 v151, a199
    v_pk_mul_f32 v[144:145], v[144:145], v[6:7] op_sel:[0,0] op_sel_hi:[1,0]
    v_pk_mul_f32 v[146:147], v[146:147], v[6:7] op_sel:[0,0] op_sel_hi:[1,0]
    v_pk_mul_f32 v[148:149], v[148:149], v[6:7] op_sel:[0,0] op_sel_hi:[1,0]
    v_pk_mul_f32 v[150:151], v[150:151], v[6:7] op_sel:[0,0] op_sel_hi:[1,0]
    v_cvt_pk_bf16_f32 v160, v144, v145
    v_cvt_pk_bf16_f32 v161, v146, v147
    v_cvt_pk_bf16_f32 v162, v148, v149
    v_cvt_pk_bf16_f32 v163, v150, v151
    s_add_u32 s25, s24, 0
    buffer_store_dwordx4 v[160:163], v3, s[16:19], s25 offen offset:2048 sc1
    v_accvgpr_read_b32 v136, a160
    v_accvgpr_read_b32 v137, a161
    v_accvgpr_read_b32 v138, a162
    v_accvgpr_read_b32 v139, a163
    v_accvgpr_read_b32 v140, a164
    v_accvgpr_read_b32 v141, a165
    v_accvgpr_read_b32 v142, a166
    v_accvgpr_read_b32 v143, a167
    v_pk_mul_f32 v[136:137], v[136:137], v[4:5] op_sel:[0,1] op_sel_hi:[1,1]
    v_pk_mul_f32 v[138:139], v[138:139], v[4:5] op_sel:[0,1] op_sel_hi:[1,1]
    v_pk_mul_f32 v[140:141], v[140:141], v[4:5] op_sel:[0,1] op_sel_hi:[1,1]
    v_pk_mul_f32 v[142:143], v[142:143], v[4:5] op_sel:[0,1] op_sel_hi:[1,1]
    v_cvt_pk_bf16_f32 v156, v136, v137
    v_cvt_pk_bf16_f32 v157, v138, v139
    v_cvt_pk_bf16_f32 v158, v140, v141
    v_cvt_pk_bf16_f32 v159, v142, v143
    s_add_u32 s25, s24, 0
    buffer_store_dwordx4 v[156:159], v3, s[16:19], s25 offen offset:1024 sc1
    v_accvgpr_read_b32 v144, a224
    v_accvgpr_read_b32 v145, a225
    v_accvgpr_read_b32 v146, a226
    v_accvgpr_read_b32 v147, a227
    v_accvgpr_read_b32 v148, a228
    v_accvgpr_read_b32 v149, a229
    v_accvgpr_read_b32 v150, a230
    v_accvgpr_read_b32 v151, a231
    v_pk_mul_f32 v[144:145], v[144:145], v[6:7] op_sel:[0,1] op_sel_hi:[1,1]
    v_pk_mul_f32 v[146:147], v[146:147], v[6:7] op_sel:[0,1] op_sel_hi:[1,1]
    v_pk_mul_f32 v[148:149], v[148:149], v[6:7] op_sel:[0,1] op_sel_hi:[1,1]
    v_pk_mul_f32 v[150:151], v[150:151], v[6:7] op_sel:[0,1] op_sel_hi:[1,1]
    v_cvt_pk_bf16_f32 v164, v144, v145
    v_cvt_pk_bf16_f32 v165, v146, v147
    v_cvt_pk_bf16_f32 v166, v148, v149
    v_cvt_pk_bf16_f32 v167, v150, v151
    s_add_u32 s25, s24, 0
    buffer_store_dwordx4 v[164:167], v3, s[16:19], s25 offen offset:3072 sc1
    v_accvgpr_read_b32 v136, a136
    v_accvgpr_read_b32 v137, a137
    v_accvgpr_read_b32 v138, a138
    v_accvgpr_read_b32 v139, a139
    v_accvgpr_read_b32 v140, a140
    v_accvgpr_read_b32 v141, a141
    v_accvgpr_read_b32 v142, a142
    v_accvgpr_read_b32 v143, a143
    v_pk_mul_f32 v[136:137], v[136:137], v[4:5] op_sel:[0,0] op_sel_hi:[1,0]
    v_pk_mul_f32 v[138:139], v[138:139], v[4:5] op_sel:[0,0] op_sel_hi:[1,0]
    v_pk_mul_f32 v[140:141], v[140:141], v[4:5] op_sel:[0,0] op_sel_hi:[1,0]
    v_pk_mul_f32 v[142:143], v[142:143], v[4:5] op_sel:[0,0] op_sel_hi:[1,0]
    v_cvt_pk_bf16_f32 v168, v136, v137
    v_cvt_pk_bf16_f32 v169, v138, v139
    v_cvt_pk_bf16_f32 v170, v140, v141
    v_cvt_pk_bf16_f32 v171, v142, v143
    s_add_u32 s25, s24, 16384
    buffer_store_dwordx4 v[168:171], v3, s[16:19], s25 offen offset:0 sc1
    v_accvgpr_read_b32 v144, a200
    v_accvgpr_read_b32 v145, a201
    v_accvgpr_read_b32 v146, a202
    v_accvgpr_read_b32 v147, a203
    v_accvgpr_read_b32 v148, a204
    v_accvgpr_read_b32 v149, a205
    v_accvgpr_read_b32 v150, a206
    v_accvgpr_read_b32 v151, a207
    v_pk_mul_f32 v[144:145], v[144:145], v[6:7] op_sel:[0,0] op_sel_hi:[1,0]
    v_pk_mul_f32 v[146:147], v[146:147], v[6:7] op_sel:[0,0] op_sel_hi:[1,0]
    v_pk_mul_f32 v[148:149], v[148:149], v[6:7] op_sel:[0,0] op_sel_hi:[1,0]
    v_pk_mul_f32 v[150:151], v[150:151], v[6:7] op_sel:[0,0] op_sel_hi:[1,0]
    v_cvt_pk_bf16_f32 v176, v144, v145
    v_cvt_pk_bf16_f32 v177, v146, v147
    v_cvt_pk_bf16_f32 v178, v148, v149
    v_cvt_pk_bf16_f32 v179, v150, v151
    s_add_u32 s25, s24, 16384
    buffer_store_dwordx4 v[176:179], v3, s[16:19], s25 offen offset:2048 sc1
    v_accvgpr_read_b32 v136, a168
    v_accvgpr_read_b32 v137, a169
    v_accvgpr_read_b32 v138, a170
    v_accvgpr_read_b32 v139, a171
    v_accvgpr_read_b32 v140, a172
    v_accvgpr_read_b32 v141, a173
    v_accvgpr_read_b32 v142, a174
    v_accvgpr_read_b32 v143, a175
    v_pk_mul_f32 v[136:137], v[136:137], v[4:5] op_sel:[0,1] op_sel_hi:[1,1]
    v_pk_mul_f32 v[138:139], v[138:139], v[4:5] op_sel:[0,1] op_sel_hi:[1,1]
    v_pk_mul_f32 v[140:141], v[140:141], v[4:5] op_sel:[0,1] op_sel_hi:[1,1]
    v_pk_mul_f32 v[142:143], v[142:143], v[4:5] op_sel:[0,1] op_sel_hi:[1,1]
    v_cvt_pk_bf16_f32 v172, v136, v137
    v_cvt_pk_bf16_f32 v173, v138, v139
    v_cvt_pk_bf16_f32 v174, v140, v141
    v_cvt_pk_bf16_f32 v175, v142, v143
    s_add_u32 s25, s24, 16384
    buffer_store_dwordx4 v[172:175], v3, s[16:19], s25 offen offset:1024 sc1
    v_accvgpr_read_b32 v144, a232
    v_accvgpr_read_b32 v145, a233
    v_accvgpr_read_b32 v146, a234
    v_accvgpr_read_b32 v147, a235
    v_accvgpr_read_b32 v148, a236
    v_accvgpr_read_b32 v149, a237
    v_accvgpr_read_b32 v150, a238
    v_accvgpr_read_b32 v151, a239
    v_pk_mul_f32 v[144:145], v[144:145], v[6:7] op_sel:[0,1] op_sel_hi:[1,1]
    v_pk_mul_f32 v[146:147], v[146:147], v[6:7] op_sel:[0,1] op_sel_hi:[1,1]
    v_pk_mul_f32 v[148:149], v[148:149], v[6:7] op_sel:[0,1] op_sel_hi:[1,1]
    v_pk_mul_f32 v[150:151], v[150:151], v[6:7] op_sel:[0,1] op_sel_hi:[1,1]
    v_cvt_pk_bf16_f32 v180, v144, v145
    v_cvt_pk_bf16_f32 v181, v146, v147
    v_cvt_pk_bf16_f32 v182, v148, v149
    v_cvt_pk_bf16_f32 v183, v150, v151
    s_add_u32 s25, s24, 16384
    buffer_store_dwordx4 v[180:183], v3, s[16:19], s25 offen offset:3072 sc1
    v_accvgpr_read_b32 v136, a144
    v_accvgpr_read_b32 v137, a145
    v_accvgpr_read_b32 v138, a146
    v_accvgpr_read_b32 v139, a147
    v_accvgpr_read_b32 v140, a148
    v_accvgpr_read_b32 v141, a149
    v_accvgpr_read_b32 v142, a150
    v_accvgpr_read_b32 v143, a151
    v_pk_mul_f32 v[136:137], v[136:137], v[4:5] op_sel:[0,0] op_sel_hi:[1,0]
    v_pk_mul_f32 v[138:139], v[138:139], v[4:5] op_sel:[0,0] op_sel_hi:[1,0]
    v_pk_mul_f32 v[140:141], v[140:141], v[4:5] op_sel:[0,0] op_sel_hi:[1,0]
    v_pk_mul_f32 v[142:143], v[142:143], v[4:5] op_sel:[0,0] op_sel_hi:[1,0]
    v_cvt_pk_bf16_f32 v184, v136, v137
    v_cvt_pk_bf16_f32 v185, v138, v139
    v_cvt_pk_bf16_f32 v186, v140, v141
    v_cvt_pk_bf16_f32 v187, v142, v143
    v_accvgpr_read_b32 v144, a208
    v_accvgpr_read_b32 v145, a209
    v_accvgpr_read_b32 v146, a210
    v_accvgpr_read_b32 v147, a211
    v_accvgpr_read_b32 v148, a212
    v_accvgpr_read_b32 v149, a213
    v_accvgpr_read_b32 v150, a214
    v_accvgpr_read_b32 v151, a215
    v_pk_mul_f32 v[144:145], v[144:145], v[6:7] op_sel:[0,0] op_sel_hi:[1,0]
    v_pk_mul_f32 v[146:147], v[146:147], v[6:7] op_sel:[0,0] op_sel_hi:[1,0]
    v_pk_mul_f32 v[148:149], v[148:149], v[6:7] op_sel:[0,0] op_sel_hi:[1,0]
    v_pk_mul_f32 v[150:151], v[150:151], v[6:7] op_sel:[0,0] op_sel_hi:[1,0]
    v_cvt_pk_bf16_f32 v192, v144, v145
    v_cvt_pk_bf16_f32 v193, v146, v147
    v_cvt_pk_bf16_f32 v194, v148, v149
    v_cvt_pk_bf16_f32 v195, v150, v151
    v_accvgpr_read_b32 v136, a176
    v_accvgpr_read_b32 v137, a177
    v_accvgpr_read_b32 v138, a178
    v_accvgpr_read_b32 v139, a179
    v_accvgpr_read_b32 v140, a180
    v_accvgpr_read_b32 v141, a181
    v_accvgpr_read_b32 v142, a182
    v_accvgpr_read_b32 v143, a183
    v_pk_mul_f32 v[136:137], v[136:137], v[4:5] op_sel:[0,1] op_sel_hi:[1,1]
    v_pk_mul_f32 v[138:139], v[138:139], v[4:5] op_sel:[0,1] op_sel_hi:[1,1]
    v_pk_mul_f32 v[140:141], v[140:141], v[4:5] op_sel:[0,1] op_sel_hi:[1,1]
    v_pk_mul_f32 v[142:143], v[142:143], v[4:5] op_sel:[0,1] op_sel_hi:[1,1]
    v_cvt_pk_bf16_f32 v188, v136, v137
    v_cvt_pk_bf16_f32 v189, v138, v139
    v_cvt_pk_bf16_f32 v190, v140, v141
    v_cvt_pk_bf16_f32 v191, v142, v143
    v_accvgpr_read_b32 v144, a240
    v_accvgpr_read_b32 v145, a241
    v_accvgpr_read_b32 v146, a242
    v_accvgpr_read_b32 v147, a243
    v_accvgpr_read_b32 v148, a244
    v_accvgpr_read_b32 v149, a245
    v_accvgpr_read_b32 v150, a246
    v_accvgpr_read_b32 v151, a247
    v_pk_mul_f32 v[144:145], v[144:145], v[6:7] op_sel:[0,1] op_sel_hi:[1,1]
    v_pk_mul_f32 v[146:147], v[146:147], v[6:7] op_sel:[0,1] op_sel_hi:[1,1]
    v_pk_mul_f32 v[148:149], v[148:149], v[6:7] op_sel:[0,1] op_sel_hi:[1,1]
    v_pk_mul_f32 v[150:151], v[150:151], v[6:7] op_sel:[0,1] op_sel_hi:[1,1]
    v_cvt_pk_bf16_f32 v196, v144, v145
    v_cvt_pk_bf16_f32 v197, v146, v147
    v_cvt_pk_bf16_f32 v198, v148, v149
    v_cvt_pk_bf16_f32 v199, v150, v151
    v_accvgpr_read_b32 v136, a152
    v_accvgpr_read_b32 v137, a153
    v_accvgpr_read_b32 v138, a154
    v_accvgpr_read_b32 v139, a155
    v_accvgpr_read_b32 v140, a156
    v_accvgpr_read_b32 v141, a157
    v_accvgpr_read_b32 v142, a158
    v_accvgpr_read_b32 v143, a159
    v_pk_mul_f32 v[136:137], v[136:137], v[4:5] op_sel:[0,0] op_sel_hi:[1,0]
    v_pk_mul_f32 v[138:139], v[138:139], v[4:5] op_sel:[0,0] op_sel_hi:[1,0]
    v_pk_mul_f32 v[140:141], v[140:141], v[4:5] op_sel:[0,0] op_sel_hi:[1,0]
    v_pk_mul_f32 v[142:143], v[142:143], v[4:5] op_sel:[0,0] op_sel_hi:[1,0]
    v_cvt_pk_bf16_f32 v200, v136, v137
    v_cvt_pk_bf16_f32 v201, v138, v139
    v_cvt_pk_bf16_f32 v202, v140, v141
    v_cvt_pk_bf16_f32 v203, v142, v143
    v_accvgpr_read_b32 v144, a216
    v_accvgpr_read_b32 v145, a217
    v_accvgpr_read_b32 v146, a218
    v_accvgpr_read_b32 v147, a219
    v_accvgpr_read_b32 v148, a220
    v_accvgpr_read_b32 v149, a221
    v_accvgpr_read_b32 v150, a222
    v_accvgpr_read_b32 v151, a223
    v_pk_mul_f32 v[144:145], v[144:145], v[6:7] op_sel:[0,0] op_sel_hi:[1,0]
    v_pk_mul_f32 v[146:147], v[146:147], v[6:7] op_sel:[0,0] op_sel_hi:[1,0]
    v_pk_mul_f32 v[148:149], v[148:149], v[6:7] op_sel:[0,0] op_sel_hi:[1,0]
    v_pk_mul_f32 v[150:151], v[150:151], v[6:7] op_sel:[0,0] op_sel_hi:[1,0]
    v_cvt_pk_bf16_f32 v208, v144, v145
    v_cvt_pk_bf16_f32 v209, v146, v147
    v_cvt_pk_bf16_f32 v210, v148, v149
    v_cvt_pk_bf16_f32 v211, v150, v151
    v_accvgpr_read_b32 v136, a184
    v_accvgpr_read_b32 v137, a185
    v_accvgpr_read_b32 v138, a186
    v_accvgpr_read_b32 v139, a187
    v_accvgpr_read_b32 v140, a188
    v_accvgpr_read_b32 v141, a189
    v_accvgpr_read_b32 v142, a190
    v_accvgpr_read_b32 v143, a191
    v_pk_mul_f32 v[136:137], v[136:137], v[4:5] op_sel:[0,1] op_sel_hi:[1,1]
    v_pk_mul_f32 v[138:139], v[138:139], v[4:5] op_sel:[0,1] op_sel_hi:[1,1]
    v_pk_mul_f32 v[140:141], v[140:141], v[4:5] op_sel:[0,1] op_sel_hi:[1,1]
    v_pk_mul_f32 v[142:143], v[142:143], v[4:5] op_sel:[0,1] op_sel_hi:[1,1]
    v_cvt_pk_bf16_f32 v204, v136, v137
    v_cvt_pk_bf16_f32 v205, v138, v139
    v_cvt_pk_bf16_f32 v206, v140, v141
    v_cvt_pk_bf16_f32 v207, v142, v143
    v_accvgpr_read_b32 v144, a248
    v_accvgpr_read_b32 v145, a249
    v_accvgpr_read_b32 v146, a250
    v_accvgpr_read_b32 v147, a251
    v_accvgpr_read_b32 v148, a252
    v_accvgpr_read_b32 v149, a253
    v_accvgpr_read_b32 v150, a254
    v_accvgpr_read_b32 v151, a255
    v_pk_mul_f32 v[144:145], v[144:145], v[6:7] op_sel:[0,1] op_sel_hi:[1,1]
    v_pk_mul_f32 v[146:147], v[146:147], v[6:7] op_sel:[0,1] op_sel_hi:[1,1]
    v_pk_mul_f32 v[148:149], v[148:149], v[6:7] op_sel:[0,1] op_sel_hi:[1,1]
    v_pk_mul_f32 v[150:151], v[150:151], v[6:7] op_sel:[0,1] op_sel_hi:[1,1]
    v_cvt_pk_bf16_f32 v212, v144, v145
    v_cvt_pk_bf16_f32 v213, v146, v147
    v_cvt_pk_bf16_f32 v214, v148, v149
    v_cvt_pk_bf16_f32 v215, v150, v151
    s_waitcnt vmcnt(0)
    buffer_store_dword v254, off, s[16:19], s57 sc1
    s_mov_b32 s15, 0
mk_pollo:
    buffer_load_dword v230, v231, s[16:19], s59 offen sc1
    s_waitcnt vmcnt(0)
    v_cmp_ne_u32 vcc, 1, v230
    s_nop 0
    s_cbranch_vccz mk_pollo_ok
    s_add_u32 s15, s15, 1
    s_cmp_ge_u32 s15, 200000
    s_cbranch_scc1 mk_pollo_ok
    s_branch mk_pollo
mk_pollo_ok:
    s_add_u32 s100, s69, 0
    buffer_load_dwordx4 v[8:11], v3, s[64:67], s100 offen offset:0 sc1
    s_add_u32 s100, s69, 0
    buffer_load_dwordx4 v[12:15], v3, s[64:67], s100 offen offset:1024 sc1
    s_add_u32 s100, s69, 0
    buffer_load_dwordx4 v[16:19], v3, s[64:67], s100 offen offset:2048 sc1
    s_add_u32 s100, s69, 0
    buffer_load_dwordx4 v[20:23], v3, s[64:67], s100 offen offset:3072 sc1
    s_add_u32 s100, s69, 16384
    buffer_load_dwordx4 v[24:27], v3, s[64:67], s100 offen offset:0 sc1
    s_add_u32 s100, s69, 16384
    buffer_load_dwordx4 v[28:31], v3, s[64:67], s100 offen offset:1024 sc1
    s_add_u32 s100, s69, 16384
    buffer_load_dwordx4 v[32:35], v3, s[64:67], s100 offen offset:2048 sc1
    s_add_u32 s100, s69, 16384
    buffer_load_dwordx4 v[36:39], v3, s[64:67], s100 offen offset:3072 sc1
    s_add_u32 s100, s69, 65536
    buffer_load_dwordx4 v[40:43], v3, s[64:67], s100 offen offset:0 sc1
    s_add_u32 s100, s69, 65536
    buffer_load_dwordx4 v[44:47], v3, s[64:67], s100 offen offset:1024 sc1
    s_add_u32 s100, s69, 65536
    buffer_load_dwordx4 v[48:51], v3, s[64:67], s100 offen offset:2048 sc1
    s_add_u32 s100, s69, 65536
    buffer_load_dwordx4 v[52:55], v3, s[64:67], s100 offen offset:3072 sc1
    s_add_u32 s100, s69, 81920
    buffer_load_dwordx4 v[56:59], v3, s[64:67], s100 offen offset:0 sc1
    s_add_u32 s100, s69, 81920
    buffer_load_dwordx4 v[60:63], v3, s[64:67], s100 offen offset:1024 sc1
    s_add_u32 s100, s69, 81920
    buffer_load_dwordx4 v[64:67], v3, s[64:67], s100 offen offset:2048 sc1
    s_add_u32 s100, s69, 81920
    buffer_load_dwordx4 v[68:71], v3, s[64:67], s100 offen offset:3072 sc1
    v_mov_b32 v229, v228
    v_lshlrev_b32 v4, 3, v2
    s_barrier
    ds_read_b64_tr_b16 v[136:137], v229 offset:0
    ds_read_b64_tr_b16 v[138:139], v229 offset:4608
    ds_read_b64_tr_b16 v[140:141], v229 offset:32
    ds_read_b64_tr_b16 v[142:143], v229 offset:4640
    ds_read_b64_tr_b16 v[144:145], v229 offset:64
    ds_read_b64_tr_b16 v[146:147], v229 offset:4672
    s_waitcnt lgkmcnt(4)
    s_waitcnt vmcnt(12)
    v_mfma_f32_16x16x32_bf16 a[0:3], v[136:139], v[8:11], 0
    v_mfma_f32_16x16x32_bf16 a[4:7], v[136:139], v[12:15], 0
    ds_read_b64_tr_b16 v[148:149], v229 offset:96
    v_mfma_f32_16x16x32_bf16 a[8:11], v[136:139], v[16:19], 0
    ds_read_b64_tr_b16 v[150:151], v229 offset:4704
    v_mfma_f32_16x16x32_bf16 a[12:15], v[136:139], v[20:23], 0
    s_add_u32 s100, s69, 131072
    s_waitcnt lgkmcnt(4)
    v_mfma_f32_16x16x32_bf16 a[16:19], v[140:143], v[8:11], 0
    buffer_load_dwordx4 v[72:75], v3, s[64:67], s100 offen offset:0 sc1
    v_mfma_f32_16x16x32_bf16 a[20:23], v[140:143], v[12:15], 0
    ds_read_b64_tr_b16 v[136:137], v229 offset:128
    v_mfma_f32_16x16x32_bf16 a[24:27], v[140:143], v[16:19], 0
    ds_read_b64_tr_b16 v[138:139], v229 offset:4736
    v_mfma_f32_16x16x32_bf16 a[28:31], v[140:143], v[20:23], 0
    s_add_u32 s100, s69, 131072
    s_waitcnt lgkmcnt(4)
    v_mfma_f32_16x16x32_bf16 a[32:35], v[144:147], v[8:11], 0
    buffer_load_dwordx4 v[76:79], v3, s[64:67], s100 offen offset:1024 sc1
    v_mfma_f32_16x16x32_bf16 a[36:39], v[144:147], v[12:15], 0
    ds_read_b64_tr_b16 v[140:141], v229 offset:160
    v_mfma_f32_16x16x32_bf16 a[40:43], v[144:147], v[16:19], 0
    ds_read_b64_tr_b16 v[142:143], v229 offset:4768
    v_mfma_f32_16x16x32_bf16 a[44:47], v[144:147], v[20:23], 0
    s_add_u32 s100, s69, 131072
    s_waitcnt lgkmcnt(4)
    v_mfma_f32_16x16x32_bf16 a[48:51], v[148:151], v[8:11], 0
    buffer_load_dwordx4 v[80:83], v3, s[64:67], s100 offen offset:2048 sc1
    v_mfma_f32_16x16x32_bf16 a[52:55], v[148:151], v[12:15], 0
    ds_read_b64_tr_b16 v[144:145], v229 offset:192
    v_mfma_f32_16x16x32_bf16 a[56:59], v[148:151], v[16:19], 0
    ds_read_b64_tr_b16 v[146:147], v229 offset:4800
    v_mfma_f32_16x16x32_bf16 a[60:63], v[148:151], v[20:23], 0
    s_add_u32 s100, s69, 131072
    s_waitcnt lgkmcnt(4)
    v_mfma_f32_16x16x32_bf16 a[64:67], v[136:139], v[8:11], 0
    buffer_load_dwordx4 v[84:87], v3, s[64:67], s100 offen offset:3072 sc1
    v_mfma_f32_16x16x32_bf16 a[68:71], v[136:139], v[12:15], 0
    ds_read_b64_tr_b16 v[148:149], v229 offset:224
    v_mfma_f32_16x16x32_bf16 a[72:75], v[136:139], v[16:19], 0
    ds_read_b64_tr_b16 v[150:151], v229 offset:4832
    v_mfma_f32_16x16x32_bf16 a[76:79], v[136:139], v[20:23], 0
    s_add_u32 s100, s69, 147456
    s_waitcnt lgkmcnt(4)
    v_mfma_f32_16x16x32_bf16 a[80:83], v[140:143], v[8:11], 0
    buffer_load_dwordx4 v[88:91], v3, s[64:67], s100 offen offset:0 sc1
    v_mfma_f32_16x16x32_bf16 a[84:87], v[140:143], v[12:15], 0
    ds_read_b64_tr_b16 v[136:137], v229 offset:256
    v_mfma_f32_16x16x32_bf16 a[88:91], v[140:143], v[16:19], 0
    ds_read_b64_tr_b16 v[138:139], v229 offset:4864
    v_mfma_f32_16x16x32_bf16 a[92:95], v[140:143], v[20:23], 0
    s_add_u32 s100, s69, 147456
    s_waitcnt lgkmcnt(4)
    v_mfma_f32_16x16x32_bf16 a[96:99], v[144:147], v[8:11], 0
    buffer_load_dwordx4 v[92:95], v3, s[64:67], s100 offen offset:1024 sc1
    v_mfma_f32_16x16x32_bf16 a[100:103], v[144:147], v[12:15], 0
    ds_read_b64_tr_b16 v[140:141], v229 offset:9216
    v_mfma_f32_16x16x32_bf16 a[104:107], v[144:147], v[16:19], 0
    ds_read_b64_tr_b16 v[142:143], v229 offset:13824
    v_mfma_f32_16x16x32_bf16 a[108:111], v[144:147], v[20:23], 0
    s_add_u32 s100, s69, 147456
    s_waitcnt lgkmcnt(4)
    v_mfma_f32_16x16x32_bf16 a[112:115], v[148:151], v[8:11], 0
    buffer_load_dwordx4 v[96:99], v3, s[64:67], s100 offen offset:2048 sc1
    v_mfma_f32_16x16x32_bf16 a[116:119], v[148:151], v[12:15], 0
    ds_read_b64_tr_b16 v[144:145], v229 offset:9248
    v_mfma_f32_16x16x32_bf16 a[120:123], v[148:151], v[16:19], 0
    ds_read_b64_tr_b16 v[146:147], v229 offset:13856
    v_mfma_f32_16x16x32_bf16 a[124:127], v[148:151], v[20:23], 0
    s_add_u32 s100, s69, 147456
    s_waitcnt lgkmcnt(4)
    v_mfma_f32_16x16x32_bf16 a[128:131], v[136:139], v[8:11], 0
    buffer_load_dwordx4 v[100:103], v3, s[64:67], s100 offen offset:3072 sc1
    v_mfma_f32_16x16x32_bf16 a[132:135], v[136:139], v[12:15], 0
    ds_read_b64_tr_b16 v[148:149], v229 offset:9280
    v_mfma_f32_16x16x32_bf16 a[136:139], v[136:139], v[16:19], 0
    ds_read_b64_tr_b16 v[150:151], v229 offset:13888
    v_mfma_f32_16x16x32_bf16 a[140:143], v[136:139], v[20:23], 0
    s_add_u32 s100, s69, 262144
    s_waitcnt lgkmcnt(4)
    s_waitcnt vmcnt(16)
    v_mfma_f32_16x16x32_bf16 a[0:3], v[140:143], v[24:27], a[0:3]
    buffer_load_dwordx4 v[8:11], v3, s[64:67], s100 offen offset:0 sc1
    v_mfma_f32_16x16x32_bf16 a[4:7], v[140:143], v[28:31], a[4:7]
    ds_read_b64_tr_b16 v[136:137], v229 offset:9312
    v_mfma_f32_16x16x32_bf16 a[8:11], v[140:143], v[32:35], a[8:11]
    ds_read_b64_tr_b16 v[138:139], v229 offset:13920
    v_mfma_f32_16x16x32_bf16 a[12:15], v[140:143], v[36:39], a[12:15]
    s_add_u32 s100, s69, 262144
    s_waitcnt lgkmcnt(4)
    v_mfma_f32_16x16x32_bf16 a[16:19], v[144:147], v[24:27], a[16:19]
    buffer_load_dwordx4 v[12:15], v3, s[64:67], s100 offen offset:1024 sc1
    v_mfma_f32_16x16x32_bf16 a[20:23], v[144:147], v[28:31], a[20:23]
    ds_read_b64_tr_b16 v[140:141], v229 offset:9344
    v_mfma_f32_16x16x32_bf16 a[24:27], v[144:147], v[32:35], a[24:27]
    ds_read_b64_tr_b16 v[142:143], v229 offset:13952
    v_mfma_f32_16x16x32_bf16 a[28:31], v[144:147], v[36:39], a[28:31]
    s_add_u32 s100, s69, 262144
    s_waitcnt lgkmcnt(4)
    v_mfma_f32_16x16x32_bf16 a[32:35], v[148:151], v[24:27], a[32:35]
    buffer_load_dwordx4 v[16:19], v3, s[64:67], s100 offen offset:2048 sc1
    v_mfma_f32_16x16x32_bf16 a[36:39], v[148:151], v[28:31], a[36:39]
    ds_read_b64_tr_b16 v[144:145], v229 offset:9376
    v_mfma_f32_16x16x32_bf16 a[40:43], v[148:151], v[32:35], a[40:43]
    ds_read_b64_tr_b16 v[146:147], v229 offset:13984
    v_mfma_f32_16x16x32_bf16 a[44:47], v[148:151], v[36:39], a[44:47]
    s_add_u32 s100, s69, 262144
    s_waitcnt lgkmcnt(4)
    v_mfma_f32_16x16x32_bf16 a[48:51], v[136:139], v[24:27], a[48:51]
    buffer_load_dwordx4 v[20:23], v3, s[64:67], s100 offen offset:3072 sc1
    v_mfma_f32_16x16x32_bf16 a[52:55], v[136:139], v[28:31], a[52:55]
    ds_read_b64_tr_b16 v[148:149], v229 offset:9408
    v_mfma_f32_16x16x32_bf16 a[56:59], v[136:139], v[32:35], a[56:59]
    ds_read_b64_tr_b16 v[150:151], v229 offset:14016
    v_mfma_f32_16x16x32_bf16 a[60:63], v[136:139], v[36:39], a[60:63]
    s_add_u32 s100, s69, 196608
    s_waitcnt lgkmcnt(4)
    v_mfma_f32_16x16x32_bf16 a[64:67], v[140:143], v[24:27], a[64:67]
    buffer_load_dwordx4 v[104:107], v3, s[64:67], s100 offen offset:0 sc1
    v_mfma_f32_16x16x32_bf16 a[68:71], v[140:143], v[28:31], a[68:71]
    ds_read_b64_tr_b16 v[136:137], v229 offset:9440
    v_mfma_f32_16x16x32_bf16 a[72:75], v[140:143], v[32:35], a[72:75]
    ds_read_b64_tr_b16 v[138:139], v229 offset:14048
    v_mfma_f32_16x16x32_bf16 a[76:79], v[140:143], v[36:39], a[76:79]
    s_add_u32 s100, s69, 196608
    s_waitcnt lgkmcnt(4)
    v_mfma_f32_16x16x32_bf16 a[80:83], v[144:147], v[24:27], a[80:83]
    buffer_load_dwordx4 v[108:111], v3, s[64:67], s100 offen offset:1024 sc1
    v_mfma_f32_16x16x32_bf16 a[84:87], v[144:147], v[28:31], a[84:87]
    ds_read_b64_tr_b16 v[140:141], v229 offset:9472
    v_mfma_f32_16x16x32_bf16 a[88:91], v[144:147], v[32:35], a[88:91]
    ds_read_b64_tr_b16 v[142:143], v229 offset:14080
    v_mfma_f32_16x16x32_bf16 a[92:95], v[144:147], v[36:39], a[92:95]
    s_add_u32 s100, s69, 196608
    s_waitcnt lgkmcnt(4)
    v_mfma_f32_16x16x32_bf16 a[96:99], v[148:151], v[24:27], a[96:99]
    buffer_load_dwordx4 v[112:115], v3, s[64:67], s100 offen offset:2048 sc1
    v_mfma_f32_16x16x32_bf16 a[100:103], v[148:151], v[28:31], a[100:103]
    ds_read_b64_tr_b16 v[144:145], v229 offset:18432
    v_mfma_f32_16x16x32_bf16 a[104:107], v[148:151], v[32:35], a[104:107]
    ds_read_b64_tr_b16 v[146:147], v229 offset:23040
    v_mfma_f32_16x16x32_bf16 a[108:111], v[148:151], v[36:39], a[108:111]
    s_add_u32 s100, s69, 196608
    s_waitcnt lgkmcnt(4)
    v_mfma_f32_16x16x32_bf16 a[112:115], v[136:139], v[24:27], a[112:115]
    buffer_load_dwordx4 v[116:119], v3, s[64:67], s100 offen offset:3072 sc1
    v_mfma_f32_16x16x32_bf16 a[116:119], v[136:139], v[28:31], a[116:119]
    ds_read_b64_tr_b16 v[148:149], v229 offset:18464
    v_mfma_f32_16x16x32_bf16 a[120:123], v[136:139], v[32:35], a[120:123]
    ds_read_b64_tr_b16 v[150:151], v229 offset:23072
    v_mfma_f32_16x16x32_bf16 a[124:127], v[136:139], v[36:39], a[124:127]
    s_add_u32 s100, s69, 212992
    s_waitcnt lgkmcnt(4)
    v_mfma_f32_16x16x32_bf16 a[128:131], v[140:143], v[24:27], a[128:131]
    buffer_load_dwordx4 v[120:123], v3, s[64:67], s100 offen offset:0 sc1
    v_mfma_f32_16x16x32_bf16 a[132:135], v[140:143], v[28:31], a[132:135]
    ds_read_b64_tr_b16 v[136:137], v229 offset:18496
    v_mfma_f32_16x16x32_bf16 a[136:139], v[140:143], v[32:35], a[136:139]
    ds_read_b64_tr_b16 v[138:139], v229 offset:23104
    v_mfma_f32_16x16x32_bf16 a[140:143], v[140:143], v[36:39], a[140:143]
    s_add_u32 s100, s69, 278528
    s_waitcnt lgkmcnt(4)
    s_waitcnt vmcnt(21)
    v_mfma_f32_16x16x32_bf16 a[0:3], v[144:147], v[40:43], a[0:3]
    buffer_load_dwordx4 v[24:27], v3, s[64:67], s100 offen offset:0 sc1
    v_mfma_f32_16x16x32_bf16 a[4:7], v[144:147], v[44:47], a[4:7]
    ds_read_b64_tr_b16 v[140:141], v229 offset:18528
    v_mfma_f32_16x16x32_bf16 a[8:11], v[144:147], v[48:51], a[8:11]
    ds_read_b64_tr_b16 v[142:143], v229 offset:23136
    v_mfma_f32_16x16x32_bf16 a[12:15], v[144:147], v[52:55], a[12:15]
    s_add_u32 s100, s69, 278528
    s_waitcnt lgkmcnt(4)
    v_mfma_f32_16x16x32_bf16 a[16:19], v[148:151], v[40:43], a[16:19]
    buffer_load_dwordx4 v[28:31], v3, s[64:67], s100 offen offset:1024 sc1
    v_mfma_f32_16x16x32_bf16 a[20:23], v[148:151], v[44:47], a[20:23]
    ds_read_b64_tr_b16 v[144:145], v229 offset:18560
    v_mfma_f32_16x16x32_bf16 a[24:27], v[148:151], v[48:51], a[24:27]
    ds_read_b64_tr_b16 v[146:147], v229 offset:23168
    v_mfma_f32_16x16x32_bf16 a[28:31], v[148:151], v[52:55], a[28:31]
    s_add_u32 s100, s69, 278528
    s_waitcnt lgkmcnt(4)
    v_mfma_f32_16x16x32_bf16 a[32:35], v[136:139], v[40:43], a[32:35]
    buffer_load_dwordx4 v[32:35], v3, s[64:67], s100 offen offset:2048 sc1
    v_mfma_f32_16x16x32_bf16 a[36:39], v[136:139], v[44:47], a[36:39]
    ds_read_b64_tr_b16 v[148:149], v229 offset:18592
    v_mfma_f32_16x16x32_bf16 a[40:43], v[136:139], v[48:51], a[40:43]
    ds_read_b64_tr_b16 v[150:151], v229 offset:23200
    v_mfma_f32_16x16x32_bf16 a[44:47], v[136:139], v[52:55], a[44:47]
    s_add_u32 s100, s69, 278528
    s_waitcnt lgkmcnt(4)
    v_mfma_f32_16x16x32_bf16 a[48:51], v[140:143], v[40:43], a[48:51]
    buffer_load_dwordx4 v[36:39], v3, s[64:67], s100 offen offset:3072 sc1
    v_mfma_f32_16x16x32_bf16 a[52:55], v[140:143], v[44:47], a[52:55]
    ds_read_b64_tr_b16 v[136:137], v229 offset:18624
    v_mfma_f32_16x16x32_bf16 a[56:59], v[140:143], v[48:51], a[56:59]
    ds_read_b64_tr_b16 v[138:139], v229 offset:23232
    v_mfma_f32_16x16x32_bf16 a[60:63], v[140:143], v[52:55], a[60:63]
    s_add_u32 s100, s69, 212992
    s_waitcnt lgkmcnt(4)
    v_mfma_f32_16x16x32_bf16 a[64:67], v[144:147], v[40:43], a[64:67]
    buffer_load_dwordx4 v[124:127], v3, s[64:67], s100 offen offset:1024 sc1
    v_mfma_f32_16x16x32_bf16 a[68:71], v[144:147], v[44:47], a[68:71]
    ds_read_b64_tr_b16 v[140:141], v229 offset:18656
    v_mfma_f32_16x16x32_bf16 a[72:75], v[144:147], v[48:51], a[72:75]
    ds_read_b64_tr_b16 v[142:143], v229 offset:23264
    v_mfma_f32_16x16x32_bf16 a[76:79], v[144:147], v[52:55], a[76:79]
    s_add_u32 s100, s69, 212992
    s_waitcnt lgkmcnt(4)
    v_mfma_f32_16x16x32_bf16 a[80:83], v[148:151], v[40:43], a[80:83]
    buffer_load_dwordx4 v[128:131], v3, s[64:67], s100 offen offset:2048 sc1
    v_mfma_f32_16x16x32_bf16 a[84:87], v[148:151], v[44:47], a[84:87]
    ds_read_b64_tr_b16 v[144:145], v229 offset:18688
    v_mfma_f32_16x16x32_bf16 a[88:91], v[148:151], v[48:51], a[88:91]
    ds_read_b64_tr_b16 v[146:147], v229 offset:23296
    v_mfma_f32_16x16x32_bf16 a[92:95], v[148:151], v[52:55], a[92:95]
    s_add_u32 s100, s69, 212992
    s_waitcnt lgkmcnt(4)
    v_mfma_f32_16x16x32_bf16 a[96:99], v[136:139], v[40:43], a[96:99]
    buffer_load_dwordx4 v[132:135], v3, s[64:67], s100 offen offset:3072 sc1
    v_mfma_f32_16x16x32_bf16 a[100:103], v[136:139], v[44:47], a[100:103]
    ds_read_b64_tr_b16 v[148:149], v229 offset:27648
    v_mfma_f32_16x16x32_bf16 a[104:107], v[136:139], v[48:51], a[104:107]
    ds_read_b64_tr_b16 v[150:151], v229 offset:32256
    v_mfma_f32_16x16x32_bf16 a[108:111], v[136:139], v[52:55], a[108:111]
    s_add_u32 s25, s24, 32768
    s_waitcnt lgkmcnt(4)
    v_mfma_f32_16x16x32_bf16 a[112:115], v[140:143], v[40:43], a[112:115]
    buffer_store_dwordx4 v[184:187], v3, s[16:19], s25 offen offset:0 sc1
    v_mfma_f32_16x16x32_bf16 a[116:119], v[140:143], v[44:47], a[116:119]
    ds_read_b64_tr_b16 v[136:137], v229 offset:27680
    v_mfma_f32_16x16x32_bf16 a[120:123], v[140:143], v[48:51], a[120:123]
    ds_read_b64_tr_b16 v[138:139], v229 offset:32288
    v_mfma_f32_16x16x32_bf16 a[124:127], v[140:143], v[52:55], a[124:127]
    s_add_u32 s25, s24, 32768
    s_waitcnt lgkmcnt(4)
    v_mfma_f32_16x16x32_bf16 a[128:131], v[144:147], v[40:43], a[128:131]
    buffer_store_dwordx4 v[192:195], v3, s[16:19], s25 offen offset:2048 sc1
    v_mfma_f32_16x16x32_bf16 a[132:135], v[144:147], v[44:47], a[132:135]
    ds_read_b64_tr_b16 v[140:141], v229 offset:27712
    v_mfma_f32_16x16x32_bf16 a[136:139], v[144:147], v[48:51], a[136:139]
    ds_read_b64_tr_b16 v[142:143], v229 offset:32320
    v_mfma_f32_16x16x32_bf16 a[140:143], v[144:147], v[52:55], a[140:143]
    s_add_u32 s100, s69, 327680
    s_waitcnt lgkmcnt(4)
    s_waitcnt vmcnt(26)
    v_mfma_f32_16x16x32_bf16 a[0:3], v[148:151], v[56:59], a[0:3]
    buffer_load_dwordx4 v[40:43], v3, s[64:67], s100 offen offset:0 sc1
    v_mfma_f32_16x16x32_bf16 a[4:7], v[148:151], v[60:63], a[4:7]
    ds_read_b64_tr_b16 v[144:145], v229 offset:27744
    v_mfma_f32_16x16x32_bf16 a[8:11], v[148:151], v[64:67], a[8:11]
    ds_read_b64_tr_b16 v[146:147], v229 offset:32352
    v_mfma_f32_16x16x32_bf16 a[12:15], v[148:151], v[68:71], a[12:15]
    s_add_u32 s100, s69, 327680
    s_waitcnt lgkmcnt(4)
    v_mfma_f32_16x16x32_bf16 a[16:19], v[136:139], v[56:59], a[16:19]
    buffer_load_dwordx4 v[44:47], v3, s[64:67], s100 offen offset:1024 sc1
    v_mfma_f32_16x16x32_bf16 a[20:23], v[136:139], v[60:63], a[20:23]
    ds_read_b64_tr_b16 v[148:149], v229 offset:27776
    v_mfma_f32_16x16x32_bf16 a[24:27], v[136:139], v[64:67], a[24:27]
    ds_read_b64_tr_b16 v[150:151], v229 offset:32384
    v_mfma_f32_16x16x32_bf16 a[28:31], v[136:139], v[68:71], a[28:31]
    s_add_u32 s100, s69, 327680
    s_waitcnt lgkmcnt(4)
    v_mfma_f32_16x16x32_bf16 a[32:35], v[140:143], v[56:59], a[32:35]
    buffer_load_dwordx4 v[48:51], v3, s[64:67], s100 offen offset:2048 sc1
    v_mfma_f32_16x16x32_bf16 a[36:39], v[140:143], v[60:63], a[36:39]
    ds_read_b64_tr_b16 v[136:137], v229 offset:27808
    v_mfma_f32_16x16x32_bf16 a[40:43], v[140:143], v[64:67], a[40:43]
    ds_read_b64_tr_b16 v[138:139], v229 offset:32416
    v_mfma_f32_16x16x32_bf16 a[44:47], v[140:143], v[68:71], a[44:47]
    s_add_u32 s100, s69, 327680
    s_waitcnt lgkmcnt(4)
    v_mfma_f32_16x16x32_bf16 a[48:51], v[144:147], v[56:59], a[48:51]
    buffer_load_dwordx4 v[52:55], v3, s[64:67], s100 offen offset:3072 sc1
    v_mfma_f32_16x16x32_bf16 a[52:55], v[144:147], v[60:63], a[52:55]
    ds_read_b64_tr_b16 v[140:141], v229 offset:27840
    v_mfma_f32_16x16x32_bf16 a[56:59], v[144:147], v[64:67], a[56:59]
    ds_read_b64_tr_b16 v[142:143], v229 offset:32448
    v_mfma_f32_16x16x32_bf16 a[60:63], v[144:147], v[68:71], a[60:63]
    s_add_u32 s25, s24, 32768
    s_waitcnt lgkmcnt(4)
    v_mfma_f32_16x16x32_bf16 a[64:67], v[148:151], v[56:59], a[64:67]
    buffer_store_dwordx4 v[188:191], v3, s[16:19], s25 offen offset:1024 sc1
    v_mfma_f32_16x16x32_bf16 a[68:71], v[148:151], v[60:63], a[68:71]
    ds_read_b64_tr_b16 v[144:145], v229 offset:27872
    v_mfma_f32_16x16x32_bf16 a[72:75], v[148:151], v[64:67], a[72:75]
    ds_read_b64_tr_b16 v[146:147], v229 offset:32480
    v_mfma_f32_16x16x32_bf16 a[76:79], v[148:151], v[68:71], a[76:79]
    s_add_u32 s25, s24, 32768
    s_waitcnt lgkmcnt(4)
    v_mfma_f32_16x16x32_bf16 a[80:83], v[136:139], v[56:59], a[80:83]
    buffer_store_dwordx4 v[196:199], v3, s[16:19], s25 offen offset:3072 sc1
    v_mfma_f32_16x16x32_bf16 a[84:87], v[136:139], v[60:63], a[84:87]
    ds_read_b64_tr_b16 v[148:149], v229 offset:27904
    v_mfma_f32_16x16x32_bf16 a[88:91], v[136:139], v[64:67], a[88:91]
    ds_read_b64_tr_b16 v[150:151], v229 offset:32512
    v_mfma_f32_16x16x32_bf16 a[92:95], v[136:139], v[68:71], a[92:95]
    s_add_u32 s25, s24, 49152
    s_waitcnt lgkmcnt(4)
    v_mfma_f32_16x16x32_bf16 a[96:99], v[140:143], v[56:59], a[96:99]
    s_waitcnt lgkmcnt(0)
    s_barrier
    v_add_u32 v229, 36864, v228
    buffer_store_dwordx4 v[200:203], v3, s[16:19], s25 offen offset:0 sc1
    v_mfma_f32_16x16x32_bf16 a[100:103], v[140:143], v[60:63], a[100:103]
    ds_read_b64_tr_b16 v[136:137], v229 offset:0
    v_mfma_f32_16x16x32_bf16 a[104:107], v[140:143], v[64:67], a[104:107]
    ds_read_b64_tr_b16 v[138:139], v229 offset:4608
    v_mfma_f32_16x16x32_bf16 a[108:111], v[140:143], v[68:71], a[108:111]
    s_add_u32 s25, s24, 49152
    v_mfma_f32_16x16x32_bf16 a[112:115], v[144:147], v[56:59], a[112:115]
    buffer_store_dwordx4 v[208:211], v3, s[16:19], s25 offen offset:2048 sc1
    v_mfma_f32_16x16x32_bf16 a[116:119], v[144:147], v[60:63], a[116:119]
    ds_read_b64_tr_b16 v[140:141], v229 offset:32
    v_mfma_f32_16x16x32_bf16 a[120:123], v[144:147], v[64:67], a[120:123]
    ds_read_b64_tr_b16 v[142:143], v229 offset:4640
    v_mfma_f32_16x16x32_bf16 a[124:127], v[144:147], v[68:71], a[124:127]
    s_add_u32 s25, s24, 49152
    v_mfma_f32_16x16x32_bf16 a[128:131], v[148:151], v[56:59], a[128:131]
    buffer_store_dwordx4 v[204:207], v3, s[16:19], s25 offen offset:1024 sc1
    v_mfma_f32_16x16x32_bf16 a[132:135], v[148:151], v[60:63], a[132:135]
    ds_read_b64_tr_b16 v[144:145], v229 offset:64
    v_mfma_f32_16x16x32_bf16 a[136:139], v[148:151], v[64:67], a[136:139]
    ds_read_b64_tr_b16 v[146:147], v229 offset:4672
    v_mfma_f32_16x16x32_bf16 a[140:143], v[148:151], v[68:71], a[140:143]
    s_add_u32 s100, s69, 344064
    s_waitcnt lgkmcnt(4)
    s_waitcnt vmcnt(31)
    v_mfma_f32_16x16x32_bf16 a[0:3], v[136:139], v[72:75], a[0:3]
    buffer_load_dwordx4 v[56:59], v3, s[64:67], s100 offen offset:0 sc1
    v_mfma_f32_16x16x32_bf16 a[4:7], v[136:139], v[76:79], a[4:7]
    ds_read_b64_tr_b16 v[148:149], v229 offset:96
    v_mfma_f32_16x16x32_bf16 a[8:11], v[136:139], v[80:83], a[8:11]
    ds_read_b64_tr_b16 v[150:151], v229 offset:4704
    v_mfma_f32_16x16x32_bf16 a[12:15], v[136:139], v[84:87], a[12:15]
    s_add_u32 s100, s69, 344064
    s_waitcnt lgkmcnt(4)
    v_mfma_f32_16x16x32_bf16 a[16:19], v[140:143], v[72:75], a[16:19]
    buffer_load_dwordx4 v[60:63], v3, s[64:67], s100 offen offset:1024 sc1
    v_mfma_f32_16x16x32_bf16 a[20:23], v[140:143], v[76:79], a[20:23]
    ds_read_b64_tr_b16 v[136:137], v229 offset:128
    v_mfma_f32_16x16x32_bf16 a[24:27], v[140:143], v[80:83], a[24:27]
    ds_read_b64_tr_b16 v[138:139], v229 offset:4736
    v_mfma_f32_16x16x32_bf16 a[28:31], v[140:143], v[84:87], a[28:31]
    s_add_u32 s100, s69, 344064
    s_waitcnt lgkmcnt(4)
    v_mfma_f32_16x16x32_bf16 a[32:35], v[144:147], v[72:75], a[32:35]
    buffer_load_dwordx4 v[64:67], v3, s[64:67], s100 offen offset:2048 sc1
    v_mfma_f32_16x16x32_bf16 a[36:39], v[144:147], v[76:79], a[36:39]
    ds_read_b64_tr_b16 v[140:141], v229 offset:160
    v_mfma_f32_16x16x32_bf16 a[40:43], v[144:147], v[80:83], a[40:43]
    ds_read_b64_tr_b16 v[142:143], v229 offset:4768
    v_mfma_f32_16x16x32_bf16 a[44:47], v[144:147], v[84:87], a[44:47]
    s_add_u32 s100, s69, 344064
    s_waitcnt lgkmcnt(4)
    v_mfma_f32_16x16x32_bf16 a[48:51], v[148:151], v[72:75], a[48:51]
    buffer_load_dwordx4 v[68:71], v3, s[64:67], s100 offen offset:3072 sc1
    v_mfma_f32_16x16x32_bf16 a[52:55], v[148:151], v[76:79], a[52:55]
    ds_read_b64_tr_b16 v[144:145], v229 offset:192
    v_mfma_f32_16x16x32_bf16 a[56:59], v[148:151], v[80:83], a[56:59]
    ds_read_b64_tr_b16 v[146:147], v229 offset:4800
    v_mfma_f32_16x16x32_bf16 a[60:63], v[148:151], v[84:87], a[60:63]
    s_add_u32 s25, s24, 49152
    s_waitcnt lgkmcnt(4)
    v_mfma_f32_16x16x32_bf16 a[64:67], v[136:139], v[72:75], a[64:67]
    buffer_store_dwordx4 v[212:215], v3, s[16:19], s25 offen offset:3072 sc1
    v_mfma_f32_16x16x32_bf16 a[68:71], v[136:139], v[76:79], a[68:71]
    ds_read_b64_tr_b16 v[148:149], v229 offset:224
    v_mfma_f32_16x16x32_bf16 a[72:75], v[136:139], v[80:83], a[72:75]
    ds_read_b64_tr_b16 v[150:151], v229 offset:4832
    v_mfma_f32_16x16x32_bf16 a[76:79], v[136:139], v[84:87], a[76:79]
    s_add_u32 s99, s68, 884736
    s_add_u32 m0, s70, 110592
    s_waitcnt lgkmcnt(4)
    v_mfma_f32_16x16x32_bf16 a[80:83], v[140:143], v[72:75], a[80:83]
    buffer_load_dwordx4 v219, s[60:63], s99 offen offset:0 lds
    v_mfma_f32_16x16x32_bf16 a[84:87], v[140:143], v[76:79], a[84:87]
    ds_read_b64_tr_b16 v[136:137], v229 offset:256
    v_mfma_f32_16x16x32_bf16 a[88:91], v[140:143], v[80:83], a[88:91]
    ds_read_b64_tr_b16 v[138:139], v229 offset:4864
    v_mfma_f32_16x16x32_bf16 a[92:95], v[140:143], v[84:87], a[92:95]
    s_waitcnt lgkmcnt(4)
    v_mfma_f32_16x16x32_bf16 a[96:99], v[144:147], v[72:75], a[96:99]
    buffer_load_dwordx4 v220, s[60:63], s99 offen offset:1024 lds
    v_mfma_f32_16x16x32_bf16 a[100:103], v[144:147], v[76:79], a[100:103]
    ds_read_b64_tr_b16 v[140:141], v229 offset:9216
    v_mfma_f32_16x16x32_bf16 a[104:107], v[144:147], v[80:83], a[104:107]
    ds_read_b64_tr_b16 v[142:143], v229 offset:13824
    v_mfma_f32_16x16x32_bf16 a[108:111], v[144:147], v[84:87], a[108:111]
    s_waitcnt lgkmcnt(4)
    v_mfma_f32_16x16x32_bf16 a[112:115], v[148:151], v[72:75], a[112:115]
    buffer_load_dwordx4 v221, s[60:63], s99 offen offset:2048 lds
    v_mfma_f32_16x16x32_bf16 a[116:119], v[148:151], v[76:79], a[116:119]
    ds_read_b64_tr_b16 v[144:145], v229 offset:9248
    v_mfma_f32_16x16x32_bf16 a[120:123], v[148:151], v[80:83], a[120:123]
    ds_read_b64_tr_b16 v[146:147], v229 offset:13856
    v_mfma_f32_16x16x32_bf16 a[124:127], v[148:151], v[84:87], a[124:127]
    s_waitcnt lgkmcnt(4)
    v_mfma_f32_16x16x32_bf16 a[128:131], v[136:139], v[72:75], a[128:131]
    buffer_load_dwordx4 v222, s[60:63], s99 offen offset:3072 lds
    v_mfma_f32_16x16x32_bf16 a[132:135], v[136:139], v[76:79], a[132:135]
    ds_read_b64_tr_b16 v[148:149], v229 offset:9280
    v_mfma_f32_16x16x32_bf16 a[136:139], v[136:139], v[80:83], a[136:139]
    ds_read_b64_tr_b16 v[150:151], v229 offset:13888
    v_mfma_f32_16x16x32_bf16 a[140:143], v[136:139], v[84:87], a[140:143]
    s_add_u32 s100, s69, 393216
    s_waitcnt lgkmcnt(4)
    s_waitcnt vmcnt(36)
    s_waitcnt vmcnt(4)
    buffer_store_dword v254, off, s[16:19], s23 sc1
    v_mfma_f32_16x16x32_bf16 a[0:3], v[140:143], v[88:91], a[0:3]
    buffer_load_dwordx4 v[72:75], v3, s[64:67], s100 offen offset:0 sc1
    v_mfma_f32_16x16x32_bf16 a[4:7], v[140:143], v[92:95], a[4:7]
    ds_read_b64_tr_b16 v[136:137], v229 offset:9312
    v_mfma_f32_16x16x32_bf16 a[8:11], v[140:143], v[96:99], a[8:11]
    ds_read_b64_tr_b16 v[138:139], v229 offset:13920
    v_mfma_f32_16x16x32_bf16 a[12:15], v[140:143], v[100:103], a[12:15]
    s_add_u32 s100, s69, 393216
    s_waitcnt lgkmcnt(4)
    v_mfma_f32_16x16x32_bf16 a[16:19], v[144:147], v[88:91], a[16:19]
    buffer_load_dwordx4 v[76:79], v3, s[64:67], s100 offen offset:1024 sc1
    v_mfma_f32_16x16x32_bf16 a[20:23], v[144:147], v[92:95], a[20:23]
    ds_read_b64_tr_b16 v[140:141], v229 offset:9344
    v_mfma_f32_16x16x32_bf16 a[24:27], v[144:147], v[96:99], a[24:27]
    ds_read_b64_tr_b16 v[142:143], v229 offset:13952
    v_mfma_f32_16x16x32_bf16 a[28:31], v[144:147], v[100:103], a[28:31]
    s_add_u32 s100, s69, 393216
    s_waitcnt lgkmcnt(4)
    v_mfma_f32_16x16x32_bf16 a[32:35], v[148:151], v[88:91], a[32:35]
    buffer_load_dwordx4 v[80:83], v3, s[64:67], s100 offen offset:2048 sc1
    v_mfma_f32_16x16x32_bf16 a[36:39], v[148:151], v[92:95], a[36:39]
    ds_read_b64_tr_b16 v[144:145], v229 offset:9376
    v_mfma_f32_16x16x32_bf16 a[40:43], v[148:151], v[96:99], a[40:43]
    ds_read_b64_tr_b16 v[146:147], v229 offset:13984
    v_mfma_f32_16x16x32_bf16 a[44:47], v[148:151], v[100:103], a[44:47]
    s_add_u32 s100, s69, 393216
    s_waitcnt lgkmcnt(4)
    v_mfma_f32_16x16x32_bf16 a[48:51], v[136:139], v[88:91], a[48:51]
    buffer_load_dwordx4 v[84:87], v3, s[64:67], s100 offen offset:3072 sc1
    v_mfma_f32_16x16x32_bf16 a[52:55], v[136:139], v[92:95], a[52:55]
    ds_read_b64_tr_b16 v[148:149], v229 offset:9408
    v_mfma_f32_16x16x32_bf16 a[56:59], v[136:139], v[96:99], a[56:59]
    ds_read_b64_tr_b16 v[150:151], v229 offset:14016
    v_mfma_f32_16x16x32_bf16 a[60:63], v[136:139], v[100:103], a[60:63]
    s_add_u32 m0, s70, 114688
    s_waitcnt lgkmcnt(4)
    v_mfma_f32_16x16x32_bf16 a[64:67], v[140:143], v[88:91], a[64:67]
    buffer_load_dwordx4 v223, s[60:63], s99 offen offset:0 lds
    v_mfma_f32_16x16x32_bf16 a[68:71], v[140:143], v[92:95], a[68:71]
    ds_read_b64_tr_b16 v[136:137], v229 offset:9440
    v_mfma_f32_16x16x32_bf16 a[72:75], v[140:143], v[96:99], a[72:75]
    ds_read_b64_tr_b16 v[138:139], v229 offset:14048
    v_mfma_f32_16x16x32_bf16 a[76:79], v[140:143], v[100:103], a[76:79]
    s_waitcnt lgkmcnt(4)
    v_mfma_f32_16x16x32_bf16 a[80:83], v[144:147], v[88:91], a[80:83]
    buffer_load_dwordx4 v224, s[60:63], s99 offen offset:1024 lds
    v_mfma_f32_16x16x32_bf16 a[84:87], v[144:147], v[92:95], a[84:87]
    ds_read_b64_tr_b16 v[140:141], v229 offset:9472
    v_mfma_f32_16x16x32_bf16 a[88:91], v[144:147], v[96:99], a[88:91]
    ds_read_b64_tr_b16 v[142:143], v229 offset:14080
    v_mfma_f32_16x16x32_bf16 a[92:95], v[144:147], v[100:103], a[92:95]
    s_waitcnt lgkmcnt(4)
    v_mfma_f32_16x16x32_bf16 a[96:99], v[148:151], v[88:91], a[96:99]
    buffer_load_dwordx4 v225, s[60:63], s99 offen offset:2048 lds
    v_mfma_f32_16x16x32_bf16 a[100:103], v[148:151], v[92:95], a[100:103]
    ds_read_b64_tr_b16 v[144:145], v229 offset:18432
    v_mfma_f32_16x16x32_bf16 a[104:107], v[148:151], v[96:99], a[104:107]
    ds_read_b64_tr_b16 v[146:147], v229 offset:23040
    v_mfma_f32_16x16x32_bf16 a[108:111], v[148:151], v[100:103], a[108:111]
    s_waitcnt lgkmcnt(4)
    v_mfma_f32_16x16x32_bf16 a[112:115], v[136:139], v[88:91], a[112:115]
    buffer_load_dwordx4 v226, s[60:63], s99 offen offset:3072 lds
    v_mfma_f32_16x16x32_bf16 a[116:119], v[136:139], v[92:95], a[116:119]
    ds_read_b64_tr_b16 v[148:149], v229 offset:18464
    v_mfma_f32_16x16x32_bf16 a[120:123], v[136:139], v[96:99], a[120:123]
    ds_read_b64_tr_b16 v[150:151], v229 offset:23072
    v_mfma_f32_16x16x32_bf16 a[124:127], v[136:139], v[100:103], a[124:127]
    s_add_u32 m0, s70, 118784
    s_waitcnt lgkmcnt(4)
    v_mfma_f32_16x16x32_bf16 a[128:131], v[140:143], v[88:91], a[128:131]
    buffer_load_dwordx4 v227, s[60:63], s99 offen offset:0 lds
    v_mfma_f32_16x16x32_bf16 a[132:135], v[140:143], v[92:95], a[132:135]
    ds_read_b64_tr_b16 v[136:137], v229 offset:18496
    v_mfma_f32_16x16x32_bf16 a[136:139], v[140:143], v[96:99], a[136:139]
    ds_read_b64_tr_b16 v[138:139], v229 offset:23104
    v_mfma_f32_16x16x32_bf16 a[140:143], v[140:143], v[100:103], a[140:143]
    s_add_u32 s100, s69, 409600
    s_waitcnt lgkmcnt(4)
    v_mfma_f32_16x16x32_bf16 a[0:3], v[144:147], v[104:107], a[0:3]
    buffer_load_dwordx4 v[88:91], v3, s[64:67], s100 offen offset:0 sc1
    v_mfma_f32_16x16x32_bf16 a[4:7], v[144:147], v[108:111], a[4:7]
    ds_read_b64_tr_b16 v[140:141], v229 offset:18528
    v_mfma_f32_16x16x32_bf16 a[8:11], v[144:147], v[112:115], a[8:11]
    ds_read_b64_tr_b16 v[142:143], v229 offset:23136
    v_mfma_f32_16x16x32_bf16 a[12:15], v[144:147], v[116:119], a[12:15]
    s_add_u32 s100, s69, 409600
    s_waitcnt lgkmcnt(4)
    v_mfma_f32_16x16x32_bf16 a[16:19], v[148:151], v[104:107], a[16:19]
    buffer_load_dwordx4 v[92:95], v3, s[64:67], s100 offen offset:1024 sc1
    v_mfma_f32_16x16x32_bf16 a[20:23], v[148:151], v[108:111], a[20:23]
    ds_read_b64_tr_b16 v[144:145], v229 offset:18560
    v_mfma_f32_16x16x32_bf16 a[24:27], v[148:151], v[112:115], a[24:27]
    ds_read_b64_tr_b16 v[146:147], v229 offset:23168
    v_mfma_f32_16x16x32_bf16 a[28:31], v[148:151], v[116:119], a[28:31]
    s_add_u32 s100, s69, 409600
    s_waitcnt lgkmcnt(4)
    v_mfma_f32_16x16x32_bf16 a[32:35], v[136:139], v[104:107], a[32:35]
    buffer_load_dwordx4 v[96:99], v3, s[64:67], s100 offen offset:2048 sc1
    v_mfma_f32_16x16x32_bf16 a[36:39], v[136:139], v[108:111], a[36:39]
    ds_read_b64_tr_b16 v[148:149], v229 offset:18592
    v_mfma_f32_16x16x32_bf16 a[40:43], v[136:139], v[112:115], a[40:43]
    ds_read_b64_tr_b16 v[150:151], v229 offset:23200
    v_mfma_f32_16x16x32_bf16 a[44:47], v[136:139], v[116:119], a[44:47]
    s_add_u32 s100, s69, 409600
    s_waitcnt lgkmcnt(4)
    v_mfma_f32_16x16x32_bf16 a[48:51], v[140:143], v[104:107], a[48:51]
    buffer_load_dwordx4 v[100:103], v3, s[64:67], s100 offen offset:3072 sc1
    v_mfma_f32_16x16x32_bf16 a[52:55], v[140:143], v[108:111], a[52:55]
    ds_read_b64_tr_b16 v[136:137], v229 offset:18624
    v_mfma_f32_16x16x32_bf16 a[56:59], v[140:143], v[112:115], a[56:59]
    ds_read_b64_tr_b16 v[138:139], v229 offset:23232
    v_mfma_f32_16x16x32_bf16 a[60:63], v[140:143], v[116:119], a[60:63]
    s_add_u32 s99, s68, 73728
    s_add_u32 m0, s70, 0
    s_waitcnt lgkmcnt(4)
    v_mfma_f32_16x16x32_bf16 a[64:67], v[144:147], v[104:107], a[64:67]
    buffer_load_dwordx4 v219, s[60:63], s99 offen offset:0 lds
    v_mfma_f32_16x16x32_bf16 a[68:71], v[144:147], v[108:111], a[68:71]
    ds_read_b64_tr_b16 v[140:141], v229 offset:18656
    v_mfma_f32_16x16x32_bf16 a[72:75], v[144:147], v[112:115], a[72:75]
    ds_read_b64_tr_b16 v[142:143], v229 offset:23264
    v_mfma_f32_16x16x32_bf16 a[76:79], v[144:147], v[116:119], a[76:79]
    s_waitcnt lgkmcnt(4)
    v_mfma_f32_16x16x32_bf16 a[80:83], v[148:151], v[104:107], a[80:83]
    buffer_load_dwordx4 v220, s[60:63], s99 offen offset:1024 lds
    v_mfma_f32_16x16x32_bf16 a[84:87], v[148:151], v[108:111], a[84:87]
    ds_read_b64_tr_b16 v[144:145], v229 offset:18688
    v_mfma_f32_16x16x32_bf16 a[88:91], v[148:151], v[112:115], a[88:91]
    ds_read_b64_tr_b16 v[146:147], v229 offset:23296
    v_mfma_f32_16x16x32_bf16 a[92:95], v[148:151], v[116:119], a[92:95]
    s_waitcnt lgkmcnt(4)
    v_mfma_f32_16x16x32_bf16 a[96:99], v[136:139], v[104:107], a[96:99]
    buffer_load_dwordx4 v221, s[60:63], s99 offen offset:2048 lds
    v_mfma_f32_16x16x32_bf16 a[100:103], v[136:139], v[108:111], a[100:103]
    ds_read_b64_tr_b16 v[148:149], v229 offset:27648
    v_mfma_f32_16x16x32_bf16 a[104:107], v[136:139], v[112:115], a[104:107]
    ds_read_b64_tr_b16 v[150:151], v229 offset:32256
    v_mfma_f32_16x16x32_bf16 a[108:111], v[136:139], v[116:119], a[108:111]
    s_waitcnt lgkmcnt(4)
    v_mfma_f32_16x16x32_bf16 a[112:115], v[140:143], v[104:107], a[112:115]
    buffer_load_dwordx4 v222, s[60:63], s99 offen offset:3072 lds
    v_mfma_f32_16x16x32_bf16 a[116:119], v[140:143], v[108:111], a[116:119]
    ds_read_b64_tr_b16 v[136:137], v229 offset:27680
    v_mfma_f32_16x16x32_bf16 a[120:123], v[140:143], v[112:115], a[120:123]
    ds_read_b64_tr_b16 v[138:139], v229 offset:32288
    v_mfma_f32_16x16x32_bf16 a[124:127], v[140:143], v[116:119], a[124:127]
    s_add_u32 m0, s70, 4096
    s_waitcnt lgkmcnt(4)
    v_mfma_f32_16x16x32_bf16 a[128:131], v[144:147], v[104:107], a[128:131]
    buffer_load_dwordx4 v223, s[60:63], s99 offen offset:0 lds
    v_mfma_f32_16x16x32_bf16 a[132:135], v[144:147], v[108:111], a[132:135]
    ds_read_b64_tr_b16 v[140:141], v229 offset:27712
    v_mfma_f32_16x16x32_bf16 a[136:139], v[144:147], v[112:115], a[136:139]
    ds_read_b64_tr_b16 v[142:143], v229 offset:32320
    v_mfma_f32_16x16x32_bf16 a[140:143], v[144:147], v[116:119], a[140:143]
    s_add_u32 s100, s69, 458752
    s_waitcnt lgkmcnt(4)
    v_mfma_f32_16x16x32_bf16 a[0:3], v[148:151], v[120:123], a[0:3]
    buffer_load_dwordx4 v[104:107], v3, s[64:67], s100 offen offset:0 sc1
    v_mfma_f32_16x16x32_bf16 a[4:7], v[148:151], v[124:127], a[4:7]
    ds_read_b64_tr_b16 v[144:145], v229 offset:27744
    v_mfma_f32_16x16x32_bf16 a[8:11], v[148:151], v[128:131], a[8:11]
    ds_read_b64_tr_b16 v[146:147], v229 offset:32352
    v_mfma_f32_16x16x32_bf16 a[12:15], v[148:151], v[132:135], a[12:15]
    s_add_u32 s100, s69, 458752
    s_waitcnt lgkmcnt(4)
    v_mfma_f32_16x16x32_bf16 a[16:19], v[136:139], v[120:123], a[16:19]
    buffer_load_dwordx4 v[108:111], v3, s[64:67], s100 offen offset:1024 sc1
    v_mfma_f32_16x16x32_bf16 a[20:23], v[136:139], v[124:127], a[20:23]
    ds_read_b64_tr_b16 v[148:149], v229 offset:27776
    v_mfma_f32_16x16x32_bf16 a[24:27], v[136:139], v[128:131], a[24:27]
    ds_read_b64_tr_b16 v[150:151], v229 offset:32384
    v_mfma_f32_16x16x32_bf16 a[28:31], v[136:139], v[132:135], a[28:31]
    s_add_u32 s100, s69, 458752
    s_waitcnt lgkmcnt(4)
    v_mfma_f32_16x16x32_bf16 a[32:35], v[140:143], v[120:123], a[32:35]
    buffer_load_dwordx4 v[112:115], v3, s[64:67], s100 offen offset:2048 sc1
    v_mfma_f32_16x16x32_bf16 a[36:39], v[140:143], v[124:127], a[36:39]
    ds_read_b64_tr_b16 v[136:137], v229 offset:27808
    v_mfma_f32_16x16x32_bf16 a[40:43], v[140:143], v[128:131], a[40:43]
    ds_read_b64_tr_b16 v[138:139], v229 offset:32416
    v_mfma_f32_16x16x32_bf16 a[44:47], v[140:143], v[132:135], a[44:47]
    s_add_u32 s100, s69, 458752
    s_waitcnt lgkmcnt(4)
    v_mfma_f32_16x16x32_bf16 a[48:51], v[144:147], v[120:123], a[48:51]
    buffer_load_dwordx4 v[116:119], v3, s[64:67], s100 offen offset:3072 sc1
    v_mfma_f32_16x16x32_bf16 a[52:55], v[144:147], v[124:127], a[52:55]
    ds_read_b64_tr_b16 v[140:141], v229 offset:27840
    v_mfma_f32_16x16x32_bf16 a[56:59], v[144:147], v[128:131], a[56:59]
    ds_read_b64_tr_b16 v[142:143], v229 offset:32448
    v_mfma_f32_16x16x32_bf16 a[60:63], v[144:147], v[132:135], a[60:63]
    s_waitcnt lgkmcnt(4)
    v_mfma_f32_16x16x32_bf16 a[64:67], v[148:151], v[120:123], a[64:67]
    buffer_load_dwordx4 v224, s[60:63], s99 offen offset:1024 lds
    v_mfma_f32_16x16x32_bf16 a[68:71], v[148:151], v[124:127], a[68:71]
    ds_read_b64_tr_b16 v[144:145], v229 offset:27872
    v_mfma_f32_16x16x32_bf16 a[72:75], v[148:151], v[128:131], a[72:75]
    ds_read_b64_tr_b16 v[146:147], v229 offset:32480
    v_mfma_f32_16x16x32_bf16 a[76:79], v[148:151], v[132:135], a[76:79]
    s_waitcnt lgkmcnt(4)
    v_mfma_f32_16x16x32_bf16 a[80:83], v[136:139], v[120:123], a[80:83]
    buffer_load_dwordx4 v225, s[60:63], s99 offen offset:2048 lds
    v_mfma_f32_16x16x32_bf16 a[84:87], v[136:139], v[124:127], a[84:87]
    ds_read_b64_tr_b16 v[148:149], v229 offset:27904
    v_mfma_f32_16x16x32_bf16 a[88:91], v[136:139], v[128:131], a[88:91]
    ds_read_b64_tr_b16 v[150:151], v229 offset:32512
    v_mfma_f32_16x16x32_bf16 a[92:95], v[136:139], v[132:135], a[92:95]
    s_waitcnt lgkmcnt(4)
    v_mfma_f32_16x16x32_bf16 a[96:99], v[140:143], v[120:123], a[96:99]
    s_waitcnt lgkmcnt(0)
    s_barrier
    v_add_u32 v229, 73728, v228
    buffer_load_dwordx4 v226, s[60:63], s99 offen offset:3072 lds
    v_mfma_f32_16x16x32_bf16 a[100:103], v[140:143], v[124:127], a[100:103]
    ds_read_b64_tr_b16 v[136:137], v229 offset:0
    v_mfma_f32_16x16x32_bf16 a[104:107], v[140:143], v[128:131], a[104:107]
    ds_read_b64_tr_b16 v[138:139], v229 offset:4608
    v_mfma_f32_16x16x32_bf16 a[108:111], v[140:143], v[132:135], a[108:111]
    s_add_u32 m0, s70, 8192
    v_mfma_f32_16x16x32_bf16 a[112:115], v[144:147], v[120:123], a[112:115]
    buffer_load_dwordx4 v227, s[60:63], s99 offen offset:0 lds
    v_mfma_f32_16x16x32_bf16 a[116:119], v[144:147], v[124:127], a[116:119]
    ds_read_b64_tr_b16 v[140:141], v229 offset:32
    v_mfma_f32_16x16x32_bf16 a[120:123], v[144:147], v[128:131], a[120:123]
    ds_read_b64_tr_b16 v[142:143], v229 offset:4640
    v_mfma_f32_16x16x32_bf16 a[124:127], v[144:147], v[132:135], a[124:127]
    s_add_u32 s99, s68, 368640
    s_add_u32 m0, s70, 36864
    v_mfma_f32_16x16x32_bf16 a[128:131], v[148:151], v[120:123], a[128:131]
    buffer_load_dwordx4 v219, s[60:63], s99 offen offset:0 lds
    v_mfma_f32_16x16x32_bf16 a[132:135], v[148:151], v[124:127], a[132:135]
    ds_read_b64_tr_b16 v[144:145], v229 offset:64
    v_mfma_f32_16x16x32_bf16 a[136:139], v[148:151], v[128:131], a[136:139]
    ds_read_b64_tr_b16 v[146:147], v229 offset:4672
    v_mfma_f32_16x16x32_bf16 a[140:143], v[148:151], v[132:135], a[140:143]
    s_add_u32 s100, s69, 475136
    s_waitcnt lgkmcnt(4)
    v_mfma_f32_16x16x32_bf16 a[0:3], v[136:139], v[8:11], a[0:3]
    buffer_load_dwordx4 v[120:123], v3, s[64:67], s100 offen offset:0 sc1
    v_mfma_f32_16x16x32_bf16 a[4:7], v[136:139], v[12:15], a[4:7]
    ds_read_b64_tr_b16 v[148:149], v229 offset:96
    v_mfma_f32_16x16x32_bf16 a[8:11], v[136:139], v[16:19], a[8:11]
    ds_read_b64_tr_b16 v[150:151], v229 offset:4704
    v_mfma_f32_16x16x32_bf16 a[12:15], v[136:139], v[20:23], a[12:15]
    s_add_u32 s100, s69, 475136
    s_waitcnt lgkmcnt(4)
    v_mfma_f32_16x16x32_bf16 a[16:19], v[140:143], v[8:11], a[16:19]
    buffer_load_dwordx4 v[124:127], v3, s[64:67], s100 offen offset:1024 sc1
    v_mfma_f32_16x16x32_bf16 a[20:23], v[140:143], v[12:15], a[20:23]
    ds_read_b64_tr_b16 v[136:137], v229 offset:128
    v_mfma_f32_16x16x32_bf16 a[24:27], v[140:143], v[16:19], a[24:27]
    ds_read_b64_tr_b16 v[138:139], v229 offset:4736
    v_mfma_f32_16x16x32_bf16 a[28:31], v[140:143], v[20:23], a[28:31]
    s_add_u32 s100, s69, 475136
    s_waitcnt lgkmcnt(4)
    v_mfma_f32_16x16x32_bf16 a[32:35], v[144:147], v[8:11], a[32:35]
    buffer_load_dwordx4 v[128:131], v3, s[64:67], s100 offen offset:2048 sc1
    v_mfma_f32_16x16x32_bf16 a[36:39], v[144:147], v[12:15], a[36:39]
    ds_read_b64_tr_b16 v[140:141], v229 offset:160
    v_mfma_f32_16x16x32_bf16 a[40:43], v[144:147], v[16:19], a[40:43]
    ds_read_b64_tr_b16 v[142:143], v229 offset:4768
    v_mfma_f32_16x16x32_bf16 a[44:47], v[144:147], v[20:23], a[44:47]
    s_add_u32 s100, s69, 475136
    s_waitcnt lgkmcnt(4)
    v_mfma_f32_16x16x32_bf16 a[48:51], v[148:151], v[8:11], a[48:51]
    buffer_load_dwordx4 v[132:135], v3, s[64:67], s100 offen offset:3072 sc1
    v_mfma_f32_16x16x32_bf16 a[52:55], v[148:151], v[12:15], a[52:55]
    ds_read_b64_tr_b16 v[144:145], v229 offset:192
    v_mfma_f32_16x16x32_bf16 a[56:59], v[148:151], v[16:19], a[56:59]
    ds_read_b64_tr_b16 v[146:147], v229 offset:4800
    v_mfma_f32_16x16x32_bf16 a[60:63], v[148:151], v[20:23], a[60:63]
    s_waitcnt lgkmcnt(4)
    v_mfma_f32_16x16x32_bf16 a[64:67], v[136:139], v[8:11], a[64:67]
    buffer_load_dwordx4 v220, s[60:63], s99 offen offset:1024 lds
    v_mfma_f32_16x16x32_bf16 a[68:71], v[136:139], v[12:15], a[68:71]
    ds_read_b64_tr_b16 v[148:149], v229 offset:224
    v_mfma_f32_16x16x32_bf16 a[72:75], v[136:139], v[16:19], a[72:75]
    ds_read_b64_tr_b16 v[150:151], v229 offset:4832
    v_mfma_f32_16x16x32_bf16 a[76:79], v[136:139], v[20:23], a[76:79]
    s_waitcnt lgkmcnt(4)
    v_mfma_f32_16x16x32_bf16 a[80:83], v[140:143], v[8:11], a[80:83]
    buffer_load_dwordx4 v221, s[60:63], s99 offen offset:2048 lds
    v_mfma_f32_16x16x32_bf16 a[84:87], v[140:143], v[12:15], a[84:87]
    ds_read_b64_tr_b16 v[136:137], v229 offset:256
    v_mfma_f32_16x16x32_bf16 a[88:91], v[140:143], v[16:19], a[88:91]
    ds_read_b64_tr_b16 v[138:139], v229 offset:4864
    v_mfma_f32_16x16x32_bf16 a[92:95], v[140:143], v[20:23], a[92:95]
    s_waitcnt lgkmcnt(4)
    v_mfma_f32_16x16x32_bf16 a[96:99], v[144:147], v[8:11], a[96:99]
    buffer_load_dwordx4 v222, s[60:63], s99 offen offset:3072 lds
    v_mfma_f32_16x16x32_bf16 a[100:103], v[144:147], v[12:15], a[100:103]
    ds_read_b64_tr_b16 v[140:141], v229 offset:9216
    v_mfma_f32_16x16x32_bf16 a[104:107], v[144:147], v[16:19], a[104:107]
    ds_read_b64_tr_b16 v[142:143], v229 offset:13824
    v_mfma_f32_16x16x32_bf16 a[108:111], v[144:147], v[20:23], a[108:111]
    s_add_u32 m0, s70, 40960
    s_waitcnt lgkmcnt(4)
    v_mfma_f32_16x16x32_bf16 a[112:115], v[148:151], v[8:11], a[112:115]
    buffer_load_dwordx4 v223, s[60:63], s99 offen offset:0 lds
    v_mfma_f32_16x16x32_bf16 a[116:119], v[148:151], v[12:15], a[116:119]
    ds_read_b64_tr_b16 v[144:145], v229 offset:9248
    v_mfma_f32_16x16x32_bf16 a[120:123], v[148:151], v[16:19], a[120:123]
    ds_read_b64_tr_b16 v[146:147], v229 offset:13856
    v_mfma_f32_16x16x32_bf16 a[124:127], v[148:151], v[20:23], a[124:127]
    s_waitcnt lgkmcnt(4)
    v_mfma_f32_16x16x32_bf16 a[128:131], v[136:139], v[8:11], a[128:131]
    buffer_load_dwordx4 v224, s[60:63], s99 offen offset:1024 lds
    v_mfma_f32_16x16x32_bf16 a[132:135], v[136:139], v[12:15], a[132:135]
    ds_read_b64_tr_b16 v[148:149], v229 offset:9280
    v_mfma_f32_16x16x32_bf16 a[136:139], v[136:139], v[16:19], a[136:139]
    ds_read_b64_tr_b16 v[150:151], v229 offset:13888
    v_mfma_f32_16x16x32_bf16 a[140:143], v[136:139], v[20:23], a[140:143]
    s_waitcnt lgkmcnt(4)
    v_mfma_f32_16x16x32_bf16 a[0:3], v[140:143], v[24:27], a[0:3]
    buffer_load_dword v230, v231, s[16:19], s22 offen sc1
    v_mfma_f32_16x16x32_bf16 a[4:7], v[140:143], v[28:31], a[4:7]
    ds_read_b64_tr_b16 v[136:137], v229 offset:9312
    v_mfma_f32_16x16x32_bf16 a[8:11], v[140:143], v[32:35], a[8:11]
    ds_read_b64_tr_b16 v[138:139], v229 offset:13920
    v_mfma_f32_16x16x32_bf16 a[12:15], v[140:143], v[36:39], a[12:15]
    s_waitcnt lgkmcnt(4)
    v_mfma_f32_16x16x32_bf16 a[16:19], v[144:147], v[24:27], a[16:19]
    buffer_load_dwordx4 v225, s[60:63], s99 offen offset:2048 lds
    v_mfma_f32_16x16x32_bf16 a[20:23], v[144:147], v[28:31], a[20:23]
    ds_read_b64_tr_b16 v[140:141], v229 offset:9344
    v_mfma_f32_16x16x32_bf16 a[24:27], v[144:147], v[32:35], a[24:27]
    ds_read_b64_tr_b16 v[142:143], v229 offset:13952
    v_mfma_f32_16x16x32_bf16 a[28:31], v[144:147], v[36:39], a[28:31]
    s_waitcnt lgkmcnt(4)
    v_mfma_f32_16x16x32_bf16 a[32:35], v[148:151], v[24:27], a[32:35]
    buffer_load_dwordx4 v226, s[60:63], s99 offen offset:3072 lds
    v_mfma_f32_16x16x32_bf16 a[36:39], v[148:151], v[28:31], a[36:39]
    ds_read_b64_tr_b16 v[144:145], v229 offset:9376
    v_mfma_f32_16x16x32_bf16 a[40:43], v[148:151], v[32:35], a[40:43]
    ds_read_b64_tr_b16 v[146:147], v229 offset:13984
    v_mfma_f32_16x16x32_bf16 a[44:47], v[148:151], v[36:39], a[44:47]
    s_add_u32 m0, s70, 45056
    s_waitcnt lgkmcnt(4)
    v_mfma_f32_16x16x32_bf16 a[48:51], v[136:139], v[24:27], a[48:51]
    buffer_load_dwordx4 v227, s[60:63], s99 offen offset:0 lds
    v_mfma_f32_16x16x32_bf16 a[52:55], v[136:139], v[28:31], a[52:55]
    ds_read_b64_tr_b16 v[148:149], v229 offset:9408
    v_mfma_f32_16x16x32_bf16 a[56:59], v[136:139], v[32:35], a[56:59]
    ds_read_b64_tr_b16 v[150:151], v229 offset:14016
    v_mfma_f32_16x16x32_bf16 a[60:63], v[136:139], v[36:39], a[60:63]
    s_waitcnt lgkmcnt(4)
    v_mfma_f32_16x16x32_bf16 a[64:67], v[140:143], v[24:27], a[64:67]
    v_mfma_f32_16x16x32_bf16 a[68:71], v[140:143], v[28:31], a[68:71]
    ds_read_b64_tr_b16 v[136:137], v229 offset:9440
    v_mfma_f32_16x16x32_bf16 a[72:75], v[140:143], v[32:35], a[72:75]
    ds_read_b64_tr_b16 v[138:139], v229 offset:14048
    v_mfma_f32_16x16x32_bf16 a[76:79], v[140:143], v[36:39], a[76:79]
    s_waitcnt lgkmcnt(4)
    v_mfma_f32_16x16x32_bf16 a[80:83], v[144:147], v[24:27], a[80:83]
    v_mfma_f32_16x16x32_bf16 a[84:87], v[144:147], v[28:31], a[84:87]
    ds_read_b64_tr_b16 v[140:141], v229 offset:9472
    v_mfma_f32_16x16x32_bf16 a[88:91], v[144:147], v[32:35], a[88:91]
    ds_read_b64_tr_b16 v[142:143], v229 offset:14080
    v_mfma_f32_16x16x32_bf16 a[92:95], v[144:147], v[36:39], a[92:95]
    s_waitcnt lgkmcnt(4)
    v_mfma_f32_16x16x32_bf16 a[96:99], v[148:151], v[24:27], a[96:99]
    v_mfma_f32_16x16x32_bf16 a[100:103], v[148:151], v[28:31], a[100:103]
    ds_read_b64_tr_b16 v[144:145], v229 offset:18432
    v_mfma_f32_16x16x32_bf16 a[104:107], v[148:151], v[32:35], a[104:107]
    ds_read_b64_tr_b16 v[146:147], v229 offset:23040
    v_mfma_f32_16x16x32_bf16 a[108:111], v[148:151], v[36:39], a[108:111]
    s_waitcnt lgkmcnt(4)
    v_mfma_f32_16x16x32_bf16 a[112:115], v[136:139], v[24:27], a[112:115]
    v_mfma_f32_16x16x32_bf16 a[116:119], v[136:139], v[28:31], a[116:119]
    ds_read_b64_tr_b16 v[148:149], v229 offset:18464
    v_mfma_f32_16x16x32_bf16 a[120:123], v[136:139], v[32:35], a[120:123]
    ds_read_b64_tr_b16 v[150:151], v229 offset:23072
    v_mfma_f32_16x16x32_bf16 a[124:127], v[136:139], v[36:39], a[124:127]
    s_waitcnt lgkmcnt(4)
    v_mfma_f32_16x16x32_bf16 a[128:131], v[140:143], v[24:27], a[128:131]
    v_mfma_f32_16x16x32_bf16 a[132:135], v[140:143], v[28:31], a[132:135]
    ds_read_b64_tr_b16 v[136:137], v229 offset:18496
    v_mfma_f32_16x16x32_bf16 a[136:139], v[140:143], v[32:35], a[136:139]
    ds_read_b64_tr_b16 v[138:139], v229 offset:23104
    v_mfma_f32_16x16x32_bf16 a[140:143], v[140:143], v[36:39], a[140:143]
    s_waitcnt lgkmcnt(4)
    v_mfma_f32_16x16x32_bf16 a[0:3], v[144:147], v[40:43], a[0:3]
    v_mfma_f32_16x16x32_bf16 a[4:7], v[144:147], v[44:47], a[4:7]
    ds_read_b64_tr_b16 v[140:141], v229 offset:18528
    v_mfma_f32_16x16x32_bf16 a[8:11], v[144:147], v[48:51], a[8:11]
    ds_read_b64_tr_b16 v[142:143], v229 offset:23136
    v_mfma_f32_16x16x32_bf16 a[12:15], v[144:147], v[52:55], a[12:15]
    s_waitcnt lgkmcnt(4)
    v_mfma_f32_16x16x32_bf16 a[16:19], v[148:151], v[40:43], a[16:19]
    v_mfma_f32_16x16x32_bf16 a[20:23], v[148:151], v[44:47], a[20:23]
    ds_read_b64_tr_b16 v[144:145], v229 offset:18560
    v_mfma_f32_16x16x32_bf16 a[24:27], v[148:151], v[48:51], a[24:27]
    ds_read_b64_tr_b16 v[146:147], v229 offset:23168
    v_mfma_f32_16x16x32_bf16 a[28:31], v[148:151], v[52:55], a[28:31]
    s_waitcnt lgkmcnt(4)
    v_mfma_f32_16x16x32_bf16 a[32:35], v[136:139], v[40:43], a[32:35]
    v_mfma_f32_16x16x32_bf16 a[36:39], v[136:139], v[44:47], a[36:39]
    ds_read_b64_tr_b16 v[148:149], v229 offset:18592
    v_mfma_f32_16x16x32_bf16 a[40:43], v[136:139], v[48:51], a[40:43]
    ds_read_b64_tr_b16 v[150:151], v229 offset:23200
    v_mfma_f32_16x16x32_bf16 a[44:47], v[136:139], v[52:55], a[44:47]
    s_waitcnt lgkmcnt(4)
    v_mfma_f32_16x16x32_bf16 a[48:51], v[140:143], v[40:43], a[48:51]
    v_mfma_f32_16x16x32_bf16 a[52:55], v[140:143], v[44:47], a[52:55]
    ds_read_b64_tr_b16 v[136:137], v229 offset:18624
    v_mfma_f32_16x16x32_bf16 a[56:59], v[140:143], v[48:51], a[56:59]
    ds_read_b64_tr_b16 v[138:139], v229 offset:23232
    v_mfma_f32_16x16x32_bf16 a[60:63], v[140:143], v[52:55], a[60:63]
    s_waitcnt lgkmcnt(4)
    v_mfma_f32_16x16x32_bf16 a[64:67], v[144:147], v[40:43], a[64:67]
    v_mfma_f32_16x16x32_bf16 a[68:71], v[144:147], v[44:47], a[68:71]
    ds_read_b64_tr_b16 v[140:141], v229 offset:18656
    v_mfma_f32_16x16x32_bf16 a[72:75], v[144:147], v[48:51], a[72:75]
    ds_read_b64_tr_b16 v[142:143], v229 offset:23264
    v_mfma_f32_16x16x32_bf16 a[76:79], v[144:147], v[52:55], a[76:79]
    s_waitcnt lgkmcnt(4)
    v_mfma_f32_16x16x32_bf16 a[80:83], v[148:151], v[40:43], a[80:83]
    v_mfma_f32_16x16x32_bf16 a[84:87], v[148:151], v[44:47], a[84:87]
    ds_read_b64_tr_b16 v[144:145], v229 offset:18688
    v_mfma_f32_16x16x32_bf16 a[88:91], v[148:151], v[48:51], a[88:91]
    ds_read_b64_tr_b16 v[146:147], v229 offset:23296
    v_mfma_f32_16x16x32_bf16 a[92:95], v[148:151], v[52:55], a[92:95]
    s_waitcnt lgkmcnt(4)
    v_mfma_f32_16x16x32_bf16 a[96:99], v[136:139], v[40:43], a[96:99]
    v_mfma_f32_16x16x32_bf16 a[100:103], v[136:139], v[44:47], a[100:103]
    ds_read_b64_tr_b16 v[148:149], v229 offset:27648
    v_mfma_f32_16x16x32_bf16 a[104:107], v[136:139], v[48:51], a[104:107]
    ds_read_b64_tr_b16 v[150:151], v229 offset:32256
    v_mfma_f32_16x16x32_bf16 a[108:111], v[136:139], v[52:55], a[108:111]
    s_waitcnt lgkmcnt(4)
    v_mfma_f32_16x16x32_bf16 a[112:115], v[140:143], v[40:43], a[112:115]
    v_mfma_f32_16x16x32_bf16 a[116:119], v[140:143], v[44:47], a[116:119]
    ds_read_b64_tr_b16 v[136:137], v229 offset:27680
    v_mfma_f32_16x16x32_bf16 a[120:123], v[140:143], v[48:51], a[120:123]
    ds_read_b64_tr_b16 v[138:139], v229 offset:32288
    v_mfma_f32_16x16x32_bf16 a[124:127], v[140:143], v[52:55], a[124:127]
    s_waitcnt lgkmcnt(4)
    v_mfma_f32_16x16x32_bf16 a[128:131], v[144:147], v[40:43], a[128:131]
    v_mfma_f32_16x16x32_bf16 a[132:135], v[144:147], v[44:47], a[132:135]
    ds_read_b64_tr_b16 v[140:141], v229 offset:27712
    v_mfma_f32_16x16x32_bf16 a[136:139], v[144:147], v[48:51], a[136:139]
    ds_read_b64_tr_b16 v[142:143], v229 offset:32320
    v_mfma_f32_16x16x32_bf16 a[140:143], v[144:147], v[52:55], a[140:143]
    s_waitcnt vmcnt(3)
    v_cmp_ne_u32 vcc, 1, v230
    s_nop 0
    s_cbranch_vccnz mk_slowo
mk_o_ok:
    s_add_u32 s100, s69, 32768
    s_waitcnt lgkmcnt(4)
    v_mfma_f32_16x16x32_bf16 a[0:3], v[148:151], v[56:59], a[0:3]
    buffer_load_dwordx4 v[8:11], v3, s[64:67], s100 offen offset:0 sc1
    v_mfma_f32_16x16x32_bf16 a[4:7], v[148:151], v[60:63], a[4:7]
    ds_read_b64_tr_b16 v[144:145], v229 offset:27744
    v_mfma_f32_16x16x32_bf16 a[8:11], v[148:151], v[64:67], a[8:11]
    ds_read_b64_tr_b16 v[146:147], v229 offset:32352
    v_mfma_f32_16x16x32_bf16 a[12:15], v[148:151], v[68:71], a[12:15]
    s_add_u32 s100, s69, 32768
    s_waitcnt lgkmcnt(4)
    v_mfma_f32_16x16x32_bf16 a[16:19], v[136:139], v[56:59], a[16:19]
    buffer_load_dwordx4 v[12:15], v3, s[64:67], s100 offen offset:1024 sc1
    v_mfma_f32_16x16x32_bf16 a[20:23], v[136:139], v[60:63], a[20:23]
    ds_read_b64_tr_b16 v[148:149], v229 offset:27776
    v_mfma_f32_16x16x32_bf16 a[24:27], v[136:139], v[64:67], a[24:27]
    ds_read_b64_tr_b16 v[150:151], v229 offset:32384
    v_mfma_f32_16x16x32_bf16 a[28:31], v[136:139], v[68:71], a[28:31]
    s_add_u32 s100, s69, 32768
    s_waitcnt lgkmcnt(4)
    v_mfma_f32_16x16x32_bf16 a[32:35], v[140:143], v[56:59], a[32:35]
    buffer_load_dwordx4 v[16:19], v3, s[64:67], s100 offen offset:2048 sc1
    v_mfma_f32_16x16x32_bf16 a[36:39], v[140:143], v[60:63], a[36:39]
    ds_read_b64_tr_b16 v[136:137], v229 offset:27808
    v_mfma_f32_16x16x32_bf16 a[40:43], v[140:143], v[64:67], a[40:43]
    ds_read_b64_tr_b16 v[138:139], v229 offset:32416
    v_mfma_f32_16x16x32_bf16 a[44:47], v[140:143], v[68:71], a[44:47]
    s_add_u32 s100, s69, 32768
    s_waitcnt lgkmcnt(4)
    v_mfma_f32_16x16x32_bf16 a[48:51], v[144:147], v[56:59], a[48:51]
    buffer_load_dwordx4 v[20:23], v3, s[64:67], s100 offen offset:3072 sc1
    v_mfma_f32_16x16x32_bf16 a[52:55], v[144:147], v[60:63], a[52:55]
    ds_read_b64_tr_b16 v[140:141], v229 offset:27840
    v_mfma_f32_16x16x32_bf16 a[56:59], v[144:147], v[64:67], a[56:59]
    ds_read_b64_tr_b16 v[142:143], v229 offset:32448
    v_mfma_f32_16x16x32_bf16 a[60:63], v[144:147], v[68:71], a[60:63]
    s_add_u32 s100, s69, 49152
    s_waitcnt lgkmcnt(4)
    v_mfma_f32_16x16x32_bf16 a[64:67], v[148:151], v[56:59], a[64:67]
    buffer_load_dwordx4 v[24:27], v3, s[64:67], s100 offen offset:0 sc1
    v_mfma_f32_16x16x32_bf16 a[68:71], v[148:151], v[60:63], a[68:71]
    ds_read_b64_tr_b16 v[144:145], v229 offset:27872
    v_mfma_f32_16x16x32_bf16 a[72:75], v[148:151], v[64:67], a[72:75]
    ds_read_b64_tr_b16 v[146:147], v229 offset:32480
    v_mfma_f32_16x16x32_bf16 a[76:79], v[148:151], v[68:71], a[76:79]
    s_add_u32 s100, s69, 49152
    s_waitcnt lgkmcnt(4)
    v_mfma_f32_16x16x32_bf16 a[80:83], v[136:139], v[56:59], a[80:83]
    buffer_load_dwordx4 v[28:31], v3, s[64:67], s100 offen offset:1024 sc1
    v_mfma_f32_16x16x32_bf16 a[84:87], v[136:139], v[60:63], a[84:87]
    ds_read_b64_tr_b16 v[148:149], v229 offset:27904
    v_mfma_f32_16x16x32_bf16 a[88:91], v[136:139], v[64:67], a[88:91]
    ds_read_b64_tr_b16 v[150:151], v229 offset:32512
    v_mfma_f32_16x16x32_bf16 a[92:95], v[136:139], v[68:71], a[92:95]
    s_add_u32 s100, s69, 49152
    s_waitcnt lgkmcnt(4)
    v_mfma_f32_16x16x32_bf16 a[96:99], v[140:143], v[56:59], a[96:99]
    s_waitcnt lgkmcnt(0)
    s_barrier
    v_add_u32 v229, 110592, v228
    buffer_load_dwordx4 v[32:35], v3, s[64:67], s100 offen offset:2048 sc1
    v_mfma_f32_16x16x32_bf16 a[100:103], v[140:143], v[60:63], a[100:103]
    ds_read_b64_tr_b16 v[136:137], v229 offset:0
    v_mfma_f32_16x16x32_bf16 a[104:107], v[140:143], v[64:67], a[104:107]
    ds_read_b64_tr_b16 v[138:139], v229 offset:4608
    v_mfma_f32_16x16x32_bf16 a[108:111], v[140:143], v[68:71], a[108:111]
    s_add_u32 s100, s69, 49152
    v_mfma_f32_16x16x32_bf16 a[112:115], v[144:147], v[56:59], a[112:115]
    buffer_load_dwordx4 v[36:39], v3, s[64:67], s100 offen offset:3072 sc1
    v_mfma_f32_16x16x32_bf16 a[116:119], v[144:147], v[60:63], a[116:119]
    ds_read_b64_tr_b16 v[140:141], v229 offset:32
    v_mfma_f32_16x16x32_bf16 a[120:123], v[144:147], v[64:67], a[120:123]
    ds_read_b64_tr_b16 v[142:143], v229 offset:4640
    v_mfma_f32_16x16x32_bf16 a[124:127], v[144:147], v[68:71], a[124:127]
    s_add_u32 s100, s69, 98304
    v_mfma_f32_16x16x32_bf16 a[128:131], v[148:151], v[56:59], a[128:131]
    buffer_load_dwordx4 v[40:43], v3, s[64:67], s100 offen offset:0 sc1
    v_mfma_f32_16x16x32_bf16 a[132:135], v[148:151], v[60:63], a[132:135]
    ds_read_b64_tr_b16 v[144:145], v229 offset:64
    v_mfma_f32_16x16x32_bf16 a[136:139], v[148:151], v[64:67], a[136:139]
    ds_read_b64_tr_b16 v[146:147], v229 offset:4672
    v_mfma_f32_16x16x32_bf16 a[140:143], v[148:151], v[68:71], a[140:143]
    s_add_u32 s100, s69, 114688
    s_waitcnt lgkmcnt(4)
    v_mfma_f32_16x16x32_bf16 a[0:3], v[136:139], v[72:75], a[0:3]
    buffer_load_dwordx4 v[56:59], v3, s[64:67], s100 offen offset:0 sc1
    v_mfma_f32_16x16x32_bf16 a[4:7], v[136:139], v[76:79], a[4:7]
    ds_read_b64_tr_b16 v[148:149], v229 offset:96
    v_mfma_f32_16x16x32_bf16 a[8:11], v[136:139], v[80:83], a[8:11]
    ds_read_b64_tr_b16 v[150:151], v229 offset:4704
    v_mfma_f32_16x16x32_bf16 a[12:15], v[136:139], v[84:87], a[12:15]
    s_add_u32 s100, s69, 114688
    s_waitcnt lgkmcnt(4)
    v_mfma_f32_16x16x32_bf16 a[16:19], v[140:143], v[72:75], a[16:19]
    buffer_load_dwordx4 v[60:63], v3, s[64:67], s100 offen offset:1024 sc1
    v_mfma_f32_16x16x32_bf16 a[20:23], v[140:143], v[76:79], a[20:23]
    ds_read_b64_tr_b16 v[136:137], v229 offset:128
    v_mfma_f32_16x16x32_bf16 a[24:27], v[140:143], v[80:83], a[24:27]
    ds_read_b64_tr_b16 v[138:139], v229 offset:4736
    v_mfma_f32_16x16x32_bf16 a[28:31], v[140:143], v[84:87], a[28:31]
    s_add_u32 s100, s69, 114688
    s_waitcnt lgkmcnt(4)
    v_mfma_f32_16x16x32_bf16 a[32:35], v[144:147], v[72:75], a[32:35]
    buffer_load_dwordx4 v[64:67], v3, s[64:67], s100 offen offset:2048 sc1
    v_mfma_f32_16x16x32_bf16 a[36:39], v[144:147], v[76:79], a[36:39]
    ds_read_b64_tr_b16 v[140:141], v229 offset:160
    v_mfma_f32_16x16x32_bf16 a[40:43], v[144:147], v[80:83], a[40:43]
    ds_read_b64_tr_b16 v[142:143], v229 offset:4768
    v_mfma_f32_16x16x32_bf16 a[44:47], v[144:147], v[84:87], a[44:47]
    s_add_u32 s100, s69, 114688
    s_waitcnt lgkmcnt(4)
    v_mfma_f32_16x16x32_bf16 a[48:51], v[148:151], v[72:75], a[48:51]
    buffer_load_dwordx4 v[68:71], v3, s[64:67], s100 offen offset:3072 sc1
    v_mfma_f32_16x16x32_bf16 a[52:55], v[148:151], v[76:79], a[52:55]
    ds_read_b64_tr_b16 v[144:145], v229 offset:192
    v_mfma_f32_16x16x32_bf16 a[56:59], v[148:151], v[80:83], a[56:59]
    ds_read_b64_tr_b16 v[146:147], v229 offset:4800
    v_mfma_f32_16x16x32_bf16 a[60:63], v[148:151], v[84:87], a[60:63]
    s_add_u32 s100, s69, 98304
    s_waitcnt lgkmcnt(4)
    v_mfma_f32_16x16x32_bf16 a[64:67], v[136:139], v[72:75], a[64:67]
    buffer_load_dwordx4 v[44:47], v3, s[64:67], s100 offen offset:1024 sc1
    v_mfma_f32_16x16x32_bf16 a[68:71], v[136:139], v[76:79], a[68:71]
    ds_read_b64_tr_b16 v[148:149], v229 offset:224
    v_mfma_f32_16x16x32_bf16 a[72:75], v[136:139], v[80:83], a[72:75]
    ds_read_b64_tr_b16 v[150:151], v229 offset:4832
    v_mfma_f32_16x16x32_bf16 a[76:79], v[136:139], v[84:87], a[76:79]
    s_add_u32 s100, s69, 98304
    s_waitcnt lgkmcnt(4)
    v_mfma_f32_16x16x32_bf16 a[80:83], v[140:143], v[72:75], a[80:83]
    buffer_load_dwordx4 v[48:51], v3, s[64:67], s100 offen offset:2048 sc1
    v_mfma_f32_16x16x32_bf16 a[84:87], v[140:143], v[76:79], a[84:87]
    ds_read_b64_tr_b16 v[136:137], v229 offset:256
    v_mfma_f32_16x16x32_bf16 a[88:91], v[140:143], v[80:83], a[88:91]
    ds_read_b64_tr_b16 v[138:139], v229 offset:4864
    v_mfma_f32_16x16x32_bf16 a[92:95], v[140:143], v[84:87], a[92:95]
    s_add_u32 s100, s69, 98304
    s_waitcnt lgkmcnt(4)
    v_mfma_f32_16x16x32_bf16 a[96:99], v[144:147], v[72:75], a[96:99]
    buffer_load_dwordx4 v[52:55], v3, s[64:67], s100 offen offset:3072 sc1
    v_mfma_f32_16x16x32_bf16 a[100:103], v[144:147], v[76:79], a[100:103]
    ds_read_b64_tr_b16 v[140:141], v229 offset:9216
    v_mfma_f32_16x16x32_bf16 a[104:107], v[144:147], v[80:83], a[104:107]
    ds_read_b64_tr_b16 v[142:143], v229 offset:13824
    v_mfma_f32_16x16x32_bf16 a[108:111], v[144:147], v[84:87], a[108:111]
    s_add_u32 s99, s68, 663552
    s_add_u32 m0, s70, 73728
    s_waitcnt lgkmcnt(4)
    v_mfma_f32_16x16x32_bf16 a[112:115], v[148:151], v[72:75], a[112:115]
    buffer_load_dwordx4 v219, s[60:63], s99 offen offset:0 lds
    v_mfma_f32_16x16x32_bf16 a[116:119], v[148:151], v[76:79], a[116:119]
    ds_read_b64_tr_b16 v[144:145], v229 offset:9248
    v_mfma_f32_16x16x32_bf16 a[120:123], v[148:151], v[80:83], a[120:123]
    ds_read_b64_tr_b16 v[146:147], v229 offset:13856
    v_mfma_f32_16x16x32_bf16 a[124:127], v[148:151], v[84:87], a[124:127]
    s_waitcnt lgkmcnt(4)
    v_mfma_f32_16x16x32_bf16 a[128:131], v[136:139], v[72:75], a[128:131]
    buffer_load_dwordx4 v220, s[60:63], s99 offen offset:1024 lds
    v_mfma_f32_16x16x32_bf16 a[132:135], v[136:139], v[76:79], a[132:135]
    ds_read_b64_tr_b16 v[148:149], v229 offset:9280
    v_mfma_f32_16x16x32_bf16 a[136:139], v[136:139], v[80:83], a[136:139]
    ds_read_b64_tr_b16 v[150:151], v229 offset:13888
    v_mfma_f32_16x16x32_bf16 a[140:143], v[136:139], v[84:87], a[140:143]
    s_add_u32 s100, s69, 163840
    s_waitcnt lgkmcnt(4)
    v_mfma_f32_16x16x32_bf16 a[0:3], v[140:143], v[88:91], a[0:3]
    buffer_load_dwordx4 v[72:75], v3, s[64:67], s100 offen offset:0 sc1
    v_mfma_f32_16x16x32_bf16 a[4:7], v[140:143], v[92:95], a[4:7]
    ds_read_b64_tr_b16 v[136:137], v229 offset:9312
    v_mfma_f32_16x16x32_bf16 a[8:11], v[140:143], v[96:99], a[8:11]
    ds_read_b64_tr_b16 v[138:139], v229 offset:13920
    v_mfma_f32_16x16x32_bf16 a[12:15], v[140:143], v[100:103], a[12:15]
    s_add_u32 s100, s69, 163840
    s_waitcnt lgkmcnt(4)
    v_mfma_f32_16x16x32_bf16 a[16:19], v[144:147], v[88:91], a[16:19]
    buffer_load_dwordx4 v[76:79], v3, s[64:67], s100 offen offset:1024 sc1
    v_mfma_f32_16x16x32_bf16 a[20:23], v[144:147], v[92:95], a[20:23]
    ds_read_b64_tr_b16 v[140:141], v229 offset:9344
    v_mfma_f32_16x16x32_bf16 a[24:27], v[144:147], v[96:99], a[24:27]
    ds_read_b64_tr_b16 v[142:143], v229 offset:13952
    v_mfma_f32_16x16x32_bf16 a[28:31], v[144:147], v[100:103], a[28:31]
    s_add_u32 s100, s69, 163840
    s_waitcnt lgkmcnt(4)
    v_mfma_f32_16x16x32_bf16 a[32:35], v[148:151], v[88:91], a[32:35]
    buffer_load_dwordx4 v[80:83], v3, s[64:67], s100 offen offset:2048 sc1
    v_mfma_f32_16x16x32_bf16 a[36:39], v[148:151], v[92:95], a[36:39]
    ds_read_b64_tr_b16 v[144:145], v229 offset:9376
    v_mfma_f32_16x16x32_bf16 a[40:43], v[148:151], v[96:99], a[40:43]
    ds_read_b64_tr_b16 v[146:147], v229 offset:13984
    v_mfma_f32_16x16x32_bf16 a[44:47], v[148:151], v[100:103], a[44:47]
    s_add_u32 s100, s69, 163840
    s_waitcnt lgkmcnt(4)
    v_mfma_f32_16x16x32_bf16 a[48:51], v[136:139], v[88:91], a[48:51]
    buffer_load_dwordx4 v[84:87], v3, s[64:67], s100 offen offset:3072 sc1
    v_mfma_f32_16x16x32_bf16 a[52:55], v[136:139], v[92:95], a[52:55]
    ds_read_b64_tr_b16 v[148:149], v229 offset:9408
    v_mfma_f32_16x16x32_bf16 a[56:59], v[136:139], v[96:99], a[56:59]
    ds_read_b64_tr_b16 v[150:151], v229 offset:14016
    v_mfma_f32_16x16x32_bf16 a[60:63], v[136:139], v[100:103], a[60:63]
    s_waitcnt lgkmcnt(4)
    v_mfma_f32_16x16x32_bf16 a[64:67], v[140:143], v[88:91], a[64:67]
    buffer_load_dwordx4 v221, s[60:63], s99 offen offset:2048 lds
    v_mfma_f32_16x16x32_bf16 a[68:71], v[140:143], v[92:95], a[68:71]
    ds_read_b64_tr_b16 v[136:137], v229 offset:9440
    v_mfma_f32_16x16x32_bf16 a[72:75], v[140:143], v[96:99], a[72:75]
    ds_read_b64_tr_b16 v[138:139], v229 offset:14048
    v_mfma_f32_16x16x32_bf16 a[76:79], v[140:143], v[100:103], a[76:79]
    s_waitcnt lgkmcnt(4)
    v_mfma_f32_16x16x32_bf16 a[80:83], v[144:147], v[88:91], a[80:83]
    buffer_load_dwordx4 v222, s[60:63], s99 offen offset:3072 lds
    v_mfma_f32_16x16x32_bf16 a[84:87], v[144:147], v[92:95], a[84:87]
    ds_read_b64_tr_b16 v[140:141], v229 offset:9472
    v_mfma_f32_16x16x32_bf16 a[88:91], v[144:147], v[96:99], a[88:91]
    ds_read_b64_tr_b16 v[142:143], v229 offset:14080
    v_mfma_f32_16x16x32_bf16 a[92:95], v[144:147], v[100:103], a[92:95]
    s_add_u32 m0, s70, 77824
    s_waitcnt lgkmcnt(4)
    v_mfma_f32_16x16x32_bf16 a[96:99], v[148:151], v[88:91], a[96:99]
    buffer_load_dwordx4 v223, s[60:63], s99 offen offset:0 lds
    v_mfma_f32_16x16x32_bf16 a[100:103], v[148:151], v[92:95], a[100:103]
    ds_read_b64_tr_b16 v[144:145], v229 offset:18432
    v_mfma_f32_16x16x32_bf16 a[104:107], v[148:151], v[96:99], a[104:107]
    ds_read_b64_tr_b16 v[146:147], v229 offset:23040
    v_mfma_f32_16x16x32_bf16 a[108:111], v[148:151], v[100:103], a[108:111]
    s_waitcnt lgkmcnt(4)
    v_mfma_f32_16x16x32_bf16 a[112:115], v[136:139], v[88:91], a[112:115]
    buffer_load_dwordx4 v224, s[60:63], s99 offen offset:1024 lds
    v_mfma_f32_16x16x32_bf16 a[116:119], v[136:139], v[92:95], a[116:119]
    ds_read_b64_tr_b16 v[148:149], v229 offset:18464
    v_mfma_f32_16x16x32_bf16 a[120:123], v[136:139], v[96:99], a[120:123]
    ds_read_b64_tr_b16 v[150:151], v229 offset:23072
    v_mfma_f32_16x16x32_bf16 a[124:127], v[136:139], v[100:103], a[124:127]
    s_waitcnt lgkmcnt(4)
    v_mfma_f32_16x16x32_bf16 a[128:131], v[140:143], v[88:91], a[128:131]
    buffer_load_dwordx4 v225, s[60:63], s99 offen offset:2048 lds
    v_mfma_f32_16x16x32_bf16 a[132:135], v[140:143], v[92:95], a[132:135]
    ds_read_b64_tr_b16 v[136:137], v229 offset:18496
    v_mfma_f32_16x16x32_bf16 a[136:139], v[140:143], v[96:99], a[136:139]
    ds_read_b64_tr_b16 v[138:139], v229 offset:23104
    v_mfma_f32_16x16x32_bf16 a[140:143], v[140:143], v[100:103], a[140:143]
    s_add_u32 s100, s69, 180224
    s_waitcnt lgkmcnt(4)
    v_mfma_f32_16x16x32_bf16 a[0:3], v[144:147], v[104:107], a[0:3]
    buffer_load_dwordx4 v[88:91], v3, s[64:67], s100 offen offset:0 sc1
    v_mfma_f32_16x16x32_bf16 a[4:7], v[144:147], v[108:111], a[4:7]
    ds_read_b64_tr_b16 v[140:141], v229 offset:18528
    v_mfma_f32_16x16x32_bf16 a[8:11], v[144:147], v[112:115], a[8:11]
    ds_read_b64_tr_b16 v[142:143], v229 offset:23136
    v_mfma_f32_16x16x32_bf16 a[12:15], v[144:147], v[116:119], a[12:15]
    s_add_u32 s100, s69, 180224
    s_waitcnt lgkmcnt(4)
    v_mfma_f32_16x16x32_bf16 a[16:19], v[148:151], v[104:107], a[16:19]
    buffer_load_dwordx4 v[92:95], v3, s[64:67], s100 offen offset:1024 sc1
    v_mfma_f32_16x16x32_bf16 a[20:23], v[148:151], v[108:111], a[20:23]
    ds_read_b64_tr_b16 v[144:145], v229 offset:18560
    v_mfma_f32_16x16x32_bf16 a[24:27], v[148:151], v[112:115], a[24:27]
    ds_read_b64_tr_b16 v[146:147], v229 offset:23168
    v_mfma_f32_16x16x32_bf16 a[28:31], v[148:151], v[116:119], a[28:31]
    s_add_u32 s100, s69, 180224
    s_waitcnt lgkmcnt(4)
    v_mfma_f32_16x16x32_bf16 a[32:35], v[136:139], v[104:107], a[32:35]
    buffer_load_dwordx4 v[96:99], v3, s[64:67], s100 offen offset:2048 sc1
    v_mfma_f32_16x16x32_bf16 a[36:39], v[136:139], v[108:111], a[36:39]
    ds_read_b64_tr_b16 v[148:149], v229 offset:18592
    v_mfma_f32_16x16x32_bf16 a[40:43], v[136:139], v[112:115], a[40:43]
    ds_read_b64_tr_b16 v[150:151], v229 offset:23200
    v_mfma_f32_16x16x32_bf16 a[44:47], v[136:139], v[116:119], a[44:47]
    s_add_u32 s100, s69, 180224
    s_waitcnt lgkmcnt(4)
    v_mfma_f32_16x16x32_bf16 a[48:51], v[140:143], v[104:107], a[48:51]
    buffer_load_dwordx4 v[100:103], v3, s[64:67], s100 offen offset:3072 sc1
    v_mfma_f32_16x16x32_bf16 a[52:55], v[140:143], v[108:111], a[52:55]
    ds_read_b64_tr_b16 v[136:137], v229 offset:18624
    v_mfma_f32_16x16x32_bf16 a[56:59], v[140:143], v[112:115], a[56:59]
    ds_read_b64_tr_b16 v[138:139], v229 offset:23232
    v_mfma_f32_16x16x32_bf16 a[60:63], v[140:143], v[116:119], a[60:63]
    s_waitcnt lgkmcnt(4)
    v_mfma_f32_16x16x32_bf16 a[64:67], v[144:147], v[104:107], a[64:67]
    buffer_load_dwordx4 v226, s[60:63], s99 offen offset:3072 lds
    v_mfma_f32_16x16x32_bf16 a[68:71], v[144:147], v[108:111], a[68:71]
    ds_read_b64_tr_b16 v[140:141], v229 offset:18656
    v_mfma_f32_16x16x32_bf16 a[72:75], v[144:147], v[112:115], a[72:75]
    ds_read_b64_tr_b16 v[142:143], v229 offset:23264
    v_mfma_f32_16x16x32_bf16 a[76:79], v[144:147], v[116:119], a[76:79]
    s_add_u32 m0, s70, 81920
    s_waitcnt lgkmcnt(4)
    v_mfma_f32_16x16x32_bf16 a[80:83], v[148:151], v[104:107], a[80:83]
    buffer_load_dwordx4 v227, s[60:63], s99 offen offset:0 lds
    v_mfma_f32_16x16x32_bf16 a[84:87], v[148:151], v[108:111], a[84:87]
    ds_read_b64_tr_b16 v[144:145], v229 offset:18688
    v_mfma_f32_16x16x32_bf16 a[88:91], v[148:151], v[112:115], a[88:91]
    ds_read_b64_tr_b16 v[146:147], v229 offset:23296
    v_mfma_f32_16x16x32_bf16 a[92:95], v[148:151], v[116:119], a[92:95]
    s_waitcnt lgkmcnt(4)
    v_mfma_f32_16x16x32_bf16 a[96:99], v[136:139], v[104:107], a[96:99]
    v_mfma_f32_16x16x32_bf16 a[100:103], v[136:139], v[108:111], a[100:103]
    ds_read_b64_tr_b16 v[148:149], v229 offset:27648
    v_mfma_f32_16x16x32_bf16 a[104:107], v[136:139], v[112:115], a[104:107]
    ds_read_b64_tr_b16 v[150:151], v229 offset:32256
    v_mfma_f32_16x16x32_bf16 a[108:111], v[136:139], v[116:119], a[108:111]
    s_waitcnt lgkmcnt(4)
    v_mfma_f32_16x16x32_bf16 a[112:115], v[140:143], v[104:107], a[112:115]
    v_mfma_f32_16x16x32_bf16 a[116:119], v[140:143], v[108:111], a[116:119]
    ds_read_b64_tr_b16 v[136:137], v229 offset:27680
    v_mfma_f32_16x16x32_bf16 a[120:123], v[140:143], v[112:115], a[120:123]
    ds_read_b64_tr_b16 v[138:139], v229 offset:32288
    v_mfma_f32_16x16x32_bf16 a[124:127], v[140:143], v[116:119], a[124:127]
    s_waitcnt lgkmcnt(4)
    v_mfma_f32_16x16x32_bf16 a[128:131], v[144:147], v[104:107], a[128:131]
    v_mfma_f32_16x16x32_bf16 a[132:135], v[144:147], v[108:111], a[132:135]
    ds_read_b64_tr_b16 v[140:141], v229 offset:27712
    v_mfma_f32_16x16x32_bf16 a[136:139], v[144:147], v[112:115], a[136:139]
    ds_read_b64_tr_b16 v[142:143], v229 offset:32320
    v_mfma_f32_16x16x32_bf16 a[140:143], v[144:147], v[116:119], a[140:143]
    s_add_u32 s100, s69, 229376
    s_waitcnt lgkmcnt(4)
    v_mfma_f32_16x16x32_bf16 a[0:3], v[148:151], v[120:123], a[0:3]
    buffer_load_dwordx4 v[104:107], v3, s[64:67], s100 offen offset:0 sc1
    v_mfma_f32_16x16x32_bf16 a[4:7], v[148:151], v[124:127], a[4:7]
    ds_read_b64_tr_b16 v[144:145], v229 offset:27744
    v_mfma_f32_16x16x32_bf16 a[8:11], v[148:151], v[128:131], a[8:11]
    ds_read_b64_tr_b16 v[146:147], v229 offset:32352
    v_mfma_f32_16x16x32_bf16 a[12:15], v[148:151], v[132:135], a[12:15]
    s_add_u32 s100, s69, 229376
    s_waitcnt lgkmcnt(4)
    v_mfma_f32_16x16x32_bf16 a[16:19], v[136:139], v[120:123], a[16:19]
    buffer_load_dwordx4 v[108:111], v3, s[64:67], s100 offen offset:1024 sc1
    v_mfma_f32_16x16x32_bf16 a[20:23], v[136:139], v[124:127], a[20:23]
    ds_read_b64_tr_b16 v[148:149], v229 offset:27776
    v_mfma_f32_16x16x32_bf16 a[24:27], v[136:139], v[128:131], a[24:27]
    ds_read_b64_tr_b16 v[150:151], v229 offset:32384
    v_mfma_f32_16x16x32_bf16 a[28:31], v[136:139], v[132:135], a[28:31]
    s_add_u32 s100, s69, 229376
    s_waitcnt lgkmcnt(4)
    v_mfma_f32_16x16x32_bf16 a[32:35], v[140:143], v[120:123], a[32:35]
    buffer_load_dwordx4 v[112:115], v3, s[64:67], s100 offen offset:2048 sc1
    v_mfma_f32_16x16x32_bf16 a[36:39], v[140:143], v[124:127], a[36:39]
    ds_read_b64_tr_b16 v[136:137], v229 offset:27808
    v_mfma_f32_16x16x32_bf16 a[40:43], v[140:143], v[128:131], a[40:43]
    ds_read_b64_tr_b16 v[138:139], v229 offset:32416
    v_mfma_f32_16x16x32_bf16 a[44:47], v[140:143], v[132:135], a[44:47]
    s_add_u32 s100, s69, 229376
    s_waitcnt lgkmcnt(4)
    v_mfma_f32_16x16x32_bf16 a[48:51], v[144:147], v[120:123], a[48:51]
    buffer_load_dwordx4 v[116:119], v3, s[64:67], s100 offen offset:3072 sc1
    v_mfma_f32_16x16x32_bf16 a[52:55], v[144:147], v[124:127], a[52:55]
    ds_read_b64_tr_b16 v[140:141], v229 offset:27840
    v_mfma_f32_16x16x32_bf16 a[56:59], v[144:147], v[128:131], a[56:59]
    ds_read_b64_tr_b16 v[142:143], v229 offset:32448
    v_mfma_f32_16x16x32_bf16 a[60:63], v[144:147], v[132:135], a[60:63]
    s_waitcnt lgkmcnt(4)
    v_mfma_f32_16x16x32_bf16 a[64:67], v[148:151], v[120:123], a[64:67]
    v_mfma_f32_16x16x32_bf16 a[68:71], v[148:151], v[124:127], a[68:71]
    ds_read_b64_tr_b16 v[144:145], v229 offset:27872
    v_mfma_f32_16x16x32_bf16 a[72:75], v[148:151], v[128:131], a[72:75]
    ds_read_b64_tr_b16 v[146:147], v229 offset:32480
    v_mfma_f32_16x16x32_bf16 a[76:79], v[148:151], v[132:135], a[76:79]
    s_waitcnt lgkmcnt(4)
    v_mfma_f32_16x16x32_bf16 a[80:83], v[136:139], v[120:123], a[80:83]
    v_mfma_f32_16x16x32_bf16 a[84:87], v[136:139], v[124:127], a[84:87]
    ds_read_b64_tr_b16 v[148:149], v229 offset:27904
    v_mfma_f32_16x16x32_bf16 a[88:91], v[136:139], v[128:131], a[88:91]
    ds_read_b64_tr_b16 v[150:151], v229 offset:32512
    v_mfma_f32_16x16x32_bf16 a[92:95], v[136:139], v[132:135], a[92:95]
    s_waitcnt lgkmcnt(4)
    v_mfma_f32_16x16x32_bf16 a[96:99], v[140:143], v[120:123], a[96:99]
    s_waitcnt lgkmcnt(0)
    s_barrier
    v_add_u32 v229, 0, v228
    v_mfma_f32_16x16x32_bf16 a[100:103], v[140:143], v[124:127], a[100:103]
    ds_read_b64_tr_b16 v[136:137], v229 offset:0
    v_mfma_f32_16x16x32_bf16 a[104:107], v[140:143], v[128:131], a[104:107]
    ds_read_b64_tr_b16 v[138:139], v229 offset:4608
    v_mfma_f32_16x16x32_bf16 a[108:111], v[140:143], v[132:135], a[108:111]
    s_add_u32 s99, s68, 958464
    s_add_u32 m0, s70, 110592
    v_mfma_f32_16x16x32_bf16 a[112:115], v[144:147], v[120:123], a[112:115]
    buffer_load_dwordx4 v219, s[60:63], s99 offen offset:0 lds
    v_mfma_f32_16x16x32_bf16 a[116:119], v[144:147], v[124:127], a[116:119]
    ds_read_b64_tr_b16 v[140:141], v229 offset:32
    v_mfma_f32_16x16x32_bf16 a[120:123], v[144:147], v[128:131], a[120:123]
    ds_read_b64_tr_b16 v[142:143], v229 offset:4640
    v_mfma_f32_16x16x32_bf16 a[124:127], v[144:147], v[132:135], a[124:127]
    v_mfma_f32_16x16x32_bf16 a[128:131], v[148:151], v[120:123], a[128:131]
    buffer_load_dwordx4 v220, s[60:63], s99 offen offset:1024 lds
    v_mfma_f32_16x16x32_bf16 a[132:135], v[148:151], v[124:127], a[132:135]
    ds_read_b64_tr_b16 v[144:145], v229 offset:64
    v_mfma_f32_16x16x32_bf16 a[136:139], v[148:151], v[128:131], a[136:139]
    ds_read_b64_tr_b16 v[146:147], v229 offset:4672
    v_mfma_f32_16x16x32_bf16 a[140:143], v[148:151], v[132:135], a[140:143]
    s_add_u32 s100, s69, 245760
    s_waitcnt lgkmcnt(4)
    s_waitcnt vmcnt(35)
    v_mfma_f32_16x16x32_bf16 a[0:3], v[136:139], v[8:11], a[0:3]
    buffer_load_dwordx4 v[120:123], v3, s[64:67], s100 offen offset:0 sc1
    v_mfma_f32_16x16x32_bf16 a[4:7], v[136:139], v[12:15], a[4:7]
    ds_read_b64_tr_b16 v[148:149], v229 offset:96
    v_mfma_f32_16x16x32_bf16 a[8:11], v[136:139], v[16:19], a[8:11]
    ds_read_b64_tr_b16 v[150:151], v229 offset:4704
    v_mfma_f32_16x16x32_bf16 a[12:15], v[136:139], v[20:23], a[12:15]
    s_add_u32 s100, s69, 245760
    s_waitcnt lgkmcnt(4)
    v_mfma_f32_16x16x32_bf16 a[16:19], v[140:143], v[8:11], a[16:19]
    buffer_load_dwordx4 v[124:127], v3, s[64:67], s100 offen offset:1024 sc1
    v_mfma_f32_16x16x32_bf16 a[20:23], v[140:143], v[12:15], a[20:23]
    ds_read_b64_tr_b16 v[136:137], v229 offset:128
    v_mfma_f32_16x16x32_bf16 a[24:27], v[140:143], v[16:19], a[24:27]
    ds_read_b64_tr_b16 v[138:139], v229 offset:4736
    v_mfma_f32_16x16x32_bf16 a[28:31], v[140:143], v[20:23], a[28:31]
    s_add_u32 s100, s69, 245760
    s_waitcnt lgkmcnt(4)
    v_mfma_f32_16x16x32_bf16 a[32:35], v[144:147], v[8:11], a[32:35]
    buffer_load_dwordx4 v[128:131], v3, s[64:67], s100 offen offset:2048 sc1
    v_mfma_f32_16x16x32_bf16 a[36:39], v[144:147], v[12:15], a[36:39]
    ds_read_b64_tr_b16 v[140:141], v229 offset:160
    v_mfma_f32_16x16x32_bf16 a[40:43], v[144:147], v[16:19], a[40:43]
    ds_read_b64_tr_b16 v[142:143], v229 offset:4768
    v_mfma_f32_16x16x32_bf16 a[44:47], v[144:147], v[20:23], a[44:47]
    s_add_u32 s100, s69, 245760
    s_waitcnt lgkmcnt(4)
    v_mfma_f32_16x16x32_bf16 a[48:51], v[148:151], v[8:11], a[48:51]
    buffer_load_dwordx4 v[132:135], v3, s[64:67], s100 offen offset:3072 sc1
    v_mfma_f32_16x16x32_bf16 a[52:55], v[148:151], v[12:15], a[52:55]
    ds_read_b64_tr_b16 v[144:145], v229 offset:192
    v_mfma_f32_16x16x32_bf16 a[56:59], v[148:151], v[16:19], a[56:59]
    ds_read_b64_tr_b16 v[146:147], v229 offset:4800
    v_mfma_f32_16x16x32_bf16 a[60:63], v[148:151], v[20:23], a[60:63]
    s_waitcnt lgkmcnt(4)
    v_mfma_f32_16x16x32_bf16 a[64:67], v[136:139], v[8:11], a[64:67]
    buffer_load_dwordx4 v221, s[60:63], s99 offen offset:2048 lds
    v_mfma_f32_16x16x32_bf16 a[68:71], v[136:139], v[12:15], a[68:71]
    ds_read_b64_tr_b16 v[148:149], v229 offset:224
    v_mfma_f32_16x16x32_bf16 a[72:75], v[136:139], v[16:19], a[72:75]
    ds_read_b64_tr_b16 v[150:151], v229 offset:4832
    v_mfma_f32_16x16x32_bf16 a[76:79], v[136:139], v[20:23], a[76:79]
    s_waitcnt lgkmcnt(4)
    v_mfma_f32_16x16x32_bf16 a[80:83], v[140:143], v[8:11], a[80:83]
    buffer_load_dwordx4 v222, s[60:63], s99 offen offset:3072 lds
    v_mfma_f32_16x16x32_bf16 a[84:87], v[140:143], v[12:15], a[84:87]
    ds_read_b64_tr_b16 v[136:137], v229 offset:256
    v_mfma_f32_16x16x32_bf16 a[88:91], v[140:143], v[16:19], a[88:91]
    ds_read_b64_tr_b16 v[138:139], v229 offset:4864
    v_mfma_f32_16x16x32_bf16 a[92:95], v[140:143], v[20:23], a[92:95]
    s_add_u32 m0, s70, 114688
    s_waitcnt lgkmcnt(4)
    v_mfma_f32_16x16x32_bf16 a[96:99], v[144:147], v[8:11], a[96:99]
    buffer_load_dwordx4 v223, s[60:63], s99 offen offset:0 lds
    v_mfma_f32_16x16x32_bf16 a[100:103], v[144:147], v[12:15], a[100:103]
    ds_read_b64_tr_b16 v[140:141], v229 offset:9216
    v_mfma_f32_16x16x32_bf16 a[104:107], v[144:147], v[16:19], a[104:107]
    ds_read_b64_tr_b16 v[142:143], v229 offset:13824
    v_mfma_f32_16x16x32_bf16 a[108:111], v[144:147], v[20:23], a[108:111]
    s_waitcnt lgkmcnt(4)
    v_mfma_f32_16x16x32_bf16 a[112:115], v[148:151], v[8:11], a[112:115]
    buffer_load_dwordx4 v224, s[60:63], s99 offen offset:1024 lds
    v_mfma_f32_16x16x32_bf16 a[116:119], v[148:151], v[12:15], a[116:119]
    ds_read_b64_tr_b16 v[144:145], v229 offset:9248
    v_mfma_f32_16x16x32_bf16 a[120:123], v[148:151], v[16:19], a[120:123]
    ds_read_b64_tr_b16 v[146:147], v229 offset:13856
    v_mfma_f32_16x16x32_bf16 a[124:127], v[148:151], v[20:23], a[124:127]
    s_waitcnt lgkmcnt(4)
    v_mfma_f32_16x16x32_bf16 a[128:131], v[136:139], v[8:11], a[128:131]
    buffer_load_dwordx4 v225, s[60:63], s99 offen offset:2048 lds
    v_mfma_f32_16x16x32_bf16 a[132:135], v[136:139], v[12:15], a[132:135]
    ds_read_b64_tr_b16 v[148:149], v229 offset:9280
    v_mfma_f32_16x16x32_bf16 a[136:139], v[136:139], v[16:19], a[136:139]
    ds_read_b64_tr_b16 v[150:151], v229 offset:13888
    v_mfma_f32_16x16x32_bf16 a[140:143], v[136:139], v[20:23], a[140:143]
    s_add_u32 s100, s69, 294912
    s_waitcnt lgkmcnt(4)
    s_waitcnt vmcnt(40)
    v_mfma_f32_16x16x32_bf16 a[0:3], v[140:143], v[24:27], a[0:3]
    buffer_load_dwordx4 v[8:11], v3, s[64:67], s100 offen offset:0 sc1
    v_mfma_f32_16x16x32_bf16 a[4:7], v[140:143], v[28:31], a[4:7]
    ds_read_b64_tr_b16 v[136:137], v229 offset:9312
    v_mfma_f32_16x16x32_bf16 a[8:11], v[140:143], v[32:35], a[8:11]
    ds_read_b64_tr_b16 v[138:139], v229 offset:13920
    v_mfma_f32_16x16x32_bf16 a[12:15], v[140:143], v[36:39], a[12:15]
    s_add_u32 s100, s69, 294912
    s_waitcnt lgkmcnt(4)
    v_mfma_f32_16x16x32_bf16 a[16:19], v[144:147], v[24:27], a[16:19]
    buffer_load_dwordx4 v[12:15], v3, s[64:67], s100 offen offset:1024 sc1
    v_mfma_f32_16x16x32_bf16 a[20:23], v[144:147], v[28:31], a[20:23]
    ds_read_b64_tr_b16 v[140:141], v229 offset:9344
    v_mfma_f32_16x16x32_bf16 a[24:27], v[144:147], v[32:35], a[24:27]
    ds_read_b64_tr_b16 v[142:143], v229 offset:13952
    v_mfma_f32_16x16x32_bf16 a[28:31], v[144:147], v[36:39], a[28:31]
    s_add_u32 s100, s69, 294912
    s_waitcnt lgkmcnt(4)
    v_mfma_f32_16x16x32_bf16 a[32:35], v[148:151], v[24:27], a[32:35]
    buffer_load_dwordx4 v[16:19], v3, s[64:67], s100 offen offset:2048 sc1
    v_mfma_f32_16x16x32_bf16 a[36:39], v[148:151], v[28:31], a[36:39]
    ds_read_b64_tr_b16 v[144:145], v229 offset:9376
    v_mfma_f32_16x16x32_bf16 a[40:43], v[148:151], v[32:35], a[40:43]
    ds_read_b64_tr_b16 v[146:147], v229 offset:13984
    v_mfma_f32_16x16x32_bf16 a[44:47], v[148:151], v[36:39], a[44:47]
    s_add_u32 s100, s69, 294912
    s_waitcnt lgkmcnt(4)
    v_mfma_f32_16x16x32_bf16 a[48:51], v[136:139], v[24:27], a[48:51]
    buffer_load_dwordx4 v[20:23], v3, s[64:67], s100 offen offset:3072 sc1
    v_mfma_f32_16x16x32_bf16 a[52:55], v[136:139], v[28:31], a[52:55]
    ds_read_b64_tr_b16 v[148:149], v229 offset:9408
    v_mfma_f32_16x16x32_bf16 a[56:59], v[136:139], v[32:35], a[56:59]
    ds_read_b64_tr_b16 v[150:151], v229 offset:14016
    v_mfma_f32_16x16x32_bf16 a[60:63], v[136:139], v[36:39], a[60:63]
    s_waitcnt lgkmcnt(4)
    v_mfma_f32_16x16x32_bf16 a[64:67], v[140:143], v[24:27], a[64:67]
    buffer_load_dwordx4 v226, s[60:63], s99 offen offset:3072 lds
    v_mfma_f32_16x16x32_bf16 a[68:71], v[140:143], v[28:31], a[68:71]
    ds_read_b64_tr_b16 v[136:137], v229 offset:9440
    v_mfma_f32_16x16x32_bf16 a[72:75], v[140:143], v[32:35], a[72:75]
    ds_read_b64_tr_b16 v[138:139], v229 offset:14048
    v_mfma_f32_16x16x32_bf16 a[76:79], v[140:143], v[36:39], a[76:79]
    s_add_u32 m0, s70, 118784
    s_waitcnt lgkmcnt(4)
    v_mfma_f32_16x16x32_bf16 a[80:83], v[144:147], v[24:27], a[80:83]
    buffer_load_dwordx4 v227, s[60:63], s99 offen offset:0 lds
    v_mfma_f32_16x16x32_bf16 a[84:87], v[144:147], v[28:31], a[84:87]
    ds_read_b64_tr_b16 v[140:141], v229 offset:9472
    v_mfma_f32_16x16x32_bf16 a[88:91], v[144:147], v[32:35], a[88:91]
    ds_read_b64_tr_b16 v[142:143], v229 offset:14080
    v_mfma_f32_16x16x32_bf16 a[92:95], v[144:147], v[36:39], a[92:95]
    s_waitcnt lgkmcnt(4)
    v_mfma_f32_16x16x32_bf16 a[96:99], v[148:151], v[24:27], a[96:99]
    v_mfma_f32_16x16x32_bf16 a[100:103], v[148:151], v[28:31], a[100:103]
    ds_read_b64_tr_b16 v[144:145], v229 offset:18432
    v_mfma_f32_16x16x32_bf16 a[104:107], v[148:151], v[32:35], a[104:107]
    ds_read_b64_tr_b16 v[146:147], v229 offset:23040
    v_mfma_f32_16x16x32_bf16 a[108:111], v[148:151], v[36:39], a[108:111]
    s_waitcnt lgkmcnt(4)
    v_mfma_f32_16x16x32_bf16 a[112:115], v[136:139], v[24:27], a[112:115]
    v_mfma_f32_16x16x32_bf16 a[116:119], v[136:139], v[28:31], a[116:119]
    ds_read_b64_tr_b16 v[148:149], v229 offset:18464
    v_mfma_f32_16x16x32_bf16 a[120:123], v[136:139], v[32:35], a[120:123]
    ds_read_b64_tr_b16 v[150:151], v229 offset:23072
    v_mfma_f32_16x16x32_bf16 a[124:127], v[136:139], v[36:39], a[124:127]
    s_waitcnt lgkmcnt(4)
    v_mfma_f32_16x16x32_bf16 a[128:131], v[140:143], v[24:27], a[128:131]
    v_mfma_f32_16x16x32_bf16 a[132:135], v[140:143], v[28:31], a[132:135]
    ds_read_b64_tr_b16 v[136:137], v229 offset:18496
    v_mfma_f32_16x16x32_bf16 a[136:139], v[140:143], v[32:35], a[136:139]
    ds_read_b64_tr_b16 v[138:139], v229 offset:23104
    v_mfma_f32_16x16x32_bf16 a[140:143], v[140:143], v[36:39], a[140:143]
    s_add_u32 s100, s69, 311296
    s_waitcnt lgkmcnt(4)
    s_waitcnt vmcnt(38)
    v_mfma_f32_16x16x32_bf16 a[0:3], v[144:147], v[40:43], a[0:3]
    buffer_load_dwordx4 v[24:27], v3, s[64:67], s100 offen offset:0 sc1
    v_mfma_f32_16x16x32_bf16 a[4:7], v[144:147], v[44:47], a[4:7]
    ds_read_b64_tr_b16 v[140:141], v229 offset:18528
    v_mfma_f32_16x16x32_bf16 a[8:11], v[144:147], v[48:51], a[8:11]
    ds_read_b64_tr_b16 v[142:143], v229 offset:23136
    v_mfma_f32_16x16x32_bf16 a[12:15], v[144:147], v[52:55], a[12:15]
    s_add_u32 s100, s69, 311296
    s_waitcnt lgkmcnt(4)
    v_mfma_f32_16x16x32_bf16 a[16:19], v[148:151], v[40:43], a[16:19]
    buffer_load_dwordx4 v[28:31], v3, s[64:67], s100 offen offset:1024 sc1
    v_mfma_f32_16x16x32_bf16 a[20:23], v[148:151], v[44:47], a[20:23]
    ds_read_b64_tr_b16 v[144:145], v229 offset:18560
    v_mfma_f32_16x16x32_bf16 a[24:27], v[148:151], v[48:51], a[24:27]
    ds_read_b64_tr_b16 v[146:147], v229 offset:23168
    v_mfma_f32_16x16x32_bf16 a[28:31], v[148:151], v[52:55], a[28:31]
    s_add_u32 s100, s69, 311296
    s_waitcnt lgkmcnt(4)
    v_mfma_f32_16x16x32_bf16 a[32:35], v[136:139], v[40:43], a[32:35]
    buffer_load_dwordx4 v[32:35], v3, s[64:67], s100 offen offset:2048 sc1
    v_mfma_f32_16x16x32_bf16 a[36:39], v[136:139], v[44:47], a[36:39]
    ds_read_b64_tr_b16 v[148:149], v229 offset:18592
    v_mfma_f32_16x16x32_bf16 a[40:43], v[136:139], v[48:51], a[40:43]
    ds_read_b64_tr_b16 v[150:151], v229 offset:23200
    v_mfma_f32_16x16x32_bf16 a[44:47], v[136:139], v[52:55], a[44:47]
    s_add_u32 s100, s69, 311296
    s_waitcnt lgkmcnt(4)
    v_mfma_f32_16x16x32_bf16 a[48:51], v[140:143], v[40:43], a[48:51]
    buffer_load_dwordx4 v[36:39], v3, s[64:67], s100 offen offset:3072 sc1
    v_mfma_f32_16x16x32_bf16 a[52:55], v[140:143], v[44:47], a[52:55]
    ds_read_b64_tr_b16 v[136:137], v229 offset:18624
    v_mfma_f32_16x16x32_bf16 a[56:59], v[140:143], v[48:51], a[56:59]
    ds_read_b64_tr_b16 v[138:139], v229 offset:23232
    v_mfma_f32_16x16x32_bf16 a[60:63], v[140:143], v[52:55], a[60:63]
    s_waitcnt lgkmcnt(4)
    v_mfma_f32_16x16x32_bf16 a[64:67], v[144:147], v[40:43], a[64:67]
    v_mfma_f32_16x16x32_bf16 a[68:71], v[144:147], v[44:47], a[68:71]
    ds_read_b64_tr_b16 v[140:141], v229 offset:18656
    v_mfma_f32_16x16x32_bf16 a[72:75], v[144:147], v[48:51], a[72:75]
    ds_read_b64_tr_b16 v[142:143], v229 offset:23264
    v_mfma_f32_16x16x32_bf16 a[76:79], v[144:147], v[52:55], a[76:79]
    s_waitcnt lgkmcnt(4)
    v_mfma_f32_16x16x32_bf16 a[80:83], v[148:151], v[40:43], a[80:83]
    v_mfma_f32_16x16x32_bf16 a[84:87], v[148:151], v[44:47], a[84:87]
    ds_read_b64_tr_b16 v[144:145], v229 offset:18688
    v_mfma_f32_16x16x32_bf16 a[88:91], v[148:151], v[48:51], a[88:91]
    ds_read_b64_tr_b16 v[146:147], v229 offset:23296
    v_mfma_f32_16x16x32_bf16 a[92:95], v[148:151], v[52:55], a[92:95]
    s_waitcnt lgkmcnt(4)
    v_mfma_f32_16x16x32_bf16 a[96:99], v[136:139], v[40:43], a[96:99]
    v_mfma_f32_16x16x32_bf16 a[100:103], v[136:139], v[44:47], a[100:103]
    ds_read_b64_tr_b16 v[148:149], v229 offset:27648
    v_mfma_f32_16x16x32_bf16 a[104:107], v[136:139], v[48:51], a[104:107]
    ds_read_b64_tr_b16 v[150:151], v229 offset:32256
    v_mfma_f32_16x16x32_bf16 a[108:111], v[136:139], v[52:55], a[108:111]
    s_waitcnt lgkmcnt(4)
    v_mfma_f32_16x16x32_bf16 a[112:115], v[140:143], v[40:43], a[112:115]
    v_mfma_f32_16x16x32_bf16 a[116:119], v[140:143], v[44:47], a[116:119]
    ds_read_b64_tr_b16 v[136:137], v229 offset:27680
    v_mfma_f32_16x16x32_bf16 a[120:123], v[140:143], v[48:51], a[120:123]
    ds_read_b64_tr_b16 v[138:139], v229 offset:32288
    v_mfma_f32_16x16x32_bf16 a[124:127], v[140:143], v[52:55], a[124:127]
    s_waitcnt lgkmcnt(4)
    v_mfma_f32_16x16x32_bf16 a[128:131], v[144:147], v[40:43], a[128:131]
    v_mfma_f32_16x16x32_bf16 a[132:135], v[144:147], v[44:47], a[132:135]
    ds_read_b64_tr_b16 v[140:141], v229 offset:27712
    v_mfma_f32_16x16x32_bf16 a[136:139], v[144:147], v[48:51], a[136:139]
    ds_read_b64_tr_b16 v[142:143], v229 offset:32320
    v_mfma_f32_16x16x32_bf16 a[140:143], v[144:147], v[52:55], a[140:143]
    s_add_u32 s100, s69, 360448
    s_waitcnt lgkmcnt(4)
    v_mfma_f32_16x16x32_bf16 a[0:3], v[148:151], v[56:59], a[0:3]
    buffer_load_dwordx4 v[40:43], v3, s[64:67], s100 offen offset:0 sc1
    v_mfma_f32_16x16x32_bf16 a[4:7], v[148:151], v[60:63], a[4:7]
    ds_read_b64_tr_b16 v[144:145], v229 offset:27744
    v_mfma_f32_16x16x32_bf16 a[8:11], v[148:151], v[64:67], a[8:11]
    ds_read_b64_tr_b16 v[146:147], v229 offset:32352
    v_mfma_f32_16x16x32_bf16 a[12:15], v[148:151], v[68:71], a[12:15]
    s_add_u32 s100, s69, 360448
    s_waitcnt lgkmcnt(4)
    v_mfma_f32_16x16x32_bf16 a[16:19], v[136:139], v[56:59], a[16:19]
    buffer_load_dwordx4 v[44:47], v3, s[64:67], s100 offen offset:1024 sc1
    v_mfma_f32_16x16x32_bf16 a[20:23], v[136:139], v[60:63], a[20:23]
    ds_read_b64_tr_b16 v[148:149], v229 offset:27776
    v_mfma_f32_16x16x32_bf16 a[24:27], v[136:139], v[64:67], a[24:27]
    ds_read_b64_tr_b16 v[150:151], v229 offset:32384
    v_mfma_f32_16x16x32_bf16 a[28:31], v[136:139], v[68:71], a[28:31]
    s_add_u32 s100, s69, 360448
    s_waitcnt lgkmcnt(4)
    v_mfma_f32_16x16x32_bf16 a[32:35], v[140:143], v[56:59], a[32:35]
    buffer_load_dwordx4 v[48:51], v3, s[64:67], s100 offen offset:2048 sc1
    v_mfma_f32_16x16x32_bf16 a[36:39], v[140:143], v[60:63], a[36:39]
    ds_read_b64_tr_b16 v[136:137], v229 offset:27808
    v_mfma_f32_16x16x32_bf16 a[40:43], v[140:143], v[64:67], a[40:43]
    ds_read_b64_tr_b16 v[138:139], v229 offset:32416
    v_mfma_f32_16x16x32_bf16 a[44:47], v[140:143], v[68:71], a[44:47]
    s_add_u32 s100, s69, 360448
    s_waitcnt lgkmcnt(4)
    v_mfma_f32_16x16x32_bf16 a[48:51], v[144:147], v[56:59], a[48:51]
    buffer_load_dwordx4 v[52:55], v3, s[64:67], s100 offen offset:3072 sc1
    v_mfma_f32_16x16x32_bf16 a[52:55], v[144:147], v[60:63], a[52:55]
    ds_read_b64_tr_b16 v[140:141], v229 offset:27840
    v_mfma_f32_16x16x32_bf16 a[56:59], v[144:147], v[64:67], a[56:59]
    ds_read_b64_tr_b16 v[142:143], v229 offset:32448
    v_mfma_f32_16x16x32_bf16 a[60:63], v[144:147], v[68:71], a[60:63]
    s_waitcnt lgkmcnt(4)
    v_mfma_f32_16x16x32_bf16 a[64:67], v[148:151], v[56:59], a[64:67]
    v_mfma_f32_16x16x32_bf16 a[68:71], v[148:151], v[60:63], a[68:71]
    ds_read_b64_tr_b16 v[144:145], v229 offset:27872
    v_mfma_f32_16x16x32_bf16 a[72:75], v[148:151], v[64:67], a[72:75]
    ds_read_b64_tr_b16 v[146:147], v229 offset:32480
    v_mfma_f32_16x16x32_bf16 a[76:79], v[148:151], v[68:71], a[76:79]
    s_waitcnt lgkmcnt(4)
    v_mfma_f32_16x16x32_bf16 a[80:83], v[136:139], v[56:59], a[80:83]
    v_mfma_f32_16x16x32_bf16 a[84:87], v[136:139], v[60:63], a[84:87]
    ds_read_b64_tr_b16 v[148:149], v229 offset:27904
    v_mfma_f32_16x16x32_bf16 a[88:91], v[136:139], v[64:67], a[88:91]
    ds_read_b64_tr_b16 v[150:151], v229 offset:32512
    v_mfma_f32_16x16x32_bf16 a[92:95], v[136:139], v[68:71], a[92:95]
    s_waitcnt lgkmcnt(4)
    v_mfma_f32_16x16x32_bf16 a[96:99], v[140:143], v[56:59], a[96:99]
    s_waitcnt lgkmcnt(0)
    s_barrier
    v_add_u32 v229, 36864, v228
    v_mfma_f32_16x16x32_bf16 a[100:103], v[140:143], v[60:63], a[100:103]
    ds_read_b64_tr_b16 v[136:137], v229 offset:0
    v_mfma_f32_16x16x32_bf16 a[104:107], v[140:143], v[64:67], a[104:107]
    ds_read_b64_tr_b16 v[138:139], v229 offset:4608
    v_mfma_f32_16x16x32_bf16 a[108:111], v[140:143], v[68:71], a[108:111]
    v_mfma_f32_16x16x32_bf16 a[112:115], v[144:147], v[56:59], a[112:115]
    v_mfma_f32_16x16x32_bf16 a[116:119], v[144:147], v[60:63], a[116:119]
    ds_read_b64_tr_b16 v[140:141], v229 offset:32
    v_mfma_f32_16x16x32_bf16 a[120:123], v[144:147], v[64:67], a[120:123]
    ds_read_b64_tr_b16 v[142:143], v229 offset:4640
    v_mfma_f32_16x16x32_bf16 a[124:127], v[144:147], v[68:71], a[124:127]
    v_mfma_f32_16x16x32_bf16 a[128:131], v[148:151], v[56:59], a[128:131]
    v_mfma_f32_16x16x32_bf16 a[132:135], v[148:151], v[60:63], a[132:135]
    ds_read_b64_tr_b16 v[144:145], v229 offset:64
    v_mfma_f32_16x16x32_bf16 a[136:139], v[148:151], v[64:67], a[136:139]
    ds_read_b64_tr_b16 v[146:147], v229 offset:4672
    v_mfma_f32_16x16x32_bf16 a[140:143], v[148:151], v[68:71], a[140:143]
    s_add_u32 s100, s69, 376832
    s_waitcnt lgkmcnt(4)
    s_waitcnt vmcnt(40)
    v_mfma_f32_16x16x32_bf16 a[0:3], v[136:139], v[72:75], a[0:3]
    buffer_load_dwordx4 v[56:59], v3, s[64:67], s100 offen offset:0 sc1
    v_mfma_f32_16x16x32_bf16 a[4:7], v[136:139], v[76:79], a[4:7]
    ds_read_b64_tr_b16 v[148:149], v229 offset:96
    v_mfma_f32_16x16x32_bf16 a[8:11], v[136:139], v[80:83], a[8:11]
    ds_read_b64_tr_b16 v[150:151], v229 offset:4704
    v_mfma_f32_16x16x32_bf16 a[12:15], v[136:139], v[84:87], a[12:15]
    s_add_u32 s100, s69, 376832
    s_waitcnt lgkmcnt(4)
    v_mfma_f32_16x16x32_bf16 a[16:19], v[140:143], v[72:75], a[16:19]
    buffer_load_dwordx4 v[60:63], v3, s[64:67], s100 offen offset:1024 sc1
    v_mfma_f32_16x16x32_bf16 a[20:23], v[140:143], v[76:79], a[20:23]
    ds_read_b64_tr_b16 v[136:137], v229 offset:128
    v_mfma_f32_16x16x32_bf16 a[24:27], v[140:143], v[80:83], a[24:27]
    ds_read_b64_tr_b16 v[138:139], v229 offset:4736
    v_mfma_f32_16x16x32_bf16 a[28:31], v[140:143], v[84:87], a[28:31]
    s_add_u32 s100, s69, 376832
    s_waitcnt lgkmcnt(4)
    v_mfma_f32_16x16x32_bf16 a[32:35], v[144:147], v[72:75], a[32:35]
    buffer_load_dwordx4 v[64:67], v3, s[64:67], s100 offen offset:2048 sc1
    v_mfma_f32_16x16x32_bf16 a[36:39], v[144:147], v[76:79], a[36:39]
    ds_read_b64_tr_b16 v[140:141], v229 offset:160
    v_mfma_f32_16x16x32_bf16 a[40:43], v[144:147], v[80:83], a[40:43]
    ds_read_b64_tr_b16 v[142:143], v229 offset:4768
    v_mfma_f32_16x16x32_bf16 a[44:47], v[144:147], v[84:87], a[44:47]
    s_add_u32 s100, s69, 376832
    s_waitcnt lgkmcnt(4)
    v_mfma_f32_16x16x32_bf16 a[48:51], v[148:151], v[72:75], a[48:51]
    buffer_load_dwordx4 v[68:71], v3, s[64:67], s100 offen offset:3072 sc1
    v_mfma_f32_16x16x32_bf16 a[52:55], v[148:151], v[76:79], a[52:55]
    ds_read_b64_tr_b16 v[144:145], v229 offset:192
    v_mfma_f32_16x16x32_bf16 a[56:59], v[148:151], v[80:83], a[56:59]
    ds_read_b64_tr_b16 v[146:147], v229 offset:4800
    v_mfma_f32_16x16x32_bf16 a[60:63], v[148:151], v[84:87], a[60:63]
    s_waitcnt lgkmcnt(4)
    v_mfma_f32_16x16x32_bf16 a[64:67], v[136:139], v[72:75], a[64:67]
    v_mfma_f32_16x16x32_bf16 a[68:71], v[136:139], v[76:79], a[68:71]
    ds_read_b64_tr_b16 v[148:149], v229 offset:224
    v_mfma_f32_16x16x32_bf16 a[72:75], v[136:139], v[80:83], a[72:75]
    ds_read_b64_tr_b16 v[150:151], v229 offset:4832
    v_mfma_f32_16x16x32_bf16 a[76:79], v[136:139], v[84:87], a[76:79]
    s_waitcnt lgkmcnt(4)
    v_mfma_f32_16x16x32_bf16 a[80:83], v[140:143], v[72:75], a[80:83]
    v_mfma_f32_16x16x32_bf16 a[84:87], v[140:143], v[76:79], a[84:87]
    ds_read_b64_tr_b16 v[136:137], v229 offset:256
    v_mfma_f32_16x16x32_bf16 a[88:91], v[140:143], v[80:83], a[88:91]
    ds_read_b64_tr_b16 v[138:139], v229 offset:4864
    v_mfma_f32_16x16x32_bf16 a[92:95], v[140:143], v[84:87], a[92:95]
    s_waitcnt lgkmcnt(4)
    v_mfma_f32_16x16x32_bf16 a[96:99], v[144:147], v[72:75], a[96:99]
    v_mfma_f32_16x16x32_bf16 a[100:103], v[144:147], v[76:79], a[100:103]
    ds_read_b64_tr_b16 v[140:141], v229 offset:9216
    v_mfma_f32_16x16x32_bf16 a[104:107], v[144:147], v[80:83], a[104:107]
    ds_read_b64_tr_b16 v[142:143], v229 offset:13824
    v_mfma_f32_16x16x32_bf16 a[108:111], v[144:147], v[84:87], a[108:111]
    s_waitcnt lgkmcnt(4)
    v_mfma_f32_16x16x32_bf16 a[112:115], v[148:151], v[72:75], a[112:115]
    v_mfma_f32_16x16x32_bf16 a[116:119], v[148:151], v[76:79], a[116:119]
    ds_read_b64_tr_b16 v[144:145], v229 offset:9248
    v_mfma_f32_16x16x32_bf16 a[120:123], v[148:151], v[80:83], a[120:123]
    ds_read_b64_tr_b16 v[146:147], v229 offset:13856
    v_mfma_f32_16x16x32_bf16 a[124:127], v[148:151], v[84:87], a[124:127]
    s_waitcnt lgkmcnt(4)
    v_mfma_f32_16x16x32_bf16 a[128:131], v[136:139], v[72:75], a[128:131]
    v_mfma_f32_16x16x32_bf16 a[132:135], v[136:139], v[76:79], a[132:135]
    ds_read_b64_tr_b16 v[148:149], v229 offset:9280
    v_mfma_f32_16x16x32_bf16 a[136:139], v[136:139], v[80:83], a[136:139]
    ds_read_b64_tr_b16 v[150:151], v229 offset:13888
    v_mfma_f32_16x16x32_bf16 a[140:143], v[136:139], v[84:87], a[140:143]
    s_add_u32 s100, s69, 425984
    s_waitcnt lgkmcnt(4)
    s_waitcnt vmcnt(35)
    v_mfma_f32_16x16x32_bf16 a[0:3], v[140:143], v[88:91], a[0:3]
    buffer_load_dwordx4 v[72:75], v3, s[64:67], s100 offen offset:0 sc1
    v_mfma_f32_16x16x32_bf16 a[4:7], v[140:143], v[92:95], a[4:7]
    ds_read_b64_tr_b16 v[136:137], v229 offset:9312
    v_mfma_f32_16x16x32_bf16 a[8:11], v[140:143], v[96:99], a[8:11]
    ds_read_b64_tr_b16 v[138:139], v229 offset:13920
    v_mfma_f32_16x16x32_bf16 a[12:15], v[140:143], v[100:103], a[12:15]
    s_add_u32 s100, s69, 425984
    s_waitcnt lgkmcnt(4)
    v_mfma_f32_16x16x32_bf16 a[16:19], v[144:147], v[88:91], a[16:19]
    buffer_load_dwordx4 v[76:79], v3, s[64:67], s100 offen offset:1024 sc1
    v_mfma_f32_16x16x32_bf16 a[20:23], v[144:147], v[92:95], a[20:23]
    ds_read_b64_tr_b16 v[140:141], v229 offset:9344
    v_mfma_f32_16x16x32_bf16 a[24:27], v[144:147], v[96:99], a[24:27]
    ds_read_b64_tr_b16 v[142:143], v229 offset:13952
    v_mfma_f32_16x16x32_bf16 a[28:31], v[144:147], v[100:103], a[28:31]
    s_add_u32 s100, s69, 425984
    s_waitcnt lgkmcnt(4)
    v_mfma_f32_16x16x32_bf16 a[32:35], v[148:151], v[88:91], a[32:35]
    buffer_load_dwordx4 v[80:83], v3, s[64:67], s100 offen offset:2048 sc1
    v_mfma_f32_16x16x32_bf16 a[36:39], v[148:151], v[92:95], a[36:39]
    ds_read_b64_tr_b16 v[144:145], v229 offset:9376
    v_mfma_f32_16x16x32_bf16 a[40:43], v[148:151], v[96:99], a[40:43]
    ds_read_b64_tr_b16 v[146:147], v229 offset:13984
    v_mfma_f32_16x16x32_bf16 a[44:47], v[148:151], v[100:103], a[44:47]
    s_add_u32 s100, s69, 425984
    s_waitcnt lgkmcnt(4)
    v_mfma_f32_16x16x32_bf16 a[48:51], v[136:139], v[88:91], a[48:51]
    buffer_load_dwordx4 v[84:87], v3, s[64:67], s100 offen offset:3072 sc1
    v_mfma_f32_16x16x32_bf16 a[52:55], v[136:139], v[92:95], a[52:55]
    ds_read_b64_tr_b16 v[148:149], v229 offset:9408
    v_mfma_f32_16x16x32_bf16 a[56:59], v[136:139], v[96:99], a[56:59]
    ds_read_b64_tr_b16 v[150:151], v229 offset:14016
    v_mfma_f32_16x16x32_bf16 a[60:63], v[136:139], v[100:103], a[60:63]
    s_waitcnt lgkmcnt(4)
    v_mfma_f32_16x16x32_bf16 a[64:67], v[140:143], v[88:91], a[64:67]
    v_mfma_f32_16x16x32_bf16 a[68:71], v[140:143], v[92:95], a[68:71]
    ds_read_b64_tr_b16 v[136:137], v229 offset:9440
    v_mfma_f32_16x16x32_bf16 a[72:75], v[140:143], v[96:99], a[72:75]
    ds_read_b64_tr_b16 v[138:139], v229 offset:14048
    v_mfma_f32_16x16x32_bf16 a[76:79], v[140:143], v[100:103], a[76:79]
    s_waitcnt lgkmcnt(4)
    v_mfma_f32_16x16x32_bf16 a[80:83], v[144:147], v[88:91], a[80:83]
    v_mfma_f32_16x16x32_bf16 a[84:87], v[144:147], v[92:95], a[84:87]
    ds_read_b64_tr_b16 v[140:141], v229 offset:9472
    v_mfma_f32_16x16x32_bf16 a[88:91], v[144:147], v[96:99], a[88:91]
    ds_read_b64_tr_b16 v[142:143], v229 offset:14080
    v_mfma_f32_16x16x32_bf16 a[92:95], v[144:147], v[100:103], a[92:95]
    s_waitcnt lgkmcnt(4)
    v_mfma_f32_16x16x32_bf16 a[96:99], v[148:151], v[88:91], a[96:99]
    v_mfma_f32_16x16x32_bf16 a[100:103], v[148:151], v[92:95], a[100:103]
    ds_read_b64_tr_b16 v[144:145], v229 offset:18432
    v_mfma_f32_16x16x32_bf16 a[104:107], v[148:151], v[96:99], a[104:107]
    ds_read_b64_tr_b16 v[146:147], v229 offset:23040
    v_mfma_f32_16x16x32_bf16 a[108:111], v[148:151], v[100:103], a[108:111]
    s_waitcnt lgkmcnt(4)
    v_mfma_f32_16x16x32_bf16 a[112:115], v[136:139], v[88:91], a[112:115]
    v_mfma_f32_16x16x32_bf16 a[116:119], v[136:139], v[92:95], a[116:119]
    ds_read_b64_tr_b16 v[148:149], v229 offset:18464
    v_mfma_f32_16x16x32_bf16 a[120:123], v[136:139], v[96:99], a[120:123]
    ds_read_b64_tr_b16 v[150:151], v229 offset:23072
    v_mfma_f32_16x16x32_bf16 a[124:127], v[136:139], v[100:103], a[124:127]
    s_waitcnt lgkmcnt(4)
    v_mfma_f32_16x16x32_bf16 a[128:131], v[140:143], v[88:91], a[128:131]
    v_mfma_f32_16x16x32_bf16 a[132:135], v[140:143], v[92:95], a[132:135]
    ds_read_b64_tr_b16 v[136:137], v229 offset:18496
    v_mfma_f32_16x16x32_bf16 a[136:139], v[140:143], v[96:99], a[136:139]
    ds_read_b64_tr_b16 v[138:139], v229 offset:23104
    v_mfma_f32_16x16x32_bf16 a[140:143], v[140:143], v[100:103], a[140:143]
    s_add_u32 s100, s69, 442368
    s_waitcnt lgkmcnt(4)
    s_waitcnt vmcnt(33)
    v_mfma_f32_16x16x32_bf16 a[0:3], v[144:147], v[104:107], a[0:3]
    buffer_load_dwordx4 v[88:91], v3, s[64:67], s100 offen offset:0 sc1
    v_mfma_f32_16x16x32_bf16 a[4:7], v[144:147], v[108:111], a[4:7]
    ds_read_b64_tr_b16 v[140:141], v229 offset:18528
    v_mfma_f32_16x16x32_bf16 a[8:11], v[144:147], v[112:115], a[8:11]
    ds_read_b64_tr_b16 v[142:143], v229 offset:23136
    v_mfma_f32_16x16x32_bf16 a[12:15], v[144:147], v[116:119], a[12:15]
    s_add_u32 s100, s69, 442368
    s_waitcnt lgkmcnt(4)
    v_mfma_f32_16x16x32_bf16 a[16:19], v[148:151], v[104:107], a[16:19]
    buffer_load_dwordx4 v[92:95], v3, s[64:67], s100 offen offset:1024 sc1
    v_mfma_f32_16x16x32_bf16 a[20:23], v[148:151], v[108:111], a[20:23]
    ds_read_b64_tr_b16 v[144:145], v229 offset:18560
    v_mfma_f32_16x16x32_bf16 a[24:27], v[148:151], v[112:115], a[24:27]
    ds_read_b64_tr_b16 v[146:147], v229 offset:23168
    v_mfma_f32_16x16x32_bf16 a[28:31], v[148:151], v[116:119], a[28:31]
    s_add_u32 s100, s69, 442368
    s_waitcnt lgkmcnt(4)
    v_mfma_f32_16x16x32_bf16 a[32:35], v[136:139], v[104:107], a[32:35]
    buffer_load_dwordx4 v[96:99], v3, s[64:67], s100 offen offset:2048 sc1
    v_mfma_f32_16x16x32_bf16 a[36:39], v[136:139], v[108:111], a[36:39]
    ds_read_b64_tr_b16 v[148:149], v229 offset:18592
    v_mfma_f32_16x16x32_bf16 a[40:43], v[136:139], v[112:115], a[40:43]
    ds_read_b64_tr_b16 v[150:151], v229 offset:23200
    v_mfma_f32_16x16x32_bf16 a[44:47], v[136:139], v[116:119], a[44:47]
    s_add_u32 s100, s69, 442368
    s_waitcnt lgkmcnt(4)
    v_mfma_f32_16x16x32_bf16 a[48:51], v[140:143], v[104:107], a[48:51]
    buffer_load_dwordx4 v[100:103], v3, s[64:67], s100 offen offset:3072 sc1
    v_mfma_f32_16x16x32_bf16 a[52:55], v[140:143], v[108:111], a[52:55]
    ds_read_b64_tr_b16 v[136:137], v229 offset:18624
    v_mfma_f32_16x16x32_bf16 a[56:59], v[140:143], v[112:115], a[56:59]
    ds_read_b64_tr_b16 v[138:139], v229 offset:23232
    v_mfma_f32_16x16x32_bf16 a[60:63], v[140:143], v[116:119], a[60:63]
    s_waitcnt lgkmcnt(4)
    v_mfma_f32_16x16x32_bf16 a[64:67], v[144:147], v[104:107], a[64:67]
    v_mfma_f32_16x16x32_bf16 a[68:71], v[144:147], v[108:111], a[68:71]
    ds_read_b64_tr_b16 v[140:141], v229 offset:18656
    v_mfma_f32_16x16x32_bf16 a[72:75], v[144:147], v[112:115], a[72:75]
    ds_read_b64_tr_b16 v[142:143], v229 offset:23264
    v_mfma_f32_16x16x32_bf16 a[76:79], v[144:147], v[116:119], a[76:79]
    s_waitcnt lgkmcnt(4)
    v_mfma_f32_16x16x32_bf16 a[80:83], v[148:151], v[104:107], a[80:83]
    v_mfma_f32_16x16x32_bf16 a[84:87], v[148:151], v[108:111], a[84:87]
    ds_read_b64_tr_b16 v[144:145], v229 offset:18688
    v_mfma_f32_16x16x32_bf16 a[88:91], v[148:151], v[112:115], a[88:91]
    ds_read_b64_tr_b16 v[146:147], v229 offset:23296
    v_mfma_f32_16x16x32_bf16 a[92:95], v[148:151], v[116:119], a[92:95]
    s_waitcnt lgkmcnt(4)
    v_mfma_f32_16x16x32_bf16 a[96:99], v[136:139], v[104:107], a[96:99]
    v_mfma_f32_16x16x32_bf16 a[100:103], v[136:139], v[108:111], a[100:103]
    ds_read_b64_tr_b16 v[148:149], v229 offset:27648
    v_mfma_f32_16x16x32_bf16 a[104:107], v[136:139], v[112:115], a[104:107]
    ds_read_b64_tr_b16 v[150:151], v229 offset:32256
    v_mfma_f32_16x16x32_bf16 a[108:111], v[136:139], v[116:119], a[108:111]
    s_waitcnt lgkmcnt(4)
    v_mfma_f32_16x16x32_bf16 a[112:115], v[140:143], v[104:107], a[112:115]
    v_mfma_f32_16x16x32_bf16 a[116:119], v[140:143], v[108:111], a[116:119]
    ds_read_b64_tr_b16 v[136:137], v229 offset:27680
    v_mfma_f32_16x16x32_bf16 a[120:123], v[140:143], v[112:115], a[120:123]
    ds_read_b64_tr_b16 v[138:139], v229 offset:32288
    v_mfma_f32_16x16x32_bf16 a[124:127], v[140:143], v[116:119], a[124:127]
    s_waitcnt lgkmcnt(4)
    v_mfma_f32_16x16x32_bf16 a[128:131], v[144:147], v[104:107], a[128:131]
    v_mfma_f32_16x16x32_bf16 a[132:135], v[144:147], v[108:111], a[132:135]
    ds_read_b64_tr_b16 v[140:141], v229 offset:27712
    v_mfma_f32_16x16x32_bf16 a[136:139], v[144:147], v[112:115], a[136:139]
    ds_read_b64_tr_b16 v[142:143], v229 offset:32320
    v_mfma_f32_16x16x32_bf16 a[140:143], v[144:147], v[116:119], a[140:143]
    s_add_u32 s100, s69, 491520
    s_waitcnt lgkmcnt(4)
    s_waitcnt vmcnt(31)
    v_mfma_f32_16x16x32_bf16 a[0:3], v[148:151], v[120:123], a[0:3]
    buffer_load_dwordx4 v[104:107], v3, s[64:67], s100 offen offset:0 sc1
    v_mfma_f32_16x16x32_bf16 a[4:7], v[148:151], v[124:127], a[4:7]
    ds_read_b64_tr_b16 v[144:145], v229 offset:27744
    v_mfma_f32_16x16x32_bf16 a[8:11], v[148:151], v[128:131], a[8:11]
    ds_read_b64_tr_b16 v[146:147], v229 offset:32352
    v_mfma_f32_16x16x32_bf16 a[12:15], v[148:151], v[132:135], a[12:15]
    s_add_u32 s100, s69, 491520
    s_waitcnt lgkmcnt(4)
    v_mfma_f32_16x16x32_bf16 a[16:19], v[136:139], v[120:123], a[16:19]
    buffer_load_dwordx4 v[108:111], v3, s[64:67], s100 offen offset:1024 sc1
    v_mfma_f32_16x16x32_bf16 a[20:23], v[136:139], v[124:127], a[20:23]
    ds_read_b64_tr_b16 v[148:149], v229 offset:27776
    v_mfma_f32_16x16x32_bf16 a[24:27], v[136:139], v[128:131], a[24:27]
    ds_read_b64_tr_b16 v[150:151], v229 offset:32384
    v_mfma_f32_16x16x32_bf16 a[28:31], v[136:139], v[132:135], a[28:31]
    s_add_u32 s100, s69, 491520
    s_waitcnt lgkmcnt(4)
    v_mfma_f32_16x16x32_bf16 a[32:35], v[140:143], v[120:123], a[32:35]
    buffer_load_dwordx4 v[112:115], v3, s[64:67], s100 offen offset:2048 sc1
    v_mfma_f32_16x16x32_bf16 a[36:39], v[140:143], v[124:127], a[36:39]
    ds_read_b64_tr_b16 v[136:137], v229 offset:27808
    v_mfma_f32_16x16x32_bf16 a[40:43], v[140:143], v[128:131], a[40:43]
    ds_read_b64_tr_b16 v[138:139], v229 offset:32416
    v_mfma_f32_16x16x32_bf16 a[44:47], v[140:143], v[132:135], a[44:47]
    s_add_u32 s100, s69, 491520
    s_waitcnt lgkmcnt(4)
    v_mfma_f32_16x16x32_bf16 a[48:51], v[144:147], v[120:123], a[48:51]
    buffer_load_dwordx4 v[116:119], v3, s[64:67], s100 offen offset:3072 sc1
    v_mfma_f32_16x16x32_bf16 a[52:55], v[144:147], v[124:127], a[52:55]
    ds_read_b64_tr_b16 v[140:141], v229 offset:27840
    v_mfma_f32_16x16x32_bf16 a[56:59], v[144:147], v[128:131], a[56:59]
    ds_read_b64_tr_b16 v[142:143], v229 offset:32448
    v_mfma_f32_16x16x32_bf16 a[60:63], v[144:147], v[132:135], a[60:63]
    s_waitcnt lgkmcnt(4)
    v_mfma_f32_16x16x32_bf16 a[64:67], v[148:151], v[120:123], a[64:67]
    v_mfma_f32_16x16x32_bf16 a[68:71], v[148:151], v[124:127], a[68:71]
    ds_read_b64_tr_b16 v[144:145], v229 offset:27872
    v_mfma_f32_16x16x32_bf16 a[72:75], v[148:151], v[128:131], a[72:75]
    ds_read_b64_tr_b16 v[146:147], v229 offset:32480
    v_mfma_f32_16x16x32_bf16 a[76:79], v[148:151], v[132:135], a[76:79]
    s_waitcnt lgkmcnt(4)
    v_mfma_f32_16x16x32_bf16 a[80:83], v[136:139], v[120:123], a[80:83]
    v_mfma_f32_16x16x32_bf16 a[84:87], v[136:139], v[124:127], a[84:87]
    ds_read_b64_tr_b16 v[148:149], v229 offset:27904
    v_mfma_f32_16x16x32_bf16 a[88:91], v[136:139], v[128:131], a[88:91]
    ds_read_b64_tr_b16 v[150:151], v229 offset:32512
    v_mfma_f32_16x16x32_bf16 a[92:95], v[136:139], v[132:135], a[92:95]
    s_waitcnt lgkmcnt(4)
    v_mfma_f32_16x16x32_bf16 a[96:99], v[140:143], v[120:123], a[96:99]
    s_waitcnt lgkmcnt(0)
    s_barrier
    v_add_u32 v229, 73728, v228
    v_mfma_f32_16x16x32_bf16 a[100:103], v[140:143], v[124:127], a[100:103]
    ds_read_b64_tr_b16 v[136:137], v229 offset:0
    v_mfma_f32_16x16x32_bf16 a[104:107], v[140:143], v[128:131], a[104:107]
    ds_read_b64_tr_b16 v[138:139], v229 offset:4608
    v_mfma_f32_16x16x32_bf16 a[108:111], v[140:143], v[132:135], a[108:111]
    v_mfma_f32_16x16x32_bf16 a[112:115], v[144:147], v[120:123], a[112:115]
    v_mfma_f32_16x16x32_bf16 a[116:119], v[144:147], v[124:127], a[116:119]
    ds_read_b64_tr_b16 v[140:141], v229 offset:32
    v_mfma_f32_16x16x32_bf16 a[120:123], v[144:147], v[128:131], a[120:123]
    ds_read_b64_tr_b16 v[142:143], v229 offset:4640
    v_mfma_f32_16x16x32_bf16 a[124:127], v[144:147], v[132:135], a[124:127]
    v_mfma_f32_16x16x32_bf16 a[128:131], v[148:151], v[120:123], a[128:131]
    v_mfma_f32_16x16x32_bf16 a[132:135], v[148:151], v[124:127], a[132:135]
    ds_read_b64_tr_b16 v[144:145], v229 offset:64
    v_mfma_f32_16x16x32_bf16 a[136:139], v[148:151], v[128:131], a[136:139]
    ds_read_b64_tr_b16 v[146:147], v229 offset:4672
    v_mfma_f32_16x16x32_bf16 a[140:143], v[148:151], v[132:135], a[140:143]
    s_add_u32 s100, s69, 507904
    s_waitcnt lgkmcnt(4)
    s_waitcnt vmcnt(26)
    v_mfma_f32_16x16x32_bf16 a[0:3], v[136:139], v[8:11], a[0:3]
    buffer_load_dwordx4 v[120:123], v3, s[64:67], s100 offen offset:0 sc1
    v_mfma_f32_16x16x32_bf16 a[4:7], v[136:139], v[12:15], a[4:7]
    ds_read_b64_tr_b16 v[148:149], v229 offset:96
    v_mfma_f32_16x16x32_bf16 a[8:11], v[136:139], v[16:19], a[8:11]
    ds_read_b64_tr_b16 v[150:151], v229 offset:4704
    v_mfma_f32_16x16x32_bf16 a[12:15], v[136:139], v[20:23], a[12:15]
    s_add_u32 s100, s69, 507904
    s_waitcnt lgkmcnt(4)
    v_mfma_f32_16x16x32_bf16 a[16:19], v[140:143], v[8:11], a[16:19]
    buffer_load_dwordx4 v[124:127], v3, s[64:67], s100 offen offset:1024 sc1
    v_mfma_f32_16x16x32_bf16 a[20:23], v[140:143], v[12:15], a[20:23]
    ds_read_b64_tr_b16 v[136:137], v229 offset:128
    v_mfma_f32_16x16x32_bf16 a[24:27], v[140:143], v[16:19], a[24:27]
    ds_read_b64_tr_b16 v[138:139], v229 offset:4736
    v_mfma_f32_16x16x32_bf16 a[28:31], v[140:143], v[20:23], a[28:31]
    s_add_u32 s100, s69, 507904
    s_waitcnt lgkmcnt(4)
    v_mfma_f32_16x16x32_bf16 a[32:35], v[144:147], v[8:11], a[32:35]
    buffer_load_dwordx4 v[128:131], v3, s[64:67], s100 offen offset:2048 sc1
    v_mfma_f32_16x16x32_bf16 a[36:39], v[144:147], v[12:15], a[36:39]
    ds_read_b64_tr_b16 v[140:141], v229 offset:160
    v_mfma_f32_16x16x32_bf16 a[40:43], v[144:147], v[16:19], a[40:43]
    ds_read_b64_tr_b16 v[142:143], v229 offset:4768
    v_mfma_f32_16x16x32_bf16 a[44:47], v[144:147], v[20:23], a[44:47]
    s_add_u32 s100, s69, 507904
    s_waitcnt lgkmcnt(4)
    v_mfma_f32_16x16x32_bf16 a[48:51], v[148:151], v[8:11], a[48:51]
    buffer_load_dwordx4 v[132:135], v3, s[64:67], s100 offen offset:3072 sc1
    v_mfma_f32_16x16x32_bf16 a[52:55], v[148:151], v[12:15], a[52:55]
    ds_read_b64_tr_b16 v[144:145], v229 offset:192
    v_mfma_f32_16x16x32_bf16 a[56:59], v[148:151], v[16:19], a[56:59]
    ds_read_b64_tr_b16 v[146:147], v229 offset:4800
    v_mfma_f32_16x16x32_bf16 a[60:63], v[148:151], v[20:23], a[60:63]
    s_waitcnt lgkmcnt(4)
    v_mfma_f32_16x16x32_bf16 a[64:67], v[136:139], v[8:11], a[64:67]
    v_mfma_f32_16x16x32_bf16 a[68:71], v[136:139], v[12:15], a[68:71]
    ds_read_b64_tr_b16 v[148:149], v229 offset:224
    v_mfma_f32_16x16x32_bf16 a[72:75], v[136:139], v[16:19], a[72:75]
    ds_read_b64_tr_b16 v[150:151], v229 offset:4832
    v_mfma_f32_16x16x32_bf16 a[76:79], v[136:139], v[20:23], a[76:79]
    s_waitcnt lgkmcnt(4)
    v_mfma_f32_16x16x32_bf16 a[80:83], v[140:143], v[8:11], a[80:83]
    v_mfma_f32_16x16x32_bf16 a[84:87], v[140:143], v[12:15], a[84:87]
    ds_read_b64_tr_b16 v[136:137], v229 offset:256
    v_mfma_f32_16x16x32_bf16 a[88:91], v[140:143], v[16:19], a[88:91]
    ds_read_b64_tr_b16 v[138:139], v229 offset:4864
    v_mfma_f32_16x16x32_bf16 a[92:95], v[140:143], v[20:23], a[92:95]
    s_waitcnt lgkmcnt(4)
    v_mfma_f32_16x16x32_bf16 a[96:99], v[144:147], v[8:11], a[96:99]
    v_mfma_f32_16x16x32_bf16 a[100:103], v[144:147], v[12:15], a[100:103]
    ds_read_b64_tr_b16 v[140:141], v229 offset:9216
    v_mfma_f32_16x16x32_bf16 a[104:107], v[144:147], v[16:19], a[104:107]
    ds_read_b64_tr_b16 v[142:143], v229 offset:13824
    v_mfma_f32_16x16x32_bf16 a[108:111], v[144:147], v[20:23], a[108:111]
    s_waitcnt lgkmcnt(4)
    v_mfma_f32_16x16x32_bf16 a[112:115], v[148:151], v[8:11], a[112:115]
    v_mfma_f32_16x16x32_bf16 a[116:119], v[148:151], v[12:15], a[116:119]
    ds_read_b64_tr_b16 v[144:145], v229 offset:9248
    v_mfma_f32_16x16x32_bf16 a[120:123], v[148:151], v[16:19], a[120:123]
    ds_read_b64_tr_b16 v[146:147], v229 offset:13856
    v_mfma_f32_16x16x32_bf16 a[124:127], v[148:151], v[20:23], a[124:127]
    s_waitcnt lgkmcnt(4)
    v_mfma_f32_16x16x32_bf16 a[128:131], v[136:139], v[8:11], a[128:131]
    v_mfma_f32_16x16x32_bf16 a[132:135], v[136:139], v[12:15], a[132:135]
    ds_read_b64_tr_b16 v[148:149], v229 offset:9280
    v_mfma_f32_16x16x32_bf16 a[136:139], v[136:139], v[16:19], a[136:139]
    ds_read_b64_tr_b16 v[150:151], v229 offset:13888
    v_mfma_f32_16x16x32_bf16 a[140:143], v[136:139], v[20:23], a[140:143]
    s_waitcnt lgkmcnt(4)
    s_waitcnt vmcnt(24)
    v_mfma_f32_16x16x32_bf16 a[0:3], v[140:143], v[24:27], a[0:3]
    v_mfma_f32_16x16x32_bf16 a[4:7], v[140:143], v[28:31], a[4:7]
    ds_read_b64_tr_b16 v[136:137], v229 offset:9312
    v_mfma_f32_16x16x32_bf16 a[8:11], v[140:143], v[32:35], a[8:11]
    ds_read_b64_tr_b16 v[138:139], v229 offset:13920
    v_mfma_f32_16x16x32_bf16 a[12:15], v[140:143], v[36:39], a[12:15]
    s_waitcnt lgkmcnt(4)
    v_mfma_f32_16x16x32_bf16 a[16:19], v[144:147], v[24:27], a[16:19]
    v_mfma_f32_16x16x32_bf16 a[20:23], v[144:147], v[28:31], a[20:23]
    ds_read_b64_tr_b16 v[140:141], v229 offset:9344
    v_mfma_f32_16x16x32_bf16 a[24:27], v[144:147], v[32:35], a[24:27]
    ds_read_b64_tr_b16 v[142:143], v229 offset:13952
    v_mfma_f32_16x16x32_bf16 a[28:31], v[144:147], v[36:39], a[28:31]
    s_waitcnt lgkmcnt(4)
    v_mfma_f32_16x16x32_bf16 a[32:35], v[148:151], v[24:27], a[32:35]
    v_mfma_f32_16x16x32_bf16 a[36:39], v[148:151], v[28:31], a[36:39]
    ds_read_b64_tr_b16 v[144:145], v229 offset:9376
    v_mfma_f32_16x16x32_bf16 a[40:43], v[148:151], v[32:35], a[40:43]
    ds_read_b64_tr_b16 v[146:147], v229 offset:13984
    v_mfma_f32_16x16x32_bf16 a[44:47], v[148:151], v[36:39], a[44:47]
    s_waitcnt lgkmcnt(4)
    v_mfma_f32_16x16x32_bf16 a[48:51], v[136:139], v[24:27], a[48:51]
    v_mfma_f32_16x16x32_bf16 a[52:55], v[136:139], v[28:31], a[52:55]
    ds_read_b64_tr_b16 v[148:149], v229 offset:9408
    v_mfma_f32_16x16x32_bf16 a[56:59], v[136:139], v[32:35], a[56:59]
    ds_read_b64_tr_b16 v[150:151], v229 offset:14016
    v_mfma_f32_16x16x32_bf16 a[60:63], v[136:139], v[36:39], a[60:63]
    s_waitcnt lgkmcnt(4)
    v_mfma_f32_16x16x32_bf16 a[64:67], v[140:143], v[24:27], a[64:67]
    v_mfma_f32_16x16x32_bf16 a[68:71], v[140:143], v[28:31], a[68:71]
    ds_read_b64_tr_b16 v[136:137], v229 offset:9440
    v_mfma_f32_16x16x32_bf16 a[72:75], v[140:143], v[32:35], a[72:75]
    ds_read_b64_tr_b16 v[138:139], v229 offset:14048
    v_mfma_f32_16x16x32_bf16 a[76:79], v[140:143], v[36:39], a[76:79]
    s_waitcnt lgkmcnt(4)
    v_mfma_f32_16x16x32_bf16 a[80:83], v[144:147], v[24:27], a[80:83]
    v_mfma_f32_16x16x32_bf16 a[84:87], v[144:147], v[28:31], a[84:87]
    ds_read_b64_tr_b16 v[140:141], v229 offset:9472
    v_mfma_f32_16x16x32_bf16 a[88:91], v[144:147], v[32:35], a[88:91]
    ds_read_b64_tr_b16 v[142:143], v229 offset:14080
    v_mfma_f32_16x16x32_bf16 a[92:95], v[144:147], v[36:39], a[92:95]
    s_waitcnt lgkmcnt(4)
    v_mfma_f32_16x16x32_bf16 a[96:99], v[148:151], v[24:27], a[96:99]
    v_mfma_f32_16x16x32_bf16 a[100:103], v[148:151], v[28:31], a[100:103]
    ds_read_b64_tr_b16 v[144:145], v229 offset:18432
    v_mfma_f32_16x16x32_bf16 a[104:107], v[148:151], v[32:35], a[104:107]
    ds_read_b64_tr_b16 v[146:147], v229 offset:23040
    v_mfma_f32_16x16x32_bf16 a[108:111], v[148:151], v[36:39], a[108:111]
    s_waitcnt lgkmcnt(4)
    v_mfma_f32_16x16x32_bf16 a[112:115], v[136:139], v[24:27], a[112:115]
    v_mfma_f32_16x16x32_bf16 a[116:119], v[136:139], v[28:31], a[116:119]
    ds_read_b64_tr_b16 v[148:149], v229 offset:18464
    v_mfma_f32_16x16x32_bf16 a[120:123], v[136:139], v[32:35], a[120:123]
    ds_read_b64_tr_b16 v[150:151], v229 offset:23072
    v_mfma_f32_16x16x32_bf16 a[124:127], v[136:139], v[36:39], a[124:127]
    s_waitcnt lgkmcnt(4)
    v_mfma_f32_16x16x32_bf16 a[128:131], v[140:143], v[24:27], a[128:131]
    v_mfma_f32_16x16x32_bf16 a[132:135], v[140:143], v[28:31], a[132:135]
    ds_read_b64_tr_b16 v[136:137], v229 offset:18496
    v_mfma_f32_16x16x32_bf16 a[136:139], v[140:143], v[32:35], a[136:139]
    ds_read_b64_tr_b16 v[138:139], v229 offset:23104
    v_mfma_f32_16x16x32_bf16 a[140:143], v[140:143], v[36:39], a[140:143]
    s_waitcnt lgkmcnt(4)
    s_waitcnt vmcnt(20)
    v_mfma_f32_16x16x32_bf16 a[0:3], v[144:147], v[40:43], a[0:3]
    v_mfma_f32_16x16x32_bf16 a[4:7], v[144:147], v[44:47], a[4:7]
    ds_read_b64_tr_b16 v[140:141], v229 offset:18528
    v_mfma_f32_16x16x32_bf16 a[8:11], v[144:147], v[48:51], a[8:11]
    ds_read_b64_tr_b16 v[142:143], v229 offset:23136
    v_mfma_f32_16x16x32_bf16 a[12:15], v[144:147], v[52:55], a[12:15]
    s_waitcnt lgkmcnt(4)
    v_mfma_f32_16x16x32_bf16 a[16:19], v[148:151], v[40:43], a[16:19]
    v_mfma_f32_16x16x32_bf16 a[20:23], v[148:151], v[44:47], a[20:23]
    ds_read_b64_tr_b16 v[144:145], v229 offset:18560
    v_mfma_f32_16x16x32_bf16 a[24:27], v[148:151], v[48:51], a[24:27]
    ds_read_b64_tr_b16 v[146:147], v229 offset:23168
    v_mfma_f32_16x16x32_bf16 a[28:31], v[148:151], v[52:55], a[28:31]
    s_waitcnt lgkmcnt(4)
    v_mfma_f32_16x16x32_bf16 a[32:35], v[136:139], v[40:43], a[32:35]
    v_mfma_f32_16x16x32_bf16 a[36:39], v[136:139], v[44:47], a[36:39]
    ds_read_b64_tr_b16 v[148:149], v229 offset:18592
    v_mfma_f32_16x16x32_bf16 a[40:43], v[136:139], v[48:51], a[40:43]
    ds_read_b64_tr_b16 v[150:151], v229 offset:23200
    v_mfma_f32_16x16x32_bf16 a[44:47], v[136:139], v[52:55], a[44:47]
    s_waitcnt lgkmcnt(4)
    v_mfma_f32_16x16x32_bf16 a[48:51], v[140:143], v[40:43], a[48:51]
    v_mfma_f32_16x16x32_bf16 a[52:55], v[140:143], v[44:47], a[52:55]
    ds_read_b64_tr_b16 v[136:137], v229 offset:18624
    v_mfma_f32_16x16x32_bf16 a[56:59], v[140:143], v[48:51], a[56:59]
    ds_read_b64_tr_b16 v[138:139], v229 offset:23232
    v_mfma_f32_16x16x32_bf16 a[60:63], v[140:143], v[52:55], a[60:63]
    s_waitcnt lgkmcnt(4)
    v_mfma_f32_16x16x32_bf16 a[64:67], v[144:147], v[40:43], a[64:67]
    v_mfma_f32_16x16x32_bf16 a[68:71], v[144:147], v[44:47], a[68:71]
    ds_read_b64_tr_b16 v[140:141], v229 offset:18656
    v_mfma_f32_16x16x32_bf16 a[72:75], v[144:147], v[48:51], a[72:75]
    ds_read_b64_tr_b16 v[142:143], v229 offset:23264
    v_mfma_f32_16x16x32_bf16 a[76:79], v[144:147], v[52:55], a[76:79]
    s_waitcnt lgkmcnt(4)
    v_mfma_f32_16x16x32_bf16 a[80:83], v[148:151], v[40:43], a[80:83]
    v_mfma_f32_16x16x32_bf16 a[84:87], v[148:151], v[44:47], a[84:87]
    ds_read_b64_tr_b16 v[144:145], v229 offset:18688
    v_mfma_f32_16x16x32_bf16 a[88:91], v[148:151], v[48:51], a[88:91]
    ds_read_b64_tr_b16 v[146:147], v229 offset:23296
    v_mfma_f32_16x16x32_bf16 a[92:95], v[148:151], v[52:55], a[92:95]
    s_waitcnt lgkmcnt(4)
    v_mfma_f32_16x16x32_bf16 a[96:99], v[136:139], v[40:43], a[96:99]
    v_mfma_f32_16x16x32_bf16 a[100:103], v[136:139], v[44:47], a[100:103]
    ds_read_b64_tr_b16 v[148:149], v229 offset:27648
    v_mfma_f32_16x16x32_bf16 a[104:107], v[136:139], v[48:51], a[104:107]
    ds_read_b64_tr_b16 v[150:151], v229 offset:32256
    v_mfma_f32_16x16x32_bf16 a[108:111], v[136:139], v[52:55], a[108:111]
    s_waitcnt lgkmcnt(4)
    v_mfma_f32_16x16x32_bf16 a[112:115], v[140:143], v[40:43], a[112:115]
    v_mfma_f32_16x16x32_bf16 a[116:119], v[140:143], v[44:47], a[116:119]
    ds_read_b64_tr_b16 v[136:137], v229 offset:27680
    v_mfma_f32_16x16x32_bf16 a[120:123], v[140:143], v[48:51], a[120:123]
    ds_read_b64_tr_b16 v[138:139], v229 offset:32288
    v_mfma_f32_16x16x32_bf16 a[124:127], v[140:143], v[52:55], a[124:127]
    s_waitcnt lgkmcnt(4)
    v_mfma_f32_16x16x32_bf16 a[128:131], v[144:147], v[40:43], a[128:131]
    v_mfma_f32_16x16x32_bf16 a[132:135], v[144:147], v[44:47], a[132:135]
    ds_read_b64_tr_b16 v[140:141], v229 offset:27712
    v_mfma_f32_16x16x32_bf16 a[136:139], v[144:147], v[48:51], a[136:139]
    ds_read_b64_tr_b16 v[142:143], v229 offset:32320
    v_mfma_f32_16x16x32_bf16 a[140:143], v[144:147], v[52:55], a[140:143]
    s_waitcnt lgkmcnt(4)
    s_waitcnt vmcnt(16)
    v_mfma_f32_16x16x32_bf16 a[0:3], v[148:151], v[56:59], a[0:3]
    v_mfma_f32_16x16x32_bf16 a[4:7], v[148:151], v[60:63], a[4:7]
    ds_read_b64_tr_b16 v[144:145], v229 offset:27744
    v_mfma_f32_16x16x32_bf16 a[8:11], v[148:151], v[64:67], a[8:11]
    ds_read_b64_tr_b16 v[146:147], v229 offset:32352
    v_mfma_f32_16x16x32_bf16 a[12:15], v[148:151], v[68:71], a[12:15]
    s_waitcnt lgkmcnt(4)
    v_mfma_f32_16x16x32_bf16 a[16:19], v[136:139], v[56:59], a[16:19]
    v_mfma_f32_16x16x32_bf16 a[20:23], v[136:139], v[60:63], a[20:23]
    ds_read_b64_tr_b16 v[148:149], v229 offset:27776
    v_mfma_f32_16x16x32_bf16 a[24:27], v[136:139], v[64:67], a[24:27]
    ds_read_b64_tr_b16 v[150:151], v229 offset:32384
    v_mfma_f32_16x16x32_bf16 a[28:31], v[136:139], v[68:71], a[28:31]
    s_waitcnt lgkmcnt(4)
    v_mfma_f32_16x16x32_bf16 a[32:35], v[140:143], v[56:59], a[32:35]
    v_mfma_f32_16x16x32_bf16 a[36:39], v[140:143], v[60:63], a[36:39]
    ds_read_b64_tr_b16 v[136:137], v229 offset:27808
    v_mfma_f32_16x16x32_bf16 a[40:43], v[140:143], v[64:67], a[40:43]
    ds_read_b64_tr_b16 v[138:139], v229 offset:32416
    v_mfma_f32_16x16x32_bf16 a[44:47], v[140:143], v[68:71], a[44:47]
    s_waitcnt lgkmcnt(4)
    v_mfma_f32_16x16x32_bf16 a[48:51], v[144:147], v[56:59], a[48:51]
    v_mfma_f32_16x16x32_bf16 a[52:55], v[144:147], v[60:63], a[52:55]
    ds_read_b64_tr_b16 v[140:141], v229 offset:27840
    v_mfma_f32_16x16x32_bf16 a[56:59], v[144:147], v[64:67], a[56:59]
    ds_read_b64_tr_b16 v[142:143], v229 offset:32448
    v_mfma_f32_16x16x32_bf16 a[60:63], v[144:147], v[68:71], a[60:63]
    s_waitcnt lgkmcnt(4)
    v_mfma_f32_16x16x32_bf16 a[64:67], v[148:151], v[56:59], a[64:67]
    v_mfma_f32_16x16x32_bf16 a[68:71], v[148:151], v[60:63], a[68:71]
    ds_read_b64_tr_b16 v[144:145], v229 offset:27872
    v_mfma_f32_16x16x32_bf16 a[72:75], v[148:151], v[64:67], a[72:75]
    ds_read_b64_tr_b16 v[146:147], v229 offset:32480
    v_mfma_f32_16x16x32_bf16 a[76:79], v[148:151], v[68:71], a[76:79]
    s_waitcnt lgkmcnt(4)
    v_mfma_f32_16x16x32_bf16 a[80:83], v[136:139], v[56:59], a[80:83]
    v_mfma_f32_16x16x32_bf16 a[84:87], v[136:139], v[60:63], a[84:87]
    ds_read_b64_tr_b16 v[148:149], v229 offset:27904
    v_mfma_f32_16x16x32_bf16 a[88:91], v[136:139], v[64:67], a[88:91]
    ds_read_b64_tr_b16 v[150:151], v229 offset:32512
    v_mfma_f32_16x16x32_bf16 a[92:95], v[136:139], v[68:71], a[92:95]
    s_waitcnt lgkmcnt(4)
    v_mfma_f32_16x16x32_bf16 a[96:99], v[140:143], v[56:59], a[96:99]
    s_waitcnt lgkmcnt(0)
    s_barrier
    v_add_u32 v229, 110592, v228
    v_mfma_f32_16x16x32_bf16 a[100:103], v[140:143], v[60:63], a[100:103]
    ds_read_b64_tr_b16 v[136:137], v229 offset:0
    v_mfma_f32_16x16x32_bf16 a[104:107], v[140:143], v[64:67], a[104:107]
    ds_read_b64_tr_b16 v[138:139], v229 offset:4608
    v_mfma_f32_16x16x32_bf16 a[108:111], v[140:143], v[68:71], a[108:111]
    v_mfma_f32_16x16x32_bf16 a[112:115], v[144:147], v[56:59], a[112:115]
    v_mfma_f32_16x16x32_bf16 a[116:119], v[144:147], v[60:63], a[116:119]
    ds_read_b64_tr_b16 v[140:141], v229 offset:32
    v_mfma_f32_16x16x32_bf16 a[120:123], v[144:147], v[64:67], a[120:123]
    ds_read_b64_tr_b16 v[142:143], v229 offset:4640
    v_mfma_f32_16x16x32_bf16 a[124:127], v[144:147], v[68:71], a[124:127]
    v_mfma_f32_16x16x32_bf16 a[128:131], v[148:151], v[56:59], a[128:131]
    v_mfma_f32_16x16x32_bf16 a[132:135], v[148:151], v[60:63], a[132:135]
    ds_read_b64_tr_b16 v[144:145], v229 offset:64
    v_mfma_f32_16x16x32_bf16 a[136:139], v[148:151], v[64:67], a[136:139]
    ds_read_b64_tr_b16 v[146:147], v229 offset:4672
    v_mfma_f32_16x16x32_bf16 a[140:143], v[148:151], v[68:71], a[140:143]
    s_waitcnt lgkmcnt(4)
    s_waitcnt vmcnt(12)
    v_mfma_f32_16x16x32_bf16 a[0:3], v[136:139], v[72:75], a[0:3]
    v_mfma_f32_16x16x32_bf16 a[4:7], v[136:139], v[76:79], a[4:7]
    ds_read_b64_tr_b16 v[148:149], v229 offset:96
    v_mfma_f32_16x16x32_bf16 a[8:11], v[136:139], v[80:83], a[8:11]
    ds_read_b64_tr_b16 v[150:151], v229 offset:4704
    v_mfma_f32_16x16x32_bf16 a[12:15], v[136:139], v[84:87], a[12:15]
    s_waitcnt lgkmcnt(4)
    v_mfma_f32_16x16x32_bf16 a[16:19], v[140:143], v[72:75], a[16:19]
    v_mfma_f32_16x16x32_bf16 a[20:23], v[140:143], v[76:79], a[20:23]
    ds_read_b64_tr_b16 v[136:137], v229 offset:128
    v_mfma_f32_16x16x32_bf16 a[24:27], v[140:143], v[80:83], a[24:27]
    ds_read_b64_tr_b16 v[138:139], v229 offset:4736
    v_mfma_f32_16x16x32_bf16 a[28:31], v[140:143], v[84:87], a[28:31]
    s_waitcnt lgkmcnt(4)
    v_mfma_f32_16x16x32_bf16 a[32:35], v[144:147], v[72:75], a[32:35]
    v_mfma_f32_16x16x32_bf16 a[36:39], v[144:147], v[76:79], a[36:39]
    ds_read_b64_tr_b16 v[140:141], v229 offset:160
    v_mfma_f32_16x16x32_bf16 a[40:43], v[144:147], v[80:83], a[40:43]
    ds_read_b64_tr_b16 v[142:143], v229 offset:4768
    v_mfma_f32_16x16x32_bf16 a[44:47], v[144:147], v[84:87], a[44:47]
    s_waitcnt lgkmcnt(4)
    v_mfma_f32_16x16x32_bf16 a[48:51], v[148:151], v[72:75], a[48:51]
    v_mfma_f32_16x16x32_bf16 a[52:55], v[148:151], v[76:79], a[52:55]
    ds_read_b64_tr_b16 v[144:145], v229 offset:192
    v_mfma_f32_16x16x32_bf16 a[56:59], v[148:151], v[80:83], a[56:59]
    ds_read_b64_tr_b16 v[146:147], v229 offset:4800
    v_mfma_f32_16x16x32_bf16 a[60:63], v[148:151], v[84:87], a[60:63]
    s_waitcnt lgkmcnt(4)
    v_mfma_f32_16x16x32_bf16 a[64:67], v[136:139], v[72:75], a[64:67]
    v_mfma_f32_16x16x32_bf16 a[68:71], v[136:139], v[76:79], a[68:71]
    ds_read_b64_tr_b16 v[148:149], v229 offset:224
    v_mfma_f32_16x16x32_bf16 a[72:75], v[136:139], v[80:83], a[72:75]
    ds_read_b64_tr_b16 v[150:151], v229 offset:4832
    v_mfma_f32_16x16x32_bf16 a[76:79], v[136:139], v[84:87], a[76:79]
    s_waitcnt lgkmcnt(4)
    v_mfma_f32_16x16x32_bf16 a[80:83], v[140:143], v[72:75], a[80:83]
    v_mfma_f32_16x16x32_bf16 a[84:87], v[140:143], v[76:79], a[84:87]
    ds_read_b64_tr_b16 v[136:137], v229 offset:256
    v_mfma_f32_16x16x32_bf16 a[88:91], v[140:143], v[80:83], a[88:91]
    ds_read_b64_tr_b16 v[138:139], v229 offset:4864
    v_mfma_f32_16x16x32_bf16 a[92:95], v[140:143], v[84:87], a[92:95]
    s_waitcnt lgkmcnt(4)
    v_mfma_f32_16x16x32_bf16 a[96:99], v[144:147], v[72:75], a[96:99]
    v_mfma_f32_16x16x32_bf16 a[100:103], v[144:147], v[76:79], a[100:103]
    ds_read_b64_tr_b16 v[140:141], v229 offset:9216
    v_mfma_f32_16x16x32_bf16 a[104:107], v[144:147], v[80:83], a[104:107]
    ds_read_b64_tr_b16 v[142:143], v229 offset:13824
    v_mfma_f32_16x16x32_bf16 a[108:111], v[144:147], v[84:87], a[108:111]
    s_waitcnt lgkmcnt(4)
    v_mfma_f32_16x16x32_bf16 a[112:115], v[148:151], v[72:75], a[112:115]
    v_mfma_f32_16x16x32_bf16 a[116:119], v[148:151], v[76:79], a[116:119]
    ds_read_b64_tr_b16 v[144:145], v229 offset:9248
    v_mfma_f32_16x16x32_bf16 a[120:123], v[148:151], v[80:83], a[120:123]
    ds_read_b64_tr_b16 v[146:147], v229 offset:13856
    v_mfma_f32_16x16x32_bf16 a[124:127], v[148:151], v[84:87], a[124:127]
    s_waitcnt lgkmcnt(4)
    v_mfma_f32_16x16x32_bf16 a[128:131], v[136:139], v[72:75], a[128:131]
    v_mfma_f32_16x16x32_bf16 a[132:135], v[136:139], v[76:79], a[132:135]
    ds_read_b64_tr_b16 v[148:149], v229 offset:9280
    v_mfma_f32_16x16x32_bf16 a[136:139], v[136:139], v[80:83], a[136:139]
    ds_read_b64_tr_b16 v[150:151], v229 offset:13888
    v_mfma_f32_16x16x32_bf16 a[140:143], v[136:139], v[84:87], a[140:143]
    s_waitcnt lgkmcnt(4)
    s_waitcnt vmcnt(8)
    v_mfma_f32_16x16x32_bf16 a[0:3], v[140:143], v[88:91], a[0:3]
    v_mfma_f32_16x16x32_bf16 a[4:7], v[140:143], v[92:95], a[4:7]
    ds_read_b64_tr_b16 v[136:137], v229 offset:9312
    v_mfma_f32_16x16x32_bf16 a[8:11], v[140:143], v[96:99], a[8:11]
    ds_read_b64_tr_b16 v[138:139], v229 offset:13920
    v_mfma_f32_16x16x32_bf16 a[12:15], v[140:143], v[100:103], a[12:15]
    s_waitcnt lgkmcnt(4)
    v_mfma_f32_16x16x32_bf16 a[16:19], v[144:147], v[88:91], a[16:19]
    v_mfma_f32_16x16x32_bf16 a[20:23], v[144:147], v[92:95], a[20:23]
    ds_read_b64_tr_b16 v[140:141], v229 offset:9344
    v_mfma_f32_16x16x32_bf16 a[24:27], v[144:147], v[96:99], a[24:27]
    ds_read_b64_tr_b16 v[142:143], v229 offset:13952
    v_mfma_f32_16x16x32_bf16 a[28:31], v[144:147], v[100:103], a[28:31]
    s_waitcnt lgkmcnt(4)
    v_mfma_f32_16x16x32_bf16 a[32:35], v[148:151], v[88:91], a[32:35]
    v_mfma_f32_16x16x32_bf16 a[36:39], v[148:151], v[92:95], a[36:39]
    ds_read_b64_tr_b16 v[144:145], v229 offset:9376
    v_mfma_f32_16x16x32_bf16 a[40:43], v[148:151], v[96:99], a[40:43]
    ds_read_b64_tr_b16 v[146:147], v229 offset:13984
    v_mfma_f32_16x16x32_bf16 a[44:47], v[148:151], v[100:103], a[44:47]
    s_waitcnt lgkmcnt(4)
    v_mfma_f32_16x16x32_bf16 a[48:51], v[136:139], v[88:91], a[48:51]
    v_mfma_f32_16x16x32_bf16 a[52:55], v[136:139], v[92:95], a[52:55]
    ds_read_b64_tr_b16 v[148:149], v229 offset:9408
    v_mfma_f32_16x16x32_bf16 a[56:59], v[136:139], v[96:99], a[56:59]
    ds_read_b64_tr_b16 v[150:151], v229 offset:14016
    v_mfma_f32_16x16x32_bf16 a[60:63], v[136:139], v[100:103], a[60:63]
    s_waitcnt lgkmcnt(4)
    v_mfma_f32_16x16x32_bf16 a[64:67], v[140:143], v[88:91], a[64:67]
    v_mfma_f32_16x16x32_bf16 a[68:71], v[140:143], v[92:95], a[68:71]
    ds_read_b64_tr_b16 v[136:137], v229 offset:9440
    v_mfma_f32_16x16x32_bf16 a[72:75], v[140:143], v[96:99], a[72:75]
    ds_read_b64_tr_b16 v[138:139], v229 offset:14048
    v_mfma_f32_16x16x32_bf16 a[76:79], v[140:143], v[100:103], a[76:79]
    s_waitcnt lgkmcnt(4)
    v_mfma_f32_16x16x32_bf16 a[80:83], v[144:147], v[88:91], a[80:83]
    v_mfma_f32_16x16x32_bf16 a[84:87], v[144:147], v[92:95], a[84:87]
    ds_read_b64_tr_b16 v[140:141], v229 offset:9472
    v_mfma_f32_16x16x32_bf16 a[88:91], v[144:147], v[96:99], a[88:91]
    ds_read_b64_tr_b16 v[142:143], v229 offset:14080
    v_mfma_f32_16x16x32_bf16 a[92:95], v[144:147], v[100:103], a[92:95]
    s_waitcnt lgkmcnt(4)
    v_mfma_f32_16x16x32_bf16 a[96:99], v[148:151], v[88:91], a[96:99]
    v_mfma_f32_16x16x32_bf16 a[100:103], v[148:151], v[92:95], a[100:103]
    ds_read_b64_tr_b16 v[144:145], v229 offset:18432
    v_mfma_f32_16x16x32_bf16 a[104:107], v[148:151], v[96:99], a[104:107]
    ds_read_b64_tr_b16 v[146:147], v229 offset:23040
    v_mfma_f32_16x16x32_bf16 a[108:111], v[148:151], v[100:103], a[108:111]
    s_waitcnt lgkmcnt(4)
    v_mfma_f32_16x16x32_bf16 a[112:115], v[136:139], v[88:91], a[112:115]
    v_mfma_f32_16x16x32_bf16 a[116:119], v[136:139], v[92:95], a[116:119]
    ds_read_b64_tr_b16 v[148:149], v229 offset:18464
    v_mfma_f32_16x16x32_bf16 a[120:123], v[136:139], v[96:99], a[120:123]
    ds_read_b64_tr_b16 v[150:151], v229 offset:23072
    v_mfma_f32_16x16x32_bf16 a[124:127], v[136:139], v[100:103], a[124:127]
    s_waitcnt lgkmcnt(4)
    v_mfma_f32_16x16x32_bf16 a[128:131], v[140:143], v[88:91], a[128:131]
    v_mfma_f32_16x16x32_bf16 a[132:135], v[140:143], v[92:95], a[132:135]
    ds_read_b64_tr_b16 v[136:137], v229 offset:18496
    v_mfma_f32_16x16x32_bf16 a[136:139], v[140:143], v[96:99], a[136:139]
    ds_read_b64_tr_b16 v[138:139], v229 offset:23104
    v_mfma_f32_16x16x32_bf16 a[140:143], v[140:143], v[100:103], a[140:143]
    s_waitcnt lgkmcnt(4)
    s_waitcnt vmcnt(4)
    v_mfma_f32_16x16x32_bf16 a[0:3], v[144:147], v[104:107], a[0:3]
    v_mfma_f32_16x16x32_bf16 a[4:7], v[144:147], v[108:111], a[4:7]
    ds_read_b64_tr_b16 v[140:141], v229 offset:18528
    v_mfma_f32_16x16x32_bf16 a[8:11], v[144:147], v[112:115], a[8:11]
    ds_read_b64_tr_b16 v[142:143], v229 offset:23136
    v_mfma_f32_16x16x32_bf16 a[12:15], v[144:147], v[116:119], a[12:15]
    s_waitcnt lgkmcnt(4)
    v_mfma_f32_16x16x32_bf16 a[16:19], v[148:151], v[104:107], a[16:19]
    v_mfma_f32_16x16x32_bf16 a[20:23], v[148:151], v[108:111], a[20:23]
    ds_read_b64_tr_b16 v[144:145], v229 offset:18560
    v_mfma_f32_16x16x32_bf16 a[24:27], v[148:151], v[112:115], a[24:27]
    ds_read_b64_tr_b16 v[146:147], v229 offset:23168
    v_mfma_f32_16x16x32_bf16 a[28:31], v[148:151], v[116:119], a[28:31]
    s_waitcnt lgkmcnt(4)
    v_mfma_f32_16x16x32_bf16 a[32:35], v[136:139], v[104:107], a[32:35]
    v_mfma_f32_16x16x32_bf16 a[36:39], v[136:139], v[108:111], a[36:39]
    ds_read_b64_tr_b16 v[148:149], v229 offset:18592
    v_mfma_f32_16x16x32_bf16 a[40:43], v[136:139], v[112:115], a[40:43]
    ds_read_b64_tr_b16 v[150:151], v229 offset:23200
    v_mfma_f32_16x16x32_bf16 a[44:47], v[136:139], v[116:119], a[44:47]
    s_waitcnt lgkmcnt(4)
    v_mfma_f32_16x16x32_bf16 a[48:51], v[140:143], v[104:107], a[48:51]
    v_mfma_f32_16x16x32_bf16 a[52:55], v[140:143], v[108:111], a[52:55]
    ds_read_b64_tr_b16 v[136:137], v229 offset:18624
    v_mfma_f32_16x16x32_bf16 a[56:59], v[140:143], v[112:115], a[56:59]
    ds_read_b64_tr_b16 v[138:139], v229 offset:23232
    v_mfma_f32_16x16x32_bf16 a[60:63], v[140:143], v[116:119], a[60:63]
    s_waitcnt lgkmcnt(4)
    v_mfma_f32_16x16x32_bf16 a[64:67], v[144:147], v[104:107], a[64:67]
    v_mfma_f32_16x16x32_bf16 a[68:71], v[144:147], v[108:111], a[68:71]
    ds_read_b64_tr_b16 v[140:141], v229 offset:18656
    v_mfma_f32_16x16x32_bf16 a[72:75], v[144:147], v[112:115], a[72:75]
    ds_read_b64_tr_b16 v[142:143], v229 offset:23264
    v_mfma_f32_16x16x32_bf16 a[76:79], v[144:147], v[116:119], a[76:79]
    s_waitcnt lgkmcnt(4)
    v_mfma_f32_16x16x32_bf16 a[80:83], v[148:151], v[104:107], a[80:83]
    v_mfma_f32_16x16x32_bf16 a[84:87], v[148:151], v[108:111], a[84:87]
    ds_read_b64_tr_b16 v[144:145], v229 offset:18688
    v_mfma_f32_16x16x32_bf16 a[88:91], v[148:151], v[112:115], a[88:91]
    ds_read_b64_tr_b16 v[146:147], v229 offset:23296
    v_mfma_f32_16x16x32_bf16 a[92:95], v[148:151], v[116:119], a[92:95]
    s_waitcnt lgkmcnt(4)
    v_mfma_f32_16x16x32_bf16 a[96:99], v[136:139], v[104:107], a[96:99]
    v_mfma_f32_16x16x32_bf16 a[100:103], v[136:139], v[108:111], a[100:103]
    ds_read_b64_tr_b16 v[148:149], v229 offset:27648
    v_mfma_f32_16x16x32_bf16 a[104:107], v[136:139], v[112:115], a[104:107]
    ds_read_b64_tr_b16 v[150:151], v229 offset:32256
    v_mfma_f32_16x16x32_bf16 a[108:111], v[136:139], v[116:119], a[108:111]
    s_waitcnt lgkmcnt(4)
    v_mfma_f32_16x16x32_bf16 a[112:115], v[140:143], v[104:107], a[112:115]
    v_mfma_f32_16x16x32_bf16 a[116:119], v[140:143], v[108:111], a[116:119]
    ds_read_b64_tr_b16 v[136:137], v229 offset:27680
    v_mfma_f32_16x16x32_bf16 a[120:123], v[140:143], v[112:115], a[120:123]
    ds_read_b64_tr_b16 v[138:139], v229 offset:32288
    v_mfma_f32_16x16x32_bf16 a[124:127], v[140:143], v[116:119], a[124:127]
    s_waitcnt lgkmcnt(4)
    v_mfma_f32_16x16x32_bf16 a[128:131], v[144:147], v[104:107], a[128:131]
    v_mfma_f32_16x16x32_bf16 a[132:135], v[144:147], v[108:111], a[132:135]
    ds_read_b64_tr_b16 v[140:141], v229 offset:27712
    v_mfma_f32_16x16x32_bf16 a[136:139], v[144:147], v[112:115], a[136:139]
    ds_read_b64_tr_b16 v[142:143], v229 offset:32320
    v_mfma_f32_16x16x32_bf16 a[140:143], v[144:147], v[116:119], a[140:143]
    s_waitcnt lgkmcnt(4)
    s_waitcnt vmcnt(0)
    v_mfma_f32_16x16x32_bf16 a[0:3], v[148:151], v[120:123], a[0:3]
    v_mfma_f32_16x16x32_bf16 a[4:7], v[148:151], v[124:127], a[4:7]
    ds_read_b64_tr_b16 v[144:145], v229 offset:27744
    v_mfma_f32_16x16x32_bf16 a[8:11], v[148:151], v[128:131], a[8:11]
    ds_read_b64_tr_b16 v[146:147], v229 offset:32352
    v_mfma_f32_16x16x32_bf16 a[12:15], v[148:151], v[132:135], a[12:15]
    s_waitcnt lgkmcnt(4)
    v_mfma_f32_16x16x32_bf16 a[16:19], v[136:139], v[120:123], a[16:19]
    v_mfma_f32_16x16x32_bf16 a[20:23], v[136:139], v[124:127], a[20:23]
    ds_read_b64_tr_b16 v[148:149], v229 offset:27776
    v_mfma_f32_16x16x32_bf16 a[24:27], v[136:139], v[128:131], a[24:27]
    ds_read_b64_tr_b16 v[150:151], v229 offset:32384
    v_mfma_f32_16x16x32_bf16 a[28:31], v[136:139], v[132:135], a[28:31]
    s_waitcnt lgkmcnt(4)
    v_mfma_f32_16x16x32_bf16 a[32:35], v[140:143], v[120:123], a[32:35]
    v_mfma_f32_16x16x32_bf16 a[36:39], v[140:143], v[124:127], a[36:39]
    ds_read_b64_tr_b16 v[136:137], v229 offset:27808
    v_mfma_f32_16x16x32_bf16 a[40:43], v[140:143], v[128:131], a[40:43]
    ds_read_b64_tr_b16 v[138:139], v229 offset:32416
    v_mfma_f32_16x16x32_bf16 a[44:47], v[140:143], v[132:135], a[44:47]
    s_waitcnt lgkmcnt(4)
    v_mfma_f32_16x16x32_bf16 a[48:51], v[144:147], v[120:123], a[48:51]
    v_mfma_f32_16x16x32_bf16 a[52:55], v[144:147], v[124:127], a[52:55]
    ds_read_b64_tr_b16 v[140:141], v229 offset:27840
    v_mfma_f32_16x16x32_bf16 a[56:59], v[144:147], v[128:131], a[56:59]
    ds_read_b64_tr_b16 v[142:143], v229 offset:32448
    v_mfma_f32_16x16x32_bf16 a[60:63], v[144:147], v[132:135], a[60:63]
    s_waitcnt lgkmcnt(4)
    v_mfma_f32_16x16x32_bf16 a[64:67], v[148:151], v[120:123], a[64:67]
    v_mfma_f32_16x16x32_bf16 a[68:71], v[148:151], v[124:127], a[68:71]
    ds_read_b64_tr_b16 v[144:145], v229 offset:27872
    v_mfma_f32_16x16x32_bf16 a[72:75], v[148:151], v[128:131], a[72:75]
    ds_read_b64_tr_b16 v[146:147], v229 offset:32480
    v_mfma_f32_16x16x32_bf16 a[76:79], v[148:151], v[132:135], a[76:79]
    s_waitcnt lgkmcnt(4)
    v_mfma_f32_16x16x32_bf16 a[80:83], v[136:139], v[120:123], a[80:83]
    v_mfma_f32_16x16x32_bf16 a[84:87], v[136:139], v[124:127], a[84:87]
    ds_read_b64_tr_b16 v[148:149], v229 offset:27904
    v_mfma_f32_16x16x32_bf16 a[88:91], v[136:139], v[128:131], a[88:91]
    ds_read_b64_tr_b16 v[150:151], v229 offset:32512
    v_mfma_f32_16x16x32_bf16 a[92:95], v[136:139], v[132:135], a[92:95]
    s_waitcnt lgkmcnt(4)
    v_mfma_f32_16x16x32_bf16 a[96:99], v[140:143], v[120:123], a[96:99]
    v_mfma_f32_16x16x32_bf16 a[100:103], v[140:143], v[124:127], a[100:103]
    v_mfma_f32_16x16x32_bf16 a[104:107], v[140:143], v[128:131], a[104:107]
    v_mfma_f32_16x16x32_bf16 a[108:111], v[140:143], v[132:135], a[108:111]
    s_waitcnt lgkmcnt(2)
    v_mfma_f32_16x16x32_bf16 a[112:115], v[144:147], v[120:123], a[112:115]
    v_mfma_f32_16x16x32_bf16 a[116:119], v[144:147], v[124:127], a[116:119]
    v_mfma_f32_16x16x32_bf16 a[120:123], v[144:147], v[128:131], a[120:123]
    v_mfma_f32_16x16x32_bf16 a[124:127], v[144:147], v[132:135], a[124:127]
    s_waitcnt lgkmcnt(0)
    v_mfma_f32_16x16x32_bf16 a[128:131], v[148:151], v[120:123], a[128:131]
    v_mfma_f32_16x16x32_bf16 a[132:135], v[148:151], v[124:127], a[132:135]
    v_mfma_f32_16x16x32_bf16 a[136:139], v[148:151], v[128:131], a[136:139]
    v_mfma_f32_16x16x32_bf16 a[140:143], v[148:151], v[132:135], a[140:143]
    s_nop 7
mk_join:
    s_waitcnt vmcnt(20) lgkmcnt(0)
    v_accvgpr_read_b32 v152, a0
    v_accvgpr_read_b32 v153, a1
    v_accvgpr_read_b32 v154, a2
    v_accvgpr_read_b32 v155, a3
    v_accvgpr_read_b32 v156, a16
    v_accvgpr_read_b32 v157, a17
    v_accvgpr_read_b32 v158, a18
    v_accvgpr_read_b32 v159, a19
    v_cvt_pk_bf16_f32 v152, v152, v153
    v_cvt_pk_bf16_f32 v153, v154, v155
    v_cvt_pk_bf16_f32 v154, v156, v157
    v_cvt_pk_bf16_f32 v155, v158, v159
    s_add_u32 s101, s71, 0
    buffer_store_dwordx4 v[152:155], v3, s[16:19], s101 offen offset:0 sc1
    v_accvgpr_read_b32 v160, a32
    v_accvgpr_read_b32 v161, a33
    v_accvgpr_read_b32 v162, a34
    v_accvgpr_read_b32 v163, a35
    v_accvgpr_read_b32 v164, a48
    v_accvgpr_read_b32 v165, a49
    v_accvgpr_read_b32 v166, a50
    v_accvgpr_read_b32 v167, a51
    v_cvt_pk_bf16_f32 v160, v160, v161
    v_cvt_pk_bf16_f32 v161, v162, v163
    v_cvt_pk_bf16_f32 v162, v164, v165
    v_cvt_pk_bf16_f32 v163, v166, v167
    s_add_u32 s101, s71, 0
    buffer_store_dwordx4 v[160:163], v3, s[16:19], s101 offen offset:1024 sc1
    v_accvgpr_read_b32 v168, a64
    v_accvgpr_read_b32 v169, a65
    v_accvgpr_read_b32 v170, a66
    v_accvgpr_read_b32 v171, a67
    v_accvgpr_read_b32 v172, a80
    v_accvgpr_read_b32 v173, a81
    v_accvgpr_read_b32 v174, a82
    v_accvgpr_read_b32 v175, a83
    v_cvt_pk_bf16_f32 v168, v168, v169
    v_cvt_pk_bf16_f32 v169, v170, v171
    v_cvt_pk_bf16_f32 v170, v172, v173
    v_cvt_pk_bf16_f32 v171, v174, v175
    s_add_u32 s101, s71, 0
    buffer_store_dwordx4 v[168:171], v3, s[16:19], s101 offen offset:2048 sc1
    v_accvgpr_read_b32 v176, a96
    v_accvgpr_read_b32 v177, a97
    v_accvgpr_read_b32 v178, a98
    v_accvgpr_read_b32 v179, a99
    v_accvgpr_read_b32 v180, a112
    v_accvgpr_read_b32 v181, a113
    v_accvgpr_read_b32 v182, a114
    v_accvgpr_read_b32 v183, a115
    v_cvt_pk_bf16_f32 v176, v176, v177
    v_cvt_pk_bf16_f32 v177, v178, v179
    v_cvt_pk_bf16_f32 v178, v180, v181
    v_cvt_pk_bf16_f32 v179, v182, v183
    s_add_u32 s101, s71, 0
    buffer_store_dwordx4 v[176:179], v3, s[16:19], s101 offen offset:3072 sc1
    v_accvgpr_read_b32 v184, a128
    v_accvgpr_read_b32 v185, a129
    v_accvgpr_read_b32 v186, a130
    v_accvgpr_read_b32 v187, a131
    v_cvt_pk_bf16_f32 v184, v184, v185
    v_cvt_pk_bf16_f32 v185, v186, v187
    s_add_u32 s101, s72, 0
    buffer_store_dwordx2 v[184:185], v4, s[16:19], s101 offen sc1
    v_accvgpr_read_b32 v192, a4
    v_accvgpr_read_b32 v193, a5
    v_accvgpr_read_b32 v194, a6
    v_accvgpr_read_b32 v195, a7
    v_accvgpr_read_b32 v196, a20
    v_accvgpr_read_b32 v197, a21
    v_accvgpr_read_b32 v198, a22
    v_accvgpr_read_b32 v199, a23
    v_cvt_pk_bf16_f32 v192, v192, v193
    v_cvt_pk_bf16_f32 v193, v194, v195
    v_cvt_pk_bf16_f32 v194, v196, v197
    v_cvt_pk_bf16_f32 v195, v198, v199
    s_add_u32 s101, s71, 147456
    buffer_store_dwordx4 v[192:195], v3, s[16:19], s101 offen offset:0 sc1
    v_accvgpr_read_b32 v200, a36
    v_accvgpr_read_b32 v201, a37
    v_accvgpr_read_b32 v202, a38
    v_accvgpr_read_b32 v203, a39
    v_accvgpr_read_b32 v204, a52
    v_accvgpr_read_b32 v205, a53
    v_accvgpr_read_b32 v206, a54
    v_accvgpr_read_b32 v207, a55
    v_cvt_pk_bf16_f32 v200, v200, v201
    v_cvt_pk_bf16_f32 v201, v202, v203
    v_cvt_pk_bf16_f32 v202, v204, v205
    v_cvt_pk_bf16_f32 v203, v206, v207
    s_add_u32 s101, s71, 147456
    buffer_store_dwordx4 v[200:203], v3, s[16:19], s101 offen offset:1024 sc1
    v_accvgpr_read_b32 v208, a68
    v_accvgpr_read_b32 v209, a69
    v_accvgpr_read_b32 v210, a70
    v_accvgpr_read_b32 v211, a71
    v_accvgpr_read_b32 v212, a84
    v_accvgpr_read_b32 v213, a85
    v_accvgpr_read_b32 v214, a86
    v_accvgpr_read_b32 v215, a87
    v_cvt_pk_bf16_f32 v208, v208, v209
    v_cvt_pk_bf16_f32 v209, v210, v211
    v_cvt_pk_bf16_f32 v210, v212, v213
    v_cvt_pk_bf16_f32 v211, v214, v215
    s_add_u32 s101, s71, 147456
    buffer_store_dwordx4 v[208:211], v3, s[16:19], s101 offen offset:2048 sc1
    v_accvgpr_read_b32 v152, a100
    v_accvgpr_read_b32 v153, a101
    v_accvgpr_read_b32 v154, a102
    v_accvgpr_read_b32 v155, a103
    v_accvgpr_read_b32 v156, a116
    v_accvgpr_read_b32 v157, a117
    v_accvgpr_read_b32 v158, a118
    v_accvgpr_read_b32 v159, a119
    v_cvt_pk_bf16_f32 v152, v152, v153
    v_cvt_pk_bf16_f32 v153, v154, v155
    v_cvt_pk_bf16_f32 v154, v156, v157
    v_cvt_pk_bf16_f32 v155, v158, v159
    s_add_u32 s101, s71, 147456
    buffer_store_dwordx4 v[152:155], v3, s[16:19], s101 offen offset:3072 sc1
    v_accvgpr_read_b32 v160, a132
    v_accvgpr_read_b32 v161, a133
    v_accvgpr_read_b32 v162, a134
    v_accvgpr_read_b32 v163, a135
    v_cvt_pk_bf16_f32 v160, v160, v161
    v_cvt_pk_bf16_f32 v161, v162, v163
    s_add_u32 s101, s72, 147456
    buffer_store_dwordx2 v[160:161], v4, s[16:19], s101 offen sc1
    v_accvgpr_read_b32 v168, a8
    v_accvgpr_read_b32 v169, a9
    v_accvgpr_read_b32 v170, a10
    v_accvgpr_read_b32 v171, a11
    v_accvgpr_read_b32 v172, a24
    v_accvgpr_read_b32 v173, a25
    v_accvgpr_read_b32 v174, a26
    v_accvgpr_read_b32 v175, a27
    v_cvt_pk_bf16_f32 v168, v168, v169
    v_cvt_pk_bf16_f32 v169, v170, v171
    v_cvt_pk_bf16_f32 v170, v172, v173
    v_cvt_pk_bf16_f32 v171, v174, v175
    s_add_u32 s101, s71, 294912
    buffer_store_dwordx4 v[168:171], v3, s[16:19], s101 offen offset:0 sc1
    v_accvgpr_read_b32 v176, a40
    v_accvgpr_read_b32 v177, a41
    v_accvgpr_read_b32 v178, a42
    v_accvgpr_read_b32 v179, a43
    v_accvgpr_read_b32 v180, a56
    v_accvgpr_read_b32 v181, a57
    v_accvgpr_read_b32 v182, a58
    v_accvgpr_read_b32 v183, a59
    v_cvt_pk_bf16_f32 v176, v176, v177
    v_cvt_pk_bf16_f32 v177, v178, v179
    v_cvt_pk_bf16_f32 v178, v180, v181
    v_cvt_pk_bf16_f32 v179, v182, v183
    s_add_u32 s101, s71, 294912
    buffer_store_dwordx4 v[176:179], v3, s[16:19], s101 offen offset:1024 sc1
    v_accvgpr_read_b32 v184, a72
    v_accvgpr_read_b32 v185, a73
    v_accvgpr_read_b32 v186, a74
    v_accvgpr_read_b32 v187, a75
    v_accvgpr_read_b32 v188, a88
    v_accvgpr_read_b32 v189, a89
    v_accvgpr_read_b32 v190, a90
    v_accvgpr_read_b32 v191, a91
    v_cvt_pk_bf16_f32 v184, v184, v185
    v_cvt_pk_bf16_f32 v185, v186, v187
    v_cvt_pk_bf16_f32 v186, v188, v189
    v_cvt_pk_bf16_f32 v187, v190, v191
    s_add_u32 s101, s71, 294912
    buffer_store_dwordx4 v[184:187], v3, s[16:19], s101 offen offset:2048 sc1
    v_accvgpr_read_b32 v192, a104
    v_accvgpr_read_b32 v193, a105
    v_accvgpr_read_b32 v194, a106
    v_accvgpr_read_b32 v195, a107
    v_accvgpr_read_b32 v196, a120
    v_accvgpr_read_b32 v197, a121
    v_accvgpr_read_b32 v198, a122
    v_accvgpr_read_b32 v199, a123
    v_cvt_pk_bf16_f32 v192, v192, v193
    v_cvt_pk_bf16_f32 v193, v194, v195
    v_cvt_pk_bf16_f32 v194, v196, v197
    v_cvt_pk_bf16_f32 v195, v198, v199
    s_add_u32 s101, s71, 294912
    buffer_store_dwordx4 v[192:195], v3, s[16:19], s101 offen offset:3072 sc1
    v_accvgpr_read_b32 v200, a136
    v_accvgpr_read_b32 v201, a137
    v_accvgpr_read_b32 v202, a138
    v_accvgpr_read_b32 v203, a139
    v_cvt_pk_bf16_f32 v200, v200, v201
    v_cvt_pk_bf16_f32 v201, v202, v203
    s_add_u32 s101, s72, 294912
    buffer_store_dwordx2 v[200:201], v4, s[16:19], s101 offen sc1
    v_accvgpr_read_b32 v208, a12
    v_accvgpr_read_b32 v209, a13
    v_accvgpr_read_b32 v210, a14
    v_accvgpr_read_b32 v211, a15
    v_accvgpr_read_b32 v212, a28
    v_accvgpr_read_b32 v213, a29
    v_accvgpr_read_b32 v214, a30
    v_accvgpr_read_b32 v215, a31
    v_cvt_pk_bf16_f32 v208, v208, v209
    v_cvt_pk_bf16_f32 v209, v210, v211
    v_cvt_pk_bf16_f32 v210, v212, v213
    v_cvt_pk_bf16_f32 v211, v214, v215
    s_add_u32 s101, s71, 442368
    buffer_store_dwordx4 v[208:211], v3, s[16:19], s101 offen offset:0 sc1
    v_accvgpr_read_b32 v152, a44
    v_accvgpr_read_b32 v153, a45
    v_accvgpr_read_b32 v154, a46
    v_accvgpr_read_b32 v155, a47
    v_accvgpr_read_b32 v156, a60
    v_accvgpr_read_b32 v157, a61
    v_accvgpr_read_b32 v158, a62
    v_accvgpr_read_b32 v159, a63
    v_cvt_pk_bf16_f32 v152, v152, v153
    v_cvt_pk_bf16_f32 v153, v154, v155
    v_cvt_pk_bf16_f32 v154, v156, v157
    v_cvt_pk_bf16_f32 v155, v158, v159
    s_add_u32 s101, s71, 442368
    buffer_store_dwordx4 v[152:155], v3, s[16:19], s101 offen offset:1024 sc1
    v_accvgpr_read_b32 v160, a76
    v_accvgpr_read_b32 v161, a77
    v_accvgpr_read_b32 v162, a78
    v_accvgpr_read_b32 v163, a79
    v_accvgpr_read_b32 v164, a92
    v_accvgpr_read_b32 v165, a93
    v_accvgpr_read_b32 v166, a94
    v_accvgpr_read_b32 v167, a95
    v_cvt_pk_bf16_f32 v160, v160, v161
    v_cvt_pk_bf16_f32 v161, v162, v163
    v_cvt_pk_bf16_f32 v162, v164, v165
    v_cvt_pk_bf16_f32 v163, v166, v167
    s_add_u32 s101, s71, 442368
    buffer_store_dwordx4 v[160:163], v3, s[16:19], s101 offen offset:2048 sc1
    v_accvgpr_read_b32 v168, a108
    v_accvgpr_read_b32 v169, a109
    v_accvgpr_read_b32 v170, a110
    v_accvgpr_read_b32 v171, a111
    v_accvgpr_read_b32 v172, a124
    v_accvgpr_read_b32 v173, a125
    v_accvgpr_read_b32 v174, a126
    v_accvgpr_read_b32 v175, a127
    v_cvt_pk_bf16_f32 v168, v168, v169
    v_cvt_pk_bf16_f32 v169, v170, v171
    v_cvt_pk_bf16_f32 v170, v172, v173
    v_cvt_pk_bf16_f32 v171, v174, v175
    s_add_u32 s101, s71, 442368
    buffer_store_dwordx4 v[168:171], v3, s[16:19], s101 offen offset:3072 sc1
    v_accvgpr_read_b32 v176, a140
    v_accvgpr_read_b32 v177, a141
    v_accvgpr_read_b32 v178, a142
    v_accvgpr_read_b32 v179, a143
    v_cvt_pk_bf16_f32 v176, v176, v177
    v_cvt_pk_bf16_f32 v177, v178, v179
    s_add_u32 s101, s72, 442368
    buffer_store_dwordx2 v[176:177], v4, s[16:19], s101 offen sc1
    s_lshl_b32 s78, s14, 4
    s_lshl_b32 s79, s53, 1
    s_add_u32 s78, s78, s79
    s_lshr_b32 s79, s12, 1
    s_add_u32 s80, s78, s79
    s_and_b32 s79, s12, 1
    s_add_u32 s81, s78, s79
    s_lshl_b32 s82, s79, 1
    v_and_b32 v4, 15, v2
    v_lshrrev_b32 v5, 4, v2
    v_mul_u32_u24 v4, 1152, v4
    v_lshl_add_u32 v4, v5, 3, v4
    s_mul_i32 s74, s55, 288
    s_mul_i32 s75, s80, 18432
    s_add_u32 s75, s75, s74
    s_lshl_b32 s76, s82, 6
    s_add_u32 s75, s75, s76
    s_mul_i32 s76, s81, 18432
    s_add_u32 s76, s76, s74
    s_add_u32 s76, s76, 256
    s_mov_b32 s60, s26
    s_mov_b32 s61, s27
    s_mov_b32 s62, 2359296
    s_mov_b32 s63, 0x20000
    s_mov_b32 s64, s28
    s_mov_b32 s65, s29
    s_mov_b32 s66, 2359296
    s_mov_b32 s67, 0x20000
    buffer_load_dwordx2 v[220:221], v4, s[60:63], s75 offen offset:0
    buffer_load_dwordx2 v[222:223], v4, s[60:63], s75 offen offset:32
    buffer_load_dwordx2 v[224:225], v4, s[60:63], s75 offen offset:64
    buffer_load_dwordx2 v[226:227], v4, s[60:63], s75 offen offset:96
    buffer_load_dwordx2 v[228:229], v4, s[60:63], s76 offen
    s_waitcnt vmcnt(5)
    buffer_store_dword v254, off, s[16:19], s58 sc1
    v_mov_b32 v6, v4
    s_lshl_b32 s77, s54, 2
    s_lshr_b32 s79, s53, 1
    s_add_u32 s77, s77, s79
    s_lshl_b32 s77, s77, 7
    s_add_u32 s77, s77, 100696064
    v_min_u32 v4, 7, v2
    v_lshlrev_b32 v4, 2, v4
    s_mov_b32 s15, 0
mk_polld:
    buffer_load_dword v5, v4, s[16:19], s77 offen sc1
    s_waitcnt vmcnt(0)
    v_cmp_ne_u32 vcc, 1, v5
    s_cbranch_vccz mk_polld_ok
    s_add_u32 s15, s15, 1
    s_cmp_ge_u32 s15, 200000
    s_cbranch_scc1 mk_polld_ok
    s_branch mk_polld
mk_polld_ok:
    s_lshl_b32 s78, s80, 2
    s_add_u32 s78, s78, s55
    s_mul_i32 s78, s78, 36864
    s_add_u32 s78, s78, 50331648
    s_lshl_b32 s79, s82, 10
    s_add_u32 s78, s78, s79
    s_lshl_b32 s79, s81, 2
    s_add_u32 s79, s79, s55
    s_mul_i32 s79, s79, 36864
    s_add_u32 s79, s79, 50364416
    v_lshlrev_b32 v7, 3, v2
    buffer_load_dwordx4 v[8:11], v3, s[16:19], s78 offen sc1
    buffer_load_dwordx4 v[72:75], v3, s[16:19], s78 offen offset:1024 sc1
    s_add_u32 s78, s78, 4096
    buffer_load_dwordx4 v[12:15], v3, s[16:19], s78 offen sc1
    buffer_load_dwordx4 v[76:79], v3, s[16:19], s78 offen offset:1024 sc1
    s_add_u32 s78, s78, 4096
    buffer_load_dwordx4 v[16:19], v3, s[16:19], s78 offen sc1
    buffer_load_dwordx4 v[80:83], v3, s[16:19], s78 offen offset:1024 sc1
    s_add_u32 s78, s78, 4096
    buffer_load_dwordx4 v[20:23], v3, s[16:19], s78 offen sc1
    buffer_load_dwordx4 v[84:87], v3, s[16:19], s78 offen offset:1024 sc1
    s_add_u32 s78, s78, 4096
    buffer_load_dwordx4 v[24:27], v3, s[16:19], s78 offen sc1
    buffer_load_dwordx4 v[88:91], v3, s[16:19], s78 offen offset:1024 sc1
    s_add_u32 s78, s78, 4096
    buffer_load_dwordx4 v[28:31], v3, s[16:19], s78 offen sc1
    buffer_load_dwordx4 v[92:95], v3, s[16:19], s78 offen offset:1024 sc1
    s_add_u32 s78, s78, 4096
    buffer_load_dwordx4 v[32:35], v3, s[16:19], s78 offen sc1
    buffer_load_dwordx4 v[96:99], v3, s[16:19], s78 offen offset:1024 sc1
    s_add_u32 s78, s78, 4096
    buffer_load_dwordx4 v[36:39], v3, s[16:19], s78 offen sc1
    buffer_load_dwordx4 v[100:103], v3, s[16:19], s78 offen offset:1024 sc1
    buffer_load_dwordx2 v[136:137], v7, s[16:19], s79 offen offset:0 sc1
    buffer_load_dwordx2 v[138:139], v7, s[16:19], s79 offen offset:512 sc1
    buffer_load_dwordx2 v[140:141], v7, s[16:19], s79 offen offset:1024 sc1
    buffer_load_dwordx2 v[142:143], v7, s[16:19], s79 offen offset:1536 sc1
    buffer_load_dwordx2 v[144:145], v7, s[16:19], s79 offen offset:2048 sc1
    buffer_load_dwordx2 v[146:147], v7, s[16:19], s79 offen offset:2560 sc1
    buffer_load_dwordx2 v[148:149], v7, s[16:19], s79 offen offset:3072 sc1
    buffer_load_dwordx2 v[150:151], v7, s[16:19], s79 offen offset:3584 sc1
    s_mov_b32 s23, 0xbfb8aa3b
    s_waitcnt vmcnt(22)
    v_lshlrev_b32 v170, 16, v8
    v_and_b32 v171, 0xffff0000, v8
    v_lshlrev_b32 v172, 16, v9
    v_and_b32 v173, 0xffff0000, v9
    v_lshlrev_b32 v174, 16, v10
    v_and_b32 v175, 0xffff0000, v10
    v_lshlrev_b32 v176, 16, v11
    v_and_b32 v177, 0xffff0000, v11
    v_lshlrev_b32 v178, 16, v72
    v_and_b32 v179, 0xffff0000, v72
    v_lshlrev_b32 v180, 16, v73
    v_and_b32 v181, 0xffff0000, v73
    v_lshlrev_b32 v182, 16, v74
    v_and_b32 v183, 0xffff0000, v74
    v_lshlrev_b32 v184, 16, v75
    v_and_b32 v185, 0xffff0000, v75
    s_waitcnt vmcnt(20)
    v_lshlrev_b32 v216, 16, v12
    v_and_b32 v217, 0xffff0000, v12
    v_pk_add_f32 v[170:171], v[170:171], v[216:217]
    v_lshlrev_b32 v218, 16, v13
    v_and_b32 v219, 0xffff0000, v13
    v_pk_add_f32 v[172:173], v[172:173], v[218:219]
    v_lshlrev_b32 v216, 16, v14
    v_and_b32 v217, 0xffff0000, v14
    v_pk_add_f32 v[174:175], v[174:175], v[216:217]
    v_lshlrev_b32 v218, 16, v15
    v_and_b32 v219, 0xffff0000, v15
    v_pk_add_f32 v[176:177], v[176:177], v[218:219]
    v_lshlrev_b32 v216, 16, v76
    v_and_b32 v217, 0xffff0000, v76
    v_pk_add_f32 v[178:179], v[178:179], v[216:217]
    v_lshlrev_b32 v218, 16, v77
    v_and_b32 v219, 0xffff0000, v77
    v_pk_add_f32 v[180:181], v[180:181], v[218:219]
    v_lshlrev_b32 v216, 16, v78
    v_and_b32 v217, 0xffff0000, v78
    v_pk_add_f32 v[182:183], v[182:183], v[216:217]
    v_lshlrev_b32 v218, 16, v79
    v_and_b32 v219, 0xffff0000, v79
    v_pk_add_f32 v[184:185], v[184:185], v[218:219]
    s_waitcnt vmcnt(18)
    v_lshlrev_b32 v216, 16, v16
    v_and_b32 v217, 0xffff0000, v16
    v_pk_add_f32 v[170:171], v[170:171], v[216:217]
    v_lshlrev_b32 v218, 16, v17
    v_and_b32 v219, 0xffff0000, v17
    v_pk_add_f32 v[172:173], v[172:173], v[218:219]
    v_lshlrev_b32 v216, 16, v18
    v_and_b32 v217, 0xffff0000, v18
    v_pk_add_f32 v[174:175], v[174:175], v[216:217]
    v_lshlrev_b32 v218, 16, v19
    v_and_b32 v219, 0xffff0000, v19
    v_pk_add_f32 v[176:177], v[176:177], v[218:219]
    v_lshlrev_b32 v216, 16, v80
    v_and_b32 v217, 0xffff0000, v80
    v_pk_add_f32 v[178:179], v[178:179], v[216:217]
    v_lshlrev_b32 v218, 16, v81
    v_and_b32 v219, 0xffff0000, v81
    v_pk_add_f32 v[180:181], v[180:181], v[218:219]
    v_lshlrev_b32 v216, 16, v82
    v_and_b32 v217, 0xffff0000, v82
    v_pk_add_f32 v[182:183], v[182:183], v[216:217]
    v_lshlrev_b32 v218, 16, v83
    v_and_b32 v219, 0xffff0000, v83
    v_pk_add_f32 v[184:185], v[184:185], v[218:219]
    s_waitcnt vmcnt(16)
    v_lshlrev_b32 v216, 16, v20
    v_and_b32 v217, 0xffff0000, v20
    v_pk_add_f32 v[170:171], v[170:171], v[216:217]
    v_lshlrev_b32 v218, 16, v21
    v_and_b32 v219, 0xffff0000, v21
    v_pk_add_f32 v[172:173], v[172:173], v[218:219]
    v_lshlrev_b32 v216, 16, v22
    v_and_b32 v217, 0xffff0000, v22
    v_pk_add_f32 v[174:175], v[174:175], v[216:217]
    v_lshlrev_b32 v218, 16, v23
    v_and_b32 v219, 0xffff0000, v23
    v_pk_add_f32 v[176:177], v[176:177], v[218:219]
    v_lshlrev_b32 v216, 16, v84
    v_and_b32 v217, 0xffff0000, v84
    v_pk_add_f32 v[178:179], v[178:179], v[216:217]
    v_lshlrev_b32 v218, 16, v85
    v_and_b32 v219, 0xffff0000, v85
    v_pk_add_f32 v[180:181], v[180:181], v[218:219]
    v_lshlrev_b32 v216, 16, v86
    v_and_b32 v217, 0xffff0000, v86
    v_pk_add_f32 v[182:183], v[182:183], v[216:217]
    v_lshlrev_b32 v218, 16, v87
    v_and_b32 v219, 0xffff0000, v87
    v_pk_add_f32 v[184:185], v[184:185], v[218:219]
    s_waitcnt vmcnt(14)
    v_lshlrev_b32 v190, 16, v24
    v_and_b32 v191, 0xffff0000, v24
    v_lshlrev_b32 v192, 16, v25
    v_and_b32 v193, 0xffff0000, v25
    v_lshlrev_b32 v194, 16, v26
    v_and_b32 v195, 0xffff0000, v26
    v_lshlrev_b32 v196, 16, v27
    v_and_b32 v197, 0xffff0000, v27
    v_lshlrev_b32 v198, 16, v88
    v_and_b32 v199, 0xffff0000, v88
    v_lshlrev_b32 v200, 16, v89
    v_and_b32 v201, 0xffff0000, v89
    v_lshlrev_b32 v202, 16, v90
    v_and_b32 v203, 0xffff0000, v90
    v_lshlrev_b32 v204, 16, v91
    v_and_b32 v205, 0xffff0000, v91
    s_waitcnt vmcnt(12)
    v_lshlrev_b32 v216, 16, v28
    v_and_b32 v217, 0xffff0000, v28
    v_pk_add_f32 v[190:191], v[190:191], v[216:217]
    v_lshlrev_b32 v218, 16, v29
    v_and_b32 v219, 0xffff0000, v29
    v_pk_add_f32 v[192:193], v[192:193], v[218:219]
    v_lshlrev_b32 v216, 16, v30
    v_and_b32 v217, 0xffff0000, v30
    v_pk_add_f32 v[194:195], v[194:195], v[216:217]
    v_lshlrev_b32 v218, 16, v31
    v_and_b32 v219, 0xffff0000, v31
    v_pk_add_f32 v[196:197], v[196:197], v[218:219]
    v_lshlrev_b32 v216, 16, v92
    v_and_b32 v217, 0xffff0000, v92
    v_pk_add_f32 v[198:199], v[198:199], v[216:217]
    v_lshlrev_b32 v218, 16, v93
    v_and_b32 v219, 0xffff0000, v93
    v_pk_add_f32 v[200:201], v[200:201], v[218:219]
    v_lshlrev_b32 v216, 16, v94
    v_and_b32 v217, 0xffff0000, v94
    v_pk_add_f32 v[202:203], v[202:203], v[216:217]
    v_lshlrev_b32 v218, 16, v95
    v_and_b32 v219, 0xffff0000, v95
    v_pk_add_f32 v[204:205], v[204:205], v[218:219]
    s_waitcnt vmcnt(10)
    v_lshlrev_b32 v216, 16, v32
    v_and_b32 v217, 0xffff0000, v32
    v_pk_add_f32 v[190:191], v[190:191], v[216:217]
    v_lshlrev_b32 v218, 16, v33
    v_and_b32 v219, 0xffff0000, v33
    v_pk_add_f32 v[192:193], v[192:193], v[218:219]
    v_lshlrev_b32 v216, 16, v34
    v_and_b32 v217, 0xffff0000, v34
    v_pk_add_f32 v[194:195], v[194:195], v[216:217]
    v_lshlrev_b32 v218, 16, v35
    v_and_b32 v219, 0xffff0000, v35
    v_pk_add_f32 v[196:197], v[196:197], v[218:219]
    v_lshlrev_b32 v216, 16, v96
    v_and_b32 v217, 0xffff0000, v96
    v_pk_add_f32 v[198:199], v[198:199], v[216:217]
    v_lshlrev_b32 v218, 16, v97
    v_and_b32 v219, 0xffff0000, v97
    v_pk_add_f32 v[200:201], v[200:201], v[218:219]
    v_lshlrev_b32 v216, 16, v98
    v_and_b32 v217, 0xffff0000, v98
    v_pk_add_f32 v[202:203], v[202:203], v[216:217]
    v_lshlrev_b32 v218, 16, v99
    v_and_b32 v219, 0xffff0000, v99
    v_pk_add_f32 v[204:205], v[204:205], v[218:219]
    s_waitcnt vmcnt(8)
    v_lshlrev_b32 v216, 16, v36
    v_and_b32 v217, 0xffff0000, v36
    v_pk_add_f32 v[190:191], v[190:191], v[216:217]
    v_lshlrev_b32 v218, 16, v37
    v_and_b32 v219, 0xffff0000, v37
    v_pk_add_f32 v[192:193], v[192:193], v[218:219]
    v_lshlrev_b32 v216, 16, v38
    v_and_b32 v217, 0xffff0000, v38
    v_pk_add_f32 v[194:195], v[194:195], v[216:217]
    v_lshlrev_b32 v218, 16, v39
    v_and_b32 v219, 0xffff0000, v39
    v_pk_add_f32 v[196:197], v[196:197], v[218:219]
    v_lshlrev_b32 v216, 16, v100
    v_and_b32 v217, 0xffff0000, v100
    v_pk_add_f32 v[198:199], v[198:199], v[216:217]
    v_lshlrev_b32 v218, 16, v101
    v_and_b32 v219, 0xffff0000, v101
    v_pk_add_f32 v[200:201], v[200:201], v[218:219]
    v_lshlrev_b32 v216, 16, v102
    v_and_b32 v217, 0xffff0000, v102
    v_pk_add_f32 v[202:203], v[202:203], v[216:217]
    v_lshlrev_b32 v218, 16, v103
    v_and_b32 v219, 0xffff0000, v103
    v_pk_add_f32 v[204:205], v[204:205], v[218:219]
    v_mul_f32 v210, s23, v190
    v_mul_f32 v211, s23, v191
    v_mul_f32 v212, s23, v192
    v_mul_f32 v213, s23, v193
    v_exp_f32 v210, v210
    v_exp_f32 v211, v211
    v_exp_f32 v212, v212
    v_exp_f32 v213, v213
    s_nop 0
    v_add_f32 v210, 1.0, v210
    v_add_f32 v211, 1.0, v211
    v_add_f32 v212, 1.0, v212
    v_add_f32 v213, 1.0, v213
    v_rcp_f32 v210, v210
    v_rcp_f32 v211, v211
    v_rcp_f32 v212, v212
    v_rcp_f32 v213, v213
    s_nop 0
    v_mul_f32 v190, v190, v210
    v_mul_f32 v191, v191, v211
    v_mul_f32 v192, v192, v212
    v_mul_f32 v193, v193, v213
    v_lshlrev_b32 v210, 16, v220
    v_and_b32 v211, 0xffff0000, v220
    v_lshlrev_b32 v212, 16, v221
    v_and_b32 v213, 0xffff0000, v221
    v_fma_f32 v210, v170, v190, v210
    v_fma_f32 v211, v171, v191, v211
    v_fma_f32 v212, v172, v192, v212
    v_fma_f32 v213, v173, v193, v213
    v_cvt_pk_bf16_f32 v220, v210, v211
    v_cvt_pk_bf16_f32 v221, v212, v213
    buffer_store_dwordx2 v[220:221], v6, s[64:67], s75 offen offset:0
    v_mul_f32 v210, s23, v194
    v_mul_f32 v211, s23, v195
    v_mul_f32 v212, s23, v196
    v_mul_f32 v213, s23, v197
    v_exp_f32 v210, v210
    v_exp_f32 v211, v211
    v_exp_f32 v212, v212
    v_exp_f32 v213, v213
    s_nop 0
    v_add_f32 v210, 1.0, v210
    v_add_f32 v211, 1.0, v211
    v_add_f32 v212, 1.0, v212
    v_add_f32 v213, 1.0, v213
    v_rcp_f32 v210, v210
    v_rcp_f32 v211, v211
    v_rcp_f32 v212, v212
    v_rcp_f32 v213, v213
    s_nop 0
    v_mul_f32 v194, v194, v210
    v_mul_f32 v195, v195, v211
    v_mul_f32 v196, v196, v212
    v_mul_f32 v197, v197, v213
    v_lshlrev_b32 v210, 16, v222
    v_and_b32 v211, 0xffff0000, v222
    v_lshlrev_b32 v212, 16, v223
    v_and_b32 v213, 0xffff0000, v223
    v_fma_f32 v210, v174, v194, v210
    v_fma_f32 v211, v175, v195, v211
    v_fma_f32 v212, v176, v196, v212
    v_fma_f32 v213, v177, v197, v213
    v_cvt_pk_bf16_f32 v222, v210, v211
    v_cvt_pk_bf16_f32 v223, v212, v213
    buffer_store_dwordx2 v[222:223], v6, s[64:67], s75 offen offset:32
    v_mul_f32 v210, s23, v198
    v_mul_f32 v211, s23, v199
    v_mul_f32 v212, s23, v200
    v_mul_f32 v213, s23, v201
    v_exp_f32 v210, v210
    v_exp_f32 v211, v211
    v_exp_f32 v212, v212
    v_exp_f32 v213, v213
    s_nop 0
    v_add_f32 v210, 1.0, v210
    v_add_f32 v211, 1.0, v211
    v_add_f32 v212, 1.0, v212
    v_add_f32 v213, 1.0, v213
    v_rcp_f32 v210, v210
    v_rcp_f32 v211, v211
    v_rcp_f32 v212, v212
    v_rcp_f32 v213, v213
    s_nop 0
    v_mul_f32 v198, v198, v210
    v_mul_f32 v199, v199, v211
    v_mul_f32 v200, v200, v212
    v_mul_f32 v201, v201, v213
    v_lshlrev_b32 v210, 16, v224
    v_and_b32 v211, 0xffff0000, v224
    v_lshlrev_b32 v212, 16, v225
    v_and_b32 v213, 0xffff0000, v225
    v_fma_f32 v210, v178, v198, v210
    v_fma_f32 v211, v179, v199, v211
    v_fma_f32 v212, v180, v200, v212
    v_fma_f32 v213, v181, v201, v213
    v_cvt_pk_bf16_f32 v224, v210, v211
    v_cvt_pk_bf16_f32 v225, v212, v213
    buffer_store_dwordx2 v[224:225], v6, s[64:67], s75 offen offset:64
    v_mul_f32 v210, s23, v202
    v_mul_f32 v211, s23, v203
    v_mul_f32 v212, s23, v204
    v_mul_f32 v213, s23, v205
    v_exp_f32 v210, v210
    v_exp_f32 v211, v211
    v_exp_f32 v212, v212
    v_exp_f32 v213, v213
    s_nop 0
    v_add_f32 v210, 1.0, v210
    v_add_f32 v211, 1.0, v211
    v_add_f32 v212, 1.0, v212
    v_add_f32 v213, 1.0, v213
    v_rcp_f32 v210, v210
    v_rcp_f32 v211, v211
    v_rcp_f32 v212, v212
    v_rcp_f32 v213, v213
    s_nop 0
    v_mul_f32 v202, v202, v210
    v_mul_f32 v203, v203, v211
    v_mul_f32 v204, v204, v212
    v_mul_f32 v205, v205, v213
    v_lshlrev_b32 v210, 16, v226
    v_and_b32 v211, 0xffff0000, v226
    v_lshlrev_b32 v212, 16, v227
    v_and_b32 v213, 0xffff0000, v227
    v_fma_f32 v210, v182, v202, v210
    v_fma_f32 v211, v183, v203, v211
    v_fma_f32 v212, v184, v204, v212
    v_fma_f32 v213, v185, v205, v213
    v_cvt_pk_bf16_f32 v226, v210, v211
    v_cvt_pk_bf16_f32 v227, v212, v213
    buffer_store_dwordx2 v[226:227], v6, s[64:67], s75 offen offset:96
    s_waitcnt vmcnt(4)
    v_lshlrev_b32 v186, 16, v136
    v_and_b32 v187, 0xffff0000, v136
    v_lshlrev_b32 v188, 16, v137
    v_and_b32 v189, 0xffff0000, v137
    v_lshlrev_b32 v216, 16, v138
    v_and_b32 v217, 0xffff0000, v138
    v_pk_add_f32 v[186:187], v[186:187], v[216:217]
    v_lshlrev_b32 v216, 16, v139
    v_and_b32 v217, 0xffff0000, v139
    v_pk_add_f32 v[188:189], v[188:189], v[216:217]
    v_lshlrev_b32 v216, 16, v140
    v_and_b32 v217, 0xffff0000, v140
    v_pk_add_f32 v[186:187], v[186:187], v[216:217]
    v_lshlrev_b32 v216, 16, v141
    v_and_b32 v217, 0xffff0000, v141
    v_pk_add_f32 v[188:189], v[188:189], v[216:217]
    v_lshlrev_b32 v216, 16, v142
    v_and_b32 v217, 0xffff0000, v142
    v_pk_add_f32 v[186:187], v[186:187], v[216:217]
    v_lshlrev_b32 v216, 16, v143
    v_and_b32 v217, 0xffff0000, v143
    v_pk_add_f32 v[188:189], v[188:189], v[216:217]
    v_lshlrev_b32 v206, 16, v144
    v_and_b32 v207, 0xffff0000, v144
    v_lshlrev_b32 v208, 16, v145
    v_and_b32 v209, 0xffff0000, v145
    v_lshlrev_b32 v216, 16, v146
    v_and_b32 v217, 0xffff0000, v146
    v_pk_add_f32 v[206:207], v[206:207], v[216:217]
    v_lshlrev_b32 v216, 16, v147
    v_and_b32 v217, 0xffff0000, v147
    v_pk_add_f32 v[208:209], v[208:209], v[216:217]
    v_lshlrev_b32 v216, 16, v148
    v_and_b32 v217, 0xffff0000, v148
    v_pk_add_f32 v[206:207], v[206:207], v[216:217]
    v_lshlrev_b32 v216, 16, v149
    v_and_b32 v217, 0xffff0000, v149
    v_pk_add_f32 v[208:209], v[208:209], v[216:217]
    v_lshlrev_b32 v216, 16, v150
    v_and_b32 v217, 0xffff0000, v150
    v_pk_add_f32 v[206:207], v[206:207], v[216:217]
    v_lshlrev_b32 v216, 16, v151
    v_and_b32 v217, 0xffff0000, v151
    v_pk_add_f32 v[208:209], v[208:209], v[216:217]
    v_mul_f32 v210, s23, v206
    v_mul_f32 v211, s23, v207
    v_mul_f32 v212, s23, v208
    v_mul_f32 v213, s23, v209
    v_exp_f32 v210, v210
    v_exp_f32 v211, v211
    v_exp_f32 v212, v212
    v_exp_f32 v213, v213
    s_nop 0
    v_add_f32 v210, 1.0, v210
    v_add_f32 v211, 1.0, v211
    v_add_f32 v212, 1.0, v212
    v_add_f32 v213, 1.0, v213
    v_rcp_f32 v210, v210
    v_rcp_f32 v211, v211
    v_rcp_f32 v212, v212
    v_rcp_f32 v213, v213
    s_nop 0
    v_mul_f32 v206, v206, v210
    v_mul_f32 v207, v207, v211
    v_mul_f32 v208, v208, v212
    v_mul_f32 v209, v209, v213
    v_lshlrev_b32 v210, 16, v228
    v_and_b32 v211, 0xffff0000, v228
    v_lshlrev_b32 v212, 16, v229
    v_and_b32 v213, 0xffff0000, v229
    v_fma_f32 v210, v186, v206, v210
    v_fma_f32 v211, v187, v207, v211
    v_fma_f32 v212, v188, v208, v212
    v_fma_f32 v213, v189, v209, v213
    v_cvt_pk_bf16_f32 v228, v210, v211
    v_cvt_pk_bf16_f32 v229, v212, v213
    buffer_store_dwordx2 v[228:229], v6, s[64:67], s76 offen
    s_endpgm
mk_slowh:
    s_mov_b32 s15, 0
mk_slowh2:
    buffer_load_dword v230, v231, s[16:19], s59 offen sc1
    s_waitcnt vmcnt(0)
    v_cmp_ne_u32 vcc, 1, v230
    s_nop 0
    s_cbranch_vccz mk_slowh2_ok
    s_add_u32 s15, s15, 1
    s_cmp_ge_u32 s15, 200000
    s_cbranch_scc1 mk_slowh2_ok
    s_sleep 2
    s_branch mk_slowh2
mk_slowh2_ok:
    s_branch mk_h_ok
mk_slowo:
    s_mov_b32 s15, 0
mk_slowo2:
    buffer_load_dword v230, v231, s[16:19], s22 offen sc1
    s_waitcnt vmcnt(0)
    v_cmp_ne_u32 vcc, 1, v230
    s_nop 0
    s_cbranch_vccz mk_slowo2_ok
    s_add_u32 s15, s15, 1
    s_cmp_ge_u32 s15, 200000
    s_cbranch_scc1 mk_slowo2_ok
    s_sleep 2
    s_branch mk_slowo2
mk_slowo2_ok:
    s_branch mk_o_ok
mk_stubp0:
    s_call_b64 s[50:51], mk_rare0
    s_branch mk_okp0
mk_stubp1:
    s_call_b64 s[50:51], mk_rare1
    s_branch mk_okp1
mk_stubl2:
    s_call_b64 s[50:51], mk_rare0
    s_branch mk_okl2
mk_stubl3:
    s_call_b64 s[50:51], mk_rare1
    s_branch mk_okl3
mk_stubl4:
    s_call_b64 s[50:51], mk_rare0
    s_branch mk_okl4
mk_stubl5:
    s_call_b64 s[50:51], mk_rare1
    s_branch mk_okl5
mk_stubl6:
    s_call_b64 s[50:51], mk_rare0
    s_branch mk_okl6
mk_stubl7:
    s_call_b64 s[50:51], mk_rare1
    s_branch mk_okl7
mk_stubl8:
    s_call_b64 s[50:51], mk_rare0
    s_branch mk_okl8
mk_stubl9:
    s_call_b64 s[50:51], mk_rare1
    s_branch mk_okl9
mk_stubt58:
    s_call_b64 s[50:51], mk_rare0
    s_branch mk_okt58
mk_stubt59:
    s_call_b64 s[50:51], mk_rare1
    s_branch mk_okt59
mk_stubt60:
    s_call_b64 s[50:51], mk_rare0
    s_branch mk_okt60
mk_stubt61:
    s_call_b64 s[50:51], mk_rare1
    s_branch mk_okt61
mk_stubt62:
    s_call_b64 s[50:51], mk_rare0
    s_branch mk_okt62
mk_stubt63:
    s_call_b64 s[50:51], mk_rare2
    s_branch mk_okt63
mk_rare0:
    s_nop 15
    v_max3_f32 v190, v8, v9, v10
    v_max3_f32 v190, v190, v11, v12
    v_max3_f32 v190, v190, v13, v14
    v_max3_f32 v190, v190, v15, 0
    v_mov_b32 v188, v190
    s_nop 1
    v_permlane32_swap_b32 v188, v190
    s_nop 1
    v_max_f32 v190, v188, v190
    v_mov_b32 v188, v190
    s_nop 1
    v_permlane16_swap_b32 v188, v190
    s_nop 1
    v_max_f32 v190, v188, v190
    v_sub_f32 v191, 0, v190
    v_exp_f32 v191, v191
    v_sub_f32 v104, v104, v190
    v_sub_f32 v105, v105, v190
    v_sub_f32 v106, v106, v190
    v_sub_f32 v107, v107, v190
    v_sub_f32 v8, v8, v190
    v_sub_f32 v9, v9, v190
    v_sub_f32 v10, v10, v190
    v_sub_f32 v11, v11, v190
    v_sub_f32 v12, v12, v190
    v_sub_f32 v13, v13, v190
    v_sub_f32 v14, v14, v190
    v_sub_f32 v15, v15, v190
    v_sub_f32 v40, v40, v190
    v_sub_f32 v41, v41, v190
    v_sub_f32 v42, v42, v190
    v_sub_f32 v43, v43, v190
    v_sub_f32 v44, v44, v190
    v_sub_f32 v45, v45, v190
    v_sub_f32 v46, v46, v190
    v_sub_f32 v47, v47, v190
    v_mul_f32 v168, v168, v191
    v_accvgpr_read_b32 v189, a128
    v_mul_f32 v189, v189, v191
    v_accvgpr_write_b32 a128, v189
    v_accvgpr_read_b32 v189, a129
    v_mul_f32 v189, v189, v191
    v_accvgpr_write_b32 a129, v189
    v_accvgpr_read_b32 v189, a130
    v_mul_f32 v189, v189, v191
    v_accvgpr_write_b32 a130, v189
    v_accvgpr_read_b32 v189, a131
    v_mul_f32 v189, v189, v191
    v_accvgpr_write_b32 a131, v189
    v_accvgpr_read_b32 v189, a132
    v_mul_f32 v189, v189, v191
    v_accvgpr_write_b32 a132, v189
    v_accvgpr_read_b32 v189, a133
    v_mul_f32 v189, v189, v191
    v_accvgpr_write_b32 a133, v189
    v_accvgpr_read_b32 v189, a134
    v_mul_f32 v189, v189, v191
    v_accvgpr_write_b32 a134, v189
    v_accvgpr_read_b32 v189, a135
    v_mul_f32 v189, v189, v191
    v_accvgpr_write_b32 a135, v189
    v_accvgpr_read_b32 v189, a136
    v_mul_f32 v189, v189, v191
    v_accvgpr_write_b32 a136, v189
    v_accvgpr_read_b32 v189, a137
    v_mul_f32 v189, v189, v191
    v_accvgpr_write_b32 a137, v189
    v_accvgpr_read_b32 v189, a138
    v_mul_f32 v189, v189, v191
    v_accvgpr_write_b32 a138, v189
    v_accvgpr_read_b32 v189, a139
    v_mul_f32 v189, v189, v191
    v_accvgpr_write_b32 a139, v189
    v_accvgpr_read_b32 v189, a140
    v_mul_f32 v189, v189, v191
    v_accvgpr_write_b32 a140, v189
    v_accvgpr_read_b32 v189, a141
    v_mul_f32 v189, v189, v191
    v_accvgpr_write_b32 a141, v189
    v_accvgpr_read_b32 v189, a142
    v_mul_f32 v189, v189, v191
    v_accvgpr_write_b32 a142, v189
    v_accvgpr_read_b32 v189, a143
    v_mul_f32 v189, v189, v191
    v_accvgpr_write_b32 a143, v189
    v_accvgpr_read_b32 v189, a144
    v_mul_f32 v189, v189, v191
    v_accvgpr_write_b32 a144, v189
    v_accvgpr_read_b32 v189, a145
    v_mul_f32 v189, v189, v191
    v_accvgpr_write_b32 a145, v189
    v_accvgpr_read_b32 v189, a146
    v_mul_f32 v189, v189, v191
    v_accvgpr_write_b32 a146, v189
    v_accvgpr_read_b32 v189, a147
    v_mul_f32 v189, v189, v191
    v_accvgpr_write_b32 a147, v189
    v_accvgpr_read_b32 v189, a148
    v_mul_f32 v189, v189, v191
    v_accvgpr_write_b32 a148, v189
    v_accvgpr_read_b32 v189, a149
    v_mul_f32 v189, v189, v191
    v_accvgpr_write_b32 a149, v189
    v_accvgpr_read_b32 v189, a150
    v_mul_f32 v189, v189, v191
    v_accvgpr_write_b32 a150, v189
    v_accvgpr_read_b32 v189, a151
    v_mul_f32 v189, v189, v191
    v_accvgpr_write_b32 a151, v189
    v_accvgpr_read_b32 v189, a152
    v_mul_f32 v189, v189, v191
    v_accvgpr_write_b32 a152, v189
    v_accvgpr_read_b32 v189, a153
    v_mul_f32 v189, v189, v191
    v_accvgpr_write_b32 a153, v189
    v_accvgpr_read_b32 v189, a154
    v_mul_f32 v189, v189, v191
    v_accvgpr_write_b32 a154, v189
    v_accvgpr_read_b32 v189, a155
    v_mul_f32 v189, v189, v191
    v_accvgpr_write_b32 a155, v189
    v_accvgpr_read_b32 v189, a156
    v_mul_f32 v189, v189, v191
    v_accvgpr_write_b32 a156, v189
    v_accvgpr_read_b32 v189, a157
    v_mul_f32 v189, v189, v191
    v_accvgpr_write_b32 a157, v189
    v_accvgpr_read_b32 v189, a158
    v_mul_f32 v189, v189, v191
    v_accvgpr_write_b32 a158, v189
    v_accvgpr_read_b32 v189, a159
    v_mul_f32 v189, v189, v191
    v_accvgpr_write_b32 a159, v189
    v_max3_f32 v190, v16, v17, v18
    v_max3_f32 v190, v190, v19, v20
    v_max3_f32 v190, v190, v21, v22
    v_max3_f32 v190, v190, v23, 0
    v_mov_b32 v188, v190
    s_nop 1
    v_permlane32_swap_b32 v188, v190
    s_nop 1
    v_max_f32 v190, v188, v190
    v_mov_b32 v188, v190
    s_nop 1
    v_permlane16_swap_b32 v188, v190
    s_nop 1
    v_max_f32 v190, v188, v190
    v_sub_f32 v191, 0, v190
    v_exp_f32 v191, v191
    v_sub_f32 v108, v108, v190
    v_sub_f32 v109, v109, v190
    v_sub_f32 v110, v110, v190
    v_sub_f32 v111, v111, v190
    v_sub_f32 v16, v16, v190
    v_sub_f32 v17, v17, v190
    v_sub_f32 v18, v18, v190
    v_sub_f32 v19, v19, v190
    v_sub_f32 v20, v20, v190
    v_sub_f32 v21, v21, v190
    v_sub_f32 v22, v22, v190
    v_sub_f32 v23, v23, v190
    v_sub_f32 v48, v48, v190
    v_sub_f32 v49, v49, v190
    v_sub_f32 v50, v50, v190
    v_sub_f32 v51, v51, v190
    v_sub_f32 v52, v52, v190
    v_sub_f32 v53, v53, v190
    v_sub_f32 v54, v54, v190
    v_sub_f32 v55, v55, v190
    v_mul_f32 v169, v169, v191
    v_accvgpr_read_b32 v189, a160
    v_mul_f32 v189, v189, v191
    v_accvgpr_write_b32 a160, v189
    v_accvgpr_read_b32 v189, a161
    v_mul_f32 v189, v189, v191
    v_accvgpr_write_b32 a161, v189
    v_accvgpr_read_b32 v189, a162
    v_mul_f32 v189, v189, v191
    v_accvgpr_write_b32 a162, v189
    v_accvgpr_read_b32 v189, a163
    v_mul_f32 v189, v189, v191
    v_accvgpr_write_b32 a163, v189
    v_accvgpr_read_b32 v189, a164
    v_mul_f32 v189, v189, v191
    v_accvgpr_write_b32 a164, v189
    v_accvgpr_read_b32 v189, a165
    v_mul_f32 v189, v189, v191
    v_accvgpr_write_b32 a165, v189
    v_accvgpr_read_b32 v189, a166
    v_mul_f32 v189, v189, v191
    v_accvgpr_write_b32 a166, v189
    v_accvgpr_read_b32 v189, a167
    v_mul_f32 v189, v189, v191
    v_accvgpr_write_b32 a167, v189
    v_accvgpr_read_b32 v189, a168
    v_mul_f32 v189, v189, v191
    v_accvgpr_write_b32 a168, v189
    v_accvgpr_read_b32 v189, a169
    v_mul_f32 v189, v189, v191
    v_accvgpr_write_b32 a169, v189
    v_accvgpr_read_b32 v189, a170
    v_mul_f32 v189, v189, v191
    v_accvgpr_write_b32 a170, v189
    v_accvgpr_read_b32 v189, a171
    v_mul_f32 v189, v189, v191
    v_accvgpr_write_b32 a171, v189
    v_accvgpr_read_b32 v189, a172
    v_mul_f32 v189, v189, v191
    v_accvgpr_write_b32 a172, v189
    v_accvgpr_read_b32 v189, a173
    v_mul_f32 v189, v189, v191
    v_accvgpr_write_b32 a173, v189
    v_accvgpr_read_b32 v189, a174
    v_mul_f32 v189, v189, v191
    v_accvgpr_write_b32 a174, v189
    v_accvgpr_read_b32 v189, a175
    v_mul_f32 v189, v189, v191
    v_accvgpr_write_b32 a175, v189
    v_accvgpr_read_b32 v189, a176
    v_mul_f32 v189, v189, v191
    v_accvgpr_write_b32 a176, v189
    v_accvgpr_read_b32 v189, a177
    v_mul_f32 v189, v189, v191
    v_accvgpr_write_b32 a177, v189
    v_accvgpr_read_b32 v189, a178
    v_mul_f32 v189, v189, v191
    v_accvgpr_write_b32 a178, v189
    v_accvgpr_read_b32 v189, a179
    v_mul_f32 v189, v189, v191
    v_accvgpr_write_b32 a179, v189
    v_accvgpr_read_b32 v189, a180
    v_mul_f32 v189, v189, v191
    v_accvgpr_write_b32 a180, v189
    v_accvgpr_read_b32 v189, a181
    v_mul_f32 v189, v189, v191
    v_accvgpr_write_b32 a181, v189
    v_accvgpr_read_b32 v189, a182
    v_mul_f32 v189, v189, v191
    v_accvgpr_write_b32 a182, v189
    v_accvgpr_read_b32 v189, a183
    v_mul_f32 v189, v189, v191
    v_accvgpr_write_b32 a183, v189
    v_accvgpr_read_b32 v189, a184
    v_mul_f32 v189, v189, v191
    v_accvgpr_write_b32 a184, v189
    v_accvgpr_read_b32 v189, a185
    v_mul_f32 v189, v189, v191
    v_accvgpr_write_b32 a185, v189
    v_accvgpr_read_b32 v189, a186
    v_mul_f32 v189, v189, v191
    v_accvgpr_write_b32 a186, v189
    v_accvgpr_read_b32 v189, a187
    v_mul_f32 v189, v189, v191
    v_accvgpr_write_b32 a187, v189
    v_accvgpr_read_b32 v189, a188
    v_mul_f32 v189, v189, v191
    v_accvgpr_write_b32 a188, v189
    v_accvgpr_read_b32 v189, a189
    v_mul_f32 v189, v189, v191
    v_accvgpr_write_b32 a189, v189
    v_accvgpr_read_b32 v189, a190
    v_mul_f32 v189, v189, v191
    v_accvgpr_write_b32 a190, v189
    v_accvgpr_read_b32 v189, a191
    v_mul_f32 v189, v189, v191
    v_accvgpr_write_b32 a191, v189
    v_max3_f32 v190, v24, v25, v26
    v_max3_f32 v190, v190, v27, v28
    v_max3_f32 v190, v190, v29, v30
    v_max3_f32 v190, v190, v31, 0
    v_mov_b32 v188, v190
    s_nop 1
    v_permlane32_swap_b32 v188, v190
    s_nop 1
    v_max_f32 v190, v188, v190
    v_mov_b32 v188, v190
    s_nop 1
    v_permlane16_swap_b32 v188, v190
    s_nop 1
    v_max_f32 v190, v188, v190
    v_sub_f32 v191, 0, v190
    v_exp_f32 v191, v191
    v_sub_f32 v112, v112, v190
    v_sub_f32 v113, v113, v190
    v_sub_f32 v114, v114, v190
    v_sub_f32 v115, v115, v190
    v_sub_f32 v24, v24, v190
    v_sub_f32 v25, v25, v190
    v_sub_f32 v26, v26, v190
    v_sub_f32 v27, v27, v190
    v_sub_f32 v28, v28, v190
    v_sub_f32 v29, v29, v190
    v_sub_f32 v30, v30, v190
    v_sub_f32 v31, v31, v190
    v_sub_f32 v56, v56, v190
    v_sub_f32 v57, v57, v190
    v_sub_f32 v58, v58, v190
    v_sub_f32 v59, v59, v190
    v_sub_f32 v60, v60, v190
    v_sub_f32 v61, v61, v190
    v_sub_f32 v62, v62, v190
    v_sub_f32 v63, v63, v190
    v_mul_f32 v170, v170, v191
    v_accvgpr_read_b32 v189, a192
    v_mul_f32 v189, v189, v191
    v_accvgpr_write_b32 a192, v189
    v_accvgpr_read_b32 v189, a193
    v_mul_f32 v189, v189, v191
    v_accvgpr_write_b32 a193, v189
    v_accvgpr_read_b32 v189, a194
    v_mul_f32 v189, v189, v191
    v_accvgpr_write_b32 a194, v189
    v_accvgpr_read_b32 v189, a195
    v_mul_f32 v189, v189, v191
    v_accvgpr_write_b32 a195, v189
    v_accvgpr_read_b32 v189, a196
    v_mul_f32 v189, v189, v191
    v_accvgpr_write_b32 a196, v189
    v_accvgpr_read_b32 v189, a197
    v_mul_f32 v189, v189, v191
    v_accvgpr_write_b32 a197, v189
    v_accvgpr_read_b32 v189, a198
    v_mul_f32 v189, v189, v191
    v_accvgpr_write_b32 a198, v189
    v_accvgpr_read_b32 v189, a199
    v_mul_f32 v189, v189, v191
    v_accvgpr_write_b32 a199, v189
    v_accvgpr_read_b32 v189, a200
    v_mul_f32 v189, v189, v191
    v_accvgpr_write_b32 a200, v189
    v_accvgpr_read_b32 v189, a201
    v_mul_f32 v189, v189, v191
    v_accvgpr_write_b32 a201, v189
    v_accvgpr_read_b32 v189, a202
    v_mul_f32 v189, v189, v191
    v_accvgpr_write_b32 a202, v189
    v_accvgpr_read_b32 v189, a203
    v_mul_f32 v189, v189, v191
    v_accvgpr_write_b32 a203, v189
    v_accvgpr_read_b32 v189, a204
    v_mul_f32 v189, v189, v191
    v_accvgpr_write_b32 a204, v189
    v_accvgpr_read_b32 v189, a205
    v_mul_f32 v189, v189, v191
    v_accvgpr_write_b32 a205, v189
    v_accvgpr_read_b32 v189, a206
    v_mul_f32 v189, v189, v191
    v_accvgpr_write_b32 a206, v189
    v_accvgpr_read_b32 v189, a207
    v_mul_f32 v189, v189, v191
    v_accvgpr_write_b32 a207, v189
    v_accvgpr_read_b32 v189, a208
    v_mul_f32 v189, v189, v191
    v_accvgpr_write_b32 a208, v189
    v_accvgpr_read_b32 v189, a209
    v_mul_f32 v189, v189, v191
    v_accvgpr_write_b32 a209, v189
    v_accvgpr_read_b32 v189, a210
    v_mul_f32 v189, v189, v191
    v_accvgpr_write_b32 a210, v189
    v_accvgpr_read_b32 v189, a211
    v_mul_f32 v189, v189, v191
    v_accvgpr_write_b32 a211, v189
    v_accvgpr_read_b32 v189, a212
    v_mul_f32 v189, v189, v191
    v_accvgpr_write_b32 a212, v189
    v_accvgpr_read_b32 v189, a213
    v_mul_f32 v189, v189, v191
    v_accvgpr_write_b32 a213, v189
    v_accvgpr_read_b32 v189, a214
    v_mul_f32 v189, v189, v191
    v_accvgpr_write_b32 a214, v189
    v_accvgpr_read_b32 v189, a215
    v_mul_f32 v189, v189, v191
    v_accvgpr_write_b32 a215, v189
    v_accvgpr_read_b32 v189, a216
    v_mul_f32 v189, v189, v191
    v_accvgpr_write_b32 a216, v189
    v_accvgpr_read_b32 v189, a217
    v_mul_f32 v189, v189, v191
    v_accvgpr_write_b32 a217, v189
    v_accvgpr_read_b32 v189, a218
    v_mul_f32 v189, v189, v191
    v_accvgpr_write_b32 a218, v189
    v_accvgpr_read_b32 v189, a219
    v_mul_f32 v189, v189, v191
    v_accvgpr_write_b32 a219, v189
    v_accvgpr_read_b32 v189, a220
    v_mul_f32 v189, v189, v191
    v_accvgpr_write_b32 a220, v189
    v_accvgpr_read_b32 v189, a221
    v_mul_f32 v189, v189, v191
    v_accvgpr_write_b32 a221, v189
    v_accvgpr_read_b32 v189, a222
    v_mul_f32 v189, v189, v191
    v_accvgpr_write_b32 a222, v189
    v_accvgpr_read_b32 v189, a223
    v_mul_f32 v189, v189, v191
    v_accvgpr_write_b32 a223, v189
    v_max3_f32 v190, v32, v33, v34
    v_max3_f32 v190, v190, v35, v36
    v_max3_f32 v190, v190, v37, v38
    v_max3_f32 v190, v190, v39, 0
    v_mov_b32 v188, v190
    s_nop 1
    v_permlane32_swap_b32 v188, v190
    s_nop 1
    v_max_f32 v190, v188, v190
    v_mov_b32 v188, v190
    s_nop 1
    v_permlane16_swap_b32 v188, v190
    s_nop 1
    v_max_f32 v190, v188, v190
    v_sub_f32 v191, 0, v190
    v_exp_f32 v191, v191
    v_sub_f32 v116, v116, v190
    v_sub_f32 v117, v117, v190
    v_sub_f32 v118, v118, v190
    v_sub_f32 v119, v119, v190
    v_sub_f32 v32, v32, v190
    v_sub_f32 v33, v33, v190
    v_sub_f32 v34, v34, v190
    v_sub_f32 v35, v35, v190
    v_sub_f32 v36, v36, v190
    v_sub_f32 v37, v37, v190
    v_sub_f32 v38, v38, v190
    v_sub_f32 v39, v39, v190
    v_sub_f32 v64, v64, v190
    v_sub_f32 v65, v65, v190
    v_sub_f32 v66, v66, v190
    v_sub_f32 v67, v67, v190
    v_sub_f32 v68, v68, v190
    v_sub_f32 v69, v69, v190
    v_sub_f32 v70, v70, v190
    v_sub_f32 v71, v71, v190
    v_mul_f32 v171, v171, v191
    v_accvgpr_read_b32 v189, a224
    v_mul_f32 v189, v189, v191
    v_accvgpr_write_b32 a224, v189
    v_accvgpr_read_b32 v189, a225
    v_mul_f32 v189, v189, v191
    v_accvgpr_write_b32 a225, v189
    v_accvgpr_read_b32 v189, a226
    v_mul_f32 v189, v189, v191
    v_accvgpr_write_b32 a226, v189
    v_accvgpr_read_b32 v189, a227
    v_mul_f32 v189, v189, v191
    v_accvgpr_write_b32 a227, v189
    v_accvgpr_read_b32 v189, a228
    v_mul_f32 v189, v189, v191
    v_accvgpr_write_b32 a228, v189
    v_accvgpr_read_b32 v189, a229
    v_mul_f32 v189, v189, v191
    v_accvgpr_write_b32 a229, v189
    v_accvgpr_read_b32 v189, a230
    v_mul_f32 v189, v189, v191
    v_accvgpr_write_b32 a230, v189
    v_accvgpr_read_b32 v189, a231
    v_mul_f32 v189, v189, v191
    v_accvgpr_write_b32 a231, v189
    v_accvgpr_read_b32 v189, a232
    v_mul_f32 v189, v189, v191
    v_accvgpr_write_b32 a232, v189
    v_accvgpr_read_b32 v189, a233
    v_mul_f32 v189, v189, v191
    v_accvgpr_write_b32 a233, v189
    v_accvgpr_read_b32 v189, a234
    v_mul_f32 v189, v189, v191
    v_accvgpr_write_b32 a234, v189
    v_accvgpr_read_b32 v189, a235
    v_mul_f32 v189, v189, v191
    v_accvgpr_write_b32 a235, v189
    v_accvgpr_read_b32 v189, a236
    v_mul_f32 v189, v189, v191
    v_accvgpr_write_b32 a236, v189
    v_accvgpr_read_b32 v189, a237
    v_mul_f32 v189, v189, v191
    v_accvgpr_write_b32 a237, v189
    v_accvgpr_read_b32 v189, a238
    v_mul_f32 v189, v189, v191
    v_accvgpr_write_b32 a238, v189
    v_accvgpr_read_b32 v189, a239
    v_mul_f32 v189, v189, v191
    v_accvgpr_write_b32 a239, v189
    v_accvgpr_read_b32 v189, a240
    v_mul_f32 v189, v189, v191
    v_accvgpr_write_b32 a240, v189
    v_accvgpr_read_b32 v189, a241
    v_mul_f32 v189, v189, v191
    v_accvgpr_write_b32 a241, v189
    v_accvgpr_read_b32 v189, a242
    v_mul_f32 v189, v189, v191
    v_accvgpr_write_b32 a242, v189
    v_accvgpr_read_b32 v189, a243
    v_mul_f32 v189, v189, v191
    v_accvgpr_write_b32 a243, v189
    v_accvgpr_read_b32 v189, a244
    v_mul_f32 v189, v189, v191
    v_accvgpr_write_b32 a244, v189
    v_accvgpr_read_b32 v189, a245
    v_mul_f32 v189, v189, v191
    v_accvgpr_write_b32 a245, v189
    v_accvgpr_read_b32 v189, a246
    v_mul_f32 v189, v189, v191
    v_accvgpr_write_b32 a246, v189
    v_accvgpr_read_b32 v189, a247
    v_mul_f32 v189, v189, v191
    v_accvgpr_write_b32 a247, v189
    v_accvgpr_read_b32 v189, a248
    v_mul_f32 v189, v189, v191
    v_accvgpr_write_b32 a248, v189
    v_accvgpr_read_b32 v189, a249
    v_mul_f32 v189, v189, v191
    v_accvgpr_write_b32 a249, v189
    v_accvgpr_read_b32 v189, a250
    v_mul_f32 v189, v189, v191
    v_accvgpr_write_b32 a250, v189
    v_accvgpr_read_b32 v189, a251
    v_mul_f32 v189, v189, v191
    v_accvgpr_write_b32 a251, v189
    v_accvgpr_read_b32 v189, a252
    v_mul_f32 v189, v189, v191
    v_accvgpr_write_b32 a252, v189
    v_accvgpr_read_b32 v189, a253
    v_mul_f32 v189, v189, v191
    v_accvgpr_write_b32 a253, v189
    v_accvgpr_read_b32 v189, a254
    v_mul_f32 v189, v189, v191
    v_accvgpr_write_b32 a254, v189
    v_accvgpr_read_b32 v189, a255
    v_mul_f32 v189, v189, v191
    v_accvgpr_write_b32 a255, v189
    v_exp_f32 v132, v8
    s_nop 0
    v_exp_f32 v133, v9
    s_nop 0
    v_add_f32 v120, v132, v133
    v_cvt_pk_bf16_f32 v72, v132, v133
    v_exp_f32 v134, v10
    s_nop 0
    v_add_f32 v120, v120, v134
    v_exp_f32 v135, v11
    s_nop 0
    v_add_f32 v120, v120, v135
    v_cvt_pk_bf16_f32 v73, v134, v135
    v_exp_f32 v136, v12
    s_nop 0
    v_add_f32 v120, v120, v136
    v_exp_f32 v137, v13
    s_nop 0
    v_add_f32 v120, v120, v137
    v_cvt_pk_bf16_f32 v74, v136, v137
    v_exp_f32 v138, v14
    s_nop 0
    v_add_f32 v120, v120, v138
    v_exp_f32 v139, v15
    s_nop 0
    v_add_f32 v120, v120, v139
    v_cvt_pk_bf16_f32 v75, v138, v139
    v_mov_b32 v188, v120
    s_nop 1
    v_permlane32_swap_b32 v188, v120
    s_nop 1
    v_add_f32 v120, v188, v120
    v_mov_b32 v188, v120
    s_nop 1
    v_permlane16_swap_b32 v188, v120
    s_nop 1
    v_add_f32 v120, v188, v120
    v_exp_f32 v140, v24
    s_nop 0
    v_exp_f32 v141, v25
    s_nop 0
    v_add_f32 v166, v140, v141
    v_cvt_pk_bf16_f32 v80, v140, v141
    v_exp_f32 v142, v26
    s_nop 0
    v_add_f32 v166, v166, v142
    v_exp_f32 v143, v27
    s_nop 0
    v_add_f32 v166, v166, v143
    v_cvt_pk_bf16_f32 v81, v142, v143
    v_exp_f32 v144, v28
    s_nop 0
    v_add_f32 v166, v166, v144
    v_exp_f32 v145, v29
    s_nop 0
    v_add_f32 v166, v166, v145
    v_cvt_pk_bf16_f32 v82, v144, v145
    v_exp_f32 v146, v30
    s_nop 0
    v_add_f32 v166, v166, v146
    v_exp_f32 v147, v31
    s_nop 0
    v_add_f32 v166, v166, v147
    v_cvt_pk_bf16_f32 v83, v146, v147
    v_exp_f32 v148, v16
    s_nop 0
    v_exp_f32 v149, v17
    s_nop 0
    v_add_f32 v124, v148, v149
    v_cvt_pk_bf16_f32 v76, v148, v149
    v_exp_f32 v150, v18
    s_nop 0
    v_add_f32 v124, v124, v150
    v_exp_f32 v151, v19
    s_nop 0
    v_add_f32 v124, v124, v151
    v_cvt_pk_bf16_f32 v77, v150, v151
    v_exp_f32 v152, v20
    s_nop 0
    v_add_f32 v124, v124, v152
    v_exp_f32 v153, v21
    s_nop 0
    v_add_f32 v124, v124, v153
    v_cvt_pk_bf16_f32 v78, v152, v153
    v_exp_f32 v154, v22
    s_nop 0
    v_add_f32 v124, v124, v154
    v_exp_f32 v155, v23
    s_nop 0
    v_add_f32 v124, v124, v155
    v_cvt_pk_bf16_f32 v79, v154, v155
    v_mov_b32 v188, v124
    s_nop 1
    v_permlane32_swap_b32 v188, v124
    s_nop 1
    v_add_f32 v124, v188, v124
    v_mov_b32 v188, v124
    s_nop 1
    v_permlane16_swap_b32 v188, v124
    s_nop 1
    v_add_f32 v124, v188, v124
    v_exp_f32 v156, v32
    s_nop 0
    v_exp_f32 v157, v33
    s_nop 0
    v_add_f32 v167, v156, v157
    v_cvt_pk_bf16_f32 v84, v156, v157
    v_exp_f32 v158, v34
    s_nop 0
    v_add_f32 v167, v167, v158
    v_exp_f32 v159, v35
    s_nop 0
    v_add_f32 v167, v167, v159
    v_cvt_pk_bf16_f32 v85, v158, v159
    v_exp_f32 v160, v36
    s_nop 0
    v_add_f32 v167, v167, v160
    v_exp_f32 v161, v37
    s_nop 0
    v_add_f32 v167, v167, v161
    v_cvt_pk_bf16_f32 v86, v160, v161
    v_exp_f32 v162, v38
    s_nop 0
    v_add_f32 v167, v167, v162
    v_exp_f32 v163, v39
    s_nop 0
    v_add_f32 v167, v167, v163
    v_cvt_pk_bf16_f32 v87, v162, v163
    v_exp_f32 v132, v40
    s_nop 0
    v_exp_f32 v133, v41
    s_nop 0
    v_cvt_pk_bf16_f32 v88, v132, v133
    s_nop 0
    v_exp_f32 v134, v42
    s_nop 0
    s_nop 3
    s_setpc_b64 s[50:51]
mk_rare1:
    s_nop 15
    v_max3_f32 v190, v40, v41, v42
    v_max3_f32 v190, v190, v43, v44
    v_max3_f32 v190, v190, v45, v46
    v_max3_f32 v190, v190, v47, 0
    v_mov_b32 v188, v190
    s_nop 1
    v_permlane32_swap_b32 v188, v190
    s_nop 1
    v_max_f32 v190, v188, v190
    v_mov_b32 v188, v190
    s_nop 1
    v_permlane16_swap_b32 v188, v190
    s_nop 1
    v_max_f32 v190, v188, v190
    v_sub_f32 v191, 0, v190
    v_exp_f32 v191, v191
    v_sub_f32 v104, v104, v190
    v_sub_f32 v105, v105, v190
    v_sub_f32 v106, v106, v190
    v_sub_f32 v107, v107, v190
    v_sub_f32 v40, v40, v190
    v_sub_f32 v41, v41, v190
    v_sub_f32 v42, v42, v190
    v_sub_f32 v43, v43, v190
    v_sub_f32 v44, v44, v190
    v_sub_f32 v45, v45, v190
    v_sub_f32 v46, v46, v190
    v_sub_f32 v47, v47, v190
    v_sub_f32 v8, v8, v190
    v_sub_f32 v9, v9, v190
    v_sub_f32 v10, v10, v190
    v_sub_f32 v11, v11, v190
    v_sub_f32 v12, v12, v190
    v_sub_f32 v13, v13, v190
    v_sub_f32 v14, v14, v190
    v_sub_f32 v15, v15, v190
    v_mul_f32 v168, v168, v191
    v_accvgpr_read_b32 v189, a128
    v_mul_f32 v189, v189, v191
    v_accvgpr_write_b32 a128, v189
    v_accvgpr_read_b32 v189, a129
    v_mul_f32 v189, v189, v191
    v_accvgpr_write_b32 a129, v189
    v_accvgpr_read_b32 v189, a130
    v_mul_f32 v189, v189, v191
    v_accvgpr_write_b32 a130, v189
    v_accvgpr_read_b32 v189, a131
    v_mul_f32 v189, v189, v191
    v_accvgpr_write_b32 a131, v189
    v_accvgpr_read_b32 v189, a132
    v_mul_f32 v189, v189, v191
    v_accvgpr_write_b32 a132, v189
    v_accvgpr_read_b32 v189, a133
    v_mul_f32 v189, v189, v191
    v_accvgpr_write_b32 a133, v189
    v_accvgpr_read_b32 v189, a134
    v_mul_f32 v189, v189, v191
    v_accvgpr_write_b32 a134, v189
    v_accvgpr_read_b32 v189, a135
    v_mul_f32 v189, v189, v191
    v_accvgpr_write_b32 a135, v189
    v_accvgpr_read_b32 v189, a136
    v_mul_f32 v189, v189, v191
    v_accvgpr_write_b32 a136, v189
    v_accvgpr_read_b32 v189, a137
    v_mul_f32 v189, v189, v191
    v_accvgpr_write_b32 a137, v189
    v_accvgpr_read_b32 v189, a138
    v_mul_f32 v189, v189, v191
    v_accvgpr_write_b32 a138, v189
    v_accvgpr_read_b32 v189, a139
    v_mul_f32 v189, v189, v191
    v_accvgpr_write_b32 a139, v189
    v_accvgpr_read_b32 v189, a140
    v_mul_f32 v189, v189, v191
    v_accvgpr_write_b32 a140, v189
    v_accvgpr_read_b32 v189, a141
    v_mul_f32 v189, v189, v191
    v_accvgpr_write_b32 a141, v189
    v_accvgpr_read_b32 v189, a142
    v_mul_f32 v189, v189, v191
    v_accvgpr_write_b32 a142, v189
    v_accvgpr_read_b32 v189, a143
    v_mul_f32 v189, v189, v191
    v_accvgpr_write_b32 a143, v189
    v_accvgpr_read_b32 v189, a144
    v_mul_f32 v189, v189, v191
    v_accvgpr_write_b32 a144, v189
    v_accvgpr_read_b32 v189, a145
    v_mul_f32 v189, v189, v191
    v_accvgpr_write_b32 a145, v189
    v_accvgpr_read_b32 v189, a146
    v_mul_f32 v189, v189, v191
    v_accvgpr_write_b32 a146, v189
    v_accvgpr_read_b32 v189, a147
    v_mul_f32 v189, v189, v191
    v_accvgpr_write_b32 a147, v189
    v_accvgpr_read_b32 v189, a148
    v_mul_f32 v189, v189, v191
    v_accvgpr_write_b32 a148, v189
    v_accvgpr_read_b32 v189, a149
    v_mul_f32 v189, v189, v191
    v_accvgpr_write_b32 a149, v189
    v_accvgpr_read_b32 v189, a150
    v_mul_f32 v189, v189, v191
    v_accvgpr_write_b32 a150, v189
    v_accvgpr_read_b32 v189, a151
    v_mul_f32 v189, v189, v191
    v_accvgpr_write_b32 a151, v189
    v_accvgpr_read_b32 v189, a152
    v_mul_f32 v189, v189, v191
    v_accvgpr_write_b32 a152, v189
    v_accvgpr_read_b32 v189, a153
    v_mul_f32 v189, v189, v191
    v_accvgpr_write_b32 a153, v189
    v_accvgpr_read_b32 v189, a154
    v_mul_f32 v189, v189, v191
    v_accvgpr_write_b32 a154, v189
    v_accvgpr_read_b32 v189, a155
    v_mul_f32 v189, v189, v191
    v_accvgpr_write_b32 a155, v189
    v_accvgpr_read_b32 v189, a156
    v_mul_f32 v189, v189, v191
    v_accvgpr_write_b32 a156, v189
    v_accvgpr_read_b32 v189, a157
    v_mul_f32 v189, v189, v191
    v_accvgpr_write_b32 a157, v189
    v_accvgpr_read_b32 v189, a158
    v_mul_f32 v189, v189, v191
    v_accvgpr_write_b32 a158, v189
    v_accvgpr_read_b32 v189, a159
    v_mul_f32 v189, v189, v191
    v_accvgpr_write_b32 a159, v189
    v_max3_f32 v190, v48, v49, v50
    v_max3_f32 v190, v190, v51, v52
    v_max3_f32 v190, v190, v53, v54
    v_max3_f32 v190, v190, v55, 0
    v_mov_b32 v188, v190
    s_nop 1
    v_permlane32_swap_b32 v188, v190
    s_nop 1
    v_max_f32 v190, v188, v190
    v_mov_b32 v188, v190
    s_nop 1
    v_permlane16_swap_b32 v188, v190
    s_nop 1
    v_max_f32 v190, v188, v190
    v_sub_f32 v191, 0, v190
    v_exp_f32 v191, v191
    v_sub_f32 v108, v108, v190
    v_sub_f32 v109, v109, v190
    v_sub_f32 v110, v110, v190
    v_sub_f32 v111, v111, v190
    v_sub_f32 v48, v48, v190
    v_sub_f32 v49, v49, v190
    v_sub_f32 v50, v50, v190
    v_sub_f32 v51, v51, v190
    v_sub_f32 v52, v52, v190
    v_sub_f32 v53, v53, v190
    v_sub_f32 v54, v54, v190
    v_sub_f32 v55, v55, v190
    v_sub_f32 v16, v16, v190
    v_sub_f32 v17, v17, v190
    v_sub_f32 v18, v18, v190
    v_sub_f32 v19, v19, v190
    v_sub_f32 v20, v20, v190
    v_sub_f32 v21, v21, v190
    v_sub_f32 v22, v22, v190
    v_sub_f32 v23, v23, v190
    v_mul_f32 v169, v169, v191
    v_accvgpr_read_b32 v189, a160
    v_mul_f32 v189, v189, v191
    v_accvgpr_write_b32 a160, v189
    v_accvgpr_read_b32 v189, a161
    v_mul_f32 v189, v189, v191
    v_accvgpr_write_b32 a161, v189
    v_accvgpr_read_b32 v189, a162
    v_mul_f32 v189, v189, v191
    v_accvgpr_write_b32 a162, v189
    v_accvgpr_read_b32 v189, a163
    v_mul_f32 v189, v189, v191
    v_accvgpr_write_b32 a163, v189
    v_accvgpr_read_b32 v189, a164
    v_mul_f32 v189, v189, v191
    v_accvgpr_write_b32 a164, v189
    v_accvgpr_read_b32 v189, a165
    v_mul_f32 v189, v189, v191
    v_accvgpr_write_b32 a165, v189
    v_accvgpr_read_b32 v189, a166
    v_mul_f32 v189, v189, v191
    v_accvgpr_write_b32 a166, v189
    v_accvgpr_read_b32 v189, a167
    v_mul_f32 v189, v189, v191
    v_accvgpr_write_b32 a167, v189
    v_accvgpr_read_b32 v189, a168
    v_mul_f32 v189, v189, v191
    v_accvgpr_write_b32 a168, v189
    v_accvgpr_read_b32 v189, a169
    v_mul_f32 v189, v189, v191
    v_accvgpr_write_b32 a169, v189
    v_accvgpr_read_b32 v189, a170
    v_mul_f32 v189, v189, v191
    v_accvgpr_write_b32 a170, v189
    v_accvgpr_read_b32 v189, a171
    v_mul_f32 v189, v189, v191
    v_accvgpr_write_b32 a171, v189
    v_accvgpr_read_b32 v189, a172
    v_mul_f32 v189, v189, v191
    v_accvgpr_write_b32 a172, v189
    v_accvgpr_read_b32 v189, a173
    v_mul_f32 v189, v189, v191
    v_accvgpr_write_b32 a173, v189
    v_accvgpr_read_b32 v189, a174
    v_mul_f32 v189, v189, v191
    v_accvgpr_write_b32 a174, v189
    v_accvgpr_read_b32 v189, a175
    v_mul_f32 v189, v189, v191
    v_accvgpr_write_b32 a175, v189
    v_accvgpr_read_b32 v189, a176
    v_mul_f32 v189, v189, v191
    v_accvgpr_write_b32 a176, v189
    v_accvgpr_read_b32 v189, a177
    v_mul_f32 v189, v189, v191
    v_accvgpr_write_b32 a177, v189
    v_accvgpr_read_b32 v189, a178
    v_mul_f32 v189, v189, v191
    v_accvgpr_write_b32 a178, v189
    v_accvgpr_read_b32 v189, a179
    v_mul_f32 v189, v189, v191
    v_accvgpr_write_b32 a179, v189
    v_accvgpr_read_b32 v189, a180
    v_mul_f32 v189, v189, v191
    v_accvgpr_write_b32 a180, v189
    v_accvgpr_read_b32 v189, a181
    v_mul_f32 v189, v189, v191
    v_accvgpr_write_b32 a181, v189
    v_accvgpr_read_b32 v189, a182
    v_mul_f32 v189, v189, v191
    v_accvgpr_write_b32 a182, v189
    v_accvgpr_read_b32 v189, a183
    v_mul_f32 v189, v189, v191
    v_accvgpr_write_b32 a183, v189
    v_accvgpr_read_b32 v189, a184
    v_mul_f32 v189, v189, v191
    v_accvgpr_write_b32 a184, v189
    v_accvgpr_read_b32 v189, a185
    v_mul_f32 v189, v189, v191
    v_accvgpr_write_b32 a185, v189
    v_accvgpr_read_b32 v189, a186
    v_mul_f32 v189, v189, v191
    v_accvgpr_write_b32 a186, v189
    v_accvgpr_read_b32 v189, a187
    v_mul_f32 v189, v189, v191
    v_accvgpr_write_b32 a187, v189
    v_accvgpr_read_b32 v189, a188
    v_mul_f32 v189, v189, v191
    v_accvgpr_write_b32 a188, v189
    v_accvgpr_read_b32 v189, a189
    v_mul_f32 v189, v189, v191
    v_accvgpr_write_b32 a189, v189
    v_accvgpr_read_b32 v189, a190
    v_mul_f32 v189, v189, v191
    v_accvgpr_write_b32 a190, v189
    v_accvgpr_read_b32 v189, a191
    v_mul_f32 v189, v189, v191
    v_accvgpr_write_b32 a191, v189
    v_max3_f32 v190, v56, v57, v58
    v_max3_f32 v190, v190, v59, v60
    v_max3_f32 v190, v190, v61, v62
    v_max3_f32 v190, v190, v63, 0
    v_mov_b32 v188, v190
    s_nop 1
    v_permlane32_swap_b32 v188, v190
    s_nop 1
    v_max_f32 v190, v188, v190
    v_mov_b32 v188, v190
    s_nop 1
    v_permlane16_swap_b32 v188, v190
    s_nop 1
    v_max_f32 v190, v188, v190
    v_sub_f32 v191, 0, v190
    v_exp_f32 v191, v191
    v_sub_f32 v112, v112, v190
    v_sub_f32 v113, v113, v190
    v_sub_f32 v114, v114, v190
    v_sub_f32 v115, v115, v190
    v_sub_f32 v56, v56, v190
    v_sub_f32 v57, v57, v190
    v_sub_f32 v58, v58, v190
    v_sub_f32 v59, v59, v190
    v_sub_f32 v60, v60, v190
    v_sub_f32 v61, v61, v190
    v_sub_f32 v62, v62, v190
    v_sub_f32 v63, v63, v190
    v_sub_f32 v24, v24, v190
    v_sub_f32 v25, v25, v190
    v_sub_f32 v26, v26, v190
    v_sub_f32 v27, v27, v190
    v_sub_f32 v28, v28, v190
    v_sub_f32 v29, v29, v190
    v_sub_f32 v30, v30, v190
    v_sub_f32 v31, v31, v190
    v_mul_f32 v170, v170, v191
    v_accvgpr_read_b32 v189, a192
    v_mul_f32 v189, v189, v191
    v_accvgpr_write_b32 a192, v189
    v_accvgpr_read_b32 v189, a193
    v_mul_f32 v189, v189, v191
    v_accvgpr_write_b32 a193, v189
    v_accvgpr_read_b32 v189, a194
    v_mul_f32 v189, v189, v191
    v_accvgpr_write_b32 a194, v189
    v_accvgpr_read_b32 v189, a195
    v_mul_f32 v189, v189, v191
    v_accvgpr_write_b32 a195, v189
    v_accvgpr_read_b32 v189, a196
    v_mul_f32 v189, v189, v191
    v_accvgpr_write_b32 a196, v189
    v_accvgpr_read_b32 v189, a197
    v_mul_f32 v189, v189, v191
    v_accvgpr_write_b32 a197, v189
    v_accvgpr_read_b32 v189, a198
    v_mul_f32 v189, v189, v191
    v_accvgpr_write_b32 a198, v189
    v_accvgpr_read_b32 v189, a199
    v_mul_f32 v189, v189, v191
    v_accvgpr_write_b32 a199, v189
    v_accvgpr_read_b32 v189, a200
    v_mul_f32 v189, v189, v191
    v_accvgpr_write_b32 a200, v189
    v_accvgpr_read_b32 v189, a201
    v_mul_f32 v189, v189, v191
    v_accvgpr_write_b32 a201, v189
    v_accvgpr_read_b32 v189, a202
    v_mul_f32 v189, v189, v191
    v_accvgpr_write_b32 a202, v189
    v_accvgpr_read_b32 v189, a203
    v_mul_f32 v189, v189, v191
    v_accvgpr_write_b32 a203, v189
    v_accvgpr_read_b32 v189, a204
    v_mul_f32 v189, v189, v191
    v_accvgpr_write_b32 a204, v189
    v_accvgpr_read_b32 v189, a205
    v_mul_f32 v189, v189, v191
    v_accvgpr_write_b32 a205, v189
    v_accvgpr_read_b32 v189, a206
    v_mul_f32 v189, v189, v191
    v_accvgpr_write_b32 a206, v189
    v_accvgpr_read_b32 v189, a207
    v_mul_f32 v189, v189, v191
    v_accvgpr_write_b32 a207, v189
    v_accvgpr_read_b32 v189, a208
    v_mul_f32 v189, v189, v191
    v_accvgpr_write_b32 a208, v189
    v_accvgpr_read_b32 v189, a209
    v_mul_f32 v189, v189, v191
    v_accvgpr_write_b32 a209, v189
    v_accvgpr_read_b32 v189, a210
    v_mul_f32 v189, v189, v191
    v_accvgpr_write_b32 a210, v189
    v_accvgpr_read_b32 v189, a211
    v_mul_f32 v189, v189, v191
    v_accvgpr_write_b32 a211, v189
    v_accvgpr_read_b32 v189, a212
    v_mul_f32 v189, v189, v191
    v_accvgpr_write_b32 a212, v189
    v_accvgpr_read_b32 v189, a213
    v_mul_f32 v189, v189, v191
    v_accvgpr_write_b32 a213, v189
    v_accvgpr_read_b32 v189, a214
    v_mul_f32 v189, v189, v191
    v_accvgpr_write_b32 a214, v189
    v_accvgpr_read_b32 v189, a215
    v_mul_f32 v189, v189, v191
    v_accvgpr_write_b32 a215, v189
    v_accvgpr_read_b32 v189, a216
    v_mul_f32 v189, v189, v191
    v_accvgpr_write_b32 a216, v189
    v_accvgpr_read_b32 v189, a217
    v_mul_f32 v189, v189, v191
    v_accvgpr_write_b32 a217, v189
    v_accvgpr_read_b32 v189, a218
    v_mul_f32 v189, v189, v191
    v_accvgpr_write_b32 a218, v189
    v_accvgpr_read_b32 v189, a219
    v_mul_f32 v189, v189, v191
    v_accvgpr_write_b32 a219, v189
    v_accvgpr_read_b32 v189, a220
    v_mul_f32 v189, v189, v191
    v_accvgpr_write_b32 a220, v189
    v_accvgpr_read_b32 v189, a221
    v_mul_f32 v189, v189, v191
    v_accvgpr_write_b32 a221, v189
    v_accvgpr_read_b32 v189, a222
    v_mul_f32 v189, v189, v191
    v_accvgpr_write_b32 a222, v189
    v_accvgpr_read_b32 v189, a223
    v_mul_f32 v189, v189, v191
    v_accvgpr_write_b32 a223, v189
    v_max3_f32 v190, v64, v65, v66
    v_max3_f32 v190, v190, v67, v68
    v_max3_f32 v190, v190, v69, v70
    v_max3_f32 v190, v190, v71, 0
    v_mov_b32 v188, v190
    s_nop 1
    v_permlane32_swap_b32 v188, v190
    s_nop 1
    v_max_f32 v190, v188, v190
    v_mov_b32 v188, v190
    s_nop 1
    v_permlane16_swap_b32 v188, v190
    s_nop 1
    v_max_f32 v190, v188, v190
    v_sub_f32 v191, 0, v190
    v_exp_f32 v191, v191
    v_sub_f32 v116, v116, v190
    v_sub_f32 v117, v117, v190
    v_sub_f32 v118, v118, v190
    v_sub_f32 v119, v119, v190
    v_sub_f32 v64, v64, v190
    v_sub_f32 v65, v65, v190
    v_sub_f32 v66, v66, v190
    v_sub_f32 v67, v67, v190
    v_sub_f32 v68, v68, v190
    v_sub_f32 v69, v69, v190
    v_sub_f32 v70, v70, v190
    v_sub_f32 v71, v71, v190
    v_sub_f32 v32, v32, v190
    v_sub_f32 v33, v33, v190
    v_sub_f32 v34, v34, v190
    v_sub_f32 v35, v35, v190
    v_sub_f32 v36, v36, v190
    v_sub_f32 v37, v37, v190
    v_sub_f32 v38, v38, v190
    v_sub_f32 v39, v39, v190
    v_mul_f32 v171, v171, v191
    v_accvgpr_read_b32 v189, a224
    v_mul_f32 v189, v189, v191
    v_accvgpr_write_b32 a224, v189
    v_accvgpr_read_b32 v189, a225
    v_mul_f32 v189, v189, v191
    v_accvgpr_write_b32 a225, v189
    v_accvgpr_read_b32 v189, a226
    v_mul_f32 v189, v189, v191
    v_accvgpr_write_b32 a226, v189
    v_accvgpr_read_b32 v189, a227
    v_mul_f32 v189, v189, v191
    v_accvgpr_write_b32 a227, v189
    v_accvgpr_read_b32 v189, a228
    v_mul_f32 v189, v189, v191
    v_accvgpr_write_b32 a228, v189
    v_accvgpr_read_b32 v189, a229
    v_mul_f32 v189, v189, v191
    v_accvgpr_write_b32 a229, v189
    v_accvgpr_read_b32 v189, a230
    v_mul_f32 v189, v189, v191
    v_accvgpr_write_b32 a230, v189
    v_accvgpr_read_b32 v189, a231
    v_mul_f32 v189, v189, v191
    v_accvgpr_write_b32 a231, v189
    v_accvgpr_read_b32 v189, a232
    v_mul_f32 v189, v189, v191
    v_accvgpr_write_b32 a232, v189
    v_accvgpr_read_b32 v189, a233
    v_mul_f32 v189, v189, v191
    v_accvgpr_write_b32 a233, v189
    v_accvgpr_read_b32 v189, a234
    v_mul_f32 v189, v189, v191
    v_accvgpr_write_b32 a234, v189
    v_accvgpr_read_b32 v189, a235
    v_mul_f32 v189, v189, v191
    v_accvgpr_write_b32 a235, v189
    v_accvgpr_read_b32 v189, a236
    v_mul_f32 v189, v189, v191
    v_accvgpr_write_b32 a236, v189
    v_accvgpr_read_b32 v189, a237
    v_mul_f32 v189, v189, v191
    v_accvgpr_write_b32 a237, v189
    v_accvgpr_read_b32 v189, a238
    v_mul_f32 v189, v189, v191
    v_accvgpr_write_b32 a238, v189
    v_accvgpr_read_b32 v189, a239
    v_mul_f32 v189, v189, v191
    v_accvgpr_write_b32 a239, v189
    v_accvgpr_read_b32 v189, a240
    v_mul_f32 v189, v189, v191
    v_accvgpr_write_b32 a240, v189
    v_accvgpr_read_b32 v189, a241
    v_mul_f32 v189, v189, v191
    v_accvgpr_write_b32 a241, v189
    v_accvgpr_read_b32 v189, a242
    v_mul_f32 v189, v189, v191
    v_accvgpr_write_b32 a242, v189
    v_accvgpr_read_b32 v189, a243
    v_mul_f32 v189, v189, v191
    v_accvgpr_write_b32 a243, v189
    v_accvgpr_read_b32 v189, a244
    v_mul_f32 v189, v189, v191
    v_accvgpr_write_b32 a244, v189
    v_accvgpr_read_b32 v189, a245
    v_mul_f32 v189, v189, v191
    v_accvgpr_write_b32 a245, v189
    v_accvgpr_read_b32 v189, a246
    v_mul_f32 v189, v189, v191
    v_accvgpr_write_b32 a246, v189
    v_accvgpr_read_b32 v189, a247
    v_mul_f32 v189, v189, v191
    v_accvgpr_write_b32 a247, v189
    v_accvgpr_read_b32 v189, a248
    v_mul_f32 v189, v189, v191
    v_accvgpr_write_b32 a248, v189
    v_accvgpr_read_b32 v189, a249
    v_mul_f32 v189, v189, v191
    v_accvgpr_write_b32 a249, v189
    v_accvgpr_read_b32 v189, a250
    v_mul_f32 v189, v189, v191
    v_accvgpr_write_b32 a250, v189
    v_accvgpr_read_b32 v189, a251
    v_mul_f32 v189, v189, v191
    v_accvgpr_write_b32 a251, v189
    v_accvgpr_read_b32 v189, a252
    v_mul_f32 v189, v189, v191
    v_accvgpr_write_b32 a252, v189
    v_accvgpr_read_b32 v189, a253
    v_mul_f32 v189, v189, v191
    v_accvgpr_write_b32 a253, v189
    v_accvgpr_read_b32 v189, a254
    v_mul_f32 v189, v189, v191
    v_accvgpr_write_b32 a254, v189
    v_accvgpr_read_b32 v189, a255
    v_mul_f32 v189, v189, v191
    v_accvgpr_write_b32 a255, v189
    v_exp_f32 v132, v40
    s_nop 0
    v_exp_f32 v133, v41
    s_nop 0
    v_add_f32 v120, v132, v133
    v_cvt_pk_bf16_f32 v88, v132, v133
    v_exp_f32 v134, v42
    s_nop 0
    v_add_f32 v120, v120, v134
    v_exp_f32 v135, v43
    s_nop 0
    v_add_f32 v120, v120, v135
    v_cvt_pk_bf16_f32 v89, v134, v135
    v_exp_f32 v136, v44
    s_nop 0
    v_add_f32 v120, v120, v136
    v_exp_f32 v137, v45
    s_nop 0
    v_add_f32 v120, v120, v137
    v_cvt_pk_bf16_f32 v90, v136, v137
    v_exp_f32 v138, v46
    s_nop 0
    v_add_f32 v120, v120, v138
    v_exp_f32 v139, v47
    s_nop 0
    v_add_f32 v120, v120, v139
    v_cvt_pk_bf16_f32 v91, v138, v139
    v_mov_b32 v188, v120
    s_nop 1
    v_permlane32_swap_b32 v188, v120
    s_nop 1
    v_add_f32 v120, v188, v120
    v_mov_b32 v188, v120
    s_nop 1
    v_permlane16_swap_b32 v188, v120
    s_nop 1
    v_add_f32 v120, v188, v120
    v_exp_f32 v140, v56
    s_nop 0
    v_exp_f32 v141, v57
    s_nop 0
    v_add_f32 v166, v140, v141
    v_cvt_pk_bf16_f32 v96, v140, v141
    v_exp_f32 v142, v58
    s_nop 0
    v_add_f32 v166, v166, v142
    v_exp_f32 v143, v59
    s_nop 0
    v_add_f32 v166, v166, v143
    v_cvt_pk_bf16_f32 v97, v142, v143
    v_exp_f32 v144, v60
    s_nop 0
    v_add_f32 v166, v166, v144
    v_exp_f32 v145, v61
    s_nop 0
    v_add_f32 v166, v166, v145
    v_cvt_pk_bf16_f32 v98, v144, v145
    v_exp_f32 v146, v62
    s_nop 0
    v_add_f32 v166, v166, v146
    v_exp_f32 v147, v63
    s_nop 0
    v_add_f32 v166, v166, v147
    v_cvt_pk_bf16_f32 v99, v146, v147
    v_exp_f32 v148, v48
    s_nop 0
    v_exp_f32 v149, v49
    s_nop 0
    v_add_f32 v124, v148, v149
    v_cvt_pk_bf16_f32 v92, v148, v149
    v_exp_f32 v150, v50
    s_nop 0
    v_add_f32 v124, v124, v150
    v_exp_f32 v151, v51
    s_nop 0
    v_add_f32 v124, v124, v151
    v_cvt_pk_bf16_f32 v93, v150, v151
    v_exp_f32 v152, v52
    s_nop 0
    v_add_f32 v124, v124, v152
    v_exp_f32 v153, v53
    s_nop 0
    v_add_f32 v124, v124, v153
    v_cvt_pk_bf16_f32 v94, v152, v153
    v_exp_f32 v154, v54
    s_nop 0
    v_add_f32 v124, v124, v154
    v_exp_f32 v155, v55
    s_nop 0
    v_add_f32 v124, v124, v155
    v_cvt_pk_bf16_f32 v95, v154, v155
    v_mov_b32 v188, v124
    s_nop 1
    v_permlane32_swap_b32 v188, v124
    s_nop 1
    v_add_f32 v124, v188, v124
    v_mov_b32 v188, v124
    s_nop 1
    v_permlane16_swap_b32 v188, v124
    s_nop 1
    v_add_f32 v124, v188, v124
    v_exp_f32 v156, v64
    s_nop 0
    v_exp_f32 v157, v65
    s_nop 0
    v_add_f32 v167, v156, v157
    v_cvt_pk_bf16_f32 v100, v156, v157
    v_exp_f32 v158, v66
    s_nop 0
    v_add_f32 v167, v167, v158
    v_exp_f32 v159, v67
    s_nop 0
    v_add_f32 v167, v167, v159
    v_cvt_pk_bf16_f32 v101, v158, v159
    v_exp_f32 v160, v68
    s_nop 0
    v_add_f32 v167, v167, v160
    v_exp_f32 v161, v69
    s_nop 0
    v_add_f32 v167, v167, v161
    v_cvt_pk_bf16_f32 v102, v160, v161
    v_exp_f32 v162, v70
    s_nop 0
    v_add_f32 v167, v167, v162
    v_exp_f32 v163, v71
    s_nop 0
    v_add_f32 v167, v167, v163
    v_cvt_pk_bf16_f32 v103, v162, v163
    v_exp_f32 v132, v8
    s_nop 0
    v_exp_f32 v133, v9
    s_nop 0
    v_cvt_pk_bf16_f32 v72, v132, v133
    s_nop 0
    v_exp_f32 v134, v10
    s_nop 0
    s_nop 3
    s_setpc_b64 s[50:51]
mk_rare2:
    s_nop 15
    v_max3_f32 v190, v40, v41, v42
    v_max3_f32 v190, v190, v43, v44
    v_max3_f32 v190, v190, v45, v46
    v_max3_f32 v190, v190, v47, 0
    v_mov_b32 v188, v190
    s_nop 1
    v_permlane32_swap_b32 v188, v190
    s_nop 1
    v_max_f32 v190, v188, v190
    v_mov_b32 v188, v190
    s_nop 1
    v_permlane16_swap_b32 v188, v190
    s_nop 1
    v_max_f32 v190, v188, v190
    v_sub_f32 v191, 0, v190
    v_exp_f32 v191, v191
    v_sub_f32 v104, v104, v190
    v_sub_f32 v105, v105, v190
    v_sub_f32 v106, v106, v190
    v_sub_f32 v107, v107, v190
    v_sub_f32 v40, v40, v190
    v_sub_f32 v41, v41, v190
    v_sub_f32 v42, v42, v190
    v_sub_f32 v43, v43, v190
    v_sub_f32 v44, v44, v190
    v_sub_f32 v45, v45, v190
    v_sub_f32 v46, v46, v190
    v_sub_f32 v47, v47, v190
    v_sub_f32 v8, v8, v190
    v_sub_f32 v9, v9, v190
    v_sub_f32 v10, v10, v190
    v_sub_f32 v11, v11, v190
    v_sub_f32 v12, v12, v190
    v_sub_f32 v13, v13, v190
    v_sub_f32 v14, v14, v190
    v_sub_f32 v15, v15, v190
    v_mul_f32 v168, v168, v191
    v_accvgpr_read_b32 v189, a128
    v_mul_f32 v189, v189, v191
    v_accvgpr_write_b32 a128, v189
    v_accvgpr_read_b32 v189, a129
    v_mul_f32 v189, v189, v191
    v_accvgpr_write_b32 a129, v189
    v_accvgpr_read_b32 v189, a130
    v_mul_f32 v189, v189, v191
    v_accvgpr_write_b32 a130, v189
    v_accvgpr_read_b32 v189, a131
    v_mul_f32 v189, v189, v191
    v_accvgpr_write_b32 a131, v189
    v_accvgpr_read_b32 v189, a132
    v_mul_f32 v189, v189, v191
    v_accvgpr_write_b32 a132, v189
    v_accvgpr_read_b32 v189, a133
    v_mul_f32 v189, v189, v191
    v_accvgpr_write_b32 a133, v189
    v_accvgpr_read_b32 v189, a134
    v_mul_f32 v189, v189, v191
    v_accvgpr_write_b32 a134, v189
    v_accvgpr_read_b32 v189, a135
    v_mul_f32 v189, v189, v191
    v_accvgpr_write_b32 a135, v189
    v_accvgpr_read_b32 v189, a136
    v_mul_f32 v189, v189, v191
    v_accvgpr_write_b32 a136, v189
    v_accvgpr_read_b32 v189, a137
    v_mul_f32 v189, v189, v191
    v_accvgpr_write_b32 a137, v189
    v_accvgpr_read_b32 v189, a138
    v_mul_f32 v189, v189, v191
    v_accvgpr_write_b32 a138, v189
    v_accvgpr_read_b32 v189, a139
    v_mul_f32 v189, v189, v191
    v_accvgpr_write_b32 a139, v189
    v_accvgpr_read_b32 v189, a140
    v_mul_f32 v189, v189, v191
    v_accvgpr_write_b32 a140, v189
    v_accvgpr_read_b32 v189, a141
    v_mul_f32 v189, v189, v191
    v_accvgpr_write_b32 a141, v189
    v_accvgpr_read_b32 v189, a142
    v_mul_f32 v189, v189, v191
    v_accvgpr_write_b32 a142, v189
    v_accvgpr_read_b32 v189, a143
    v_mul_f32 v189, v189, v191
    v_accvgpr_write_b32 a143, v189
    v_accvgpr_read_b32 v189, a144
    v_mul_f32 v189, v189, v191
    v_accvgpr_write_b32 a144, v189
    v_accvgpr_read_b32 v189, a145
    v_mul_f32 v189, v189, v191
    v_accvgpr_write_b32 a145, v189
    v_accvgpr_read_b32 v189, a146
    v_mul_f32 v189, v189, v191
    v_accvgpr_write_b32 a146, v189
    v_accvgpr_read_b32 v189, a147
    v_mul_f32 v189, v189, v191
    v_accvgpr_write_b32 a147, v189
    v_accvgpr_read_b32 v189, a148
    v_mul_f32 v189, v189, v191
    v_accvgpr_write_b32 a148, v189
    v_accvgpr_read_b32 v189, a149
    v_mul_f32 v189, v189, v191
    v_accvgpr_write_b32 a149, v189
    v_accvgpr_read_b32 v189, a150
    v_mul_f32 v189, v189, v191
    v_accvgpr_write_b32 a150, v189
    v_accvgpr_read_b32 v189, a151
    v_mul_f32 v189, v189, v191
    v_accvgpr_write_b32 a151, v189
    v_accvgpr_read_b32 v189, a152
    v_mul_f32 v189, v189, v191
    v_accvgpr_write_b32 a152, v189
    v_accvgpr_read_b32 v189, a153
    v_mul_f32 v189, v189, v191
    v_accvgpr_write_b32 a153, v189
    v_accvgpr_read_b32 v189, a154
    v_mul_f32 v189, v189, v191
    v_accvgpr_write_b32 a154, v189
    v_accvgpr_read_b32 v189, a155
    v_mul_f32 v189, v189, v191
    v_accvgpr_write_b32 a155, v189
    v_accvgpr_read_b32 v189, a156
    v_mul_f32 v189, v189, v191
    v_accvgpr_write_b32 a156, v189
    v_accvgpr_read_b32 v189, a157
    v_mul_f32 v189, v189, v191
    v_accvgpr_write_b32 a157, v189
    v_accvgpr_read_b32 v189, a158
    v_mul_f32 v189, v189, v191
    v_accvgpr_write_b32 a158, v189
    v_accvgpr_read_b32 v189, a159
    v_mul_f32 v189, v189, v191
    v_accvgpr_write_b32 a159, v189
    v_max3_f32 v190, v48, v49, v50
    v_max3_f32 v190, v190, v51, v52
    v_max3_f32 v190, v190, v53, v54
    v_max3_f32 v190, v190, v55, 0
    v_mov_b32 v188, v190
    s_nop 1
    v_permlane32_swap_b32 v188, v190
    s_nop 1
    v_max_f32 v190, v188, v190
    v_mov_b32 v188, v190
    s_nop 1
    v_permlane16_swap_b32 v188, v190
    s_nop 1
    v_max_f32 v190, v188, v190
    v_sub_f32 v191, 0, v190
    v_exp_f32 v191, v191
    v_sub_f32 v108, v108, v190
    v_sub_f32 v109, v109, v190
    v_sub_f32 v110, v110, v190
    v_sub_f32 v111, v111, v190
    v_sub_f32 v48, v48, v190
    v_sub_f32 v49, v49, v190
    v_sub_f32 v50, v50, v190
    v_sub_f32 v51, v51, v190
    v_sub_f32 v52, v52, v190
    v_sub_f32 v53, v53, v190
    v_sub_f32 v54, v54, v190
    v_sub_f32 v55, v55, v190
    v_sub_f32 v16, v16, v190
    v_sub_f32 v17, v17, v190
    v_sub_f32 v18, v18, v190
    v_sub_f32 v19, v19, v190
    v_sub_f32 v20, v20, v190
    v_sub_f32 v21, v21, v190
    v_sub_f32 v22, v22, v190
    v_sub_f32 v23, v23, v190
    v_mul_f32 v169, v169, v191
    v_accvgpr_read_b32 v189, a160
    v_mul_f32 v189, v189, v191
    v_accvgpr_write_b32 a160, v189
    v_accvgpr_read_b32 v189, a161
    v_mul_f32 v189, v189, v191
    v_accvgpr_write_b32 a161, v189
    v_accvgpr_read_b32 v189, a162
    v_mul_f32 v189, v189, v191
    v_accvgpr_write_b32 a162, v189
    v_accvgpr_read_b32 v189, a163
    v_mul_f32 v189, v189, v191
    v_accvgpr_write_b32 a163, v189
    v_accvgpr_read_b32 v189, a164
    v_mul_f32 v189, v189, v191
    v_accvgpr_write_b32 a164, v189
    v_accvgpr_read_b32 v189, a165
    v_mul_f32 v189, v189, v191
    v_accvgpr_write_b32 a165, v189
    v_accvgpr_read_b32 v189, a166
    v_mul_f32 v189, v189, v191
    v_accvgpr_write_b32 a166, v189
    v_accvgpr_read_b32 v189, a167
    v_mul_f32 v189, v189, v191
    v_accvgpr_write_b32 a167, v189
    v_accvgpr_read_b32 v189, a168
    v_mul_f32 v189, v189, v191
    v_accvgpr_write_b32 a168, v189
    v_accvgpr_read_b32 v189, a169
    v_mul_f32 v189, v189, v191
    v_accvgpr_write_b32 a169, v189
    v_accvgpr_read_b32 v189, a170
    v_mul_f32 v189, v189, v191
    v_accvgpr_write_b32 a170, v189
    v_accvgpr_read_b32 v189, a171
    v_mul_f32 v189, v189, v191
    v_accvgpr_write_b32 a171, v189
    v_accvgpr_read_b32 v189, a172
    v_mul_f32 v189, v189, v191
    v_accvgpr_write_b32 a172, v189
    v_accvgpr_read_b32 v189, a173
    v_mul_f32 v189, v189, v191
    v_accvgpr_write_b32 a173, v189
    v_accvgpr_read_b32 v189, a174
    v_mul_f32 v189, v189, v191
    v_accvgpr_write_b32 a174, v189
    v_accvgpr_read_b32 v189, a175
    v_mul_f32 v189, v189, v191
    v_accvgpr_write_b32 a175, v189
    v_accvgpr_read_b32 v189, a176
    v_mul_f32 v189, v189, v191
    v_accvgpr_write_b32 a176, v189
    v_accvgpr_read_b32 v189, a177
    v_mul_f32 v189, v189, v191
    v_accvgpr_write_b32 a177, v189
    v_accvgpr_read_b32 v189, a178
    v_mul_f32 v189, v189, v191
    v_accvgpr_write_b32 a178, v189
    v_accvgpr_read_b32 v189, a179
    v_mul_f32 v189, v189, v191
    v_accvgpr_write_b32 a179, v189
    v_accvgpr_read_b32 v189, a180
    v_mul_f32 v189, v189, v191
    v_accvgpr_write_b32 a180, v189
    v_accvgpr_read_b32 v189, a181
    v_mul_f32 v189, v189, v191
    v_accvgpr_write_b32 a181, v189
    v_accvgpr_read_b32 v189, a182
    v_mul_f32 v189, v189, v191
    v_accvgpr_write_b32 a182, v189
    v_accvgpr_read_b32 v189, a183
    v_mul_f32 v189, v189, v191
    v_accvgpr_write_b32 a183, v189
    v_accvgpr_read_b32 v189, a184
    v_mul_f32 v189, v189, v191
    v_accvgpr_write_b32 a184, v189
    v_accvgpr_read_b32 v189, a185
    v_mul_f32 v189, v189, v191
    v_accvgpr_write_b32 a185, v189
    v_accvgpr_read_b32 v189, a186
    v_mul_f32 v189, v189, v191
    v_accvgpr_write_b32 a186, v189
    v_accvgpr_read_b32 v189, a187
    v_mul_f32 v189, v189, v191
    v_accvgpr_write_b32 a187, v189
    v_accvgpr_read_b32 v189, a188
    v_mul_f32 v189, v189, v191
    v_accvgpr_write_b32 a188, v189
    v_accvgpr_read_b32 v189, a189
    v_mul_f32 v189, v189, v191
    v_accvgpr_write_b32 a189, v189
    v_accvgpr_read_b32 v189, a190
    v_mul_f32 v189, v189, v191
    v_accvgpr_write_b32 a190, v189
    v_accvgpr_read_b32 v189, a191
    v_mul_f32 v189, v189, v191
    v_accvgpr_write_b32 a191, v189
    v_max3_f32 v190, v56, v57, v58
    v_max3_f32 v190, v190, v59, v60
    v_max3_f32 v190, v190, v61, v62
    v_max3_f32 v190, v190, v63, 0
    v_mov_b32 v188, v190
    s_nop 1
    v_permlane32_swap_b32 v188, v190
    s_nop 1
    v_max_f32 v190, v188, v190
    v_mov_b32 v188, v190
    s_nop 1
    v_permlane16_swap_b32 v188, v190
    s_nop 1
    v_max_f32 v190, v188, v190
    v_sub_f32 v191, 0, v190
    v_exp_f32 v191, v191
    v_sub_f32 v112, v112, v190
    v_sub_f32 v113, v113, v190
    v_sub_f32 v114, v114, v190
    v_sub_f32 v115, v115, v190
    v_sub_f32 v56, v56, v190
    v_sub_f32 v57, v57, v190
    v_sub_f32 v58, v58, v190
    v_sub_f32 v59, v59, v190
    v_sub_f32 v60, v60, v190
    v_sub_f32 v61, v61, v190
    v_sub_f32 v62, v62, v190
    v_sub_f32 v63, v63, v190
    v_sub_f32 v24, v24, v190
    v_sub_f32 v25, v25, v190
    v_sub_f32 v26, v26, v190
    v_sub_f32 v27, v27, v190
    v_sub_f32 v28, v28, v190
    v_sub_f32 v29, v29, v190
    v_sub_f32 v30, v30, v190
    v_sub_f32 v31, v31, v190
    v_mul_f32 v170, v170, v191
    v_accvgpr_read_b32 v189, a192
    v_mul_f32 v189, v189, v191
    v_accvgpr_write_b32 a192, v189
    v_accvgpr_read_b32 v189, a193
    v_mul_f32 v189, v189, v191
    v_accvgpr_write_b32 a193, v189
    v_accvgpr_read_b32 v189, a194
    v_mul_f32 v189, v189, v191
    v_accvgpr_write_b32 a194, v189
    v_accvgpr_read_b32 v189, a195
    v_mul_f32 v189, v189, v191
    v_accvgpr_write_b32 a195, v189
    v_accvgpr_read_b32 v189, a196
    v_mul_f32 v189, v189, v191
    v_accvgpr_write_b32 a196, v189
    v_accvgpr_read_b32 v189, a197
    v_mul_f32 v189, v189, v191
    v_accvgpr_write_b32 a197, v189
    v_accvgpr_read_b32 v189, a198
    v_mul_f32 v189, v189, v191
    v_accvgpr_write_b32 a198, v189
    v_accvgpr_read_b32 v189, a199
    v_mul_f32 v189, v189, v191
    v_accvgpr_write_b32 a199, v189
    v_accvgpr_read_b32 v189, a200
    v_mul_f32 v189, v189, v191
    v_accvgpr_write_b32 a200, v189
    v_accvgpr_read_b32 v189, a201
    v_mul_f32 v189, v189, v191
    v_accvgpr_write_b32 a201, v189
    v_accvgpr_read_b32 v189, a202
    v_mul_f32 v189, v189, v191
    v_accvgpr_write_b32 a202, v189
    v_accvgpr_read_b32 v189, a203
    v_mul_f32 v189, v189, v191
    v_accvgpr_write_b32 a203, v189
    v_accvgpr_read_b32 v189, a204
    v_mul_f32 v189, v189, v191
    v_accvgpr_write_b32 a204, v189
    v_accvgpr_read_b32 v189, a205
    v_mul_f32 v189, v189, v191
    v_accvgpr_write_b32 a205, v189
    v_accvgpr_read_b32 v189, a206
    v_mul_f32 v189, v189, v191
    v_accvgpr_write_b32 a206, v189
    v_accvgpr_read_b32 v189, a207
    v_mul_f32 v189, v189, v191
    v_accvgpr_write_b32 a207, v189
    v_accvgpr_read_b32 v189, a208
    v_mul_f32 v189, v189, v191
    v_accvgpr_write_b32 a208, v189
    v_accvgpr_read_b32 v189, a209
    v_mul_f32 v189, v189, v191
    v_accvgpr_write_b32 a209, v189
    v_accvgpr_read_b32 v189, a210
    v_mul_f32 v189, v189, v191
    v_accvgpr_write_b32 a210, v189
    v_accvgpr_read_b32 v189, a211
    v_mul_f32 v189, v189, v191
    v_accvgpr_write_b32 a211, v189
    v_accvgpr_read_b32 v189, a212
    v_mul_f32 v189, v189, v191
    v_accvgpr_write_b32 a212, v189
    v_accvgpr_read_b32 v189, a213
    v_mul_f32 v189, v189, v191
    v_accvgpr_write_b32 a213, v189
    v_accvgpr_read_b32 v189, a214
    v_mul_f32 v189, v189, v191
    v_accvgpr_write_b32 a214, v189
    v_accvgpr_read_b32 v189, a215
    v_mul_f32 v189, v189, v191
    v_accvgpr_write_b32 a215, v189
    v_accvgpr_read_b32 v189, a216
    v_mul_f32 v189, v189, v191
    v_accvgpr_write_b32 a216, v189
    v_accvgpr_read_b32 v189, a217
    v_mul_f32 v189, v189, v191
    v_accvgpr_write_b32 a217, v189
    v_accvgpr_read_b32 v189, a218
    v_mul_f32 v189, v189, v191
    v_accvgpr_write_b32 a218, v189
    v_accvgpr_read_b32 v189, a219
    v_mul_f32 v189, v189, v191
    v_accvgpr_write_b32 a219, v189
    v_accvgpr_read_b32 v189, a220
    v_mul_f32 v189, v189, v191
    v_accvgpr_write_b32 a220, v189
    v_accvgpr_read_b32 v189, a221
    v_mul_f32 v189, v189, v191
    v_accvgpr_write_b32 a221, v189
    v_accvgpr_read_b32 v189, a222
    v_mul_f32 v189, v189, v191
    v_accvgpr_write_b32 a222, v189
    v_accvgpr_read_b32 v189, a223
    v_mul_f32 v189, v189, v191
    v_accvgpr_write_b32 a223, v189
    v_max3_f32 v190, v64, v65, v66
    v_max3_f32 v190, v190, v67, v68
    v_max3_f32 v190, v190, v69, v70
    v_max3_f32 v190, v190, v71, 0
    v_mov_b32 v188, v190
    s_nop 1
    v_permlane32_swap_b32 v188, v190
    s_nop 1
    v_max_f32 v190, v188, v190
    v_mov_b32 v188, v190
    s_nop 1
    v_permlane16_swap_b32 v188, v190
    s_nop 1
    v_max_f32 v190, v188, v190
    v_sub_f32 v191, 0, v190
    v_exp_f32 v191, v191
    v_sub_f32 v116, v116, v190
    v_sub_f32 v117, v117, v190
    v_sub_f32 v118, v118, v190
    v_sub_f32 v119, v119, v190
    v_sub_f32 v64, v64, v190
    v_sub_f32 v65, v65, v190
    v_sub_f32 v66, v66, v190
    v_sub_f32 v67, v67, v190
    v_sub_f32 v68, v68, v190
    v_sub_f32 v69, v69, v190
    v_sub_f32 v70, v70, v190
    v_sub_f32 v71, v71, v190
    v_sub_f32 v32, v32, v190
    v_sub_f32 v33, v33, v190
    v_sub_f32 v34, v34, v190
    v_sub_f32 v35, v35, v190
    v_sub_f32 v36, v36, v190
    v_sub_f32 v37, v37, v190
    v_sub_f32 v38, v38, v190
    v_sub_f32 v39, v39, v190
    v_mul_f32 v171, v171, v191
    v_accvgpr_read_b32 v189, a224
    v_mul_f32 v189, v189, v191
    v_accvgpr_write_b32 a224, v189
    v_accvgpr_read_b32 v189, a225
    v_mul_f32 v189, v189, v191
    v_accvgpr_write_b32 a225, v189
    v_accvgpr_read_b32 v189, a226
    v_mul_f32 v189, v189, v191
    v_accvgpr_write_b32 a226, v189
    v_accvgpr_read_b32 v189, a227
    v_mul_f32 v189, v189, v191
    v_accvgpr_write_b32 a227, v189
    v_accvgpr_read_b32 v189, a228
    v_mul_f32 v189, v189, v191
    v_accvgpr_write_b32 a228, v189
    v_accvgpr_read_b32 v189, a229
    v_mul_f32 v189, v189, v191
    v_accvgpr_write_b32 a229, v189
    v_accvgpr_read_b32 v189, a230
    v_mul_f32 v189, v189, v191
    v_accvgpr_write_b32 a230, v189
    v_accvgpr_read_b32 v189, a231
    v_mul_f32 v189, v189, v191
    v_accvgpr_write_b32 a231, v189
    v_accvgpr_read_b32 v189, a232
    v_mul_f32 v189, v189, v191
    v_accvgpr_write_b32 a232, v189
    v_accvgpr_read_b32 v189, a233
    v_mul_f32 v189, v189, v191
    v_accvgpr_write_b32 a233, v189
    v_accvgpr_read_b32 v189, a234
    v_mul_f32 v189, v189, v191
    v_accvgpr_write_b32 a234, v189
    v_accvgpr_read_b32 v189, a235
    v_mul_f32 v189, v189, v191
    v_accvgpr_write_b32 a235, v189
    v_accvgpr_read_b32 v189, a236
    v_mul_f32 v189, v189, v191
    v_accvgpr_write_b32 a236, v189
    v_accvgpr_read_b32 v189, a237
    v_mul_f32 v189, v189, v191
    v_accvgpr_write_b32 a237, v189
    v_accvgpr_read_b32 v189, a238
    v_mul_f32 v189, v189, v191
    v_accvgpr_write_b32 a238, v189
    v_accvgpr_read_b32 v189, a239
    v_mul_f32 v189, v189, v191
    v_accvgpr_write_b32 a239, v189
    v_accvgpr_read_b32 v189, a240
    v_mul_f32 v189, v189, v191
    v_accvgpr_write_b32 a240, v189
    v_accvgpr_read_b32 v189, a241
    v_mul_f32 v189, v189, v191
    v_accvgpr_write_b32 a241, v189
    v_accvgpr_read_b32 v189, a242
    v_mul_f32 v189, v189, v191
    v_accvgpr_write_b32 a242, v189
    v_accvgpr_read_b32 v189, a243
    v_mul_f32 v189, v189, v191
    v_accvgpr_write_b32 a243, v189
    v_accvgpr_read_b32 v189, a244
    v_mul_f32 v189, v189, v191
    v_accvgpr_write_b32 a244, v189
    v_accvgpr_read_b32 v189, a245
    v_mul_f32 v189, v189, v191
    v_accvgpr_write_b32 a245, v189
    v_accvgpr_read_b32 v189, a246
    v_mul_f32 v189, v189, v191
    v_accvgpr_write_b32 a246, v189
    v_accvgpr_read_b32 v189, a247
    v_mul_f32 v189, v189, v191
    v_accvgpr_write_b32 a247, v189
    v_accvgpr_read_b32 v189, a248
    v_mul_f32 v189, v189, v191
    v_accvgpr_write_b32 a248, v189
    v_accvgpr_read_b32 v189, a249
    v_mul_f32 v189, v189, v191
    v_accvgpr_write_b32 a249, v189
    v_accvgpr_read_b32 v189, a250
    v_mul_f32 v189, v189, v191
    v_accvgpr_write_b32 a250, v189
    v_accvgpr_read_b32 v189, a251
    v_mul_f32 v189, v189, v191
    v_accvgpr_write_b32 a251, v189
    v_accvgpr_read_b32 v189, a252
    v_mul_f32 v189, v189, v191
    v_accvgpr_write_b32 a252, v189
    v_accvgpr_read_b32 v189, a253
    v_mul_f32 v189, v189, v191
    v_accvgpr_write_b32 a253, v189
    v_accvgpr_read_b32 v189, a254
    v_mul_f32 v189, v189, v191
    v_accvgpr_write_b32 a254, v189
    v_accvgpr_read_b32 v189, a255
    v_mul_f32 v189, v189, v191
    v_accvgpr_write_b32 a255, v189
    v_exp_f32 v132, v40
    s_nop 0
    v_exp_f32 v133, v41
    s_nop 0
    v_add_f32 v120, v132, v133
    v_cvt_pk_bf16_f32 v88, v132, v133
    v_exp_f32 v134, v42
    s_nop 0
    v_add_f32 v120, v120, v134
    v_exp_f32 v135, v43
    s_nop 0
    v_add_f32 v120, v120, v135
    v_cvt_pk_bf16_f32 v89, v134, v135
    v_exp_f32 v136, v44
    s_nop 0
    v_add_f32 v120, v120, v136
    v_exp_f32 v137, v45
    s_nop 0
    v_add_f32 v120, v120, v137
    v_cvt_pk_bf16_f32 v90, v136, v137
    v_exp_f32 v138, v46
    s_nop 0
    v_add_f32 v120, v120, v138
    v_exp_f32 v139, v47
    s_nop 0
    v_add_f32 v120, v120, v139
    v_cvt_pk_bf16_f32 v91, v138, v139
    v_mov_b32 v188, v120
    s_nop 1
    v_permlane32_swap_b32 v188, v120
    s_nop 1
    v_add_f32 v120, v188, v120
    v_mov_b32 v188, v120
    s_nop 1
    v_permlane16_swap_b32 v188, v120
    s_nop 1
    v_add_f32 v120, v188, v120
    v_exp_f32 v140, v56
    s_nop 0
    v_exp_f32 v141, v57
    s_nop 0
    v_add_f32 v166, v140, v141
    v_cvt_pk_bf16_f32 v96, v140, v141
    v_exp_f32 v142, v58
    s_nop 0
    v_add_f32 v166, v166, v142
    v_exp_f32 v143, v59
    s_nop 0
    v_add_f32 v166, v166, v143
    v_cvt_pk_bf16_f32 v97, v142, v143
    v_exp_f32 v144, v60
    s_nop 0
    v_add_f32 v166, v166, v144
    v_exp_f32 v145, v61
    s_nop 0
    v_add_f32 v166, v166, v145
    v_cvt_pk_bf16_f32 v98, v144, v145
    v_exp_f32 v146, v62
    s_nop 0
    v_add_f32 v166, v166, v146
    v_exp_f32 v147, v63
    s_nop 0
    v_add_f32 v166, v166, v147
    v_cvt_pk_bf16_f32 v99, v146, v147
    v_exp_f32 v148, v48
    s_nop 0
    v_exp_f32 v149, v49
    s_nop 0
    v_add_f32 v124, v148, v149
    v_cvt_pk_bf16_f32 v92, v148, v149
    v_exp_f32 v150, v50
    s_nop 0
    v_add_f32 v124, v124, v150
    v_exp_f32 v151, v51
    s_nop 0
    v_add_f32 v124, v124, v151
    v_cvt_pk_bf16_f32 v93, v150, v151
    v_exp_f32 v152, v52
    s_nop 0
    v_add_f32 v124, v124, v152
    v_exp_f32 v153, v53
    s_nop 0
    v_add_f32 v124, v124, v153
    v_cvt_pk_bf16_f32 v94, v152, v153
    v_exp_f32 v154, v54
    s_nop 0
    v_add_f32 v124, v124, v154
    v_exp_f32 v155, v55
    s_nop 0
    v_add_f32 v124, v124, v155
    v_cvt_pk_bf16_f32 v95, v154, v155
    v_mov_b32 v188, v124
    s_nop 1
    v_permlane32_swap_b32 v188, v124
    s_nop 1
    v_add_f32 v124, v188, v124
    v_mov_b32 v188, v124
    s_nop 1
    v_permlane16_swap_b32 v188, v124
    s_nop 1
    v_add_f32 v124, v188, v124
    v_exp_f32 v156, v64
    s_nop 0
    v_exp_f32 v157, v65
    s_nop 0
    v_add_f32 v167, v156, v157
    v_cvt_pk_bf16_f32 v100, v156, v157
    v_exp_f32 v158, v66
    s_nop 0
    v_add_f32 v167, v167, v158
    v_exp_f32 v159, v67
    s_nop 0
    v_add_f32 v167, v167, v159
    v_cvt_pk_bf16_f32 v101, v158, v159
    v_exp_f32 v160, v68
    s_nop 0
    v_add_f32 v167, v167, v160
    v_exp_f32 v161, v69
    s_nop 0
    v_add_f32 v167, v167, v161
    v_cvt_pk_bf16_f32 v102, v160, v161
    v_exp_f32 v162, v70
    s_nop 0
    v_add_f32 v167, v167, v162
    v_exp_f32 v163, v71
    s_nop 0
    v_add_f32 v167, v167, v163
    v_cvt_pk_bf16_f32 v103, v162, v163
    s_nop 3
    s_setpc_b64 s[50:51]
mk_end:
    s_endpgm
.section .rodata,"a"
.p2align 6
.amdhsa_kernel recurrent_scan__gqa_block_cached__glu_gated_reglu__prompt_kernel
  .amdhsa_next_free_vgpr 512
  .amdhsa_next_free_sgpr 102
  .amdhsa_accum_offset 256
  .amdhsa_group_segment_fixed_size 0
  .amdhsa_kernarg_size 96
  .amdhsa_user_sgpr_count 2
  .amdhsa_user_sgpr_kernarg_segment_ptr 1
  .amdhsa_system_sgpr_workgroup_id_x 1
  .amdhsa_float_denorm_mode_32 3
.end_amdhsa_kernel
.text
```
